```python
import torch

def _softmax(x, axis=-1):
    return torch.softmax(x, dim=axis)

def _gelu(x):
    return torch.nn.functional.gelu(x, approximate='tanh')

def _silu(x):
    return torch.nn.functional.silu(x)

def _sigmoid(x):
    return torch.sigmoid(x)

def _layernorm(x, axis=-1, eps=1e-05):
    m = x.mean(dim=axis, keepdim=True)
    v = x.var(dim=axis, keepdim=True, unbiased=False)
    return (x - m) / torch.sqrt(v + eps)

def _scatter_add(tgt, idx, src, axis=0):
    return tgt.clone().index_add_(axis, idx, src)

def _segment_sum(src, seg, n):
    out = torch.zeros((n,) + src.shape[1:], dtype=src.dtype)
    return out.index_add_(0, seg, src)

def _pad(x, pw):
    flat = tuple((v for pair in reversed(pw) for v in pair))
    return torch.nn.functional.pad(x, flat)
kernel_name = 'standalone__autoregressive_conv_wavernn__speech'

def setup_inputs():

    _w = lambda a: (lambda t: t.to(torch.bfloat16) if t.is_floating_point() else t)(torch.as_tensor(a))
    B, T, D, K = (2, 16000, 512, 5)
    return {'x': _w((lambda *s: torch.randn(*s, dtype=torch.bfloat16) * 0.05)(B, T, D)), 'w': _w((lambda *s: torch.randn(*s, dtype=torch.bfloat16) * 0.05)(K, D, 2 * D))}

def reference(x, w):
    B, T, D = x.shape
    K = w.shape[0]
    dil = 2
    pad = (K - 1) * dil
    xp = _pad(x, ((0, 0), (pad, 0), (0, 0)))
    h = torch.einsum('btd,de->bte', xp[:, 0:T, :], w[0])
    for i in range(1, K):
        h = h + torch.einsum('btd,de->bte', xp[:, i * dil:i * dil + T, :], w[i])
    f, g = (h[..., :D].clone(), h[..., D:].clone())
    return torch.tanh(f) * _sigmoid(g)
```

```asm
; @launch grid=(256,1,1) block=(256,1,1) lds=161792
.amdgcn_target "amdgcn-amd-amdhsa--gfx950"
.text
.globl standalone__autoregressive_conv_wavernn__speech_kernel
.p2align 8
.type standalone__autoregressive_conv_wavernn__speech_kernel,@function
standalone__autoregressive_conv_wavernn__speech_kernel:
 s_load_dwordx8 s[16:23], s[0:1], 0
 s_cmp_ge_u32 s2, 256
 s_cbranch_scc1 L_done
 s_and_b32 s34, s2, 7
 s_lshr_b32 s35, s2, 3
 s_and_b32 s24, s35, 3
 s_lshr_b32 s35, s35, 2
 s_lshl_b32 s35, s35, 3
 s_add_u32 s34, s34, s35
 s_cmp_ge_u32 s34, 32
 s_cselect_b32 s39, 16384000, 0
 s_and_b32 s34, s34, 31
 s_lshl_b32 s44, s34, 18
 s_sub_u32 s36, s44, 0x2000
 s_getpc_b64 s[86:87]
L_pc:
 s_add_u32 s88, s86, L_disp-L_pc
 s_addc_u32 s89, s87, 0
 s_add_u32 s86, s86, L_c0-L_pc
 s_addc_u32 s87, s87, 0
 v_lshlrev_b32 v47, 6, v0
 global_load_dword v44, v47, s[86:87]
 v_lshrrev_b32 v16, 6, v0
 v_and_b32 v17, 63, v0
 v_lshrrev_b32 v5, 2, v17
 v_readfirstlane_b32 s3, v16
 v_lshlrev_b32 v5, 11, v5
 v_and_b32 v18, 3, v17
 v_lshl_add_u32 v5, v18, 4, v5
 v_lshrrev_b32 v23, 3, v17
 v_and_b32 v19, 7, v17
 s_lshl_b32 s34, s24, 2
 s_add_u32 s34, s34, s3
 s_lshl_b32 s45, s34, 6
 s_mul_i32 s29, s3, 20480
 s_add_u32 s29, s29, 79872
 s_cmp_eq_u32 s3, 0
 s_cselect_b32 s29, 34816, s29
 s_mov_b32 s10, 5242880
 s_mov_b32 s11, 0x20000
 s_mov_b32 s7, 0x20000
 s_mov_b32 s76, 0
 s_mov_b32 s77, 32768
 s_mov_b32 s78, 1048576
 s_mov_b32 s79, 1081344
 s_mov_b32 s80, 2097152
 s_mov_b32 s81, 2129920
 s_mov_b32 s82, 3145728
 s_mov_b32 s83, 3178496
 s_mov_b32 s84, 4194304
 s_mov_b32 s85, 4227072
 s_lshl_b32 s37, s3, 6
 s_lshl_b32 s38, s3, 3
 s_add_u32 s38, s38, 256
 s_lshl_b32 s26, s3, 13
 s_lshl_b32 s27, s3, 10
 s_cmp_lt_u32 s3, 2
 s_mov_b32 s34, 53248
 s_cselect_b32 s34, 0x8000, s34
 s_cselect_b32 s31, 0x10000, 0
 s_cselect_b32 s32, 0, 0x80000000
 s_add_u32 s27, s27, s34
 s_mov_b32 s6, 16384000
 v_mov_b32 v36, 0
 v_mov_b32 v37, 0
 v_add_u32 v18, s37, v23
 s_add_u32 s37, s37, 8
 v_mul_u32_u24 v20, 241, v18
 v_lshrrev_b32 v20, 12, v20
 v_mul_u32_u24 v21, 17, v20
 v_sub_u32 v21, v18, v21
 v_bfe_u32 v22, v21, 1, 3
 v_xor_b32 v22, v22, v19
 v_lshl_add_u32 v20, v21, 4, v20
 v_lshlrev_b32 v22, 4, v22
 v_lshl_add_u32 v7, v20, 10, v22
 v_add_u32 v7, s36, v7
 v_lshl_or_b32 v36, v21, 0, v36
 v_add_u32 v18, s37, v23
 s_add_u32 s37, s37, 8
 v_mul_u32_u24 v20, 241, v18
 v_lshrrev_b32 v20, 12, v20
 v_mul_u32_u24 v21, 17, v20
 v_sub_u32 v21, v18, v21
 v_bfe_u32 v22, v21, 1, 3
 v_xor_b32 v22, v22, v19
 v_lshl_add_u32 v20, v21, 4, v20
 v_lshlrev_b32 v22, 4, v22
 v_lshl_add_u32 v8, v20, 10, v22
 v_add_u32 v8, s36, v8
 v_lshl_or_b32 v36, v21, 5, v36
 v_add_u32 v18, s37, v23
 s_add_u32 s37, s37, 8
 v_mul_u32_u24 v20, 241, v18
 v_lshrrev_b32 v20, 12, v20
 v_mul_u32_u24 v21, 17, v20
 v_sub_u32 v21, v18, v21
 v_bfe_u32 v22, v21, 1, 3
 v_xor_b32 v22, v22, v19
 v_lshl_add_u32 v20, v21, 4, v20
 v_lshlrev_b32 v22, 4, v22
 v_lshl_add_u32 v9, v20, 10, v22
 v_add_u32 v9, s36, v9
 v_lshl_or_b32 v36, v21, 10, v36
 v_add_u32 v18, s37, v23
 s_add_u32 s37, s37, 8
 v_mul_u32_u24 v20, 241, v18
 v_lshrrev_b32 v20, 12, v20
 v_mul_u32_u24 v21, 17, v20
 v_sub_u32 v21, v18, v21
 v_bfe_u32 v22, v21, 1, 3
 v_xor_b32 v22, v22, v19
 v_lshl_add_u32 v20, v21, 4, v20
 v_lshlrev_b32 v22, 4, v22
 v_lshl_add_u32 v10, v20, 10, v22
 v_add_u32 v10, s36, v10
 v_lshl_or_b32 v36, v21, 15, v36
 v_add_u32 v18, s37, v23
 s_add_u32 s37, s37, 8
 v_mul_u32_u24 v20, 241, v18
 v_lshrrev_b32 v20, 12, v20
 v_mul_u32_u24 v21, 17, v20
 v_sub_u32 v21, v18, v21
 v_bfe_u32 v22, v21, 1, 3
 v_xor_b32 v22, v22, v19
 v_lshl_add_u32 v20, v21, 4, v20
 v_lshlrev_b32 v22, 4, v22
 v_lshl_add_u32 v11, v20, 10, v22
 v_add_u32 v11, s36, v11
 v_lshl_or_b32 v36, v21, 20, v36
 v_add_u32 v18, s37, v23
 s_add_u32 s37, s37, 8
 v_mul_u32_u24 v20, 241, v18
 v_lshrrev_b32 v20, 12, v20
 v_mul_u32_u24 v21, 17, v20
 v_sub_u32 v21, v18, v21
 v_bfe_u32 v22, v21, 1, 3
 v_xor_b32 v22, v22, v19
 v_lshl_add_u32 v20, v21, 4, v20
 v_lshlrev_b32 v22, 4, v22
 v_lshl_add_u32 v12, v20, 10, v22
 v_add_u32 v12, s36, v12
 v_lshl_or_b32 v36, v21, 25, v36
 v_add_u32 v18, s37, v23
 s_add_u32 s37, s37, 8
 v_mul_u32_u24 v20, 241, v18
 v_lshrrev_b32 v20, 12, v20
 v_mul_u32_u24 v21, 17, v20
 v_sub_u32 v21, v18, v21
 v_bfe_u32 v22, v21, 1, 3
 v_xor_b32 v22, v22, v19
 v_lshl_add_u32 v20, v21, 4, v20
 v_lshlrev_b32 v22, 4, v22
 v_lshl_add_u32 v13, v20, 10, v22
 v_add_u32 v13, s36, v13
 v_lshl_or_b32 v37, v21, 0, v37
 v_add_u32 v18, s37, v23
 s_add_u32 s37, s37, 8
 v_mul_u32_u24 v20, 241, v18
 v_lshrrev_b32 v20, 12, v20
 v_mul_u32_u24 v21, 17, v20
 v_sub_u32 v21, v18, v21
 v_bfe_u32 v22, v21, 1, 3
 v_xor_b32 v22, v22, v19
 v_lshl_add_u32 v20, v21, 4, v20
 v_lshlrev_b32 v22, 4, v22
 v_lshl_add_u32 v14, v20, 10, v22
 v_add_u32 v14, s36, v14
 v_lshl_or_b32 v37, v21, 5, v37
 v_add_u32 v18, s38, v23
 v_mul_u32_u24 v20, 241, v18
 v_lshrrev_b32 v20, 12, v20
 v_mul_u32_u24 v21, 17, v20
 v_sub_u32 v21, v18, v21
 v_bfe_u32 v22, v21, 1, 3
 v_xor_b32 v22, v22, v19
 v_lshl_add_u32 v20, v21, 4, v20
 v_lshlrev_b32 v22, 4, v22
 v_lshl_add_u32 v15, v20, 10, v22
 v_add_u32 v15, s36, v15
 v_lshl_or_b32 v37, v21, 10, v37
 v_lshrrev_b32 v20, 1, v15
 v_or_b32 v20, s32, v20
 s_cmp_lt_u32 s3, 2
 s_cselect_b64 vcc, -1, 0
 v_cndmask_b32 v15, v20, v15, vcc
 s_waitcnt lgkmcnt(0)
 s_add_u32 s4, s16, s39
 s_addc_u32 s5, s17, 0
 s_add_u32 s8, s18, s45
 s_addc_u32 s9, s19, 0
 s_mov_b64 s[62:63], s[8:9]
 s_mov_b32 s64, s22
 s_mov_b32 s65, s23
 s_mov_b32 s22, s3
 s_add_u32 m0, s26, 0
 s_nop 0
 buffer_load_dwordx4 v7, s[4:7], 0 offen nt lds
 s_add_u32 m0, s26, 1024
 s_nop 0
 buffer_load_dwordx4 v8, s[4:7], 0 offen nt lds
 s_add_u32 m0, s26, 2048
 s_nop 0
 buffer_load_dwordx4 v9, s[4:7], 0 offen nt lds
 s_add_u32 m0, s26, 3072
 s_nop 0
 buffer_load_dwordx4 v10, s[4:7], 0 offen nt lds
 s_add_u32 m0, s26, 4096
 s_nop 0
 buffer_load_dwordx4 v11, s[4:7], 0 offen nt lds
 s_add_u32 m0, s26, 5120
 s_nop 0
 buffer_load_dwordx4 v12, s[4:7], 0 offen nt lds
 s_add_u32 m0, s26, 6144
 s_nop 0
 buffer_load_dwordx4 v13, s[4:7], 0 offen nt lds
 s_add_u32 m0, s26, 7168
 s_nop 0
 buffer_load_dwordx4 v14, s[4:7], 0 offen nt lds
 s_mov_b32 m0, s27
 s_nop 0
 buffer_load_dwordx4 v15, s[4:7], 0 offen nt lds
 s_add_u32 m0, s29, 0
 s_nop 0
 buffer_load_dwordx4 v5, s[8:11], s76 offen offset:0 lds
 s_add_u32 m0, s29, 2048
 s_nop 0
 buffer_load_dwordx4 v5, s[8:11], s77 offen offset:0 lds
 s_add_u32 m0, s29, 4096
 s_nop 0
 buffer_load_dwordx4 v5, s[8:11], s78 offen offset:0 lds
 s_add_u32 m0, s29, 6144
 s_nop 0
 buffer_load_dwordx4 v5, s[8:11], s79 offen offset:0 lds
 s_add_u32 m0, s29, 8192
 s_nop 0
 buffer_load_dwordx4 v5, s[8:11], s80 offen offset:0 lds
 s_add_u32 m0, s29, 10240
 s_nop 0
 buffer_load_dwordx4 v5, s[8:11], s81 offen offset:0 lds
 s_add_u32 m0, s29, 12288
 s_nop 0
 buffer_load_dwordx4 v5, s[8:11], s82 offen offset:0 lds
 s_add_u32 m0, s29, 14336
 s_nop 0
 buffer_load_dwordx4 v5, s[8:11], s83 offen offset:0 lds
 s_add_u32 m0, s29, 16384
 s_nop 0
 buffer_load_dwordx4 v5, s[8:11], s84 offen offset:0 lds
 s_add_u32 m0, s29, 18432
 s_nop 0
 buffer_load_dwordx4 v5, s[8:11], s85 offen offset:0 lds
 s_add_u32 s4, s4, 128
 s_addc_u32 s5, s5, 0
 s_xor_b32 s26, s26, 0x10000
 s_xor_b32 s27, s27, s31
 v_and_b32 v39, 15, v17
 v_lshrrev_b32 v19, 4, v17
 v_lshrrev_b32 v20, 1, v19
 v_lshlrev_b32 v20, 11, v20
 v_and_b32 v21, 1, v19
 v_lshl_add_u32 v20, v21, 9, v20
 v_lshl_add_u32 v20, v39, 4, v20
 v_add_u32 v46, s29, v20
 v_lshlrev_b32 v6, 14, v39
 v_lshl_add_u32 v6, v19, 4, v6
 v_add_u32 v20, 0, v39
 v_bfe_u32 v21, v20, 1, 3
 v_add_u32 v22, 0, v19
 v_xor_b32 v21, v21, v22
 v_lshlrev_b32 v21, 4, v21
 v_lshl_add_u32 v1, v20, 7, v21
 v_add_u32 v20, 0, v39
 v_bfe_u32 v21, v20, 1, 3
 v_add_u32 v22, 4, v19
 v_xor_b32 v21, v21, v22
 v_lshlrev_b32 v21, 4, v21
 v_lshl_add_u32 v2, v20, 7, v21
 v_add_u32 v20, 1, v39
 v_bfe_u32 v21, v20, 1, 3
 v_add_u32 v22, 0, v19
 v_xor_b32 v21, v21, v22
 v_lshlrev_b32 v21, 4, v21
 v_lshl_add_u32 v3, v20, 7, v21
 v_add_u32 v20, 1, v39
 v_bfe_u32 v21, v20, 1, 3
 v_add_u32 v22, 4, v19
 v_xor_b32 v21, v21, v22
 v_lshlrev_b32 v21, 4, v21
 v_lshl_add_u32 v4, v20, 7, v21
 s_mov_b32 s42, 0x4038aa3b
 s_mov_b32 s43, 0xbfb8aa3b
 s_mov_b32 s47, 0x41f00000
 s_mov_b32 s15, 0x20000
 s_mov_b32 s14, 16384000
 s_movk_i32 s66, 256
 s_mov_b32 s67, 0x20000
 s_add_u32 s12, s20, s39
 s_addc_u32 s13, s21, 0
 s_add_u32 s40, s44, s45
 s_mov_b32 s25, 6
 s_mov_b32 s70, 7
 s_cmp_eq_u32 s24, 0
 s_cselect_b32 s28, 5, 4
 s_mov_b64 s[94:95], 0
 s_cmp_eq_u32 s22, 0
 s_cselect_b32 s23, 6, 64
 s_getreg_b32 s75, hwreg(HW_REG_XCC_ID, 0, 3)
 s_mov_b32 s30, 6
 v_mov_b32 v38, 57344
 s_waitcnt vmcnt(10)
 s_barrier
 ds_read_b128 a[160:163], v1 offset:0
 ds_read_b128 a[164:167], v1 offset:4352
 ds_read_b128 a[168:171], v1 offset:8704
 ds_read_b128 a[172:175], v1 offset:13056
 ds_read_b128 a[176:179], v1 offset:17408
 ds_read_b128 a[180:183], v1 offset:21760
 s_waitcnt vmcnt(8)
 ds_read_b64_tr_b16 a[0:1], v46 offset:0
 ds_read_b64_tr_b16 a[2:3], v46 offset:256
 ds_read_b64_tr_b16 a[4:5], v46 offset:8
 ds_read_b64_tr_b16 a[6:7], v46 offset:264
 s_waitcnt vmcnt(6)
 ds_read_b64_tr_b16 a[16:17], v46 offset:4096
 ds_read_b64_tr_b16 a[18:19], v46 offset:4352
 ds_read_b64_tr_b16 a[20:21], v46 offset:4104
 ds_read_b64_tr_b16 a[22:23], v46 offset:4360
L_c0:
 s_waitcnt lgkmcnt(6)
 ds_read_b128 a[184:187], v1 offset:26112
 ds_read_b128 a[200:203], v1 offset:30464
 v_mfma_f32_16x16x32_bf16 v[48:51], a[0:3], a[160:163], 0
 s_waitcnt lgkmcnt(4)
 ds_read_b128 a[188:191], v3 offset:0
 ds_read_b128 a[192:195], v1 offset:2176
 v_mfma_f32_16x16x32_bf16 v[48:51], a[16:19], a[164:167], v[48:51]
 s_waitcnt lgkmcnt(4)
 ds_read_b128 a[196:199], v1 offset:6528
 ds_read_b128 a[204:207], v1 offset:10880
 v_mfma_f32_16x16x32_bf16 v[52:55], a[20:23], a[164:167], 0
 s_add_u32 m0, s29, 0
 v_mfma_f32_16x16x32_bf16 v[52:55], a[4:7], a[160:163], v[52:55]
 buffer_load_dwordx4 v5, s[8:11], s76 offen offset:1024 lds
 v_mfma_f32_16x16x32_bf16 v[68:71], a[4:7], a[164:167], 0
 v_mfma_f32_16x16x32_bf16 v[68:71], a[20:23], a[168:171], v[68:71]
 v_mfma_f32_16x16x32_bf16 v[64:67], a[16:19], a[168:171], 0
 s_add_u32 m0, s29, 2048
 v_mfma_f32_16x16x32_bf16 v[64:67], a[0:3], a[164:167], v[64:67]
 buffer_load_dwordx4 v5, s[8:11], s77 offen offset:1024 lds
 v_mfma_f32_16x16x32_bf16 v[80:83], a[0:3], a[168:171], 0
 v_mfma_f32_16x16x32_bf16 v[80:83], a[16:19], a[172:175], v[80:83]
 v_mfma_f32_16x16x32_bf16 v[84:87], a[20:23], a[172:175], 0
 v_mfma_f32_16x16x32_bf16 v[84:87], a[4:7], a[168:171], v[84:87]
 v_mfma_f32_16x16x32_bf16 v[100:103], a[4:7], a[172:175], 0
 s_add_u32 m0, s29, 4096
 v_mfma_f32_16x16x32_bf16 v[100:103], a[20:23], a[176:179], v[100:103]
 buffer_load_dwordx4 v5, s[8:11], s78 offen offset:1024 lds
 v_mfma_f32_16x16x32_bf16 v[96:99], a[16:19], a[176:179], 0
 v_mfma_f32_16x16x32_bf16 v[96:99], a[0:3], a[172:175], v[96:99]
 v_mfma_f32_16x16x32_bf16 v[112:115], a[0:3], a[176:179], 0
 v_mfma_f32_16x16x32_bf16 v[112:115], a[16:19], a[180:183], v[112:115]
 v_mfma_f32_16x16x32_bf16 v[116:119], a[20:23], a[180:183], 0
 v_mfma_f32_16x16x32_bf16 v[116:119], a[4:7], a[176:179], v[116:119]
 ds_read_b128 a[176:179], v1 offset:15232
 ds_read_b128 a[160:163], v1 offset:19584
 v_mfma_f32_16x16x32_bf16 v[132:135], a[4:7], a[180:183], 0
 s_waitcnt lgkmcnt(2)
 ds_read_b128 a[168:171], v1 offset:23936
 ds_read_b128 a[164:167], v1 offset:28288
 v_mfma_f32_16x16x32_bf16 v[132:135], a[20:23], a[184:187], v[132:135]
 s_add_u32 m0, s29, 6144
 ds_read_b128 a[172:175], v1 offset:32640
 v_mfma_f32_16x16x32_bf16 v[128:131], a[16:19], a[184:187], 0
 buffer_load_dwordx4 v5, s[8:11], s79 offen offset:1024 lds
 v_mfma_f32_16x16x32_bf16 v[128:131], a[0:3], a[180:183], v[128:131]
 s_waitcnt vmcnt(8)
 ds_read_b128 a[180:183], v3 offset:2176
 ds_read_b64_tr_b16 a[32:33], v46 offset:8192
 v_mfma_f32_16x16x32_bf16 v[144:147], a[0:3], a[184:187], 0
 s_add_u32 m0, s29, 8192
 v_mfma_f32_16x16x32_bf16 v[144:147], a[16:19], a[200:203], v[144:147]
 buffer_load_dwordx4 v5, s[8:11], s80 offen offset:1024 lds
 ds_read_b64_tr_b16 a[34:35], v46 offset:8448
 v_mfma_f32_16x16x32_bf16 v[148:151], a[20:23], a[200:203], 0
 v_mfma_f32_16x16x32_bf16 v[148:151], a[4:7], a[184:187], v[148:151]
 ds_read_b128 a[184:187], v1 offset:8704
 ds_read_b64_tr_b16 a[36:37], v46 offset:8200
 v_mfma_f32_16x16x32_bf16 v[164:167], a[4:7], a[200:203], 0
 v_mfma_f32_16x16x32_bf16 v[164:167], a[20:23], a[188:191], v[164:167]
 ds_read_b64_tr_b16 a[38:39], v46 offset:8456
 v_mfma_f32_16x16x32_bf16 v[160:163], a[16:19], a[188:191], 0
 s_add_u32 m0, s29, 10240
 ds_read_b128 a[188:191], v1 offset:13056
 v_mfma_f32_16x16x32_bf16 v[160:163], a[0:3], a[200:203], v[160:163]
 s_waitcnt vmcnt(7)
 buffer_load_dwordx4 v5, s[8:11], s81 offen offset:1024 lds
 ds_read_b64_tr_b16 a[48:49], v46 offset:12288
 v_mfma_f32_16x16x32_bf16 v[176:179], a[0:3], a[192:195], 0
 v_mfma_f32_16x16x32_bf16 v[176:179], a[16:19], a[196:199], v[176:179]
 ds_read_b64_tr_b16 a[50:51], v46 offset:12544
 v_mfma_f32_16x16x32_bf16 v[180:183], a[20:23], a[196:199], 0
 v_mfma_f32_16x16x32_bf16 v[180:183], a[4:7], a[192:195], v[180:183]
 ds_read_b64_tr_b16 a[52:53], v46 offset:12296
 v_mfma_f32_16x16x32_bf16 v[196:199], a[4:7], a[196:199], 0
 s_add_u32 m0, s29, 12288
 v_mfma_f32_16x16x32_bf16 v[196:199], a[20:23], a[204:207], v[196:199]
 buffer_load_dwordx4 v5, s[8:11], s82 offen offset:1024 lds
 ds_read_b64_tr_b16 a[54:55], v46 offset:12552
 v_mfma_f32_16x16x32_bf16 v[192:195], a[16:19], a[204:207], 0
 v_mfma_f32_16x16x32_bf16 v[192:195], a[0:3], a[196:199], v[192:195]
 ds_read_b128 a[196:199], v1 offset:17408
 ds_read_b128 a[200:203], v1 offset:21760
 v_mfma_f32_16x16x32_bf16 v[208:211], a[0:3], a[204:207], 0
 s_waitcnt vmcnt(7) lgkmcnt(8)
 ds_read_b128 a[192:195], v1 offset:26112
 ds_read_b64_tr_b16 a[64:65], v46 offset:16384
 v_mfma_f32_16x16x32_bf16 v[208:211], a[16:19], a[176:179], v[208:211]
 v_mfma_f32_16x16x32_bf16 v[212:215], a[20:23], a[176:179], 0
 s_add_u32 m0, s29, 14336
 ds_read_b64_tr_b16 a[66:67], v46 offset:16640
 v_mfma_f32_16x16x32_bf16 v[212:215], a[4:7], a[204:207], v[212:215]
 ds_read_b128 a[204:207], v1 offset:30464
 buffer_load_dwordx4 v5, s[8:11], s83 offen offset:1024 lds
 v_mfma_f32_16x16x32_bf16 v[228:231], a[4:7], a[176:179], 0
 ds_read_b64_tr_b16 a[68:69], v46 offset:16392
 v_mfma_f32_16x16x32_bf16 v[228:231], a[20:23], a[160:163], v[228:231]
 v_mfma_f32_16x16x32_bf16 v[224:227], a[16:19], a[160:163], 0
 ds_read_b64_tr_b16 a[70:71], v46 offset:16648
 v_mfma_f32_16x16x32_bf16 v[224:227], a[0:3], a[176:179], v[224:227]
 ds_read_b128 a[176:179], v3 offset:0
 v_mfma_f32_16x16x32_bf16 v[240:243], a[0:3], a[160:163], 0
 s_add_u32 m0, s29, 16384
 v_mfma_f32_16x16x32_bf16 v[240:243], a[16:19], a[168:171], v[240:243]
 buffer_load_dwordx4 v5, s[8:11], s84 offen offset:1024 lds
 v_mfma_f32_16x16x32_bf16 v[244:247], a[20:23], a[168:171], 0
 v_mfma_f32_16x16x32_bf16 v[244:247], a[4:7], a[160:163], v[244:247]
 ds_read_b128 a[160:163], v3 offset:4352
 v_mfma_f32_16x16x32_bf16 a[212:215], a[4:7], a[168:171], 0
 v_mfma_f32_16x16x32_bf16 a[212:215], a[20:23], a[164:167], a[212:215]
 v_mfma_f32_16x16x32_bf16 a[208:211], a[16:19], a[164:167], 0
 s_add_u32 m0, s29, 18432
 v_mfma_f32_16x16x32_bf16 a[208:211], a[0:3], a[168:171], a[208:211]
 buffer_load_dwordx4 v5, s[8:11], s85 offen offset:1024 lds
 v_mfma_f32_16x16x32_bf16 a[224:227], a[0:3], a[164:167], 0
 s_add_u32 s8, s8, 0x10000
 s_addc_u32 s9, s9, 0
 v_mfma_f32_16x16x32_bf16 a[224:227], a[16:19], a[172:175], a[224:227]
 v_mfma_f32_16x16x32_bf16 a[228:231], a[20:23], a[172:175], 0
 v_mfma_f32_16x16x32_bf16 a[228:231], a[4:7], a[164:167], a[228:231]
 v_mfma_f32_16x16x32_bf16 a[244:247], a[4:7], a[172:175], 0
 v_mfma_f32_16x16x32_bf16 a[244:247], a[20:23], a[180:183], a[244:247]
 s_add_u32 m0, s29, 0
 v_mfma_f32_16x16x32_bf16 a[240:243], a[16:19], a[180:183], 0
 buffer_load_dwordx4 v5, s[8:11], s76 offen offset:0 lds
 v_mfma_f32_16x16x32_bf16 a[240:243], a[0:3], a[172:175], a[240:243]
 ds_read_b128 a[172:175], v3 offset:8704
 ds_read_b128 a[168:171], v3 offset:13056
 v_mfma_f32_16x16x32_bf16 v[48:51], a[32:35], a[184:187], v[48:51]
 s_waitcnt lgkmcnt(2)
 ds_read_b128 a[164:167], v1 offset:10880
 ds_read_b128 a[180:183], v1 offset:15232
 v_mfma_f32_16x16x32_bf16 v[48:51], a[48:51], a[188:191], v[48:51]
 v_mfma_f32_16x16x32_bf16 v[48:51], a[64:67], a[196:199], v[48:51]
 v_mfma_f32_16x16x32_bf16 v[52:55], a[68:71], a[196:199], v[52:55]
 s_add_u32 m0, s29, 2048
 v_mfma_f32_16x16x32_bf16 v[52:55], a[52:55], a[188:191], v[52:55]
 buffer_load_dwordx4 v5, s[8:11], s77 offen offset:0 lds
 v_mfma_f32_16x16x32_bf16 v[52:55], a[36:39], a[184:187], v[52:55]
 ds_read_b128 a[184:187], v1 offset:19584
 v_mfma_f32_16x16x32_bf16 v[68:71], a[36:39], a[188:191], v[68:71]
 v_mfma_f32_16x16x32_bf16 v[68:71], a[52:55], a[196:199], v[68:71]
 v_mfma_f32_16x16x32_bf16 v[68:71], a[68:71], a[200:203], v[68:71]
 v_mfma_f32_16x16x32_bf16 v[64:67], a[64:67], a[200:203], v[64:67]
 s_add_u32 m0, s29, 4096
 v_mfma_f32_16x16x32_bf16 v[64:67], a[48:51], a[196:199], v[64:67]
 buffer_load_dwordx4 v5, s[8:11], s78 offen offset:0 lds
 v_mfma_f32_16x16x32_bf16 v[64:67], a[32:35], a[188:191], v[64:67]
 ds_read_b128 a[188:191], v1 offset:23936
 v_mfma_f32_16x16x32_bf16 v[80:83], a[32:35], a[196:199], v[80:83]
 v_mfma_f32_16x16x32_bf16 v[80:83], a[48:51], a[200:203], v[80:83]
 s_waitcnt vmcnt(11)
 ds_read_b64_tr_b16 a[8:9], v46 offset:1024
 v_mfma_f32_16x16x32_bf16 v[80:83], a[64:67], a[192:195], v[80:83]
 v_mfma_f32_16x16x32_bf16 v[84:87], a[68:71], a[192:195], v[84:87]
 s_add_u32 m0, s29, 6144
 v_mfma_f32_16x16x32_bf16 v[84:87], a[52:55], a[200:203], v[84:87]
 ds_read_b64_tr_b16 a[10:11], v46 offset:1280
 buffer_load_dwordx4 v5, s[8:11], s79 offen offset:0 lds
 v_mfma_f32_16x16x32_bf16 v[84:87], a[36:39], a[196:199], v[84:87]
 v_mfma_f32_16x16x32_bf16 v[100:103], a[36:39], a[200:203], v[100:103]
 v_mfma_f32_16x16x32_bf16 v[100:103], a[52:55], a[192:195], v[100:103]
 ds_read_b64_tr_b16 a[12:13], v46 offset:1032
 v_mfma_f32_16x16x32_bf16 v[100:103], a[68:71], a[204:207], v[100:103]
 v_mfma_f32_16x16x32_bf16 v[96:99], a[64:67], a[204:207], v[96:99]
 s_add_u32 m0, s29, 8192
 v_mfma_f32_16x16x32_bf16 v[96:99], a[48:51], a[192:195], v[96:99]
 ds_read_b64_tr_b16 a[14:15], v46 offset:1288
 buffer_load_dwordx4 v5, s[8:11], s80 offen offset:0 lds
 v_mfma_f32_16x16x32_bf16 v[96:99], a[32:35], a[200:203], v[96:99]
 ds_read_b128 a[200:203], v1 offset:28288
 ds_read_b128 a[196:199], v1 offset:32640
 v_mfma_f32_16x16x32_bf16 v[112:115], a[32:35], a[192:195], v[112:115]
 v_mfma_f32_16x16x32_bf16 v[112:115], a[48:51], a[204:207], v[112:115]
 v_mfma_f32_16x16x32_bf16 v[112:115], a[64:67], a[176:179], v[112:115]
 v_mfma_f32_16x16x32_bf16 v[116:119], a[68:71], a[176:179], v[116:119]
 s_add_u32 m0, s29, 10240
 v_mfma_f32_16x16x32_bf16 v[116:119], a[52:55], a[204:207], v[116:119]
 s_waitcnt vmcnt(11)
 ds_read_b64_tr_b16 a[24:25], v46 offset:5120
 buffer_load_dwordx4 v5, s[8:11], s81 offen offset:0 lds
 v_mfma_f32_16x16x32_bf16 v[116:119], a[36:39], a[192:195], v[116:119]
 v_mfma_f32_16x16x32_bf16 v[132:135], a[36:39], a[204:207], v[132:135]
 v_mfma_f32_16x16x32_bf16 v[132:135], a[52:55], a[176:179], v[132:135]
 ds_read_b64_tr_b16 a[26:27], v46 offset:5376
 v_mfma_f32_16x16x32_bf16 v[132:135], a[68:71], a[160:163], v[132:135]
 v_mfma_f32_16x16x32_bf16 v[128:131], a[64:67], a[160:163], v[128:131]
 s_add_u32 m0, s29, 12288
 v_mfma_f32_16x16x32_bf16 v[128:131], a[48:51], a[176:179], v[128:131]
 ds_read_b64_tr_b16 a[28:29], v46 offset:5128
 buffer_load_dwordx4 v5, s[8:11], s82 offen offset:0 lds
 v_mfma_f32_16x16x32_bf16 v[128:131], a[32:35], a[204:207], v[128:131]
 ds_read_b128 a[204:207], v3 offset:2176
 v_mfma_f32_16x16x32_bf16 v[144:147], a[32:35], a[176:179], v[144:147]
 v_mfma_f32_16x16x32_bf16 v[144:147], a[48:51], a[160:163], v[144:147]
 s_waitcnt lgkmcnt(4)
 ds_read_b64_tr_b16 a[30:31], v46 offset:5384
 v_mfma_f32_16x16x32_bf16 v[144:147], a[64:67], a[172:175], v[144:147]
 v_mfma_f32_16x16x32_bf16 v[148:151], a[68:71], a[172:175], v[148:151]
 s_add_u32 m0, s29, 14336
 v_mfma_f32_16x16x32_bf16 v[148:151], a[52:55], a[160:163], v[148:151]
 s_waitcnt vmcnt(11)
 ds_read_b64_tr_b16 a[40:41], v46 offset:9216
 buffer_load_dwordx4 v5, s[8:11], s83 offen offset:0 lds
 v_mfma_f32_16x16x32_bf16 v[148:151], a[36:39], a[176:179], v[148:151]
 v_mfma_f32_16x16x32_bf16 v[164:167], a[36:39], a[160:163], v[164:167]
 v_mfma_f32_16x16x32_bf16 v[164:167], a[52:55], a[172:175], v[164:167]
 ds_read_b64_tr_b16 a[42:43], v46 offset:9472
 v_mfma_f32_16x16x32_bf16 v[164:167], a[68:71], a[168:171], v[164:167]
 v_mfma_f32_16x16x32_bf16 v[160:163], a[64:67], a[168:171], v[160:163]
 s_add_u32 m0, s29, 16384
 v_mfma_f32_16x16x32_bf16 v[160:163], a[48:51], a[172:175], v[160:163]
 ds_read_b64_tr_b16 a[44:45], v46 offset:9224
 buffer_load_dwordx4 v5, s[8:11], s84 offen offset:0 lds
 v_mfma_f32_16x16x32_bf16 v[160:163], a[32:35], a[160:163], v[160:163]
 v_mfma_f32_16x16x32_bf16 v[176:179], a[32:35], a[164:167], v[176:179]
 v_mfma_f32_16x16x32_bf16 v[176:179], a[48:51], a[180:183], v[176:179]
 ds_read_b64_tr_b16 a[46:47], v46 offset:9480
 v_mfma_f32_16x16x32_bf16 v[176:179], a[64:67], a[184:187], v[176:179]
 v_mfma_f32_16x16x32_bf16 v[180:183], a[68:71], a[184:187], v[180:183]
 s_add_u32 m0, s29, 18432
 v_mfma_f32_16x16x32_bf16 v[180:183], a[52:55], a[180:183], v[180:183]
 s_waitcnt vmcnt(11)
 ds_read_b64_tr_b16 a[56:57], v46 offset:13312
 buffer_load_dwordx4 v5, s[8:11], s85 offen offset:0 lds
 v_mfma_f32_16x16x32_bf16 v[180:183], a[36:39], a[164:167], v[180:183]
 ds_read_b128 a[164:167], v3 offset:6528
 ds_read_b128 a[192:195], v3 offset:10880
 v_mfma_f32_16x16x32_bf16 v[196:199], a[36:39], a[180:183], v[196:199]
 ds_read_b128 a[176:179], v3 offset:15232
 v_mfma_f32_16x16x32_bf16 v[196:199], a[52:55], a[184:187], v[196:199]
 ds_read_b64_tr_b16 a[58:59], v46 offset:13568
 v_mfma_f32_16x16x32_bf16 v[196:199], a[68:71], a[188:191], v[196:199]
 v_mfma_f32_16x16x32_bf16 v[192:195], a[64:67], a[188:191], v[192:195]
 s_add_u32 m0, s29, 0
 v_mfma_f32_16x16x32_bf16 v[192:195], a[48:51], a[184:187], v[192:195]
 ds_read_b64_tr_b16 a[60:61], v46 offset:13320
 buffer_load_dwordx4 v5, s[8:11], s76 offen offset:1024 lds
 v_mfma_f32_16x16x32_bf16 v[192:195], a[32:35], a[180:183], v[192:195]
 v_mfma_f32_16x16x32_bf16 v[208:211], a[32:35], a[184:187], v[208:211]
 v_mfma_f32_16x16x32_bf16 v[208:211], a[48:51], a[188:191], v[208:211]
 ds_read_b64_tr_b16 a[62:63], v46 offset:13576
 v_mfma_f32_16x16x32_bf16 v[208:211], a[64:67], a[200:203], v[208:211]
 v_mfma_f32_16x16x32_bf16 v[212:215], a[68:71], a[200:203], v[212:215]
 s_add_u32 m0, s29, 2048
 v_mfma_f32_16x16x32_bf16 v[212:215], a[52:55], a[188:191], v[212:215]
 s_waitcnt vmcnt(11)
 ds_read_b64_tr_b16 a[72:73], v46 offset:17408
 buffer_load_dwordx4 v5, s[8:11], s77 offen offset:1024 lds
 v_mfma_f32_16x16x32_bf16 v[212:215], a[36:39], a[184:187], v[212:215]
 ds_read_b128 a[184:187], v1 offset:0
 ds_read_b128 a[168:171], v1 offset:4352
 v_mfma_f32_16x16x32_bf16 v[228:231], a[36:39], a[188:191], v[228:231]
 ds_read_b128 a[172:175], v1 offset:8704
 ds_read_b128 a[160:163], v1 offset:13056
 v_mfma_f32_16x16x32_bf16 v[228:231], a[52:55], a[200:203], v[228:231]
 ds_read_b128 a[180:183], v1 offset:17408
 ds_read_b64_tr_b16 a[74:75], v46 offset:17664
 v_mfma_f32_16x16x32_bf16 v[228:231], a[68:71], a[196:199], v[228:231]
 v_mfma_f32_16x16x32_bf16 v[224:227], a[64:67], a[196:199], v[224:227]
 s_add_u32 m0, s29, 4096
 v_mfma_f32_16x16x32_bf16 v[224:227], a[48:51], a[200:203], v[224:227]
 s_waitcnt lgkmcnt(8)
 ds_read_b64_tr_b16 a[76:77], v46 offset:17416
 buffer_load_dwordx4 v5, s[8:11], s78 offen offset:1024 lds
 v_mfma_f32_16x16x32_bf16 v[224:227], a[32:35], a[188:191], v[224:227]
 ds_read_b128 a[188:191], v1 offset:21760
 v_mfma_f32_16x16x32_bf16 v[240:243], a[32:35], a[200:203], v[240:243]
 v_mfma_f32_16x16x32_bf16 v[240:243], a[48:51], a[196:199], v[240:243]
 ds_read_b64_tr_b16 a[78:79], v46 offset:17672
 v_mfma_f32_16x16x32_bf16 v[240:243], a[64:67], a[204:207], v[240:243]
 s_waitcnt vmcnt(11)
 ds_read_b64_tr_b16 a[80:81], v46 offset:0
 v_mfma_f32_16x16x32_bf16 v[244:247], a[68:71], a[204:207], v[244:247]
 s_add_u32 m0, s29, 6144
 v_mfma_f32_16x16x32_bf16 v[244:247], a[52:55], a[196:199], v[244:247]
 buffer_load_dwordx4 v5, s[8:11], s79 offen offset:1024 lds
 v_mfma_f32_16x16x32_bf16 v[244:247], a[36:39], a[200:203], v[244:247]
 ds_read_b64_tr_b16 a[82:83], v46 offset:256
 v_mfma_f32_16x16x32_bf16 a[212:215], a[36:39], a[196:199], a[212:215]
 v_mfma_f32_16x16x32_bf16 a[212:215], a[52:55], a[204:207], a[212:215]
 v_mfma_f32_16x16x32_bf16 a[212:215], a[68:71], a[164:167], a[212:215]
 ds_read_b64_tr_b16 a[84:85], v46 offset:8
 v_mfma_f32_16x16x32_bf16 a[208:211], a[64:67], a[164:167], a[208:211]
 s_add_u32 m0, s29, 8192
 v_mfma_f32_16x16x32_bf16 a[208:211], a[48:51], a[204:207], a[208:211]
 buffer_load_dwordx4 v5, s[8:11], s80 offen offset:1024 lds
 v_mfma_f32_16x16x32_bf16 a[208:211], a[32:35], a[196:199], a[208:211]
 ds_read_b128 a[196:199], v1 offset:26112
 ds_read_b128 a[200:203], v1 offset:30464
 v_mfma_f32_16x16x32_bf16 a[224:227], a[32:35], a[204:207], a[224:227]
 ds_read_b64_tr_b16 a[86:87], v46 offset:264
 v_mfma_f32_16x16x32_bf16 a[224:227], a[48:51], a[164:167], a[224:227]
 v_mfma_f32_16x16x32_bf16 a[224:227], a[64:67], a[192:195], a[224:227]
 v_mfma_f32_16x16x32_bf16 a[228:231], a[68:71], a[192:195], a[228:231]
 s_waitcnt vmcnt(11)
 s_add_u32 m0, s29, 10240
 ds_read_b64_tr_b16 a[96:97], v46 offset:4096
 v_mfma_f32_16x16x32_bf16 a[228:231], a[52:55], a[164:167], a[228:231]
 buffer_load_dwordx4 v5, s[8:11], s81 offen offset:1024 lds
 v_mfma_f32_16x16x32_bf16 a[228:231], a[36:39], a[204:207], a[228:231]
 ds_read_b128 a[204:207], v3 offset:0
 v_mfma_f32_16x16x32_bf16 a[244:247], a[36:39], a[164:167], a[244:247]
 ds_read_b64_tr_b16 a[98:99], v46 offset:4352
 v_mfma_f32_16x16x32_bf16 a[244:247], a[52:55], a[192:195], a[244:247]
 v_mfma_f32_16x16x32_bf16 a[244:247], a[68:71], a[176:179], a[244:247]
 v_mfma_f32_16x16x32_bf16 a[240:243], a[64:67], a[176:179], a[240:243]
 s_add_u32 m0, s29, 12288
 ds_read_b128 a[176:179], v3 offset:4352
 ds_read_b64_tr_b16 a[100:101], v46 offset:4104
 v_mfma_f32_16x16x32_bf16 a[240:243], a[48:51], a[192:195], a[240:243]
 s_waitcnt lgkmcnt(8)
 ds_read_b128 a[192:195], v3 offset:8704
 buffer_load_dwordx4 v5, s[8:11], s82 offen offset:1024 lds
 v_mfma_f32_16x16x32_bf16 a[240:243], a[32:35], a[164:167], a[240:243]
 ds_read_b128 a[164:167], v3 offset:13056
 v_mfma_f32_16x16x32_bf16 v[56:59], a[8:11], a[184:187], 0
 ds_read_b64_tr_b16 a[102:103], v46 offset:4360
 v_mfma_f32_16x16x32_bf16 v[56:59], a[24:27], a[168:171], v[56:59]
 v_mfma_f32_16x16x32_bf16 v[56:59], a[40:43], a[172:175], v[56:59]
 v_mfma_f32_16x16x32_bf16 v[56:59], a[56:59], a[160:163], v[56:59]
 s_waitcnt vmcnt(11)
 s_add_u32 m0, s29, 14336
 ds_read_b64_tr_b16 a[112:113], v46 offset:8192
 v_mfma_f32_16x16x32_bf16 v[56:59], a[72:75], a[180:183], v[56:59]
 buffer_load_dwordx4 v5, s[8:11], s83 offen offset:1024 lds
 v_mfma_f32_16x16x32_bf16 v[72:75], a[72:75], a[188:191], 0
 v_mfma_f32_16x16x32_bf16 v[72:75], a[56:59], a[180:183], v[72:75]
 ds_read_b64_tr_b16 a[114:115], v46 offset:8448
 v_mfma_f32_16x16x32_bf16 v[72:75], a[40:43], a[160:163], v[72:75]
 v_mfma_f32_16x16x32_bf16 v[72:75], a[24:27], a[172:175], v[72:75]
 v_mfma_f32_16x16x32_bf16 v[72:75], a[8:11], a[168:171], v[72:75]
 s_add_u32 m0, s29, 16384
 ds_read_b64_tr_b16 a[116:117], v46 offset:8200
 v_mfma_f32_16x16x32_bf16 v[88:91], a[8:11], a[172:175], 0
 buffer_load_dwordx4 v5, s[8:11], s84 offen offset:1024 lds
 v_mfma_f32_16x16x32_bf16 v[88:91], a[24:27], a[160:163], v[88:91]
 s_add_u32 m0, s26, 0
 v_mfma_f32_16x16x32_bf16 v[88:91], a[40:43], a[180:183], v[88:91]
 ds_read_b64_tr_b16 a[118:119], v46 offset:8456
 buffer_load_dwordx4 v7, s[4:7], 0 offen nt lds
 v_mfma_f32_16x16x32_bf16 v[88:91], a[56:59], a[188:191], v[88:91]
 s_waitcnt lgkmcnt(4)
 v_mfma_f32_16x16x32_bf16 v[88:91], a[72:75], a[196:199], v[88:91]
 v_mfma_f32_16x16x32_bf16 v[104:107], a[72:75], a[200:203], 0
 s_waitcnt vmcnt(12)
 s_add_u32 m0, s29, 18432
 ds_read_b64_tr_b16 a[128:129], v46 offset:12288
 v_mfma_f32_16x16x32_bf16 v[104:107], a[56:59], a[196:199], v[104:107]
 buffer_load_dwordx4 v5, s[8:11], s85 offen offset:1024 lds
 v_mfma_f32_16x16x32_bf16 v[104:107], a[40:43], a[188:191], v[104:107]
 s_add_u32 s8, s8, 0x10000
 s_addc_u32 s9, s9, 0
 v_mfma_f32_16x16x32_bf16 v[104:107], a[24:27], a[180:183], v[104:107]
 ds_read_b64_tr_b16 a[130:131], v46 offset:12544
 v_mfma_f32_16x16x32_bf16 v[104:107], a[8:11], a[160:163], v[104:107]
 v_mfma_f32_16x16x32_bf16 v[108:111], a[12:15], a[160:163], 0
 s_add_u32 m0, s29, 0
 v_mfma_f32_16x16x32_bf16 v[108:111], a[28:31], a[180:183], v[108:111]
 ds_read_b64_tr_b16 a[132:133], v46 offset:12296
 buffer_load_dwordx4 v5, s[8:11], s76 offen offset:0 lds
 v_mfma_f32_16x16x32_bf16 v[108:111], a[44:47], a[188:191], v[108:111]
 v_mfma_f32_16x16x32_bf16 v[108:111], a[60:63], a[196:199], v[108:111]
 v_mfma_f32_16x16x32_bf16 v[108:111], a[76:79], a[200:203], v[108:111]
 ds_read_b64_tr_b16 a[134:135], v46 offset:12552
 v_mfma_f32_16x16x32_bf16 v[92:95], a[76:79], a[196:199], 0
 v_mfma_f32_16x16x32_bf16 v[92:95], a[60:63], a[188:191], v[92:95]
 v_mfma_f32_16x16x32_bf16 v[92:95], a[44:47], a[180:183], v[92:95]
 s_waitcnt vmcnt(12)
 ds_read_b64_tr_b16 a[144:145], v46 offset:16384
 v_mfma_f32_16x16x32_bf16 v[92:95], a[28:31], a[160:163], v[92:95]
 v_mfma_f32_16x16x32_bf16 v[92:95], a[12:15], a[172:175], v[92:95]
 v_mfma_f32_16x16x32_bf16 v[76:79], a[12:15], a[168:171], 0
 ds_read_b64_tr_b16 a[146:147], v46 offset:16640
 v_mfma_f32_16x16x32_bf16 v[76:79], a[28:31], a[172:175], v[76:79]
 v_mfma_f32_16x16x32_bf16 v[76:79], a[44:47], a[160:163], v[76:79]
 v_mfma_f32_16x16x32_bf16 v[76:79], a[60:63], a[180:183], v[76:79]
 s_add_u32 m0, s29, 2048
 ds_read_b64_tr_b16 a[148:149], v46 offset:16392
 v_mfma_f32_16x16x32_bf16 v[76:79], a[76:79], a[188:191], v[76:79]
 buffer_load_dwordx4 v5, s[8:11], s77 offen offset:0 lds
 v_mfma_f32_16x16x32_bf16 v[60:63], a[76:79], a[180:183], 0
 v_mfma_f32_16x16x32_bf16 v[60:63], a[60:63], a[160:163], v[60:63]
 ds_read_b128 a[160:163], v1 offset:2176
 ds_read_b64_tr_b16 a[150:151], v46 offset:16648
 v_mfma_f32_16x16x32_bf16 v[60:63], a[44:47], a[172:175], v[60:63]
 v_mfma_f32_16x16x32_bf16 v[60:63], a[28:31], a[168:171], v[60:63]
 ds_read_b128 a[168:171], v1 offset:6528
 v_mfma_f32_16x16x32_bf16 v[60:63], a[12:15], a[184:187], v[60:63]
 s_add_u32 m0, s26, 1024
 ds_read_b128 a[184:187], v1 offset:10880
 ds_read_b128 a[172:175], v1 offset:15232
 v_mfma_f32_16x16x32_bf16 v[124:127], a[12:15], a[180:183], 0
 s_waitcnt vmcnt(11)
 ds_read_b64_tr_b16 a[88:89], v46 offset:1024
 buffer_load_dwordx4 v8, s[4:7], 0 offen nt lds
 v_mfma_f32_16x16x32_bf16 v[124:127], a[28:31], a[188:191], v[124:127]
 v_mfma_f32_16x16x32_bf16 v[124:127], a[44:47], a[196:199], v[124:127]
 v_mfma_f32_16x16x32_bf16 v[124:127], a[60:63], a[200:203], v[124:127]
 ds_read_b64_tr_b16 a[90:91], v46 offset:1280
 v_mfma_f32_16x16x32_bf16 v[124:127], a[76:79], a[204:207], v[124:127]
 v_mfma_f32_16x16x32_bf16 v[140:143], a[76:79], a[176:179], 0
 v_mfma_f32_16x16x32_bf16 v[140:143], a[60:63], a[204:207], v[140:143]
 s_add_u32 m0, s29, 4096
 ds_read_b64_tr_b16 a[92:93], v46 offset:1032
 v_mfma_f32_16x16x32_bf16 v[140:143], a[44:47], a[200:203], v[140:143]
 buffer_load_dwordx4 v5, s[8:11], s78 offen offset:0 lds
 v_mfma_f32_16x16x32_bf16 v[140:143], a[28:31], a[196:199], v[140:143]
 v_mfma_f32_16x16x32_bf16 v[140:143], a[12:15], a[188:191], v[140:143]
 ds_read_b64_tr_b16 a[94:95], v46 offset:1288
 v_mfma_f32_16x16x32_bf16 v[156:159], a[12:15], a[196:199], 0
 v_mfma_f32_16x16x32_bf16 v[156:159], a[28:31], a[200:203], v[156:159]
 v_mfma_f32_16x16x32_bf16 v[156:159], a[44:47], a[204:207], v[156:159]
 s_waitcnt vmcnt(11)
 ds_read_b64_tr_b16 a[104:105], v46 offset:5120
 v_mfma_f32_16x16x32_bf16 v[156:159], a[60:63], a[176:179], v[156:159]
 v_mfma_f32_16x16x32_bf16 v[156:159], a[76:79], a[192:195], v[156:159]
 v_mfma_f32_16x16x32_bf16 v[172:175], a[76:79], a[164:167], 0
 ds_read_b64_tr_b16 a[106:107], v46 offset:5376
 v_mfma_f32_16x16x32_bf16 v[172:175], a[60:63], a[192:195], v[172:175]
 v_mfma_f32_16x16x32_bf16 v[172:175], a[44:47], a[176:179], v[172:175]
 v_mfma_f32_16x16x32_bf16 v[172:175], a[28:31], a[204:207], v[172:175]
 ds_read_b64_tr_b16 a[108:109], v46 offset:5128
 v_mfma_f32_16x16x32_bf16 v[172:175], a[12:15], a[200:203], v[172:175]
 s_add_u32 m0, s29, 6144
 v_mfma_f32_16x16x32_bf16 v[168:171], a[8:11], a[200:203], 0
 buffer_load_dwordx4 v5, s[8:11], s79 offen offset:0 lds
 v_mfma_f32_16x16x32_bf16 v[168:171], a[24:27], a[204:207], v[168:171]
 ds_read_b64_tr_b16 a[110:111], v46 offset:5384
 v_mfma_f32_16x16x32_bf16 v[168:171], a[40:43], a[176:179], v[168:171]
 v_mfma_f32_16x16x32_bf16 v[168:171], a[56:59], a[192:195], v[168:171]
 v_mfma_f32_16x16x32_bf16 v[168:171], a[72:75], a[164:167], v[168:171]
 s_waitcnt vmcnt(10)
 ds_read_b128 a[164:167], v1 offset:19584
 ds_read_b64_tr_b16 a[120:121], v46 offset:9216
 v_mfma_f32_16x16x32_bf16 v[152:155], a[72:75], a[192:195], 0
 ds_read_b128 a[192:195], v1 offset:23936
 v_mfma_f32_16x16x32_bf16 v[152:155], a[56:59], a[176:179], v[152:155]
 s_add_u32 m0, s26, 2048
 v_mfma_f32_16x16x32_bf16 v[152:155], a[40:43], a[204:207], v[152:155]
 ds_read_b64_tr_b16 a[122:123], v46 offset:9472
 buffer_load_dwordx4 v9, s[4:7], 0 offen nt lds
 v_mfma_f32_16x16x32_bf16 v[152:155], a[24:27], a[200:203], v[152:155]
 v_mfma_f32_16x16x32_bf16 v[152:155], a[8:11], a[196:199], v[152:155]
 v_mfma_f32_16x16x32_bf16 v[136:139], a[8:11], a[188:191], 0
 ds_read_b64_tr_b16 a[124:125], v46 offset:9224
 v_mfma_f32_16x16x32_bf16 v[136:139], a[24:27], a[196:199], v[136:139]
 v_mfma_f32_16x16x32_bf16 v[136:139], a[40:43], a[200:203], v[136:139]
 s_add_u32 m0, s29, 8192
 v_mfma_f32_16x16x32_bf16 v[136:139], a[56:59], a[204:207], v[136:139]
 s_waitcnt lgkmcnt(5)
 ds_read_b64_tr_b16 a[126:127], v46 offset:9480
 buffer_load_dwordx4 v5, s[8:11], s80 offen offset:0 lds
 v_mfma_f32_16x16x32_bf16 v[136:139], a[72:75], a[176:179], v[136:139]
 ds_read_b128 a[176:179], v1 offset:28288
 v_mfma_f32_16x16x32_bf16 v[120:123], a[72:75], a[204:207], 0
 ds_read_b128 a[204:207], v1 offset:32640
 v_mfma_f32_16x16x32_bf16 v[120:123], a[56:59], a[200:203], v[120:123]
 s_waitcnt vmcnt(10)
 ds_read_b128 a[200:203], v3 offset:2176
 ds_read_b64_tr_b16 a[136:137], v46 offset:13312
 v_mfma_f32_16x16x32_bf16 v[120:123], a[40:43], a[196:199], v[120:123]
 ds_read_b128 a[196:199], v3 offset:6528
 v_mfma_f32_16x16x32_bf16 v[120:123], a[24:27], a[188:191], v[120:123]
 ds_read_b128 a[188:191], v3 offset:10880
 v_mfma_f32_16x16x32_bf16 v[120:123], a[8:11], a[180:183], v[120:123]
 ds_read_b128 a[180:183], v3 offset:15232
 ds_read_b64_tr_b16 a[138:139], v46 offset:13568
 v_mfma_f32_16x16x32_bf16 v[184:187], a[8:11], a[160:163], 0
 v_mfma_f32_16x16x32_bf16 v[184:187], a[24:27], a[168:171], v[184:187]
 v_mfma_f32_16x16x32_bf16 v[184:187], a[40:43], a[184:187], v[184:187]
 ds_read_b64_tr_b16 a[140:141], v46 offset:13320
 v_mfma_f32_16x16x32_bf16 v[184:187], a[56:59], a[172:175], v[184:187]
 s_waitcnt lgkmcnt(10)
 v_mfma_f32_16x16x32_bf16 v[184:187], a[72:75], a[164:167], v[184:187]
 v_mfma_f32_16x16x32_bf16 v[200:203], a[72:75], a[192:195], 0
 s_add_u32 m0, s29, 10240
 ds_read_b64_tr_b16 a[142:143], v46 offset:13576
 v_mfma_f32_16x16x32_bf16 v[200:203], a[56:59], a[164:167], v[200:203]
 buffer_load_dwordx4 v5, s[8:11], s81 offen offset:0 lds
 v_mfma_f32_16x16x32_bf16 v[200:203], a[40:43], a[172:175], v[200:203]
 v_mfma_f32_16x16x32_bf16 v[200:203], a[24:27], a[184:187], v[200:203]
 s_waitcnt vmcnt(8)
 ds_read_b64_tr_b16 a[152:153], v46 offset:17408
 v_mfma_f32_16x16x32_bf16 v[200:203], a[8:11], a[168:171], v[200:203]
 v_mfma_f32_16x16x32_bf16 v[216:219], a[8:11], a[184:187], 0
 v_mfma_f32_16x16x32_bf16 v[216:219], a[24:27], a[172:175], v[216:219]
 ds_read_b64_tr_b16 a[154:155], v46 offset:17664
 v_mfma_f32_16x16x32_bf16 v[216:219], a[40:43], a[164:167], v[216:219]
 v_mfma_f32_16x16x32_bf16 v[216:219], a[56:59], a[192:195], v[216:219]
 s_waitcnt lgkmcnt(4)
 s_add_u32 m0, s26, 3072
 v_mfma_f32_16x16x32_bf16 v[216:219], a[72:75], a[176:179], v[216:219]
 ds_read_b64_tr_b16 a[156:157], v46 offset:17416
 buffer_load_dwordx4 v10, s[4:7], 0 offen nt lds
 v_mfma_f32_16x16x32_bf16 v[232:235], a[72:75], a[204:207], 0
 v_mfma_f32_16x16x32_bf16 v[232:235], a[56:59], a[176:179], v[232:235]
 v_mfma_f32_16x16x32_bf16 v[232:235], a[40:43], a[192:195], v[232:235]
 ds_read_b64_tr_b16 a[158:159], v46 offset:17672
 v_mfma_f32_16x16x32_bf16 v[232:235], a[24:27], a[164:167], v[232:235]
 s_add_u32 m0, s29, 12288
 v_mfma_f32_16x16x32_bf16 v[232:235], a[8:11], a[172:175], v[232:235]
 buffer_load_dwordx4 v5, s[8:11], s82 offen offset:0 lds
 v_mfma_f32_16x16x32_bf16 v[236:239], a[12:15], a[172:175], 0
 v_mfma_f32_16x16x32_bf16 v[236:239], a[28:31], a[164:167], v[236:239]
 v_mfma_f32_16x16x32_bf16 v[236:239], a[44:47], a[192:195], v[236:239]
 v_mfma_f32_16x16x32_bf16 v[236:239], a[60:63], a[176:179], v[236:239]
 v_mfma_f32_16x16x32_bf16 v[236:239], a[76:79], a[204:207], v[236:239]
 s_waitcnt vmcnt(8)
 ds_read_b64_tr_b16 a[0:1], v46 offset:0
 v_mfma_f32_16x16x32_bf16 v[220:223], a[76:79], a[176:179], 0
 v_mfma_f32_16x16x32_bf16 v[220:223], a[60:63], a[192:195], v[220:223]
 v_mfma_f32_16x16x32_bf16 v[220:223], a[44:47], a[164:167], v[220:223]
 ds_read_b64_tr_b16 a[2:3], v46 offset:256
 v_mfma_f32_16x16x32_bf16 v[220:223], a[28:31], a[172:175], v[220:223]
 v_mfma_f32_16x16x32_bf16 v[220:223], a[12:15], a[184:187], v[220:223]
 v_mfma_f32_16x16x32_bf16 v[204:207], a[12:15], a[168:171], 0
 ds_read_b64_tr_b16 a[4:5], v46 offset:8
 v_mfma_f32_16x16x32_bf16 v[204:207], a[28:31], a[184:187], v[204:207]
 s_add_u32 m0, s29, 14336
 v_mfma_f32_16x16x32_bf16 v[204:207], a[44:47], a[172:175], v[204:207]
 buffer_load_dwordx4 v5, s[8:11], s83 offen offset:0 lds
 v_mfma_f32_16x16x32_bf16 v[204:207], a[60:63], a[164:167], v[204:207]
 ds_read_b64_tr_b16 a[6:7], v46 offset:264
 v_mfma_f32_16x16x32_bf16 v[204:207], a[76:79], a[192:195], v[204:207]
 v_mfma_f32_16x16x32_bf16 v[188:191], a[76:79], a[164:167], 0
 v_mfma_f32_16x16x32_bf16 v[188:191], a[60:63], a[172:175], v[188:191]
 ds_read_b128 a[172:175], v2 offset:0
 v_mfma_f32_16x16x32_bf16 v[188:191], a[44:47], a[184:187], v[188:191]
 v_mfma_f32_16x16x32_bf16 v[188:191], a[28:31], a[168:171], v[188:191]
 v_mfma_f32_16x16x32_bf16 v[188:191], a[12:15], a[160:163], v[188:191]
 ds_read_b128 a[160:163], v2 offset:4352
 ds_read_b128 a[168:171], v2 offset:8704
 v_mfma_f32_16x16x32_bf16 v[252:255], a[12:15], a[164:167], 0
 s_add_u32 m0, s26, 4096
 ds_read_b128 a[184:187], v2 offset:13056
 v_mfma_f32_16x16x32_bf16 v[252:255], a[28:31], a[192:195], v[252:255]
 buffer_load_dwordx4 v11, s[4:7], 0 offen nt lds
 v_mfma_f32_16x16x32_bf16 v[252:255], a[44:47], a[176:179], v[252:255]
 v_mfma_f32_16x16x32_bf16 v[252:255], a[60:63], a[204:207], v[252:255]
 v_mfma_f32_16x16x32_bf16 v[252:255], a[76:79], a[200:203], v[252:255]
 s_add_u32 m0, s29, 16384
 v_mfma_f32_16x16x32_bf16 a[220:223], a[76:79], a[196:199], 0
 buffer_load_dwordx4 v5, s[8:11], s84 offen offset:0 lds
 v_mfma_f32_16x16x32_bf16 a[220:223], a[60:63], a[200:203], a[220:223]
 v_mfma_f32_16x16x32_bf16 a[220:223], a[44:47], a[204:207], a[220:223]
 v_mfma_f32_16x16x32_bf16 a[220:223], a[28:31], a[176:179], a[220:223]
 v_mfma_f32_16x16x32_bf16 a[220:223], a[12:15], a[192:195], a[220:223]
 v_mfma_f32_16x16x32_bf16 a[236:239], a[12:15], a[176:179], 0
 s_waitcnt vmcnt(8)
 ds_read_b64_tr_b16 a[16:17], v46 offset:4096
 v_mfma_f32_16x16x32_bf16 a[236:239], a[28:31], a[204:207], a[236:239]
 v_mfma_f32_16x16x32_bf16 a[236:239], a[44:47], a[200:203], a[236:239]
 v_mfma_f32_16x16x32_bf16 a[236:239], a[60:63], a[196:199], a[236:239]
 ds_read_b64_tr_b16 a[18:19], v46 offset:4352
 v_mfma_f32_16x16x32_bf16 a[236:239], a[76:79], a[188:191], a[236:239]
 v_mfma_f32_16x16x32_bf16 a[252:255], a[76:79], a[180:183], 0
 v_mfma_f32_16x16x32_bf16 a[252:255], a[60:63], a[188:191], a[252:255]
 ds_read_b64_tr_b16 a[20:21], v46 offset:4104
 v_mfma_f32_16x16x32_bf16 a[252:255], a[44:47], a[196:199], a[252:255]
 s_add_u32 m0, s29, 18432
 v_mfma_f32_16x16x32_bf16 a[252:255], a[28:31], a[200:203], a[252:255]
 buffer_load_dwordx4 v5, s[8:11], s85 offen offset:0 lds
 v_mfma_f32_16x16x32_bf16 a[252:255], a[12:15], a[204:207], a[252:255]
 ds_read_b64_tr_b16 a[22:23], v46 offset:4360
 v_mfma_f32_16x16x32_bf16 a[248:251], a[8:11], a[204:207], 0
 v_mfma_f32_16x16x32_bf16 a[248:251], a[24:27], a[200:203], a[248:251]
 v_mfma_f32_16x16x32_bf16 a[248:251], a[40:43], a[196:199], a[248:251]
 v_mfma_f32_16x16x32_bf16 a[248:251], a[56:59], a[188:191], a[248:251]
 v_mfma_f32_16x16x32_bf16 a[248:251], a[72:75], a[180:183], a[248:251]
 ds_read_b128 a[180:183], v2 offset:17408
 v_mfma_f32_16x16x32_bf16 a[232:235], a[72:75], a[188:191], 0
 ds_read_b128 a[188:191], v2 offset:21760
 v_mfma_f32_16x16x32_bf16 a[232:235], a[56:59], a[196:199], a[232:235]
 v_mfma_f32_16x16x32_bf16 a[232:235], a[40:43], a[200:203], a[232:235]
 s_add_u32 m0, s26, 5120
 v_mfma_f32_16x16x32_bf16 a[232:235], a[24:27], a[204:207], a[232:235]
 buffer_load_dwordx4 v12, s[4:7], 0 offen nt lds
 v_mfma_f32_16x16x32_bf16 a[232:235], a[8:11], a[176:179], a[232:235]
 v_mfma_f32_16x16x32_bf16 a[216:219], a[8:11], a[192:195], 0
 s_add_u32 m0, s29, 0
 v_mfma_f32_16x16x32_bf16 a[216:219], a[24:27], a[176:179], a[216:219]
 buffer_load_dwordx4 v5, s[8:11], s76 offen offset:1024 lds
 v_mfma_f32_16x16x32_bf16 a[216:219], a[40:43], a[204:207], a[216:219]
 v_mfma_f32_16x16x32_bf16 a[216:219], a[56:59], a[200:203], a[216:219]
 v_mfma_f32_16x16x32_bf16 a[216:219], a[72:75], a[196:199], a[216:219]
 ds_read_b128 a[196:199], v2 offset:26112
 v_mfma_f32_16x16x32_bf16 v[248:251], a[72:75], a[200:203], 0
 ds_read_b128 a[200:203], v2 offset:30464
 v_mfma_f32_16x16x32_bf16 v[248:251], a[56:59], a[204:207], v[248:251]
 s_waitcnt vmcnt(8)
 ds_read_b64_tr_b16 a[32:33], v46 offset:8192
 v_mfma_f32_16x16x32_bf16 v[248:251], a[40:43], a[176:179], v[248:251]
 v_mfma_f32_16x16x32_bf16 v[248:251], a[24:27], a[192:195], v[248:251]
 v_mfma_f32_16x16x32_bf16 v[248:251], a[8:11], a[164:167], v[248:251]
 s_waitcnt lgkmcnt(3)
 ds_read_b64_tr_b16 a[34:35], v46 offset:8448
 v_mfma_f32_16x16x32_bf16 v[48:51], a[80:83], a[172:175], v[48:51]
 v_mfma_f32_16x16x32_bf16 v[48:51], a[96:99], a[160:163], v[48:51]
 v_mfma_f32_16x16x32_bf16 v[48:51], a[112:115], a[168:171], v[48:51]
 ds_read_b64_tr_b16 a[36:37], v46 offset:8200
 v_mfma_f32_16x16x32_bf16 v[48:51], a[128:131], a[184:187], v[48:51]
 s_add_u32 m0, s29, 2048
 v_mfma_f32_16x16x32_bf16 v[48:51], a[144:147], a[180:183], v[48:51]
 buffer_load_dwordx4 v5, s[8:11], s77 offen offset:1024 lds
 v_mfma_f32_16x16x32_bf16 v[64:67], a[144:147], a[188:191], v[64:67]
 ds_read_b64_tr_b16 a[38:39], v46 offset:8456
 v_mfma_f32_16x16x32_bf16 v[64:67], a[128:131], a[180:183], v[64:67]
 v_mfma_f32_16x16x32_bf16 v[64:67], a[112:115], a[184:187], v[64:67]
 v_mfma_f32_16x16x32_bf16 v[64:67], a[96:99], a[168:171], v[64:67]
 v_mfma_f32_16x16x32_bf16 v[64:67], a[80:83], a[160:163], v[64:67]
 v_mfma_f32_16x16x32_bf16 v[80:83], a[80:83], a[168:171], v[80:83]
 v_mfma_f32_16x16x32_bf16 v[80:83], a[96:99], a[184:187], v[80:83]
 v_mfma_f32_16x16x32_bf16 v[80:83], a[112:115], a[180:183], v[80:83]
 v_mfma_f32_16x16x32_bf16 v[80:83], a[128:131], a[188:191], v[80:83]
 s_waitcnt lgkmcnt(2)
 v_mfma_f32_16x16x32_bf16 v[80:83], a[144:147], a[196:199], v[80:83]
 s_add_u32 m0, s26, 6144
 v_mfma_f32_16x16x32_bf16 v[96:99], a[144:147], a[200:203], v[96:99]
 buffer_load_dwordx4 v13, s[4:7], 0 offen nt lds
 v_mfma_f32_16x16x32_bf16 v[96:99], a[128:131], a[196:199], v[96:99]
 s_add_u32 m0, s29, 4096
 v_mfma_f32_16x16x32_bf16 v[96:99], a[112:115], a[188:191], v[96:99]
 buffer_load_dwordx4 v5, s[8:11], s78 offen offset:1024 lds
 v_mfma_f32_16x16x32_bf16 v[96:99], a[96:99], a[180:183], v[96:99]
 v_mfma_f32_16x16x32_bf16 v[96:99], a[80:83], a[184:187], v[96:99]
 v_mfma_f32_16x16x32_bf16 v[100:103], a[84:87], a[184:187], v[100:103]
 v_mfma_f32_16x16x32_bf16 v[100:103], a[100:103], a[180:183], v[100:103]
 v_mfma_f32_16x16x32_bf16 v[100:103], a[116:119], a[188:191], v[100:103]
 s_waitcnt vmcnt(8)
 ds_read_b64_tr_b16 a[48:49], v46 offset:12288
 v_mfma_f32_16x16x32_bf16 v[100:103], a[132:135], a[196:199], v[100:103]
 ds_read_b128 a[204:207], v4 offset:0
 v_mfma_f32_16x16x32_bf16 v[100:103], a[148:151], a[200:203], v[100:103]
 ds_read_b128 a[176:179], v4 offset:4352
 v_mfma_f32_16x16x32_bf16 v[84:87], a[148:151], a[196:199], v[84:87]
 ds_read_b64_tr_b16 a[50:51], v46 offset:12544
 v_mfma_f32_16x16x32_bf16 v[84:87], a[132:135], a[188:191], v[84:87]
 v_mfma_f32_16x16x32_bf16 v[84:87], a[116:119], a[180:183], v[84:87]
 v_mfma_f32_16x16x32_bf16 v[84:87], a[100:103], a[184:187], v[84:87]
 ds_read_b64_tr_b16 a[52:53], v46 offset:12296
 v_mfma_f32_16x16x32_bf16 v[84:87], a[84:87], a[168:171], v[84:87]
 s_add_u32 m0, s29, 6144
 v_mfma_f32_16x16x32_bf16 v[68:71], a[84:87], a[160:163], v[68:71]
 buffer_load_dwordx4 v5, s[8:11], s79 offen offset:1024 lds
 v_mfma_f32_16x16x32_bf16 v[68:71], a[100:103], a[168:171], v[68:71]
 ds_read_b64_tr_b16 a[54:55], v46 offset:12552
 v_mfma_f32_16x16x32_bf16 v[68:71], a[116:119], a[184:187], v[68:71]
 v_mfma_f32_16x16x32_bf16 v[68:71], a[132:135], a[180:183], v[68:71]
 ds_read_b128 a[192:195], v4 offset:8704
 v_mfma_f32_16x16x32_bf16 v[68:71], a[148:151], a[188:191], v[68:71]
 v_mfma_f32_16x16x32_bf16 v[52:55], a[148:151], a[180:183], v[52:55]
 v_mfma_f32_16x16x32_bf16 v[52:55], a[132:135], a[184:187], v[52:55]
 v_mfma_f32_16x16x32_bf16 v[52:55], a[116:119], a[168:171], v[52:55]
 v_mfma_f32_16x16x32_bf16 v[52:55], a[100:103], a[160:163], v[52:55]
 v_mfma_f32_16x16x32_bf16 v[52:55], a[84:87], a[172:175], v[52:55]
 v_mfma_f32_16x16x32_bf16 v[56:59], a[88:91], a[172:175], v[56:59]
 v_mfma_f32_16x16x32_bf16 v[56:59], a[104:107], a[160:163], v[56:59]
 v_mfma_f32_16x16x32_bf16 v[56:59], a[120:123], a[168:171], v[56:59]
 s_add_u32 m0, s29, 8192
 v_mfma_f32_16x16x32_bf16 v[56:59], a[136:139], a[184:187], v[56:59]
 buffer_load_dwordx4 v5, s[8:11], s80 offen offset:1024 lds
 v_mfma_f32_16x16x32_bf16 v[56:59], a[152:155], a[180:183], v[56:59]
 s_add_u32 m0, s26, 7168
 v_mfma_f32_16x16x32_bf16 v[72:75], a[152:155], a[188:191], v[72:75]
 buffer_load_dwordx4 v14, s[4:7], 0 offen nt lds
 v_mfma_f32_16x16x32_bf16 v[72:75], a[136:139], a[180:183], v[72:75]
 v_mfma_f32_16x16x32_bf16 v[72:75], a[120:123], a[184:187], v[72:75]
 v_mfma_f32_16x16x32_bf16 v[72:75], a[104:107], a[168:171], v[72:75]
 s_waitcnt vmcnt(8)
 ds_read_b64_tr_b16 a[64:65], v46 offset:16384
 v_mfma_f32_16x16x32_bf16 v[72:75], a[88:91], a[160:163], v[72:75]
 v_mfma_f32_16x16x32_bf16 v[88:91], a[88:91], a[168:171], v[88:91]
 v_mfma_f32_16x16x32_bf16 v[88:91], a[104:107], a[184:187], v[88:91]
 ds_read_b64_tr_b16 a[66:67], v46 offset:16640
 v_mfma_f32_16x16x32_bf16 v[88:91], a[120:123], a[180:183], v[88:91]
 v_mfma_f32_16x16x32_bf16 v[88:91], a[136:139], a[188:191], v[88:91]
 v_mfma_f32_16x16x32_bf16 v[88:91], a[152:155], a[196:199], v[88:91]
 ds_read_b64_tr_b16 a[68:69], v46 offset:16392
 v_mfma_f32_16x16x32_bf16 v[104:107], a[152:155], a[200:203], v[104:107]
 s_add_u32 m0, s29, 10240
 v_mfma_f32_16x16x32_bf16 v[104:107], a[136:139], a[196:199], v[104:107]
 buffer_load_dwordx4 v5, s[8:11], s81 offen offset:1024 lds
 v_mfma_f32_16x16x32_bf16 v[104:107], a[120:123], a[188:191], v[104:107]
 ds_read_b64_tr_b16 a[70:71], v46 offset:16648
 v_mfma_f32_16x16x32_bf16 v[104:107], a[104:107], a[180:183], v[104:107]
 v_mfma_f32_16x16x32_bf16 v[104:107], a[88:91], a[184:187], v[104:107]
 v_mfma_f32_16x16x32_bf16 v[108:111], a[92:95], a[184:187], v[108:111]
 v_mfma_f32_16x16x32_bf16 v[108:111], a[108:111], a[180:183], v[108:111]
 v_mfma_f32_16x16x32_bf16 v[108:111], a[124:127], a[188:191], v[108:111]
 v_mfma_f32_16x16x32_bf16 v[108:111], a[140:143], a[196:199], v[108:111]
 v_mfma_f32_16x16x32_bf16 v[108:111], a[156:159], a[200:203], v[108:111]
 v_mfma_f32_16x16x32_bf16 v[92:95], a[156:159], a[196:199], v[92:95]
 v_mfma_f32_16x16x32_bf16 v[92:95], a[140:143], a[188:191], v[92:95]
 v_mfma_f32_16x16x32_bf16 v[92:95], a[124:127], a[180:183], v[92:95]
 v_mfma_f32_16x16x32_bf16 v[92:95], a[108:111], a[184:187], v[92:95]
 s_add_u32 m0, s29, 12288
 v_mfma_f32_16x16x32_bf16 v[92:95], a[92:95], a[168:171], v[92:95]
 buffer_load_dwordx4 v5, s[8:11], s82 offen offset:1024 lds
 v_mfma_f32_16x16x32_bf16 v[76:79], a[92:95], a[160:163], v[76:79]
 v_mfma_f32_16x16x32_bf16 v[76:79], a[108:111], a[168:171], v[76:79]
 s_mov_b32 m0, s27
 v_mfma_f32_16x16x32_bf16 v[76:79], a[124:127], a[184:187], v[76:79]
 buffer_load_dwordx4 v15, s[4:7], 0 offen nt lds
 v_mfma_f32_16x16x32_bf16 v[76:79], a[140:143], a[180:183], v[76:79]
 s_add_u32 s4, s4, 128
 s_addc_u32 s5, s5, 0
 s_xor_b32 s26, s26, 0x10000
 v_mfma_f32_16x16x32_bf16 v[76:79], a[156:159], a[188:191], v[76:79]
 s_waitcnt vmcnt(8)
 s_xor_b32 s27, s27, s31
 ds_read_b64_tr_b16 a[8:9], v46 offset:1024
 v_mfma_f32_16x16x32_bf16 v[60:63], a[156:159], a[180:183], v[60:63]
 v_mfma_f32_16x16x32_bf16 v[60:63], a[140:143], a[184:187], v[60:63]
 ds_read_b128 a[184:187], v4 offset:13056
 v_mfma_f32_16x16x32_bf16 v[60:63], a[124:127], a[168:171], v[60:63]
 ds_read_b64_tr_b16 a[10:11], v46 offset:1280
 v_mfma_f32_16x16x32_bf16 v[60:63], a[108:111], a[160:163], v[60:63]
 v_mfma_f32_16x16x32_bf16 v[60:63], a[92:95], a[172:175], v[60:63]
 v_mfma_f32_16x16x32_bf16 v[124:127], a[92:95], a[180:183], v[124:127]
 ds_read_b64_tr_b16 a[12:13], v46 offset:1032
 v_mfma_f32_16x16x32_bf16 v[124:127], a[108:111], a[188:191], v[124:127]
 s_add_u32 m0, s29, 14336
 v_mfma_f32_16x16x32_bf16 v[124:127], a[124:127], a[196:199], v[124:127]
 buffer_load_dwordx4 v5, s[8:11], s83 offen offset:1024 lds
 v_mfma_f32_16x16x32_bf16 v[124:127], a[140:143], a[200:203], v[124:127]
 s_waitcnt lgkmcnt(4)
 ds_read_b64_tr_b16 a[14:15], v46 offset:1288
 v_mfma_f32_16x16x32_bf16 v[124:127], a[156:159], a[204:207], v[124:127]
 v_mfma_f32_16x16x32_bf16 v[140:143], a[156:159], a[176:179], v[140:143]
 v_mfma_f32_16x16x32_bf16 v[140:143], a[140:143], a[204:207], v[140:143]
 v_mfma_f32_16x16x32_bf16 v[140:143], a[124:127], a[200:203], v[140:143]
 v_mfma_f32_16x16x32_bf16 v[140:143], a[108:111], a[196:199], v[140:143]
 v_mfma_f32_16x16x32_bf16 v[140:143], a[92:95], a[188:191], v[140:143]
 v_mfma_f32_16x16x32_bf16 v[156:159], a[92:95], a[196:199], v[156:159]
 v_mfma_f32_16x16x32_bf16 v[156:159], a[108:111], a[200:203], v[156:159]
 v_mfma_f32_16x16x32_bf16 v[156:159], a[124:127], a[204:207], v[156:159]
 v_mfma_f32_16x16x32_bf16 v[156:159], a[140:143], a[176:179], v[156:159]
 v_mfma_f32_16x16x32_bf16 v[156:159], a[156:159], a[192:195], v[156:159]
 s_waitcnt lgkmcnt(1)
 s_add_u32 m0, s29, 16384
 v_mfma_f32_16x16x32_bf16 v[172:175], a[156:159], a[184:187], v[172:175]
 buffer_load_dwordx4 v5, s[8:11], s84 offen offset:1024 lds
 v_mfma_f32_16x16x32_bf16 v[172:175], a[140:143], a[192:195], v[172:175]
 v_mfma_f32_16x16x32_bf16 v[172:175], a[124:127], a[176:179], v[172:175]
 v_mfma_f32_16x16x32_bf16 v[172:175], a[108:111], a[204:207], v[172:175]
 v_mfma_f32_16x16x32_bf16 v[172:175], a[92:95], a[200:203], v[172:175]
 ds_read_b128 a[164:167], v2 offset:2176
 v_mfma_f32_16x16x32_bf16 v[168:171], a[88:91], a[200:203], v[168:171]
 s_waitcnt vmcnt(7)
 ds_read_b128 a[160:163], v2 offset:6528
 ds_read_b64_tr_b16 a[24:25], v46 offset:5120
 v_mfma_f32_16x16x32_bf16 v[168:171], a[104:107], a[204:207], v[168:171]
 ds_read_b128 a[168:171], v2 offset:10880
 v_mfma_f32_16x16x32_bf16 v[168:171], a[120:123], a[176:179], v[168:171]
 ds_read_b128 a[172:175], v2 offset:15232
 v_mfma_f32_16x16x32_bf16 v[168:171], a[136:139], a[192:195], v[168:171]
 ds_read_b64_tr_b16 a[26:27], v46 offset:5376
 v_mfma_f32_16x16x32_bf16 v[168:171], a[152:155], a[184:187], v[168:171]
 v_mfma_f32_16x16x32_bf16 v[152:155], a[152:155], a[192:195], v[152:155]
 v_mfma_f32_16x16x32_bf16 v[152:155], a[136:139], a[176:179], v[152:155]
 ds_read_b64_tr_b16 a[28:29], v46 offset:5128
 v_mfma_f32_16x16x32_bf16 v[152:155], a[120:123], a[204:207], v[152:155]
 s_add_u32 m0, s29, 18432
 v_mfma_f32_16x16x32_bf16 v[152:155], a[104:107], a[200:203], v[152:155]
 buffer_load_dwordx4 v5, s[8:11], s85 offen offset:1024 lds
 v_mfma_f32_16x16x32_bf16 v[152:155], a[88:91], a[196:199], v[152:155]
 s_add_u32 s8, s8, 0x10000
 s_addc_u32 s9, s9, 0
 ds_read_b64_tr_b16 a[30:31], v46 offset:5384
 v_mfma_f32_16x16x32_bf16 v[136:139], a[88:91], a[188:191], v[136:139]
 v_mfma_f32_16x16x32_bf16 v[136:139], a[104:107], a[196:199], v[136:139]
 v_mfma_f32_16x16x32_bf16 v[136:139], a[120:123], a[200:203], v[136:139]
 s_add_u32 m0, s29, 0
 v_mfma_f32_16x16x32_bf16 v[136:139], a[136:139], a[204:207], v[136:139]
 buffer_load_dwordx4 v5, s[8:11], s76 offen offset:0 lds
 v_mfma_f32_16x16x32_bf16 v[136:139], a[152:155], a[176:179], v[136:139]
 v_mfma_f32_16x16x32_bf16 v[120:123], a[152:155], a[204:207], v[120:123]
 v_mfma_f32_16x16x32_bf16 v[120:123], a[136:139], a[200:203], v[120:123]
 v_mfma_f32_16x16x32_bf16 v[120:123], a[120:123], a[196:199], v[120:123]
 v_mfma_f32_16x16x32_bf16 v[120:123], a[104:107], a[188:191], v[120:123]
 v_mfma_f32_16x16x32_bf16 v[120:123], a[88:91], a[180:183], v[120:123]
 v_mfma_f32_16x16x32_bf16 v[116:119], a[84:87], a[180:183], v[116:119]
 v_mfma_f32_16x16x32_bf16 v[116:119], a[100:103], a[188:191], v[116:119]
 s_add_u32 m0, s29, 2048
 v_mfma_f32_16x16x32_bf16 v[116:119], a[116:119], a[196:199], v[116:119]
 buffer_load_dwordx4 v5, s[8:11], s77 offen offset:0 lds
 v_mfma_f32_16x16x32_bf16 v[116:119], a[132:135], a[200:203], v[116:119]
 v_mfma_f32_16x16x32_bf16 v[116:119], a[148:151], a[204:207], v[116:119]
 v_mfma_f32_16x16x32_bf16 v[132:135], a[148:151], a[176:179], v[132:135]
 v_mfma_f32_16x16x32_bf16 v[132:135], a[132:135], a[204:207], v[132:135]
 s_waitcnt vmcnt(7)
 ds_read_b64_tr_b16 a[40:41], v46 offset:9216
 v_mfma_f32_16x16x32_bf16 v[132:135], a[116:119], a[200:203], v[132:135]
 v_mfma_f32_16x16x32_bf16 v[132:135], a[100:103], a[196:199], v[132:135]
 v_mfma_f32_16x16x32_bf16 v[132:135], a[84:87], a[188:191], v[132:135]
 ds_read_b64_tr_b16 a[42:43], v46 offset:9472
 v_mfma_f32_16x16x32_bf16 v[148:151], a[84:87], a[196:199], v[148:151]
 s_add_u32 m0, s29, 4096
 v_mfma_f32_16x16x32_bf16 v[148:151], a[100:103], a[200:203], v[148:151]
 buffer_load_dwordx4 v5, s[8:11], s78 offen offset:0 lds
 v_mfma_f32_16x16x32_bf16 v[148:151], a[116:119], a[204:207], v[148:151]
 ds_read_b64_tr_b16 a[44:45], v46 offset:9224
 v_mfma_f32_16x16x32_bf16 v[148:151], a[132:135], a[176:179], v[148:151]
 v_mfma_f32_16x16x32_bf16 v[148:151], a[148:151], a[192:195], v[148:151]
 v_mfma_f32_16x16x32_bf16 v[164:167], a[148:151], a[184:187], v[164:167]
 ds_read_b64_tr_b16 a[46:47], v46 offset:9480
 v_mfma_f32_16x16x32_bf16 v[164:167], a[132:135], a[192:195], v[164:167]
 v_mfma_f32_16x16x32_bf16 v[164:167], a[116:119], a[176:179], v[164:167]
 v_mfma_f32_16x16x32_bf16 v[164:167], a[100:103], a[204:207], v[164:167]
 v_mfma_f32_16x16x32_bf16 v[164:167], a[84:87], a[200:203], v[164:167]
 s_add_u32 m0, s29, 6144
 v_mfma_f32_16x16x32_bf16 v[160:163], a[80:83], a[200:203], v[160:163]
 buffer_load_dwordx4 v5, s[8:11], s79 offen offset:0 lds
 v_mfma_f32_16x16x32_bf16 v[160:163], a[96:99], a[204:207], v[160:163]
 v_mfma_f32_16x16x32_bf16 v[160:163], a[112:115], a[176:179], v[160:163]
 v_mfma_f32_16x16x32_bf16 v[160:163], a[128:131], a[192:195], v[160:163]
 v_mfma_f32_16x16x32_bf16 v[160:163], a[144:147], a[184:187], v[160:163]
 ds_read_b128 a[184:187], v2 offset:19584
 v_mfma_f32_16x16x32_bf16 v[144:147], a[144:147], a[192:195], v[144:147]
 ds_read_b128 a[192:195], v2 offset:23936
 v_mfma_f32_16x16x32_bf16 v[144:147], a[128:131], a[176:179], v[144:147]
 v_mfma_f32_16x16x32_bf16 v[144:147], a[112:115], a[204:207], v[144:147]
 v_mfma_f32_16x16x32_bf16 v[144:147], a[96:99], a[200:203], v[144:147]
 s_add_u32 m0, s29, 8192
 v_mfma_f32_16x16x32_bf16 v[144:147], a[80:83], a[196:199], v[144:147]
 buffer_load_dwordx4 v5, s[8:11], s80 offen offset:0 lds
 v_mfma_f32_16x16x32_bf16 v[128:131], a[80:83], a[188:191], v[128:131]
 v_mfma_f32_16x16x32_bf16 v[128:131], a[96:99], a[196:199], v[128:131]
 v_mfma_f32_16x16x32_bf16 v[128:131], a[112:115], a[200:203], v[128:131]
 s_waitcnt vmcnt(7)
 ds_read_b64_tr_b16 a[56:57], v46 offset:13312
 v_mfma_f32_16x16x32_bf16 v[128:131], a[128:131], a[204:207], v[128:131]
 v_mfma_f32_16x16x32_bf16 v[128:131], a[144:147], a[176:179], v[128:131]
 v_mfma_f32_16x16x32_bf16 v[112:115], a[144:147], a[204:207], v[112:115]
 ds_read_b128 a[204:207], v2 offset:28288
 ds_read_b64_tr_b16 a[58:59], v46 offset:13568
 v_mfma_f32_16x16x32_bf16 v[112:115], a[128:131], a[200:203], v[112:115]
 ds_read_b128 a[200:203], v2 offset:32640
 v_mfma_f32_16x16x32_bf16 v[112:115], a[112:115], a[196:199], v[112:115]
 s_add_u32 m0, s29, 10240
 v_mfma_f32_16x16x32_bf16 v[112:115], a[96:99], a[188:191], v[112:115]
 ds_read_b64_tr_b16 a[60:61], v46 offset:13320
 buffer_load_dwordx4 v5, s[8:11], s81 offen offset:0 lds
 v_mfma_f32_16x16x32_bf16 v[112:115], a[80:83], a[180:183], v[112:115]
 s_waitcnt lgkmcnt(5)
 v_mfma_f32_16x16x32_bf16 v[176:179], a[80:83], a[164:167], v[176:179]
 v_mfma_f32_16x16x32_bf16 v[176:179], a[96:99], a[160:163], v[176:179]
 ds_read_b64_tr_b16 a[62:63], v46 offset:13576
 v_mfma_f32_16x16x32_bf16 v[176:179], a[112:115], a[168:171], v[176:179]
 v_mfma_f32_16x16x32_bf16 v[176:179], a[128:131], a[172:175], v[176:179]
 v_mfma_f32_16x16x32_bf16 v[176:179], a[144:147], a[184:187], v[176:179]
 v_mfma_f32_16x16x32_bf16 v[192:195], a[144:147], a[192:195], v[192:195]
 v_mfma_f32_16x16x32_bf16 v[192:195], a[128:131], a[184:187], v[192:195]
 s_add_u32 m0, s29, 12288
 v_mfma_f32_16x16x32_bf16 v[192:195], a[112:115], a[172:175], v[192:195]
 buffer_load_dwordx4 v5, s[8:11], s82 offen offset:0 lds
 v_mfma_f32_16x16x32_bf16 v[192:195], a[96:99], a[168:171], v[192:195]
 v_mfma_f32_16x16x32_bf16 v[192:195], a[80:83], a[160:163], v[192:195]
 v_mfma_f32_16x16x32_bf16 v[208:211], a[80:83], a[168:171], v[208:211]
 v_mfma_f32_16x16x32_bf16 v[208:211], a[96:99], a[172:175], v[208:211]
 v_mfma_f32_16x16x32_bf16 v[208:211], a[112:115], a[184:187], v[208:211]
 v_mfma_f32_16x16x32_bf16 v[208:211], a[128:131], a[192:195], v[208:211]
 s_waitcnt lgkmcnt(0)
 v_mfma_f32_16x16x32_bf16 v[208:211], a[144:147], a[204:207], v[208:211]
 v_mfma_f32_16x16x32_bf16 v[224:227], a[144:147], a[200:203], v[224:227]
 v_mfma_f32_16x16x32_bf16 v[224:227], a[128:131], a[204:207], v[224:227]
 s_add_u32 m0, s29, 14336
 v_mfma_f32_16x16x32_bf16 v[224:227], a[112:115], a[192:195], v[224:227]
 buffer_load_dwordx4 v5, s[8:11], s83 offen offset:0 lds
 v_mfma_f32_16x16x32_bf16 v[224:227], a[96:99], a[184:187], v[224:227]
 s_waitcnt vmcnt(8)
 ds_read_b64_tr_b16 a[72:73], v46 offset:17408
 v_mfma_f32_16x16x32_bf16 v[224:227], a[80:83], a[172:175], v[224:227]
 v_mfma_f32_16x16x32_bf16 v[228:231], a[84:87], a[172:175], v[228:231]
 v_mfma_f32_16x16x32_bf16 v[228:231], a[100:103], a[184:187], v[228:231]
 ds_read_b64_tr_b16 a[74:75], v46 offset:17664
 v_mfma_f32_16x16x32_bf16 v[228:231], a[116:119], a[192:195], v[228:231]
 v_mfma_f32_16x16x32_bf16 v[228:231], a[132:135], a[204:207], v[228:231]
 ds_read_b128 a[196:199], v4 offset:2176
 v_mfma_f32_16x16x32_bf16 v[228:231], a[148:151], a[200:203], v[228:231]
 ds_read_b128 a[188:191], v4 offset:6528
 ds_read_b64_tr_b16 a[76:77], v46 offset:17416
 v_mfma_f32_16x16x32_bf16 v[212:215], a[148:151], a[204:207], v[212:215]
 s_add_u32 m0, s29, 16384
 v_mfma_f32_16x16x32_bf16 v[212:215], a[132:135], a[192:195], v[212:215]
 buffer_load_dwordx4 v5, s[8:11], s84 offen offset:0 lds
 v_mfma_f32_16x16x32_bf16 v[212:215], a[116:119], a[184:187], v[212:215]
 ds_read_b64_tr_b16 a[78:79], v46 offset:17672
 v_mfma_f32_16x16x32_bf16 v[212:215], a[100:103], a[172:175], v[212:215]
 v_mfma_f32_16x16x32_bf16 v[212:215], a[84:87], a[168:171], v[212:215]
 v_mfma_f32_16x16x32_bf16 v[196:199], a[84:87], a[160:163], v[196:199]
 v_mfma_f32_16x16x32_bf16 v[196:199], a[100:103], a[168:171], v[196:199]
 v_mfma_f32_16x16x32_bf16 v[196:199], a[116:119], a[172:175], v[196:199]
 v_mfma_f32_16x16x32_bf16 v[196:199], a[132:135], a[184:187], v[196:199]
 ds_read_b128 a[176:179], v4 offset:10880
 v_mfma_f32_16x16x32_bf16 v[196:199], a[148:151], a[192:195], v[196:199]
 s_add_u32 m0, s29, 18432
 ds_read_b128 a[180:183], v4 offset:15232
 v_mfma_f32_16x16x32_bf16 v[180:183], a[148:151], a[184:187], v[180:183]
 buffer_load_dwordx4 v5, s[8:11], s85 offen offset:0 lds
 v_mfma_f32_16x16x32_bf16 v[180:183], a[132:135], a[172:175], v[180:183]
 v_mfma_f32_16x16x32_bf16 v[180:183], a[116:119], a[168:171], v[180:183]
 v_mfma_f32_16x16x32_bf16 v[180:183], a[100:103], a[160:163], v[180:183]
 v_mfma_f32_16x16x32_bf16 v[180:183], a[84:87], a[164:167], v[180:183]
 v_mfma_f32_16x16x32_bf16 v[184:187], a[88:91], a[164:167], v[184:187]
 v_mfma_f32_16x16x32_bf16 v[184:187], a[104:107], a[160:163], v[184:187]
 v_mfma_f32_16x16x32_bf16 v[184:187], a[120:123], a[168:171], v[184:187]
 v_mfma_f32_16x16x32_bf16 v[184:187], a[136:139], a[172:175], v[184:187]
 s_add_u32 m0, s29, 0
 v_mfma_f32_16x16x32_bf16 v[184:187], a[152:155], a[184:187], v[184:187]
 buffer_load_dwordx4 v5, s[8:11], s76 offen offset:1024 lds
 v_mfma_f32_16x16x32_bf16 v[200:203], a[152:155], a[192:195], v[200:203]
 v_mfma_f32_16x16x32_bf16 v[200:203], a[136:139], a[184:187], v[200:203]
 v_mfma_f32_16x16x32_bf16 v[200:203], a[120:123], a[172:175], v[200:203]
 v_mfma_f32_16x16x32_bf16 v[200:203], a[104:107], a[168:171], v[200:203]
 v_mfma_f32_16x16x32_bf16 v[200:203], a[88:91], a[160:163], v[200:203]
 v_mfma_f32_16x16x32_bf16 v[216:219], a[88:91], a[168:171], v[216:219]
 v_mfma_f32_16x16x32_bf16 v[216:219], a[104:107], a[172:175], v[216:219]
 v_mfma_f32_16x16x32_bf16 v[216:219], a[120:123], a[184:187], v[216:219]
 s_add_u32 m0, s29, 2048
 v_mfma_f32_16x16x32_bf16 v[216:219], a[136:139], a[192:195], v[216:219]
 buffer_load_dwordx4 v5, s[8:11], s77 offen offset:1024 lds
 v_mfma_f32_16x16x32_bf16 v[216:219], a[152:155], a[204:207], v[216:219]
 v_mfma_f32_16x16x32_bf16 v[232:235], a[152:155], a[200:203], v[232:235]
 v_mfma_f32_16x16x32_bf16 v[232:235], a[136:139], a[204:207], v[232:235]
 v_mfma_f32_16x16x32_bf16 v[232:235], a[120:123], a[192:195], v[232:235]
 v_mfma_f32_16x16x32_bf16 v[232:235], a[104:107], a[184:187], v[232:235]
 v_mfma_f32_16x16x32_bf16 v[232:235], a[88:91], a[172:175], v[232:235]
 v_mfma_f32_16x16x32_bf16 v[236:239], a[92:95], a[172:175], v[236:239]
 v_mfma_f32_16x16x32_bf16 v[236:239], a[108:111], a[184:187], v[236:239]
 s_add_u32 m0, s29, 4096
 v_mfma_f32_16x16x32_bf16 v[236:239], a[124:127], a[192:195], v[236:239]
 buffer_load_dwordx4 v5, s[8:11], s78 offen offset:1024 lds
 v_mfma_f32_16x16x32_bf16 v[236:239], a[140:143], a[204:207], v[236:239]
 v_mfma_f32_16x16x32_bf16 v[236:239], a[156:159], a[200:203], v[236:239]
 v_mfma_f32_16x16x32_bf16 v[220:223], a[156:159], a[204:207], v[220:223]
 v_mfma_f32_16x16x32_bf16 v[220:223], a[140:143], a[192:195], v[220:223]
 v_mfma_f32_16x16x32_bf16 v[220:223], a[124:127], a[184:187], v[220:223]
 v_mfma_f32_16x16x32_bf16 v[220:223], a[108:111], a[172:175], v[220:223]
 v_mfma_f32_16x16x32_bf16 v[220:223], a[92:95], a[168:171], v[220:223]
 v_mfma_f32_16x16x32_bf16 v[204:207], a[92:95], a[160:163], v[204:207]
 s_add_u32 m0, s29, 6144
 v_mfma_f32_16x16x32_bf16 v[204:207], a[108:111], a[168:171], v[204:207]
 buffer_load_dwordx4 v5, s[8:11], s79 offen offset:1024 lds
 v_mfma_f32_16x16x32_bf16 v[204:207], a[124:127], a[172:175], v[204:207]
 v_mfma_f32_16x16x32_bf16 v[204:207], a[140:143], a[184:187], v[204:207]
 v_mfma_f32_16x16x32_bf16 v[204:207], a[156:159], a[192:195], v[204:207]
 v_mfma_f32_16x16x32_bf16 v[188:191], a[156:159], a[184:187], v[188:191]
 v_mfma_f32_16x16x32_bf16 v[188:191], a[140:143], a[172:175], v[188:191]
 v_mfma_f32_16x16x32_bf16 v[188:191], a[124:127], a[168:171], v[188:191]
 v_mfma_f32_16x16x32_bf16 v[188:191], a[108:111], a[160:163], v[188:191]
 s_waitcnt lgkmcnt(0)
 s_barrier
 v_mfma_f32_16x16x32_bf16 v[188:191], a[92:95], a[164:167], v[188:191]
 v_xor_b32 v1, 0x10000, v1
 v_xor_b32 v2, 0x10000, v2
 v_mfma_f32_16x16x32_bf16 v[252:255], a[92:95], a[184:187], v[252:255]
 v_xor_b32 v3, 0x10000, v3
 v_xor_b32 v4, 0x10000, v4
 v_mfma_f32_16x16x32_bf16 v[252:255], a[108:111], a[192:195], v[252:255]
 ds_read_b128 a[160:163], v1 offset:0
 ds_read_b128 a[164:167], v1 offset:4352
 v_mfma_f32_16x16x32_bf16 v[252:255], a[124:127], a[204:207], v[252:255]
 s_add_u32 m0, s29, 8192
 ds_read_b128 a[168:171], v1 offset:8704
 ds_read_b128 a[172:175], v1 offset:13056
 v_mfma_f32_16x16x32_bf16 v[252:255], a[140:143], a[200:203], v[252:255]
 buffer_load_dwordx4 v5, s[8:11], s80 offen offset:1024 lds
 v_mfma_f32_16x16x32_bf16 v[252:255], a[156:159], a[196:199], v[252:255]
 v_mfma_f32_16x16x32_bf16 a[220:223], a[156:159], a[188:191], a[220:223]
 v_mfma_f32_16x16x32_bf16 a[220:223], a[140:143], a[196:199], a[220:223]
 v_mfma_f32_16x16x32_bf16 a[220:223], a[124:127], a[200:203], a[220:223]
 v_mfma_f32_16x16x32_bf16 a[220:223], a[108:111], a[204:207], a[220:223]
 v_mfma_f32_16x16x32_bf16 a[220:223], a[92:95], a[192:195], a[220:223]
 s_add_u32 m0, s29, 10240
 v_mfma_f32_16x16x32_bf16 a[236:239], a[92:95], a[204:207], a[236:239]
 buffer_load_dwordx4 v5, s[8:11], s81 offen offset:1024 lds
 v_mfma_f32_16x16x32_bf16 a[236:239], a[108:111], a[200:203], a[236:239]
 v_mfma_f32_16x16x32_bf16 a[236:239], a[124:127], a[196:199], a[236:239]
 v_mfma_f32_16x16x32_bf16 a[236:239], a[140:143], a[188:191], a[236:239]
 v_mfma_f32_16x16x32_bf16 a[236:239], a[156:159], a[176:179], a[236:239]
 v_mfma_f32_16x16x32_bf16 a[252:255], a[156:159], a[180:183], a[252:255]
 v_mfma_f32_16x16x32_bf16 a[252:255], a[140:143], a[176:179], a[252:255]
 v_mfma_f32_16x16x32_bf16 a[252:255], a[124:127], a[188:191], a[252:255]
 v_mfma_f32_16x16x32_bf16 a[252:255], a[108:111], a[196:199], a[252:255]
 s_add_u32 m0, s29, 12288
 v_mfma_f32_16x16x32_bf16 a[252:255], a[92:95], a[200:203], a[252:255]
 buffer_load_dwordx4 v5, s[8:11], s82 offen offset:1024 lds
 v_mfma_f32_16x16x32_bf16 a[248:251], a[88:91], a[200:203], a[248:251]
 v_mfma_f32_16x16x32_bf16 a[248:251], a[104:107], a[196:199], a[248:251]
 v_mfma_f32_16x16x32_bf16 a[248:251], a[120:123], a[188:191], a[248:251]
 v_mfma_f32_16x16x32_bf16 a[248:251], a[136:139], a[176:179], a[248:251]
 v_mfma_f32_16x16x32_bf16 a[248:251], a[152:155], a[180:183], a[248:251]
 v_mfma_f32_16x16x32_bf16 a[232:235], a[152:155], a[176:179], a[232:235]
 v_mfma_f32_16x16x32_bf16 a[232:235], a[136:139], a[188:191], a[232:235]
 v_mfma_f32_16x16x32_bf16 a[232:235], a[120:123], a[196:199], a[232:235]
 s_add_u32 m0, s29, 14336
 v_mfma_f32_16x16x32_bf16 a[232:235], a[104:107], a[200:203], a[232:235]
 buffer_load_dwordx4 v5, s[8:11], s83 offen offset:1024 lds
 v_mfma_f32_16x16x32_bf16 a[232:235], a[88:91], a[204:207], a[232:235]
 v_mfma_f32_16x16x32_bf16 a[216:219], a[88:91], a[192:195], a[216:219]
 v_mfma_f32_16x16x32_bf16 a[216:219], a[104:107], a[204:207], a[216:219]
 v_mfma_f32_16x16x32_bf16 a[216:219], a[120:123], a[200:203], a[216:219]
 v_mfma_f32_16x16x32_bf16 a[216:219], a[136:139], a[196:199], a[216:219]
 v_mfma_f32_16x16x32_bf16 a[216:219], a[152:155], a[188:191], a[216:219]
 v_mfma_f32_16x16x32_bf16 v[248:251], a[152:155], a[196:199], v[248:251]
 v_mfma_f32_16x16x32_bf16 v[248:251], a[136:139], a[200:203], v[248:251]
 s_add_u32 m0, s29, 16384
 v_mfma_f32_16x16x32_bf16 v[248:251], a[120:123], a[204:207], v[248:251]
 buffer_load_dwordx4 v5, s[8:11], s84 offen offset:1024 lds
 v_mfma_f32_16x16x32_bf16 v[248:251], a[104:107], a[192:195], v[248:251]
 v_mfma_f32_16x16x32_bf16 v[248:251], a[88:91], a[184:187], v[248:251]
 v_mfma_f32_16x16x32_bf16 v[244:247], a[84:87], a[184:187], v[244:247]
 v_mfma_f32_16x16x32_bf16 v[244:247], a[100:103], a[192:195], v[244:247]
 v_mfma_f32_16x16x32_bf16 v[244:247], a[116:119], a[204:207], v[244:247]
 v_mfma_f32_16x16x32_bf16 v[244:247], a[132:135], a[200:203], v[244:247]
 v_mfma_f32_16x16x32_bf16 v[244:247], a[148:151], a[196:199], v[244:247]
 v_mfma_f32_16x16x32_bf16 a[212:215], a[148:151], a[188:191], a[212:215]
 s_add_u32 m0, s29, 18432
 v_mfma_f32_16x16x32_bf16 a[212:215], a[132:135], a[196:199], a[212:215]
 buffer_load_dwordx4 v5, s[8:11], s85 offen offset:1024 lds
 v_mfma_f32_16x16x32_bf16 a[212:215], a[116:119], a[200:203], a[212:215]
 s_add_u32 s8, s8, 0x10000
 s_addc_u32 s9, s9, 0
 v_mfma_f32_16x16x32_bf16 a[212:215], a[100:103], a[204:207], a[212:215]
 v_mfma_f32_16x16x32_bf16 a[212:215], a[84:87], a[192:195], a[212:215]
 v_mfma_f32_16x16x32_bf16 a[228:231], a[84:87], a[204:207], a[228:231]
 v_mfma_f32_16x16x32_bf16 a[228:231], a[100:103], a[200:203], a[228:231]
 v_mfma_f32_16x16x32_bf16 a[228:231], a[116:119], a[196:199], a[228:231]
 v_mfma_f32_16x16x32_bf16 a[228:231], a[132:135], a[188:191], a[228:231]
 v_mfma_f32_16x16x32_bf16 a[228:231], a[148:151], a[176:179], a[228:231]
 v_mfma_f32_16x16x32_bf16 a[244:247], a[148:151], a[180:183], a[244:247]
 v_mfma_f32_16x16x32_bf16 a[244:247], a[132:135], a[176:179], a[244:247]
 v_mfma_f32_16x16x32_bf16 a[244:247], a[116:119], a[188:191], a[244:247]
 v_mfma_f32_16x16x32_bf16 a[244:247], a[100:103], a[196:199], a[244:247]
 v_mfma_f32_16x16x32_bf16 a[244:247], a[84:87], a[200:203], a[244:247]
 v_mfma_f32_16x16x32_bf16 a[240:243], a[80:83], a[200:203], a[240:243]
 v_mfma_f32_16x16x32_bf16 a[240:243], a[96:99], a[196:199], a[240:243]
 v_mfma_f32_16x16x32_bf16 a[240:243], a[112:115], a[188:191], a[240:243]
 v_mfma_f32_16x16x32_bf16 a[240:243], a[128:131], a[176:179], a[240:243]
 v_mfma_f32_16x16x32_bf16 a[240:243], a[144:147], a[180:183], a[240:243]
 v_mfma_f32_16x16x32_bf16 a[224:227], a[144:147], a[176:179], a[224:227]
 ds_read_b128 a[176:179], v1 offset:17408
 ds_read_b128 a[180:183], v1 offset:21760
 v_mfma_f32_16x16x32_bf16 a[224:227], a[128:131], a[188:191], a[224:227]
 v_mfma_f32_16x16x32_bf16 a[224:227], a[112:115], a[196:199], a[224:227]
 v_mfma_f32_16x16x32_bf16 a[224:227], a[96:99], a[200:203], a[224:227]
 v_mfma_f32_16x16x32_bf16 a[224:227], a[80:83], a[204:207], a[224:227]
 v_mfma_f32_16x16x32_bf16 a[208:211], a[80:83], a[192:195], a[208:211]
 v_mfma_f32_16x16x32_bf16 a[208:211], a[96:99], a[204:207], a[208:211]
 v_mfma_f32_16x16x32_bf16 a[208:211], a[112:115], a[200:203], a[208:211]
 v_mfma_f32_16x16x32_bf16 a[208:211], a[128:131], a[196:199], a[208:211]
 v_mfma_f32_16x16x32_bf16 a[208:211], a[144:147], a[188:191], a[208:211]
 v_mfma_f32_16x16x32_bf16 v[240:243], a[144:147], a[196:199], v[240:243]
 v_mfma_f32_16x16x32_bf16 v[240:243], a[128:131], a[200:203], v[240:243]
 v_mfma_f32_16x16x32_bf16 v[240:243], a[112:115], a[204:207], v[240:243]
 v_mfma_f32_16x16x32_bf16 v[240:243], a[96:99], a[192:195], v[240:243]
 v_mfma_f32_16x16x32_bf16 v[240:243], a[80:83], a[184:187], v[240:243]
.p2align 6
L_mid:
 s_waitcnt lgkmcnt(5)
 ds_read_b128 a[184:187], v1 offset:26112
 ds_read_b128 a[188:191], v1 offset:30464
 v_mfma_f32_16x16x32_bf16 v[48:51], a[0:3], a[160:163], v[48:51]
 s_waitcnt lgkmcnt(6)
 v_mfma_f32_16x16x32_bf16 v[48:51], a[16:19], a[164:167], v[48:51]
 s_waitcnt vmcnt(18) lgkmcnt(5)
 ds_read_b64_tr_b16 a[80:81], v46 offset:0
 v_mfma_f32_16x16x32_bf16 v[48:51], a[32:35], a[168:171], v[48:51]
 s_waitcnt lgkmcnt(5)
 v_mfma_f32_16x16x32_bf16 v[48:51], a[48:51], a[172:175], v[48:51]
 s_waitcnt lgkmcnt(4)
 v_mfma_f32_16x16x32_bf16 v[48:51], a[64:67], a[176:179], v[48:51]
 s_waitcnt lgkmcnt(3)
 ds_read_b64_tr_b16 a[82:83], v46 offset:256
 v_mfma_f32_16x16x32_bf16 v[64:67], a[64:67], a[180:183], v[64:67]
 v_mfma_f32_16x16x32_bf16 v[64:67], a[48:51], a[176:179], v[64:67]
 s_add_u32 m0, s26, 0
 v_mfma_f32_16x16x32_bf16 v[64:67], a[32:35], a[172:175], v[64:67]
 ds_read_b64_tr_b16 a[84:85], v46 offset:8
 buffer_load_dwordx4 v7, s[4:7], 0 offen nt lds
 v_mfma_f32_16x16x32_bf16 v[64:67], a[16:19], a[168:171], v[64:67]
 v_mfma_f32_16x16x32_bf16 v[64:67], a[0:3], a[164:167], v[64:67]
 v_mfma_f32_16x16x32_bf16 v[80:83], a[0:3], a[168:171], v[80:83]
 ds_read_b64_tr_b16 a[86:87], v46 offset:264
 v_mfma_f32_16x16x32_bf16 v[80:83], a[16:19], a[172:175], v[80:83]
 v_mfma_f32_16x16x32_bf16 v[80:83], a[32:35], a[176:179], v[80:83]
 v_mfma_f32_16x16x32_bf16 v[80:83], a[48:51], a[180:183], v[80:83]
 s_waitcnt vmcnt(17) lgkmcnt(3)
 ds_read_b64_tr_b16 a[96:97], v46 offset:4096
 v_mfma_f32_16x16x32_bf16 v[80:83], a[64:67], a[184:187], v[80:83]
 v_mfma_f32_16x16x32_bf16 v[96:99], a[64:67], a[188:191], v[96:99]
 v_mfma_f32_16x16x32_bf16 v[96:99], a[48:51], a[184:187], v[96:99]
 s_add_u32 m0, s29, 0
 ds_read_b64_tr_b16 a[98:99], v46 offset:4352
 v_mfma_f32_16x16x32_bf16 v[96:99], a[32:35], a[180:183], v[96:99]
 s_waitcnt lgkmcnt(2)
 buffer_load_dwordx4 v5, s[8:11], s76 offen offset:0 lds
 v_mfma_f32_16x16x32_bf16 v[96:99], a[16:19], a[176:179], v[96:99]
 v_mfma_f32_16x16x32_bf16 v[96:99], a[0:3], a[172:175], v[96:99]
 ds_read_b64_tr_b16 a[100:101], v46 offset:4104
 v_mfma_f32_16x16x32_bf16 v[100:103], a[4:7], a[172:175], v[100:103]
 v_mfma_f32_16x16x32_bf16 v[100:103], a[20:23], a[176:179], v[100:103]
 v_mfma_f32_16x16x32_bf16 v[100:103], a[36:39], a[180:183], v[100:103]
 ds_read_b64_tr_b16 a[102:103], v46 offset:4360
 v_mfma_f32_16x16x32_bf16 v[100:103], a[52:55], a[184:187], v[100:103]
 ds_read_b128 a[192:195], v3 offset:0
 v_mfma_f32_16x16x32_bf16 v[100:103], a[68:71], a[188:191], v[100:103]
 ds_read_b128 a[196:199], v3 offset:4352
 v_mfma_f32_16x16x32_bf16 v[84:87], a[68:71], a[184:187], v[84:87]
 s_waitcnt vmcnt(16)
 ds_read_b64_tr_b16 a[112:113], v46 offset:8192
 v_mfma_f32_16x16x32_bf16 v[84:87], a[52:55], a[180:183], v[84:87]
 v_mfma_f32_16x16x32_bf16 v[84:87], a[36:39], a[176:179], v[84:87]
 s_add_u32 m0, s29, 2048
 v_mfma_f32_16x16x32_bf16 v[84:87], a[20:23], a[172:175], v[84:87]
 ds_read_b64_tr_b16 a[114:115], v46 offset:8448
 buffer_load_dwordx4 v5, s[8:11], s77 offen offset:0 lds
 v_mfma_f32_16x16x32_bf16 v[84:87], a[4:7], a[168:171], v[84:87]
 v_mfma_f32_16x16x32_bf16 v[68:71], a[4:7], a[164:167], v[68:71]
 v_mfma_f32_16x16x32_bf16 v[68:71], a[20:23], a[168:171], v[68:71]
 ds_read_b64_tr_b16 a[116:117], v46 offset:8200
 v_mfma_f32_16x16x32_bf16 v[68:71], a[36:39], a[172:175], v[68:71]
 v_mfma_f32_16x16x32_bf16 v[68:71], a[52:55], a[176:179], v[68:71]
 ds_read_b128 a[200:203], v3 offset:8704
 v_mfma_f32_16x16x32_bf16 v[68:71], a[68:71], a[180:183], v[68:71]
 ds_read_b128 a[204:207], v3 offset:13056
 ds_read_b64_tr_b16 a[118:119], v46 offset:8456
 v_mfma_f32_16x16x32_bf16 v[52:55], a[68:71], a[176:179], v[52:55]
 v_mfma_f32_16x16x32_bf16 v[52:55], a[52:55], a[172:175], v[52:55]
 v_mfma_f32_16x16x32_bf16 v[52:55], a[36:39], a[168:171], v[52:55]
 s_waitcnt vmcnt(15)
 ds_read_b64_tr_b16 a[128:129], v46 offset:12288
 v_mfma_f32_16x16x32_bf16 v[52:55], a[20:23], a[164:167], v[52:55]
 s_add_u32 m0, s29, 4096
 v_mfma_f32_16x16x32_bf16 v[52:55], a[4:7], a[160:163], v[52:55]
 s_waitcnt lgkmcnt(6)
 buffer_load_dwordx4 v5, s[8:11], s78 offen offset:0 lds
 v_mfma_f32_16x16x32_bf16 v[56:59], a[8:11], a[160:163], v[56:59]
 ds_read_b64_tr_b16 a[130:131], v46 offset:12544
 v_mfma_f32_16x16x32_bf16 v[56:59], a[24:27], a[164:167], v[56:59]
 v_mfma_f32_16x16x32_bf16 v[56:59], a[40:43], a[168:171], v[56:59]
 v_mfma_f32_16x16x32_bf16 v[56:59], a[56:59], a[172:175], v[56:59]
 s_add_u32 m0, s26, 1024
 ds_read_b64_tr_b16 a[132:133], v46 offset:12296
 v_mfma_f32_16x16x32_bf16 v[56:59], a[72:75], a[176:179], v[56:59]
 buffer_load_dwordx4 v8, s[4:7], 0 offen nt lds
 v_mfma_f32_16x16x32_bf16 v[72:75], a[72:75], a[180:183], v[72:75]
 v_mfma_f32_16x16x32_bf16 v[72:75], a[56:59], a[176:179], v[72:75]
 ds_read_b64_tr_b16 a[134:135], v46 offset:12552
 v_mfma_f32_16x16x32_bf16 v[72:75], a[40:43], a[172:175], v[72:75]
 v_mfma_f32_16x16x32_bf16 v[72:75], a[24:27], a[168:171], v[72:75]
 v_mfma_f32_16x16x32_bf16 v[72:75], a[8:11], a[164:167], v[72:75]
 s_waitcnt vmcnt(15)
 s_add_u32 m0, s29, 6144
 ds_read_b64_tr_b16 a[144:145], v46 offset:16384
 v_mfma_f32_16x16x32_bf16 v[88:91], a[8:11], a[168:171], v[88:91]
 buffer_load_dwordx4 v5, s[8:11], s79 offen offset:0 lds
 v_mfma_f32_16x16x32_bf16 v[88:91], a[24:27], a[172:175], v[88:91]
 v_mfma_f32_16x16x32_bf16 v[88:91], a[40:43], a[176:179], v[88:91]
 ds_read_b64_tr_b16 a[146:147], v46 offset:16640
 v_mfma_f32_16x16x32_bf16 v[88:91], a[56:59], a[180:183], v[88:91]
 v_mfma_f32_16x16x32_bf16 v[88:91], a[72:75], a[184:187], v[88:91]
 v_mfma_f32_16x16x32_bf16 v[104:107], a[72:75], a[188:191], v[104:107]
 ds_read_b64_tr_b16 a[148:149], v46 offset:16392
 v_mfma_f32_16x16x32_bf16 v[104:107], a[56:59], a[184:187], v[104:107]
 v_mfma_f32_16x16x32_bf16 v[104:107], a[40:43], a[180:183], v[104:107]
 v_mfma_f32_16x16x32_bf16 v[104:107], a[24:27], a[176:179], v[104:107]
 ds_read_b64_tr_b16 a[150:151], v46 offset:16648
 v_mfma_f32_16x16x32_bf16 v[104:107], a[8:11], a[172:175], v[104:107]
 v_mfma_f32_16x16x32_bf16 v[108:111], a[12:15], a[172:175], v[108:111]
 s_add_u32 m0, s29, 8192
 v_mfma_f32_16x16x32_bf16 v[108:111], a[28:31], a[176:179], v[108:111]
 s_waitcnt vmcnt(14) lgkmcnt(3)
 ds_read_b64_tr_b16 a[88:89], v46 offset:1024
 buffer_load_dwordx4 v5, s[8:11], s80 offen offset:0 lds
 v_mfma_f32_16x16x32_bf16 v[108:111], a[44:47], a[180:183], v[108:111]
 v_mfma_f32_16x16x32_bf16 v[108:111], a[60:63], a[184:187], v[108:111]
 v_mfma_f32_16x16x32_bf16 v[108:111], a[76:79], a[188:191], v[108:111]
 ds_read_b64_tr_b16 a[90:91], v46 offset:1280
 v_mfma_f32_16x16x32_bf16 v[92:95], a[76:79], a[184:187], v[92:95]
 v_mfma_f32_16x16x32_bf16 v[92:95], a[60:63], a[180:183], v[92:95]
 v_mfma_f32_16x16x32_bf16 v[92:95], a[44:47], a[176:179], v[92:95]
 ds_read_b64_tr_b16 a[92:93], v46 offset:1032
 v_mfma_f32_16x16x32_bf16 v[92:95], a[28:31], a[172:175], v[92:95]
 v_mfma_f32_16x16x32_bf16 v[92:95], a[12:15], a[168:171], v[92:95]
 v_mfma_f32_16x16x32_bf16 v[76:79], a[12:15], a[164:167], v[76:79]
 ds_read_b64_tr_b16 a[94:95], v46 offset:1288
 v_mfma_f32_16x16x32_bf16 v[76:79], a[28:31], a[168:171], v[76:79]
 s_add_u32 m0, s29, 10240
 v_mfma_f32_16x16x32_bf16 v[76:79], a[44:47], a[172:175], v[76:79]
 buffer_load_dwordx4 v5, s[8:11], s81 offen offset:0 lds
 v_mfma_f32_16x16x32_bf16 v[76:79], a[60:63], a[176:179], v[76:79]
 s_waitcnt vmcnt(14)
 ds_read_b64_tr_b16 a[104:105], v46 offset:5120
 v_mfma_f32_16x16x32_bf16 v[76:79], a[76:79], a[180:183], v[76:79]
 v_mfma_f32_16x16x32_bf16 v[60:63], a[76:79], a[176:179], v[60:63]
 v_mfma_f32_16x16x32_bf16 v[60:63], a[60:63], a[172:175], v[60:63]
 ds_read_b64_tr_b16 a[106:107], v46 offset:5376
 v_mfma_f32_16x16x32_bf16 v[60:63], a[44:47], a[168:171], v[60:63]
 v_mfma_f32_16x16x32_bf16 v[60:63], a[28:31], a[164:167], v[60:63]
 v_mfma_f32_16x16x32_bf16 v[60:63], a[12:15], a[160:163], v[60:63]
 ds_read_b64_tr_b16 a[108:109], v46 offset:5128
 v_mfma_f32_16x16x32_bf16 v[124:127], a[12:15], a[176:179], v[124:127]
 s_add_u32 m0, s26, 2048
 v_mfma_f32_16x16x32_bf16 v[124:127], a[28:31], a[180:183], v[124:127]
 buffer_load_dwordx4 v9, s[4:7], 0 offen nt lds
 v_mfma_f32_16x16x32_bf16 v[124:127], a[44:47], a[184:187], v[124:127]
 s_add_u32 m0, s29, 12288
 ds_read_b64_tr_b16 a[110:111], v46 offset:5384
 v_mfma_f32_16x16x32_bf16 v[124:127], a[60:63], a[188:191], v[124:127]
 buffer_load_dwordx4 v5, s[8:11], s82 offen offset:0 lds
 v_mfma_f32_16x16x32_bf16 v[124:127], a[76:79], a[192:195], v[124:127]
 v_mfma_f32_16x16x32_bf16 v[140:143], a[76:79], a[196:199], v[140:143]
 s_waitcnt vmcnt(14)
 ds_read_b64_tr_b16 a[120:121], v46 offset:9216
 v_mfma_f32_16x16x32_bf16 v[140:143], a[60:63], a[192:195], v[140:143]
 v_mfma_f32_16x16x32_bf16 v[140:143], a[44:47], a[188:191], v[140:143]
 v_mfma_f32_16x16x32_bf16 v[140:143], a[28:31], a[184:187], v[140:143]
 ds_read_b64_tr_b16 a[122:123], v46 offset:9472
 v_mfma_f32_16x16x32_bf16 v[140:143], a[12:15], a[180:183], v[140:143]
 v_mfma_f32_16x16x32_bf16 v[156:159], a[12:15], a[184:187], v[156:159]
 v_mfma_f32_16x16x32_bf16 v[156:159], a[28:31], a[188:191], v[156:159]
 ds_read_b64_tr_b16 a[124:125], v46 offset:9224
 v_mfma_f32_16x16x32_bf16 v[156:159], a[44:47], a[192:195], v[156:159]
 v_mfma_f32_16x16x32_bf16 v[156:159], a[60:63], a[196:199], v[156:159]
 v_mfma_f32_16x16x32_bf16 v[156:159], a[76:79], a[200:203], v[156:159]
 s_add_u32 m0, s29, 14336
 ds_read_b64_tr_b16 a[126:127], v46 offset:9480
 v_mfma_f32_16x16x32_bf16 v[172:175], a[76:79], a[204:207], v[172:175]
 buffer_load_dwordx4 v5, s[8:11], s83 offen offset:0 lds
 v_mfma_f32_16x16x32_bf16 v[172:175], a[60:63], a[200:203], v[172:175]
 v_mfma_f32_16x16x32_bf16 v[172:175], a[44:47], a[196:199], v[172:175]
 s_waitcnt vmcnt(13)
 ds_read_b64_tr_b16 a[136:137], v46 offset:13312
 v_mfma_f32_16x16x32_bf16 v[172:175], a[28:31], a[192:195], v[172:175]
 v_mfma_f32_16x16x32_bf16 v[172:175], a[12:15], a[188:191], v[172:175]
 ds_read_b128 a[172:175], v1 offset:2176
 v_mfma_f32_16x16x32_bf16 v[168:171], a[8:11], a[188:191], v[168:171]
 ds_read_b128 a[168:171], v1 offset:6528
 ds_read_b64_tr_b16 a[138:139], v46 offset:13568
 v_mfma_f32_16x16x32_bf16 v[168:171], a[24:27], a[192:195], v[168:171]
 ds_read_b128 a[164:167], v1 offset:10880
 v_mfma_f32_16x16x32_bf16 v[168:171], a[40:43], a[196:199], v[168:171]
 ds_read_b128 a[160:163], v1 offset:15232
 v_mfma_f32_16x16x32_bf16 v[168:171], a[56:59], a[200:203], v[168:171]
 ds_read_b64_tr_b16 a[140:141], v46 offset:13320
 v_mfma_f32_16x16x32_bf16 v[168:171], a[72:75], a[204:207], v[168:171]
 v_mfma_f32_16x16x32_bf16 v[152:155], a[72:75], a[200:203], v[152:155]
 s_add_u32 m0, s29, 16384
 v_mfma_f32_16x16x32_bf16 v[152:155], a[56:59], a[196:199], v[152:155]
 s_waitcnt lgkmcnt(7)
 ds_read_b64_tr_b16 a[142:143], v46 offset:13576
 buffer_load_dwordx4 v5, s[8:11], s84 offen offset:0 lds
 v_mfma_f32_16x16x32_bf16 v[152:155], a[40:43], a[192:195], v[152:155]
 v_mfma_f32_16x16x32_bf16 v[152:155], a[24:27], a[188:191], v[152:155]
 v_mfma_f32_16x16x32_bf16 v[152:155], a[8:11], a[184:187], v[152:155]
 s_waitcnt vmcnt(12)
 ds_read_b64_tr_b16 a[152:153], v46 offset:17408
 v_mfma_f32_16x16x32_bf16 v[136:139], a[8:11], a[180:183], v[136:139]
 v_mfma_f32_16x16x32_bf16 v[136:139], a[24:27], a[184:187], v[136:139]
 v_mfma_f32_16x16x32_bf16 v[136:139], a[40:43], a[188:191], v[136:139]
 ds_read_b64_tr_b16 a[154:155], v46 offset:17664
 v_mfma_f32_16x16x32_bf16 v[136:139], a[56:59], a[192:195], v[136:139]
 v_mfma_f32_16x16x32_bf16 v[136:139], a[72:75], a[196:199], v[136:139]
 v_mfma_f32_16x16x32_bf16 v[120:123], a[72:75], a[192:195], v[120:123]
 ds_read_b64_tr_b16 a[156:157], v46 offset:17416
 v_mfma_f32_16x16x32_bf16 v[120:123], a[56:59], a[188:191], v[120:123]
 s_add_u32 m0, s29, 18432
 v_mfma_f32_16x16x32_bf16 v[120:123], a[40:43], a[184:187], v[120:123]
 buffer_load_dwordx4 v5, s[8:11], s85 offen offset:0 lds
 v_mfma_f32_16x16x32_bf16 v[120:123], a[24:27], a[180:183], v[120:123]
 s_add_u32 m0, s26, 3072
 ds_read_b64_tr_b16 a[158:159], v46 offset:17672
 v_mfma_f32_16x16x32_bf16 v[120:123], a[8:11], a[176:179], v[120:123]
 buffer_load_dwordx4 v10, s[4:7], 0 offen nt lds
 v_mfma_f32_16x16x32_bf16 v[116:119], a[4:7], a[176:179], v[116:119]
 v_mfma_f32_16x16x32_bf16 v[116:119], a[20:23], a[180:183], v[116:119]
 v_mfma_f32_16x16x32_bf16 v[116:119], a[36:39], a[184:187], v[116:119]
 v_mfma_f32_16x16x32_bf16 v[116:119], a[52:55], a[188:191], v[116:119]
 v_mfma_f32_16x16x32_bf16 v[116:119], a[68:71], a[192:195], v[116:119]
 v_mfma_f32_16x16x32_bf16 v[132:135], a[68:71], a[196:199], v[132:135]
 v_mfma_f32_16x16x32_bf16 v[132:135], a[52:55], a[192:195], v[132:135]
 v_mfma_f32_16x16x32_bf16 v[132:135], a[36:39], a[188:191], v[132:135]
 s_add_u32 m0, s29, 0
 v_mfma_f32_16x16x32_bf16 v[132:135], a[20:23], a[184:187], v[132:135]
 buffer_load_dwordx4 v5, s[8:11], s76 offen offset:1024 lds
 v_mfma_f32_16x16x32_bf16 v[132:135], a[4:7], a[180:183], v[132:135]
 v_mfma_f32_16x16x32_bf16 v[148:151], a[4:7], a[184:187], v[148:151]
 v_mfma_f32_16x16x32_bf16 v[148:151], a[20:23], a[188:191], v[148:151]
 v_mfma_f32_16x16x32_bf16 v[148:151], a[36:39], a[192:195], v[148:151]
 v_mfma_f32_16x16x32_bf16 v[148:151], a[52:55], a[196:199], v[148:151]
 v_mfma_f32_16x16x32_bf16 v[148:151], a[68:71], a[200:203], v[148:151]
 v_mfma_f32_16x16x32_bf16 v[164:167], a[68:71], a[204:207], v[164:167]
 v_mfma_f32_16x16x32_bf16 v[164:167], a[52:55], a[200:203], v[164:167]
 v_mfma_f32_16x16x32_bf16 v[164:167], a[36:39], a[196:199], v[164:167]
 v_mfma_f32_16x16x32_bf16 v[164:167], a[20:23], a[192:195], v[164:167]
 s_add_u32 m0, s29, 2048
 v_mfma_f32_16x16x32_bf16 v[164:167], a[4:7], a[188:191], v[164:167]
 buffer_load_dwordx4 v5, s[8:11], s77 offen offset:1024 lds
 v_mfma_f32_16x16x32_bf16 v[160:163], a[0:3], a[188:191], v[160:163]
 v_mfma_f32_16x16x32_bf16 v[160:163], a[16:19], a[192:195], v[160:163]
 v_mfma_f32_16x16x32_bf16 v[160:163], a[32:35], a[196:199], v[160:163]
 v_mfma_f32_16x16x32_bf16 v[160:163], a[48:51], a[200:203], v[160:163]
 v_mfma_f32_16x16x32_bf16 v[160:163], a[64:67], a[204:207], v[160:163]
 ds_read_b128 a[204:207], v1 offset:19584
 v_mfma_f32_16x16x32_bf16 v[144:147], a[64:67], a[200:203], v[144:147]
 ds_read_b128 a[200:203], v1 offset:23936
 v_mfma_f32_16x16x32_bf16 v[144:147], a[48:51], a[196:199], v[144:147]
 v_mfma_f32_16x16x32_bf16 v[144:147], a[32:35], a[192:195], v[144:147]
 v_mfma_f32_16x16x32_bf16 v[144:147], a[16:19], a[188:191], v[144:147]
 v_mfma_f32_16x16x32_bf16 v[144:147], a[0:3], a[184:187], v[144:147]
 s_add_u32 m0, s29, 4096
 v_mfma_f32_16x16x32_bf16 v[128:131], a[0:3], a[180:183], v[128:131]
 buffer_load_dwordx4 v5, s[8:11], s78 offen offset:1024 lds
 v_mfma_f32_16x16x32_bf16 v[128:131], a[16:19], a[184:187], v[128:131]
 v_mfma_f32_16x16x32_bf16 v[128:131], a[32:35], a[188:191], v[128:131]
 v_mfma_f32_16x16x32_bf16 v[128:131], a[48:51], a[192:195], v[128:131]
 v_mfma_f32_16x16x32_bf16 v[128:131], a[64:67], a[196:199], v[128:131]
 ds_read_b128 a[196:199], v1 offset:28288
 v_mfma_f32_16x16x32_bf16 v[112:115], a[64:67], a[192:195], v[112:115]
 s_add_u32 m0, s26, 4096
 ds_read_b128 a[192:195], v1 offset:32640
 v_mfma_f32_16x16x32_bf16 v[112:115], a[48:51], a[188:191], v[112:115]
 buffer_load_dwordx4 v11, s[4:7], 0 offen nt lds
 v_mfma_f32_16x16x32_bf16 v[112:115], a[32:35], a[184:187], v[112:115]
 v_mfma_f32_16x16x32_bf16 v[112:115], a[16:19], a[180:183], v[112:115]
 v_mfma_f32_16x16x32_bf16 v[112:115], a[0:3], a[176:179], v[112:115]
 s_waitcnt lgkmcnt(2)
 v_mfma_f32_16x16x32_bf16 v[176:179], a[0:3], a[172:175], v[176:179]
 s_add_u32 m0, s29, 6144
 v_mfma_f32_16x16x32_bf16 v[176:179], a[16:19], a[168:171], v[176:179]
 buffer_load_dwordx4 v5, s[8:11], s79 offen offset:1024 lds
 v_mfma_f32_16x16x32_bf16 v[176:179], a[32:35], a[164:167], v[176:179]
 v_mfma_f32_16x16x32_bf16 v[176:179], a[48:51], a[160:163], v[176:179]
 v_mfma_f32_16x16x32_bf16 v[176:179], a[64:67], a[204:207], v[176:179]
 v_mfma_f32_16x16x32_bf16 v[192:195], a[64:67], a[200:203], v[192:195]
 v_mfma_f32_16x16x32_bf16 v[192:195], a[48:51], a[204:207], v[192:195]
 v_mfma_f32_16x16x32_bf16 v[192:195], a[32:35], a[160:163], v[192:195]
 v_mfma_f32_16x16x32_bf16 v[192:195], a[16:19], a[164:167], v[192:195]
 v_mfma_f32_16x16x32_bf16 v[192:195], a[0:3], a[168:171], v[192:195]
 v_mfma_f32_16x16x32_bf16 v[208:211], a[0:3], a[164:167], v[208:211]
 v_mfma_f32_16x16x32_bf16 v[208:211], a[16:19], a[160:163], v[208:211]
 v_mfma_f32_16x16x32_bf16 v[208:211], a[32:35], a[204:207], v[208:211]
 s_add_u32 m0, s29, 8192
 v_mfma_f32_16x16x32_bf16 v[208:211], a[48:51], a[200:203], v[208:211]
 s_waitcnt lgkmcnt(0)
 buffer_load_dwordx4 v5, s[8:11], s80 offen offset:1024 lds
 v_mfma_f32_16x16x32_bf16 v[208:211], a[64:67], a[196:199], v[208:211]
 v_mfma_f32_16x16x32_bf16 v[224:227], a[64:67], a[192:195], v[224:227]
 v_mfma_f32_16x16x32_bf16 v[224:227], a[48:51], a[196:199], v[224:227]
 v_mfma_f32_16x16x32_bf16 v[224:227], a[32:35], a[200:203], v[224:227]
 v_mfma_f32_16x16x32_bf16 v[224:227], a[16:19], a[204:207], v[224:227]
 v_mfma_f32_16x16x32_bf16 v[224:227], a[0:3], a[160:163], v[224:227]
 v_mfma_f32_16x16x32_bf16 v[228:231], a[4:7], a[160:163], v[228:231]
 v_mfma_f32_16x16x32_bf16 v[228:231], a[20:23], a[204:207], v[228:231]
 v_mfma_f32_16x16x32_bf16 v[228:231], a[36:39], a[200:203], v[228:231]
 v_mfma_f32_16x16x32_bf16 v[228:231], a[52:55], a[196:199], v[228:231]
 s_add_u32 m0, s29, 10240
 ds_read_b128 a[188:191], v3 offset:2176
 v_mfma_f32_16x16x32_bf16 v[228:231], a[68:71], a[192:195], v[228:231]
 ds_read_b128 a[184:187], v3 offset:6528
 buffer_load_dwordx4 v5, s[8:11], s81 offen offset:1024 lds
 v_mfma_f32_16x16x32_bf16 v[212:215], a[68:71], a[196:199], v[212:215]
 v_mfma_f32_16x16x32_bf16 v[212:215], a[52:55], a[200:203], v[212:215]
 v_mfma_f32_16x16x32_bf16 v[212:215], a[36:39], a[204:207], v[212:215]
 v_mfma_f32_16x16x32_bf16 v[212:215], a[20:23], a[160:163], v[212:215]
 v_mfma_f32_16x16x32_bf16 v[212:215], a[4:7], a[164:167], v[212:215]
 v_mfma_f32_16x16x32_bf16 v[196:199], a[4:7], a[168:171], v[196:199]
 v_mfma_f32_16x16x32_bf16 v[196:199], a[20:23], a[164:167], v[196:199]
 v_mfma_f32_16x16x32_bf16 v[196:199], a[36:39], a[160:163], v[196:199]
 s_add_u32 m0, s26, 5120
 v_mfma_f32_16x16x32_bf16 v[196:199], a[52:55], a[204:207], v[196:199]
 ds_read_b128 a[180:183], v3 offset:10880
 buffer_load_dwordx4 v12, s[4:7], 0 offen nt lds
 v_mfma_f32_16x16x32_bf16 v[196:199], a[68:71], a[200:203], v[196:199]
 s_add_u32 m0, s29, 12288
 ds_read_b128 a[176:179], v3 offset:15232
 v_mfma_f32_16x16x32_bf16 v[180:183], a[68:71], a[204:207], v[180:183]
 buffer_load_dwordx4 v5, s[8:11], s82 offen offset:1024 lds
 v_mfma_f32_16x16x32_bf16 v[180:183], a[52:55], a[160:163], v[180:183]
 v_mfma_f32_16x16x32_bf16 v[180:183], a[36:39], a[164:167], v[180:183]
 v_mfma_f32_16x16x32_bf16 v[180:183], a[20:23], a[168:171], v[180:183]
 v_mfma_f32_16x16x32_bf16 v[180:183], a[4:7], a[172:175], v[180:183]
 v_mfma_f32_16x16x32_bf16 v[184:187], a[8:11], a[172:175], v[184:187]
 v_mfma_f32_16x16x32_bf16 v[184:187], a[24:27], a[168:171], v[184:187]
 v_mfma_f32_16x16x32_bf16 v[184:187], a[40:43], a[164:167], v[184:187]
 v_mfma_f32_16x16x32_bf16 v[184:187], a[56:59], a[160:163], v[184:187]
 v_mfma_f32_16x16x32_bf16 v[184:187], a[72:75], a[204:207], v[184:187]
 v_mfma_f32_16x16x32_bf16 v[200:203], a[72:75], a[200:203], v[200:203]
 s_add_u32 m0, s29, 14336
 v_mfma_f32_16x16x32_bf16 v[200:203], a[56:59], a[204:207], v[200:203]
 buffer_load_dwordx4 v5, s[8:11], s83 offen offset:1024 lds
 v_mfma_f32_16x16x32_bf16 v[200:203], a[40:43], a[160:163], v[200:203]
 v_mfma_f32_16x16x32_bf16 v[200:203], a[24:27], a[164:167], v[200:203]
 v_mfma_f32_16x16x32_bf16 v[200:203], a[8:11], a[168:171], v[200:203]
 v_mfma_f32_16x16x32_bf16 v[216:219], a[8:11], a[164:167], v[216:219]
 v_mfma_f32_16x16x32_bf16 v[216:219], a[24:27], a[160:163], v[216:219]
 v_mfma_f32_16x16x32_bf16 v[216:219], a[40:43], a[204:207], v[216:219]
 v_mfma_f32_16x16x32_bf16 v[216:219], a[56:59], a[200:203], v[216:219]
 v_mfma_f32_16x16x32_bf16 v[216:219], a[72:75], a[196:199], v[216:219]
 v_mfma_f32_16x16x32_bf16 v[232:235], a[72:75], a[192:195], v[232:235]
 v_mfma_f32_16x16x32_bf16 v[232:235], a[56:59], a[196:199], v[232:235]
 s_add_u32 m0, s29, 16384
 v_mfma_f32_16x16x32_bf16 v[232:235], a[40:43], a[200:203], v[232:235]
 buffer_load_dwordx4 v5, s[8:11], s84 offen offset:1024 lds
 v_mfma_f32_16x16x32_bf16 v[232:235], a[24:27], a[204:207], v[232:235]
 v_mfma_f32_16x16x32_bf16 v[232:235], a[8:11], a[160:163], v[232:235]
 v_mfma_f32_16x16x32_bf16 v[236:239], a[12:15], a[160:163], v[236:239]
 v_mfma_f32_16x16x32_bf16 v[236:239], a[28:31], a[204:207], v[236:239]
 v_mfma_f32_16x16x32_bf16 v[236:239], a[44:47], a[200:203], v[236:239]
 v_mfma_f32_16x16x32_bf16 v[236:239], a[60:63], a[196:199], v[236:239]
 v_mfma_f32_16x16x32_bf16 v[236:239], a[76:79], a[192:195], v[236:239]
 v_mfma_f32_16x16x32_bf16 v[220:223], a[76:79], a[196:199], v[220:223]
 v_mfma_f32_16x16x32_bf16 v[220:223], a[60:63], a[200:203], v[220:223]
 v_mfma_f32_16x16x32_bf16 v[220:223], a[44:47], a[204:207], v[220:223]
 s_add_u32 m0, s29, 18432
 v_mfma_f32_16x16x32_bf16 v[220:223], a[28:31], a[160:163], v[220:223]
 buffer_load_dwordx4 v5, s[8:11], s85 offen offset:1024 lds
 v_mfma_f32_16x16x32_bf16 v[220:223], a[12:15], a[164:167], v[220:223]
 s_add_u32 s8, s8, 0x10000
 s_addc_u32 s9, s9, 0
 s_add_u32 m0, s26, 6144
 v_mfma_f32_16x16x32_bf16 v[204:207], a[12:15], a[168:171], v[204:207]
 buffer_load_dwordx4 v13, s[4:7], 0 offen nt lds
 v_mfma_f32_16x16x32_bf16 v[204:207], a[28:31], a[164:167], v[204:207]
 v_mfma_f32_16x16x32_bf16 v[204:207], a[44:47], a[160:163], v[204:207]
 v_mfma_f32_16x16x32_bf16 v[204:207], a[60:63], a[204:207], v[204:207]
 v_mfma_f32_16x16x32_bf16 v[204:207], a[76:79], a[200:203], v[204:207]
 v_mfma_f32_16x16x32_bf16 v[188:191], a[76:79], a[204:207], v[188:191]
 v_mfma_f32_16x16x32_bf16 v[188:191], a[60:63], a[160:163], v[188:191]
 v_mfma_f32_16x16x32_bf16 v[188:191], a[44:47], a[164:167], v[188:191]
 v_mfma_f32_16x16x32_bf16 v[188:191], a[28:31], a[168:171], v[188:191]
 v_mfma_f32_16x16x32_bf16 v[188:191], a[12:15], a[172:175], v[188:191]
 v_mfma_f32_16x16x32_bf16 v[252:255], a[12:15], a[204:207], v[252:255]
 v_mfma_f32_16x16x32_bf16 v[252:255], a[28:31], a[200:203], v[252:255]
 v_mfma_f32_16x16x32_bf16 v[252:255], a[44:47], a[196:199], v[252:255]
 v_mfma_f32_16x16x32_bf16 v[252:255], a[60:63], a[192:195], v[252:255]
 s_waitcnt lgkmcnt(0)
 v_mfma_f32_16x16x32_bf16 v[252:255], a[76:79], a[188:191], v[252:255]
 v_mfma_f32_16x16x32_bf16 a[220:223], a[76:79], a[184:187], a[220:223]
 v_mfma_f32_16x16x32_bf16 a[220:223], a[60:63], a[188:191], a[220:223]
 v_mfma_f32_16x16x32_bf16 a[220:223], a[44:47], a[192:195], a[220:223]
 v_mfma_f32_16x16x32_bf16 a[220:223], a[28:31], a[196:199], a[220:223]
 v_mfma_f32_16x16x32_bf16 a[220:223], a[12:15], a[200:203], a[220:223]
 v_mfma_f32_16x16x32_bf16 a[236:239], a[12:15], a[196:199], a[236:239]
 v_mfma_f32_16x16x32_bf16 a[236:239], a[28:31], a[192:195], a[236:239]
 v_mfma_f32_16x16x32_bf16 a[236:239], a[44:47], a[188:191], a[236:239]
 v_mfma_f32_16x16x32_bf16 a[236:239], a[60:63], a[184:187], a[236:239]
 v_mfma_f32_16x16x32_bf16 a[236:239], a[76:79], a[180:183], a[236:239]
 v_mfma_f32_16x16x32_bf16 a[252:255], a[76:79], a[176:179], a[252:255]
 v_mfma_f32_16x16x32_bf16 a[252:255], a[60:63], a[180:183], a[252:255]
 v_mfma_f32_16x16x32_bf16 a[252:255], a[44:47], a[184:187], a[252:255]
 v_mfma_f32_16x16x32_bf16 a[252:255], a[28:31], a[188:191], a[252:255]
 v_mfma_f32_16x16x32_bf16 a[252:255], a[12:15], a[192:195], a[252:255]
 ds_read_b128 a[160:163], v2 offset:0
 v_mfma_f32_16x16x32_bf16 a[248:251], a[8:11], a[192:195], a[248:251]
 ds_read_b128 a[164:167], v2 offset:4352
 v_mfma_f32_16x16x32_bf16 a[248:251], a[24:27], a[188:191], a[248:251]
 ds_read_b128 a[168:171], v2 offset:8704
 v_mfma_f32_16x16x32_bf16 a[248:251], a[40:43], a[184:187], a[248:251]
 ds_read_b128 a[172:175], v2 offset:13056
 v_mfma_f32_16x16x32_bf16 a[248:251], a[56:59], a[180:183], a[248:251]
 v_mfma_f32_16x16x32_bf16 a[248:251], a[72:75], a[176:179], a[248:251]
 v_mfma_f32_16x16x32_bf16 a[232:235], a[72:75], a[180:183], a[232:235]
 v_mfma_f32_16x16x32_bf16 a[232:235], a[56:59], a[184:187], a[232:235]
 s_add_u32 m0, s26, 7168
 v_mfma_f32_16x16x32_bf16 a[232:235], a[40:43], a[188:191], a[232:235]
 buffer_load_dwordx4 v14, s[4:7], 0 offen nt lds
 v_mfma_f32_16x16x32_bf16 a[232:235], a[24:27], a[192:195], a[232:235]
 v_mfma_f32_16x16x32_bf16 a[232:235], a[8:11], a[196:199], a[232:235]
 s_cmp_lt_u32 s23, s28
 s_cbranch_scc1 L_disp
L_pf:
 global_load_dword v44, v47, s[88:89]
L_mid2:
 v_mfma_f32_16x16x32_bf16 a[216:219], a[8:11], a[200:203], a[216:219]
 s_mov_b64 s[96:97], s[94:95]
 s_memrealtime s[94:95]
 v_mfma_f32_16x16x32_bf16 a[216:219], a[24:27], a[196:199], a[216:219]
 v_mfma_f32_16x16x32_bf16 a[216:219], a[40:43], a[192:195], a[216:219]
 v_mfma_f32_16x16x32_bf16 a[216:219], a[56:59], a[188:191], a[216:219]
 v_mfma_f32_16x16x32_bf16 a[216:219], a[72:75], a[184:187], a[216:219]
 v_mfma_f32_16x16x32_bf16 v[248:251], a[72:75], a[188:191], v[248:251]
 v_mfma_f32_16x16x32_bf16 v[248:251], a[56:59], a[192:195], v[248:251]
 v_mfma_f32_16x16x32_bf16 v[248:251], a[40:43], a[196:199], v[248:251]
 v_mfma_f32_16x16x32_bf16 v[248:251], a[24:27], a[200:203], v[248:251]
 v_mfma_f32_16x16x32_bf16 v[248:251], a[8:11], a[204:207], v[248:251]
 v_mfma_f32_16x16x32_bf16 v[244:247], a[4:7], a[204:207], v[244:247]
 v_mfma_f32_16x16x32_bf16 v[244:247], a[20:23], a[200:203], v[244:247]
 v_mfma_f32_16x16x32_bf16 v[244:247], a[36:39], a[196:199], v[244:247]
 v_mfma_f32_16x16x32_bf16 v[244:247], a[52:55], a[192:195], v[244:247]
 v_mfma_f32_16x16x32_bf16 v[244:247], a[68:71], a[188:191], v[244:247]
 v_mfma_f32_16x16x32_bf16 a[212:215], a[68:71], a[184:187], a[212:215]
 v_mfma_f32_16x16x32_bf16 a[212:215], a[52:55], a[188:191], a[212:215]
 v_mfma_f32_16x16x32_bf16 a[212:215], a[36:39], a[192:195], a[212:215]
 v_mfma_f32_16x16x32_bf16 a[212:215], a[20:23], a[196:199], a[212:215]
 v_mfma_f32_16x16x32_bf16 a[212:215], a[4:7], a[200:203], a[212:215]
 v_mfma_f32_16x16x32_bf16 a[228:231], a[4:7], a[196:199], a[228:231]
 v_mfma_f32_16x16x32_bf16 a[228:231], a[20:23], a[192:195], a[228:231]
 v_mfma_f32_16x16x32_bf16 a[228:231], a[36:39], a[188:191], a[228:231]
 v_mfma_f32_16x16x32_bf16 a[228:231], a[52:55], a[184:187], a[228:231]
 v_mfma_f32_16x16x32_bf16 a[228:231], a[68:71], a[180:183], a[228:231]
 v_mfma_f32_16x16x32_bf16 a[244:247], a[68:71], a[176:179], a[244:247]
 v_mfma_f32_16x16x32_bf16 a[244:247], a[52:55], a[180:183], a[244:247]
 v_mfma_f32_16x16x32_bf16 a[244:247], a[36:39], a[184:187], a[244:247]
 v_mfma_f32_16x16x32_bf16 a[244:247], a[20:23], a[188:191], a[244:247]
 v_mfma_f32_16x16x32_bf16 a[244:247], a[4:7], a[192:195], a[244:247]
 v_mfma_f32_16x16x32_bf16 a[240:243], a[0:3], a[192:195], a[240:243]
 v_mfma_f32_16x16x32_bf16 a[240:243], a[16:19], a[188:191], a[240:243]
 v_mfma_f32_16x16x32_bf16 a[240:243], a[32:35], a[184:187], a[240:243]
 v_mfma_f32_16x16x32_bf16 a[240:243], a[48:51], a[180:183], a[240:243]
 s_mov_b32 m0, s27
 v_mfma_f32_16x16x32_bf16 a[240:243], a[64:67], a[176:179], a[240:243]
 ds_read_b128 a[176:179], v2 offset:17408
 buffer_load_dwordx4 v15, s[4:7], 0 offen nt lds
 v_mfma_f32_16x16x32_bf16 a[224:227], a[64:67], a[180:183], a[224:227]
 s_add_u32 s4, s4, 128
 s_addc_u32 s5, s5, 0
 ds_read_b128 a[180:183], v2 offset:21760
 v_mfma_f32_16x16x32_bf16 a[224:227], a[48:51], a[184:187], a[224:227]
 s_xor_b32 s26, s26, 0x10000
 s_xor_b32 s27, s27, s31
 v_mfma_f32_16x16x32_bf16 a[224:227], a[32:35], a[188:191], a[224:227]
 v_mfma_f32_16x16x32_bf16 a[224:227], a[16:19], a[192:195], a[224:227]
 v_mfma_f32_16x16x32_bf16 a[224:227], a[0:3], a[196:199], a[224:227]
 v_mfma_f32_16x16x32_bf16 a[208:211], a[0:3], a[200:203], a[208:211]
 v_mfma_f32_16x16x32_bf16 a[208:211], a[16:19], a[196:199], a[208:211]
 v_mfma_f32_16x16x32_bf16 a[208:211], a[32:35], a[192:195], a[208:211]
 v_mfma_f32_16x16x32_bf16 a[208:211], a[48:51], a[188:191], a[208:211]
 v_mfma_f32_16x16x32_bf16 a[208:211], a[64:67], a[184:187], a[208:211]
 ds_read_b128 a[184:187], v2 offset:26112
 v_mfma_f32_16x16x32_bf16 v[240:243], a[64:67], a[188:191], v[240:243]
 ds_read_b128 a[188:191], v2 offset:30464
 v_mfma_f32_16x16x32_bf16 v[240:243], a[48:51], a[192:195], v[240:243]
 v_mfma_f32_16x16x32_bf16 v[240:243], a[32:35], a[196:199], v[240:243]
 v_mfma_f32_16x16x32_bf16 v[240:243], a[16:19], a[200:203], v[240:243]
 v_mfma_f32_16x16x32_bf16 v[240:243], a[0:3], a[204:207], v[240:243]
 s_waitcnt vmcnt(7) lgkmcnt(2)
 ds_read_b64_tr_b16 a[0:1], v46 offset:0
 v_mfma_f32_16x16x32_bf16 v[48:51], a[80:83], a[160:163], v[48:51]
 v_mfma_f32_16x16x32_bf16 v[48:51], a[96:99], a[164:167], v[48:51]
 v_mfma_f32_16x16x32_bf16 v[48:51], a[112:115], a[168:171], v[48:51]
 ds_read_b64_tr_b16 a[2:3], v46 offset:256
 v_mfma_f32_16x16x32_bf16 v[48:51], a[128:131], a[172:175], v[48:51]
 v_mfma_f32_16x16x32_bf16 v[48:51], a[144:147], a[176:179], v[48:51]
 v_mfma_f32_16x16x32_bf16 v[64:67], a[144:147], a[180:183], v[64:67]
 ds_read_b64_tr_b16 a[4:5], v46 offset:8
 v_mfma_f32_16x16x32_bf16 v[64:67], a[128:131], a[176:179], v[64:67]
 v_mfma_f32_16x16x32_bf16 v[64:67], a[112:115], a[172:175], v[64:67]
 v_mfma_f32_16x16x32_bf16 v[64:67], a[96:99], a[168:171], v[64:67]
 ds_read_b64_tr_b16 a[6:7], v46 offset:264
 v_mfma_f32_16x16x32_bf16 v[64:67], a[80:83], a[164:167], v[64:67]
 v_mfma_f32_16x16x32_bf16 v[80:83], a[80:83], a[168:171], v[80:83]
 v_mfma_f32_16x16x32_bf16 v[80:83], a[96:99], a[172:175], v[80:83]
 ds_read_b64_tr_b16 a[16:17], v46 offset:4096
 v_mfma_f32_16x16x32_bf16 v[80:83], a[112:115], a[176:179], v[80:83]
 v_mfma_f32_16x16x32_bf16 v[80:83], a[128:131], a[180:183], v[80:83]
 s_waitcnt lgkmcnt(4)
 v_mfma_f32_16x16x32_bf16 v[80:83], a[144:147], a[184:187], v[80:83]
 s_add_u32 m0, s29, 0
 ds_read_b64_tr_b16 a[18:19], v46 offset:4352
 v_mfma_f32_16x16x32_bf16 v[96:99], a[144:147], a[188:191], v[96:99]
 s_waitcnt lgkmcnt(2)
 buffer_load_dwordx4 v5, s[8:11], s76 offen offset:0 lds
 v_mfma_f32_16x16x32_bf16 v[96:99], a[128:131], a[184:187], v[96:99]
 v_mfma_f32_16x16x32_bf16 v[96:99], a[112:115], a[180:183], v[96:99]
 ds_read_b64_tr_b16 a[20:21], v46 offset:4104
 v_mfma_f32_16x16x32_bf16 v[96:99], a[96:99], a[176:179], v[96:99]
 v_mfma_f32_16x16x32_bf16 v[96:99], a[80:83], a[172:175], v[96:99]
 v_mfma_f32_16x16x32_bf16 v[100:103], a[84:87], a[172:175], v[100:103]
 ds_read_b64_tr_b16 a[22:23], v46 offset:4360
 v_mfma_f32_16x16x32_bf16 v[100:103], a[100:103], a[176:179], v[100:103]
 v_mfma_f32_16x16x32_bf16 v[100:103], a[116:119], a[180:183], v[100:103]
 v_mfma_f32_16x16x32_bf16 v[100:103], a[132:135], a[184:187], v[100:103]
 ds_read_b128 a[192:195], v4 offset:0
 ds_read_b64_tr_b16 a[32:33], v46 offset:8192
 v_mfma_f32_16x16x32_bf16 v[100:103], a[148:151], a[188:191], v[100:103]
 ds_read_b128 a[196:199], v4 offset:4352
 v_mfma_f32_16x16x32_bf16 v[84:87], a[148:151], a[184:187], v[84:87]
 v_mfma_f32_16x16x32_bf16 v[84:87], a[132:135], a[180:183], v[84:87]
 ds_read_b64_tr_b16 a[34:35], v46 offset:8448
 v_mfma_f32_16x16x32_bf16 v[84:87], a[116:119], a[176:179], v[84:87]
 s_add_u32 m0, s29, 2048
 v_mfma_f32_16x16x32_bf16 v[84:87], a[100:103], a[172:175], v[84:87]
 buffer_load_dwordx4 v5, s[8:11], s77 offen offset:0 lds
 v_mfma_f32_16x16x32_bf16 v[84:87], a[84:87], a[168:171], v[84:87]
 ds_read_b64_tr_b16 a[36:37], v46 offset:8200
 v_mfma_f32_16x16x32_bf16 v[68:71], a[84:87], a[164:167], v[68:71]
 v_mfma_f32_16x16x32_bf16 v[68:71], a[100:103], a[168:171], v[68:71]
 v_mfma_f32_16x16x32_bf16 v[68:71], a[116:119], a[172:175], v[68:71]
 ds_read_b64_tr_b16 a[38:39], v46 offset:8456
 v_mfma_f32_16x16x32_bf16 v[68:71], a[132:135], a[176:179], v[68:71]
 ds_read_b128 a[200:203], v4 offset:8704
 v_mfma_f32_16x16x32_bf16 v[68:71], a[148:151], a[180:183], v[68:71]
 ds_read_b128 a[204:207], v4 offset:13056
 v_mfma_f32_16x16x32_bf16 v[52:55], a[148:151], a[176:179], v[52:55]
 ds_read_b64_tr_b16 a[48:49], v46 offset:12288
 v_mfma_f32_16x16x32_bf16 v[52:55], a[132:135], a[172:175], v[52:55]
 v_mfma_f32_16x16x32_bf16 v[52:55], a[116:119], a[168:171], v[52:55]
 v_mfma_f32_16x16x32_bf16 v[52:55], a[100:103], a[164:167], v[52:55]
 ds_read_b64_tr_b16 a[50:51], v46 offset:12544
 v_mfma_f32_16x16x32_bf16 v[52:55], a[84:87], a[160:163], v[52:55]
 v_mfma_f32_16x16x32_bf16 v[56:59], a[88:91], a[160:163], v[56:59]
 s_add_u32 m0, s29, 4096
 v_mfma_f32_16x16x32_bf16 v[56:59], a[104:107], a[164:167], v[56:59]
 s_waitcnt lgkmcnt(5)
 ds_read_b64_tr_b16 a[52:53], v46 offset:12296
 buffer_load_dwordx4 v5, s[8:11], s78 offen offset:0 lds
 v_mfma_f32_16x16x32_bf16 v[56:59], a[120:123], a[168:171], v[56:59]
 v_mfma_f32_16x16x32_bf16 v[56:59], a[136:139], a[172:175], v[56:59]
 v_mfma_f32_16x16x32_bf16 v[56:59], a[152:155], a[176:179], v[56:59]
 ds_read_b64_tr_b16 a[54:55], v46 offset:12552
 v_mfma_f32_16x16x32_bf16 v[72:75], a[152:155], a[180:183], v[72:75]
 v_mfma_f32_16x16x32_bf16 v[72:75], a[136:139], a[176:179], v[72:75]
 v_mfma_f32_16x16x32_bf16 v[72:75], a[120:123], a[172:175], v[72:75]
 ds_read_b64_tr_b16 a[64:65], v46 offset:16384
 v_mfma_f32_16x16x32_bf16 v[72:75], a[104:107], a[168:171], v[72:75]
 v_mfma_f32_16x16x32_bf16 v[72:75], a[88:91], a[164:167], v[72:75]
 v_mfma_f32_16x16x32_bf16 v[88:91], a[88:91], a[168:171], v[88:91]
 ds_read_b64_tr_b16 a[66:67], v46 offset:16640
 v_mfma_f32_16x16x32_bf16 v[88:91], a[104:107], a[172:175], v[88:91]
 v_mfma_f32_16x16x32_bf16 v[88:91], a[120:123], a[176:179], v[88:91]
 v_mfma_f32_16x16x32_bf16 v[88:91], a[136:139], a[180:183], v[88:91]
 s_add_u32 m0, s29, 6144
 ds_read_b64_tr_b16 a[68:69], v46 offset:16392
 v_mfma_f32_16x16x32_bf16 v[88:91], a[152:155], a[184:187], v[88:91]
 buffer_load_dwordx4 v5, s[8:11], s79 offen offset:0 lds
 v_mfma_f32_16x16x32_bf16 v[104:107], a[152:155], a[188:191], v[104:107]
 v_mfma_f32_16x16x32_bf16 v[104:107], a[136:139], a[184:187], v[104:107]
 ds_read_b64_tr_b16 a[70:71], v46 offset:16648
 v_mfma_f32_16x16x32_bf16 v[104:107], a[120:123], a[180:183], v[104:107]
 v_mfma_f32_16x16x32_bf16 v[104:107], a[104:107], a[176:179], v[104:107]
 v_mfma_f32_16x16x32_bf16 v[104:107], a[88:91], a[172:175], v[104:107]
 ds_read_b64_tr_b16 a[8:9], v46 offset:1024
 v_mfma_f32_16x16x32_bf16 v[108:111], a[92:95], a[172:175], v[108:111]
 v_mfma_f32_16x16x32_bf16 v[108:111], a[108:111], a[176:179], v[108:111]
 v_mfma_f32_16x16x32_bf16 v[108:111], a[124:127], a[180:183], v[108:111]
 ds_read_b64_tr_b16 a[10:11], v46 offset:1280
 v_mfma_f32_16x16x32_bf16 v[108:111], a[140:143], a[184:187], v[108:111]
 v_mfma_f32_16x16x32_bf16 v[108:111], a[156:159], a[188:191], v[108:111]
 v_mfma_f32_16x16x32_bf16 v[92:95], a[156:159], a[184:187], v[92:95]
 ds_read_b64_tr_b16 a[12:13], v46 offset:1032
 v_mfma_f32_16x16x32_bf16 v[92:95], a[140:143], a[180:183], v[92:95]
 s_add_u32 m0, s29, 8192
 v_mfma_f32_16x16x32_bf16 v[92:95], a[124:127], a[176:179], v[92:95]
 s_waitcnt lgkmcnt(4)
 buffer_load_dwordx4 v5, s[8:11], s80 offen offset:0 lds
 v_mfma_f32_16x16x32_bf16 v[92:95], a[108:111], a[172:175], v[92:95]
 ds_read_b64_tr_b16 a[14:15], v46 offset:1288
 v_mfma_f32_16x16x32_bf16 v[92:95], a[92:95], a[168:171], v[92:95]
 v_mfma_f32_16x16x32_bf16 v[76:79], a[92:95], a[164:167], v[76:79]
 v_mfma_f32_16x16x32_bf16 v[76:79], a[108:111], a[168:171], v[76:79]
 ds_read_b64_tr_b16 a[24:25], v46 offset:5120
 v_mfma_f32_16x16x32_bf16 v[76:79], a[124:127], a[172:175], v[76:79]
 v_mfma_f32_16x16x32_bf16 v[76:79], a[140:143], a[176:179], v[76:79]
 v_mfma_f32_16x16x32_bf16 v[76:79], a[156:159], a[180:183], v[76:79]
 ds_read_b64_tr_b16 a[26:27], v46 offset:5376
 v_mfma_f32_16x16x32_bf16 v[60:63], a[156:159], a[176:179], v[60:63]
 v_mfma_f32_16x16x32_bf16 v[60:63], a[140:143], a[172:175], v[60:63]
 v_mfma_f32_16x16x32_bf16 v[60:63], a[124:127], a[168:171], v[60:63]
 ds_read_b64_tr_b16 a[28:29], v46 offset:5128
 v_mfma_f32_16x16x32_bf16 v[60:63], a[108:111], a[164:167], v[60:63]
 v_mfma_f32_16x16x32_bf16 v[60:63], a[92:95], a[160:163], v[60:63]
 s_add_u32 m0, s29, 10240
 v_mfma_f32_16x16x32_bf16 v[124:127], a[92:95], a[176:179], v[124:127]
 ds_read_b64_tr_b16 a[30:31], v46 offset:5384
 buffer_load_dwordx4 v5, s[8:11], s81 offen offset:0 lds
 v_mfma_f32_16x16x32_bf16 v[124:127], a[108:111], a[180:183], v[124:127]
 v_mfma_f32_16x16x32_bf16 v[124:127], a[124:127], a[184:187], v[124:127]
 v_mfma_f32_16x16x32_bf16 v[124:127], a[140:143], a[188:191], v[124:127]
 ds_read_b64_tr_b16 a[40:41], v46 offset:9216
 v_mfma_f32_16x16x32_bf16 v[124:127], a[156:159], a[192:195], v[124:127]
 v_mfma_f32_16x16x32_bf16 v[140:143], a[156:159], a[196:199], v[140:143]
 v_mfma_f32_16x16x32_bf16 v[140:143], a[140:143], a[192:195], v[140:143]
 ds_read_b64_tr_b16 a[42:43], v46 offset:9472
 v_mfma_f32_16x16x32_bf16 v[140:143], a[124:127], a[188:191], v[140:143]
 v_mfma_f32_16x16x32_bf16 v[140:143], a[108:111], a[184:187], v[140:143]
 v_mfma_f32_16x16x32_bf16 v[140:143], a[92:95], a[180:183], v[140:143]
 ds_read_b64_tr_b16 a[44:45], v46 offset:9224
 v_mfma_f32_16x16x32_bf16 v[156:159], a[92:95], a[184:187], v[156:159]
 v_mfma_f32_16x16x32_bf16 v[156:159], a[108:111], a[188:191], v[156:159]
 v_mfma_f32_16x16x32_bf16 v[156:159], a[124:127], a[192:195], v[156:159]
 s_add_u32 m0, s29, 12288
 ds_read_b64_tr_b16 a[46:47], v46 offset:9480
 v_mfma_f32_16x16x32_bf16 v[156:159], a[140:143], a[196:199], v[156:159]
 buffer_load_dwordx4 v5, s[8:11], s82 offen offset:0 lds
 v_mfma_f32_16x16x32_bf16 v[156:159], a[156:159], a[200:203], v[156:159]
 v_mfma_f32_16x16x32_bf16 v[172:175], a[156:159], a[204:207], v[172:175]
 s_waitcnt vmcnt(8)
 ds_read_b64_tr_b16 a[56:57], v46 offset:13312
 v_mfma_f32_16x16x32_bf16 v[172:175], a[140:143], a[200:203], v[172:175]
 v_mfma_f32_16x16x32_bf16 v[172:175], a[124:127], a[196:199], v[172:175]
 v_mfma_f32_16x16x32_bf16 v[172:175], a[108:111], a[192:195], v[172:175]
 ds_read_b64_tr_b16 a[58:59], v46 offset:13568
 v_mfma_f32_16x16x32_bf16 v[172:175], a[92:95], a[188:191], v[172:175]
 ds_read_b128 a[172:175], v2 offset:2176
 v_mfma_f32_16x16x32_bf16 v[168:171], a[88:91], a[188:191], v[168:171]
 ds_read_b128 a[168:171], v2 offset:6528
 v_mfma_f32_16x16x32_bf16 v[168:171], a[104:107], a[192:195], v[168:171]
 ds_read_b128 a[164:167], v2 offset:10880
 ds_read_b64_tr_b16 a[60:61], v46 offset:13320
 v_mfma_f32_16x16x32_bf16 v[168:171], a[120:123], a[196:199], v[168:171]
 ds_read_b128 a[160:163], v2 offset:15232
 v_mfma_f32_16x16x32_bf16 v[168:171], a[136:139], a[200:203], v[168:171]
 v_mfma_f32_16x16x32_bf16 v[168:171], a[152:155], a[204:207], v[168:171]
 ds_read_b64_tr_b16 a[62:63], v46 offset:13576
 v_mfma_f32_16x16x32_bf16 v[152:155], a[152:155], a[200:203], v[152:155]
 s_add_u32 m0, s29, 14336
 v_mfma_f32_16x16x32_bf16 v[152:155], a[136:139], a[196:199], v[152:155]
 buffer_load_dwordx4 v5, s[8:11], s83 offen offset:0 lds
 v_mfma_f32_16x16x32_bf16 v[152:155], a[120:123], a[192:195], v[152:155]
 ds_read_b64_tr_b16 a[72:73], v46 offset:17408
 v_mfma_f32_16x16x32_bf16 v[152:155], a[104:107], a[188:191], v[152:155]
 v_mfma_f32_16x16x32_bf16 v[152:155], a[88:91], a[184:187], v[152:155]
 v_mfma_f32_16x16x32_bf16 v[136:139], a[88:91], a[180:183], v[136:139]
 ds_read_b64_tr_b16 a[74:75], v46 offset:17664
 v_mfma_f32_16x16x32_bf16 v[136:139], a[104:107], a[184:187], v[136:139]
 v_mfma_f32_16x16x32_bf16 v[136:139], a[120:123], a[188:191], v[136:139]
 v_mfma_f32_16x16x32_bf16 v[136:139], a[136:139], a[192:195], v[136:139]
 ds_read_b64_tr_b16 a[76:77], v46 offset:17416
 v_mfma_f32_16x16x32_bf16 v[136:139], a[152:155], a[196:199], v[136:139]
 v_mfma_f32_16x16x32_bf16 v[120:123], a[152:155], a[192:195], v[120:123]
 v_mfma_f32_16x16x32_bf16 v[120:123], a[136:139], a[188:191], v[120:123]
 ds_read_b64_tr_b16 a[78:79], v46 offset:17672
 v_mfma_f32_16x16x32_bf16 v[120:123], a[120:123], a[184:187], v[120:123]
 v_mfma_f32_16x16x32_bf16 v[120:123], a[104:107], a[180:183], v[120:123]
 s_add_u32 m0, s29, 16384
 v_mfma_f32_16x16x32_bf16 v[120:123], a[88:91], a[176:179], v[120:123]
 s_waitcnt lgkmcnt(3)
 buffer_load_dwordx4 v5, s[8:11], s84 offen offset:0 lds
 v_mfma_f32_16x16x32_bf16 v[116:119], a[84:87], a[176:179], v[116:119]
 v_mfma_f32_16x16x32_bf16 v[116:119], a[100:103], a[180:183], v[116:119]
 v_mfma_f32_16x16x32_bf16 v[116:119], a[116:119], a[184:187], v[116:119]
 v_mfma_f32_16x16x32_bf16 v[116:119], a[132:135], a[188:191], v[116:119]
 v_mfma_f32_16x16x32_bf16 v[116:119], a[148:151], a[192:195], v[116:119]
 v_mfma_f32_16x16x32_bf16 v[132:135], a[148:151], a[196:199], v[132:135]
 v_mfma_f32_16x16x32_bf16 v[132:135], a[132:135], a[192:195], v[132:135]
 v_mfma_f32_16x16x32_bf16 v[132:135], a[116:119], a[188:191], v[132:135]
 v_mfma_f32_16x16x32_bf16 v[132:135], a[100:103], a[184:187], v[132:135]
 v_mfma_f32_16x16x32_bf16 v[132:135], a[84:87], a[180:183], v[132:135]
 v_mfma_f32_16x16x32_bf16 v[148:151], a[84:87], a[184:187], v[148:151]
 v_mfma_f32_16x16x32_bf16 v[148:151], a[100:103], a[188:191], v[148:151]
 s_add_u32 m0, s29, 18432
 v_mfma_f32_16x16x32_bf16 v[148:151], a[116:119], a[192:195], v[148:151]
 buffer_load_dwordx4 v5, s[8:11], s85 offen offset:0 lds
 v_mfma_f32_16x16x32_bf16 v[148:151], a[132:135], a[196:199], v[148:151]
 v_mfma_f32_16x16x32_bf16 v[148:151], a[148:151], a[200:203], v[148:151]
 v_mfma_f32_16x16x32_bf16 v[164:167], a[148:151], a[204:207], v[164:167]
 v_mfma_f32_16x16x32_bf16 v[164:167], a[132:135], a[200:203], v[164:167]
 v_mfma_f32_16x16x32_bf16 v[164:167], a[116:119], a[196:199], v[164:167]
 v_mfma_f32_16x16x32_bf16 v[164:167], a[100:103], a[192:195], v[164:167]
 v_mfma_f32_16x16x32_bf16 v[164:167], a[84:87], a[188:191], v[164:167]
 v_mfma_f32_16x16x32_bf16 v[160:163], a[80:83], a[188:191], v[160:163]
 v_mfma_f32_16x16x32_bf16 v[160:163], a[96:99], a[192:195], v[160:163]
 v_mfma_f32_16x16x32_bf16 v[160:163], a[112:115], a[196:199], v[160:163]
 v_mfma_f32_16x16x32_bf16 v[160:163], a[128:131], a[200:203], v[160:163]
 v_mfma_f32_16x16x32_bf16 v[160:163], a[144:147], a[204:207], v[160:163]
 s_add_u32 m0, s29, 0
 ds_read_b128 a[204:207], v2 offset:19584
 v_mfma_f32_16x16x32_bf16 v[144:147], a[144:147], a[200:203], v[144:147]
 ds_read_b128 a[200:203], v2 offset:23936
 buffer_load_dwordx4 v5, s[8:11], s76 offen offset:1024 lds
 v_mfma_f32_16x16x32_bf16 v[144:147], a[128:131], a[196:199], v[144:147]
 v_mfma_f32_16x16x32_bf16 v[144:147], a[112:115], a[192:195], v[144:147]
 v_mfma_f32_16x16x32_bf16 v[144:147], a[96:99], a[188:191], v[144:147]
 v_mfma_f32_16x16x32_bf16 v[144:147], a[80:83], a[184:187], v[144:147]
 v_mfma_f32_16x16x32_bf16 v[128:131], a[80:83], a[180:183], v[128:131]
 v_mfma_f32_16x16x32_bf16 v[128:131], a[96:99], a[184:187], v[128:131]
 v_mfma_f32_16x16x32_bf16 v[128:131], a[112:115], a[188:191], v[128:131]
 v_mfma_f32_16x16x32_bf16 v[128:131], a[128:131], a[192:195], v[128:131]
 v_mfma_f32_16x16x32_bf16 v[128:131], a[144:147], a[196:199], v[128:131]
 ds_read_b128 a[196:199], v2 offset:28288
 v_mfma_f32_16x16x32_bf16 v[112:115], a[144:147], a[192:195], v[112:115]
 ds_read_b128 a[192:195], v2 offset:32640
 v_mfma_f32_16x16x32_bf16 v[112:115], a[128:131], a[188:191], v[112:115]
 v_mfma_f32_16x16x32_bf16 v[112:115], a[112:115], a[184:187], v[112:115]
 s_add_u32 m0, s29, 2048
 v_mfma_f32_16x16x32_bf16 v[112:115], a[96:99], a[180:183], v[112:115]
 buffer_load_dwordx4 v5, s[8:11], s77 offen offset:1024 lds
 v_mfma_f32_16x16x32_bf16 v[112:115], a[80:83], a[176:179], v[112:115]
 v_mfma_f32_16x16x32_bf16 v[176:179], a[80:83], a[172:175], v[176:179]
 v_mfma_f32_16x16x32_bf16 v[176:179], a[96:99], a[168:171], v[176:179]
 v_mfma_f32_16x16x32_bf16 v[176:179], a[112:115], a[164:167], v[176:179]
 v_mfma_f32_16x16x32_bf16 v[176:179], a[128:131], a[160:163], v[176:179]
 s_waitcnt lgkmcnt(2)
 v_mfma_f32_16x16x32_bf16 v[176:179], a[144:147], a[204:207], v[176:179]
 v_mfma_f32_16x16x32_bf16 v[192:195], a[144:147], a[200:203], v[192:195]
 v_mfma_f32_16x16x32_bf16 v[192:195], a[128:131], a[204:207], v[192:195]
 v_mfma_f32_16x16x32_bf16 v[192:195], a[112:115], a[160:163], v[192:195]
 v_mfma_f32_16x16x32_bf16 v[192:195], a[96:99], a[164:167], v[192:195]
 v_mfma_f32_16x16x32_bf16 v[192:195], a[80:83], a[168:171], v[192:195]
 v_mfma_f32_16x16x32_bf16 v[208:211], a[80:83], a[164:167], v[208:211]
 s_add_u32 m0, s29, 4096
 v_mfma_f32_16x16x32_bf16 v[208:211], a[96:99], a[160:163], v[208:211]
 buffer_load_dwordx4 v5, s[8:11], s78 offen offset:1024 lds
 v_mfma_f32_16x16x32_bf16 v[208:211], a[112:115], a[204:207], v[208:211]
 v_mfma_f32_16x16x32_bf16 v[208:211], a[128:131], a[200:203], v[208:211]
 s_waitcnt lgkmcnt(0)
 v_mfma_f32_16x16x32_bf16 v[208:211], a[144:147], a[196:199], v[208:211]
 v_mfma_f32_16x16x32_bf16 v[224:227], a[144:147], a[192:195], v[224:227]
 v_mfma_f32_16x16x32_bf16 v[224:227], a[128:131], a[196:199], v[224:227]
 v_mfma_f32_16x16x32_bf16 v[224:227], a[112:115], a[200:203], v[224:227]
 v_mfma_f32_16x16x32_bf16 v[224:227], a[96:99], a[204:207], v[224:227]
 v_mfma_f32_16x16x32_bf16 v[224:227], a[80:83], a[160:163], v[224:227]
 v_mfma_f32_16x16x32_bf16 v[228:231], a[84:87], a[160:163], v[228:231]
 v_mfma_f32_16x16x32_bf16 v[228:231], a[100:103], a[204:207], v[228:231]
 v_mfma_f32_16x16x32_bf16 v[228:231], a[116:119], a[200:203], v[228:231]
 v_mfma_f32_16x16x32_bf16 v[228:231], a[132:135], a[196:199], v[228:231]
 s_add_u32 m0, s29, 6144
 ds_read_b128 a[188:191], v4 offset:2176
 v_mfma_f32_16x16x32_bf16 v[228:231], a[148:151], a[192:195], v[228:231]
 ds_read_b128 a[184:187], v4 offset:6528
 buffer_load_dwordx4 v5, s[8:11], s79 offen offset:1024 lds
 v_mfma_f32_16x16x32_bf16 v[212:215], a[148:151], a[196:199], v[212:215]
 v_mfma_f32_16x16x32_bf16 v[212:215], a[132:135], a[200:203], v[212:215]
 v_mfma_f32_16x16x32_bf16 v[212:215], a[116:119], a[204:207], v[212:215]
 v_mfma_f32_16x16x32_bf16 v[212:215], a[100:103], a[160:163], v[212:215]
 v_mfma_f32_16x16x32_bf16 v[212:215], a[84:87], a[164:167], v[212:215]
 v_mfma_f32_16x16x32_bf16 v[196:199], a[84:87], a[168:171], v[196:199]
 v_mfma_f32_16x16x32_bf16 v[196:199], a[100:103], a[164:167], v[196:199]
 v_mfma_f32_16x16x32_bf16 v[196:199], a[116:119], a[160:163], v[196:199]
 v_mfma_f32_16x16x32_bf16 v[196:199], a[132:135], a[204:207], v[196:199]
 ds_read_b128 a[180:183], v4 offset:10880
 v_mfma_f32_16x16x32_bf16 v[196:199], a[148:151], a[200:203], v[196:199]
 ds_read_b128 a[176:179], v4 offset:15232
 v_mfma_f32_16x16x32_bf16 v[180:183], a[148:151], a[204:207], v[180:183]
 v_mfma_f32_16x16x32_bf16 v[180:183], a[132:135], a[160:163], v[180:183]
 s_add_u32 m0, s29, 8192
 v_mfma_f32_16x16x32_bf16 v[180:183], a[116:119], a[164:167], v[180:183]
 buffer_load_dwordx4 v5, s[8:11], s80 offen offset:1024 lds
 v_mfma_f32_16x16x32_bf16 v[180:183], a[100:103], a[168:171], v[180:183]
 v_mfma_f32_16x16x32_bf16 v[180:183], a[84:87], a[172:175], v[180:183]
 v_mfma_f32_16x16x32_bf16 v[184:187], a[88:91], a[172:175], v[184:187]
 v_mfma_f32_16x16x32_bf16 v[184:187], a[104:107], a[168:171], v[184:187]
 v_mfma_f32_16x16x32_bf16 v[184:187], a[120:123], a[164:167], v[184:187]
 v_mfma_f32_16x16x32_bf16 v[184:187], a[136:139], a[160:163], v[184:187]
 v_mfma_f32_16x16x32_bf16 v[184:187], a[152:155], a[204:207], v[184:187]
 v_mfma_f32_16x16x32_bf16 v[200:203], a[152:155], a[200:203], v[200:203]
 v_mfma_f32_16x16x32_bf16 v[200:203], a[136:139], a[204:207], v[200:203]
 v_mfma_f32_16x16x32_bf16 v[200:203], a[120:123], a[160:163], v[200:203]
 v_mfma_f32_16x16x32_bf16 v[200:203], a[104:107], a[164:167], v[200:203]
 v_mfma_f32_16x16x32_bf16 v[200:203], a[88:91], a[168:171], v[200:203]
 s_add_u32 m0, s29, 10240
 v_mfma_f32_16x16x32_bf16 v[216:219], a[88:91], a[164:167], v[216:219]
 buffer_load_dwordx4 v5, s[8:11], s81 offen offset:1024 lds
 v_mfma_f32_16x16x32_bf16 v[216:219], a[104:107], a[160:163], v[216:219]
 v_mfma_f32_16x16x32_bf16 v[216:219], a[120:123], a[204:207], v[216:219]
 v_mfma_f32_16x16x32_bf16 v[216:219], a[136:139], a[200:203], v[216:219]
 v_mfma_f32_16x16x32_bf16 v[216:219], a[152:155], a[196:199], v[216:219]
 v_mfma_f32_16x16x32_bf16 v[232:235], a[152:155], a[192:195], v[232:235]
 v_mfma_f32_16x16x32_bf16 v[232:235], a[136:139], a[196:199], v[232:235]
 v_mfma_f32_16x16x32_bf16 v[232:235], a[120:123], a[200:203], v[232:235]
 v_mfma_f32_16x16x32_bf16 v[232:235], a[104:107], a[204:207], v[232:235]
 v_mfma_f32_16x16x32_bf16 v[232:235], a[88:91], a[160:163], v[232:235]
 v_mfma_f32_16x16x32_bf16 v[236:239], a[92:95], a[160:163], v[236:239]
 v_mfma_f32_16x16x32_bf16 v[236:239], a[108:111], a[204:207], v[236:239]
 v_mfma_f32_16x16x32_bf16 v[236:239], a[124:127], a[200:203], v[236:239]
 s_add_u32 m0, s29, 12288
 v_mfma_f32_16x16x32_bf16 v[236:239], a[140:143], a[196:199], v[236:239]
 buffer_load_dwordx4 v5, s[8:11], s82 offen offset:1024 lds
 v_mfma_f32_16x16x32_bf16 v[236:239], a[156:159], a[192:195], v[236:239]
 v_mfma_f32_16x16x32_bf16 v[220:223], a[156:159], a[196:199], v[220:223]
 v_mfma_f32_16x16x32_bf16 v[220:223], a[140:143], a[200:203], v[220:223]
 v_mfma_f32_16x16x32_bf16 v[220:223], a[124:127], a[204:207], v[220:223]
 v_mfma_f32_16x16x32_bf16 v[220:223], a[108:111], a[160:163], v[220:223]
 v_mfma_f32_16x16x32_bf16 v[220:223], a[92:95], a[164:167], v[220:223]
 v_mfma_f32_16x16x32_bf16 v[204:207], a[92:95], a[168:171], v[204:207]
 v_mfma_f32_16x16x32_bf16 v[204:207], a[108:111], a[164:167], v[204:207]
 v_mfma_f32_16x16x32_bf16 v[204:207], a[124:127], a[160:163], v[204:207]
 v_mfma_f32_16x16x32_bf16 v[204:207], a[140:143], a[204:207], v[204:207]
 v_mfma_f32_16x16x32_bf16 v[204:207], a[156:159], a[200:203], v[204:207]
 v_mfma_f32_16x16x32_bf16 v[188:191], a[156:159], a[204:207], v[188:191]
 s_add_u32 m0, s29, 14336
 v_mfma_f32_16x16x32_bf16 v[188:191], a[140:143], a[160:163], v[188:191]
 s_waitcnt vmcnt(9) lgkmcnt(0)
 s_barrier
 buffer_load_dwordx4 v5, s[8:11], s83 offen offset:1024 lds
 v_mfma_f32_16x16x32_bf16 v[188:191], a[124:127], a[164:167], v[188:191]
 v_xor_b32 v1, 0x10000, v1
 v_xor_b32 v2, 0x10000, v2
 v_mfma_f32_16x16x32_bf16 v[188:191], a[108:111], a[168:171], v[188:191]
 v_xor_b32 v3, 0x10000, v3
 v_xor_b32 v4, 0x10000, v4
 v_mfma_f32_16x16x32_bf16 v[188:191], a[92:95], a[172:175], v[188:191]
 ds_read_b128 a[160:163], v1 offset:0
 ds_read_b128 a[164:167], v1 offset:4352
 v_mfma_f32_16x16x32_bf16 v[252:255], a[92:95], a[204:207], v[252:255]
 ds_read_b128 a[168:171], v1 offset:8704
 ds_read_b128 a[172:175], v1 offset:13056
 v_mfma_f32_16x16x32_bf16 v[252:255], a[108:111], a[200:203], v[252:255]
 v_mfma_f32_16x16x32_bf16 v[252:255], a[124:127], a[196:199], v[252:255]
 v_mfma_f32_16x16x32_bf16 v[252:255], a[140:143], a[192:195], v[252:255]
 v_mfma_f32_16x16x32_bf16 v[252:255], a[156:159], a[188:191], v[252:255]
 v_mfma_f32_16x16x32_bf16 a[220:223], a[156:159], a[184:187], a[220:223]
 v_mfma_f32_16x16x32_bf16 a[220:223], a[140:143], a[188:191], a[220:223]
 v_mfma_f32_16x16x32_bf16 a[220:223], a[124:127], a[192:195], a[220:223]
 v_mfma_f32_16x16x32_bf16 a[220:223], a[108:111], a[196:199], a[220:223]
 s_add_u32 m0, s29, 16384
 v_mfma_f32_16x16x32_bf16 a[220:223], a[92:95], a[200:203], a[220:223]
 buffer_load_dwordx4 v5, s[8:11], s84 offen offset:1024 lds
 v_mfma_f32_16x16x32_bf16 a[236:239], a[92:95], a[196:199], a[236:239]
 v_mfma_f32_16x16x32_bf16 a[236:239], a[108:111], a[192:195], a[236:239]
 v_mfma_f32_16x16x32_bf16 a[236:239], a[124:127], a[188:191], a[236:239]
 v_mfma_f32_16x16x32_bf16 a[236:239], a[140:143], a[184:187], a[236:239]
 v_mfma_f32_16x16x32_bf16 a[236:239], a[156:159], a[180:183], a[236:239]
 v_mfma_f32_16x16x32_bf16 a[252:255], a[156:159], a[176:179], a[252:255]
 v_mfma_f32_16x16x32_bf16 a[252:255], a[140:143], a[180:183], a[252:255]
 v_mfma_f32_16x16x32_bf16 a[252:255], a[124:127], a[184:187], a[252:255]
 v_mfma_f32_16x16x32_bf16 a[252:255], a[108:111], a[188:191], a[252:255]
 v_mfma_f32_16x16x32_bf16 a[252:255], a[92:95], a[192:195], a[252:255]
 v_mfma_f32_16x16x32_bf16 a[248:251], a[88:91], a[192:195], a[248:251]
 v_mfma_f32_16x16x32_bf16 a[248:251], a[104:107], a[188:191], a[248:251]
 s_add_u32 m0, s29, 18432
 v_mfma_f32_16x16x32_bf16 a[248:251], a[120:123], a[184:187], a[248:251]
 buffer_load_dwordx4 v5, s[8:11], s85 offen offset:1024 lds
 v_mfma_f32_16x16x32_bf16 a[248:251], a[136:139], a[180:183], a[248:251]
 s_add_u32 s8, s8, 0x10000
 s_addc_u32 s9, s9, 0
 v_mfma_f32_16x16x32_bf16 a[248:251], a[152:155], a[176:179], a[248:251]
 v_mfma_f32_16x16x32_bf16 a[232:235], a[152:155], a[180:183], a[232:235]
 v_mfma_f32_16x16x32_bf16 a[232:235], a[136:139], a[184:187], a[232:235]
 v_mfma_f32_16x16x32_bf16 a[232:235], a[120:123], a[188:191], a[232:235]
 v_mfma_f32_16x16x32_bf16 a[232:235], a[104:107], a[192:195], a[232:235]
 v_mfma_f32_16x16x32_bf16 a[232:235], a[88:91], a[196:199], a[232:235]
 v_mfma_f32_16x16x32_bf16 a[216:219], a[88:91], a[200:203], a[216:219]
 v_mfma_f32_16x16x32_bf16 a[216:219], a[104:107], a[196:199], a[216:219]
 v_mfma_f32_16x16x32_bf16 a[216:219], a[120:123], a[192:195], a[216:219]
 v_mfma_f32_16x16x32_bf16 a[216:219], a[136:139], a[188:191], a[216:219]
 v_mfma_f32_16x16x32_bf16 a[216:219], a[152:155], a[184:187], a[216:219]
 v_mfma_f32_16x16x32_bf16 v[248:251], a[152:155], a[188:191], v[248:251]
 v_mfma_f32_16x16x32_bf16 v[248:251], a[136:139], a[192:195], v[248:251]
 v_mfma_f32_16x16x32_bf16 v[248:251], a[120:123], a[196:199], v[248:251]
 v_mfma_f32_16x16x32_bf16 v[248:251], a[104:107], a[200:203], v[248:251]
 v_mfma_f32_16x16x32_bf16 v[248:251], a[88:91], a[204:207], v[248:251]
 v_mfma_f32_16x16x32_bf16 v[244:247], a[84:87], a[204:207], v[244:247]
 v_mfma_f32_16x16x32_bf16 v[244:247], a[100:103], a[200:203], v[244:247]
 v_mfma_f32_16x16x32_bf16 v[244:247], a[116:119], a[196:199], v[244:247]
 v_mfma_f32_16x16x32_bf16 v[244:247], a[132:135], a[192:195], v[244:247]
 v_mfma_f32_16x16x32_bf16 v[244:247], a[148:151], a[188:191], v[244:247]
 v_mfma_f32_16x16x32_bf16 a[212:215], a[148:151], a[184:187], a[212:215]
 v_mfma_f32_16x16x32_bf16 a[212:215], a[132:135], a[188:191], a[212:215]
 v_mfma_f32_16x16x32_bf16 a[212:215], a[116:119], a[192:195], a[212:215]
 v_mfma_f32_16x16x32_bf16 a[212:215], a[100:103], a[196:199], a[212:215]
 v_mfma_f32_16x16x32_bf16 a[212:215], a[84:87], a[200:203], a[212:215]
 v_mfma_f32_16x16x32_bf16 a[228:231], a[84:87], a[196:199], a[228:231]
 v_mfma_f32_16x16x32_bf16 a[228:231], a[100:103], a[192:195], a[228:231]
 v_mfma_f32_16x16x32_bf16 a[228:231], a[116:119], a[188:191], a[228:231]
 v_mfma_f32_16x16x32_bf16 a[228:231], a[132:135], a[184:187], a[228:231]
 v_mfma_f32_16x16x32_bf16 a[228:231], a[148:151], a[180:183], a[228:231]
 v_mfma_f32_16x16x32_bf16 a[244:247], a[148:151], a[176:179], a[244:247]
 v_mfma_f32_16x16x32_bf16 a[244:247], a[132:135], a[180:183], a[244:247]
 v_mfma_f32_16x16x32_bf16 a[244:247], a[116:119], a[184:187], a[244:247]
 v_mfma_f32_16x16x32_bf16 a[244:247], a[100:103], a[188:191], a[244:247]
 v_mfma_f32_16x16x32_bf16 a[244:247], a[84:87], a[192:195], a[244:247]
 v_mfma_f32_16x16x32_bf16 a[240:243], a[80:83], a[192:195], a[240:243]
 v_mfma_f32_16x16x32_bf16 a[240:243], a[96:99], a[188:191], a[240:243]
 v_mfma_f32_16x16x32_bf16 a[240:243], a[112:115], a[184:187], a[240:243]
 v_mfma_f32_16x16x32_bf16 a[240:243], a[128:131], a[180:183], a[240:243]
 v_mfma_f32_16x16x32_bf16 a[240:243], a[144:147], a[176:179], a[240:243]
 ds_read_b128 a[176:179], v1 offset:17408
 v_mfma_f32_16x16x32_bf16 a[224:227], a[144:147], a[180:183], a[224:227]
 ds_read_b128 a[180:183], v1 offset:21760
 v_mfma_f32_16x16x32_bf16 a[224:227], a[128:131], a[184:187], a[224:227]
 v_mfma_f32_16x16x32_bf16 a[224:227], a[112:115], a[188:191], a[224:227]
 v_mfma_f32_16x16x32_bf16 a[224:227], a[96:99], a[192:195], a[224:227]
 v_mfma_f32_16x16x32_bf16 a[224:227], a[80:83], a[196:199], a[224:227]
 v_mfma_f32_16x16x32_bf16 a[208:211], a[80:83], a[200:203], a[208:211]
 v_mfma_f32_16x16x32_bf16 a[208:211], a[96:99], a[196:199], a[208:211]
 v_mfma_f32_16x16x32_bf16 a[208:211], a[112:115], a[192:195], a[208:211]
 v_mfma_f32_16x16x32_bf16 a[208:211], a[128:131], a[188:191], a[208:211]
 v_mfma_f32_16x16x32_bf16 a[208:211], a[144:147], a[184:187], a[208:211]
 v_mfma_f32_16x16x32_bf16 v[240:243], a[144:147], a[188:191], v[240:243]
 v_mfma_f32_16x16x32_bf16 v[240:243], a[128:131], a[192:195], v[240:243]
 v_mfma_f32_16x16x32_bf16 v[240:243], a[112:115], a[196:199], v[240:243]
 v_mfma_f32_16x16x32_bf16 v[240:243], a[96:99], a[200:203], v[240:243]
 v_mfma_f32_16x16x32_bf16 v[240:243], a[80:83], a[204:207], v[240:243]
 s_sub_u32 s25, s25, 1
 s_sub_u32 s23, s23, 1
 s_sub_u32 s30, s30, 1
 s_cmp_lg_u32 s30, 0
 s_cbranch_scc1 L_mid
 s_cmp_lg_u32 s25, 0
 s_cbranch_scc1 L_f16
 s_branch L_c7
L_disp:
 s_cmp_eq_u32 s23, 4
 s_cbranch_scc0 L_d3
 s_lshl_b32 s35, s75, 2
 s_sub_u32 s34, s94, s96
 s_min_u32 s34, s34, 4095
 s_add_u32 s34, s34, 0x100000
 v_mov_b32 v45, s34
 s_mov_b64 exec, 1
 buffer_atomic_add v45, off, s[64:67], s35 offset:128
 s_mov_b64 exec, -1
 s_branch L_mid2
L_d3:
 s_cmp_eq_u32 s23, 3
 s_cbranch_scc0 L_d2
 v_lshlrev_b32 v16, 2, v39
 s_mov_b64 exec, 0xff
 buffer_load_dword v45, v16, s[64:67], 0 offen offset:128 sc0 sc1
 s_mov_b64 exec, -1
 s_branch L_mid2
L_d2:
 s_cmp_eq_u32 s23, 2
 s_cbranch_scc0 L_d1
 s_waitcnt vmcnt(40)
 v_readlane_b32 s34, v45, s75
 v_lshrrev_b32 v16, 20, v45
 v_and_b32 v17, 0xfffff, v45
 s_lshr_b32 s35, s34, 20
 s_and_b32 s34, s34, 0xfffff
 v_mul_u32_u24 v17, s35, v17
 v_mul_u32_u24 v16, s34, v16
 s_mov_b64 exec, 0xff
 v_cmp_gt_u32 vcc, v17, v16
 v_cmp_eq_u32 s[36:37], v17, v16
 s_mov_b64 exec, 1
 v_mov_b32 v45, 1
 s_bfm_b32 s35, s75, 0
 s_nop 2
 s_and_b32 s36, s36, s35
 s_or_b32 s36, s36, vcc_lo
 s_bcnt1_i32_b32 s74, s36
 s_lshl_b32 s35, s24, 5
 s_lshl_b32 s34, s74, 2
 s_add_u32 s35, s35, s34
 buffer_atomic_add v45, off, s[64:67], s35 sc0
 s_mov_b64 exec, -1
 s_branch L_mid2
L_d1:
 s_waitcnt vmcnt(40)
L_d1b:
 v_readfirstlane_b32 s34, v45
 s_nop 3
 s_cmp_lt_u32 s34, 8
 s_cbranch_scc1 L_d1c
 s_add_u32 s74, s74, 1
 s_and_b32 s74, s74, 7
 s_lshl_b32 s35, s24, 5
 s_lshl_b32 s34, s74, 2
 s_add_u32 s35, s35, s34
 v_mov_b32 v45, 1
 s_mov_b64 exec, 1
 buffer_atomic_add v45, off, s[64:67], s35 sc0
 s_mov_b64 exec, -1
 s_sub_u32 s70, s70, 1
 s_waitcnt vmcnt(0)
 s_cmp_lg_u32 s70, 0
 s_cbranch_scc1 L_d1b
 v_readfirstlane_b32 s34, v45
 s_nop 3
 s_and_b32 s34, s34, 7
L_d1c:
 s_lshl_b32 s35, s74, 3
 s_add_u32 s34, s34, s35
 v_mov_b32 v45, s34
 ds_write_b32 v38, v45
 s_branch L_pf
L_c7:
 ds_read_b32 v45, v38
 s_waitcnt lgkmcnt(0)
 v_readfirstlane_b32 s34, v45
 s_nop 3
 s_lshr_b32 s35, s34, 3
 s_and_b32 s36, s34, 3
 s_bitcmp1_b32 s34, 2
 s_cselect_b32 s68, 16384000, 0
 s_movk_i32 s72, 14
 s_mov_b32 s37, 8192
 s_cmp_ge_u32 s35, 1
 s_cselect_b32 s72, 15, s72
 s_cselect_b32 s37, 8128, s37
 s_cmp_ge_u32 s35, 5
 s_cselect_b32 s72, 16, s72
 s_cselect_b32 s37, 7808, s37
 s_lshl_b32 s35, s35, 2
 s_add_u32 s35, s35, s36
 s_mul_i32 s35, s35, s72
 s_lshl_b32 s35, s35, 4
 s_add_u32 s35, s35, s37
 s_lshl_b32 s69, s35, 10
 s_sub_u32 s73, s69, s44
 s_mov_b32 s35, L_p16-L_c0
 s_cmp_eq_u32 s72, 15
 s_cselect_b32 s35, L_p15-L_c0, s35
 s_cmp_eq_u32 s72, 14
 s_cselect_b32 s35, L_p14-L_c0, s35
 s_add_u32 s88, s86, s35
 s_addc_u32 s89, s87, 0
 s_sub_u32 s71, s72, 16
 s_lshl_b32 s71, s71, 10
 s_waitcnt lgkmcnt(5)
 ds_read_b128 a[184:187], v1 offset:26112
 v_mfma_f32_16x16x32_bf16 v[48:51], a[0:3], a[160:163], v[48:51]
 s_waitcnt lgkmcnt(5)
 v_mfma_f32_16x16x32_bf16 v[48:51], a[16:19], a[164:167], v[48:51]
 s_waitcnt lgkmcnt(4)
 ds_read_b64_tr_b16 a[80:81], v46 offset:0
 v_mfma_f32_16x16x32_bf16 v[48:51], a[32:35], a[168:171], v[48:51]
 s_waitcnt lgkmcnt(4)
 ds_read_b64_tr_b16 a[82:83], v46 offset:256
 v_mfma_f32_16x16x32_bf16 v[48:51], a[48:51], a[172:175], v[48:51]
 s_waitcnt lgkmcnt(4)
 ds_read_b128 a[188:191], v1 offset:30464
 ds_read_b64_tr_b16 a[84:85], v46 offset:8
 v_mfma_f32_16x16x32_bf16 v[48:51], a[64:67], a[176:179], v[48:51]
 ds_read_b64_tr_b16 a[86:87], v46 offset:264
 v_mfma_f32_16x16x32_bf16 v[52:55], a[68:71], a[176:179], v[52:55]
 ds_read_b64_tr_b16 a[96:97], v46 offset:4096
 v_mfma_f32_16x16x32_bf16 v[52:55], a[52:55], a[172:175], v[52:55]
 s_add_u32 s4, s16, s68
 s_addc_u32 s5, s17, 0
 ds_read_b64_tr_b16 a[98:99], v46 offset:4352
 v_mfma_f32_16x16x32_bf16 v[52:55], a[36:39], a[168:171], v[52:55]
 s_mov_b32 s8, s62
 s_mov_b32 s9, s63
 ds_read_b64_tr_b16 a[100:101], v46 offset:4104
 v_mfma_f32_16x16x32_bf16 v[52:55], a[20:23], a[164:167], v[52:55]
 ds_read_b64_tr_b16 a[102:103], v46 offset:4360
 v_mfma_f32_16x16x32_bf16 v[52:55], a[4:7], a[160:163], v[52:55]
 ds_read_b64_tr_b16 a[112:113], v46 offset:8192
 v_mfma_f32_16x16x32_bf16 v[56:59], a[8:11], a[160:163], v[56:59]
 s_add_u32 m0, s29, 0
 ds_read_b64_tr_b16 a[114:115], v46 offset:8448
 v_mfma_f32_16x16x32_bf16 v[56:59], a[24:27], a[164:167], v[56:59]
 s_waitcnt lgkmcnt(6)
 ds_read_b64_tr_b16 a[116:117], v46 offset:8200
 buffer_load_dwordx4 v5, s[8:11], s76 offen offset:0 lds
 v_mfma_f32_16x16x32_bf16 v[56:59], a[40:43], a[168:171], v[56:59]
 ds_read_b64_tr_b16 a[118:119], v46 offset:8456
 v_mfma_f32_16x16x32_bf16 v[56:59], a[56:59], a[172:175], v[56:59]
 ds_read_b64_tr_b16 a[128:129], v46 offset:12288
 v_mfma_f32_16x16x32_bf16 v[56:59], a[72:75], a[176:179], v[56:59]
 ds_read_b64_tr_b16 a[130:131], v46 offset:12544
 v_mfma_f32_16x16x32_bf16 v[60:63], a[76:79], a[176:179], v[60:63]
 ds_read_b64_tr_b16 a[132:133], v46 offset:12296
 v_mfma_f32_16x16x32_bf16 v[60:63], a[60:63], a[172:175], v[60:63]
 ds_read_b64_tr_b16 a[134:135], v46 offset:12552
 v_mfma_f32_16x16x32_bf16 v[60:63], a[44:47], a[168:171], v[60:63]
 s_waitcnt vmcnt(11)
 ds_read_b64_tr_b16 a[144:145], v46 offset:16384
 v_mfma_f32_16x16x32_bf16 v[60:63], a[28:31], a[164:167], v[60:63]
 ds_read_b64_tr_b16 a[146:147], v46 offset:16640
 v_mfma_f32_16x16x32_bf16 v[60:63], a[12:15], a[160:163], v[60:63]
 ds_read_b128 a[192:195], v2 offset:0
 ds_read_b64_tr_b16 a[148:149], v46 offset:16392
 v_mfma_f32_16x16x32_bf16 v[76:79], a[12:15], a[164:167], v[76:79]
 ds_read_b128 a[196:199], v2 offset:4352
 ds_read_b64_tr_b16 a[150:151], v46 offset:16648
 v_mfma_f32_16x16x32_bf16 v[76:79], a[28:31], a[168:171], v[76:79]
 s_waitcnt vmcnt(9)
 ds_read_b128 a[200:203], v2 offset:8704
 ds_read_b64_tr_b16 a[88:89], v46 offset:1024
 v_mfma_f32_16x16x32_bf16 v[76:79], a[44:47], a[172:175], v[76:79]
 ds_read_b128 a[204:207], v2 offset:13056
 ds_read_b64_tr_b16 a[90:91], v46 offset:1280
 v_mfma_f32_16x16x32_bf16 v[76:79], a[60:63], a[176:179], v[76:79]
 s_add_u32 m0, s29, 2048
 ds_read_b128 a[160:163], v2 offset:17408
 ds_read_b64_tr_b16 a[92:93], v46 offset:1032
 v_mfma_f32_16x16x32_bf16 v[76:79], a[76:79], a[180:183], v[76:79]
 ds_read_b64_tr_b16 a[94:95], v46 offset:1288
 buffer_load_dwordx4 v5, s[8:11], s77 offen offset:0 lds
 v_mfma_f32_16x16x32_bf16 v[72:75], a[72:75], a[180:183], v[72:75]
 s_waitcnt vmcnt(8)
 ds_read_b64_tr_b16 a[104:105], v46 offset:5120
 v_mfma_f32_16x16x32_bf16 v[72:75], a[56:59], a[176:179], v[72:75]
 ds_read_b64_tr_b16 a[106:107], v46 offset:5376
 v_mfma_f32_16x16x32_bf16 v[72:75], a[40:43], a[172:175], v[72:75]
 ds_read_b64_tr_b16 a[108:109], v46 offset:5128
 v_mfma_f32_16x16x32_bf16 v[72:75], a[24:27], a[168:171], v[72:75]
 ds_read_b64_tr_b16 a[110:111], v46 offset:5384
 v_mfma_f32_16x16x32_bf16 v[72:75], a[8:11], a[164:167], v[72:75]
 s_waitcnt vmcnt(6)
 ds_read_b64_tr_b16 a[120:121], v46 offset:9216
 v_mfma_f32_16x16x32_bf16 v[68:71], a[4:7], a[164:167], v[68:71]
 ds_read_b64_tr_b16 a[122:123], v46 offset:9472
 v_mfma_f32_16x16x32_bf16 v[68:71], a[20:23], a[168:171], v[68:71]
 ds_read_b64_tr_b16 a[124:125], v46 offset:9224
 v_mfma_f32_16x16x32_bf16 v[68:71], a[36:39], a[172:175], v[68:71]
 ds_read_b64_tr_b16 a[126:127], v46 offset:9480
 v_mfma_f32_16x16x32_bf16 v[68:71], a[52:55], a[176:179], v[68:71]
 s_waitcnt vmcnt(4)
 ds_read_b64_tr_b16 a[136:137], v46 offset:13312
 v_mfma_f32_16x16x32_bf16 v[68:71], a[68:71], a[180:183], v[68:71]
 ds_read_b64_tr_b16 a[138:139], v46 offset:13568
 v_mfma_f32_16x16x32_bf16 v[64:67], a[64:67], a[180:183], v[64:67]
 ds_read_b64_tr_b16 a[140:141], v46 offset:13320
 v_mfma_f32_16x16x32_bf16 v[64:67], a[48:51], a[176:179], v[64:67]
 s_add_u32 m0, s29, 4096
 ds_read_b64_tr_b16 a[142:143], v46 offset:13576
 v_mfma_f32_16x16x32_bf16 v[64:67], a[32:35], a[172:175], v[64:67]
 s_waitcnt vmcnt(2) lgkmcnt(11)
 ds_read_b64_tr_b16 a[152:153], v46 offset:17408
 buffer_load_dwordx4 v5, s[8:11], s78 offen offset:0 lds
 v_mfma_f32_16x16x32_bf16 v[64:67], a[16:19], a[168:171], v[64:67]
 ds_read_b64_tr_b16 a[154:155], v46 offset:17664
 v_mfma_f32_16x16x32_bf16 v[64:67], a[0:3], a[164:167], v[64:67]
 ds_read_b64_tr_b16 a[156:157], v46 offset:17416
 v_mfma_f32_16x16x32_bf16 v[80:83], a[0:3], a[168:171], v[80:83]
 ds_read_b64_tr_b16 a[158:159], v46 offset:17672
 v_mfma_f32_16x16x32_bf16 v[80:83], a[16:19], a[172:175], v[80:83]
 v_bfe_u32 v38, v36, 0, 5
 v_mad_i32_i24 v7, v38, s71, v7
 v_mfma_f32_16x16x32_bf16 v[80:83], a[32:35], a[176:179], v[80:83]
 v_add_u32 v7, s73, v7
 v_mfma_f32_16x16x32_bf16 v[80:83], a[48:51], a[180:183], v[80:83]
 ds_read_b128 a[164:167], v2 offset:21760
 v_mfma_f32_16x16x32_bf16 v[80:83], a[64:67], a[184:187], v[80:83]
 v_bfe_u32 v38, v36, 5, 5
 v_mad_i32_i24 v8, v38, s71, v8
 v_mfma_f32_16x16x32_bf16 v[84:87], a[68:71], a[184:187], v[84:87]
 v_add_u32 v8, s73, v8
 v_mfma_f32_16x16x32_bf16 v[84:87], a[52:55], a[180:183], v[84:87]
 v_bfe_u32 v38, v36, 10, 5
 v_mad_i32_i24 v9, v38, s71, v9
 v_mfma_f32_16x16x32_bf16 v[84:87], a[36:39], a[176:179], v[84:87]
 v_add_u32 v9, s73, v9
 v_mfma_f32_16x16x32_bf16 v[84:87], a[20:23], a[172:175], v[84:87]
 v_bfe_u32 v38, v36, 15, 5
 v_mad_i32_i24 v10, v38, s71, v10
 v_mfma_f32_16x16x32_bf16 v[84:87], a[4:7], a[168:171], v[84:87]
 s_add_u32 m0, s29, 6144
 v_add_u32 v10, s73, v10
 v_mfma_f32_16x16x32_bf16 v[88:91], a[8:11], a[168:171], v[88:91]
 buffer_load_dwordx4 v5, s[8:11], s79 offen offset:0 lds
 v_mfma_f32_16x16x32_bf16 v[88:91], a[24:27], a[172:175], v[88:91]
 v_bfe_u32 v38, v36, 20, 5
 v_mad_i32_i24 v11, v38, s71, v11
 v_mfma_f32_16x16x32_bf16 v[88:91], a[40:43], a[176:179], v[88:91]
 v_add_u32 v11, s73, v11
 v_mfma_f32_16x16x32_bf16 v[88:91], a[56:59], a[180:183], v[88:91]
 v_bfe_u32 v38, v36, 25, 5
 v_mad_i32_i24 v12, v38, s71, v12
 v_mfma_f32_16x16x32_bf16 v[88:91], a[72:75], a[184:187], v[88:91]
 v_add_u32 v12, s73, v12
 v_mfma_f32_16x16x32_bf16 v[92:95], a[76:79], a[184:187], v[92:95]
 v_bfe_u32 v38, v37, 0, 5
 v_mad_i32_i24 v13, v38, s71, v13
 v_mfma_f32_16x16x32_bf16 v[92:95], a[60:63], a[180:183], v[92:95]
 v_add_u32 v13, s73, v13
 v_mfma_f32_16x16x32_bf16 v[92:95], a[44:47], a[176:179], v[92:95]
 v_bfe_u32 v38, v37, 5, 5
 v_mad_i32_i24 v14, v38, s71, v14
 v_mfma_f32_16x16x32_bf16 v[92:95], a[28:31], a[172:175], v[92:95]
 v_add_u32 v14, s73, v14
 v_mfma_f32_16x16x32_bf16 v[92:95], a[12:15], a[168:171], v[92:95]
 v_bfe_u32 v38, v37, 10, 5
 v_mad_i32_i24 v15, v38, s71, v15
 v_mfma_f32_16x16x32_bf16 v[108:111], a[12:15], a[172:175], v[108:111]
 v_add_u32 v15, s73, v15
 v_mfma_f32_16x16x32_bf16 v[108:111], a[28:31], a[176:179], v[108:111]
 v_mfma_f32_16x16x32_bf16 v[108:111], a[44:47], a[180:183], v[108:111]
 s_add_u32 m0, s29, 8192
 v_mfma_f32_16x16x32_bf16 v[108:111], a[60:63], a[184:187], v[108:111]
 ds_read_b128 a[168:171], v2 offset:26112
 buffer_load_dwordx4 v5, s[8:11], s80 offen offset:0 lds
 v_mfma_f32_16x16x32_bf16 v[108:111], a[76:79], a[188:191], v[108:111]
 s_add_u32 m0, s26, 0
 v_mfma_f32_16x16x32_bf16 v[104:107], a[72:75], a[188:191], v[104:107]
 buffer_load_dwordx4 v7, s[4:7], 0 offen nt lds
 v_mfma_f32_16x16x32_bf16 v[104:107], a[56:59], a[184:187], v[104:107]
 v_mfma_f32_16x16x32_bf16 v[104:107], a[40:43], a[180:183], v[104:107]
 v_mfma_f32_16x16x32_bf16 v[104:107], a[24:27], a[176:179], v[104:107]
 v_mfma_f32_16x16x32_bf16 v[104:107], a[8:11], a[172:175], v[104:107]
 v_mfma_f32_16x16x32_bf16 v[100:103], a[4:7], a[172:175], v[100:103]
 v_mfma_f32_16x16x32_bf16 v[100:103], a[20:23], a[176:179], v[100:103]
 v_mfma_f32_16x16x32_bf16 v[100:103], a[36:39], a[180:183], v[100:103]
 v_mfma_f32_16x16x32_bf16 v[100:103], a[52:55], a[184:187], v[100:103]
 v_mfma_f32_16x16x32_bf16 v[100:103], a[68:71], a[188:191], v[100:103]
 v_mfma_f32_16x16x32_bf16 v[96:99], a[64:67], a[188:191], v[96:99]
 s_add_u32 m0, s29, 10240
 v_mfma_f32_16x16x32_bf16 v[96:99], a[48:51], a[184:187], v[96:99]
 buffer_load_dwordx4 v5, s[8:11], s81 offen offset:0 lds
 v_mfma_f32_16x16x32_bf16 v[96:99], a[32:35], a[180:183], v[96:99]
 v_mfma_f32_16x16x32_bf16 v[96:99], a[16:19], a[176:179], v[96:99]
 v_mfma_f32_16x16x32_bf16 v[96:99], a[0:3], a[172:175], v[96:99]
 v_mfma_f32_16x16x32_bf16 v[48:51], a[80:83], a[192:195], v[48:51]
 v_mfma_f32_16x16x32_bf16 v[48:51], a[96:99], a[196:199], v[48:51]
 v_mfma_f32_16x16x32_bf16 v[48:51], a[112:115], a[200:203], v[48:51]
 v_mfma_f32_16x16x32_bf16 v[48:51], a[128:131], a[204:207], v[48:51]
 ds_read_b128 a[188:191], v2 offset:30464
 v_mfma_f32_16x16x32_bf16 v[48:51], a[144:147], a[160:163], v[48:51]
 v_mfma_f32_16x16x32_bf16 v[52:55], a[148:151], a[160:163], v[52:55]
 v_mfma_f32_16x16x32_bf16 v[52:55], a[132:135], a[204:207], v[52:55]
 v_mfma_f32_16x16x32_bf16 v[52:55], a[116:119], a[200:203], v[52:55]
 v_mfma_f32_16x16x32_bf16 v[52:55], a[100:103], a[196:199], v[52:55]
 s_add_u32 m0, s29, 12288
 v_mfma_f32_16x16x32_bf16 v[52:55], a[84:87], a[192:195], v[52:55]
 buffer_load_dwordx4 v5, s[8:11], s82 offen offset:0 lds
 v_mfma_f32_16x16x32_bf16 v[56:59], a[88:91], a[192:195], v[56:59]
 s_waitcnt lgkmcnt(1)
 v_mfma_f32_16x16x32_bf16 v[56:59], a[104:107], a[196:199], v[56:59]
 v_mfma_f32_16x16x32_bf16 v[56:59], a[120:123], a[200:203], v[56:59]
 v_mfma_f32_16x16x32_bf16 v[56:59], a[136:139], a[204:207], v[56:59]
 v_mfma_f32_16x16x32_bf16 v[56:59], a[152:155], a[160:163], v[56:59]
 v_mfma_f32_16x16x32_bf16 v[60:63], a[156:159], a[160:163], v[60:63]
 v_mfma_f32_16x16x32_bf16 v[60:63], a[140:143], a[204:207], v[60:63]
 v_mfma_f32_16x16x32_bf16 v[60:63], a[124:127], a[200:203], v[60:63]
 v_mfma_f32_16x16x32_bf16 v[60:63], a[108:111], a[196:199], v[60:63]
 v_mfma_f32_16x16x32_bf16 v[60:63], a[92:95], a[192:195], v[60:63]
 ds_read_b128 a[184:187], v1 offset:17408
 v_mfma_f32_16x16x32_bf16 v[76:79], a[92:95], a[196:199], v[76:79]
 ds_read_b128 a[180:183], v1 offset:21760
 v_mfma_f32_16x16x32_bf16 v[76:79], a[108:111], a[200:203], v[76:79]
 s_add_u32 m0, s29, 14336
 ds_read_b128 a[176:179], v1 offset:26112
 v_mfma_f32_16x16x32_bf16 v[76:79], a[124:127], a[204:207], v[76:79]
 ds_read_b128 a[172:175], v1 offset:30464
 buffer_load_dwordx4 v5, s[8:11], s83 offen offset:0 lds
 v_mfma_f32_16x16x32_bf16 v[76:79], a[140:143], a[160:163], v[76:79]
 s_add_u32 m0, s26, 1024
 ds_read_b128 a[192:195], v3 offset:0
 v_mfma_f32_16x16x32_bf16 v[76:79], a[156:159], a[164:167], v[76:79]
 buffer_load_dwordx4 v8, s[4:7], 0 offen nt lds
 v_mfma_f32_16x16x32_bf16 v[72:75], a[152:155], a[164:167], v[72:75]
 v_mfma_f32_16x16x32_bf16 v[72:75], a[136:139], a[160:163], v[72:75]
 v_mfma_f32_16x16x32_bf16 v[72:75], a[120:123], a[204:207], v[72:75]
 v_mul_f32 v20, s42, v48
 v_mul_f32 v21, s42, v49
 v_mfma_f32_16x16x32_bf16 v[72:75], a[104:107], a[200:203], v[72:75]
 v_mul_f32 v22, s42, v50
 v_mul_f32 v23, s42, v51
 v_mfma_f32_16x16x32_bf16 v[72:75], a[88:91], a[196:199], v[72:75]
 v_min_f32 v20, s47, v20
 v_min_f32 v21, s47, v21
 v_mfma_f32_16x16x32_bf16 v[68:71], a[84:87], a[196:199], v[68:71]
 v_min_f32 v22, s47, v22
 v_min_f32 v23, s47, v23
 v_mfma_f32_16x16x32_bf16 v[68:71], a[100:103], a[200:203], v[68:71]
 v_exp_f32 v20, v20
 v_mfma_f32_16x16x32_bf16 v[68:71], a[116:119], a[204:207], v[68:71]
 v_mul_f32 v24, s43, v56
 v_mul_f32 v25, s43, v57
 v_mfma_f32_16x16x32_bf16 v[68:71], a[132:135], a[160:163], v[68:71]
 v_exp_f32 v21, v21
 v_mfma_f32_16x16x32_bf16 v[68:71], a[148:151], a[164:167], v[68:71]
 s_add_u32 m0, s29, 16384
 v_mul_f32 v26, s43, v58
 v_mul_f32 v27, s43, v59
 v_mfma_f32_16x16x32_bf16 v[64:67], a[144:147], a[164:167], v[64:67]
 buffer_load_dwordx4 v5, s[8:11], s84 offen offset:0 lds
 v_add_f32 v28, 1.0, v20
 v_mfma_f32_16x16x32_bf16 v[64:67], a[128:131], a[160:163], v[64:67]
 v_exp_f32 v22, v22
 v_mfma_f32_16x16x32_bf16 v[64:67], a[112:115], a[204:207], v[64:67]
 v_exp_f32 v23, v23
 v_mfma_f32_16x16x32_bf16 v[64:67], a[96:99], a[200:203], v[64:67]
 v_exp_f32 v24, v24
 v_mfma_f32_16x16x32_bf16 v[64:67], a[80:83], a[196:199], v[64:67]
 v_add_f32 v29, 1.0, v21
 v_add_f32 v30, 1.0, v22
 v_mfma_f32_16x16x32_bf16 v[80:83], a[80:83], a[200:203], v[80:83]
 v_exp_f32 v25, v25
 v_mfma_f32_16x16x32_bf16 v[80:83], a[96:99], a[204:207], v[80:83]
 v_add_f32 v31, 1.0, v23
 v_fmac_f32 v28, v28, v24
 v_mfma_f32_16x16x32_bf16 v[80:83], a[112:115], a[160:163], v[80:83]
 v_exp_f32 v26, v26
 v_mfma_f32_16x16x32_bf16 v[80:83], a[128:131], a[164:167], v[80:83]
 ds_read_b128 a[196:199], v3 offset:4352
 v_fmac_f32 v29, v29, v25
 v_mfma_f32_16x16x32_bf16 v[80:83], a[144:147], a[168:171], v[80:83]
 v_exp_f32 v27, v27
 v_mfma_f32_16x16x32_bf16 v[84:87], a[148:151], a[168:171], v[84:87]
 v_fmac_f32 v30, v30, v26
 v_fmac_f32 v31, v31, v27
 v_mfma_f32_16x16x32_bf16 v[84:87], a[132:135], a[164:167], v[84:87]
 v_rcp_f32 v28, v28
 v_mfma_f32_16x16x32_bf16 v[84:87], a[116:119], a[160:163], v[84:87]
 s_add_u32 m0, s29, 18432
 v_rcp_f32 v29, v29
 v_mfma_f32_16x16x32_bf16 v[84:87], a[100:103], a[204:207], v[84:87]
 buffer_load_dwordx4 v5, s[8:11], s85 offen offset:0 lds
 v_fma_f32 v20, v20, v28, -v28
 v_mfma_f32_16x16x32_bf16 v[84:87], a[84:87], a[200:203], v[84:87]
 v_rcp_f32 v30, v30
 v_mfma_f32_16x16x32_bf16 v[88:91], a[88:91], a[200:203], v[88:91]
 v_rcp_f32 v31, v31
 v_mfma_f32_16x16x32_bf16 v[88:91], a[104:107], a[204:207], v[88:91]
 v_fma_f32 v21, v21, v29, -v29
 v_fma_f32 v22, v22, v30, -v30
 v_mfma_f32_16x16x32_bf16 v[88:91], a[120:123], a[160:163], v[88:91]
 v_fma_f32 v23, v23, v31, -v31
 v_cvt_pk_bf16_f32 v16, v20, v21
 v_mfma_f32_16x16x32_bf16 v[88:91], a[136:139], a[164:167], v[88:91]
 v_cvt_pk_bf16_f32 v17, v22, v23
 v_mul_f32 v32, s42, v52
 v_mfma_f32_16x16x32_bf16 v[88:91], a[152:155], a[168:171], v[88:91]
 v_mul_f32 v33, s42, v53
 v_mul_f32 v34, s42, v54
 v_mfma_f32_16x16x32_bf16 v[92:95], a[156:159], a[168:171], v[92:95]
 v_mul_f32 v35, s42, v55
 v_min_f32 v32, s47, v32
 v_mfma_f32_16x16x32_bf16 v[92:95], a[140:143], a[164:167], v[92:95]
 v_min_f32 v33, s47, v33
 v_min_f32 v34, s47, v34
 v_mfma_f32_16x16x32_bf16 v[92:95], a[124:127], a[160:163], v[92:95]
 v_min_f32 v35, s47, v35
 v_mul_f32 v40, s43, v60
 v_mfma_f32_16x16x32_bf16 v[92:95], a[108:111], a[204:207], v[92:95]
 v_exp_f32 v32, v32
 v_mfma_f32_16x16x32_bf16 v[92:95], a[92:95], a[200:203], v[92:95]
 v_mul_f32 v41, s43, v61
 v_mul_f32 v42, s43, v62
 v_mfma_f32_16x16x32_bf16 v[108:111], a[92:95], a[204:207], v[108:111]
 s_add_u32 m0, s29, 0
 v_exp_f32 v33, v33
 v_mfma_f32_16x16x32_bf16 v[108:111], a[108:111], a[160:163], v[108:111]
 buffer_load_dwordx4 v5, s[8:11], s76 offen offset:1024 lds
 v_mul_f32 v43, s43, v63
 v_mfma_f32_16x16x32_bf16 v[108:111], a[124:127], a[164:167], v[108:111]
 s_add_u32 m0, s26, 2048
 v_exp_f32 v34, v34
 v_mfma_f32_16x16x32_bf16 v[108:111], a[140:143], a[168:171], v[108:111]
 s_waitcnt lgkmcnt(0)
 ds_read_b128 a[200:203], v3 offset:8704
 buffer_load_dwordx4 v9, s[4:7], 0 offen nt lds
 v_mfma_f32_16x16x32_bf16 v[108:111], a[156:159], a[188:191], v[108:111]
 v_exp_f32 v35, v35
 v_mfma_f32_16x16x32_bf16 v[104:107], a[152:155], a[188:191], v[104:107]
 v_exp_f32 v40, v40
 v_mfma_f32_16x16x32_bf16 v[104:107], a[136:139], a[168:171], v[104:107]
 v_add_f32 v28, 1.0, v32
 v_add_f32 v29, 1.0, v33
 v_mfma_f32_16x16x32_bf16 v[104:107], a[120:123], a[164:167], v[104:107]
 v_exp_f32 v41, v41
 v_mfma_f32_16x16x32_bf16 v[104:107], a[104:107], a[160:163], v[104:107]
 v_add_f32 v30, 1.0, v34
 v_add_f32 v31, 1.0, v35
 v_mfma_f32_16x16x32_bf16 v[104:107], a[88:91], a[204:207], v[104:107]
 v_exp_f32 v42, v42
 v_mfma_f32_16x16x32_bf16 v[100:103], a[84:87], a[204:207], v[100:103]
 v_exp_f32 v43, v43
 v_mfma_f32_16x16x32_bf16 v[100:103], a[100:103], a[160:163], v[100:103]
 v_fmac_f32 v28, v28, v40
 v_fmac_f32 v29, v29, v41
 v_mfma_f32_16x16x32_bf16 v[100:103], a[116:119], a[164:167], v[100:103]
 v_fmac_f32 v30, v30, v42
 v_fmac_f32 v31, v31, v43
 v_mfma_f32_16x16x32_bf16 v[100:103], a[132:135], a[168:171], v[100:103]
 s_add_u32 m0, s29, 2048
 v_rcp_f32 v28, v28
 v_mfma_f32_16x16x32_bf16 v[100:103], a[148:151], a[188:191], v[100:103]
 buffer_load_dwordx4 v5, s[8:11], s77 offen offset:1024 lds
 v_fma_f32 v32, v32, v28, -v28
 v_mfma_f32_16x16x32_bf16 v[96:99], a[144:147], a[188:191], v[96:99]
 v_rcp_f32 v29, v29
 v_mfma_f32_16x16x32_bf16 v[96:99], a[128:131], a[168:171], v[96:99]
 v_rcp_f32 v30, v30
 v_mfma_f32_16x16x32_bf16 v[96:99], a[112:115], a[164:167], v[96:99]
 v_rcp_f32 v31, v31
 v_mfma_f32_16x16x32_bf16 v[96:99], a[96:99], a[160:163], v[96:99]
 v_fma_f32 v33, v33, v29, -v29
 v_fma_f32 v34, v34, v30, -v30
 v_mfma_f32_16x16x32_bf16 v[96:99], a[80:83], a[204:207], v[96:99]
 v_fma_f32 v35, v35, v31, -v31
 v_cvt_pk_bf16_f32 v18, v32, v33
 v_mfma_f32_16x16x32_bf16 v[112:115], a[0:3], a[184:187], v[112:115]
 s_add_u32 s46, s40, 0
 v_cvt_pk_bf16_f32 v19, v34, v35
 buffer_store_dwordx4 v[16:19], v6, s[12:15], s46 offen
 v_mfma_f32_16x16x32_bf16 v[112:115], a[16:19], a[180:183], v[112:115]
 v_mul_f32 v20, s42, v64
 v_mul_f32 v21, s42, v65
 v_mfma_f32_16x16x32_bf16 v[112:115], a[32:35], a[176:179], v[112:115]
 v_mul_f32 v22, s42, v66
 v_mul_f32 v23, s42, v67
 v_mfma_f32_16x16x32_bf16 v[112:115], a[48:51], a[172:175], v[112:115]
 ds_read_b128 a[188:191], v3 offset:13056
 v_min_f32 v20, s47, v20
 v_mfma_f32_16x16x32_bf16 v[112:115], a[64:67], a[192:195], v[112:115]
 v_min_f32 v21, s47, v21
 v_min_f32 v22, s47, v22
 v_mfma_f32_16x16x32_bf16 v[116:119], a[68:71], a[192:195], v[116:119]
 v_min_f32 v23, s47, v23
 v_mul_f32 v24, s43, v72
 v_mfma_f32_16x16x32_bf16 v[116:119], a[52:55], a[172:175], v[116:119]
 s_add_u32 m0, s29, 4096
 v_exp_f32 v20, v20
 v_mfma_f32_16x16x32_bf16 v[116:119], a[36:39], a[176:179], v[116:119]
 buffer_load_dwordx4 v5, s[8:11], s78 offen offset:1024 lds
 v_mul_f32 v25, s43, v73
 v_mfma_f32_16x16x32_bf16 v[116:119], a[20:23], a[180:183], v[116:119]
 v_exp_f32 v21, v21
 v_mfma_f32_16x16x32_bf16 v[116:119], a[4:7], a[184:187], v[116:119]
 v_mul_f32 v26, s43, v74
 v_mul_f32 v27, s43, v75
 v_mfma_f32_16x16x32_bf16 v[120:123], a[8:11], a[184:187], v[120:123]
 v_exp_f32 v22, v22
 v_mfma_f32_16x16x32_bf16 v[120:123], a[24:27], a[180:183], v[120:123]
 v_exp_f32 v23, v23
 v_mfma_f32_16x16x32_bf16 v[120:123], a[40:43], a[176:179], v[120:123]
 v_exp_f32 v24, v24
 v_mfma_f32_16x16x32_bf16 v[120:123], a[56:59], a[172:175], v[120:123]
 v_add_f32 v28, 1.0, v20
 v_add_f32 v29, 1.0, v21
 v_mfma_f32_16x16x32_bf16 v[120:123], a[72:75], a[192:195], v[120:123]
 v_exp_f32 v25, v25
 v_mfma_f32_16x16x32_bf16 v[124:127], a[76:79], a[192:195], v[124:127]
 v_add_f32 v30, 1.0, v22
 v_add_f32 v31, 1.0, v23
 v_mfma_f32_16x16x32_bf16 v[124:127], a[60:63], a[172:175], v[124:127]
 v_exp_f32 v26, v26
 v_mfma_f32_16x16x32_bf16 v[124:127], a[44:47], a[176:179], v[124:127]
 v_exp_f32 v27, v27
 v_mfma_f32_16x16x32_bf16 v[124:127], a[28:31], a[180:183], v[124:127]
 v_fmac_f32 v28, v28, v24
 v_fmac_f32 v29, v29, v25
 v_mfma_f32_16x16x32_bf16 v[124:127], a[12:15], a[184:187], v[124:127]
 s_add_u32 m0, s29, 6144
 ds_read_b128 a[168:171], v2 offset:17408
 v_fmac_f32 v30, v30, v26
 v_mfma_f32_16x16x32_bf16 v[140:143], a[12:15], a[180:183], v[140:143]
 ds_read_b128 a[164:167], v2 offset:21760
 buffer_load_dwordx4 v5, s[8:11], s79 offen offset:1024 lds
 v_mfma_f32_16x16x32_bf16 v[140:143], a[28:31], a[176:179], v[140:143]
 s_add_u32 m0, s26, 3072
 ds_read_b128 a[160:163], v2 offset:26112
 v_fmac_f32 v31, v31, v27
 v_mfma_f32_16x16x32_bf16 v[140:143], a[44:47], a[172:175], v[140:143]
 ds_read_b128 a[204:207], v2 offset:30464
 buffer_load_dwordx4 v10, s[4:7], 0 offen nt lds
 v_mfma_f32_16x16x32_bf16 v[140:143], a[60:63], a[192:195], v[140:143]
 ds_read_b128 a[184:187], v4 offset:0
 v_mul_f32 v32, s42, v68
 v_mfma_f32_16x16x32_bf16 v[140:143], a[76:79], a[196:199], v[140:143]
 v_rcp_f32 v28, v28
 v_mfma_f32_16x16x32_bf16 v[136:139], a[72:75], a[196:199], v[136:139]
 v_rcp_f32 v29, v29
 v_mfma_f32_16x16x32_bf16 v[136:139], a[56:59], a[192:195], v[136:139]
 v_rcp_f32 v30, v30
 v_mfma_f32_16x16x32_bf16 v[136:139], a[40:43], a[172:175], v[136:139]
 v_rcp_f32 v31, v31
 v_mfma_f32_16x16x32_bf16 v[136:139], a[24:27], a[176:179], v[136:139]
 v_fma_f32 v20, v20, v28, -v28
 v_fma_f32 v21, v21, v29, -v29
 v_mfma_f32_16x16x32_bf16 v[136:139], a[8:11], a[180:183], v[136:139]
 v_fma_f32 v22, v22, v30, -v30
 v_fma_f32 v23, v23, v31, -v31
 v_mfma_f32_16x16x32_bf16 v[132:135], a[4:7], a[180:183], v[132:135]
 v_cvt_pk_bf16_f32 v16, v20, v21
 v_cvt_pk_bf16_f32 v17, v22, v23
 v_mfma_f32_16x16x32_bf16 v[132:135], a[20:23], a[176:179], v[132:135]
 v_mul_f32 v33, s42, v69
 v_mul_f32 v34, s42, v70
 v_mfma_f32_16x16x32_bf16 v[132:135], a[36:39], a[172:175], v[132:135]
 s_add_u32 m0, s29, 8192
 v_mul_f32 v35, s42, v71
 v_min_f32 v32, s47, v32
 v_mfma_f32_16x16x32_bf16 v[132:135], a[52:55], a[192:195], v[132:135]
 buffer_load_dwordx4 v5, s[8:11], s80 offen offset:1024 lds
 v_min_f32 v33, s47, v33
 v_mfma_f32_16x16x32_bf16 v[132:135], a[68:71], a[196:199], v[132:135]
 v_min_f32 v34, s47, v34
 v_min_f32 v35, s47, v35
 v_mfma_f32_16x16x32_bf16 v[128:131], a[64:67], a[196:199], v[128:131]
 v_exp_f32 v32, v32
 v_mfma_f32_16x16x32_bf16 v[128:131], a[48:51], a[192:195], v[128:131]
 v_mul_f32 v40, s43, v76
 v_mul_f32 v41, s43, v77
 v_mfma_f32_16x16x32_bf16 v[128:131], a[32:35], a[172:175], v[128:131]
 v_exp_f32 v33, v33
 v_mfma_f32_16x16x32_bf16 v[128:131], a[16:19], a[176:179], v[128:131]
 v_mul_f32 v42, s43, v78
 v_mul_f32 v43, s43, v79
 v_mfma_f32_16x16x32_bf16 v[128:131], a[0:3], a[180:183], v[128:131]
 v_exp_f32 v34, v34
 v_mfma_f32_16x16x32_bf16 v[144:147], a[0:3], a[176:179], v[144:147]
 v_exp_f32 v35, v35
 v_mfma_f32_16x16x32_bf16 v[144:147], a[16:19], a[172:175], v[144:147]
 v_exp_f32 v40, v40
 v_mfma_f32_16x16x32_bf16 v[144:147], a[32:35], a[192:195], v[144:147]
 v_add_f32 v28, 1.0, v32
 v_add_f32 v29, 1.0, v33
 v_mfma_f32_16x16x32_bf16 v[144:147], a[48:51], a[196:199], v[144:147]
 s_waitcnt lgkmcnt(0)
 ds_read_b128 a[180:183], v4 offset:4352
 v_add_f32 v30, 1.0, v34
 v_mfma_f32_16x16x32_bf16 v[144:147], a[64:67], a[200:203], v[144:147]
 v_exp_f32 v41, v41
 v_mfma_f32_16x16x32_bf16 v[148:151], a[68:71], a[200:203], v[148:151]
 s_add_u32 m0, s29, 10240
 v_add_f32 v31, 1.0, v35
 v_fmac_f32 v28, v28, v40
 v_mfma_f32_16x16x32_bf16 v[148:151], a[52:55], a[196:199], v[148:151]
 buffer_load_dwordx4 v5, s[8:11], s81 offen offset:1024 lds
 v_fmac_f32 v29, v29, v41
 v_mfma_f32_16x16x32_bf16 v[148:151], a[36:39], a[192:195], v[148:151]
 v_exp_f32 v42, v42
 v_mfma_f32_16x16x32_bf16 v[148:151], a[20:23], a[172:175], v[148:151]
 v_exp_f32 v43, v43
 v_mfma_f32_16x16x32_bf16 v[148:151], a[4:7], a[176:179], v[148:151]
 v_fmac_f32 v30, v30, v42
 v_fmac_f32 v31, v31, v43
 v_mfma_f32_16x16x32_bf16 v[152:155], a[8:11], a[176:179], v[152:155]
 v_rcp_f32 v28, v28
 v_mfma_f32_16x16x32_bf16 v[152:155], a[24:27], a[172:175], v[152:155]
 v_rcp_f32 v29, v29
 v_mfma_f32_16x16x32_bf16 v[152:155], a[40:43], a[192:195], v[152:155]
 v_rcp_f32 v30, v30
 v_mfma_f32_16x16x32_bf16 v[152:155], a[56:59], a[196:199], v[152:155]
 v_rcp_f32 v31, v31
 v_mfma_f32_16x16x32_bf16 v[152:155], a[72:75], a[200:203], v[152:155]
 v_fma_f32 v32, v32, v28, -v28
 v_fma_f32 v33, v33, v29, -v29
 v_mfma_f32_16x16x32_bf16 v[156:159], a[76:79], a[200:203], v[156:159]
 v_fma_f32 v34, v34, v30, -v30
 v_fma_f32 v35, v35, v31, -v31
 v_mfma_f32_16x16x32_bf16 v[156:159], a[60:63], a[196:199], v[156:159]
 v_cvt_pk_bf16_f32 v18, v32, v33
 v_cvt_pk_bf16_f32 v19, v34, v35
 v_mfma_f32_16x16x32_bf16 v[156:159], a[44:47], a[192:195], v[156:159]
 s_add_u32 s46, s40, 2048
 buffer_store_dwordx4 v[16:19], v6, s[12:15], s46 offen
 v_mul_f32 v20, s42, v80
 v_mfma_f32_16x16x32_bf16 v[156:159], a[28:31], a[172:175], v[156:159]
 s_add_u32 m0, s29, 12288
 v_mul_f32 v21, s42, v81
 v_mul_f32 v22, s42, v82
 v_mfma_f32_16x16x32_bf16 v[156:159], a[12:15], a[176:179], v[156:159]
 buffer_load_dwordx4 v5, s[8:11], s82 offen offset:1024 lds
 v_mul_f32 v23, s42, v83
 v_mfma_f32_16x16x32_bf16 v[172:175], a[12:15], a[172:175], v[172:175]
 s_add_u32 m0, s26, 4096
 v_min_f32 v20, s47, v20
 v_min_f32 v21, s47, v21
 v_mfma_f32_16x16x32_bf16 v[172:175], a[28:31], a[192:195], v[172:175]
 buffer_load_dwordx4 v11, s[4:7], 0 offen nt lds
 v_min_f32 v22, s47, v22
 v_mfma_f32_16x16x32_bf16 v[172:175], a[44:47], a[196:199], v[172:175]
 v_min_f32 v23, s47, v23
 v_mul_f32 v24, s43, v88
 v_mfma_f32_16x16x32_bf16 v[172:175], a[60:63], a[200:203], v[172:175]
 ds_read_b128 a[176:179], v4 offset:8704
 v_mul_f32 v25, s43, v89
 v_mfma_f32_16x16x32_bf16 v[172:175], a[76:79], a[188:191], v[172:175]
 v_exp_f32 v20, v20
 v_mfma_f32_16x16x32_bf16 v[168:171], a[72:75], a[188:191], v[168:171]
 v_exp_f32 v21, v21
 v_mfma_f32_16x16x32_bf16 v[168:171], a[56:59], a[200:203], v[168:171]
 v_mul_f32 v26, s43, v90
 v_mul_f32 v27, s43, v91
 v_mfma_f32_16x16x32_bf16 v[168:171], a[40:43], a[196:199], v[168:171]
 v_exp_f32 v22, v22
 v_mfma_f32_16x16x32_bf16 v[168:171], a[24:27], a[192:195], v[168:171]
 v_exp_f32 v23, v23
 v_mfma_f32_16x16x32_bf16 v[168:171], a[8:11], a[172:175], v[168:171]
 v_exp_f32 v24, v24
 v_mfma_f32_16x16x32_bf16 v[164:167], a[4:7], a[172:175], v[164:167]
 v_add_f32 v28, 1.0, v20
 v_add_f32 v29, 1.0, v21
 v_mfma_f32_16x16x32_bf16 v[164:167], a[20:23], a[192:195], v[164:167]
 s_add_u32 m0, s29, 14336
 v_exp_f32 v25, v25
 v_mfma_f32_16x16x32_bf16 v[164:167], a[36:39], a[196:199], v[164:167]
 buffer_load_dwordx4 v5, s[8:11], s83 offen offset:1024 lds
 v_add_f32 v30, 1.0, v22
 v_mfma_f32_16x16x32_bf16 v[164:167], a[52:55], a[200:203], v[164:167]
 v_add_f32 v31, 1.0, v23
 v_fmac_f32 v28, v28, v24
 v_mfma_f32_16x16x32_bf16 v[164:167], a[68:71], a[188:191], v[164:167]
 v_exp_f32 v26, v26
 v_mfma_f32_16x16x32_bf16 v[160:163], a[64:67], a[188:191], v[160:163]
 v_exp_f32 v27, v27
 v_mfma_f32_16x16x32_bf16 v[160:163], a[48:51], a[200:203], v[160:163]
 v_fmac_f32 v29, v29, v25
 v_fmac_f32 v30, v30, v26
 v_mfma_f32_16x16x32_bf16 v[160:163], a[32:35], a[196:199], v[160:163]
 v_fmac_f32 v31, v31, v27
 v_mul_f32 v32, s42, v84
 v_mfma_f32_16x16x32_bf16 v[160:163], a[16:19], a[192:195], v[160:163]
 v_rcp_f32 v28, v28
 v_mfma_f32_16x16x32_bf16 v[160:163], a[0:3], a[172:175], v[160:163]
 v_rcp_f32 v29, v29
 v_mfma_f32_16x16x32_bf16 v[112:115], a[80:83], a[168:171], v[112:115]
 v_rcp_f32 v30, v30
 v_mfma_f32_16x16x32_bf16 v[112:115], a[96:99], a[164:167], v[112:115]
 v_rcp_f32 v31, v31
 v_mfma_f32_16x16x32_bf16 v[112:115], a[112:115], a[160:163], v[112:115]
 v_fma_f32 v20, v20, v28, -v28
 v_fma_f32 v21, v21, v29, -v29
 v_mfma_f32_16x16x32_bf16 v[112:115], a[128:131], a[204:207], v[112:115]
 ds_read_b128 a[188:191], v4 offset:13056
 v_fma_f32 v22, v22, v30, -v30
 v_mfma_f32_16x16x32_bf16 v[112:115], a[144:147], a[184:187], v[112:115]
 s_add_u32 m0, s29, 16384
 v_fma_f32 v23, v23, v31, -v31
 v_cvt_pk_bf16_f32 v16, v20, v21
 v_mfma_f32_16x16x32_bf16 v[116:119], a[148:151], a[184:187], v[116:119]
 buffer_load_dwordx4 v5, s[8:11], s84 offen offset:1024 lds
 v_cvt_pk_bf16_f32 v17, v22, v23
 v_mfma_f32_16x16x32_bf16 v[116:119], a[132:135], a[204:207], v[116:119]
 v_mul_f32 v33, s42, v85
 v_mul_f32 v34, s42, v86
 v_mfma_f32_16x16x32_bf16 v[116:119], a[116:119], a[160:163], v[116:119]
 v_mul_f32 v35, s42, v87
 v_min_f32 v32, s47, v32
 v_mfma_f32_16x16x32_bf16 v[116:119], a[100:103], a[164:167], v[116:119]
 v_min_f32 v33, s47, v33
 v_min_f32 v34, s47, v34
 v_mfma_f32_16x16x32_bf16 v[116:119], a[84:87], a[168:171], v[116:119]
 v_min_f32 v35, s47, v35
 v_mul_f32 v40, s43, v92
 v_mfma_f32_16x16x32_bf16 v[120:123], a[88:91], a[168:171], v[120:123]
 v_exp_f32 v32, v32
 v_mfma_f32_16x16x32_bf16 v[120:123], a[104:107], a[164:167], v[120:123]
 v_mul_f32 v41, s43, v93
 v_mul_f32 v42, s43, v94
 v_mfma_f32_16x16x32_bf16 v[120:123], a[120:123], a[160:163], v[120:123]
 v_exp_f32 v33, v33
 v_mfma_f32_16x16x32_bf16 v[120:123], a[136:139], a[204:207], v[120:123]
 v_mul_f32 v43, s43, v95
 v_add_f32 v28, 1.0, v32
 v_mfma_f32_16x16x32_bf16 v[120:123], a[152:155], a[184:187], v[120:123]
 v_exp_f32 v34, v34
 v_mfma_f32_16x16x32_bf16 v[124:127], a[156:159], a[184:187], v[124:127]
 v_exp_f32 v35, v35
 v_mfma_f32_16x16x32_bf16 v[124:127], a[140:143], a[204:207], v[124:127]
 v_exp_f32 v40, v40
 v_mfma_f32_16x16x32_bf16 v[124:127], a[124:127], a[160:163], v[124:127]
 s_add_u32 m0, s29, 18432
 v_add_f32 v29, 1.0, v33
 v_add_f32 v30, 1.0, v34
 v_mfma_f32_16x16x32_bf16 v[124:127], a[108:111], a[164:167], v[124:127]
 buffer_load_dwordx4 v5, s[8:11], s85 offen offset:1024 lds
 v_add_f32 v31, 1.0, v35
 v_mfma_f32_16x16x32_bf16 v[124:127], a[92:95], a[168:171], v[124:127]
 s_add_u32 s8, s8, 0x10000
 s_addc_u32 s9, s9, 0
 ds_read_b128 a[200:203], v1 offset:2176
 v_mfma_f32_16x16x32_bf16 v[140:143], a[92:95], a[164:167], v[140:143]
 s_add_u32 m0, s26, 5120
 ds_read_b128 a[196:199], v1 offset:6528
 v_fmac_f32 v28, v28, v40
 v_mfma_f32_16x16x32_bf16 v[140:143], a[108:111], a[160:163], v[140:143]
 ds_read_b128 a[192:195], v1 offset:10880
 buffer_load_dwordx4 v12, s[4:7], 0 offen nt lds
 v_mfma_f32_16x16x32_bf16 v[140:143], a[124:127], a[204:207], v[140:143]
 ds_read_b128 a[172:175], v1 offset:15232
 v_mul_f32 v20, s42, v96
 v_mfma_f32_16x16x32_bf16 v[140:143], a[140:143], a[184:187], v[140:143]
 s_waitcnt lgkmcnt(4)
 ds_read_b128 a[168:171], v1 offset:19584
 v_mul_f32 v21, s42, v97
 v_mfma_f32_16x16x32_bf16 v[140:143], a[156:159], a[180:183], v[140:143]
 v_exp_f32 v41, v41
 v_mfma_f32_16x16x32_bf16 v[136:139], a[152:155], a[180:183], v[136:139]
 v_exp_f32 v42, v42
 v_mfma_f32_16x16x32_bf16 v[136:139], a[136:139], a[184:187], v[136:139]
 v_exp_f32 v43, v43
 v_mfma_f32_16x16x32_bf16 v[136:139], a[120:123], a[204:207], v[136:139]
 v_fmac_f32 v29, v29, v41
 v_fmac_f32 v30, v30, v42
 v_mfma_f32_16x16x32_bf16 v[136:139], a[104:107], a[160:163], v[136:139]
 v_fmac_f32 v31, v31, v43
 v_mul_f32 v22, s42, v98
 v_mfma_f32_16x16x32_bf16 v[136:139], a[88:91], a[164:167], v[136:139]
 global_load_dword v44, v47, s[88:89]
 v_mul_f32 v23, s42, v99
 v_mfma_f32_16x16x32_bf16 v[132:135], a[84:87], a[164:167], v[132:135]
 v_rcp_f32 v28, v28
 v_mfma_f32_16x16x32_bf16 v[132:135], a[100:103], a[160:163], v[132:135]
 v_rcp_f32 v29, v29
 v_mfma_f32_16x16x32_bf16 v[132:135], a[116:119], a[204:207], v[132:135]
 v_rcp_f32 v30, v30
 v_mfma_f32_16x16x32_bf16 v[132:135], a[132:135], a[184:187], v[132:135]
 v_rcp_f32 v31, v31
 v_mfma_f32_16x16x32_bf16 v[132:135], a[148:151], a[180:183], v[132:135]
 v_fma_f32 v32, v32, v28, -v28
 v_fma_f32 v33, v33, v29, -v29
 v_mfma_f32_16x16x32_bf16 v[128:131], a[144:147], a[180:183], v[128:131]
 v_fma_f32 v34, v34, v30, -v30
 v_fma_f32 v35, v35, v31, -v31
 v_mfma_f32_16x16x32_bf16 v[128:131], a[128:131], a[184:187], v[128:131]
 v_cvt_pk_bf16_f32 v18, v32, v33
 v_cvt_pk_bf16_f32 v19, v34, v35
 v_mfma_f32_16x16x32_bf16 v[128:131], a[112:115], a[204:207], v[128:131]
 s_add_u32 s46, s40, 4096
 buffer_store_dwordx4 v[16:19], v6, s[12:15], s46 offen
 v_min_f32 v20, s47, v20
 v_mfma_f32_16x16x32_bf16 v[128:131], a[96:99], a[160:163], v[128:131]
 v_min_f32 v21, s47, v21
 v_min_f32 v22, s47, v22
 v_mfma_f32_16x16x32_bf16 v[128:131], a[80:83], a[164:167], v[128:131]
 v_min_f32 v23, s47, v23
 v_mul_f32 v24, s43, v104
 v_mfma_f32_16x16x32_bf16 v[144:147], a[80:83], a[160:163], v[144:147]
 v_exp_f32 v20, v20
 v_mfma_f32_16x16x32_bf16 v[144:147], a[96:99], a[204:207], v[144:147]
 v_mul_f32 v25, s43, v105
 v_mul_f32 v26, s43, v106
 v_mfma_f32_16x16x32_bf16 v[144:147], a[112:115], a[184:187], v[144:147]
 v_exp_f32 v21, v21
 v_mfma_f32_16x16x32_bf16 v[144:147], a[128:131], a[180:183], v[144:147]
 ds_read_b128 a[164:167], v1 offset:23936
 v_mul_f32 v27, s43, v107
 v_mfma_f32_16x16x32_bf16 v[144:147], a[144:147], a[176:179], v[144:147]
 v_exp_f32 v22, v22
 v_mfma_f32_16x16x32_bf16 v[148:151], a[148:151], a[176:179], v[148:151]
 v_exp_f32 v23, v23
 v_mfma_f32_16x16x32_bf16 v[148:151], a[132:135], a[180:183], v[148:151]
 v_exp_f32 v24, v24
 v_mfma_f32_16x16x32_bf16 v[148:151], a[116:119], a[184:187], v[148:151]
 v_add_f32 v28, 1.0, v20
 v_add_f32 v29, 1.0, v21
 v_mfma_f32_16x16x32_bf16 v[148:151], a[100:103], a[204:207], v[148:151]
 v_exp_f32 v25, v25
 v_mfma_f32_16x16x32_bf16 v[148:151], a[84:87], a[160:163], v[148:151]
 v_add_f32 v30, 1.0, v22
 v_add_f32 v31, 1.0, v23
 v_mfma_f32_16x16x32_bf16 v[152:155], a[88:91], a[160:163], v[152:155]
 v_exp_f32 v26, v26
 v_mfma_f32_16x16x32_bf16 v[152:155], a[104:107], a[204:207], v[152:155]
 v_exp_f32 v27, v27
 v_mfma_f32_16x16x32_bf16 v[152:155], a[120:123], a[184:187], v[152:155]
 v_fmac_f32 v28, v28, v24
 v_fmac_f32 v29, v29, v25
 v_mfma_f32_16x16x32_bf16 v[152:155], a[136:139], a[180:183], v[152:155]
 v_fmac_f32 v30, v30, v26
 v_fmac_f32 v31, v31, v27
 v_mfma_f32_16x16x32_bf16 v[152:155], a[152:155], a[176:179], v[152:155]
 v_rcp_f32 v28, v28
 v_mfma_f32_16x16x32_bf16 v[156:159], a[156:159], a[176:179], v[156:159]
 v_rcp_f32 v29, v29
 v_mfma_f32_16x16x32_bf16 v[156:159], a[140:143], a[180:183], v[156:159]
 v_rcp_f32 v30, v30
 v_mfma_f32_16x16x32_bf16 v[156:159], a[124:127], a[184:187], v[156:159]
 s_add_u32 m0, s26, 6144
 v_rcp_f32 v31, v31
 v_mfma_f32_16x16x32_bf16 v[156:159], a[108:111], a[204:207], v[156:159]
 buffer_load_dwordx4 v13, s[4:7], 0 offen nt lds
 v_fma_f32 v20, v20, v28, -v28
 v_mfma_f32_16x16x32_bf16 v[156:159], a[92:95], a[160:163], v[156:159]
 v_fma_f32 v21, v21, v29, -v29
 v_fma_f32 v22, v22, v30, -v30
 v_mfma_f32_16x16x32_bf16 v[172:175], a[92:95], a[204:207], v[172:175]
 v_fma_f32 v23, v23, v31, -v31
 v_cvt_pk_bf16_f32 v16, v20, v21
 v_mfma_f32_16x16x32_bf16 v[172:175], a[108:111], a[184:187], v[172:175]
 v_cvt_pk_bf16_f32 v17, v22, v23
 v_mul_f32 v32, s42, v100
 v_mfma_f32_16x16x32_bf16 v[172:175], a[124:127], a[180:183], v[172:175]
 v_mul_f32 v33, s42, v101
 v_mul_f32 v34, s42, v102
 v_mfma_f32_16x16x32_bf16 v[172:175], a[140:143], a[176:179], v[172:175]
 ds_read_b128 a[160:163], v1 offset:28288
 v_mul_f32 v35, s42, v103
 v_mfma_f32_16x16x32_bf16 v[172:175], a[156:159], a[188:191], v[172:175]
 v_min_f32 v32, s47, v32
 v_min_f32 v33, s47, v33
 v_mfma_f32_16x16x32_bf16 v[168:171], a[152:155], a[188:191], v[168:171]
 v_min_f32 v34, s47, v34
 v_min_f32 v35, s47, v35
 v_mfma_f32_16x16x32_bf16 v[168:171], a[136:139], a[176:179], v[168:171]
 v_exp_f32 v32, v32
 v_mfma_f32_16x16x32_bf16 v[168:171], a[120:123], a[180:183], v[168:171]
 v_mul_f32 v40, s43, v108
 v_mul_f32 v41, s43, v109
 v_mfma_f32_16x16x32_bf16 v[168:171], a[104:107], a[184:187], v[168:171]
 v_exp_f32 v33, v33
 v_mfma_f32_16x16x32_bf16 v[168:171], a[88:91], a[204:207], v[168:171]
 v_mul_f32 v42, s43, v110
 v_mul_f32 v43, s43, v111
 v_mfma_f32_16x16x32_bf16 v[164:167], a[84:87], a[204:207], v[164:167]
 v_exp_f32 v34, v34
 v_mfma_f32_16x16x32_bf16 v[164:167], a[100:103], a[184:187], v[164:167]
 v_exp_f32 v35, v35
 v_mfma_f32_16x16x32_bf16 v[164:167], a[116:119], a[180:183], v[164:167]
 v_exp_f32 v40, v40
 v_mfma_f32_16x16x32_bf16 v[164:167], a[132:135], a[176:179], v[164:167]
 v_add_f32 v28, 1.0, v32
 v_add_f32 v29, 1.0, v33
 v_mfma_f32_16x16x32_bf16 v[164:167], a[148:151], a[188:191], v[164:167]
 v_exp_f32 v41, v41
 v_mfma_f32_16x16x32_bf16 v[160:163], a[144:147], a[188:191], v[160:163]
 v_add_f32 v30, 1.0, v34
 v_add_f32 v31, 1.0, v35
 v_mfma_f32_16x16x32_bf16 v[160:163], a[128:131], a[176:179], v[160:163]
 v_exp_f32 v42, v42
 v_mfma_f32_16x16x32_bf16 v[160:163], a[112:115], a[180:183], v[160:163]
 v_exp_f32 v43, v43
 v_mfma_f32_16x16x32_bf16 v[160:163], a[96:99], a[184:187], v[160:163]
 v_fmac_f32 v28, v28, v40
 v_fmac_f32 v29, v29, v41
 v_mfma_f32_16x16x32_bf16 v[160:163], a[80:83], a[204:207], v[160:163]
 s_waitcnt lgkmcnt(0)
 v_fmac_f32 v30, v30, v42
 v_fmac_f32 v31, v31, v43
 v_mfma_f32_16x16x32_bf16 v[176:179], a[0:3], a[200:203], v[176:179]
 v_rcp_f32 v28, v28
 v_mfma_f32_16x16x32_bf16 v[176:179], a[16:19], a[196:199], v[176:179]
 v_rcp_f32 v29, v29
 v_mfma_f32_16x16x32_bf16 v[176:179], a[32:35], a[192:195], v[176:179]
 v_rcp_f32 v30, v30
 v_mfma_f32_16x16x32_bf16 v[176:179], a[48:51], a[172:175], v[176:179]
 ds_read_b128 a[188:191], v1 offset:32640
 v_fma_f32 v32, v32, v28, -v28
 v_mfma_f32_16x16x32_bf16 v[176:179], a[64:67], a[168:171], v[176:179]
 v_rcp_f32 v31, v31
 v_mfma_f32_16x16x32_bf16 v[180:183], a[68:71], a[168:171], v[180:183]
 v_fma_f32 v33, v33, v29, -v29
 v_fma_f32 v34, v34, v30, -v30
 v_mfma_f32_16x16x32_bf16 v[180:183], a[52:55], a[172:175], v[180:183]
 v_fma_f32 v35, v35, v31, -v31
 v_cvt_pk_bf16_f32 v18, v32, v33
 v_mfma_f32_16x16x32_bf16 v[180:183], a[36:39], a[192:195], v[180:183]
 s_add_u32 s46, s40, 6144
 v_cvt_pk_bf16_f32 v19, v34, v35
 buffer_store_dwordx4 v[16:19], v6, s[12:15], s46 offen
 v_mfma_f32_16x16x32_bf16 v[180:183], a[20:23], a[196:199], v[180:183]
 v_mul_f32 v20, s42, v112
 v_mul_f32 v21, s42, v113
 v_mfma_f32_16x16x32_bf16 v[180:183], a[4:7], a[200:203], v[180:183]
 v_mul_f32 v22, s42, v114
 v_mul_f32 v23, s42, v115
 v_mfma_f32_16x16x32_bf16 v[184:187], a[8:11], a[200:203], v[184:187]
 v_min_f32 v20, s47, v20
 v_min_f32 v21, s47, v21
 v_mfma_f32_16x16x32_bf16 v[184:187], a[24:27], a[196:199], v[184:187]
 v_min_f32 v22, s47, v22
 v_min_f32 v23, s47, v23
 v_mfma_f32_16x16x32_bf16 v[184:187], a[40:43], a[192:195], v[184:187]
 v_exp_f32 v20, v20
 v_mfma_f32_16x16x32_bf16 v[184:187], a[56:59], a[172:175], v[184:187]
 v_mul_f32 v24, s43, v120
 v_mul_f32 v25, s43, v121
 v_mfma_f32_16x16x32_bf16 v[184:187], a[72:75], a[168:171], v[184:187]
 s_add_u32 m0, s26, 7168
 v_exp_f32 v21, v21
 v_mfma_f32_16x16x32_bf16 v[188:191], a[76:79], a[168:171], v[188:191]
 buffer_load_dwordx4 v14, s[4:7], 0 offen nt lds
 v_mul_f32 v26, s43, v122
 v_mfma_f32_16x16x32_bf16 v[188:191], a[60:63], a[172:175], v[188:191]
 v_mul_f32 v27, s43, v123
 v_add_f32 v28, 1.0, v20
 v_mfma_f32_16x16x32_bf16 v[188:191], a[44:47], a[192:195], v[188:191]
 v_exp_f32 v22, v22
 v_mfma_f32_16x16x32_bf16 v[188:191], a[28:31], a[196:199], v[188:191]
 v_exp_f32 v23, v23
 v_mfma_f32_16x16x32_bf16 v[188:191], a[12:15], a[200:203], v[188:191]
 v_exp_f32 v24, v24
 v_mfma_f32_16x16x32_bf16 v[204:207], a[12:15], a[196:199], v[204:207]
 v_add_f32 v29, 1.0, v21
 v_add_f32 v30, 1.0, v22
 v_mfma_f32_16x16x32_bf16 v[204:207], a[28:31], a[192:195], v[204:207]
 v_exp_f32 v25, v25
 v_mfma_f32_16x16x32_bf16 v[204:207], a[44:47], a[172:175], v[204:207]
 v_add_f32 v31, 1.0, v23
 v_fmac_f32 v28, v28, v24
 v_mfma_f32_16x16x32_bf16 v[204:207], a[60:63], a[168:171], v[204:207]
 ds_read_b128 a[176:179], v3 offset:2176
 v_fmac_f32 v29, v29, v25
 v_mfma_f32_16x16x32_bf16 v[204:207], a[76:79], a[164:167], v[204:207]
 v_exp_f32 v26, v26
 v_mfma_f32_16x16x32_bf16 v[200:203], a[72:75], a[164:167], v[200:203]
 v_exp_f32 v27, v27
 v_mfma_f32_16x16x32_bf16 v[200:203], a[56:59], a[168:171], v[200:203]
 v_fmac_f32 v30, v30, v26
 v_fmac_f32 v31, v31, v27
 v_mfma_f32_16x16x32_bf16 v[200:203], a[40:43], a[172:175], v[200:203]
 v_rcp_f32 v28, v28
 v_mfma_f32_16x16x32_bf16 v[200:203], a[24:27], a[192:195], v[200:203]
 v_rcp_f32 v29, v29
 v_mfma_f32_16x16x32_bf16 v[200:203], a[8:11], a[196:199], v[200:203]
 v_rcp_f32 v30, v30
 v_mfma_f32_16x16x32_bf16 v[196:199], a[4:7], a[196:199], v[196:199]
 v_rcp_f32 v31, v31
 v_mfma_f32_16x16x32_bf16 v[196:199], a[20:23], a[192:195], v[196:199]
 v_fma_f32 v20, v20, v28, -v28
 v_fma_f32 v21, v21, v29, -v29
 v_mfma_f32_16x16x32_bf16 v[196:199], a[36:39], a[172:175], v[196:199]
 v_fma_f32 v22, v22, v30, -v30
 v_fma_f32 v23, v23, v31, -v31
 v_mfma_f32_16x16x32_bf16 v[196:199], a[52:55], a[168:171], v[196:199]
 v_cvt_pk_bf16_f32 v16, v20, v21
 v_cvt_pk_bf16_f32 v17, v22, v23
 v_mfma_f32_16x16x32_bf16 v[196:199], a[68:71], a[164:167], v[196:199]
 v_mul_f32 v32, s42, v116
 v_mul_f32 v33, s42, v117
 v_mfma_f32_16x16x32_bf16 v[192:195], a[64:67], a[164:167], v[192:195]
 v_mul_f32 v34, s42, v118
 v_mul_f32 v35, s42, v119
 v_mfma_f32_16x16x32_bf16 v[192:195], a[48:51], a[168:171], v[192:195]
 v_min_f32 v32, s47, v32
 v_min_f32 v33, s47, v33
 v_mfma_f32_16x16x32_bf16 v[192:195], a[32:35], a[172:175], v[192:195]
 v_min_f32 v34, s47, v34
 v_min_f32 v35, s47, v35
 v_mfma_f32_16x16x32_bf16 v[192:195], a[16:19], a[192:195], v[192:195]
 v_exp_f32 v32, v32
 v_mfma_f32_16x16x32_bf16 v[192:195], a[0:3], a[196:199], v[192:195]
 v_mul_f32 v40, s43, v124
 v_mul_f32 v41, s43, v125
 v_mfma_f32_16x16x32_bf16 v[208:211], a[0:3], a[192:195], v[208:211]
 v_exp_f32 v33, v33
 v_mfma_f32_16x16x32_bf16 v[208:211], a[16:19], a[172:175], v[208:211]
 v_mul_f32 v42, s43, v126
 v_mul_f32 v43, s43, v127
 v_mfma_f32_16x16x32_bf16 v[208:211], a[32:35], a[168:171], v[208:211]
 v_exp_f32 v34, v34
 v_mfma_f32_16x16x32_bf16 v[208:211], a[48:51], a[164:167], v[208:211]
 ds_read_b128 a[180:183], v3 offset:6528
 v_add_f32 v28, 1.0, v32
 v_mfma_f32_16x16x32_bf16 v[208:211], a[64:67], a[160:163], v[208:211]
 v_exp_f32 v35, v35
 v_mfma_f32_16x16x32_bf16 v[212:215], a[68:71], a[160:163], v[212:215]
 v_exp_f32 v40, v40
 v_mfma_f32_16x16x32_bf16 v[212:215], a[52:55], a[164:167], v[212:215]
 v_add_f32 v29, 1.0, v33
 v_add_f32 v30, 1.0, v34
 v_mfma_f32_16x16x32_bf16 v[212:215], a[36:39], a[168:171], v[212:215]
 v_exp_f32 v41, v41
 v_mfma_f32_16x16x32_bf16 v[212:215], a[20:23], a[172:175], v[212:215]
 v_add_f32 v31, 1.0, v35
 v_fmac_f32 v28, v28, v40
 v_mfma_f32_16x16x32_bf16 v[212:215], a[4:7], a[192:195], v[212:215]
 v_exp_f32 v42, v42
 v_mfma_f32_16x16x32_bf16 v[216:219], a[8:11], a[192:195], v[216:219]
 v_exp_f32 v43, v43
 v_mfma_f32_16x16x32_bf16 v[216:219], a[24:27], a[172:175], v[216:219]
 s_mov_b32 m0, s27
 v_fmac_f32 v29, v29, v41
 v_fmac_f32 v30, v30, v42
 v_mfma_f32_16x16x32_bf16 v[216:219], a[40:43], a[168:171], v[216:219]
 buffer_load_dwordx4 v15, s[4:7], 0 offen nt lds
 v_fmac_f32 v31, v31, v43
 v_mfma_f32_16x16x32_bf16 v[216:219], a[56:59], a[164:167], v[216:219]
 s_add_u32 s4, s4, 128
 s_addc_u32 s5, s5, 0
 s_xor_b32 s26, s26, 0x10000
 v_mfma_f32_16x16x32_bf16 v[216:219], a[72:75], a[160:163], v[216:219]
 s_xor_b32 s27, s27, s31
 v_rcp_f32 v28, v28
 v_mfma_f32_16x16x32_bf16 v[220:223], a[76:79], a[160:163], v[220:223]
 v_rcp_f32 v29, v29
 v_mfma_f32_16x16x32_bf16 v[220:223], a[60:63], a[164:167], v[220:223]
 v_rcp_f32 v30, v30
 v_mfma_f32_16x16x32_bf16 v[220:223], a[44:47], a[168:171], v[220:223]
 v_rcp_f32 v31, v31
 v_mfma_f32_16x16x32_bf16 v[220:223], a[28:31], a[172:175], v[220:223]
 v_fma_f32 v32, v32, v28, -v28
 v_fma_f32 v33, v33, v29, -v29
 v_mfma_f32_16x16x32_bf16 v[220:223], a[12:15], a[192:195], v[220:223]
 v_fma_f32 v34, v34, v30, -v30
 v_fma_f32 v35, v35, v31, -v31
 v_mfma_f32_16x16x32_bf16 v[236:239], a[12:15], a[172:175], v[236:239]
 v_cvt_pk_bf16_f32 v18, v32, v33
 v_cvt_pk_bf16_f32 v19, v34, v35
 v_mfma_f32_16x16x32_bf16 v[236:239], a[28:31], a[168:171], v[236:239]
 s_add_u32 s46, s40, 8192
 buffer_store_dwordx4 v[16:19], v6, s[12:15], s46 offen
 v_mul_f32 v20, s42, v128
 v_mfma_f32_16x16x32_bf16 v[236:239], a[44:47], a[164:167], v[236:239]
 v_mul_f32 v21, s42, v129
 v_mul_f32 v22, s42, v130
 v_mfma_f32_16x16x32_bf16 v[236:239], a[60:63], a[160:163], v[236:239]
 s_waitcnt lgkmcnt(0)
 ds_read_b128 a[184:187], v3 offset:10880
 v_mul_f32 v23, s42, v131
 v_mfma_f32_16x16x32_bf16 v[236:239], a[76:79], a[188:191], v[236:239]
 v_min_f32 v20, s47, v20
 v_min_f32 v21, s47, v21
 v_mfma_f32_16x16x32_bf16 v[232:235], a[72:75], a[188:191], v[232:235]
 v_min_f32 v22, s47, v22
 v_min_f32 v23, s47, v23
 v_mfma_f32_16x16x32_bf16 v[232:235], a[56:59], a[160:163], v[232:235]
 v_exp_f32 v20, v20
 v_mfma_f32_16x16x32_bf16 v[232:235], a[40:43], a[164:167], v[232:235]
 v_mul_f32 v24, s43, v136
 v_mul_f32 v25, s43, v137
 v_mfma_f32_16x16x32_bf16 v[232:235], a[24:27], a[168:171], v[232:235]
 v_exp_f32 v21, v21
 v_mfma_f32_16x16x32_bf16 v[232:235], a[8:11], a[172:175], v[232:235]
 v_mul_f32 v26, s43, v138
 v_mul_f32 v27, s43, v139
 v_mfma_f32_16x16x32_bf16 v[228:231], a[4:7], a[172:175], v[228:231]
 v_exp_f32 v22, v22
 v_mfma_f32_16x16x32_bf16 v[228:231], a[20:23], a[168:171], v[228:231]
 v_exp_f32 v23, v23
 v_mfma_f32_16x16x32_bf16 v[228:231], a[36:39], a[164:167], v[228:231]
 v_exp_f32 v24, v24
 v_mfma_f32_16x16x32_bf16 v[228:231], a[52:55], a[160:163], v[228:231]
 v_add_f32 v28, 1.0, v20
 v_add_f32 v29, 1.0, v21
 v_mfma_f32_16x16x32_bf16 v[228:231], a[68:71], a[188:191], v[228:231]
 v_exp_f32 v25, v25
 v_mfma_f32_16x16x32_bf16 v[224:227], a[64:67], a[188:191], v[224:227]
 v_add_f32 v30, 1.0, v22
 v_add_f32 v31, 1.0, v23
 v_mfma_f32_16x16x32_bf16 v[224:227], a[48:51], a[160:163], v[224:227]
 v_exp_f32 v26, v26
 v_mfma_f32_16x16x32_bf16 v[224:227], a[32:35], a[164:167], v[224:227]
 v_exp_f32 v27, v27
 v_mfma_f32_16x16x32_bf16 v[224:227], a[16:19], a[168:171], v[224:227]
 v_fmac_f32 v28, v28, v24
 v_fmac_f32 v29, v29, v25
 v_mfma_f32_16x16x32_bf16 v[224:227], a[0:3], a[172:175], v[224:227]
 v_fmac_f32 v30, v30, v26
 v_fmac_f32 v31, v31, v27
 v_mfma_f32_16x16x32_bf16 v[240:243], a[0:3], a[168:171], v[240:243]
 v_rcp_f32 v28, v28
 v_mfma_f32_16x16x32_bf16 v[240:243], a[16:19], a[164:167], v[240:243]
 v_rcp_f32 v29, v29
 v_mfma_f32_16x16x32_bf16 v[240:243], a[32:35], a[160:163], v[240:243]
 v_rcp_f32 v30, v30
 v_mfma_f32_16x16x32_bf16 v[240:243], a[48:51], a[188:191], v[240:243]
 ds_read_b128 a[204:207], v3 offset:15232
 v_fma_f32 v20, v20, v28, -v28
 v_mfma_f32_16x16x32_bf16 v[240:243], a[64:67], a[176:179], v[240:243]
 v_rcp_f32 v31, v31
 v_mfma_f32_16x16x32_bf16 v[244:247], a[68:71], a[176:179], v[244:247]
 v_fma_f32 v21, v21, v29, -v29
 v_fma_f32 v22, v22, v30, -v30
 v_mfma_f32_16x16x32_bf16 v[244:247], a[52:55], a[188:191], v[244:247]
 v_fma_f32 v23, v23, v31, -v31
 v_cvt_pk_bf16_f32 v16, v20, v21
 v_mfma_f32_16x16x32_bf16 v[244:247], a[36:39], a[160:163], v[244:247]
 v_cvt_pk_bf16_f32 v17, v22, v23
 v_mul_f32 v32, s42, v132
 v_mfma_f32_16x16x32_bf16 v[244:247], a[20:23], a[164:167], v[244:247]
 v_mul_f32 v33, s42, v133
 v_mul_f32 v34, s42, v134
 v_mfma_f32_16x16x32_bf16 v[244:247], a[4:7], a[168:171], v[244:247]
 v_mul_f32 v35, s42, v135
 v_min_f32 v32, s47, v32
 v_mfma_f32_16x16x32_bf16 v[248:251], a[8:11], a[168:171], v[248:251]
 v_min_f32 v33, s47, v33
 v_min_f32 v34, s47, v34
 v_mfma_f32_16x16x32_bf16 v[248:251], a[24:27], a[164:167], v[248:251]
 v_min_f32 v35, s47, v35
 v_mul_f32 v40, s43, v140
 v_mfma_f32_16x16x32_bf16 v[248:251], a[40:43], a[160:163], v[248:251]
 v_exp_f32 v32, v32
 v_mfma_f32_16x16x32_bf16 v[248:251], a[56:59], a[188:191], v[248:251]
 v_mul_f32 v41, s43, v141
 v_mul_f32 v42, s43, v142
 v_mfma_f32_16x16x32_bf16 v[248:251], a[72:75], a[176:179], v[248:251]
 v_exp_f32 v33, v33
 v_mfma_f32_16x16x32_bf16 v[252:255], a[76:79], a[176:179], v[252:255]
 v_mul_f32 v43, s43, v143
 v_add_f32 v28, 1.0, v32
 v_mfma_f32_16x16x32_bf16 v[252:255], a[60:63], a[188:191], v[252:255]
 v_exp_f32 v34, v34
 v_mfma_f32_16x16x32_bf16 v[252:255], a[44:47], a[160:163], v[252:255]
 v_exp_f32 v35, v35
 v_mfma_f32_16x16x32_bf16 v[252:255], a[28:31], a[164:167], v[252:255]
 v_exp_f32 v40, v40
 v_mfma_f32_16x16x32_bf16 v[252:255], a[12:15], a[168:171], v[252:255]
 ds_read_b128 a[200:203], v2 offset:2176
 v_add_f32 v29, 1.0, v33
 v_mfma_f32_16x16x32_bf16 a[220:223], a[12:15], a[164:167], a[220:223]
 ds_read_b128 a[196:199], v2 offset:6528
 v_add_f32 v30, 1.0, v34
 v_mfma_f32_16x16x32_bf16 a[220:223], a[28:31], a[160:163], a[220:223]
 ds_read_b128 a[192:195], v2 offset:10880
 v_add_f32 v31, 1.0, v35
 v_mfma_f32_16x16x32_bf16 a[220:223], a[44:47], a[188:191], a[220:223]
 ds_read_b128 a[172:175], v2 offset:15232
 v_fmac_f32 v28, v28, v40
 v_mfma_f32_16x16x32_bf16 a[220:223], a[60:63], a[176:179], a[220:223]
 ds_read_b128 a[168:171], v2 offset:19584
 v_mul_f32 v20, s42, v144
 v_mfma_f32_16x16x32_bf16 a[220:223], a[76:79], a[180:183], a[220:223]
 v_exp_f32 v41, v41
 v_mfma_f32_16x16x32_bf16 a[216:219], a[72:75], a[180:183], a[216:219]
 v_exp_f32 v42, v42
 v_mfma_f32_16x16x32_bf16 a[216:219], a[56:59], a[176:179], a[216:219]
 v_exp_f32 v43, v43
 v_mfma_f32_16x16x32_bf16 a[216:219], a[40:43], a[188:191], a[216:219]
 v_fmac_f32 v29, v29, v41
 v_fmac_f32 v30, v30, v42
 v_mfma_f32_16x16x32_bf16 a[216:219], a[24:27], a[160:163], a[216:219]
 v_fmac_f32 v31, v31, v43
 v_mul_f32 v21, s42, v145
 v_mfma_f32_16x16x32_bf16 a[216:219], a[8:11], a[164:167], a[216:219]
 v_rcp_f32 v28, v28
 v_mfma_f32_16x16x32_bf16 a[212:215], a[4:7], a[164:167], a[212:215]
 v_rcp_f32 v29, v29
 v_mfma_f32_16x16x32_bf16 a[212:215], a[20:23], a[160:163], a[212:215]
 v_rcp_f32 v30, v30
 v_mfma_f32_16x16x32_bf16 a[212:215], a[36:39], a[188:191], a[212:215]
 v_rcp_f32 v31, v31
 v_mfma_f32_16x16x32_bf16 a[212:215], a[52:55], a[176:179], a[212:215]
 v_fma_f32 v32, v32, v28, -v28
 v_fma_f32 v33, v33, v29, -v29
 v_mfma_f32_16x16x32_bf16 a[212:215], a[68:71], a[180:183], a[212:215]
 v_fma_f32 v34, v34, v30, -v30
 v_fma_f32 v35, v35, v31, -v31
 v_mfma_f32_16x16x32_bf16 a[208:211], a[64:67], a[180:183], a[208:211]
 v_cvt_pk_bf16_f32 v18, v32, v33
 v_cvt_pk_bf16_f32 v19, v34, v35
 v_mfma_f32_16x16x32_bf16 a[208:211], a[48:51], a[176:179], a[208:211]
 s_add_u32 s46, s40, 10240
 buffer_store_dwordx4 v[16:19], v6, s[12:15], s46 offen
 v_mul_f32 v22, s42, v146
 v_mfma_f32_16x16x32_bf16 a[208:211], a[32:35], a[188:191], a[208:211]
 v_mul_f32 v23, s42, v147
 v_min_f32 v20, s47, v20
 v_mfma_f32_16x16x32_bf16 a[208:211], a[16:19], a[160:163], a[208:211]
 v_min_f32 v21, s47, v21
 v_min_f32 v22, s47, v22
 v_mfma_f32_16x16x32_bf16 a[208:211], a[0:3], a[164:167], a[208:211]
 v_min_f32 v23, s47, v23
 v_mul_f32 v24, s43, v152
 v_mfma_f32_16x16x32_bf16 a[224:227], a[0:3], a[160:163], a[224:227]
 v_exp_f32 v20, v20
 v_mfma_f32_16x16x32_bf16 a[224:227], a[16:19], a[188:191], a[224:227]
 v_mul_f32 v25, s43, v153
 v_mul_f32 v26, s43, v154
 v_mfma_f32_16x16x32_bf16 a[224:227], a[32:35], a[176:179], a[224:227]
 v_exp_f32 v21, v21
 v_mfma_f32_16x16x32_bf16 a[224:227], a[48:51], a[180:183], a[224:227]
 s_waitcnt lgkmcnt(0)
 ds_read_b128 a[164:167], v2 offset:23936
 v_mul_f32 v27, s43, v155
 v_mfma_f32_16x16x32_bf16 a[224:227], a[64:67], a[184:187], a[224:227]
 v_exp_f32 v22, v22
 v_mfma_f32_16x16x32_bf16 a[228:231], a[68:71], a[184:187], a[228:231]
 v_exp_f32 v23, v23
 v_mfma_f32_16x16x32_bf16 a[228:231], a[52:55], a[180:183], a[228:231]
 v_exp_f32 v24, v24
 v_mfma_f32_16x16x32_bf16 a[228:231], a[36:39], a[176:179], a[228:231]
 v_add_f32 v28, 1.0, v20
 v_add_f32 v29, 1.0, v21
 v_mfma_f32_16x16x32_bf16 a[228:231], a[20:23], a[188:191], a[228:231]
 v_exp_f32 v25, v25
 v_mfma_f32_16x16x32_bf16 a[228:231], a[4:7], a[160:163], a[228:231]
 v_add_f32 v30, 1.0, v22
 v_add_f32 v31, 1.0, v23
 v_mfma_f32_16x16x32_bf16 a[232:235], a[8:11], a[160:163], a[232:235]
 v_exp_f32 v26, v26
 v_mfma_f32_16x16x32_bf16 a[232:235], a[24:27], a[188:191], a[232:235]
 v_exp_f32 v27, v27
 v_mfma_f32_16x16x32_bf16 a[232:235], a[40:43], a[176:179], a[232:235]
 v_fmac_f32 v28, v28, v24
 v_fmac_f32 v29, v29, v25
 v_mfma_f32_16x16x32_bf16 a[232:235], a[56:59], a[180:183], a[232:235]
 v_fmac_f32 v30, v30, v26
 v_fmac_f32 v31, v31, v27
 v_mfma_f32_16x16x32_bf16 a[232:235], a[72:75], a[184:187], a[232:235]
 v_rcp_f32 v28, v28
 v_mfma_f32_16x16x32_bf16 a[236:239], a[76:79], a[184:187], a[236:239]
 v_rcp_f32 v29, v29
 v_mfma_f32_16x16x32_bf16 a[236:239], a[60:63], a[180:183], a[236:239]
 v_rcp_f32 v30, v30
 v_mfma_f32_16x16x32_bf16 a[236:239], a[44:47], a[176:179], a[236:239]
 v_rcp_f32 v31, v31
 v_mfma_f32_16x16x32_bf16 a[236:239], a[28:31], a[188:191], a[236:239]
 v_fma_f32 v20, v20, v28, -v28
 v_fma_f32 v21, v21, v29, -v29
 v_mfma_f32_16x16x32_bf16 a[236:239], a[12:15], a[160:163], a[236:239]
 v_fma_f32 v22, v22, v30, -v30
 v_fma_f32 v23, v23, v31, -v31
 v_mfma_f32_16x16x32_bf16 a[252:255], a[12:15], a[188:191], a[252:255]
 v_cvt_pk_bf16_f32 v16, v20, v21
 v_cvt_pk_bf16_f32 v17, v22, v23
 v_mfma_f32_16x16x32_bf16 a[252:255], a[28:31], a[176:179], a[252:255]
 v_mul_f32 v32, s42, v148
 v_mul_f32 v33, s42, v149
 v_mfma_f32_16x16x32_bf16 a[252:255], a[44:47], a[180:183], a[252:255]
 v_mul_f32 v34, s42, v150
 v_mul_f32 v35, s42, v151
 v_mfma_f32_16x16x32_bf16 a[252:255], a[60:63], a[184:187], a[252:255]
 ds_read_b128 a[160:163], v2 offset:28288
 v_min_f32 v32, s47, v32
 v_mfma_f32_16x16x32_bf16 a[252:255], a[76:79], a[204:207], a[252:255]
 v_min_f32 v33, s47, v33
 v_min_f32 v34, s47, v34
 v_mfma_f32_16x16x32_bf16 a[248:251], a[72:75], a[204:207], a[248:251]
 v_min_f32 v35, s47, v35
 v_mul_f32 v40, s43, v156
 v_mfma_f32_16x16x32_bf16 a[248:251], a[56:59], a[184:187], a[248:251]
 v_exp_f32 v32, v32
 v_mfma_f32_16x16x32_bf16 a[248:251], a[40:43], a[180:183], a[248:251]
 v_mul_f32 v41, s43, v157
 v_mul_f32 v42, s43, v158
 v_mfma_f32_16x16x32_bf16 a[248:251], a[24:27], a[176:179], a[248:251]
 v_exp_f32 v33, v33
 v_mfma_f32_16x16x32_bf16 a[248:251], a[8:11], a[188:191], a[248:251]
 v_mul_f32 v43, s43, v159
 v_add_f32 v28, 1.0, v32
 v_mfma_f32_16x16x32_bf16 a[244:247], a[4:7], a[188:191], a[244:247]
 v_exp_f32 v34, v34
 v_mfma_f32_16x16x32_bf16 a[244:247], a[20:23], a[176:179], a[244:247]
 v_exp_f32 v35, v35
 v_mfma_f32_16x16x32_bf16 a[244:247], a[36:39], a[180:183], a[244:247]
 v_exp_f32 v40, v40
 v_mfma_f32_16x16x32_bf16 a[244:247], a[52:55], a[184:187], a[244:247]
 v_add_f32 v29, 1.0, v33
 v_add_f32 v30, 1.0, v34
 v_mfma_f32_16x16x32_bf16 a[244:247], a[68:71], a[204:207], a[244:247]
 v_exp_f32 v41, v41
 v_mfma_f32_16x16x32_bf16 a[240:243], a[64:67], a[204:207], a[240:243]
 v_add_f32 v31, 1.0, v35
 v_fmac_f32 v28, v28, v40
 v_mfma_f32_16x16x32_bf16 a[240:243], a[48:51], a[184:187], a[240:243]
 v_exp_f32 v42, v42
 v_mfma_f32_16x16x32_bf16 a[240:243], a[32:35], a[180:183], a[240:243]
 v_exp_f32 v43, v43
 v_mfma_f32_16x16x32_bf16 a[240:243], a[16:19], a[176:179], a[240:243]
 v_fmac_f32 v29, v29, v41
 v_fmac_f32 v30, v30, v42
 v_mfma_f32_16x16x32_bf16 a[240:243], a[0:3], a[188:191], a[240:243]
 s_waitcnt vmcnt(3)
 ds_read_b64_tr_b16 a[0:1], v46 offset:0
 v_fmac_f32 v31, v31, v43
 v_mfma_f32_16x16x32_bf16 v[176:179], a[80:83], a[200:203], v[176:179]
 v_rcp_f32 v28, v28
 v_mfma_f32_16x16x32_bf16 v[176:179], a[96:99], a[196:199], v[176:179]
 ds_read_b64_tr_b16 a[2:3], v46 offset:256
 v_fma_f32 v32, v32, v28, -v28
 v_mfma_f32_16x16x32_bf16 v[176:179], a[112:115], a[192:195], v[176:179]
 v_rcp_f32 v29, v29
 v_mfma_f32_16x16x32_bf16 v[176:179], a[128:131], a[172:175], v[176:179]
 ds_read_b128 a[204:207], v2 offset:32640
 ds_read_b64_tr_b16 a[4:5], v46 offset:8
 v_mfma_f32_16x16x32_bf16 v[176:179], a[144:147], a[168:171], v[176:179]
 v_rcp_f32 v30, v30
 v_mfma_f32_16x16x32_bf16 v[180:183], a[148:151], a[168:171], v[180:183]
 ds_read_b64_tr_b16 a[6:7], v46 offset:264
 v_fma_f32 v33, v33, v29, -v29
 v_mfma_f32_16x16x32_bf16 v[180:183], a[132:135], a[172:175], v[180:183]
 v_rcp_f32 v31, v31
 v_mfma_f32_16x16x32_bf16 v[180:183], a[116:119], a[192:195], v[180:183]
 ds_read_b64_tr_b16 a[16:17], v46 offset:4096
 v_fma_f32 v34, v34, v30, -v30
 v_mfma_f32_16x16x32_bf16 v[180:183], a[100:103], a[196:199], v[180:183]
 v_fma_f32 v35, v35, v31, -v31
 v_cvt_pk_bf16_f32 v18, v32, v33
 v_mfma_f32_16x16x32_bf16 v[180:183], a[84:87], a[200:203], v[180:183]
 ds_read_b64_tr_b16 a[18:19], v46 offset:4352
 v_cvt_pk_bf16_f32 v19, v34, v35
 v_mfma_f32_16x16x32_bf16 v[184:187], a[88:91], a[200:203], v[184:187]
 s_add_u32 s46, s40, 12288
 buffer_store_dwordx4 v[16:19], v6, s[12:15], s46 offen
 v_mul_f32 v20, s42, v160
 v_mfma_f32_16x16x32_bf16 v[184:187], a[104:107], a[196:199], v[184:187]
 s_add_u32 m0, s29, 0
 ds_read_b64_tr_b16 a[20:21], v46 offset:4104
 v_mul_f32 v21, s42, v161
 v_mfma_f32_16x16x32_bf16 v[184:187], a[120:123], a[192:195], v[184:187]
 s_waitcnt lgkmcnt(3)
 buffer_load_dwordx4 v5, s[8:11], s76 offen offset:0 lds
 v_mul_f32 v22, s42, v162
 v_mfma_f32_16x16x32_bf16 v[184:187], a[136:139], a[172:175], v[184:187]
 ds_read_b64_tr_b16 a[22:23], v46 offset:4360
 v_mul_f32 v23, s42, v163
 v_mfma_f32_16x16x32_bf16 v[184:187], a[152:155], a[168:171], v[184:187]
 v_min_f32 v20, s47, v20
 v_min_f32 v21, s47, v21
 v_mfma_f32_16x16x32_bf16 v[188:191], a[156:159], a[168:171], v[188:191]
 ds_read_b64_tr_b16 a[32:33], v46 offset:8192
 v_min_f32 v22, s47, v22
 v_mfma_f32_16x16x32_bf16 v[188:191], a[140:143], a[172:175], v[188:191]
 v_min_f32 v23, s47, v23
 v_mul_f32 v24, s43, v168
 v_mfma_f32_16x16x32_bf16 v[188:191], a[124:127], a[192:195], v[188:191]
 s_add_u32 m0, s29, 2048
 ds_read_b64_tr_b16 a[34:35], v46 offset:8448
 v_mul_f32 v25, s43, v169
 v_mfma_f32_16x16x32_bf16 v[188:191], a[108:111], a[196:199], v[188:191]
 buffer_load_dwordx4 v5, s[8:11], s77 offen offset:0 lds
 v_mul_f32 v26, s43, v170
 v_mfma_f32_16x16x32_bf16 v[188:191], a[92:95], a[200:203], v[188:191]
 ds_read_b64_tr_b16 a[36:37], v46 offset:8200
 v_mul_f32 v27, s43, v171
 v_mfma_f32_16x16x32_bf16 v[204:207], a[92:95], a[196:199], v[204:207]
 v_exp_f32 v20, v20
 v_mfma_f32_16x16x32_bf16 v[204:207], a[108:111], a[192:195], v[204:207]
 ds_read_b64_tr_b16 a[38:39], v46 offset:8456
 v_add_f32 v28, 1.0, v20
 v_mfma_f32_16x16x32_bf16 v[204:207], a[124:127], a[172:175], v[204:207]
 v_exp_f32 v21, v21
 v_mfma_f32_16x16x32_bf16 v[204:207], a[140:143], a[168:171], v[204:207]
 s_add_u32 m0, s29, 4096
 ds_read_b128 a[184:187], v4 offset:2176
 ds_read_b64_tr_b16 a[48:49], v46 offset:12288
 v_mfma_f32_16x16x32_bf16 v[204:207], a[156:159], a[164:167], v[204:207]
 s_waitcnt lgkmcnt(6)
 buffer_load_dwordx4 v5, s[8:11], s78 offen offset:0 lds
 v_add_f32 v29, 1.0, v21
 v_mfma_f32_16x16x32_bf16 v[200:203], a[152:155], a[164:167], v[200:203]
 ds_read_b64_tr_b16 a[50:51], v46 offset:12544
 v_mul_f32 v32, s42, v164
 v_mfma_f32_16x16x32_bf16 v[200:203], a[136:139], a[168:171], v[200:203]
 v_exp_f32 v22, v22
 v_mfma_f32_16x16x32_bf16 v[200:203], a[120:123], a[172:175], v[200:203]
 ds_read_b64_tr_b16 a[52:53], v46 offset:12296
 v_add_f32 v30, 1.0, v22
 v_mfma_f32_16x16x32_bf16 v[200:203], a[104:107], a[192:195], v[200:203]
 v_exp_f32 v23, v23
 v_mfma_f32_16x16x32_bf16 v[200:203], a[88:91], a[196:199], v[200:203]
 s_add_u32 m0, s29, 6144
 ds_read_b64_tr_b16 a[54:55], v46 offset:12552
 v_add_f32 v31, 1.0, v23
 v_mfma_f32_16x16x32_bf16 v[196:199], a[84:87], a[196:199], v[196:199]
 buffer_load_dwordx4 v5, s[8:11], s79 offen offset:0 lds
 v_mul_f32 v33, s42, v165
 v_mfma_f32_16x16x32_bf16 v[196:199], a[100:103], a[192:195], v[196:199]
 ds_read_b64_tr_b16 a[64:65], v46 offset:16384
 v_mul_f32 v34, s42, v166
 v_mfma_f32_16x16x32_bf16 v[196:199], a[116:119], a[172:175], v[196:199]
 v_exp_f32 v24, v24
 v_mfma_f32_16x16x32_bf16 v[196:199], a[132:135], a[168:171], v[196:199]
 ds_read_b64_tr_b16 a[66:67], v46 offset:16640
 v_fmac_f32 v28, v28, v24
 v_mfma_f32_16x16x32_bf16 v[196:199], a[148:151], a[164:167], v[196:199]
 v_exp_f32 v25, v25
 v_mfma_f32_16x16x32_bf16 v[192:195], a[144:147], a[164:167], v[192:195]
 s_add_u32 m0, s29, 8192
 ds_read_b64_tr_b16 a[68:69], v46 offset:16392
 v_fmac_f32 v29, v29, v25
 v_mfma_f32_16x16x32_bf16 v[192:195], a[128:131], a[168:171], v[192:195]
 s_waitcnt lgkmcnt(6)
 buffer_load_dwordx4 v5, s[8:11], s80 offen offset:0 lds
 v_mul_f32 v35, s42, v167
 v_mfma_f32_16x16x32_bf16 v[192:195], a[112:115], a[172:175], v[192:195]
 ds_read_b64_tr_b16 a[70:71], v46 offset:16648
 v_min_f32 v32, s47, v32
 v_mfma_f32_16x16x32_bf16 v[192:195], a[96:99], a[192:195], v[192:195]
 v_exp_f32 v26, v26
 v_mfma_f32_16x16x32_bf16 v[192:195], a[80:83], a[196:199], v[192:195]
 ds_read_b64_tr_b16 a[8:9], v46 offset:1024
 v_fmac_f32 v30, v30, v26
 v_mfma_f32_16x16x32_bf16 v[208:211], a[80:83], a[192:195], v[208:211]
 v_exp_f32 v27, v27
 v_mfma_f32_16x16x32_bf16 v[208:211], a[96:99], a[172:175], v[208:211]
 ds_read_b64_tr_b16 a[10:11], v46 offset:1280
 v_fmac_f32 v31, v31, v27
 v_mfma_f32_16x16x32_bf16 v[208:211], a[112:115], a[168:171], v[208:211]
 v_rcp_f32 v28, v28
 v_mfma_f32_16x16x32_bf16 v[208:211], a[128:131], a[164:167], v[208:211]
 s_add_u32 m0, s29, 10240
 ds_read_b128 a[188:191], v4 offset:6528
 ds_read_b64_tr_b16 a[12:13], v46 offset:1032
 v_mfma_f32_16x16x32_bf16 v[208:211], a[144:147], a[160:163], v[208:211]
 buffer_load_dwordx4 v5, s[8:11], s81 offen offset:0 lds
 v_fma_f32 v20, v20, v28, -v28
 v_mfma_f32_16x16x32_bf16 v[212:215], a[148:151], a[160:163], v[212:215]
 ds_read_b64_tr_b16 a[14:15], v46 offset:1288
 v_min_f32 v33, s47, v33
 v_mfma_f32_16x16x32_bf16 v[212:215], a[132:135], a[164:167], v[212:215]
 v_rcp_f32 v29, v29
 v_mfma_f32_16x16x32_bf16 v[212:215], a[116:119], a[168:171], v[212:215]
 ds_read_b64_tr_b16 a[24:25], v46 offset:5120
 v_fma_f32 v21, v21, v29, -v29
 v_mfma_f32_16x16x32_bf16 v[212:215], a[100:103], a[172:175], v[212:215]
 s_add_u32 m0, s29, 12288
 v_rcp_f32 v30, v30
 v_mfma_f32_16x16x32_bf16 v[212:215], a[84:87], a[192:195], v[212:215]
 s_waitcnt lgkmcnt(6)
 ds_read_b64_tr_b16 a[26:27], v46 offset:5376
 buffer_load_dwordx4 v5, s[8:11], s82 offen offset:0 lds
 v_mfma_f32_16x16x32_bf16 v[216:219], a[88:91], a[192:195], v[216:219]
 v_rcp_f32 v31, v31
 v_mfma_f32_16x16x32_bf16 v[216:219], a[104:107], a[172:175], v[216:219]
 ds_read_b64_tr_b16 a[28:29], v46 offset:5128
 v_fma_f32 v22, v22, v30, -v30
 v_mfma_f32_16x16x32_bf16 v[216:219], a[120:123], a[168:171], v[216:219]
 v_fma_f32 v23, v23, v31, -v31
 v_cvt_pk_bf16_f32 v16, v20, v21
 v_mfma_f32_16x16x32_bf16 v[216:219], a[136:139], a[164:167], v[216:219]
 ds_read_b64_tr_b16 a[30:31], v46 offset:5384
 v_cvt_pk_bf16_f32 v17, v22, v23
 v_mfma_f32_16x16x32_bf16 v[216:219], a[152:155], a[160:163], v[216:219]
 s_add_u32 m0, s29, 14336
 v_min_f32 v34, s47, v34
 v_min_f32 v35, s47, v35
 v_mfma_f32_16x16x32_bf16 v[220:223], a[156:159], a[160:163], v[220:223]
 ds_read_b64_tr_b16 a[40:41], v46 offset:9216
 buffer_load_dwordx4 v5, s[8:11], s83 offen offset:0 lds
 v_mfma_f32_16x16x32_bf16 v[220:223], a[140:143], a[164:167], v[220:223]
 v_exp_f32 v32, v32
 v_mfma_f32_16x16x32_bf16 v[220:223], a[124:127], a[168:171], v[220:223]
 ds_read_b64_tr_b16 a[42:43], v46 offset:9472
 v_mul_f32 v40, s43, v172
 v_mfma_f32_16x16x32_bf16 v[220:223], a[108:111], a[172:175], v[220:223]
 v_mul_f32 v41, s43, v173
 v_mul_f32 v42, s43, v174
 v_mfma_f32_16x16x32_bf16 v[220:223], a[92:95], a[192:195], v[220:223]
 ds_read_b64_tr_b16 a[44:45], v46 offset:9224
 v_mul_f32 v43, s43, v175
 v_mfma_f32_16x16x32_bf16 v[236:239], a[92:95], a[172:175], v[236:239]
 s_add_u32 m0, s29, 16384
 v_exp_f32 v33, v33
 v_mfma_f32_16x16x32_bf16 v[236:239], a[108:111], a[168:171], v[236:239]
 ds_read_b64_tr_b16 a[46:47], v46 offset:9480
 buffer_load_dwordx4 v5, s[8:11], s84 offen offset:0 lds
 v_mfma_f32_16x16x32_bf16 v[236:239], a[124:127], a[164:167], v[236:239]
 v_exp_f32 v34, v34
 v_mfma_f32_16x16x32_bf16 v[236:239], a[140:143], a[160:163], v[236:239]
 ds_read_b128 a[200:203], v4 offset:10880
 ds_read_b64_tr_b16 a[56:57], v46 offset:13312
 v_mfma_f32_16x16x32_bf16 v[236:239], a[156:159], a[204:207], v[236:239]
 v_exp_f32 v35, v35
 v_mfma_f32_16x16x32_bf16 v[232:235], a[152:155], a[204:207], v[232:235]
 ds_read_b64_tr_b16 a[58:59], v46 offset:13568
 v_add_f32 v28, 1.0, v32
 v_mfma_f32_16x16x32_bf16 v[232:235], a[136:139], a[160:163], v[232:235]
 s_add_u32 m0, s29, 18432
 v_exp_f32 v40, v40
 v_mfma_f32_16x16x32_bf16 v[232:235], a[120:123], a[164:167], v[232:235]
 ds_read_b64_tr_b16 a[60:61], v46 offset:13320
 buffer_load_dwordx4 v5, s[8:11], s85 offen offset:0 lds
 v_mfma_f32_16x16x32_bf16 v[232:235], a[104:107], a[168:171], v[232:235]
 v_add_f32 v29, 1.0, v33
 v_add_f32 v30, 1.0, v34
 v_mfma_f32_16x16x32_bf16 v[232:235], a[88:91], a[172:175], v[232:235]
 ds_read_b64_tr_b16 a[62:63], v46 offset:13576
 v_add_f32 v31, 1.0, v35
 v_mfma_f32_16x16x32_bf16 v[228:231], a[84:87], a[172:175], v[228:231]
 v_exp_f32 v41, v41
 v_mfma_f32_16x16x32_bf16 v[228:231], a[100:103], a[168:171], v[228:231]
 ds_read_b64_tr_b16 a[72:73], v46 offset:17408
 v_fmac_f32 v28, v28, v40
 v_mfma_f32_16x16x32_bf16 v[228:231], a[116:119], a[164:167], v[228:231]
 v_exp_f32 v42, v42
 v_mfma_f32_16x16x32_bf16 v[228:231], a[132:135], a[160:163], v[228:231]
 s_add_u32 m0, s29, 0
 ds_read_b64_tr_b16 a[74:75], v46 offset:17664
 v_fmac_f32 v29, v29, v41
 v_mfma_f32_16x16x32_bf16 v[228:231], a[148:151], a[204:207], v[228:231]
 s_waitcnt lgkmcnt(7)
 buffer_load_dwordx4 v5, s[8:11], s76 offen offset:1024 lds
 v_fmac_f32 v30, v30, v42
 v_mfma_f32_16x16x32_bf16 v[224:227], a[144:147], a[204:207], v[224:227]
 ds_read_b64_tr_b16 a[76:77], v46 offset:17416
 v_mul_f32 v20, s42, v176
 v_mfma_f32_16x16x32_bf16 v[224:227], a[128:131], a[160:163], v[224:227]
 v_exp_f32 v43, v43
 v_mfma_f32_16x16x32_bf16 v[224:227], a[112:115], a[164:167], v[224:227]
 ds_read_b64_tr_b16 a[78:79], v46 offset:17672
 v_fmac_f32 v31, v31, v43
 v_mfma_f32_16x16x32_bf16 v[224:227], a[96:99], a[168:171], v[224:227]
 v_rcp_f32 v28, v28
 v_mfma_f32_16x16x32_bf16 v[224:227], a[80:83], a[172:175], v[224:227]
 s_add_u32 m0, s29, 2048
 v_rcp_f32 v29, v29
 v_mfma_f32_16x16x32_bf16 v[240:243], a[80:83], a[168:171], v[240:243]
 buffer_load_dwordx4 v5, s[8:11], s77 offen offset:1024 lds
 v_fma_f32 v32, v32, v28, -v28
 v_mfma_f32_16x16x32_bf16 v[240:243], a[96:99], a[164:167], v[240:243]
 v_rcp_f32 v30, v30
 v_mfma_f32_16x16x32_bf16 v[240:243], a[112:115], a[160:163], v[240:243]
 v_rcp_f32 v31, v31
 v_mfma_f32_16x16x32_bf16 v[240:243], a[128:131], a[204:207], v[240:243]
 ds_read_b128 a[196:199], v4 offset:15232
 v_fma_f32 v33, v33, v29, -v29
 v_mfma_f32_16x16x32_bf16 v[240:243], a[144:147], a[184:187], v[240:243]
 v_fma_f32 v34, v34, v30, -v30
 v_fma_f32 v35, v35, v31, -v31
 v_mfma_f32_16x16x32_bf16 v[244:247], a[148:151], a[184:187], v[244:247]
 s_add_u32 m0, s29, 4096
 v_cvt_pk_bf16_f32 v18, v32, v33
 v_cvt_pk_bf16_f32 v19, v34, v35
 v_mfma_f32_16x16x32_bf16 v[244:247], a[132:135], a[204:207], v[244:247]
 s_add_u32 s46, s40, 14336
 buffer_load_dwordx4 v5, s[8:11], s78 offen offset:1024 lds
 buffer_store_dwordx4 v[16:19], v6, s[12:15], s46 offen
 v_mfma_f32_16x16x32_bf16 v[244:247], a[116:119], a[160:163], v[244:247]
 v_mul_f32 v21, s42, v177
 v_mul_f32 v22, s42, v178
 v_mfma_f32_16x16x32_bf16 v[244:247], a[100:103], a[164:167], v[244:247]
 v_mul_f32 v23, s42, v179
 v_min_f32 v20, s47, v20
 v_mfma_f32_16x16x32_bf16 v[244:247], a[84:87], a[168:171], v[244:247]
 v_min_f32 v21, s47, v21
 v_min_f32 v22, s47, v22
 v_mfma_f32_16x16x32_bf16 v[248:251], a[88:91], a[168:171], v[248:251]
 v_min_f32 v23, s47, v23
 v_mul_f32 v24, s43, v184
 v_mfma_f32_16x16x32_bf16 v[248:251], a[104:107], a[164:167], v[248:251]
 s_add_u32 m0, s29, 6144
 v_exp_f32 v20, v20
 v_mfma_f32_16x16x32_bf16 v[248:251], a[120:123], a[160:163], v[248:251]
 buffer_load_dwordx4 v5, s[8:11], s79 offen offset:1024 lds
 v_mul_f32 v25, s43, v185
 v_mfma_f32_16x16x32_bf16 v[248:251], a[136:139], a[204:207], v[248:251]
 v_exp_f32 v21, v21
 v_mfma_f32_16x16x32_bf16 v[248:251], a[152:155], a[184:187], v[248:251]
 v_mul_f32 v26, s43, v186
 v_mul_f32 v27, s43, v187
 v_mfma_f32_16x16x32_bf16 v[252:255], a[156:159], a[184:187], v[252:255]
 v_exp_f32 v22, v22
 v_mfma_f32_16x16x32_bf16 v[252:255], a[140:143], a[204:207], v[252:255]
 v_exp_f32 v23, v23
 v_mfma_f32_16x16x32_bf16 v[252:255], a[124:127], a[160:163], v[252:255]
 s_add_u32 m0, s29, 8192
 v_exp_f32 v24, v24
 v_mfma_f32_16x16x32_bf16 v[252:255], a[108:111], a[164:167], v[252:255]
 buffer_load_dwordx4 v5, s[8:11], s80 offen offset:1024 lds
 v_add_f32 v28, 1.0, v20
 v_mfma_f32_16x16x32_bf16 v[252:255], a[92:95], a[168:171], v[252:255]
 v_add_f32 v29, 1.0, v21
 v_add_f32 v30, 1.0, v22
 v_mfma_f32_16x16x32_bf16 a[220:223], a[92:95], a[164:167], a[220:223]
 v_exp_f32 v25, v25
 v_mfma_f32_16x16x32_bf16 a[220:223], a[108:111], a[160:163], a[220:223]
 v_add_f32 v31, 1.0, v23
 v_fmac_f32 v28, v28, v24
 v_mfma_f32_16x16x32_bf16 a[220:223], a[124:127], a[204:207], a[220:223]
 v_exp_f32 v26, v26
 v_mfma_f32_16x16x32_bf16 a[220:223], a[140:143], a[184:187], a[220:223]
 v_exp_f32 v27, v27
 v_mfma_f32_16x16x32_bf16 a[220:223], a[156:159], a[188:191], a[220:223]
 s_add_u32 m0, s29, 10240
 v_fmac_f32 v29, v29, v25
 v_fmac_f32 v30, v30, v26
 v_mfma_f32_16x16x32_bf16 a[216:219], a[152:155], a[188:191], a[216:219]
 buffer_load_dwordx4 v5, s[8:11], s81 offen offset:1024 lds
 v_fmac_f32 v31, v31, v27
 v_mfma_f32_16x16x32_bf16 a[216:219], a[136:139], a[184:187], a[216:219]
 v_rcp_f32 v28, v28
 v_mfma_f32_16x16x32_bf16 a[216:219], a[120:123], a[204:207], a[216:219]
 v_rcp_f32 v29, v29
 v_mfma_f32_16x16x32_bf16 a[216:219], a[104:107], a[160:163], a[216:219]
 v_rcp_f32 v30, v30
 v_mfma_f32_16x16x32_bf16 a[216:219], a[88:91], a[164:167], a[216:219]
 v_rcp_f32 v31, v31
 v_mfma_f32_16x16x32_bf16 a[212:215], a[84:87], a[164:167], a[212:215]
 s_add_u32 m0, s29, 12288
 v_fma_f32 v20, v20, v28, -v28
 v_fma_f32 v21, v21, v29, -v29
 v_mfma_f32_16x16x32_bf16 a[212:215], a[100:103], a[160:163], a[212:215]
 s_waitcnt lgkmcnt(0)
 buffer_load_dwordx4 v5, s[8:11], s82 offen offset:1024 lds
 v_fma_f32 v22, v22, v30, -v30
 v_mfma_f32_16x16x32_bf16 a[212:215], a[116:119], a[204:207], a[212:215]
 v_fma_f32 v23, v23, v31, -v31
 v_cvt_pk_bf16_f32 v16, v20, v21
 v_mfma_f32_16x16x32_bf16 a[212:215], a[132:135], a[184:187], a[212:215]
 v_cvt_pk_bf16_f32 v17, v22, v23
 v_mul_f32 v32, s42, v180
 v_mfma_f32_16x16x32_bf16 a[212:215], a[148:151], a[188:191], a[212:215]
 v_mul_f32 v33, s42, v181
 v_mul_f32 v34, s42, v182
 v_mfma_f32_16x16x32_bf16 a[208:211], a[144:147], a[188:191], a[208:211]
 v_mul_f32 v35, s42, v183
 v_min_f32 v32, s47, v32
 v_mfma_f32_16x16x32_bf16 a[208:211], a[128:131], a[184:187], a[208:211]
 s_add_u32 m0, s29, 14336
 v_min_f32 v33, s47, v33
 v_min_f32 v34, s47, v34
 v_mfma_f32_16x16x32_bf16 a[208:211], a[112:115], a[204:207], a[208:211]
 buffer_load_dwordx4 v5, s[8:11], s83 offen offset:1024 lds
 v_min_f32 v35, s47, v35
 v_mfma_f32_16x16x32_bf16 a[208:211], a[96:99], a[160:163], a[208:211]
 v_exp_f32 v32, v32
 v_mfma_f32_16x16x32_bf16 a[208:211], a[80:83], a[164:167], a[208:211]
 v_mul_f32 v40, s43, v188
 v_mul_f32 v41, s43, v189
 v_mfma_f32_16x16x32_bf16 a[224:227], a[80:83], a[160:163], a[224:227]
 v_exp_f32 v33, v33
 v_mfma_f32_16x16x32_bf16 a[224:227], a[96:99], a[204:207], a[224:227]
 v_mul_f32 v42, s43, v190
 v_mul_f32 v43, s43, v191
 v_mfma_f32_16x16x32_bf16 a[224:227], a[112:115], a[184:187], a[224:227]
 s_add_u32 m0, s29, 16384
 v_exp_f32 v34, v34
 v_mfma_f32_16x16x32_bf16 a[224:227], a[128:131], a[188:191], a[224:227]
 buffer_load_dwordx4 v5, s[8:11], s84 offen offset:1024 lds
 v_add_f32 v28, 1.0, v32
 v_mfma_f32_16x16x32_bf16 a[224:227], a[144:147], a[200:203], a[224:227]
 v_exp_f32 v35, v35
 v_mfma_f32_16x16x32_bf16 a[228:231], a[148:151], a[200:203], a[228:231]
 v_exp_f32 v40, v40
 v_mfma_f32_16x16x32_bf16 a[228:231], a[132:135], a[188:191], a[228:231]
 v_add_f32 v29, 1.0, v33
 v_add_f32 v30, 1.0, v34
 v_mfma_f32_16x16x32_bf16 a[228:231], a[116:119], a[184:187], a[228:231]
 v_exp_f32 v41, v41
 v_mfma_f32_16x16x32_bf16 a[228:231], a[100:103], a[204:207], a[228:231]
 s_add_u32 m0, s29, 18432
 v_add_f32 v31, 1.0, v35
 v_fmac_f32 v28, v28, v40
 v_mfma_f32_16x16x32_bf16 a[228:231], a[84:87], a[160:163], a[228:231]
 buffer_load_dwordx4 v5, s[8:11], s85 offen offset:1024 lds
 v_fmac_f32 v29, v29, v41
 v_mfma_f32_16x16x32_bf16 a[232:235], a[88:91], a[160:163], a[232:235]
 s_add_u32 s8, s8, 0x10000
 s_addc_u32 s9, s9, 0
 v_mfma_f32_16x16x32_bf16 a[232:235], a[104:107], a[204:207], a[232:235]
 v_exp_f32 v42, v42
 v_mfma_f32_16x16x32_bf16 a[232:235], a[120:123], a[184:187], a[232:235]
 v_exp_f32 v43, v43
 v_mfma_f32_16x16x32_bf16 a[232:235], a[136:139], a[188:191], a[232:235]
 v_fmac_f32 v30, v30, v42
 v_fmac_f32 v31, v31, v43
 v_mfma_f32_16x16x32_bf16 a[232:235], a[152:155], a[200:203], a[232:235]
 v_rcp_f32 v28, v28
 v_mfma_f32_16x16x32_bf16 a[236:239], a[156:159], a[200:203], a[236:239]
 v_rcp_f32 v29, v29
 v_mfma_f32_16x16x32_bf16 a[236:239], a[140:143], a[188:191], a[236:239]
 v_rcp_f32 v30, v30
 v_mfma_f32_16x16x32_bf16 a[236:239], a[124:127], a[184:187], a[236:239]
 v_rcp_f32 v31, v31
 v_mfma_f32_16x16x32_bf16 a[236:239], a[108:111], a[204:207], a[236:239]
 v_fma_f32 v32, v32, v28, -v28
 v_fma_f32 v33, v33, v29, -v29
 v_mfma_f32_16x16x32_bf16 a[236:239], a[92:95], a[160:163], a[236:239]
 s_waitcnt vmcnt(19)
 s_barrier
 v_fma_f32 v34, v34, v30, -v30
 v_mfma_f32_16x16x32_bf16 a[252:255], a[92:95], a[204:207], a[252:255]
 v_xor_b32 v1, 0x10000, v1
 v_xor_b32 v2, 0x10000, v2
 v_mfma_f32_16x16x32_bf16 a[252:255], a[108:111], a[184:187], a[252:255]
 v_xor_b32 v3, 0x10000, v3
 v_xor_b32 v4, 0x10000, v4
 v_mfma_f32_16x16x32_bf16 a[252:255], a[124:127], a[188:191], a[252:255]
 ds_read_b128 a[160:163], v1 offset:0
 ds_read_b128 a[164:167], v1 offset:4352
 v_mfma_f32_16x16x32_bf16 a[252:255], a[140:143], a[200:203], a[252:255]
 ds_read_b128 a[168:171], v1 offset:8704
 ds_read_b128 a[172:175], v1 offset:13056
 v_mfma_f32_16x16x32_bf16 a[252:255], a[156:159], a[196:199], a[252:255]
 ds_read_b128 a[176:179], v1 offset:17408
 ds_read_b128 a[180:183], v1 offset:21760
 v_mfma_f32_16x16x32_bf16 a[248:251], a[152:155], a[196:199], a[248:251]
 v_fma_f32 v35, v35, v31, -v31
 v_cvt_pk_bf16_f32 v18, v32, v33
 v_mfma_f32_16x16x32_bf16 a[248:251], a[136:139], a[200:203], a[248:251]
 s_add_u32 s46, s40, 1024
 v_cvt_pk_bf16_f32 v19, v34, v35
 buffer_store_dwordx4 v[16:19], v6, s[12:15], s46 offen
 v_mfma_f32_16x16x32_bf16 a[248:251], a[120:123], a[188:191], a[248:251]
 v_mfma_f32_16x16x32_bf16 a[248:251], a[104:107], a[184:187], a[248:251]
 v_mfma_f32_16x16x32_bf16 a[248:251], a[88:91], a[204:207], a[248:251]
 v_mfma_f32_16x16x32_bf16 a[244:247], a[84:87], a[204:207], a[244:247]
 v_mfma_f32_16x16x32_bf16 a[244:247], a[100:103], a[184:187], a[244:247]
 v_mfma_f32_16x16x32_bf16 a[244:247], a[116:119], a[188:191], a[244:247]
 v_mfma_f32_16x16x32_bf16 a[244:247], a[132:135], a[200:203], a[244:247]
 v_mfma_f32_16x16x32_bf16 a[244:247], a[148:151], a[196:199], a[244:247]
 v_mfma_f32_16x16x32_bf16 a[240:243], a[144:147], a[196:199], a[240:243]
 v_mfma_f32_16x16x32_bf16 a[240:243], a[128:131], a[200:203], a[240:243]
 v_mfma_f32_16x16x32_bf16 a[240:243], a[112:115], a[188:191], a[240:243]
 v_mfma_f32_16x16x32_bf16 a[240:243], a[96:99], a[184:187], a[240:243]
 v_mfma_f32_16x16x32_bf16 a[240:243], a[80:83], a[204:207], a[240:243]
 s_cmp_eq_u32 s72, 15
 s_cbranch_scc1 L_p15
 s_cmp_eq_u32 s72, 14
 s_cbranch_scc1 L_p14
L_p16:
 s_waitcnt lgkmcnt(5)
 ds_read_b128 a[184:187], v1 offset:26112
 v_mul_f32 v20, s42, v192
 v_mul_f32 v21, s42, v193
 v_mfma_f32_16x16x32_bf16 v[48:51], a[0:3], a[160:163], 0
 s_waitcnt lgkmcnt(5)
 v_mul_f32 v22, s42, v194
 v_mul_f32 v23, s42, v195
 v_mfma_f32_16x16x32_bf16 v[48:51], a[16:19], a[164:167], v[48:51]
 s_waitcnt lgkmcnt(4)
 v_min_f32 v20, s47, v20
 v_min_f32 v21, s47, v21
 v_mfma_f32_16x16x32_bf16 v[48:51], a[32:35], a[168:171], v[48:51]
 s_waitcnt lgkmcnt(3)
 v_min_f32 v22, s47, v22
 v_min_f32 v23, s47, v23
 v_mfma_f32_16x16x32_bf16 v[48:51], a[48:51], a[172:175], v[48:51]
 s_waitcnt lgkmcnt(2)
 ds_read_b128 a[188:191], v1 offset:30464
 v_mul_f32 v24, s43, v200
 v_mfma_f32_16x16x32_bf16 v[48:51], a[64:67], a[176:179], v[48:51]
 v_exp_f32 v20, v20
 v_mfma_f32_16x16x32_bf16 v[52:55], a[68:71], a[176:179], 0
 v_mul_f32 v25, s43, v201
 v_mul_f32 v26, s43, v202
 v_mfma_f32_16x16x32_bf16 v[52:55], a[52:55], a[172:175], v[52:55]
 s_add_u32 m0, s26, 0
 v_exp_f32 v21, v21
 v_mfma_f32_16x16x32_bf16 v[52:55], a[36:39], a[168:171], v[52:55]
 buffer_load_dwordx4 v7, s[4:7], 0 offen nt lds
 v_mul_f32 v27, s43, v203
 v_add_f32 v28, 1.0, v20
 v_mfma_f32_16x16x32_bf16 v[52:55], a[20:23], a[164:167], v[52:55]
 v_exp_f32 v22, v22
 v_mfma_f32_16x16x32_bf16 v[52:55], a[4:7], a[160:163], v[52:55]
 v_exp_f32 v23, v23
 v_mfma_f32_16x16x32_bf16 v[56:59], a[8:11], a[160:163], 0
 v_exp_f32 v24, v24
 v_mfma_f32_16x16x32_bf16 v[56:59], a[24:27], a[164:167], v[56:59]
 v_add_f32 v29, 1.0, v21
 v_add_f32 v30, 1.0, v22
 v_mfma_f32_16x16x32_bf16 v[56:59], a[40:43], a[168:171], v[56:59]
 v_exp_f32 v25, v25
 v_mfma_f32_16x16x32_bf16 v[56:59], a[56:59], a[172:175], v[56:59]
 v_add_f32 v31, 1.0, v23
 v_fmac_f32 v28, v28, v24
 v_mfma_f32_16x16x32_bf16 v[56:59], a[72:75], a[176:179], v[56:59]
 v_exp_f32 v26, v26
 v_mfma_f32_16x16x32_bf16 v[60:63], a[76:79], a[176:179], 0
 v_exp_f32 v27, v27
 v_fmac_f32 v29, v29, v25
 v_mfma_f32_16x16x32_bf16 v[60:63], a[60:63], a[172:175], v[60:63]
 v_fmac_f32 v30, v30, v26
 v_fmac_f32 v31, v31, v27
 v_mfma_f32_16x16x32_bf16 v[60:63], a[44:47], a[168:171], v[60:63]
 v_rcp_f32 v28, v28
 v_mfma_f32_16x16x32_bf16 v[60:63], a[28:31], a[164:167], v[60:63]
 v_rcp_f32 v29, v29
 v_mfma_f32_16x16x32_bf16 v[60:63], a[12:15], a[160:163], v[60:63]
 v_rcp_f32 v30, v30
 v_mfma_f32_16x16x32_bf16 v[76:79], a[12:15], a[164:167], 0
 v_rcp_f32 v31, v31
 v_mfma_f32_16x16x32_bf16 v[76:79], a[28:31], a[168:171], v[76:79]
 v_fma_f32 v20, v20, v28, -v28
 v_fma_f32 v21, v21, v29, -v29
 v_mfma_f32_16x16x32_bf16 v[76:79], a[44:47], a[172:175], v[76:79]
 v_fma_f32 v22, v22, v30, -v30
 v_fma_f32 v23, v23, v31, -v31
 v_mfma_f32_16x16x32_bf16 v[76:79], a[60:63], a[176:179], v[76:79]
 s_waitcnt lgkmcnt(0)
 ds_read_b128 a[192:195], v3 offset:0
 v_cvt_pk_bf16_f32 v16, v20, v21
 v_cvt_pk_bf16_f32 v17, v22, v23
 v_mfma_f32_16x16x32_bf16 v[76:79], a[76:79], a[180:183], v[76:79]
 v_mul_f32 v32, s42, v196
 v_mul_f32 v33, s42, v197
 v_mfma_f32_16x16x32_bf16 v[72:75], a[72:75], a[180:183], 0
 v_mul_f32 v34, s42, v198
 v_mul_f32 v35, s42, v199
 v_mfma_f32_16x16x32_bf16 v[72:75], a[56:59], a[176:179], v[72:75]
 v_min_f32 v32, s47, v32
 v_min_f32 v33, s47, v33
 v_mfma_f32_16x16x32_bf16 v[72:75], a[40:43], a[172:175], v[72:75]
 v_min_f32 v34, s47, v34
 v_min_f32 v35, s47, v35
 v_mfma_f32_16x16x32_bf16 v[72:75], a[24:27], a[168:171], v[72:75]
 v_exp_f32 v32, v32
 v_mfma_f32_16x16x32_bf16 v[72:75], a[8:11], a[164:167], v[72:75]
 v_mul_f32 v40, s43, v204
 v_mul_f32 v41, s43, v205
 v_mfma_f32_16x16x32_bf16 v[68:71], a[4:7], a[164:167], 0
 v_exp_f32 v33, v33
 v_mfma_f32_16x16x32_bf16 v[68:71], a[20:23], a[168:171], v[68:71]
 v_mul_f32 v42, s43, v206
 v_mul_f32 v43, s43, v207
 v_add_f32 v28, 1.0, v32
 v_mfma_f32_16x16x32_bf16 v[68:71], a[36:39], a[172:175], v[68:71]
 v_exp_f32 v34, v34
 v_mfma_f32_16x16x32_bf16 v[68:71], a[52:55], a[176:179], v[68:71]
 v_exp_f32 v35, v35
 v_mfma_f32_16x16x32_bf16 v[68:71], a[68:71], a[180:183], v[68:71]
 v_exp_f32 v40, v40
 v_mfma_f32_16x16x32_bf16 v[64:67], a[64:67], a[180:183], 0
 v_add_f32 v29, 1.0, v33
 v_add_f32 v30, 1.0, v34
 v_mfma_f32_16x16x32_bf16 v[64:67], a[48:51], a[176:179], v[64:67]
 v_exp_f32 v41, v41
 v_mfma_f32_16x16x32_bf16 v[64:67], a[32:35], a[172:175], v[64:67]
 v_add_f32 v31, 1.0, v35
 v_fmac_f32 v28, v28, v40
 v_mfma_f32_16x16x32_bf16 v[64:67], a[16:19], a[168:171], v[64:67]
 v_exp_f32 v42, v42
 v_mfma_f32_16x16x32_bf16 v[64:67], a[0:3], a[164:167], v[64:67]
 ds_read_b64_tr_b16 a[80:81], v46 offset:0
 v_exp_f32 v43, v43
 v_mfma_f32_16x16x32_bf16 v[80:83], a[0:3], a[168:171], 0
 v_fmac_f32 v29, v29, v41
 v_fmac_f32 v30, v30, v42
 v_mfma_f32_16x16x32_bf16 v[80:83], a[16:19], a[172:175], v[80:83]
 ds_read_b64_tr_b16 a[82:83], v46 offset:256
 v_fmac_f32 v31, v31, v43
 v_mfma_f32_16x16x32_bf16 v[80:83], a[32:35], a[176:179], v[80:83]
 v_rcp_f32 v28, v28
 v_mfma_f32_16x16x32_bf16 v[80:83], a[48:51], a[180:183], v[80:83]
 s_add_u32 m0, s26, 1024
 ds_read_b128 a[196:199], v3 offset:4352
 ds_read_b64_tr_b16 a[84:85], v46 offset:8
 v_mfma_f32_16x16x32_bf16 v[80:83], a[64:67], a[184:187], v[80:83]
 buffer_load_dwordx4 v8, s[4:7], 0 offen nt lds
 v_fma_f32 v32, v32, v28, -v28
 v_mfma_f32_16x16x32_bf16 v[84:87], a[68:71], a[184:187], 0
 ds_read_b64_tr_b16 a[86:87], v46 offset:264
 v_mul_f32 v20, s42, v208
 v_mfma_f32_16x16x32_bf16 v[84:87], a[52:55], a[180:183], v[84:87]
 v_rcp_f32 v29, v29
 v_mfma_f32_16x16x32_bf16 v[84:87], a[36:39], a[176:179], v[84:87]
 s_waitcnt vmcnt(20)
 ds_read_b64_tr_b16 a[96:97], v46 offset:4096
 v_rcp_f32 v30, v30
 v_mfma_f32_16x16x32_bf16 v[84:87], a[20:23], a[172:175], v[84:87]
 v_rcp_f32 v31, v31
 v_mfma_f32_16x16x32_bf16 v[84:87], a[4:7], a[168:171], v[84:87]
 ds_read_b64_tr_b16 a[98:99], v46 offset:4352
 v_fma_f32 v33, v33, v29, -v29
 v_mfma_f32_16x16x32_bf16 v[88:91], a[8:11], a[168:171], 0
 v_fma_f32 v34, v34, v30, -v30
 v_fma_f32 v35, v35, v31, -v31
 v_mfma_f32_16x16x32_bf16 v[88:91], a[24:27], a[172:175], v[88:91]
 s_add_u32 m0, s29, 0
 ds_read_b64_tr_b16 a[100:101], v46 offset:4104
 v_cvt_pk_bf16_f32 v18, v32, v33
 v_mfma_f32_16x16x32_bf16 v[88:91], a[40:43], a[176:179], v[88:91]
 s_waitcnt lgkmcnt(3)
 buffer_load_dwordx4 v5, s[8:11], s76 offen offset:0 lds
 v_cvt_pk_bf16_f32 v19, v34, v35
 v_mfma_f32_16x16x32_bf16 v[88:91], a[56:59], a[180:183], v[88:91]
 s_add_u32 s46, s40, 3072
 ds_read_b64_tr_b16 a[102:103], v46 offset:4360
 buffer_store_dwordx4 v[16:19], v6, s[12:15], s46 offen
 v_mfma_f32_16x16x32_bf16 v[88:91], a[72:75], a[184:187], v[88:91]
 v_mul_f32 v21, s42, v209
 v_mul_f32 v22, s42, v210
 v_mfma_f32_16x16x32_bf16 v[92:95], a[76:79], a[184:187], 0
 s_waitcnt vmcnt(20)
 ds_read_b64_tr_b16 a[112:113], v46 offset:8192
 v_mul_f32 v23, s42, v211
 v_min_f32 v20, s47, v20
 v_mfma_f32_16x16x32_bf16 v[92:95], a[60:63], a[180:183], v[92:95]
 v_min_f32 v21, s47, v21
 v_min_f32 v22, s47, v22
 v_mfma_f32_16x16x32_bf16 v[92:95], a[44:47], a[176:179], v[92:95]
 ds_read_b64_tr_b16 a[114:115], v46 offset:8448
 v_min_f32 v23, s47, v23
 v_mfma_f32_16x16x32_bf16 v[92:95], a[28:31], a[172:175], v[92:95]
 v_exp_f32 v20, v20
 v_mfma_f32_16x16x32_bf16 v[92:95], a[12:15], a[168:171], v[92:95]
 ds_read_b64_tr_b16 a[116:117], v46 offset:8200
 v_mul_f32 v24, s43, v216
 v_mfma_f32_16x16x32_bf16 v[108:111], a[12:15], a[172:175], 0
 v_mul_f32 v25, s43, v217
 v_mul_f32 v26, s43, v218
 v_mfma_f32_16x16x32_bf16 v[108:111], a[28:31], a[176:179], v[108:111]
 ds_read_b64_tr_b16 a[118:119], v46 offset:8456
 v_mul_f32 v27, s43, v219
 v_mfma_f32_16x16x32_bf16 v[108:111], a[44:47], a[180:183], v[108:111]
 v_exp_f32 v21, v21
 v_mfma_f32_16x16x32_bf16 v[108:111], a[60:63], a[184:187], v[108:111]
 s_waitcnt vmcnt(18)
 ds_read_b128 a[200:203], v3 offset:8704
 ds_read_b64_tr_b16 a[128:129], v46 offset:12288
 v_add_f32 v28, 1.0, v20
 v_mfma_f32_16x16x32_bf16 v[108:111], a[76:79], a[188:191], v[108:111]
 s_add_u32 m0, s29, 2048
 v_exp_f32 v22, v22
 v_mfma_f32_16x16x32_bf16 v[104:107], a[72:75], a[188:191], 0
 ds_read_b64_tr_b16 a[130:131], v46 offset:12544
 buffer_load_dwordx4 v5, s[8:11], s77 offen offset:0 lds
 v_mfma_f32_16x16x32_bf16 v[104:107], a[56:59], a[184:187], v[104:107]
 v_exp_f32 v23, v23
 v_mfma_f32_16x16x32_bf16 v[104:107], a[40:43], a[180:183], v[104:107]
 ds_read_b64_tr_b16 a[132:133], v46 offset:12296
 v_add_f32 v29, 1.0, v21
 v_mfma_f32_16x16x32_bf16 v[104:107], a[24:27], a[176:179], v[104:107]
 v_exp_f32 v24, v24
 v_mfma_f32_16x16x32_bf16 v[104:107], a[8:11], a[172:175], v[104:107]
 ds_read_b64_tr_b16 a[134:135], v46 offset:12552
 v_add_f32 v30, 1.0, v22
 v_mfma_f32_16x16x32_bf16 v[100:103], a[4:7], a[172:175], 0
 v_exp_f32 v25, v25
 v_mfma_f32_16x16x32_bf16 v[100:103], a[20:23], a[176:179], v[100:103]
 s_waitcnt vmcnt(17)
 ds_read_b64_tr_b16 a[144:145], v46 offset:16384
 v_add_f32 v31, 1.0, v23
 v_fmac_f32 v28, v28, v24
 v_mfma_f32_16x16x32_bf16 v[100:103], a[36:39], a[180:183], v[100:103]
 v_exp_f32 v26, v26
 v_mfma_f32_16x16x32_bf16 v[100:103], a[52:55], a[184:187], v[100:103]
 ds_read_b64_tr_b16 a[146:147], v46 offset:16640
 v_fmac_f32 v29, v29, v25
 v_mfma_f32_16x16x32_bf16 v[100:103], a[68:71], a[188:191], v[100:103]
 v_exp_f32 v27, v27
 v_mfma_f32_16x16x32_bf16 v[96:99], a[64:67], a[188:191], 0
 ds_read_b64_tr_b16 a[148:149], v46 offset:16392
 v_fmac_f32 v30, v30, v26
 v_mfma_f32_16x16x32_bf16 v[96:99], a[48:51], a[184:187], v[96:99]
 v_fmac_f32 v31, v31, v27
 v_mul_f32 v32, s42, v212
 v_mfma_f32_16x16x32_bf16 v[96:99], a[32:35], a[180:183], v[96:99]
 s_add_u32 m0, s29, 4096
 ds_read_b64_tr_b16 a[150:151], v46 offset:16648
 v_mul_f32 v33, s42, v213
 v_mfma_f32_16x16x32_bf16 v[96:99], a[16:19], a[176:179], v[96:99]
 s_waitcnt lgkmcnt(6)
 buffer_load_dwordx4 v5, s[8:11], s78 offen offset:0 lds
 v_mul_f32 v34, s42, v214
 v_mfma_f32_16x16x32_bf16 v[96:99], a[0:3], a[172:175], v[96:99]
 s_waitcnt vmcnt(16)
 ds_read_b64_tr_b16 a[88:89], v46 offset:1024
 v_rcp_f32 v28, v28
 v_mfma_f32_16x16x32_bf16 v[112:115], a[0:3], a[176:179], 0
 s_add_u32 m0, s26, 2048
 v_rcp_f32 v29, v29
 v_mfma_f32_16x16x32_bf16 v[112:115], a[16:19], a[180:183], v[112:115]
 ds_read_b64_tr_b16 a[90:91], v46 offset:1280
 buffer_load_dwordx4 v9, s[4:7], 0 offen nt lds
 v_mfma_f32_16x16x32_bf16 v[112:115], a[32:35], a[184:187], v[112:115]
 v_rcp_f32 v30, v30
 v_mfma_f32_16x16x32_bf16 v[112:115], a[48:51], a[188:191], v[112:115]
 ds_read_b128 a[160:163], v3 offset:13056
 ds_read_b64_tr_b16 a[92:93], v46 offset:1032
 v_mfma_f32_16x16x32_bf16 v[112:115], a[64:67], a[192:195], v[112:115]
 v_rcp_f32 v31, v31
 v_mfma_f32_16x16x32_bf16 v[116:119], a[68:71], a[192:195], 0
 ds_read_b64_tr_b16 a[94:95], v46 offset:1288
 v_fma_f32 v20, v20, v28, -v28
 v_mfma_f32_16x16x32_bf16 v[116:119], a[52:55], a[188:191], v[116:119]
 v_fma_f32 v21, v21, v29, -v29
 v_fma_f32 v22, v22, v30, -v30
 v_mfma_f32_16x16x32_bf16 v[116:119], a[36:39], a[184:187], v[116:119]
 s_waitcnt vmcnt(14)
 ds_read_b64_tr_b16 a[104:105], v46 offset:5120
 v_fma_f32 v23, v23, v31, -v31
 v_cvt_pk_bf16_f32 v16, v20, v21
 v_mfma_f32_16x16x32_bf16 v[116:119], a[20:23], a[180:183], v[116:119]
 v_cvt_pk_bf16_f32 v17, v22, v23
 v_mul_f32 v35, s42, v215
 v_mfma_f32_16x16x32_bf16 v[116:119], a[4:7], a[176:179], v[116:119]
 ds_read_b64_tr_b16 a[106:107], v46 offset:5376
 v_min_f32 v32, s47, v32
 v_mfma_f32_16x16x32_bf16 v[120:123], a[8:11], a[176:179], 0
 s_add_u32 m0, s29, 6144
 v_min_f32 v33, s47, v33
 v_min_f32 v34, s47, v34
 v_mfma_f32_16x16x32_bf16 v[120:123], a[24:27], a[180:183], v[120:123]
 ds_read_b64_tr_b16 a[108:109], v46 offset:5128
 buffer_load_dwordx4 v5, s[8:11], s79 offen offset:0 lds
 v_mfma_f32_16x16x32_bf16 v[120:123], a[40:43], a[184:187], v[120:123]
 v_min_f32 v35, s47, v35
 v_mul_f32 v40, s43, v220
 v_mfma_f32_16x16x32_bf16 v[120:123], a[56:59], a[188:191], v[120:123]
 ds_read_b64_tr_b16 a[110:111], v46 offset:5384
 v_mul_f32 v41, s43, v221
 v_mfma_f32_16x16x32_bf16 v[120:123], a[72:75], a[192:195], v[120:123]
 v_exp_f32 v32, v32
 v_mfma_f32_16x16x32_bf16 v[124:127], a[76:79], a[192:195], 0
 s_waitcnt vmcnt(13)
 ds_read_b64_tr_b16 a[120:121], v46 offset:9216
 v_exp_f32 v33, v33
 v_mfma_f32_16x16x32_bf16 v[124:127], a[60:63], a[188:191], v[124:127]
 v_mul_f32 v42, s43, v222
 v_mul_f32 v43, s43, v223
 v_mfma_f32_16x16x32_bf16 v[124:127], a[44:47], a[184:187], v[124:127]
 ds_read_b64_tr_b16 a[122:123], v46 offset:9472
 v_add_f32 v28, 1.0, v32
 v_mfma_f32_16x16x32_bf16 v[124:127], a[28:31], a[180:183], v[124:127]
 v_exp_f32 v34, v34
 v_mfma_f32_16x16x32_bf16 v[124:127], a[12:15], a[176:179], v[124:127]
 ds_read_b128 a[204:207], v2 offset:0
 ds_read_b64_tr_b16 a[124:125], v46 offset:9224
 v_mfma_f32_16x16x32_bf16 v[140:143], a[12:15], a[180:183], 0
 ds_read_b128 a[164:167], v2 offset:4352
 v_add_f32 v29, 1.0, v33
 v_mfma_f32_16x16x32_bf16 v[140:143], a[28:31], a[184:187], v[140:143]
 ds_read_b64_tr_b16 a[126:127], v46 offset:9480
 v_add_f32 v30, 1.0, v34
 v_mfma_f32_16x16x32_bf16 v[140:143], a[44:47], a[188:191], v[140:143]
 v_exp_f32 v35, v35
 v_mfma_f32_16x16x32_bf16 v[140:143], a[60:63], a[192:195], v[140:143]
 s_waitcnt vmcnt(11)
 s_add_u32 m0, s29, 8192
 ds_read_b64_tr_b16 a[136:137], v46 offset:13312
 v_add_f32 v31, 1.0, v35
 v_mfma_f32_16x16x32_bf16 v[140:143], a[76:79], a[196:199], v[140:143]
 buffer_load_dwordx4 v5, s[8:11], s80 offen offset:0 lds
 v_mul_f32 v20, s42, v224
 v_mfma_f32_16x16x32_bf16 v[136:139], a[72:75], a[196:199], 0
 ds_read_b64_tr_b16 a[138:139], v46 offset:13568
 v_mul_f32 v21, s42, v225
 v_mfma_f32_16x16x32_bf16 v[136:139], a[56:59], a[192:195], v[136:139]
 v_exp_f32 v40, v40
 v_mfma_f32_16x16x32_bf16 v[136:139], a[40:43], a[188:191], v[136:139]
 ds_read_b64_tr_b16 a[140:141], v46 offset:13320
 v_fmac_f32 v28, v28, v40
 v_mfma_f32_16x16x32_bf16 v[136:139], a[24:27], a[184:187], v[136:139]
 v_exp_f32 v41, v41
 v_mfma_f32_16x16x32_bf16 v[136:139], a[8:11], a[180:183], v[136:139]
 ds_read_b64_tr_b16 a[142:143], v46 offset:13576
 v_fmac_f32 v29, v29, v41
 v_mfma_f32_16x16x32_bf16 v[132:135], a[4:7], a[180:183], 0
 v_exp_f32 v42, v42
 v_mfma_f32_16x16x32_bf16 v[132:135], a[20:23], a[184:187], v[132:135]
 s_waitcnt vmcnt(10)
 ds_read_b64_tr_b16 a[152:153], v46 offset:17408
 v_exp_f32 v43, v43
 v_mfma_f32_16x16x32_bf16 v[132:135], a[36:39], a[188:191], v[132:135]
 v_fmac_f32 v30, v30, v42
 v_fmac_f32 v31, v31, v43
 v_mfma_f32_16x16x32_bf16 v[132:135], a[52:55], a[192:195], v[132:135]
 ds_read_b64_tr_b16 a[154:155], v46 offset:17664
 v_mul_f32 v22, s42, v226
 v_mfma_f32_16x16x32_bf16 v[132:135], a[68:71], a[196:199], v[132:135]
 v_rcp_f32 v28, v28
 v_mfma_f32_16x16x32_bf16 v[128:131], a[64:67], a[196:199], 0
 ds_read_b64_tr_b16 a[156:157], v46 offset:17416
 v_fma_f32 v32, v32, v28, -v28
 v_mfma_f32_16x16x32_bf16 v[128:131], a[48:51], a[192:195], v[128:131]
 s_add_u32 m0, s29, 10240
 v_rcp_f32 v29, v29
 v_mfma_f32_16x16x32_bf16 v[128:131], a[32:35], a[188:191], v[128:131]
 ds_read_b64_tr_b16 a[158:159], v46 offset:17672
 buffer_load_dwordx4 v5, s[8:11], s81 offen offset:0 lds
 v_mfma_f32_16x16x32_bf16 v[128:131], a[16:19], a[184:187], v[128:131]
 v_rcp_f32 v30, v30
 v_mfma_f32_16x16x32_bf16 v[128:131], a[0:3], a[180:183], v[128:131]
 s_add_u32 m0, s26, 3072
 ds_read_b128 a[180:183], v2 offset:8704
 ds_read_b128 a[168:171], v2 offset:13056
 v_fma_f32 v33, v33, v29, -v29
 v_mfma_f32_16x16x32_bf16 v[144:147], a[0:3], a[184:187], 0
 ds_read_b128 a[176:179], v2 offset:17408
 buffer_load_dwordx4 v10, s[4:7], 0 offen nt lds
 v_mfma_f32_16x16x32_bf16 v[144:147], a[16:19], a[188:191], v[144:147]
 v_rcp_f32 v31, v31
 v_mfma_f32_16x16x32_bf16 v[144:147], a[32:35], a[192:195], v[144:147]
 v_fma_f32 v34, v34, v30, -v30
 v_fma_f32 v35, v35, v31, -v31
 v_mfma_f32_16x16x32_bf16 v[144:147], a[48:51], a[196:199], v[144:147]
 ds_read_b128 a[172:175], v2 offset:21760
 v_cvt_pk_bf16_f32 v18, v32, v33
 v_mfma_f32_16x16x32_bf16 v[144:147], a[64:67], a[200:203], v[144:147]
 s_add_u32 s46, s40, 5120
 v_cvt_pk_bf16_f32 v19, v34, v35
 buffer_store_dwordx4 v[16:19], v6, s[12:15], s46 offen
 v_mfma_f32_16x16x32_bf16 v[148:151], a[68:71], a[200:203], 0
 v_mul_f32 v23, s42, v227
 v_min_f32 v20, s47, v20
 v_mfma_f32_16x16x32_bf16 v[148:151], a[52:55], a[196:199], v[148:151]
 v_min_f32 v21, s47, v21
 v_min_f32 v22, s47, v22
 v_mfma_f32_16x16x32_bf16 v[148:151], a[36:39], a[192:195], v[148:151]
 v_min_f32 v23, s47, v23
 v_exp_f32 v20, v20
 v_mfma_f32_16x16x32_bf16 v[148:151], a[20:23], a[188:191], v[148:151]
 v_mul_f32 v24, s43, v232
 v_mul_f32 v25, s43, v233
 v_mfma_f32_16x16x32_bf16 v[148:151], a[4:7], a[184:187], v[148:151]
 s_add_u32 m0, s29, 12288
 v_exp_f32 v21, v21
 v_mfma_f32_16x16x32_bf16 v[152:155], a[8:11], a[184:187], 0
 s_waitcnt lgkmcnt(4)
 buffer_load_dwordx4 v5, s[8:11], s82 offen offset:0 lds
 v_mul_f32 v26, s43, v234
 v_mfma_f32_16x16x32_bf16 v[152:155], a[24:27], a[188:191], v[152:155]
 v_mul_f32 v27, s43, v235
 v_add_f32 v28, 1.0, v20
 v_mfma_f32_16x16x32_bf16 v[152:155], a[40:43], a[192:195], v[152:155]
 v_exp_f32 v22, v22
 v_mfma_f32_16x16x32_bf16 v[152:155], a[56:59], a[196:199], v[152:155]
 v_exp_f32 v23, v23
 v_mfma_f32_16x16x32_bf16 v[152:155], a[72:75], a[200:203], v[152:155]
 v_exp_f32 v24, v24
 v_mfma_f32_16x16x32_bf16 v[156:159], a[76:79], a[200:203], 0
 v_add_f32 v29, 1.0, v21
 v_exp_f32 v25, v25
 v_mfma_f32_16x16x32_bf16 v[156:159], a[60:63], a[196:199], v[156:159]
 v_add_f32 v30, 1.0, v22
 v_add_f32 v31, 1.0, v23
 v_mfma_f32_16x16x32_bf16 v[156:159], a[44:47], a[192:195], v[156:159]
 v_exp_f32 v26, v26
 v_mfma_f32_16x16x32_bf16 v[156:159], a[28:31], a[188:191], v[156:159]
 v_exp_f32 v27, v27
 v_mfma_f32_16x16x32_bf16 v[156:159], a[12:15], a[184:187], v[156:159]
 v_fmac_f32 v28, v28, v24
 v_fmac_f32 v29, v29, v25
 v_mfma_f32_16x16x32_bf16 v[172:175], a[12:15], a[188:191], 0
 v_fmac_f32 v30, v30, v26
 v_fmac_f32 v31, v31, v27
 v_mfma_f32_16x16x32_bf16 v[172:175], a[28:31], a[192:195], v[172:175]
 v_rcp_f32 v28, v28
 v_mfma_f32_16x16x32_bf16 v[172:175], a[44:47], a[196:199], v[172:175]
 s_add_u32 m0, s29, 14336
 v_rcp_f32 v29, v29
 v_mfma_f32_16x16x32_bf16 v[172:175], a[60:63], a[200:203], v[172:175]
 ds_read_b128 a[184:187], v2 offset:26112
 buffer_load_dwordx4 v5, s[8:11], s83 offen offset:0 lds
 v_fma_f32 v20, v20, v28, -v28
 v_mfma_f32_16x16x32_bf16 v[172:175], a[76:79], a[160:163], v[172:175]
 v_rcp_f32 v30, v30
 v_mfma_f32_16x16x32_bf16 v[168:171], a[72:75], a[160:163], 0
 v_rcp_f32 v31, v31
 v_mfma_f32_16x16x32_bf16 v[168:171], a[56:59], a[200:203], v[168:171]
 v_fma_f32 v21, v21, v29, -v29
 v_fma_f32 v22, v22, v30, -v30
 v_mfma_f32_16x16x32_bf16 v[168:171], a[40:43], a[196:199], v[168:171]
 v_fma_f32 v23, v23, v31, -v31
 v_cvt_pk_bf16_f32 v16, v20, v21
 v_mfma_f32_16x16x32_bf16 v[168:171], a[24:27], a[192:195], v[168:171]
 v_cvt_pk_bf16_f32 v17, v22, v23
 v_mul_f32 v32, s42, v228
 v_mfma_f32_16x16x32_bf16 v[168:171], a[8:11], a[188:191], v[168:171]
 v_mul_f32 v33, s42, v229
 v_mul_f32 v34, s42, v230
 v_mfma_f32_16x16x32_bf16 v[164:167], a[4:7], a[188:191], 0
 v_mul_f32 v35, s42, v231
 v_min_f32 v32, s47, v32
 v_mfma_f32_16x16x32_bf16 v[164:167], a[20:23], a[192:195], v[164:167]
 v_min_f32 v33, s47, v33
 v_min_f32 v34, s47, v34
 v_min_f32 v35, s47, v35
 v_mfma_f32_16x16x32_bf16 v[164:167], a[36:39], a[196:199], v[164:167]
 v_exp_f32 v32, v32
 v_mfma_f32_16x16x32_bf16 v[164:167], a[52:55], a[200:203], v[164:167]
 v_mul_f32 v40, s43, v236
 v_mul_f32 v41, s43, v237
 v_mfma_f32_16x16x32_bf16 v[164:167], a[68:71], a[160:163], v[164:167]
 v_exp_f32 v33, v33
 v_mfma_f32_16x16x32_bf16 v[160:163], a[64:67], a[160:163], 0
 s_add_u32 m0, s29, 16384
 v_mul_f32 v42, s43, v238
 v_mul_f32 v43, s43, v239
 v_mfma_f32_16x16x32_bf16 v[160:163], a[48:51], a[200:203], v[160:163]
 buffer_load_dwordx4 v5, s[8:11], s84 offen offset:0 lds
 v_add_f32 v28, 1.0, v32
 v_mfma_f32_16x16x32_bf16 v[160:163], a[32:35], a[196:199], v[160:163]
 s_add_u32 m0, s26, 4096
 v_exp_f32 v34, v34
 v_mfma_f32_16x16x32_bf16 v[160:163], a[16:19], a[192:195], v[160:163]
 buffer_load_dwordx4 v11, s[4:7], 0 offen nt lds
 v_add_f32 v29, 1.0, v33
 v_mfma_f32_16x16x32_bf16 v[160:163], a[0:3], a[188:191], v[160:163]
 v_exp_f32 v35, v35
 v_add_f32 v30, 1.0, v34
 v_mfma_f32_16x16x32_bf16 v[48:51], a[80:83], a[204:207], v[48:51]
 v_exp_f32 v40, v40
 v_mfma_f32_16x16x32_bf16 v[48:51], a[96:99], a[164:167], v[48:51]
 s_waitcnt lgkmcnt(0)
 v_exp_f32 v41, v41
 v_mfma_f32_16x16x32_bf16 v[48:51], a[112:115], a[180:183], v[48:51]
 v_add_f32 v31, 1.0, v35
 v_fmac_f32 v28, v28, v40
 v_mfma_f32_16x16x32_bf16 v[48:51], a[128:131], a[168:171], v[48:51]
 ds_read_b128 a[160:163], v2 offset:30464
 v_fmac_f32 v29, v29, v41
 v_mfma_f32_16x16x32_bf16 v[48:51], a[144:147], a[176:179], v[48:51]
 v_exp_f32 v42, v42
 v_mfma_f32_16x16x32_bf16 v[52:55], a[148:151], a[176:179], v[52:55]
 v_exp_f32 v43, v43
 v_mfma_f32_16x16x32_bf16 v[52:55], a[132:135], a[168:171], v[52:55]
 v_fmac_f32 v30, v30, v42
 v_fmac_f32 v31, v31, v43
 v_mfma_f32_16x16x32_bf16 v[52:55], a[116:119], a[180:183], v[52:55]
 v_rcp_f32 v28, v28
 v_mul_f32 v20, s42, v240
 v_mfma_f32_16x16x32_bf16 v[52:55], a[100:103], a[164:167], v[52:55]
 s_add_u32 m0, s29, 18432
 v_rcp_f32 v29, v29
 v_mfma_f32_16x16x32_bf16 v[52:55], a[84:87], a[204:207], v[52:55]
 buffer_load_dwordx4 v5, s[8:11], s85 offen offset:0 lds
 v_fma_f32 v32, v32, v28, -v28
 v_mfma_f32_16x16x32_bf16 v[56:59], a[88:91], a[204:207], v[56:59]
 v_rcp_f32 v30, v30
 v_mfma_f32_16x16x32_bf16 v[56:59], a[104:107], a[164:167], v[56:59]
 v_rcp_f32 v31, v31
 v_mfma_f32_16x16x32_bf16 v[56:59], a[120:123], a[180:183], v[56:59]
 v_fma_f32 v33, v33, v29, -v29
 v_fma_f32 v34, v34, v30, -v30
 v_mfma_f32_16x16x32_bf16 v[56:59], a[136:139], a[168:171], v[56:59]
 v_fma_f32 v35, v35, v31, -v31
 v_cvt_pk_bf16_f32 v18, v32, v33
 v_mfma_f32_16x16x32_bf16 v[56:59], a[152:155], a[176:179], v[56:59]
 s_add_u32 s46, s40, 7168
 v_cvt_pk_bf16_f32 v19, v34, v35
 buffer_store_dwordx4 v[16:19], v6, s[12:15], s46 offen
 v_mfma_f32_16x16x32_bf16 v[60:63], a[156:159], a[176:179], v[60:63]
 v_mul_f32 v21, s42, v241
 v_mul_f32 v22, s42, v242
 v_mul_f32 v23, s42, v243
 v_mfma_f32_16x16x32_bf16 v[60:63], a[140:143], a[168:171], v[60:63]
 v_min_f32 v20, s47, v20
 v_min_f32 v21, s47, v21
 v_mfma_f32_16x16x32_bf16 v[60:63], a[124:127], a[180:183], v[60:63]
 v_min_f32 v22, s47, v22
 v_min_f32 v23, s47, v23
 v_mfma_f32_16x16x32_bf16 v[60:63], a[108:111], a[164:167], v[60:63]
 v_exp_f32 v20, v20
 v_mfma_f32_16x16x32_bf16 v[60:63], a[92:95], a[204:207], v[60:63]
 ds_read_b128 a[200:203], v1 offset:2176
 v_mul_f32 v24, s43, v248
 v_mfma_f32_16x16x32_bf16 v[76:79], a[92:95], a[164:167], v[76:79]
 ds_read_b128 a[196:199], v1 offset:6528
 v_mul_f32 v25, s43, v249
 v_mfma_f32_16x16x32_bf16 v[76:79], a[108:111], a[180:183], v[76:79]
 s_add_u32 m0, s29, 0
 ds_read_b128 a[192:195], v1 offset:10880
 v_mul_f32 v26, s43, v250
 v_mfma_f32_16x16x32_bf16 v[76:79], a[124:127], a[168:171], v[76:79]
 ds_read_b128 a[204:207], v1 offset:15232
 buffer_load_dwordx4 v5, s[8:11], s76 offen offset:1024 lds
 v_mfma_f32_16x16x32_bf16 v[76:79], a[140:143], a[176:179], v[76:79]
 v_exp_f32 v21, v21
 v_mul_f32 v27, s43, v251
 v_mfma_f32_16x16x32_bf16 v[76:79], a[156:159], a[172:175], v[76:79]
 v_exp_f32 v22, v22
 v_mfma_f32_16x16x32_bf16 v[72:75], a[152:155], a[172:175], v[72:75]
 v_exp_f32 v23, v23
 v_mfma_f32_16x16x32_bf16 v[72:75], a[136:139], a[176:179], v[72:75]
 v_exp_f32 v24, v24
 v_mfma_f32_16x16x32_bf16 v[72:75], a[120:123], a[168:171], v[72:75]
 v_add_f32 v28, 1.0, v20
 v_add_f32 v29, 1.0, v21
 v_mfma_f32_16x16x32_bf16 v[72:75], a[104:107], a[180:183], v[72:75]
 v_exp_f32 v25, v25
 v_mfma_f32_16x16x32_bf16 v[72:75], a[88:91], a[164:167], v[72:75]
 v_add_f32 v30, 1.0, v22
 v_add_f32 v31, 1.0, v23
 v_mfma_f32_16x16x32_bf16 v[68:71], a[84:87], a[164:167], v[68:71]
 v_exp_f32 v26, v26
 v_mfma_f32_16x16x32_bf16 v[68:71], a[100:103], a[180:183], v[68:71]
 v_exp_f32 v27, v27
 v_fmac_f32 v28, v28, v24
 v_mfma_f32_16x16x32_bf16 v[68:71], a[116:119], a[168:171], v[68:71]
 v_fmac_f32 v29, v29, v25
 v_fmac_f32 v30, v30, v26
 v_mfma_f32_16x16x32_bf16 v[68:71], a[132:135], a[176:179], v[68:71]
 v_fmac_f32 v31, v31, v27
 v_mul_f32 v32, s42, v244
 v_mfma_f32_16x16x32_bf16 v[68:71], a[148:151], a[172:175], v[68:71]
 s_add_u32 m0, s29, 2048
 v_rcp_f32 v28, v28
 v_mfma_f32_16x16x32_bf16 v[64:67], a[144:147], a[172:175], v[64:67]
 buffer_load_dwordx4 v5, s[8:11], s77 offen offset:1024 lds
 v_fma_f32 v20, v20, v28, -v28
 v_mfma_f32_16x16x32_bf16 v[64:67], a[128:131], a[176:179], v[64:67]
 s_add_u32 m0, s26, 5120
 v_rcp_f32 v29, v29
 v_mfma_f32_16x16x32_bf16 v[64:67], a[112:115], a[168:171], v[64:67]
 buffer_load_dwordx4 v12, s[4:7], 0 offen nt lds
 v_fma_f32 v21, v21, v29, -v29
 v_mfma_f32_16x16x32_bf16 v[64:67], a[96:99], a[180:183], v[64:67]
 v_rcp_f32 v30, v30
 v_mfma_f32_16x16x32_bf16 v[64:67], a[80:83], a[164:167], v[64:67]
 ds_read_b128 a[164:167], v1 offset:19584
 v_rcp_f32 v31, v31
 v_mfma_f32_16x16x32_bf16 v[80:83], a[80:83], a[180:183], v[80:83]
 v_fma_f32 v22, v22, v30, -v30
 v_fma_f32 v23, v23, v31, -v31
 v_mfma_f32_16x16x32_bf16 v[80:83], a[96:99], a[168:171], v[80:83]
 v_cvt_pk_bf16_f32 v16, v20, v21
 v_cvt_pk_bf16_f32 v17, v22, v23
 v_mfma_f32_16x16x32_bf16 v[80:83], a[112:115], a[176:179], v[80:83]
 v_mul_f32 v33, s42, v245
 v_mul_f32 v34, s42, v246
 v_mfma_f32_16x16x32_bf16 v[80:83], a[128:131], a[172:175], v[80:83]
 ds_read_b128 a[188:191], v1 offset:23936
 v_mul_f32 v35, s42, v247
 v_mfma_f32_16x16x32_bf16 v[80:83], a[144:147], a[184:187], v[80:83]
 v_min_f32 v32, s47, v32
 v_min_f32 v33, s47, v33
 v_mfma_f32_16x16x32_bf16 v[84:87], a[148:151], a[184:187], v[84:87]
 v_min_f32 v34, s47, v34
 v_min_f32 v35, s47, v35
 v_mfma_f32_16x16x32_bf16 v[84:87], a[132:135], a[172:175], v[84:87]
 v_exp_f32 v32, v32
 v_mfma_f32_16x16x32_bf16 v[84:87], a[116:119], a[176:179], v[84:87]
 s_add_u32 m0, s29, 4096
 v_mul_f32 v40, s43, v252
 v_mul_f32 v41, s43, v253
 v_mul_f32 v42, s43, v254
 v_mfma_f32_16x16x32_bf16 v[84:87], a[100:103], a[168:171], v[84:87]
 buffer_load_dwordx4 v5, s[8:11], s78 offen offset:1024 lds
 v_mul_f32 v43, s43, v255
 v_mfma_f32_16x16x32_bf16 v[84:87], a[84:87], a[180:183], v[84:87]
 v_exp_f32 v33, v33
 v_mfma_f32_16x16x32_bf16 v[88:91], a[88:91], a[180:183], v[88:91]
 v_exp_f32 v34, v34
 v_mfma_f32_16x16x32_bf16 v[88:91], a[104:107], a[168:171], v[88:91]
 v_exp_f32 v35, v35
 v_mfma_f32_16x16x32_bf16 v[88:91], a[120:123], a[176:179], v[88:91]
 v_exp_f32 v40, v40
 v_mfma_f32_16x16x32_bf16 v[88:91], a[136:139], a[172:175], v[88:91]
 v_add_f32 v28, 1.0, v32
 v_add_f32 v29, 1.0, v33
 v_mfma_f32_16x16x32_bf16 v[88:91], a[152:155], a[184:187], v[88:91]
 v_exp_f32 v41, v41
 v_mfma_f32_16x16x32_bf16 v[92:95], a[156:159], a[184:187], v[92:95]
 v_add_f32 v30, 1.0, v34
 v_add_f32 v31, 1.0, v35
 v_fmac_f32 v28, v28, v40
 v_mfma_f32_16x16x32_bf16 v[92:95], a[140:143], a[172:175], v[92:95]
 v_exp_f32 v42, v42
 v_mfma_f32_16x16x32_bf16 v[92:95], a[124:127], a[176:179], v[92:95]
 v_exp_f32 v43, v43
 v_mfma_f32_16x16x32_bf16 v[92:95], a[108:111], a[168:171], v[92:95]
 v_fmac_f32 v29, v29, v41
 v_fmac_f32 v30, v30, v42
 v_mfma_f32_16x16x32_bf16 v[92:95], a[92:95], a[180:183], v[92:95]
 v_fmac_f32 v31, v31, v43
 v_accvgpr_read_b32 v20, a208
 v_mfma_f32_16x16x32_bf16 v[108:111], a[92:95], a[168:171], v[108:111]
 s_add_u32 m0, s29, 6144
 v_rcp_f32 v28, v28
 v_mfma_f32_16x16x32_bf16 v[108:111], a[108:111], a[176:179], v[108:111]
 buffer_load_dwordx4 v5, s[8:11], s79 offen offset:1024 lds
 v_fma_f32 v32, v32, v28, -v28
 v_mfma_f32_16x16x32_bf16 v[108:111], a[124:127], a[172:175], v[108:111]
 v_rcp_f32 v29, v29
 v_mfma_f32_16x16x32_bf16 v[108:111], a[140:143], a[184:187], v[108:111]
 s_waitcnt lgkmcnt(0)
 v_rcp_f32 v30, v30
 v_fma_f32 v33, v33, v29, -v29
 v_mfma_f32_16x16x32_bf16 v[108:111], a[156:159], a[160:163], v[108:111]
 v_rcp_f32 v31, v31
 v_mfma_f32_16x16x32_bf16 v[104:107], a[152:155], a[160:163], v[104:107]
 v_fma_f32 v34, v34, v30, -v30
 v_fma_f32 v35, v35, v31, -v31
 v_mfma_f32_16x16x32_bf16 v[104:107], a[136:139], a[184:187], v[104:107]
 v_cvt_pk_bf16_f32 v18, v32, v33
 v_cvt_pk_bf16_f32 v19, v34, v35
 v_mfma_f32_16x16x32_bf16 v[104:107], a[120:123], a[172:175], v[104:107]
 s_add_u32 s46, s40, 9216
 buffer_store_dwordx4 v[16:19], v6, s[12:15], s46 offen
 v_accvgpr_read_b32 v24, a216
 v_mfma_f32_16x16x32_bf16 v[104:107], a[104:107], a[176:179], v[104:107]
 v_accvgpr_read_b32 v21, a209
 v_accvgpr_read_b32 v25, a217
 v_mfma_f32_16x16x32_bf16 v[104:107], a[88:91], a[168:171], v[104:107]
 v_accvgpr_read_b32 v22, a210
 v_accvgpr_read_b32 v26, a218
 v_mfma_f32_16x16x32_bf16 v[100:103], a[84:87], a[168:171], v[100:103]
 v_accvgpr_read_b32 v23, a211
 v_accvgpr_read_b32 v27, a219
 v_mfma_f32_16x16x32_bf16 v[100:103], a[100:103], a[176:179], v[100:103]
 v_mul_f32 v20, s42, v20
 v_mul_f32 v21, s42, v21
 v_mul_f32 v22, s42, v22
 v_mfma_f32_16x16x32_bf16 v[100:103], a[116:119], a[172:175], v[100:103]
 v_mul_f32 v23, s42, v23
 v_min_f32 v20, s47, v20
 v_mfma_f32_16x16x32_bf16 v[100:103], a[132:135], a[184:187], v[100:103]
 s_add_u32 m0, s29, 8192
 v_min_f32 v21, s47, v21
 v_min_f32 v22, s47, v22
 v_mfma_f32_16x16x32_bf16 v[100:103], a[148:151], a[160:163], v[100:103]
 buffer_load_dwordx4 v5, s[8:11], s80 offen offset:1024 lds
 v_min_f32 v23, s47, v23
 v_mfma_f32_16x16x32_bf16 v[96:99], a[144:147], a[160:163], v[96:99]
 s_add_u32 m0, s26, 6144
 v_exp_f32 v20, v20
 v_mfma_f32_16x16x32_bf16 v[96:99], a[128:131], a[184:187], v[96:99]
 buffer_load_dwordx4 v13, s[4:7], 0 offen nt lds
 v_mul_f32 v24, s43, v24
 v_mfma_f32_16x16x32_bf16 v[96:99], a[112:115], a[172:175], v[96:99]
 ds_read_b128 a[172:175], v1 offset:28288
 v_mul_f32 v25, s43, v25
 v_mfma_f32_16x16x32_bf16 v[96:99], a[96:99], a[176:179], v[96:99]
 v_exp_f32 v21, v21
 v_mfma_f32_16x16x32_bf16 v[96:99], a[80:83], a[168:171], v[96:99]
 v_mul_f32 v26, s43, v26
 v_mul_f32 v27, s43, v27
 v_add_f32 v28, 1.0, v20
 v_mfma_f32_16x16x32_bf16 v[176:179], a[0:3], a[200:203], 0
 v_exp_f32 v22, v22
 v_mfma_f32_16x16x32_bf16 v[176:179], a[16:19], a[196:199], v[176:179]
 v_exp_f32 v23, v23
 v_mfma_f32_16x16x32_bf16 v[176:179], a[32:35], a[192:195], v[176:179]
 v_exp_f32 v24, v24
 v_mfma_f32_16x16x32_bf16 v[176:179], a[48:51], a[204:207], v[176:179]
 ds_read_b128 a[180:183], v1 offset:32640
 v_add_f32 v29, 1.0, v21
 v_mfma_f32_16x16x32_bf16 v[176:179], a[64:67], a[164:167], v[176:179]
 v_exp_f32 v25, v25
 v_mfma_f32_16x16x32_bf16 v[180:183], a[68:71], a[164:167], 0
 v_add_f32 v30, 1.0, v22
 v_add_f32 v31, 1.0, v23
 v_mfma_f32_16x16x32_bf16 v[180:183], a[52:55], a[204:207], v[180:183]
 s_add_u32 m0, s29, 10240
 v_exp_f32 v26, v26
 v_mfma_f32_16x16x32_bf16 v[180:183], a[36:39], a[192:195], v[180:183]
 buffer_load_dwordx4 v5, s[8:11], s81 offen offset:1024 lds
 v_exp_f32 v27, v27
 v_mfma_f32_16x16x32_bf16 v[180:183], a[20:23], a[196:199], v[180:183]
 v_fmac_f32 v28, v28, v24
 v_fmac_f32 v29, v29, v25
 v_mfma_f32_16x16x32_bf16 v[180:183], a[4:7], a[200:203], v[180:183]
 v_fmac_f32 v30, v30, v26
 v_fmac_f32 v31, v31, v27
 v_mfma_f32_16x16x32_bf16 v[184:187], a[8:11], a[200:203], 0
 v_rcp_f32 v28, v28
 v_mfma_f32_16x16x32_bf16 v[184:187], a[24:27], a[196:199], v[184:187]
 v_rcp_f32 v29, v29
 v_mfma_f32_16x16x32_bf16 v[184:187], a[40:43], a[192:195], v[184:187]
 v_rcp_f32 v30, v30
 v_mfma_f32_16x16x32_bf16 v[184:187], a[56:59], a[204:207], v[184:187]
 v_rcp_f32 v31, v31
 v_mfma_f32_16x16x32_bf16 v[184:187], a[72:75], a[164:167], v[184:187]
 v_fma_f32 v20, v20, v28, -v28
 v_fma_f32 v21, v21, v29, -v29
 v_mfma_f32_16x16x32_bf16 v[188:191], a[76:79], a[164:167], 0
 v_fma_f32 v22, v22, v30, -v30
 v_fma_f32 v23, v23, v31, -v31
 v_cvt_pk_bf16_f32 v16, v20, v21
 v_mfma_f32_16x16x32_bf16 v[188:191], a[60:63], a[204:207], v[188:191]
 v_cvt_pk_bf16_f32 v17, v22, v23
 v_accvgpr_read_b32 v32, a212
 v_mfma_f32_16x16x32_bf16 v[188:191], a[44:47], a[192:195], v[188:191]
 v_accvgpr_read_b32 v40, a220
 v_accvgpr_read_b32 v33, a213
 v_mfma_f32_16x16x32_bf16 v[188:191], a[28:31], a[196:199], v[188:191]
 v_accvgpr_read_b32 v41, a221
 v_accvgpr_read_b32 v34, a214
 v_mfma_f32_16x16x32_bf16 v[188:191], a[12:15], a[200:203], v[188:191]
 s_add_u32 m0, s29, 12288
 v_accvgpr_read_b32 v42, a222
 v_accvgpr_read_b32 v35, a215
 v_mfma_f32_16x16x32_bf16 v[204:207], a[12:15], a[196:199], 0
 buffer_load_dwordx4 v5, s[8:11], s82 offen offset:1024 lds
 v_accvgpr_read_b32 v43, a223
 v_mfma_f32_16x16x32_bf16 v[204:207], a[28:31], a[192:195], v[204:207]
 v_mul_f32 v32, s42, v32
 v_mul_f32 v33, s42, v33
 v_mfma_f32_16x16x32_bf16 v[204:207], a[44:47], a[204:207], v[204:207]
 v_mul_f32 v34, s42, v34
 v_mul_f32 v35, s42, v35
 v_mfma_f32_16x16x32_bf16 v[204:207], a[60:63], a[164:167], v[204:207]
 ds_read_b128 a[160:163], v3 offset:2176
 v_min_f32 v32, s47, v32
 v_min_f32 v33, s47, v33
 v_mfma_f32_16x16x32_bf16 v[204:207], a[76:79], a[188:191], v[204:207]
 v_min_f32 v34, s47, v34
 v_min_f32 v35, s47, v35
 v_mfma_f32_16x16x32_bf16 v[200:203], a[72:75], a[188:191], 0
 v_exp_f32 v32, v32
 v_mfma_f32_16x16x32_bf16 v[200:203], a[56:59], a[164:167], v[200:203]
 v_mul_f32 v40, s43, v40
 v_mul_f32 v41, s43, v41
 v_mfma_f32_16x16x32_bf16 v[200:203], a[40:43], a[204:207], v[200:203]
 v_exp_f32 v33, v33
 v_mfma_f32_16x16x32_bf16 v[200:203], a[24:27], a[192:195], v[200:203]
 v_mul_f32 v42, s43, v42
 v_mul_f32 v43, s43, v43
 v_mfma_f32_16x16x32_bf16 v[200:203], a[8:11], a[196:199], v[200:203]
 v_exp_f32 v34, v34
 v_mfma_f32_16x16x32_bf16 v[196:199], a[4:7], a[196:199], 0
 v_exp_f32 v35, v35
 v_mfma_f32_16x16x32_bf16 v[196:199], a[20:23], a[192:195], v[196:199]
 v_exp_f32 v40, v40
 v_add_f32 v28, 1.0, v32
 v_mfma_f32_16x16x32_bf16 v[196:199], a[36:39], a[204:207], v[196:199]
 s_add_u32 m0, s29, 14336
 v_add_f32 v29, 1.0, v33
 v_add_f32 v30, 1.0, v34
 v_mfma_f32_16x16x32_bf16 v[196:199], a[52:55], a[164:167], v[196:199]
 buffer_load_dwordx4 v5, s[8:11], s83 offen offset:1024 lds
 v_add_f32 v31, 1.0, v35
 v_mfma_f32_16x16x32_bf16 v[196:199], a[68:71], a[188:191], v[196:199]
 s_add_u32 m0, s26, 7168
 v_exp_f32 v41, v41
 v_mfma_f32_16x16x32_bf16 v[192:195], a[64:67], a[188:191], 0
 buffer_load_dwordx4 v14, s[4:7], 0 offen nt lds
 v_fmac_f32 v28, v28, v40
 v_mfma_f32_16x16x32_bf16 v[192:195], a[48:51], a[164:167], v[192:195]
 v_exp_f32 v42, v42
 v_mfma_f32_16x16x32_bf16 v[192:195], a[32:35], a[204:207], v[192:195]
 v_exp_f32 v43, v43
 v_mfma_f32_16x16x32_bf16 v[192:195], a[16:19], a[192:195], v[192:195]
 v_fmac_f32 v29, v29, v41
 v_fmac_f32 v30, v30, v42
 v_mfma_f32_16x16x32_bf16 v[192:195], a[0:3], a[196:199], v[192:195]
 v_fmac_f32 v31, v31, v43
 v_rcp_f32 v28, v28
 v_mfma_f32_16x16x32_bf16 v[208:211], a[0:3], a[192:195], 0
 v_rcp_f32 v29, v29
 v_mfma_f32_16x16x32_bf16 v[208:211], a[16:19], a[204:207], v[208:211]
 v_rcp_f32 v30, v30
 v_mfma_f32_16x16x32_bf16 v[208:211], a[32:35], a[164:167], v[208:211]
 v_rcp_f32 v31, v31
 v_mfma_f32_16x16x32_bf16 v[208:211], a[48:51], a[188:191], v[208:211]
 s_waitcnt lgkmcnt(0)
 ds_read_b128 a[200:203], v3 offset:6528
 v_fma_f32 v32, v32, v28, -v28
 v_mfma_f32_16x16x32_bf16 v[208:211], a[64:67], a[172:175], v[208:211]
 v_fma_f32 v33, v33, v29, -v29
 v_fma_f32 v34, v34, v30, -v30
 v_mfma_f32_16x16x32_bf16 v[212:215], a[68:71], a[172:175], 0
 s_add_u32 m0, s29, 16384
 v_fma_f32 v35, v35, v31, -v31
 v_cvt_pk_bf16_f32 v18, v32, v33
 v_mfma_f32_16x16x32_bf16 v[212:215], a[52:55], a[188:191], v[212:215]
 buffer_load_dwordx4 v5, s[8:11], s84 offen offset:1024 lds
 v_cvt_pk_bf16_f32 v19, v34, v35
 v_mfma_f32_16x16x32_bf16 v[212:215], a[36:39], a[164:167], v[212:215]
 s_add_u32 s46, s40, 11264
 buffer_store_dwordx4 v[16:19], v6, s[12:15], s46 offen
 v_accvgpr_read_b32 v20, a224
 v_accvgpr_read_b32 v24, a232
 v_mfma_f32_16x16x32_bf16 v[212:215], a[20:23], a[204:207], v[212:215]
 v_accvgpr_read_b32 v21, a225
 v_accvgpr_read_b32 v25, a233
 v_mfma_f32_16x16x32_bf16 v[212:215], a[4:7], a[192:195], v[212:215]
 v_accvgpr_read_b32 v22, a226
 v_accvgpr_read_b32 v26, a234
 v_mfma_f32_16x16x32_bf16 v[216:219], a[8:11], a[192:195], 0
 v_accvgpr_read_b32 v23, a227
 v_accvgpr_read_b32 v27, a235
 v_mfma_f32_16x16x32_bf16 v[216:219], a[24:27], a[204:207], v[216:219]
 v_mul_f32 v20, s42, v20
 v_mul_f32 v21, s42, v21
 v_mfma_f32_16x16x32_bf16 v[216:219], a[40:43], a[164:167], v[216:219]
 v_mul_f32 v22, s42, v22
 v_mul_f32 v23, s42, v23
 v_mfma_f32_16x16x32_bf16 v[216:219], a[56:59], a[188:191], v[216:219]
 v_min_f32 v20, s47, v20
 v_min_f32 v21, s47, v21
 v_mfma_f32_16x16x32_bf16 v[216:219], a[72:75], a[172:175], v[216:219]
 v_min_f32 v22, s47, v22
 v_min_f32 v23, s47, v23
 v_mfma_f32_16x16x32_bf16 v[220:223], a[76:79], a[172:175], 0
 v_exp_f32 v20, v20
 v_mul_f32 v24, s43, v24
 v_mfma_f32_16x16x32_bf16 v[220:223], a[60:63], a[188:191], v[220:223]
 v_mul_f32 v25, s43, v25
 v_mul_f32 v26, s43, v26
 v_mfma_f32_16x16x32_bf16 v[220:223], a[44:47], a[164:167], v[220:223]
 v_exp_f32 v21, v21
 v_mfma_f32_16x16x32_bf16 v[220:223], a[28:31], a[204:207], v[220:223]
 s_add_u32 m0, s29, 18432
 v_mul_f32 v27, s43, v27
 v_add_f32 v28, 1.0, v20
 v_mfma_f32_16x16x32_bf16 v[220:223], a[12:15], a[192:195], v[220:223]
 buffer_load_dwordx4 v5, s[8:11], s85 offen offset:1024 lds
 v_add_f32 v29, 1.0, v21
 v_mfma_f32_16x16x32_bf16 v[236:239], a[12:15], a[204:207], 0
 s_add_u32 s8, s8, 0x10000
 s_addc_u32 s9, s9, 0
 v_accvgpr_read_b32 v32, a228
 v_mfma_f32_16x16x32_bf16 v[236:239], a[28:31], a[164:167], v[236:239]
 v_exp_f32 v22, v22
 v_mfma_f32_16x16x32_bf16 v[236:239], a[44:47], a[188:191], v[236:239]
 v_exp_f32 v23, v23
 v_mfma_f32_16x16x32_bf16 v[236:239], a[60:63], a[172:175], v[236:239]
 ds_read_b128 a[184:187], v3 offset:10880
 v_exp_f32 v24, v24
 v_mfma_f32_16x16x32_bf16 v[236:239], a[76:79], a[180:183], v[236:239]
 v_exp_f32 v25, v25
 v_mfma_f32_16x16x32_bf16 v[232:235], a[72:75], a[180:183], 0
 v_add_f32 v30, 1.0, v22
 v_add_f32 v31, 1.0, v23
 v_mfma_f32_16x16x32_bf16 v[232:235], a[56:59], a[172:175], v[232:235]
 v_exp_f32 v26, v26
 v_mfma_f32_16x16x32_bf16 v[232:235], a[40:43], a[188:191], v[232:235]
 v_exp_f32 v27, v27
 v_mfma_f32_16x16x32_bf16 v[232:235], a[24:27], a[164:167], v[232:235]
 v_fmac_f32 v28, v28, v24
 v_fmac_f32 v29, v29, v25
 v_mfma_f32_16x16x32_bf16 v[232:235], a[8:11], a[204:207], v[232:235]
 v_fmac_f32 v30, v30, v26
 v_fmac_f32 v31, v31, v27
 v_mfma_f32_16x16x32_bf16 v[228:231], a[4:7], a[204:207], 0
 v_rcp_f32 v28, v28
 v_mfma_f32_16x16x32_bf16 v[228:231], a[20:23], a[164:167], v[228:231]
 s_mov_b32 m0, s27
 v_rcp_f32 v29, v29
 v_fma_f32 v20, v20, v28, -v28
 v_mfma_f32_16x16x32_bf16 v[228:231], a[36:39], a[188:191], v[228:231]
 buffer_load_dwordx4 v15, s[4:7], 0 offen nt lds
 v_fma_f32 v21, v21, v29, -v29
 v_mfma_f32_16x16x32_bf16 v[228:231], a[52:55], a[172:175], v[228:231]
 s_add_u32 s4, s4, 128
 s_addc_u32 s5, s5, 0
 s_xor_b32 s26, s26, 0x10000
 v_mfma_f32_16x16x32_bf16 v[228:231], a[68:71], a[180:183], v[228:231]
 s_xor_b32 s27, s27, s31
 v_rcp_f32 v30, v30
 v_mfma_f32_16x16x32_bf16 v[224:227], a[64:67], a[180:183], 0
 v_rcp_f32 v31, v31
 v_mfma_f32_16x16x32_bf16 v[224:227], a[48:51], a[172:175], v[224:227]
 v_fma_f32 v22, v22, v30, -v30
 v_fma_f32 v23, v23, v31, -v31
 v_mfma_f32_16x16x32_bf16 v[224:227], a[32:35], a[188:191], v[224:227]
 v_cvt_pk_bf16_f32 v16, v20, v21
 v_cvt_pk_bf16_f32 v17, v22, v23
 v_mfma_f32_16x16x32_bf16 v[224:227], a[16:19], a[164:167], v[224:227]
 v_accvgpr_read_b32 v40, a236
 v_accvgpr_read_b32 v33, a229
 v_mfma_f32_16x16x32_bf16 v[224:227], a[0:3], a[204:207], v[224:227]
 v_accvgpr_read_b32 v41, a237
 v_accvgpr_read_b32 v34, a230
 v_accvgpr_read_b32 v42, a238
 v_mfma_f32_16x16x32_bf16 v[240:243], a[0:3], a[164:167], 0
 v_accvgpr_read_b32 v35, a231
 v_accvgpr_read_b32 v43, a239
 v_mfma_f32_16x16x32_bf16 v[240:243], a[16:19], a[188:191], v[240:243]
 v_mul_f32 v32, s42, v32
 v_mul_f32 v33, s42, v33
 v_mfma_f32_16x16x32_bf16 v[240:243], a[32:35], a[172:175], v[240:243]
 v_mul_f32 v34, s42, v34
 v_mul_f32 v35, s42, v35
 v_mfma_f32_16x16x32_bf16 v[240:243], a[48:51], a[180:183], v[240:243]
 ds_read_b128 a[176:179], v3 offset:15232
 v_min_f32 v32, s47, v32
 v_mfma_f32_16x16x32_bf16 v[240:243], a[64:67], a[160:163], v[240:243]
 v_min_f32 v33, s47, v33
 v_min_f32 v34, s47, v34
 v_mfma_f32_16x16x32_bf16 v[244:247], a[68:71], a[160:163], 0
 v_min_f32 v35, s47, v35
 v_mul_f32 v40, s43, v40
 v_mfma_f32_16x16x32_bf16 v[244:247], a[52:55], a[180:183], v[244:247]
 v_exp_f32 v32, v32
 v_mfma_f32_16x16x32_bf16 v[244:247], a[36:39], a[172:175], v[244:247]
 v_mul_f32 v41, s43, v41
 v_exp_f32 v33, v33
 v_mfma_f32_16x16x32_bf16 v[244:247], a[20:23], a[188:191], v[244:247]
 v_mul_f32 v42, s43, v42
 v_mul_f32 v43, s43, v43
 v_mfma_f32_16x16x32_bf16 v[244:247], a[4:7], a[164:167], v[244:247]
 v_exp_f32 v34, v34
 v_mfma_f32_16x16x32_bf16 v[248:251], a[8:11], a[164:167], 0
 v_exp_f32 v35, v35
 v_mfma_f32_16x16x32_bf16 v[248:251], a[24:27], a[188:191], v[248:251]
 v_exp_f32 v40, v40
 v_mfma_f32_16x16x32_bf16 v[248:251], a[40:43], a[172:175], v[248:251]
 v_add_f32 v28, 1.0, v32
 v_add_f32 v29, 1.0, v33
 v_mfma_f32_16x16x32_bf16 v[248:251], a[56:59], a[180:183], v[248:251]
 v_exp_f32 v41, v41
 v_mfma_f32_16x16x32_bf16 v[248:251], a[72:75], a[160:163], v[248:251]
 v_add_f32 v30, 1.0, v34
 v_add_f32 v31, 1.0, v35
 v_mfma_f32_16x16x32_bf16 v[252:255], a[76:79], a[160:163], 0
 v_exp_f32 v42, v42
 v_fmac_f32 v28, v28, v40
 v_mfma_f32_16x16x32_bf16 v[252:255], a[60:63], a[180:183], v[252:255]
 v_exp_f32 v43, v43
 v_mfma_f32_16x16x32_bf16 v[252:255], a[44:47], a[172:175], v[252:255]
 v_fmac_f32 v29, v29, v41
 v_fmac_f32 v30, v30, v42
 v_mfma_f32_16x16x32_bf16 v[252:255], a[28:31], a[188:191], v[252:255]
 v_fmac_f32 v31, v31, v43
 v_accvgpr_read_b32 v20, a240
 v_mfma_f32_16x16x32_bf16 v[252:255], a[12:15], a[164:167], v[252:255]
 v_rcp_f32 v28, v28
 v_mfma_f32_16x16x32_bf16 a[220:223], a[12:15], a[188:191], 0
 v_rcp_f32 v29, v29
 v_mfma_f32_16x16x32_bf16 a[220:223], a[28:31], a[172:175], a[220:223]
 v_rcp_f32 v30, v30
 v_mfma_f32_16x16x32_bf16 a[220:223], a[44:47], a[180:183], a[220:223]
 v_rcp_f32 v31, v31
 v_mfma_f32_16x16x32_bf16 a[220:223], a[60:63], a[160:163], a[220:223]
 s_waitcnt lgkmcnt(0)
 v_fma_f32 v32, v32, v28, -v28
 v_fma_f32 v33, v33, v29, -v29
 v_fma_f32 v34, v34, v30, -v30
 v_mfma_f32_16x16x32_bf16 a[220:223], a[76:79], a[200:203], a[220:223]
 v_fma_f32 v35, v35, v31, -v31
 v_cvt_pk_bf16_f32 v18, v32, v33
 v_mfma_f32_16x16x32_bf16 a[216:219], a[72:75], a[200:203], 0
 s_add_u32 s46, s40, 13312
 v_cvt_pk_bf16_f32 v19, v34, v35
 buffer_store_dwordx4 v[16:19], v6, s[12:15], s46 offen
 v_mfma_f32_16x16x32_bf16 a[216:219], a[56:59], a[160:163], a[216:219]
 v_accvgpr_read_b32 v24, a248
 v_accvgpr_read_b32 v21, a241
 v_mfma_f32_16x16x32_bf16 a[216:219], a[40:43], a[180:183], a[216:219]
 v_accvgpr_read_b32 v25, a249
 v_accvgpr_read_b32 v22, a242
 v_mfma_f32_16x16x32_bf16 a[216:219], a[24:27], a[172:175], a[216:219]
 v_accvgpr_read_b32 v26, a250
 v_accvgpr_read_b32 v23, a243
 v_mfma_f32_16x16x32_bf16 a[216:219], a[8:11], a[188:191], a[216:219]
 v_accvgpr_read_b32 v27, a251
 v_mul_f32 v20, s42, v20
 v_mfma_f32_16x16x32_bf16 a[212:215], a[4:7], a[188:191], 0
 v_mul_f32 v21, s42, v21
 v_mul_f32 v22, s42, v22
 v_mfma_f32_16x16x32_bf16 a[212:215], a[20:23], a[172:175], a[212:215]
 v_mul_f32 v23, s42, v23
 v_min_f32 v20, s47, v20
 v_min_f32 v21, s47, v21
 v_mfma_f32_16x16x32_bf16 a[212:215], a[36:39], a[180:183], a[212:215]
 v_min_f32 v22, s47, v22
 v_min_f32 v23, s47, v23
 v_mfma_f32_16x16x32_bf16 a[212:215], a[52:55], a[160:163], a[212:215]
 v_exp_f32 v20, v20
 v_mfma_f32_16x16x32_bf16 a[212:215], a[68:71], a[200:203], a[212:215]
 v_mul_f32 v24, s43, v24
 v_mul_f32 v25, s43, v25
 v_mfma_f32_16x16x32_bf16 a[208:211], a[64:67], a[200:203], 0
 v_exp_f32 v21, v21
 v_mfma_f32_16x16x32_bf16 a[208:211], a[48:51], a[160:163], a[208:211]
 v_mul_f32 v26, s43, v26
 v_mul_f32 v27, s43, v27
 v_mfma_f32_16x16x32_bf16 a[208:211], a[32:35], a[180:183], a[208:211]
 v_exp_f32 v22, v22
 v_mfma_f32_16x16x32_bf16 a[208:211], a[16:19], a[172:175], a[208:211]
 v_exp_f32 v23, v23
 v_mfma_f32_16x16x32_bf16 a[208:211], a[0:3], a[188:191], a[208:211]
 ds_read_b128 a[188:191], v2 offset:17408
 ds_read_b128 a[168:171], v2 offset:21760
 v_add_f32 v28, 1.0, v20
 v_mfma_f32_16x16x32_bf16 a[224:227], a[0:3], a[172:175], 0
 ds_read_b128 a[204:207], v2 offset:26112
 ds_read_b128 a[196:199], v2 offset:30464
 v_mfma_f32_16x16x32_bf16 a[224:227], a[16:19], a[180:183], a[224:227]
 ds_read_b128 a[192:195], v4 offset:0
 v_add_f32 v29, 1.0, v21
 v_mfma_f32_16x16x32_bf16 a[224:227], a[32:35], a[160:163], a[224:227]
 v_exp_f32 v24, v24
 v_mfma_f32_16x16x32_bf16 a[224:227], a[48:51], a[200:203], a[224:227]
 v_exp_f32 v25, v25
 v_mfma_f32_16x16x32_bf16 a[224:227], a[64:67], a[184:187], a[224:227]
 v_add_f32 v30, 1.0, v22
 v_add_f32 v31, 1.0, v23
 v_mfma_f32_16x16x32_bf16 a[228:231], a[68:71], a[184:187], 0
 v_exp_f32 v26, v26
 v_mfma_f32_16x16x32_bf16 a[228:231], a[52:55], a[200:203], a[228:231]
 v_exp_f32 v27, v27
 v_mfma_f32_16x16x32_bf16 a[228:231], a[36:39], a[160:163], a[228:231]
 v_fmac_f32 v28, v28, v24
 v_fmac_f32 v29, v29, v25
 v_fmac_f32 v30, v30, v26
 v_mfma_f32_16x16x32_bf16 a[228:231], a[20:23], a[180:183], a[228:231]
 v_fmac_f32 v31, v31, v27
 v_accvgpr_read_b32 v32, a244
 v_mfma_f32_16x16x32_bf16 a[228:231], a[4:7], a[172:175], a[228:231]
 v_rcp_f32 v28, v28
 v_mfma_f32_16x16x32_bf16 a[232:235], a[8:11], a[172:175], 0
 v_rcp_f32 v29, v29
 v_mfma_f32_16x16x32_bf16 a[232:235], a[24:27], a[180:183], a[232:235]
 v_rcp_f32 v30, v30
 v_mfma_f32_16x16x32_bf16 a[232:235], a[40:43], a[160:163], a[232:235]
 v_rcp_f32 v31, v31
 v_mfma_f32_16x16x32_bf16 a[232:235], a[56:59], a[200:203], a[232:235]
 v_fma_f32 v20, v20, v28, -v28
 v_fma_f32 v21, v21, v29, -v29
 v_mfma_f32_16x16x32_bf16 a[232:235], a[72:75], a[184:187], a[232:235]
 v_fma_f32 v22, v22, v30, -v30
 v_fma_f32 v23, v23, v31, -v31
 v_mfma_f32_16x16x32_bf16 a[236:239], a[76:79], a[184:187], 0
 v_cvt_pk_bf16_f32 v16, v20, v21
 v_cvt_pk_bf16_f32 v17, v22, v23
 v_accvgpr_read_b32 v40, a252
 v_mfma_f32_16x16x32_bf16 a[236:239], a[60:63], a[200:203], a[236:239]
 v_accvgpr_read_b32 v33, a245
 v_accvgpr_read_b32 v41, a253
 v_mfma_f32_16x16x32_bf16 a[236:239], a[44:47], a[160:163], a[236:239]
 v_accvgpr_read_b32 v34, a246
 v_accvgpr_read_b32 v42, a254
 v_mfma_f32_16x16x32_bf16 a[236:239], a[28:31], a[180:183], a[236:239]
 v_accvgpr_read_b32 v35, a247
 v_accvgpr_read_b32 v43, a255
 v_mfma_f32_16x16x32_bf16 a[236:239], a[12:15], a[172:175], a[236:239]
 ds_read_b128 a[172:175], v4 offset:4352
 v_mul_f32 v32, s42, v32
 v_mfma_f32_16x16x32_bf16 a[252:255], a[12:15], a[180:183], 0
 v_mul_f32 v33, s42, v33
 v_mul_f32 v34, s42, v34
 v_mfma_f32_16x16x32_bf16 a[252:255], a[28:31], a[160:163], a[252:255]
 v_mul_f32 v35, s42, v35
 v_min_f32 v32, s47, v32
 v_mfma_f32_16x16x32_bf16 a[252:255], a[44:47], a[200:203], a[252:255]
 v_min_f32 v33, s47, v33
 v_min_f32 v34, s47, v34
 v_mfma_f32_16x16x32_bf16 a[252:255], a[60:63], a[184:187], a[252:255]
 ds_read_b128 a[164:167], v4 offset:8704
 v_min_f32 v35, s47, v35
 v_mul_f32 v40, s43, v40
 v_mfma_f32_16x16x32_bf16 a[252:255], a[76:79], a[176:179], a[252:255]
 v_exp_f32 v32, v32
 v_mfma_f32_16x16x32_bf16 a[248:251], a[72:75], a[176:179], 0
 v_mul_f32 v41, s43, v41
 v_mul_f32 v42, s43, v42
 v_mfma_f32_16x16x32_bf16 a[248:251], a[56:59], a[184:187], a[248:251]
 v_exp_f32 v33, v33
 v_mfma_f32_16x16x32_bf16 a[248:251], a[40:43], a[200:203], a[248:251]
 v_mul_f32 v43, s43, v43
 v_add_f32 v28, 1.0, v32
 v_mfma_f32_16x16x32_bf16 a[248:251], a[24:27], a[160:163], a[248:251]
 v_exp_f32 v34, v34
 v_mfma_f32_16x16x32_bf16 a[248:251], a[8:11], a[180:183], a[248:251]
 v_exp_f32 v35, v35
 v_mfma_f32_16x16x32_bf16 a[244:247], a[4:7], a[180:183], 0
 v_exp_f32 v40, v40
 v_mfma_f32_16x16x32_bf16 a[244:247], a[20:23], a[160:163], a[244:247]
 v_add_f32 v29, 1.0, v33
 v_exp_f32 v41, v41
 v_mfma_f32_16x16x32_bf16 a[244:247], a[36:39], a[200:203], a[244:247]
 v_add_f32 v30, 1.0, v34
 v_add_f32 v31, 1.0, v35
 v_mfma_f32_16x16x32_bf16 a[244:247], a[52:55], a[184:187], a[244:247]
 v_exp_f32 v42, v42
 v_mfma_f32_16x16x32_bf16 a[244:247], a[68:71], a[176:179], a[244:247]
 v_exp_f32 v43, v43
 v_mfma_f32_16x16x32_bf16 a[240:243], a[64:67], a[176:179], 0
 v_fmac_f32 v28, v28, v40
 v_fmac_f32 v29, v29, v41
 v_mfma_f32_16x16x32_bf16 a[240:243], a[48:51], a[184:187], a[240:243]
 v_fmac_f32 v30, v30, v42
 v_fmac_f32 v31, v31, v43
 v_mfma_f32_16x16x32_bf16 a[240:243], a[32:35], a[200:203], a[240:243]
 v_rcp_f32 v28, v28
 v_mfma_f32_16x16x32_bf16 a[240:243], a[16:19], a[160:163], a[240:243]
 v_rcp_f32 v29, v29
 v_mfma_f32_16x16x32_bf16 a[240:243], a[0:3], a[180:183], a[240:243]
 s_waitcnt vmcnt(5) lgkmcnt(0)
 ds_read_b64_tr_b16 a[0:1], v46 offset:0
 v_rcp_f32 v30, v30
 v_mfma_f32_16x16x32_bf16 v[112:115], a[80:83], a[188:191], v[112:115]
 v_rcp_f32 v31, v31
 v_mfma_f32_16x16x32_bf16 v[112:115], a[96:99], a[168:171], v[112:115]
 v_fma_f32 v32, v32, v28, -v28
 v_fma_f32 v33, v33, v29, -v29
 v_mfma_f32_16x16x32_bf16 v[112:115], a[112:115], a[204:207], v[112:115]
 ds_read_b64_tr_b16 a[2:3], v46 offset:256
 v_fma_f32 v34, v34, v30, -v30
 v_mfma_f32_16x16x32_bf16 v[112:115], a[128:131], a[196:199], v[112:115]
 ds_read_b128 a[184:187], v4 offset:13056
 v_fma_f32 v35, v35, v31, -v31
 v_mfma_f32_16x16x32_bf16 v[112:115], a[144:147], a[192:195], v[112:115]
 v_cvt_pk_bf16_f32 v18, v32, v33
 v_cvt_pk_bf16_f32 v19, v34, v35
 v_mfma_f32_16x16x32_bf16 v[116:119], a[148:151], a[192:195], v[116:119]
 s_add_u32 s46, s40, 15360
 ds_read_b64_tr_b16 a[4:5], v46 offset:8
 buffer_store_dwordx4 v[16:19], v6, s[12:15], s46 offen
 v_mfma_f32_16x16x32_bf16 v[116:119], a[132:135], a[196:199], v[116:119]
 v_mfma_f32_16x16x32_bf16 v[116:119], a[116:119], a[204:207], v[116:119]
 v_mfma_f32_16x16x32_bf16 v[116:119], a[100:103], a[168:171], v[116:119]
 ds_read_b64_tr_b16 a[6:7], v46 offset:264
 v_mfma_f32_16x16x32_bf16 v[116:119], a[84:87], a[188:191], v[116:119]
 v_mfma_f32_16x16x32_bf16 v[120:123], a[88:91], a[188:191], v[120:123]
 v_mfma_f32_16x16x32_bf16 v[120:123], a[104:107], a[168:171], v[120:123]
 ds_read_b64_tr_b16 a[16:17], v46 offset:4096
 v_mfma_f32_16x16x32_bf16 v[120:123], a[120:123], a[204:207], v[120:123]
 v_mfma_f32_16x16x32_bf16 v[120:123], a[136:139], a[196:199], v[120:123]
 v_mfma_f32_16x16x32_bf16 v[120:123], a[152:155], a[192:195], v[120:123]
 s_add_u32 m0, s29, 0
 ds_read_b64_tr_b16 a[18:19], v46 offset:4352
 v_mfma_f32_16x16x32_bf16 v[124:127], a[156:159], a[192:195], v[124:127]
 s_waitcnt lgkmcnt(2)
 buffer_load_dwordx4 v5, s[8:11], s76 offen offset:0 lds
 v_mfma_f32_16x16x32_bf16 v[124:127], a[140:143], a[196:199], v[124:127]
 v_mfma_f32_16x16x32_bf16 v[124:127], a[124:127], a[204:207], v[124:127]
 ds_read_b64_tr_b16 a[20:21], v46 offset:4104
 v_mfma_f32_16x16x32_bf16 v[124:127], a[108:111], a[168:171], v[124:127]
 v_mfma_f32_16x16x32_bf16 v[124:127], a[92:95], a[188:191], v[124:127]
 ds_read_b128 a[176:179], v2 offset:2176
 v_mfma_f32_16x16x32_bf16 v[140:143], a[92:95], a[168:171], v[140:143]
 ds_read_b128 a[200:203], v2 offset:6528
 ds_read_b64_tr_b16 a[22:23], v46 offset:4360
 v_mfma_f32_16x16x32_bf16 v[140:143], a[108:111], a[204:207], v[140:143]
 v_mfma_f32_16x16x32_bf16 v[140:143], a[124:127], a[196:199], v[140:143]
 v_mfma_f32_16x16x32_bf16 v[140:143], a[140:143], a[192:195], v[140:143]
 ds_read_b64_tr_b16 a[32:33], v46 offset:8192
 v_mfma_f32_16x16x32_bf16 v[140:143], a[156:159], a[172:175], v[140:143]
 s_add_u32 m0, s29, 2048
 v_mfma_f32_16x16x32_bf16 v[136:139], a[152:155], a[172:175], v[136:139]
 buffer_load_dwordx4 v5, s[8:11], s77 offen offset:0 lds
 v_mfma_f32_16x16x32_bf16 v[136:139], a[136:139], a[192:195], v[136:139]
 ds_read_b64_tr_b16 a[34:35], v46 offset:8448
 v_mfma_f32_16x16x32_bf16 v[136:139], a[120:123], a[196:199], v[136:139]
 v_mfma_f32_16x16x32_bf16 v[136:139], a[104:107], a[204:207], v[136:139]
 v_mfma_f32_16x16x32_bf16 v[136:139], a[88:91], a[168:171], v[136:139]
 ds_read_b64_tr_b16 a[36:37], v46 offset:8200
 v_mfma_f32_16x16x32_bf16 v[132:135], a[84:87], a[168:171], v[132:135]
 v_mfma_f32_16x16x32_bf16 v[132:135], a[100:103], a[204:207], v[132:135]
 v_mfma_f32_16x16x32_bf16 v[132:135], a[116:119], a[196:199], v[132:135]
 ds_read_b64_tr_b16 a[38:39], v46 offset:8456
 v_mfma_f32_16x16x32_bf16 v[132:135], a[132:135], a[192:195], v[132:135]
 v_mfma_f32_16x16x32_bf16 v[132:135], a[148:151], a[172:175], v[132:135]
 s_add_u32 m0, s29, 4096
 v_mfma_f32_16x16x32_bf16 v[128:131], a[144:147], a[172:175], v[128:131]
 s_waitcnt lgkmcnt(3)
 ds_read_b64_tr_b16 a[48:49], v46 offset:12288
 buffer_load_dwordx4 v5, s[8:11], s78 offen offset:0 lds
 v_mfma_f32_16x16x32_bf16 v[128:131], a[128:131], a[192:195], v[128:131]
 v_mfma_f32_16x16x32_bf16 v[128:131], a[112:115], a[196:199], v[128:131]
 v_mfma_f32_16x16x32_bf16 v[128:131], a[96:99], a[204:207], v[128:131]
 ds_read_b64_tr_b16 a[50:51], v46 offset:12544
 v_mfma_f32_16x16x32_bf16 v[128:131], a[80:83], a[168:171], v[128:131]
 ds_read_b128 a[168:171], v2 offset:10880
 ds_read_b128 a[160:163], v2 offset:15232
 v_mfma_f32_16x16x32_bf16 v[144:147], a[80:83], a[204:207], v[144:147]
 ds_read_b128 a[180:183], v2 offset:19584
 v_mfma_f32_16x16x32_bf16 v[144:147], a[96:99], a[196:199], v[144:147]
 ds_read_b64_tr_b16 a[52:53], v46 offset:12296
 v_mfma_f32_16x16x32_bf16 v[144:147], a[112:115], a[192:195], v[144:147]
 v_mfma_f32_16x16x32_bf16 v[144:147], a[128:131], a[172:175], v[144:147]
 ds_read_b128 a[188:191], v2 offset:23936
 v_mfma_f32_16x16x32_bf16 v[144:147], a[144:147], a[164:167], v[144:147]
 s_add_u32 m0, s29, 6144
 ds_read_b64_tr_b16 a[54:55], v46 offset:12552
 v_mfma_f32_16x16x32_bf16 v[148:151], a[148:151], a[164:167], v[148:151]
 buffer_load_dwordx4 v5, s[8:11], s79 offen offset:0 lds
 v_mfma_f32_16x16x32_bf16 v[148:151], a[132:135], a[172:175], v[148:151]
 v_mfma_f32_16x16x32_bf16 v[148:151], a[116:119], a[192:195], v[148:151]
 ds_read_b64_tr_b16 a[64:65], v46 offset:16384
 v_mfma_f32_16x16x32_bf16 v[148:151], a[100:103], a[196:199], v[148:151]
 v_mfma_f32_16x16x32_bf16 v[148:151], a[84:87], a[204:207], v[148:151]
 v_mfma_f32_16x16x32_bf16 v[152:155], a[88:91], a[204:207], v[152:155]
 ds_read_b64_tr_b16 a[66:67], v46 offset:16640
 v_mfma_f32_16x16x32_bf16 v[152:155], a[104:107], a[196:199], v[152:155]
 v_mfma_f32_16x16x32_bf16 v[152:155], a[120:123], a[192:195], v[152:155]
 v_mfma_f32_16x16x32_bf16 v[152:155], a[136:139], a[172:175], v[152:155]
 ds_read_b64_tr_b16 a[68:69], v46 offset:16392
 v_mfma_f32_16x16x32_bf16 v[152:155], a[152:155], a[164:167], v[152:155]
 s_add_u32 m0, s29, 8192
 v_mfma_f32_16x16x32_bf16 v[156:159], a[156:159], a[164:167], v[156:159]
 s_waitcnt lgkmcnt(4)
 buffer_load_dwordx4 v5, s[8:11], s80 offen offset:0 lds
 v_mfma_f32_16x16x32_bf16 v[156:159], a[140:143], a[172:175], v[156:159]
 ds_read_b64_tr_b16 a[70:71], v46 offset:16648
 v_mfma_f32_16x16x32_bf16 v[156:159], a[124:127], a[192:195], v[156:159]
 v_mfma_f32_16x16x32_bf16 v[156:159], a[108:111], a[196:199], v[156:159]
 v_mfma_f32_16x16x32_bf16 v[156:159], a[92:95], a[204:207], v[156:159]
 ds_read_b64_tr_b16 a[8:9], v46 offset:1024
 v_mfma_f32_16x16x32_bf16 v[172:175], a[92:95], a[196:199], v[172:175]
 v_mfma_f32_16x16x32_bf16 v[172:175], a[108:111], a[192:195], v[172:175]
 v_mfma_f32_16x16x32_bf16 v[172:175], a[124:127], a[172:175], v[172:175]
 ds_read_b64_tr_b16 a[10:11], v46 offset:1280
 v_mfma_f32_16x16x32_bf16 v[172:175], a[140:143], a[164:167], v[172:175]
 v_mfma_f32_16x16x32_bf16 v[172:175], a[156:159], a[184:187], v[172:175]
 s_add_u32 m0, s29, 10240
 v_mfma_f32_16x16x32_bf16 v[168:171], a[152:155], a[184:187], v[168:171]
 ds_read_b64_tr_b16 a[12:13], v46 offset:1032
 buffer_load_dwordx4 v5, s[8:11], s81 offen offset:0 lds
 v_mfma_f32_16x16x32_bf16 v[168:171], a[136:139], a[164:167], v[168:171]
 v_mfma_f32_16x16x32_bf16 v[168:171], a[120:123], a[172:175], v[168:171]
 v_mfma_f32_16x16x32_bf16 v[168:171], a[104:107], a[192:195], v[168:171]
 ds_read_b64_tr_b16 a[14:15], v46 offset:1288
 v_mfma_f32_16x16x32_bf16 v[168:171], a[88:91], a[196:199], v[168:171]
 v_mfma_f32_16x16x32_bf16 v[164:167], a[84:87], a[196:199], v[164:167]
 v_mfma_f32_16x16x32_bf16 v[164:167], a[100:103], a[192:195], v[164:167]
 ds_read_b64_tr_b16 a[24:25], v46 offset:5120
 v_mfma_f32_16x16x32_bf16 v[164:167], a[116:119], a[172:175], v[164:167]
 v_mfma_f32_16x16x32_bf16 v[164:167], a[132:135], a[164:167], v[164:167]
 v_mfma_f32_16x16x32_bf16 v[164:167], a[148:151], a[184:187], v[164:167]
 s_add_u32 m0, s29, 12288
 ds_read_b64_tr_b16 a[26:27], v46 offset:5376
 v_mfma_f32_16x16x32_bf16 v[160:163], a[144:147], a[184:187], v[160:163]
 s_waitcnt lgkmcnt(4)
 buffer_load_dwordx4 v5, s[8:11], s82 offen offset:0 lds
 v_mfma_f32_16x16x32_bf16 v[160:163], a[128:131], a[164:167], v[160:163]
 v_mfma_f32_16x16x32_bf16 v[160:163], a[112:115], a[172:175], v[160:163]
 ds_read_b128 a[172:175], v2 offset:28288
 ds_read_b64_tr_b16 a[28:29], v46 offset:5128
 v_mfma_f32_16x16x32_bf16 v[160:163], a[96:99], a[192:195], v[160:163]
 v_mfma_f32_16x16x32_bf16 v[160:163], a[80:83], a[196:199], v[160:163]
 v_mfma_f32_16x16x32_bf16 v[176:179], a[80:83], a[176:179], v[176:179]
 ds_read_b64_tr_b16 a[30:31], v46 offset:5384
 v_mfma_f32_16x16x32_bf16 v[176:179], a[96:99], a[200:203], v[176:179]
 v_mfma_f32_16x16x32_bf16 v[176:179], a[112:115], a[168:171], v[176:179]
 v_mfma_f32_16x16x32_bf16 v[176:179], a[128:131], a[160:163], v[176:179]
 ds_read_b128 a[192:195], v2 offset:32640
 ds_read_b64_tr_b16 a[40:41], v46 offset:9216
 v_mfma_f32_16x16x32_bf16 v[176:179], a[144:147], a[180:183], v[176:179]
 s_add_u32 m0, s29, 14336
 v_mfma_f32_16x16x32_bf16 v[180:183], a[148:151], a[180:183], v[180:183]
 buffer_load_dwordx4 v5, s[8:11], s83 offen offset:0 lds
 v_mfma_f32_16x16x32_bf16 v[180:183], a[132:135], a[160:163], v[180:183]
 ds_read_b64_tr_b16 a[42:43], v46 offset:9472
 v_mfma_f32_16x16x32_bf16 v[180:183], a[116:119], a[168:171], v[180:183]
 v_mfma_f32_16x16x32_bf16 v[180:183], a[100:103], a[200:203], v[180:183]
 v_mfma_f32_16x16x32_bf16 v[180:183], a[84:87], a[176:179], v[180:183]
 ds_read_b64_tr_b16 a[44:45], v46 offset:9224
 v_mfma_f32_16x16x32_bf16 v[184:187], a[88:91], a[176:179], v[184:187]
 v_mfma_f32_16x16x32_bf16 v[184:187], a[104:107], a[200:203], v[184:187]
 v_mfma_f32_16x16x32_bf16 v[184:187], a[120:123], a[168:171], v[184:187]
 ds_read_b64_tr_b16 a[46:47], v46 offset:9480
 v_mfma_f32_16x16x32_bf16 v[184:187], a[136:139], a[160:163], v[184:187]
 v_mfma_f32_16x16x32_bf16 v[184:187], a[152:155], a[180:183], v[184:187]
 s_add_u32 m0, s29, 16384
 v_mfma_f32_16x16x32_bf16 v[188:191], a[156:159], a[180:183], v[188:191]
 ds_read_b64_tr_b16 a[56:57], v46 offset:13312
 buffer_load_dwordx4 v5, s[8:11], s84 offen offset:0 lds
 v_mfma_f32_16x16x32_bf16 v[188:191], a[140:143], a[160:163], v[188:191]
 v_mfma_f32_16x16x32_bf16 v[188:191], a[124:127], a[168:171], v[188:191]
 v_mfma_f32_16x16x32_bf16 v[188:191], a[108:111], a[200:203], v[188:191]
 ds_read_b64_tr_b16 a[58:59], v46 offset:13568
 v_mfma_f32_16x16x32_bf16 v[188:191], a[92:95], a[176:179], v[188:191]
 v_mfma_f32_16x16x32_bf16 v[204:207], a[92:95], a[200:203], v[204:207]
 v_mfma_f32_16x16x32_bf16 v[204:207], a[108:111], a[168:171], v[204:207]
 ds_read_b64_tr_b16 a[60:61], v46 offset:13320
 v_mfma_f32_16x16x32_bf16 v[204:207], a[124:127], a[160:163], v[204:207]
 v_mfma_f32_16x16x32_bf16 v[204:207], a[140:143], a[180:183], v[204:207]
 ds_read_b128 a[204:207], v4 offset:2176
 v_mfma_f32_16x16x32_bf16 v[204:207], a[156:159], a[188:191], v[204:207]
 s_add_u32 m0, s29, 18432
 ds_read_b64_tr_b16 a[62:63], v46 offset:13576
 v_mfma_f32_16x16x32_bf16 v[200:203], a[152:155], a[188:191], v[200:203]
 buffer_load_dwordx4 v5, s[8:11], s85 offen offset:0 lds
 v_mfma_f32_16x16x32_bf16 v[200:203], a[136:139], a[180:183], v[200:203]
 v_mfma_f32_16x16x32_bf16 v[200:203], a[120:123], a[160:163], v[200:203]
 s_waitcnt vmcnt(11)
 ds_read_b64_tr_b16 a[72:73], v46 offset:17408
 v_mfma_f32_16x16x32_bf16 v[200:203], a[104:107], a[168:171], v[200:203]
 v_mfma_f32_16x16x32_bf16 v[200:203], a[88:91], a[200:203], v[200:203]
 v_mfma_f32_16x16x32_bf16 v[196:199], a[84:87], a[200:203], v[196:199]
 ds_read_b64_tr_b16 a[74:75], v46 offset:17664
 v_mfma_f32_16x16x32_bf16 v[196:199], a[100:103], a[168:171], v[196:199]
 v_mfma_f32_16x16x32_bf16 v[196:199], a[116:119], a[160:163], v[196:199]
 v_mfma_f32_16x16x32_bf16 v[196:199], a[132:135], a[180:183], v[196:199]
 ds_read_b64_tr_b16 a[76:77], v46 offset:17416
 v_mfma_f32_16x16x32_bf16 v[196:199], a[148:151], a[188:191], v[196:199]
 s_add_u32 m0, s29, 0
 v_mfma_f32_16x16x32_bf16 v[192:195], a[144:147], a[188:191], v[192:195]
 s_waitcnt lgkmcnt(4)
 buffer_load_dwordx4 v5, s[8:11], s76 offen offset:1024 lds
 v_mfma_f32_16x16x32_bf16 v[192:195], a[128:131], a[180:183], v[192:195]
 ds_read_b64_tr_b16 a[78:79], v46 offset:17672
 v_mfma_f32_16x16x32_bf16 v[192:195], a[112:115], a[160:163], v[192:195]
 v_mfma_f32_16x16x32_bf16 v[192:195], a[96:99], a[168:171], v[192:195]
 v_mfma_f32_16x16x32_bf16 v[192:195], a[80:83], a[200:203], v[192:195]
 v_mfma_f32_16x16x32_bf16 v[208:211], a[80:83], a[168:171], v[208:211]
 v_mfma_f32_16x16x32_bf16 v[208:211], a[96:99], a[160:163], v[208:211]
 v_mfma_f32_16x16x32_bf16 v[208:211], a[112:115], a[180:183], v[208:211]
 v_mfma_f32_16x16x32_bf16 v[208:211], a[128:131], a[188:191], v[208:211]
 ds_read_b128 a[200:203], v4 offset:6528
 v_mfma_f32_16x16x32_bf16 v[208:211], a[144:147], a[172:175], v[208:211]
 s_add_u32 m0, s29, 2048
 v_mfma_f32_16x16x32_bf16 v[212:215], a[148:151], a[172:175], v[212:215]
 buffer_load_dwordx4 v5, s[8:11], s77 offen offset:1024 lds
 v_mfma_f32_16x16x32_bf16 v[212:215], a[132:135], a[188:191], v[212:215]
 v_mfma_f32_16x16x32_bf16 v[212:215], a[116:119], a[180:183], v[212:215]
 v_mfma_f32_16x16x32_bf16 v[212:215], a[100:103], a[160:163], v[212:215]
 v_mfma_f32_16x16x32_bf16 v[212:215], a[84:87], a[168:171], v[212:215]
 v_mfma_f32_16x16x32_bf16 v[216:219], a[88:91], a[168:171], v[216:219]
 v_mfma_f32_16x16x32_bf16 v[216:219], a[104:107], a[160:163], v[216:219]
 v_mfma_f32_16x16x32_bf16 v[216:219], a[120:123], a[180:183], v[216:219]
 v_mfma_f32_16x16x32_bf16 v[216:219], a[136:139], a[188:191], v[216:219]
 v_mfma_f32_16x16x32_bf16 v[216:219], a[152:155], a[172:175], v[216:219]
 s_add_u32 m0, s29, 4096
 v_mfma_f32_16x16x32_bf16 v[220:223], a[156:159], a[172:175], v[220:223]
 buffer_load_dwordx4 v5, s[8:11], s78 offen offset:1024 lds
 v_mfma_f32_16x16x32_bf16 v[220:223], a[140:143], a[188:191], v[220:223]
 v_mfma_f32_16x16x32_bf16 v[220:223], a[124:127], a[180:183], v[220:223]
 v_mfma_f32_16x16x32_bf16 v[220:223], a[108:111], a[160:163], v[220:223]
 v_mfma_f32_16x16x32_bf16 v[220:223], a[92:95], a[168:171], v[220:223]
 v_mfma_f32_16x16x32_bf16 v[236:239], a[92:95], a[160:163], v[236:239]
 v_mfma_f32_16x16x32_bf16 v[236:239], a[108:111], a[180:183], v[236:239]
 v_mfma_f32_16x16x32_bf16 v[236:239], a[124:127], a[188:191], v[236:239]
 v_mfma_f32_16x16x32_bf16 v[236:239], a[140:143], a[172:175], v[236:239]
 ds_read_b128 a[184:187], v4 offset:10880
 v_mfma_f32_16x16x32_bf16 v[236:239], a[156:159], a[192:195], v[236:239]
 s_add_u32 m0, s29, 6144
 v_mfma_f32_16x16x32_bf16 v[232:235], a[152:155], a[192:195], v[232:235]
 buffer_load_dwordx4 v5, s[8:11], s79 offen offset:1024 lds
 v_mfma_f32_16x16x32_bf16 v[232:235], a[136:139], a[172:175], v[232:235]
 v_mfma_f32_16x16x32_bf16 v[232:235], a[120:123], a[188:191], v[232:235]
 v_mfma_f32_16x16x32_bf16 v[232:235], a[104:107], a[180:183], v[232:235]
 v_mfma_f32_16x16x32_bf16 v[232:235], a[88:91], a[160:163], v[232:235]
 v_mfma_f32_16x16x32_bf16 v[228:231], a[84:87], a[160:163], v[228:231]
 v_mfma_f32_16x16x32_bf16 v[228:231], a[100:103], a[180:183], v[228:231]
 v_mfma_f32_16x16x32_bf16 v[228:231], a[116:119], a[188:191], v[228:231]
 v_mfma_f32_16x16x32_bf16 v[228:231], a[132:135], a[172:175], v[228:231]
 v_mfma_f32_16x16x32_bf16 v[228:231], a[148:151], a[192:195], v[228:231]
 s_add_u32 m0, s29, 8192
 v_mfma_f32_16x16x32_bf16 v[224:227], a[144:147], a[192:195], v[224:227]
 buffer_load_dwordx4 v5, s[8:11], s80 offen offset:1024 lds
 v_mfma_f32_16x16x32_bf16 v[224:227], a[128:131], a[172:175], v[224:227]
 v_mfma_f32_16x16x32_bf16 v[224:227], a[112:115], a[188:191], v[224:227]
 v_mfma_f32_16x16x32_bf16 v[224:227], a[96:99], a[180:183], v[224:227]
 v_mfma_f32_16x16x32_bf16 v[224:227], a[80:83], a[160:163], v[224:227]
 v_mfma_f32_16x16x32_bf16 v[240:243], a[80:83], a[180:183], v[240:243]
 v_mfma_f32_16x16x32_bf16 v[240:243], a[96:99], a[188:191], v[240:243]
 v_mfma_f32_16x16x32_bf16 v[240:243], a[112:115], a[172:175], v[240:243]
 v_mfma_f32_16x16x32_bf16 v[240:243], a[128:131], a[192:195], v[240:243]
 ds_read_b128 a[196:199], v4 offset:15232
 v_mfma_f32_16x16x32_bf16 v[240:243], a[144:147], a[204:207], v[240:243]
 s_add_u32 m0, s29, 10240
 v_mfma_f32_16x16x32_bf16 v[244:247], a[148:151], a[204:207], v[244:247]
 buffer_load_dwordx4 v5, s[8:11], s81 offen offset:1024 lds
 v_mfma_f32_16x16x32_bf16 v[244:247], a[132:135], a[192:195], v[244:247]
 v_mfma_f32_16x16x32_bf16 v[244:247], a[116:119], a[172:175], v[244:247]
 v_mfma_f32_16x16x32_bf16 v[244:247], a[100:103], a[188:191], v[244:247]
 v_mfma_f32_16x16x32_bf16 v[244:247], a[84:87], a[180:183], v[244:247]
 v_mfma_f32_16x16x32_bf16 v[248:251], a[88:91], a[180:183], v[248:251]
 v_mfma_f32_16x16x32_bf16 v[248:251], a[104:107], a[188:191], v[248:251]
 s_waitcnt lgkmcnt(0)
 s_barrier
 v_mfma_f32_16x16x32_bf16 v[248:251], a[120:123], a[172:175], v[248:251]
 v_xor_b32 v1, 0x10000, v1
 v_xor_b32 v2, 0x10000, v2
 v_mfma_f32_16x16x32_bf16 v[248:251], a[136:139], a[192:195], v[248:251]
 v_xor_b32 v3, 0x10000, v3
 v_xor_b32 v4, 0x10000, v4
 v_mfma_f32_16x16x32_bf16 v[248:251], a[152:155], a[204:207], v[248:251]
 s_add_u32 m0, s29, 12288
 ds_read_b128 a[160:163], v1 offset:0
 ds_read_b128 a[164:167], v1 offset:4352
 v_mfma_f32_16x16x32_bf16 v[252:255], a[156:159], a[204:207], v[252:255]
 ds_read_b128 a[168:171], v1 offset:8704
 buffer_load_dwordx4 v5, s[8:11], s82 offen offset:1024 lds
 v_mfma_f32_16x16x32_bf16 v[252:255], a[140:143], a[192:195], v[252:255]
 v_mfma_f32_16x16x32_bf16 v[252:255], a[124:127], a[172:175], v[252:255]
 v_mfma_f32_16x16x32_bf16 v[252:255], a[108:111], a[188:191], v[252:255]
 v_mfma_f32_16x16x32_bf16 v[252:255], a[92:95], a[180:183], v[252:255]
 v_mfma_f32_16x16x32_bf16 a[220:223], a[92:95], a[188:191], a[220:223]
 v_mfma_f32_16x16x32_bf16 a[220:223], a[108:111], a[172:175], a[220:223]
 v_mfma_f32_16x16x32_bf16 a[220:223], a[124:127], a[192:195], a[220:223]
 v_mfma_f32_16x16x32_bf16 a[220:223], a[140:143], a[204:207], a[220:223]
 v_mfma_f32_16x16x32_bf16 a[220:223], a[156:159], a[200:203], a[220:223]
 s_add_u32 m0, s29, 14336
 v_mfma_f32_16x16x32_bf16 a[216:219], a[152:155], a[200:203], a[216:219]
 buffer_load_dwordx4 v5, s[8:11], s83 offen offset:1024 lds
 v_mfma_f32_16x16x32_bf16 a[216:219], a[136:139], a[204:207], a[216:219]
 v_mfma_f32_16x16x32_bf16 a[216:219], a[120:123], a[192:195], a[216:219]
 v_mfma_f32_16x16x32_bf16 a[216:219], a[104:107], a[172:175], a[216:219]
 v_mfma_f32_16x16x32_bf16 a[216:219], a[88:91], a[188:191], a[216:219]
 v_mfma_f32_16x16x32_bf16 a[212:215], a[84:87], a[188:191], a[212:215]
 v_mfma_f32_16x16x32_bf16 a[212:215], a[100:103], a[172:175], a[212:215]
 v_mfma_f32_16x16x32_bf16 a[212:215], a[116:119], a[192:195], a[212:215]
 v_mfma_f32_16x16x32_bf16 a[212:215], a[132:135], a[204:207], a[212:215]
 v_mfma_f32_16x16x32_bf16 a[212:215], a[148:151], a[200:203], a[212:215]
 s_add_u32 m0, s29, 16384
 v_mfma_f32_16x16x32_bf16 a[208:211], a[144:147], a[200:203], a[208:211]
 buffer_load_dwordx4 v5, s[8:11], s84 offen offset:1024 lds
 v_mfma_f32_16x16x32_bf16 a[208:211], a[128:131], a[204:207], a[208:211]
 v_mfma_f32_16x16x32_bf16 a[208:211], a[112:115], a[192:195], a[208:211]
 v_mfma_f32_16x16x32_bf16 a[208:211], a[96:99], a[172:175], a[208:211]
 v_mfma_f32_16x16x32_bf16 a[208:211], a[80:83], a[188:191], a[208:211]
 v_mfma_f32_16x16x32_bf16 a[224:227], a[80:83], a[172:175], a[224:227]
 v_mfma_f32_16x16x32_bf16 a[224:227], a[96:99], a[192:195], a[224:227]
 v_mfma_f32_16x16x32_bf16 a[224:227], a[112:115], a[204:207], a[224:227]
 v_mfma_f32_16x16x32_bf16 a[224:227], a[128:131], a[200:203], a[224:227]
 v_mfma_f32_16x16x32_bf16 a[224:227], a[144:147], a[184:187], a[224:227]
 s_add_u32 m0, s29, 18432
 v_mfma_f32_16x16x32_bf16 a[228:231], a[148:151], a[184:187], a[228:231]
 buffer_load_dwordx4 v5, s[8:11], s85 offen offset:1024 lds
 v_mfma_f32_16x16x32_bf16 a[228:231], a[132:135], a[200:203], a[228:231]
 s_add_u32 s8, s8, 0x10000
 s_addc_u32 s9, s9, 0
 v_mfma_f32_16x16x32_bf16 a[228:231], a[116:119], a[204:207], a[228:231]
 v_mfma_f32_16x16x32_bf16 a[228:231], a[100:103], a[192:195], a[228:231]
 v_mfma_f32_16x16x32_bf16 a[228:231], a[84:87], a[172:175], a[228:231]
 v_mfma_f32_16x16x32_bf16 a[232:235], a[88:91], a[172:175], a[232:235]
 v_mfma_f32_16x16x32_bf16 a[232:235], a[104:107], a[192:195], a[232:235]
 v_mfma_f32_16x16x32_bf16 a[232:235], a[120:123], a[204:207], a[232:235]
 v_mfma_f32_16x16x32_bf16 a[232:235], a[136:139], a[200:203], a[232:235]
 v_mfma_f32_16x16x32_bf16 a[232:235], a[152:155], a[184:187], a[232:235]
 v_mfma_f32_16x16x32_bf16 a[236:239], a[156:159], a[184:187], a[236:239]
 v_mfma_f32_16x16x32_bf16 a[236:239], a[140:143], a[200:203], a[236:239]
 v_mfma_f32_16x16x32_bf16 a[236:239], a[124:127], a[204:207], a[236:239]
 v_mfma_f32_16x16x32_bf16 a[236:239], a[108:111], a[192:195], a[236:239]
 v_mfma_f32_16x16x32_bf16 a[236:239], a[92:95], a[172:175], a[236:239]
 ds_read_b128 a[172:175], v1 offset:13056
 ds_read_b128 a[176:179], v1 offset:17408
 v_mfma_f32_16x16x32_bf16 a[252:255], a[92:95], a[192:195], a[252:255]
 ds_read_b128 a[180:183], v1 offset:21760
 v_mfma_f32_16x16x32_bf16 a[252:255], a[108:111], a[204:207], a[252:255]
 v_mfma_f32_16x16x32_bf16 a[252:255], a[124:127], a[200:203], a[252:255]
 v_mfma_f32_16x16x32_bf16 a[252:255], a[140:143], a[184:187], a[252:255]
 v_mfma_f32_16x16x32_bf16 a[252:255], a[156:159], a[196:199], a[252:255]
 v_mfma_f32_16x16x32_bf16 a[248:251], a[152:155], a[196:199], a[248:251]
 v_mfma_f32_16x16x32_bf16 a[248:251], a[136:139], a[184:187], a[248:251]
 v_mfma_f32_16x16x32_bf16 a[248:251], a[120:123], a[200:203], a[248:251]
 v_mfma_f32_16x16x32_bf16 a[248:251], a[104:107], a[204:207], a[248:251]
 v_mfma_f32_16x16x32_bf16 a[248:251], a[88:91], a[192:195], a[248:251]
 v_mfma_f32_16x16x32_bf16 a[244:247], a[84:87], a[192:195], a[244:247]
 v_mfma_f32_16x16x32_bf16 a[244:247], a[100:103], a[204:207], a[244:247]
 v_mfma_f32_16x16x32_bf16 a[244:247], a[116:119], a[200:203], a[244:247]
 v_mfma_f32_16x16x32_bf16 a[244:247], a[132:135], a[184:187], a[244:247]
 v_mfma_f32_16x16x32_bf16 a[244:247], a[148:151], a[196:199], a[244:247]
 v_mfma_f32_16x16x32_bf16 a[240:243], a[144:147], a[196:199], a[240:243]
 v_mfma_f32_16x16x32_bf16 a[240:243], a[128:131], a[184:187], a[240:243]
 v_mfma_f32_16x16x32_bf16 a[240:243], a[112:115], a[200:203], a[240:243]
 v_mfma_f32_16x16x32_bf16 a[240:243], a[96:99], a[204:207], a[240:243]
 v_mfma_f32_16x16x32_bf16 a[240:243], a[80:83], a[192:195], a[240:243]
 s_add_u32 s12, s20, s68
 s_addc_u32 s13, s21, 0
 s_add_u32 s40, s69, s45
 v_mad_i32_i24 v6, v39, s71, v6
 s_movk_i32 s25, 100
 s_movk_i32 s23, 100
 s_mov_b32 s30, 6
 v_min_u32 v47, L_e16-L_f16-4, v47
 s_add_u32 s88, s86, L_f16-L_c0
 s_addc_u32 s89, s87, 0
 s_branch L_mid
L_f16:
 s_waitcnt lgkmcnt(5)
 ds_read_b128 a[184:187], v1 offset:26112
 v_mfma_f32_16x16x32_bf16 v[48:51], a[0:3], a[160:163], v[48:51]
 s_waitcnt lgkmcnt(5)
 v_mfma_f32_16x16x32_bf16 v[48:51], a[16:19], a[164:167], v[48:51]
 s_waitcnt lgkmcnt(4)
 ds_read_b64_tr_b16 a[80:81], v46 offset:0
 v_mfma_f32_16x16x32_bf16 v[48:51], a[32:35], a[168:171], v[48:51]
 s_waitcnt lgkmcnt(4)
 ds_read_b64_tr_b16 a[82:83], v46 offset:256
 v_mfma_f32_16x16x32_bf16 v[48:51], a[48:51], a[172:175], v[48:51]
 s_waitcnt lgkmcnt(4)
 ds_read_b128 a[188:191], v1 offset:30464
 ds_read_b64_tr_b16 a[84:85], v46 offset:8
 v_mfma_f32_16x16x32_bf16 v[48:51], a[64:67], a[176:179], v[48:51]
 ds_read_b64_tr_b16 a[86:87], v46 offset:264
 v_mfma_f32_16x16x32_bf16 v[52:55], a[68:71], a[176:179], v[52:55]
 ds_read_b64_tr_b16 a[96:97], v46 offset:4096
 v_mfma_f32_16x16x32_bf16 v[52:55], a[52:55], a[172:175], v[52:55]
 ds_read_b64_tr_b16 a[98:99], v46 offset:4352
 v_mfma_f32_16x16x32_bf16 v[52:55], a[36:39], a[168:171], v[52:55]
 ds_read_b64_tr_b16 a[100:101], v46 offset:4104
 v_mfma_f32_16x16x32_bf16 v[52:55], a[20:23], a[164:167], v[52:55]
 ds_read_b64_tr_b16 a[102:103], v46 offset:4360
 v_mfma_f32_16x16x32_bf16 v[52:55], a[4:7], a[160:163], v[52:55]
 ds_read_b64_tr_b16 a[112:113], v46 offset:8192
 v_mfma_f32_16x16x32_bf16 v[56:59], a[8:11], a[160:163], v[56:59]
 ds_read_b64_tr_b16 a[114:115], v46 offset:8448
 v_mfma_f32_16x16x32_bf16 v[56:59], a[24:27], a[164:167], v[56:59]
 ds_read_b64_tr_b16 a[116:117], v46 offset:8200
 v_mfma_f32_16x16x32_bf16 v[56:59], a[40:43], a[168:171], v[56:59]
 ds_read_b64_tr_b16 a[118:119], v46 offset:8456
 v_mfma_f32_16x16x32_bf16 v[56:59], a[56:59], a[172:175], v[56:59]
 ds_read_b64_tr_b16 a[128:129], v46 offset:12288
 v_mfma_f32_16x16x32_bf16 v[56:59], a[72:75], a[176:179], v[56:59]
 ds_read_b64_tr_b16 a[130:131], v46 offset:12544
 v_mfma_f32_16x16x32_bf16 v[60:63], a[76:79], a[176:179], v[60:63]
 ds_read_b64_tr_b16 a[132:133], v46 offset:12296
 v_mfma_f32_16x16x32_bf16 v[60:63], a[60:63], a[172:175], v[60:63]
 ds_read_b64_tr_b16 a[134:135], v46 offset:12552
 v_mfma_f32_16x16x32_bf16 v[60:63], a[44:47], a[168:171], v[60:63]
 s_waitcnt vmcnt(10)
 ds_read_b64_tr_b16 a[144:145], v46 offset:16384
 v_mfma_f32_16x16x32_bf16 v[60:63], a[28:31], a[164:167], v[60:63]
 ds_read_b64_tr_b16 a[146:147], v46 offset:16640
 v_mfma_f32_16x16x32_bf16 v[60:63], a[12:15], a[160:163], v[60:63]
 ds_read_b128 a[192:195], v2 offset:0
 ds_read_b64_tr_b16 a[148:149], v46 offset:16392
 v_mfma_f32_16x16x32_bf16 v[76:79], a[12:15], a[164:167], v[76:79]
 ds_read_b128 a[196:199], v2 offset:4352
 ds_read_b64_tr_b16 a[150:151], v46 offset:16648
 v_mfma_f32_16x16x32_bf16 v[76:79], a[28:31], a[168:171], v[76:79]
 s_waitcnt vmcnt(8)
 ds_read_b128 a[200:203], v2 offset:8704
 ds_read_b64_tr_b16 a[88:89], v46 offset:1024
 v_mfma_f32_16x16x32_bf16 v[76:79], a[44:47], a[172:175], v[76:79]
 ds_read_b128 a[204:207], v2 offset:13056
 ds_read_b64_tr_b16 a[90:91], v46 offset:1280
 v_mfma_f32_16x16x32_bf16 v[76:79], a[60:63], a[176:179], v[76:79]
 s_waitcnt lgkmcnt(15)
 ds_read_b128 a[160:163], v2 offset:17408
 ds_read_b64_tr_b16 a[92:93], v46 offset:1032
 v_mfma_f32_16x16x32_bf16 v[76:79], a[76:79], a[180:183], v[76:79]
 ds_read_b64_tr_b16 a[94:95], v46 offset:1288
 v_mfma_f32_16x16x32_bf16 v[72:75], a[72:75], a[180:183], v[72:75]
 s_waitcnt vmcnt(6)
 ds_read_b64_tr_b16 a[104:105], v46 offset:5120
 v_mfma_f32_16x16x32_bf16 v[72:75], a[56:59], a[176:179], v[72:75]
 ds_read_b64_tr_b16 a[106:107], v46 offset:5376
 v_mfma_f32_16x16x32_bf16 v[72:75], a[40:43], a[172:175], v[72:75]
 ds_read_b64_tr_b16 a[108:109], v46 offset:5128
 v_mfma_f32_16x16x32_bf16 v[72:75], a[24:27], a[168:171], v[72:75]
 ds_read_b64_tr_b16 a[110:111], v46 offset:5384
 v_mfma_f32_16x16x32_bf16 v[72:75], a[8:11], a[164:167], v[72:75]
 s_waitcnt vmcnt(4)
 ds_read_b64_tr_b16 a[120:121], v46 offset:9216
 v_mfma_f32_16x16x32_bf16 v[68:71], a[4:7], a[164:167], v[68:71]
 ds_read_b64_tr_b16 a[122:123], v46 offset:9472
 v_mfma_f32_16x16x32_bf16 v[68:71], a[20:23], a[168:171], v[68:71]
 ds_read_b64_tr_b16 a[124:125], v46 offset:9224
 v_mfma_f32_16x16x32_bf16 v[68:71], a[36:39], a[172:175], v[68:71]
 ds_read_b64_tr_b16 a[126:127], v46 offset:9480
 v_mfma_f32_16x16x32_bf16 v[68:71], a[52:55], a[176:179], v[68:71]
 s_waitcnt vmcnt(2)
 ds_read_b64_tr_b16 a[136:137], v46 offset:13312
 v_mfma_f32_16x16x32_bf16 v[68:71], a[68:71], a[180:183], v[68:71]
 ds_read_b64_tr_b16 a[138:139], v46 offset:13568
 v_mfma_f32_16x16x32_bf16 v[64:67], a[64:67], a[180:183], v[64:67]
 ds_read_b64_tr_b16 a[140:141], v46 offset:13320
 v_mfma_f32_16x16x32_bf16 v[64:67], a[48:51], a[176:179], v[64:67]
 ds_read_b64_tr_b16 a[142:143], v46 offset:13576
 v_mfma_f32_16x16x32_bf16 v[64:67], a[32:35], a[172:175], v[64:67]
 s_waitcnt vmcnt(0)
 ds_read_b64_tr_b16 a[152:153], v46 offset:17408
 v_mfma_f32_16x16x32_bf16 v[64:67], a[16:19], a[168:171], v[64:67]
 ds_read_b64_tr_b16 a[154:155], v46 offset:17664
 v_mfma_f32_16x16x32_bf16 v[64:67], a[0:3], a[164:167], v[64:67]
 ds_read_b64_tr_b16 a[156:157], v46 offset:17416
 v_mfma_f32_16x16x32_bf16 v[80:83], a[0:3], a[168:171], v[80:83]
 ds_read_b64_tr_b16 a[158:159], v46 offset:17672
 v_mfma_f32_16x16x32_bf16 v[80:83], a[16:19], a[172:175], v[80:83]
 v_mfma_f32_16x16x32_bf16 v[80:83], a[32:35], a[176:179], v[80:83]
 v_mfma_f32_16x16x32_bf16 v[80:83], a[48:51], a[180:183], v[80:83]
 ds_read_b128 a[164:167], v2 offset:21760
 v_mfma_f32_16x16x32_bf16 v[80:83], a[64:67], a[184:187], v[80:83]
 v_mfma_f32_16x16x32_bf16 v[84:87], a[68:71], a[184:187], v[84:87]
 v_mfma_f32_16x16x32_bf16 v[84:87], a[52:55], a[180:183], v[84:87]
 v_mfma_f32_16x16x32_bf16 v[84:87], a[36:39], a[176:179], v[84:87]
 v_mfma_f32_16x16x32_bf16 v[84:87], a[20:23], a[172:175], v[84:87]
 v_mfma_f32_16x16x32_bf16 v[84:87], a[4:7], a[168:171], v[84:87]
 v_mfma_f32_16x16x32_bf16 v[88:91], a[8:11], a[168:171], v[88:91]
 v_mfma_f32_16x16x32_bf16 v[88:91], a[24:27], a[172:175], v[88:91]
 v_mfma_f32_16x16x32_bf16 v[88:91], a[40:43], a[176:179], v[88:91]
 v_mfma_f32_16x16x32_bf16 v[88:91], a[56:59], a[180:183], v[88:91]
 v_mfma_f32_16x16x32_bf16 v[88:91], a[72:75], a[184:187], v[88:91]
 v_mfma_f32_16x16x32_bf16 v[92:95], a[76:79], a[184:187], v[92:95]
 v_mfma_f32_16x16x32_bf16 v[92:95], a[60:63], a[180:183], v[92:95]
 v_mfma_f32_16x16x32_bf16 v[92:95], a[44:47], a[176:179], v[92:95]
 v_mfma_f32_16x16x32_bf16 v[92:95], a[28:31], a[172:175], v[92:95]
 v_mfma_f32_16x16x32_bf16 v[92:95], a[12:15], a[168:171], v[92:95]
 v_mfma_f32_16x16x32_bf16 v[108:111], a[12:15], a[172:175], v[108:111]
 v_mfma_f32_16x16x32_bf16 v[108:111], a[28:31], a[176:179], v[108:111]
 v_mfma_f32_16x16x32_bf16 v[108:111], a[44:47], a[180:183], v[108:111]
 v_mfma_f32_16x16x32_bf16 v[108:111], a[60:63], a[184:187], v[108:111]
 ds_read_b128 a[168:171], v2 offset:26112
 v_mfma_f32_16x16x32_bf16 v[108:111], a[76:79], a[188:191], v[108:111]
 v_mfma_f32_16x16x32_bf16 v[104:107], a[72:75], a[188:191], v[104:107]
 v_mfma_f32_16x16x32_bf16 v[104:107], a[56:59], a[184:187], v[104:107]
 v_mfma_f32_16x16x32_bf16 v[104:107], a[40:43], a[180:183], v[104:107]
 v_mfma_f32_16x16x32_bf16 v[104:107], a[24:27], a[176:179], v[104:107]
 v_mfma_f32_16x16x32_bf16 v[104:107], a[8:11], a[172:175], v[104:107]
 v_mfma_f32_16x16x32_bf16 v[100:103], a[4:7], a[172:175], v[100:103]
 v_mfma_f32_16x16x32_bf16 v[100:103], a[20:23], a[176:179], v[100:103]
 v_mfma_f32_16x16x32_bf16 v[100:103], a[36:39], a[180:183], v[100:103]
 v_mfma_f32_16x16x32_bf16 v[100:103], a[52:55], a[184:187], v[100:103]
 v_mfma_f32_16x16x32_bf16 v[100:103], a[68:71], a[188:191], v[100:103]
 v_mfma_f32_16x16x32_bf16 v[96:99], a[64:67], a[188:191], v[96:99]
 v_mfma_f32_16x16x32_bf16 v[96:99], a[48:51], a[184:187], v[96:99]
 v_mfma_f32_16x16x32_bf16 v[96:99], a[32:35], a[180:183], v[96:99]
 v_mfma_f32_16x16x32_bf16 v[96:99], a[16:19], a[176:179], v[96:99]
 v_mfma_f32_16x16x32_bf16 v[96:99], a[0:3], a[172:175], v[96:99]
 s_waitcnt lgkmcnt(0)
 v_mfma_f32_16x16x32_bf16 v[48:51], a[80:83], a[192:195], v[48:51]
 v_mfma_f32_16x16x32_bf16 v[48:51], a[96:99], a[196:199], v[48:51]
 v_mfma_f32_16x16x32_bf16 v[48:51], a[112:115], a[200:203], v[48:51]
 v_mfma_f32_16x16x32_bf16 v[48:51], a[128:131], a[204:207], v[48:51]
 ds_read_b128 a[188:191], v2 offset:30464
 v_mfma_f32_16x16x32_bf16 v[48:51], a[144:147], a[160:163], v[48:51]
 v_mfma_f32_16x16x32_bf16 v[52:55], a[148:151], a[160:163], v[52:55]
 v_mfma_f32_16x16x32_bf16 v[52:55], a[132:135], a[204:207], v[52:55]
 v_mfma_f32_16x16x32_bf16 v[52:55], a[116:119], a[200:203], v[52:55]
 v_mfma_f32_16x16x32_bf16 v[52:55], a[100:103], a[196:199], v[52:55]
 v_mfma_f32_16x16x32_bf16 v[52:55], a[84:87], a[192:195], v[52:55]
 v_mfma_f32_16x16x32_bf16 v[56:59], a[88:91], a[192:195], v[56:59]
 v_mfma_f32_16x16x32_bf16 v[56:59], a[104:107], a[196:199], v[56:59]
 v_mfma_f32_16x16x32_bf16 v[56:59], a[120:123], a[200:203], v[56:59]
 v_mfma_f32_16x16x32_bf16 v[56:59], a[136:139], a[204:207], v[56:59]
 v_mfma_f32_16x16x32_bf16 v[56:59], a[152:155], a[160:163], v[56:59]
 v_mfma_f32_16x16x32_bf16 v[60:63], a[156:159], a[160:163], v[60:63]
 v_mfma_f32_16x16x32_bf16 v[60:63], a[140:143], a[204:207], v[60:63]
 v_mfma_f32_16x16x32_bf16 v[60:63], a[124:127], a[200:203], v[60:63]
 v_mfma_f32_16x16x32_bf16 v[60:63], a[108:111], a[196:199], v[60:63]
 v_mfma_f32_16x16x32_bf16 v[60:63], a[92:95], a[192:195], v[60:63]
 ds_read_b128 a[184:187], v1 offset:17408
 v_mfma_f32_16x16x32_bf16 v[76:79], a[92:95], a[196:199], v[76:79]
 ds_read_b128 a[180:183], v1 offset:21760
 v_mfma_f32_16x16x32_bf16 v[76:79], a[108:111], a[200:203], v[76:79]
 ds_read_b128 a[176:179], v1 offset:26112
 v_mfma_f32_16x16x32_bf16 v[76:79], a[124:127], a[204:207], v[76:79]
 ds_read_b128 a[172:175], v1 offset:30464
 v_mfma_f32_16x16x32_bf16 v[76:79], a[140:143], a[160:163], v[76:79]
 ds_read_b128 a[192:195], v3 offset:0
 v_mfma_f32_16x16x32_bf16 v[76:79], a[156:159], a[164:167], v[76:79]
 v_mfma_f32_16x16x32_bf16 v[72:75], a[152:155], a[164:167], v[72:75]
 v_mfma_f32_16x16x32_bf16 v[72:75], a[136:139], a[160:163], v[72:75]
 v_mfma_f32_16x16x32_bf16 v[72:75], a[120:123], a[204:207], v[72:75]
 v_mul_f32 v20, s42, v48
 v_mul_f32 v21, s42, v49
 v_mfma_f32_16x16x32_bf16 v[72:75], a[104:107], a[200:203], v[72:75]
 v_mul_f32 v22, s42, v50
 v_mul_f32 v23, s42, v51
 v_mfma_f32_16x16x32_bf16 v[72:75], a[88:91], a[196:199], v[72:75]
 v_min_f32 v20, s47, v20
 v_min_f32 v21, s47, v21
 v_mfma_f32_16x16x32_bf16 v[68:71], a[84:87], a[196:199], v[68:71]
 v_min_f32 v22, s47, v22
 v_min_f32 v23, s47, v23
 v_mfma_f32_16x16x32_bf16 v[68:71], a[100:103], a[200:203], v[68:71]
 v_exp_f32 v20, v20
 v_mfma_f32_16x16x32_bf16 v[68:71], a[116:119], a[204:207], v[68:71]
 v_mul_f32 v24, s43, v56
 v_mul_f32 v25, s43, v57
 v_mfma_f32_16x16x32_bf16 v[68:71], a[132:135], a[160:163], v[68:71]
 v_exp_f32 v21, v21
 v_mfma_f32_16x16x32_bf16 v[68:71], a[148:151], a[164:167], v[68:71]
 v_mul_f32 v26, s43, v58
 v_mul_f32 v27, s43, v59
 v_mfma_f32_16x16x32_bf16 v[64:67], a[144:147], a[164:167], v[64:67]
 v_exp_f32 v22, v22
 v_mfma_f32_16x16x32_bf16 v[64:67], a[128:131], a[160:163], v[64:67]
 v_exp_f32 v23, v23
 v_mfma_f32_16x16x32_bf16 v[64:67], a[112:115], a[204:207], v[64:67]
 v_exp_f32 v24, v24
 v_mfma_f32_16x16x32_bf16 v[64:67], a[96:99], a[200:203], v[64:67]
 v_add_f32 v28, 1.0, v20
 v_add_f32 v29, 1.0, v21
 v_mfma_f32_16x16x32_bf16 v[64:67], a[80:83], a[196:199], v[64:67]
 v_exp_f32 v25, v25
 v_mfma_f32_16x16x32_bf16 v[80:83], a[80:83], a[200:203], v[80:83]
 v_add_f32 v30, 1.0, v22
 v_add_f32 v31, 1.0, v23
 v_mfma_f32_16x16x32_bf16 v[80:83], a[96:99], a[204:207], v[80:83]
 v_exp_f32 v26, v26
 v_mfma_f32_16x16x32_bf16 v[80:83], a[112:115], a[160:163], v[80:83]
 v_exp_f32 v27, v27
 v_mfma_f32_16x16x32_bf16 v[80:83], a[128:131], a[164:167], v[80:83]
 ds_read_b128 a[196:199], v3 offset:4352
 v_fmac_f32 v28, v28, v24
 v_mfma_f32_16x16x32_bf16 v[80:83], a[144:147], a[168:171], v[80:83]
 v_fmac_f32 v29, v29, v25
 v_fmac_f32 v30, v30, v26
 v_mfma_f32_16x16x32_bf16 v[84:87], a[148:151], a[168:171], v[84:87]
 v_fmac_f32 v31, v31, v27
 v_mul_f32 v32, s42, v52
 v_mfma_f32_16x16x32_bf16 v[84:87], a[132:135], a[164:167], v[84:87]
 v_rcp_f32 v28, v28
 v_mfma_f32_16x16x32_bf16 v[84:87], a[116:119], a[160:163], v[84:87]
 v_rcp_f32 v29, v29
 v_mfma_f32_16x16x32_bf16 v[84:87], a[100:103], a[204:207], v[84:87]
 v_rcp_f32 v30, v30
 v_mfma_f32_16x16x32_bf16 v[84:87], a[84:87], a[200:203], v[84:87]
 v_rcp_f32 v31, v31
 v_mfma_f32_16x16x32_bf16 v[88:91], a[88:91], a[200:203], v[88:91]
 v_fma_f32 v20, v20, v28, -v28
 v_fma_f32 v21, v21, v29, -v29
 v_mfma_f32_16x16x32_bf16 v[88:91], a[104:107], a[204:207], v[88:91]
 v_fma_f32 v22, v22, v30, -v30
 v_fma_f32 v23, v23, v31, -v31
 v_mfma_f32_16x16x32_bf16 v[88:91], a[120:123], a[160:163], v[88:91]
 v_cvt_pk_bf16_f32 v16, v20, v21
 v_cvt_pk_bf16_f32 v17, v22, v23
 v_mfma_f32_16x16x32_bf16 v[88:91], a[136:139], a[164:167], v[88:91]
 v_mul_f32 v33, s42, v53
 v_mul_f32 v34, s42, v54
 v_mfma_f32_16x16x32_bf16 v[88:91], a[152:155], a[168:171], v[88:91]
 v_mul_f32 v35, s42, v55
 v_min_f32 v32, s47, v32
 v_mfma_f32_16x16x32_bf16 v[92:95], a[156:159], a[168:171], v[92:95]
 v_min_f32 v33, s47, v33
 v_min_f32 v34, s47, v34
 v_mfma_f32_16x16x32_bf16 v[92:95], a[140:143], a[164:167], v[92:95]
 v_min_f32 v35, s47, v35
 v_mul_f32 v40, s43, v60
 v_mfma_f32_16x16x32_bf16 v[92:95], a[124:127], a[160:163], v[92:95]
 v_exp_f32 v32, v32
 v_mfma_f32_16x16x32_bf16 v[92:95], a[108:111], a[204:207], v[92:95]
 v_mul_f32 v41, s43, v61
 v_mul_f32 v42, s43, v62
 v_mfma_f32_16x16x32_bf16 v[92:95], a[92:95], a[200:203], v[92:95]
 v_exp_f32 v33, v33
 v_mfma_f32_16x16x32_bf16 v[108:111], a[92:95], a[204:207], v[108:111]
 v_mul_f32 v43, s43, v63
 v_add_f32 v28, 1.0, v32
 v_mfma_f32_16x16x32_bf16 v[108:111], a[108:111], a[160:163], v[108:111]
 v_exp_f32 v34, v34
 v_mfma_f32_16x16x32_bf16 v[108:111], a[124:127], a[164:167], v[108:111]
 v_exp_f32 v35, v35
 v_mfma_f32_16x16x32_bf16 v[108:111], a[140:143], a[168:171], v[108:111]
 s_waitcnt lgkmcnt(0)
 ds_read_b128 a[200:203], v3 offset:8704
 v_add_f32 v29, 1.0, v33
 v_mfma_f32_16x16x32_bf16 v[108:111], a[156:159], a[188:191], v[108:111]
 v_exp_f32 v40, v40
 v_mfma_f32_16x16x32_bf16 v[104:107], a[152:155], a[188:191], v[104:107]
 v_exp_f32 v41, v41
 v_mfma_f32_16x16x32_bf16 v[104:107], a[136:139], a[168:171], v[104:107]
 v_add_f32 v30, 1.0, v34
 v_add_f32 v31, 1.0, v35
 v_mfma_f32_16x16x32_bf16 v[104:107], a[120:123], a[164:167], v[104:107]
 v_exp_f32 v42, v42
 v_mfma_f32_16x16x32_bf16 v[104:107], a[104:107], a[160:163], v[104:107]
 v_exp_f32 v43, v43
 v_mfma_f32_16x16x32_bf16 v[104:107], a[88:91], a[204:207], v[104:107]
 v_fmac_f32 v28, v28, v40
 v_fmac_f32 v29, v29, v41
 v_mfma_f32_16x16x32_bf16 v[100:103], a[84:87], a[204:207], v[100:103]
 v_fmac_f32 v30, v30, v42
 v_fmac_f32 v31, v31, v43
 v_mfma_f32_16x16x32_bf16 v[100:103], a[100:103], a[160:163], v[100:103]
 v_rcp_f32 v28, v28
 v_mfma_f32_16x16x32_bf16 v[100:103], a[116:119], a[164:167], v[100:103]
 v_rcp_f32 v29, v29
 v_mfma_f32_16x16x32_bf16 v[100:103], a[132:135], a[168:171], v[100:103]
 v_rcp_f32 v30, v30
 v_mfma_f32_16x16x32_bf16 v[100:103], a[148:151], a[188:191], v[100:103]
 v_rcp_f32 v31, v31
 v_mfma_f32_16x16x32_bf16 v[96:99], a[144:147], a[188:191], v[96:99]
 v_fma_f32 v32, v32, v28, -v28
 v_fma_f32 v33, v33, v29, -v29
 v_mfma_f32_16x16x32_bf16 v[96:99], a[128:131], a[168:171], v[96:99]
 v_fma_f32 v34, v34, v30, -v30
 v_fma_f32 v35, v35, v31, -v31
 v_mfma_f32_16x16x32_bf16 v[96:99], a[112:115], a[164:167], v[96:99]
 v_cvt_pk_bf16_f32 v18, v32, v33
 v_cvt_pk_bf16_f32 v19, v34, v35
 v_mfma_f32_16x16x32_bf16 v[96:99], a[96:99], a[160:163], v[96:99]
 s_add_u32 s46, s40, 0
 buffer_store_dwordx4 v[16:19], v6, s[12:15], s46 offen
 v_mul_f32 v20, s42, v64
 v_mfma_f32_16x16x32_bf16 v[96:99], a[80:83], a[204:207], v[96:99]
 v_mul_f32 v21, s42, v65
 v_mul_f32 v22, s42, v66
 v_mfma_f32_16x16x32_bf16 v[112:115], a[0:3], a[184:187], v[112:115]
 v_mul_f32 v23, s42, v67
 v_min_f32 v20, s47, v20
 v_mfma_f32_16x16x32_bf16 v[112:115], a[16:19], a[180:183], v[112:115]
 v_min_f32 v21, s47, v21
 v_min_f32 v22, s47, v22
 v_mfma_f32_16x16x32_bf16 v[112:115], a[32:35], a[176:179], v[112:115]
 v_min_f32 v23, s47, v23
 v_mul_f32 v24, s43, v72
 v_mfma_f32_16x16x32_bf16 v[112:115], a[48:51], a[172:175], v[112:115]
 ds_read_b128 a[188:191], v3 offset:13056
 v_mul_f32 v25, s43, v73
 v_mfma_f32_16x16x32_bf16 v[112:115], a[64:67], a[192:195], v[112:115]
 v_exp_f32 v20, v20
 v_mfma_f32_16x16x32_bf16 v[116:119], a[68:71], a[192:195], v[116:119]
 v_exp_f32 v21, v21
 v_mfma_f32_16x16x32_bf16 v[116:119], a[52:55], a[172:175], v[116:119]
 v_mul_f32 v26, s43, v74
 v_mul_f32 v27, s43, v75
 v_mfma_f32_16x16x32_bf16 v[116:119], a[36:39], a[176:179], v[116:119]
 v_exp_f32 v22, v22
 v_mfma_f32_16x16x32_bf16 v[116:119], a[20:23], a[180:183], v[116:119]
 v_exp_f32 v23, v23
 v_mfma_f32_16x16x32_bf16 v[116:119], a[4:7], a[184:187], v[116:119]
 v_exp_f32 v24, v24
 v_mfma_f32_16x16x32_bf16 v[120:123], a[8:11], a[184:187], v[120:123]
 v_add_f32 v28, 1.0, v20
 v_add_f32 v29, 1.0, v21
 v_mfma_f32_16x16x32_bf16 v[120:123], a[24:27], a[180:183], v[120:123]
 v_exp_f32 v25, v25
 v_mfma_f32_16x16x32_bf16 v[120:123], a[40:43], a[176:179], v[120:123]
 v_add_f32 v30, 1.0, v22
 v_add_f32 v31, 1.0, v23
 v_mfma_f32_16x16x32_bf16 v[120:123], a[56:59], a[172:175], v[120:123]
 v_exp_f32 v26, v26
 v_mfma_f32_16x16x32_bf16 v[120:123], a[72:75], a[192:195], v[120:123]
 v_exp_f32 v27, v27
 v_mfma_f32_16x16x32_bf16 v[124:127], a[76:79], a[192:195], v[124:127]
 v_fmac_f32 v28, v28, v24
 v_fmac_f32 v29, v29, v25
 v_mfma_f32_16x16x32_bf16 v[124:127], a[60:63], a[172:175], v[124:127]
 v_fmac_f32 v30, v30, v26
 v_fmac_f32 v31, v31, v27
 v_mfma_f32_16x16x32_bf16 v[124:127], a[44:47], a[176:179], v[124:127]
 v_rcp_f32 v28, v28
 v_mfma_f32_16x16x32_bf16 v[124:127], a[28:31], a[180:183], v[124:127]
 v_rcp_f32 v29, v29
 v_mfma_f32_16x16x32_bf16 v[124:127], a[12:15], a[184:187], v[124:127]
 ds_read_b128 a[168:171], v2 offset:17408
 v_fma_f32 v20, v20, v28, -v28
 v_mfma_f32_16x16x32_bf16 v[140:143], a[12:15], a[180:183], v[140:143]
 ds_read_b128 a[164:167], v2 offset:21760
 v_fma_f32 v21, v21, v29, -v29
 v_mfma_f32_16x16x32_bf16 v[140:143], a[28:31], a[176:179], v[140:143]
 ds_read_b128 a[160:163], v2 offset:26112
 v_cvt_pk_bf16_f32 v16, v20, v21
 v_mfma_f32_16x16x32_bf16 v[140:143], a[44:47], a[172:175], v[140:143]
 ds_read_b128 a[204:207], v2 offset:30464
 v_mul_f32 v32, s42, v68
 v_mfma_f32_16x16x32_bf16 v[140:143], a[60:63], a[192:195], v[140:143]
 ds_read_b128 a[184:187], v4 offset:0
 v_mul_f32 v33, s42, v69
 v_mfma_f32_16x16x32_bf16 v[140:143], a[76:79], a[196:199], v[140:143]
 v_rcp_f32 v30, v30
 v_mfma_f32_16x16x32_bf16 v[136:139], a[72:75], a[196:199], v[136:139]
 v_rcp_f32 v31, v31
 v_mfma_f32_16x16x32_bf16 v[136:139], a[56:59], a[192:195], v[136:139]
 v_fma_f32 v22, v22, v30, -v30
 v_fma_f32 v23, v23, v31, -v31
 v_mfma_f32_16x16x32_bf16 v[136:139], a[40:43], a[172:175], v[136:139]
 v_cvt_pk_bf16_f32 v17, v22, v23
 v_mul_f32 v34, s42, v70
 v_mfma_f32_16x16x32_bf16 v[136:139], a[24:27], a[176:179], v[136:139]
 v_mul_f32 v35, s42, v71
 v_min_f32 v32, s47, v32
 v_mfma_f32_16x16x32_bf16 v[136:139], a[8:11], a[180:183], v[136:139]
 v_min_f32 v33, s47, v33
 v_min_f32 v34, s47, v34
 v_mfma_f32_16x16x32_bf16 v[132:135], a[4:7], a[180:183], v[132:135]
 v_min_f32 v35, s47, v35
 v_mul_f32 v40, s43, v76
 v_mfma_f32_16x16x32_bf16 v[132:135], a[20:23], a[176:179], v[132:135]
 v_exp_f32 v32, v32
 v_mfma_f32_16x16x32_bf16 v[132:135], a[36:39], a[172:175], v[132:135]
 v_mul_f32 v41, s43, v77
 v_mul_f32 v42, s43, v78
 v_mfma_f32_16x16x32_bf16 v[132:135], a[52:55], a[192:195], v[132:135]
 v_exp_f32 v33, v33
 v_mfma_f32_16x16x32_bf16 v[132:135], a[68:71], a[196:199], v[132:135]
 v_mul_f32 v43, s43, v79
 v_add_f32 v28, 1.0, v32
 v_mfma_f32_16x16x32_bf16 v[128:131], a[64:67], a[196:199], v[128:131]
 v_exp_f32 v34, v34
 v_mfma_f32_16x16x32_bf16 v[128:131], a[48:51], a[192:195], v[128:131]
 v_exp_f32 v35, v35
 v_mfma_f32_16x16x32_bf16 v[128:131], a[32:35], a[172:175], v[128:131]
 v_exp_f32 v40, v40
 v_mfma_f32_16x16x32_bf16 v[128:131], a[16:19], a[176:179], v[128:131]
 v_add_f32 v29, 1.0, v33
 v_add_f32 v30, 1.0, v34
 v_mfma_f32_16x16x32_bf16 v[128:131], a[0:3], a[180:183], v[128:131]
 v_exp_f32 v41, v41
 v_mfma_f32_16x16x32_bf16 v[144:147], a[0:3], a[176:179], v[144:147]
 v_add_f32 v31, 1.0, v35
 v_fmac_f32 v28, v28, v40
 v_mfma_f32_16x16x32_bf16 v[144:147], a[16:19], a[172:175], v[144:147]
 v_exp_f32 v42, v42
 v_mfma_f32_16x16x32_bf16 v[144:147], a[32:35], a[192:195], v[144:147]
 v_exp_f32 v43, v43
 v_mfma_f32_16x16x32_bf16 v[144:147], a[48:51], a[196:199], v[144:147]
 s_waitcnt lgkmcnt(0)
 ds_read_b128 a[180:183], v4 offset:4352
 v_fmac_f32 v29, v29, v41
 v_mfma_f32_16x16x32_bf16 v[144:147], a[64:67], a[200:203], v[144:147]
 v_fmac_f32 v30, v30, v42
 v_fmac_f32 v31, v31, v43
 v_mfma_f32_16x16x32_bf16 v[148:151], a[68:71], a[200:203], v[148:151]
 v_rcp_f32 v28, v28
 v_mfma_f32_16x16x32_bf16 v[148:151], a[52:55], a[196:199], v[148:151]
 v_rcp_f32 v29, v29
 v_mfma_f32_16x16x32_bf16 v[148:151], a[36:39], a[192:195], v[148:151]
 v_rcp_f32 v30, v30
 v_mfma_f32_16x16x32_bf16 v[148:151], a[20:23], a[172:175], v[148:151]
 v_rcp_f32 v31, v31
 v_mfma_f32_16x16x32_bf16 v[148:151], a[4:7], a[176:179], v[148:151]
 v_fma_f32 v32, v32, v28, -v28
 v_fma_f32 v33, v33, v29, -v29
 v_mfma_f32_16x16x32_bf16 v[152:155], a[8:11], a[176:179], v[152:155]
 v_fma_f32 v34, v34, v30, -v30
 v_fma_f32 v35, v35, v31, -v31
 v_mfma_f32_16x16x32_bf16 v[152:155], a[24:27], a[172:175], v[152:155]
 v_cvt_pk_bf16_f32 v18, v32, v33
 v_cvt_pk_bf16_f32 v19, v34, v35
 v_mfma_f32_16x16x32_bf16 v[152:155], a[40:43], a[192:195], v[152:155]
 s_add_u32 s46, s40, 2048
 buffer_store_dwordx4 v[16:19], v6, s[12:15], s46 offen
 v_mul_f32 v20, s42, v80
 v_mfma_f32_16x16x32_bf16 v[152:155], a[56:59], a[196:199], v[152:155]
 v_mul_f32 v21, s42, v81
 v_mul_f32 v22, s42, v82
 v_mfma_f32_16x16x32_bf16 v[152:155], a[72:75], a[200:203], v[152:155]
 v_mul_f32 v23, s42, v83
 v_min_f32 v20, s47, v20
 v_mfma_f32_16x16x32_bf16 v[156:159], a[76:79], a[200:203], v[156:159]
 v_min_f32 v21, s47, v21
 v_min_f32 v22, s47, v22
 v_mfma_f32_16x16x32_bf16 v[156:159], a[60:63], a[196:199], v[156:159]
 v_min_f32 v23, s47, v23
 v_mul_f32 v24, s43, v88
 v_mfma_f32_16x16x32_bf16 v[156:159], a[44:47], a[192:195], v[156:159]
 v_exp_f32 v20, v20
 v_mfma_f32_16x16x32_bf16 v[156:159], a[28:31], a[172:175], v[156:159]
 v_mul_f32 v25, s43, v89
 v_mul_f32 v26, s43, v90
 v_mfma_f32_16x16x32_bf16 v[156:159], a[12:15], a[176:179], v[156:159]
 v_exp_f32 v21, v21
 v_mfma_f32_16x16x32_bf16 v[172:175], a[12:15], a[172:175], v[172:175]
 v_mul_f32 v27, s43, v91
 v_add_f32 v28, 1.0, v20
 v_mfma_f32_16x16x32_bf16 v[172:175], a[28:31], a[192:195], v[172:175]
 v_exp_f32 v22, v22
 v_mfma_f32_16x16x32_bf16 v[172:175], a[44:47], a[196:199], v[172:175]
 v_exp_f32 v23, v23
 v_mfma_f32_16x16x32_bf16 v[172:175], a[60:63], a[200:203], v[172:175]
 ds_read_b128 a[176:179], v4 offset:8704
 v_add_f32 v29, 1.0, v21
 v_mfma_f32_16x16x32_bf16 v[172:175], a[76:79], a[188:191], v[172:175]
 v_exp_f32 v24, v24
 v_mfma_f32_16x16x32_bf16 v[168:171], a[72:75], a[188:191], v[168:171]
 v_exp_f32 v25, v25
 v_mfma_f32_16x16x32_bf16 v[168:171], a[56:59], a[200:203], v[168:171]
 v_add_f32 v30, 1.0, v22
 v_add_f32 v31, 1.0, v23
 v_mfma_f32_16x16x32_bf16 v[168:171], a[40:43], a[196:199], v[168:171]
 v_exp_f32 v26, v26
 v_mfma_f32_16x16x32_bf16 v[168:171], a[24:27], a[192:195], v[168:171]
 v_exp_f32 v27, v27
 v_mfma_f32_16x16x32_bf16 v[168:171], a[8:11], a[172:175], v[168:171]
 v_fmac_f32 v28, v28, v24
 v_fmac_f32 v29, v29, v25
 v_mfma_f32_16x16x32_bf16 v[164:167], a[4:7], a[172:175], v[164:167]
 v_fmac_f32 v30, v30, v26
 v_fmac_f32 v31, v31, v27
 v_mfma_f32_16x16x32_bf16 v[164:167], a[20:23], a[192:195], v[164:167]
 v_rcp_f32 v28, v28
 v_mfma_f32_16x16x32_bf16 v[164:167], a[36:39], a[196:199], v[164:167]
 v_rcp_f32 v29, v29
 v_mfma_f32_16x16x32_bf16 v[164:167], a[52:55], a[200:203], v[164:167]
 v_rcp_f32 v30, v30
 v_mfma_f32_16x16x32_bf16 v[164:167], a[68:71], a[188:191], v[164:167]
 v_rcp_f32 v31, v31
 v_mfma_f32_16x16x32_bf16 v[160:163], a[64:67], a[188:191], v[160:163]
 v_fma_f32 v20, v20, v28, -v28
 v_fma_f32 v21, v21, v29, -v29
 v_mfma_f32_16x16x32_bf16 v[160:163], a[48:51], a[200:203], v[160:163]
 v_fma_f32 v22, v22, v30, -v30
 v_fma_f32 v23, v23, v31, -v31
 v_mfma_f32_16x16x32_bf16 v[160:163], a[32:35], a[196:199], v[160:163]
 v_cvt_pk_bf16_f32 v16, v20, v21
 v_cvt_pk_bf16_f32 v17, v22, v23
 v_mfma_f32_16x16x32_bf16 v[160:163], a[16:19], a[192:195], v[160:163]
 v_mul_f32 v32, s42, v84
 v_mul_f32 v33, s42, v85
 v_mfma_f32_16x16x32_bf16 v[160:163], a[0:3], a[172:175], v[160:163]
 v_mul_f32 v34, s42, v86
 v_mul_f32 v35, s42, v87
 v_mfma_f32_16x16x32_bf16 v[112:115], a[80:83], a[168:171], v[112:115]
 v_min_f32 v32, s47, v32
 v_min_f32 v33, s47, v33
 v_mfma_f32_16x16x32_bf16 v[112:115], a[96:99], a[164:167], v[112:115]
 v_min_f32 v34, s47, v34
 v_min_f32 v35, s47, v35
 v_mfma_f32_16x16x32_bf16 v[112:115], a[112:115], a[160:163], v[112:115]
 v_exp_f32 v32, v32
 v_mfma_f32_16x16x32_bf16 v[112:115], a[128:131], a[204:207], v[112:115]
 ds_read_b128 a[188:191], v4 offset:13056
 v_mul_f32 v40, s43, v92
 v_mfma_f32_16x16x32_bf16 v[112:115], a[144:147], a[184:187], v[112:115]
 v_mul_f32 v41, s43, v93
 v_mul_f32 v42, s43, v94
 v_mfma_f32_16x16x32_bf16 v[116:119], a[148:151], a[184:187], v[116:119]
 v_exp_f32 v33, v33
 v_mfma_f32_16x16x32_bf16 v[116:119], a[132:135], a[204:207], v[116:119]
 v_mul_f32 v43, s43, v95
 v_add_f32 v28, 1.0, v32
 v_mfma_f32_16x16x32_bf16 v[116:119], a[116:119], a[160:163], v[116:119]
 v_exp_f32 v34, v34
 v_mfma_f32_16x16x32_bf16 v[116:119], a[100:103], a[164:167], v[116:119]
 v_exp_f32 v35, v35
 v_mfma_f32_16x16x32_bf16 v[116:119], a[84:87], a[168:171], v[116:119]
 v_exp_f32 v40, v40
 v_mfma_f32_16x16x32_bf16 v[120:123], a[88:91], a[168:171], v[120:123]
 v_add_f32 v29, 1.0, v33
 v_add_f32 v30, 1.0, v34
 v_mfma_f32_16x16x32_bf16 v[120:123], a[104:107], a[164:167], v[120:123]
 v_exp_f32 v41, v41
 v_mfma_f32_16x16x32_bf16 v[120:123], a[120:123], a[160:163], v[120:123]
 v_add_f32 v31, 1.0, v35
 v_fmac_f32 v28, v28, v40
 v_mfma_f32_16x16x32_bf16 v[120:123], a[136:139], a[204:207], v[120:123]
 v_exp_f32 v42, v42
 v_mfma_f32_16x16x32_bf16 v[120:123], a[152:155], a[184:187], v[120:123]
 v_exp_f32 v43, v43
 v_mfma_f32_16x16x32_bf16 v[124:127], a[156:159], a[184:187], v[124:127]
 v_fmac_f32 v29, v29, v41
 v_fmac_f32 v30, v30, v42
 v_mfma_f32_16x16x32_bf16 v[124:127], a[140:143], a[204:207], v[124:127]
 v_fmac_f32 v31, v31, v43
 v_mul_f32 v20, s42, v96
 v_mfma_f32_16x16x32_bf16 v[124:127], a[124:127], a[160:163], v[124:127]
 v_rcp_f32 v28, v28
 v_mfma_f32_16x16x32_bf16 v[124:127], a[108:111], a[164:167], v[124:127]
 v_rcp_f32 v29, v29
 v_mfma_f32_16x16x32_bf16 v[124:127], a[92:95], a[168:171], v[124:127]
 ds_read_b128 a[200:203], v1 offset:2176
 v_fma_f32 v32, v32, v28, -v28
 v_mfma_f32_16x16x32_bf16 v[140:143], a[92:95], a[164:167], v[140:143]
 ds_read_b128 a[196:199], v1 offset:6528
 v_fma_f32 v33, v33, v29, -v29
 v_mfma_f32_16x16x32_bf16 v[140:143], a[108:111], a[160:163], v[140:143]
 ds_read_b128 a[192:195], v1 offset:10880
 v_cvt_pk_bf16_f32 v18, v32, v33
 v_mfma_f32_16x16x32_bf16 v[140:143], a[124:127], a[204:207], v[140:143]
 ds_read_b128 a[172:175], v1 offset:15232
 v_mul_f32 v21, s42, v97
 v_mfma_f32_16x16x32_bf16 v[140:143], a[140:143], a[184:187], v[140:143]
 s_waitcnt lgkmcnt(4)
 ds_read_b128 a[168:171], v1 offset:19584
 v_mul_f32 v22, s42, v98
 v_mfma_f32_16x16x32_bf16 v[140:143], a[156:159], a[180:183], v[140:143]
 v_rcp_f32 v30, v30
 v_mfma_f32_16x16x32_bf16 v[136:139], a[152:155], a[180:183], v[136:139]
 v_rcp_f32 v31, v31
 v_mfma_f32_16x16x32_bf16 v[136:139], a[136:139], a[184:187], v[136:139]
 v_fma_f32 v34, v34, v30, -v30
 v_fma_f32 v35, v35, v31, -v31
 v_mfma_f32_16x16x32_bf16 v[136:139], a[120:123], a[204:207], v[136:139]
 s_add_u32 s46, s40, 4096
 v_cvt_pk_bf16_f32 v19, v34, v35
 buffer_store_dwordx4 v[16:19], v6, s[12:15], s46 offen
 v_mfma_f32_16x16x32_bf16 v[136:139], a[104:107], a[160:163], v[136:139]
 v_mul_f32 v23, s42, v99
 v_min_f32 v20, s47, v20
 v_mfma_f32_16x16x32_bf16 v[136:139], a[88:91], a[164:167], v[136:139]
 v_min_f32 v21, s47, v21
 v_min_f32 v22, s47, v22
 v_mfma_f32_16x16x32_bf16 v[132:135], a[84:87], a[164:167], v[132:135]
 v_min_f32 v23, s47, v23
 v_mul_f32 v24, s43, v104
 v_mfma_f32_16x16x32_bf16 v[132:135], a[100:103], a[160:163], v[132:135]
 v_exp_f32 v20, v20
 v_mfma_f32_16x16x32_bf16 v[132:135], a[116:119], a[204:207], v[132:135]
 v_mul_f32 v25, s43, v105
 v_mul_f32 v26, s43, v106
 v_mfma_f32_16x16x32_bf16 v[132:135], a[132:135], a[184:187], v[132:135]
 v_exp_f32 v21, v21
 v_mfma_f32_16x16x32_bf16 v[132:135], a[148:151], a[180:183], v[132:135]
 v_mul_f32 v27, s43, v107
 v_add_f32 v28, 1.0, v20
 v_mfma_f32_16x16x32_bf16 v[128:131], a[144:147], a[180:183], v[128:131]
 v_exp_f32 v22, v22
 v_mfma_f32_16x16x32_bf16 v[128:131], a[128:131], a[184:187], v[128:131]
 v_exp_f32 v23, v23
 v_mfma_f32_16x16x32_bf16 v[128:131], a[112:115], a[204:207], v[128:131]
 v_exp_f32 v24, v24
 v_mfma_f32_16x16x32_bf16 v[128:131], a[96:99], a[160:163], v[128:131]
 v_add_f32 v29, 1.0, v21
 v_add_f32 v30, 1.0, v22
 v_mfma_f32_16x16x32_bf16 v[128:131], a[80:83], a[164:167], v[128:131]
 v_exp_f32 v25, v25
 v_mfma_f32_16x16x32_bf16 v[144:147], a[80:83], a[160:163], v[144:147]
 v_add_f32 v31, 1.0, v23
 v_fmac_f32 v28, v28, v24
 v_mfma_f32_16x16x32_bf16 v[144:147], a[96:99], a[204:207], v[144:147]
 v_exp_f32 v26, v26
 v_mfma_f32_16x16x32_bf16 v[144:147], a[112:115], a[184:187], v[144:147]
 v_exp_f32 v27, v27
 v_mfma_f32_16x16x32_bf16 v[144:147], a[128:131], a[180:183], v[144:147]
 ds_read_b128 a[164:167], v1 offset:23936
 v_fmac_f32 v29, v29, v25
 v_mfma_f32_16x16x32_bf16 v[144:147], a[144:147], a[176:179], v[144:147]
 v_fmac_f32 v30, v30, v26
 v_fmac_f32 v31, v31, v27
 v_mfma_f32_16x16x32_bf16 v[148:151], a[148:151], a[176:179], v[148:151]
 v_rcp_f32 v28, v28
 v_mfma_f32_16x16x32_bf16 v[148:151], a[132:135], a[180:183], v[148:151]
 v_rcp_f32 v29, v29
 v_mfma_f32_16x16x32_bf16 v[148:151], a[116:119], a[184:187], v[148:151]
 v_rcp_f32 v30, v30
 v_mfma_f32_16x16x32_bf16 v[148:151], a[100:103], a[204:207], v[148:151]
 v_rcp_f32 v31, v31
 v_mfma_f32_16x16x32_bf16 v[148:151], a[84:87], a[160:163], v[148:151]
 v_fma_f32 v20, v20, v28, -v28
 v_fma_f32 v21, v21, v29, -v29
 v_mfma_f32_16x16x32_bf16 v[152:155], a[88:91], a[160:163], v[152:155]
 v_fma_f32 v22, v22, v30, -v30
 v_fma_f32 v23, v23, v31, -v31
 v_mfma_f32_16x16x32_bf16 v[152:155], a[104:107], a[204:207], v[152:155]
 v_cvt_pk_bf16_f32 v16, v20, v21
 v_cvt_pk_bf16_f32 v17, v22, v23
 v_mfma_f32_16x16x32_bf16 v[152:155], a[120:123], a[184:187], v[152:155]
 v_mul_f32 v32, s42, v100
 v_mul_f32 v33, s42, v101
 v_mfma_f32_16x16x32_bf16 v[152:155], a[136:139], a[180:183], v[152:155]
 v_mul_f32 v34, s42, v102
 v_mul_f32 v35, s42, v103
 v_mfma_f32_16x16x32_bf16 v[152:155], a[152:155], a[176:179], v[152:155]
 v_min_f32 v32, s47, v32
 v_min_f32 v33, s47, v33
 v_mfma_f32_16x16x32_bf16 v[156:159], a[156:159], a[176:179], v[156:159]
 v_min_f32 v34, s47, v34
 v_min_f32 v35, s47, v35
 v_mfma_f32_16x16x32_bf16 v[156:159], a[140:143], a[180:183], v[156:159]
 v_exp_f32 v32, v32
 v_mfma_f32_16x16x32_bf16 v[156:159], a[124:127], a[184:187], v[156:159]
 v_mul_f32 v40, s43, v108
 v_mul_f32 v41, s43, v109
 v_mfma_f32_16x16x32_bf16 v[156:159], a[108:111], a[204:207], v[156:159]
 v_exp_f32 v33, v33
 v_mfma_f32_16x16x32_bf16 v[156:159], a[92:95], a[160:163], v[156:159]
 v_mul_f32 v42, s43, v110
 v_mul_f32 v43, s43, v111
 v_mfma_f32_16x16x32_bf16 v[172:175], a[92:95], a[204:207], v[172:175]
 v_exp_f32 v34, v34
 v_mfma_f32_16x16x32_bf16 v[172:175], a[108:111], a[184:187], v[172:175]
 v_exp_f32 v35, v35
 v_mfma_f32_16x16x32_bf16 v[172:175], a[124:127], a[180:183], v[172:175]
 v_exp_f32 v40, v40
 v_mfma_f32_16x16x32_bf16 v[172:175], a[140:143], a[176:179], v[172:175]
 ds_read_b128 a[160:163], v1 offset:28288
 v_add_f32 v28, 1.0, v32
 v_mfma_f32_16x16x32_bf16 v[172:175], a[156:159], a[188:191], v[172:175]
 v_add_f32 v29, 1.0, v33
 v_add_f32 v30, 1.0, v34
 v_mfma_f32_16x16x32_bf16 v[168:171], a[152:155], a[188:191], v[168:171]
 v_exp_f32 v41, v41
 v_mfma_f32_16x16x32_bf16 v[168:171], a[136:139], a[176:179], v[168:171]
 v_add_f32 v31, 1.0, v35
 v_fmac_f32 v28, v28, v40
 v_mfma_f32_16x16x32_bf16 v[168:171], a[120:123], a[180:183], v[168:171]
 v_exp_f32 v42, v42
 v_mfma_f32_16x16x32_bf16 v[168:171], a[104:107], a[184:187], v[168:171]
 v_exp_f32 v43, v43
 v_mfma_f32_16x16x32_bf16 v[168:171], a[88:91], a[204:207], v[168:171]
 v_fmac_f32 v29, v29, v41
 v_fmac_f32 v30, v30, v42
 v_mfma_f32_16x16x32_bf16 v[164:167], a[84:87], a[204:207], v[164:167]
 v_fmac_f32 v31, v31, v43
 v_mul_f32 v20, s42, v112
 v_mfma_f32_16x16x32_bf16 v[164:167], a[100:103], a[184:187], v[164:167]
 v_rcp_f32 v28, v28
 v_mfma_f32_16x16x32_bf16 v[164:167], a[116:119], a[180:183], v[164:167]
 v_rcp_f32 v29, v29
 v_mfma_f32_16x16x32_bf16 v[164:167], a[132:135], a[176:179], v[164:167]
 v_rcp_f32 v30, v30
 v_mfma_f32_16x16x32_bf16 v[164:167], a[148:151], a[188:191], v[164:167]
 v_rcp_f32 v31, v31
 v_mfma_f32_16x16x32_bf16 v[160:163], a[144:147], a[188:191], v[160:163]
 v_fma_f32 v32, v32, v28, -v28
 v_fma_f32 v33, v33, v29, -v29
 v_mfma_f32_16x16x32_bf16 v[160:163], a[128:131], a[176:179], v[160:163]
 v_fma_f32 v34, v34, v30, -v30
 v_fma_f32 v35, v35, v31, -v31
 v_mfma_f32_16x16x32_bf16 v[160:163], a[112:115], a[180:183], v[160:163]
 v_cvt_pk_bf16_f32 v18, v32, v33
 v_cvt_pk_bf16_f32 v19, v34, v35
 v_mfma_f32_16x16x32_bf16 v[160:163], a[96:99], a[184:187], v[160:163]
 s_add_u32 s46, s40, 6144
 buffer_store_dwordx4 v[16:19], v6, s[12:15], s46 offen
 v_mul_f32 v21, s42, v113
 v_mfma_f32_16x16x32_bf16 v[160:163], a[80:83], a[204:207], v[160:163]
 s_waitcnt lgkmcnt(0)
 v_mul_f32 v22, s42, v114
 v_mul_f32 v23, s42, v115
 v_mfma_f32_16x16x32_bf16 v[176:179], a[0:3], a[200:203], v[176:179]
 v_min_f32 v20, s47, v20
 v_min_f32 v21, s47, v21
 v_mfma_f32_16x16x32_bf16 v[176:179], a[16:19], a[196:199], v[176:179]
 v_min_f32 v22, s47, v22
 v_min_f32 v23, s47, v23
 v_mfma_f32_16x16x32_bf16 v[176:179], a[32:35], a[192:195], v[176:179]
 v_exp_f32 v20, v20
 v_mfma_f32_16x16x32_bf16 v[176:179], a[48:51], a[172:175], v[176:179]
 ds_read_b128 a[188:191], v1 offset:32640
 v_mul_f32 v24, s43, v120
 v_mfma_f32_16x16x32_bf16 v[176:179], a[64:67], a[168:171], v[176:179]
 v_mul_f32 v25, s43, v121
 v_mul_f32 v26, s43, v122
 v_mfma_f32_16x16x32_bf16 v[180:183], a[68:71], a[168:171], v[180:183]
 v_exp_f32 v21, v21
 v_mfma_f32_16x16x32_bf16 v[180:183], a[52:55], a[172:175], v[180:183]
 v_mul_f32 v27, s43, v123
 v_add_f32 v28, 1.0, v20
 v_mfma_f32_16x16x32_bf16 v[180:183], a[36:39], a[192:195], v[180:183]
 v_exp_f32 v22, v22
 v_mfma_f32_16x16x32_bf16 v[180:183], a[20:23], a[196:199], v[180:183]
 v_exp_f32 v23, v23
 v_mfma_f32_16x16x32_bf16 v[180:183], a[4:7], a[200:203], v[180:183]
 v_exp_f32 v24, v24
 v_mfma_f32_16x16x32_bf16 v[184:187], a[8:11], a[200:203], v[184:187]
 v_add_f32 v29, 1.0, v21
 v_add_f32 v30, 1.0, v22
 v_mfma_f32_16x16x32_bf16 v[184:187], a[24:27], a[196:199], v[184:187]
 v_exp_f32 v25, v25
 v_mfma_f32_16x16x32_bf16 v[184:187], a[40:43], a[192:195], v[184:187]
 v_add_f32 v31, 1.0, v23
 v_fmac_f32 v28, v28, v24
 v_mfma_f32_16x16x32_bf16 v[184:187], a[56:59], a[172:175], v[184:187]
 v_exp_f32 v26, v26
 v_mfma_f32_16x16x32_bf16 v[184:187], a[72:75], a[168:171], v[184:187]
 v_exp_f32 v27, v27
 v_mfma_f32_16x16x32_bf16 v[188:191], a[76:79], a[168:171], v[188:191]
 v_fmac_f32 v29, v29, v25
 v_fmac_f32 v30, v30, v26
 v_mfma_f32_16x16x32_bf16 v[188:191], a[60:63], a[172:175], v[188:191]
 v_fmac_f32 v31, v31, v27
 v_mul_f32 v32, s42, v116
 v_mfma_f32_16x16x32_bf16 v[188:191], a[44:47], a[192:195], v[188:191]
 v_rcp_f32 v28, v28
 v_mfma_f32_16x16x32_bf16 v[188:191], a[28:31], a[196:199], v[188:191]
 v_rcp_f32 v29, v29
 v_mfma_f32_16x16x32_bf16 v[188:191], a[12:15], a[200:203], v[188:191]
 ds_read_b128 a[176:179], v2 offset:2176
 v_fma_f32 v20, v20, v28, -v28
 v_mfma_f32_16x16x32_bf16 v[204:207], a[12:15], a[196:199], v[204:207]
 ds_read_b128 a[180:183], v2 offset:6528
 v_fma_f32 v21, v21, v29, -v29
 v_mfma_f32_16x16x32_bf16 v[204:207], a[28:31], a[192:195], v[204:207]
 ds_read_b128 a[184:187], v2 offset:10880
 v_cvt_pk_bf16_f32 v16, v20, v21
 v_mfma_f32_16x16x32_bf16 v[204:207], a[44:47], a[172:175], v[204:207]
 ds_read_b128 a[204:207], v2 offset:15232
 v_mul_f32 v33, s42, v117
 v_mfma_f32_16x16x32_bf16 v[204:207], a[60:63], a[168:171], v[204:207]
 ds_read_b128 a[200:203], v2 offset:19584
 v_mul_f32 v34, s42, v118
 v_mfma_f32_16x16x32_bf16 v[204:207], a[76:79], a[164:167], v[204:207]
 v_rcp_f32 v30, v30
 v_mfma_f32_16x16x32_bf16 v[200:203], a[72:75], a[164:167], v[200:203]
 v_rcp_f32 v31, v31
 v_mfma_f32_16x16x32_bf16 v[200:203], a[56:59], a[168:171], v[200:203]
 v_fma_f32 v22, v22, v30, -v30
 v_fma_f32 v23, v23, v31, -v31
 v_mfma_f32_16x16x32_bf16 v[200:203], a[40:43], a[172:175], v[200:203]
 v_cvt_pk_bf16_f32 v17, v22, v23
 v_mul_f32 v35, s42, v119
 v_mfma_f32_16x16x32_bf16 v[200:203], a[24:27], a[192:195], v[200:203]
 v_min_f32 v32, s47, v32
 v_min_f32 v33, s47, v33
 v_mfma_f32_16x16x32_bf16 v[200:203], a[8:11], a[196:199], v[200:203]
 v_min_f32 v34, s47, v34
 v_min_f32 v35, s47, v35
 v_mfma_f32_16x16x32_bf16 v[196:199], a[4:7], a[196:199], v[196:199]
 v_exp_f32 v32, v32
 v_mfma_f32_16x16x32_bf16 v[196:199], a[20:23], a[192:195], v[196:199]
 v_mul_f32 v40, s43, v124
 v_mul_f32 v41, s43, v125
 v_mfma_f32_16x16x32_bf16 v[196:199], a[36:39], a[172:175], v[196:199]
 v_exp_f32 v33, v33
 v_mfma_f32_16x16x32_bf16 v[196:199], a[52:55], a[168:171], v[196:199]
 v_mul_f32 v42, s43, v126
 v_mul_f32 v43, s43, v127
 v_mfma_f32_16x16x32_bf16 v[196:199], a[68:71], a[164:167], v[196:199]
 v_exp_f32 v34, v34
 v_mfma_f32_16x16x32_bf16 v[192:195], a[64:67], a[164:167], v[192:195]
 v_exp_f32 v35, v35
 v_mfma_f32_16x16x32_bf16 v[192:195], a[48:51], a[168:171], v[192:195]
 v_exp_f32 v40, v40
 v_mfma_f32_16x16x32_bf16 v[192:195], a[32:35], a[172:175], v[192:195]
 v_add_f32 v28, 1.0, v32
 v_add_f32 v29, 1.0, v33
 v_mfma_f32_16x16x32_bf16 v[192:195], a[16:19], a[192:195], v[192:195]
 v_exp_f32 v41, v41
 v_mfma_f32_16x16x32_bf16 v[192:195], a[0:3], a[196:199], v[192:195]
 v_add_f32 v30, 1.0, v34
 v_add_f32 v31, 1.0, v35
 v_mfma_f32_16x16x32_bf16 v[208:211], a[0:3], a[192:195], v[208:211]
 v_exp_f32 v42, v42
 v_mfma_f32_16x16x32_bf16 v[208:211], a[16:19], a[172:175], v[208:211]
 v_exp_f32 v43, v43
 v_mfma_f32_16x16x32_bf16 v[208:211], a[32:35], a[168:171], v[208:211]
 v_fmac_f32 v28, v28, v40
 v_fmac_f32 v29, v29, v41
 v_mfma_f32_16x16x32_bf16 v[208:211], a[48:51], a[164:167], v[208:211]
 ds_read_b128 a[196:199], v2 offset:23936
 v_fmac_f32 v30, v30, v42
 v_mfma_f32_16x16x32_bf16 v[208:211], a[64:67], a[160:163], v[208:211]
 v_fmac_f32 v31, v31, v43
 v_mul_f32 v20, s42, v128
 v_mfma_f32_16x16x32_bf16 v[212:215], a[68:71], a[160:163], v[212:215]
 v_rcp_f32 v28, v28
 v_mfma_f32_16x16x32_bf16 v[212:215], a[52:55], a[164:167], v[212:215]
 v_rcp_f32 v29, v29
 v_mfma_f32_16x16x32_bf16 v[212:215], a[36:39], a[168:171], v[212:215]
 v_rcp_f32 v30, v30
 v_mfma_f32_16x16x32_bf16 v[212:215], a[20:23], a[172:175], v[212:215]
 v_rcp_f32 v31, v31
 v_mfma_f32_16x16x32_bf16 v[212:215], a[4:7], a[192:195], v[212:215]
 v_fma_f32 v32, v32, v28, -v28
 v_fma_f32 v33, v33, v29, -v29
 v_mfma_f32_16x16x32_bf16 v[216:219], a[8:11], a[192:195], v[216:219]
 v_fma_f32 v34, v34, v30, -v30
 v_fma_f32 v35, v35, v31, -v31
 v_mfma_f32_16x16x32_bf16 v[216:219], a[24:27], a[172:175], v[216:219]
 v_cvt_pk_bf16_f32 v18, v32, v33
 v_cvt_pk_bf16_f32 v19, v34, v35
 v_mfma_f32_16x16x32_bf16 v[216:219], a[40:43], a[168:171], v[216:219]
 s_add_u32 s46, s40, 8192
 buffer_store_dwordx4 v[16:19], v6, s[12:15], s46 offen
 v_mul_f32 v21, s42, v129
 v_mfma_f32_16x16x32_bf16 v[216:219], a[56:59], a[164:167], v[216:219]
 v_mul_f32 v22, s42, v130
 v_mul_f32 v23, s42, v131
 v_mfma_f32_16x16x32_bf16 v[216:219], a[72:75], a[160:163], v[216:219]
 v_min_f32 v20, s47, v20
 v_min_f32 v21, s47, v21
 v_mfma_f32_16x16x32_bf16 v[220:223], a[76:79], a[160:163], v[220:223]
 v_min_f32 v22, s47, v22
 v_min_f32 v23, s47, v23
 v_mfma_f32_16x16x32_bf16 v[220:223], a[60:63], a[164:167], v[220:223]
 v_exp_f32 v20, v20
 v_mfma_f32_16x16x32_bf16 v[220:223], a[44:47], a[168:171], v[220:223]
 v_mul_f32 v24, s43, v136
 v_mul_f32 v25, s43, v137
 v_mfma_f32_16x16x32_bf16 v[220:223], a[28:31], a[172:175], v[220:223]
 v_exp_f32 v21, v21
 v_mfma_f32_16x16x32_bf16 v[220:223], a[12:15], a[192:195], v[220:223]
 v_mul_f32 v26, s43, v138
 v_mul_f32 v27, s43, v139
 v_mfma_f32_16x16x32_bf16 v[236:239], a[12:15], a[172:175], v[236:239]
 v_exp_f32 v22, v22
 v_mfma_f32_16x16x32_bf16 v[236:239], a[28:31], a[168:171], v[236:239]
 v_exp_f32 v23, v23
 v_mfma_f32_16x16x32_bf16 v[236:239], a[44:47], a[164:167], v[236:239]
 v_exp_f32 v24, v24
 v_mfma_f32_16x16x32_bf16 v[236:239], a[60:63], a[160:163], v[236:239]
 s_waitcnt lgkmcnt(0)
 ds_read_b128 a[192:195], v2 offset:28288
 v_add_f32 v28, 1.0, v20
 v_mfma_f32_16x16x32_bf16 v[236:239], a[76:79], a[188:191], v[236:239]
 v_add_f32 v29, 1.0, v21
 v_add_f32 v30, 1.0, v22
 v_mfma_f32_16x16x32_bf16 v[232:235], a[72:75], a[188:191], v[232:235]
 v_exp_f32 v25, v25
 v_mfma_f32_16x16x32_bf16 v[232:235], a[56:59], a[160:163], v[232:235]
 v_add_f32 v31, 1.0, v23
 v_fmac_f32 v28, v28, v24
 v_mfma_f32_16x16x32_bf16 v[232:235], a[40:43], a[164:167], v[232:235]
 v_exp_f32 v26, v26
 v_mfma_f32_16x16x32_bf16 v[232:235], a[24:27], a[168:171], v[232:235]
 v_exp_f32 v27, v27
 v_mfma_f32_16x16x32_bf16 v[232:235], a[8:11], a[172:175], v[232:235]
 v_fmac_f32 v29, v29, v25
 v_fmac_f32 v30, v30, v26
 v_mfma_f32_16x16x32_bf16 v[228:231], a[4:7], a[172:175], v[228:231]
 v_fmac_f32 v31, v31, v27
 v_mul_f32 v32, s42, v132
 v_mfma_f32_16x16x32_bf16 v[228:231], a[20:23], a[168:171], v[228:231]
 v_rcp_f32 v28, v28
 v_mfma_f32_16x16x32_bf16 v[228:231], a[36:39], a[164:167], v[228:231]
 v_rcp_f32 v29, v29
 v_mfma_f32_16x16x32_bf16 v[228:231], a[52:55], a[160:163], v[228:231]
 v_rcp_f32 v30, v30
 v_mfma_f32_16x16x32_bf16 v[228:231], a[68:71], a[188:191], v[228:231]
 v_rcp_f32 v31, v31
 v_mfma_f32_16x16x32_bf16 v[224:227], a[64:67], a[188:191], v[224:227]
 v_fma_f32 v20, v20, v28, -v28
 v_fma_f32 v21, v21, v29, -v29
 v_mfma_f32_16x16x32_bf16 v[224:227], a[48:51], a[160:163], v[224:227]
 v_fma_f32 v22, v22, v30, -v30
 v_fma_f32 v23, v23, v31, -v31
 v_mfma_f32_16x16x32_bf16 v[224:227], a[32:35], a[164:167], v[224:227]
 v_cvt_pk_bf16_f32 v16, v20, v21
 v_cvt_pk_bf16_f32 v17, v22, v23
 v_mfma_f32_16x16x32_bf16 v[224:227], a[16:19], a[168:171], v[224:227]
 v_mul_f32 v33, s42, v133
 v_mul_f32 v34, s42, v134
 v_mfma_f32_16x16x32_bf16 v[224:227], a[0:3], a[172:175], v[224:227]
 v_mul_f32 v35, s42, v135
 v_min_f32 v32, s47, v32
 v_mfma_f32_16x16x32_bf16 v[176:179], a[80:83], a[176:179], v[176:179]
 v_min_f32 v33, s47, v33
 v_min_f32 v34, s47, v34
 v_mfma_f32_16x16x32_bf16 v[176:179], a[96:99], a[180:183], v[176:179]
 v_min_f32 v35, s47, v35
 v_mul_f32 v40, s43, v140
 v_mfma_f32_16x16x32_bf16 v[176:179], a[112:115], a[184:187], v[176:179]
 v_exp_f32 v32, v32
 v_mfma_f32_16x16x32_bf16 v[176:179], a[128:131], a[204:207], v[176:179]
 ds_read_b128 a[188:191], v2 offset:32640
 v_mul_f32 v41, s43, v141
 v_mfma_f32_16x16x32_bf16 v[176:179], a[144:147], a[200:203], v[176:179]
 v_exp_f32 v33, v33
 v_mfma_f32_16x16x32_bf16 v[180:183], a[148:151], a[200:203], v[180:183]
 v_mul_f32 v42, s43, v142
 v_mul_f32 v43, s43, v143
 v_mfma_f32_16x16x32_bf16 v[180:183], a[132:135], a[204:207], v[180:183]
 v_exp_f32 v34, v34
 v_mfma_f32_16x16x32_bf16 v[180:183], a[116:119], a[184:187], v[180:183]
 v_exp_f32 v35, v35
 v_mfma_f32_16x16x32_bf16 v[180:183], a[100:103], a[180:183], v[180:183]
 v_exp_f32 v40, v40
 v_mfma_f32_16x16x32_bf16 v[180:183], a[84:87], a[176:179], v[180:183]
 v_add_f32 v28, 1.0, v32
 v_add_f32 v29, 1.0, v33
 v_mfma_f32_16x16x32_bf16 v[184:187], a[88:91], a[176:179], v[184:187]
 v_exp_f32 v41, v41
 v_mfma_f32_16x16x32_bf16 v[184:187], a[104:107], a[180:183], v[184:187]
 v_add_f32 v30, 1.0, v34
 v_add_f32 v31, 1.0, v35
 v_mfma_f32_16x16x32_bf16 v[184:187], a[120:123], a[184:187], v[184:187]
 v_exp_f32 v42, v42
 v_mfma_f32_16x16x32_bf16 v[184:187], a[136:139], a[204:207], v[184:187]
 v_exp_f32 v43, v43
 v_mfma_f32_16x16x32_bf16 v[184:187], a[152:155], a[200:203], v[184:187]
 v_fmac_f32 v28, v28, v40
 v_fmac_f32 v29, v29, v41
 v_mfma_f32_16x16x32_bf16 v[188:191], a[156:159], a[200:203], v[188:191]
 v_fmac_f32 v30, v30, v42
 v_fmac_f32 v31, v31, v43
 v_mfma_f32_16x16x32_bf16 v[188:191], a[140:143], a[204:207], v[188:191]
 v_rcp_f32 v28, v28
 v_mfma_f32_16x16x32_bf16 v[188:191], a[124:127], a[184:187], v[188:191]
 v_rcp_f32 v29, v29
 v_mfma_f32_16x16x32_bf16 v[188:191], a[108:111], a[180:183], v[188:191]
 v_rcp_f32 v30, v30
 v_mfma_f32_16x16x32_bf16 v[188:191], a[92:95], a[176:179], v[188:191]
 ds_read_b128 a[160:163], v1 offset:19584
 v_fma_f32 v32, v32, v28, -v28
 v_mfma_f32_16x16x32_bf16 v[204:207], a[92:95], a[180:183], v[204:207]
 ds_read_b128 a[164:167], v1 offset:23936
 v_fma_f32 v33, v33, v29, -v29
 v_mfma_f32_16x16x32_bf16 v[204:207], a[108:111], a[184:187], v[204:207]
 ds_read_b128 a[168:171], v1 offset:28288
 v_fma_f32 v34, v34, v30, -v30
 v_mfma_f32_16x16x32_bf16 v[204:207], a[124:127], a[204:207], v[204:207]
 ds_read_b128 a[172:175], v1 offset:32640
 v_cvt_pk_bf16_f32 v18, v32, v33
 v_mfma_f32_16x16x32_bf16 v[204:207], a[140:143], a[200:203], v[204:207]
 ds_read_b128 a[176:179], v3 offset:2176
 v_mul_f32 v20, s42, v144
 v_mfma_f32_16x16x32_bf16 v[204:207], a[156:159], a[196:199], v[204:207]
 v_rcp_f32 v31, v31
 v_mfma_f32_16x16x32_bf16 v[200:203], a[152:155], a[196:199], v[200:203]
 v_fma_f32 v35, v35, v31, -v31
 v_cvt_pk_bf16_f32 v19, v34, v35
 v_mfma_f32_16x16x32_bf16 v[200:203], a[136:139], a[200:203], v[200:203]
 s_add_u32 s46, s40, 10240
 buffer_store_dwordx4 v[16:19], v6, s[12:15], s46 offen
 v_mul_f32 v21, s42, v145
 v_mfma_f32_16x16x32_bf16 v[200:203], a[120:123], a[204:207], v[200:203]
 v_mul_f32 v22, s42, v146
 v_mul_f32 v23, s42, v147
 v_mfma_f32_16x16x32_bf16 v[200:203], a[104:107], a[184:187], v[200:203]
 v_min_f32 v20, s47, v20
 v_min_f32 v21, s47, v21
 v_mfma_f32_16x16x32_bf16 v[200:203], a[88:91], a[180:183], v[200:203]
 v_min_f32 v22, s47, v22
 v_min_f32 v23, s47, v23
 v_mfma_f32_16x16x32_bf16 v[196:199], a[84:87], a[180:183], v[196:199]
 v_exp_f32 v20, v20
 v_mfma_f32_16x16x32_bf16 v[196:199], a[100:103], a[184:187], v[196:199]
 v_mul_f32 v24, s43, v152
 v_mul_f32 v25, s43, v153
 v_mfma_f32_16x16x32_bf16 v[196:199], a[116:119], a[204:207], v[196:199]
 v_exp_f32 v21, v21
 v_mfma_f32_16x16x32_bf16 v[196:199], a[132:135], a[200:203], v[196:199]
 v_mul_f32 v26, s43, v154
 v_mul_f32 v27, s43, v155
 v_mfma_f32_16x16x32_bf16 v[196:199], a[148:151], a[196:199], v[196:199]
 v_exp_f32 v22, v22
 v_mfma_f32_16x16x32_bf16 v[192:195], a[144:147], a[196:199], v[192:195]
 v_exp_f32 v23, v23
 v_mfma_f32_16x16x32_bf16 v[192:195], a[128:131], a[200:203], v[192:195]
 v_exp_f32 v24, v24
 v_mfma_f32_16x16x32_bf16 v[192:195], a[112:115], a[204:207], v[192:195]
 v_add_f32 v28, 1.0, v20
 v_add_f32 v29, 1.0, v21
 v_mfma_f32_16x16x32_bf16 v[192:195], a[96:99], a[184:187], v[192:195]
 v_exp_f32 v25, v25
 v_mfma_f32_16x16x32_bf16 v[192:195], a[80:83], a[180:183], v[192:195]
 v_add_f32 v30, 1.0, v22
 v_add_f32 v31, 1.0, v23
 v_mfma_f32_16x16x32_bf16 v[208:211], a[80:83], a[184:187], v[208:211]
 v_exp_f32 v26, v26
 v_mfma_f32_16x16x32_bf16 v[208:211], a[96:99], a[204:207], v[208:211]
 v_exp_f32 v27, v27
 v_mfma_f32_16x16x32_bf16 v[208:211], a[112:115], a[200:203], v[208:211]
 v_fmac_f32 v28, v28, v24
 v_fmac_f32 v29, v29, v25
 v_mfma_f32_16x16x32_bf16 v[208:211], a[128:131], a[196:199], v[208:211]
 s_waitcnt lgkmcnt(0)
 ds_read_b128 a[180:183], v3 offset:6528
 v_fmac_f32 v30, v30, v26
 v_mfma_f32_16x16x32_bf16 v[208:211], a[144:147], a[192:195], v[208:211]
 v_fmac_f32 v31, v31, v27
 v_mul_f32 v32, s42, v148
 v_mfma_f32_16x16x32_bf16 v[212:215], a[148:151], a[192:195], v[212:215]
 v_rcp_f32 v28, v28
 v_mfma_f32_16x16x32_bf16 v[212:215], a[132:135], a[196:199], v[212:215]
 v_rcp_f32 v29, v29
 v_mfma_f32_16x16x32_bf16 v[212:215], a[116:119], a[200:203], v[212:215]
 v_rcp_f32 v30, v30
 v_mfma_f32_16x16x32_bf16 v[212:215], a[100:103], a[204:207], v[212:215]
 v_rcp_f32 v31, v31
 v_mfma_f32_16x16x32_bf16 v[212:215], a[84:87], a[184:187], v[212:215]
 v_fma_f32 v20, v20, v28, -v28
 v_fma_f32 v21, v21, v29, -v29
 v_mfma_f32_16x16x32_bf16 v[216:219], a[88:91], a[184:187], v[216:219]
 v_fma_f32 v22, v22, v30, -v30
 v_fma_f32 v23, v23, v31, -v31
 v_mfma_f32_16x16x32_bf16 v[216:219], a[104:107], a[204:207], v[216:219]
 v_cvt_pk_bf16_f32 v16, v20, v21
 v_cvt_pk_bf16_f32 v17, v22, v23
 v_mfma_f32_16x16x32_bf16 v[216:219], a[120:123], a[200:203], v[216:219]
 v_mul_f32 v33, s42, v149
 v_mul_f32 v34, s42, v150
 v_mfma_f32_16x16x32_bf16 v[216:219], a[136:139], a[196:199], v[216:219]
 v_mul_f32 v35, s42, v151
 v_min_f32 v32, s47, v32
 v_mfma_f32_16x16x32_bf16 v[216:219], a[152:155], a[192:195], v[216:219]
 v_min_f32 v33, s47, v33
 v_min_f32 v34, s47, v34
 v_mfma_f32_16x16x32_bf16 v[220:223], a[156:159], a[192:195], v[220:223]
 v_min_f32 v35, s47, v35
 v_mul_f32 v40, s43, v156
 v_mfma_f32_16x16x32_bf16 v[220:223], a[140:143], a[196:199], v[220:223]
 v_exp_f32 v32, v32
 v_mfma_f32_16x16x32_bf16 v[220:223], a[124:127], a[200:203], v[220:223]
 v_mul_f32 v41, s43, v157
 v_mul_f32 v42, s43, v158
 v_mfma_f32_16x16x32_bf16 v[220:223], a[108:111], a[204:207], v[220:223]
 v_exp_f32 v33, v33
 v_mfma_f32_16x16x32_bf16 v[220:223], a[92:95], a[184:187], v[220:223]
 v_mul_f32 v43, s43, v159
 v_add_f32 v28, 1.0, v32
 v_mfma_f32_16x16x32_bf16 v[236:239], a[92:95], a[204:207], v[236:239]
 v_exp_f32 v34, v34
 v_mfma_f32_16x16x32_bf16 v[236:239], a[108:111], a[200:203], v[236:239]
 v_exp_f32 v35, v35
 v_mfma_f32_16x16x32_bf16 v[236:239], a[124:127], a[196:199], v[236:239]
 v_exp_f32 v40, v40
 v_mfma_f32_16x16x32_bf16 v[236:239], a[140:143], a[192:195], v[236:239]
 ds_read_b128 a[184:187], v3 offset:10880
 v_add_f32 v29, 1.0, v33
 v_mfma_f32_16x16x32_bf16 v[236:239], a[156:159], a[188:191], v[236:239]
 v_exp_f32 v41, v41
 v_mfma_f32_16x16x32_bf16 v[232:235], a[152:155], a[188:191], v[232:235]
 v_add_f32 v30, 1.0, v34
 v_add_f32 v31, 1.0, v35
 v_mfma_f32_16x16x32_bf16 v[232:235], a[136:139], a[192:195], v[232:235]
 v_exp_f32 v42, v42
 v_mfma_f32_16x16x32_bf16 v[232:235], a[120:123], a[196:199], v[232:235]
 v_exp_f32 v43, v43
 v_mfma_f32_16x16x32_bf16 v[232:235], a[104:107], a[200:203], v[232:235]
 v_fmac_f32 v28, v28, v40
 v_fmac_f32 v29, v29, v41
 v_mfma_f32_16x16x32_bf16 v[232:235], a[88:91], a[204:207], v[232:235]
 v_fmac_f32 v30, v30, v42
 v_fmac_f32 v31, v31, v43
 v_mfma_f32_16x16x32_bf16 v[228:231], a[84:87], a[204:207], v[228:231]
 v_rcp_f32 v28, v28
 v_mfma_f32_16x16x32_bf16 v[228:231], a[100:103], a[200:203], v[228:231]
 v_rcp_f32 v29, v29
 v_mfma_f32_16x16x32_bf16 v[228:231], a[116:119], a[196:199], v[228:231]
 v_rcp_f32 v30, v30
 v_mfma_f32_16x16x32_bf16 v[228:231], a[132:135], a[192:195], v[228:231]
 v_rcp_f32 v31, v31
 v_mfma_f32_16x16x32_bf16 v[228:231], a[148:151], a[188:191], v[228:231]
 v_fma_f32 v32, v32, v28, -v28
 v_fma_f32 v33, v33, v29, -v29
 v_mfma_f32_16x16x32_bf16 v[224:227], a[144:147], a[188:191], v[224:227]
 v_fma_f32 v34, v34, v30, -v30
 v_fma_f32 v35, v35, v31, -v31
 v_mfma_f32_16x16x32_bf16 v[224:227], a[128:131], a[192:195], v[224:227]
 v_cvt_pk_bf16_f32 v18, v32, v33
 v_cvt_pk_bf16_f32 v19, v34, v35
 v_mfma_f32_16x16x32_bf16 v[224:227], a[112:115], a[196:199], v[224:227]
 s_add_u32 s46, s40, 12288
 buffer_store_dwordx4 v[16:19], v6, s[12:15], s46 offen
 v_mul_f32 v20, s42, v160
 v_mfma_f32_16x16x32_bf16 v[224:227], a[96:99], a[200:203], v[224:227]
 v_mul_f32 v21, s42, v161
 v_mul_f32 v22, s42, v162
 v_mfma_f32_16x16x32_bf16 v[224:227], a[80:83], a[204:207], v[224:227]
 v_mul_f32 v23, s42, v163
 v_min_f32 v20, s47, v20
 v_mfma_f32_16x16x32_bf16 v[240:243], a[0:3], a[160:163], v[240:243]
 v_min_f32 v21, s47, v21
 v_min_f32 v22, s47, v22
 v_mfma_f32_16x16x32_bf16 v[240:243], a[16:19], a[164:167], v[240:243]
 v_min_f32 v23, s47, v23
 v_mul_f32 v24, s43, v168
 v_mfma_f32_16x16x32_bf16 v[240:243], a[32:35], a[168:171], v[240:243]
 v_exp_f32 v20, v20
 v_mfma_f32_16x16x32_bf16 v[240:243], a[48:51], a[172:175], v[240:243]
 ds_read_b128 a[188:191], v3 offset:15232
 v_mul_f32 v25, s43, v169
 v_mfma_f32_16x16x32_bf16 v[240:243], a[64:67], a[176:179], v[240:243]
 v_exp_f32 v21, v21
 v_mfma_f32_16x16x32_bf16 v[244:247], a[68:71], a[176:179], v[244:247]
 v_mul_f32 v26, s43, v170
 v_mul_f32 v27, s43, v171
 v_mfma_f32_16x16x32_bf16 v[244:247], a[52:55], a[172:175], v[244:247]
 v_exp_f32 v22, v22
 v_mfma_f32_16x16x32_bf16 v[244:247], a[36:39], a[168:171], v[244:247]
 v_exp_f32 v23, v23
 v_mfma_f32_16x16x32_bf16 v[244:247], a[20:23], a[164:167], v[244:247]
 v_exp_f32 v24, v24
 v_mfma_f32_16x16x32_bf16 v[244:247], a[4:7], a[160:163], v[244:247]
 v_add_f32 v28, 1.0, v20
 v_add_f32 v29, 1.0, v21
 v_mfma_f32_16x16x32_bf16 v[248:251], a[8:11], a[160:163], v[248:251]
 v_exp_f32 v25, v25
 v_mfma_f32_16x16x32_bf16 v[248:251], a[24:27], a[164:167], v[248:251]
 v_add_f32 v30, 1.0, v22
 v_add_f32 v31, 1.0, v23
 v_mfma_f32_16x16x32_bf16 v[248:251], a[40:43], a[168:171], v[248:251]
 v_exp_f32 v26, v26
 v_mfma_f32_16x16x32_bf16 v[248:251], a[56:59], a[172:175], v[248:251]
 v_exp_f32 v27, v27
 v_mfma_f32_16x16x32_bf16 v[248:251], a[72:75], a[176:179], v[248:251]
 v_fmac_f32 v28, v28, v24
 v_fmac_f32 v29, v29, v25
 v_mfma_f32_16x16x32_bf16 v[252:255], a[76:79], a[176:179], v[252:255]
 v_fmac_f32 v30, v30, v26
 v_fmac_f32 v31, v31, v27
 v_mfma_f32_16x16x32_bf16 v[252:255], a[60:63], a[172:175], v[252:255]
 v_rcp_f32 v28, v28
 v_mfma_f32_16x16x32_bf16 v[252:255], a[44:47], a[168:171], v[252:255]
 v_rcp_f32 v29, v29
 v_mfma_f32_16x16x32_bf16 v[252:255], a[28:31], a[164:167], v[252:255]
 v_rcp_f32 v30, v30
 v_mfma_f32_16x16x32_bf16 v[252:255], a[12:15], a[160:163], v[252:255]
 ds_read_b128 a[192:195], v2 offset:19584
 v_fma_f32 v20, v20, v28, -v28
 v_mfma_f32_16x16x32_bf16 a[220:223], a[12:15], a[164:167], a[220:223]
 ds_read_b128 a[196:199], v2 offset:23936
 v_fma_f32 v21, v21, v29, -v29
 v_mfma_f32_16x16x32_bf16 a[220:223], a[28:31], a[168:171], a[220:223]
 ds_read_b128 a[200:203], v2 offset:28288
 v_fma_f32 v22, v22, v30, -v30
 v_mfma_f32_16x16x32_bf16 a[220:223], a[44:47], a[172:175], a[220:223]
 ds_read_b128 a[204:207], v2 offset:32640
 v_cvt_pk_bf16_f32 v16, v20, v21
 v_mfma_f32_16x16x32_bf16 a[220:223], a[60:63], a[176:179], a[220:223]
 s_waitcnt lgkmcnt(4)
 ds_read_b128 a[160:163], v4 offset:2176
 v_mul_f32 v32, s42, v164
 v_mfma_f32_16x16x32_bf16 a[220:223], a[76:79], a[180:183], a[220:223]
 v_rcp_f32 v31, v31
 v_mfma_f32_16x16x32_bf16 a[216:219], a[72:75], a[180:183], a[216:219]
 v_fma_f32 v23, v23, v31, -v31
 v_cvt_pk_bf16_f32 v17, v22, v23
 v_mfma_f32_16x16x32_bf16 a[216:219], a[56:59], a[176:179], a[216:219]
 v_mul_f32 v33, s42, v165
 v_mul_f32 v34, s42, v166
 v_mfma_f32_16x16x32_bf16 a[216:219], a[40:43], a[172:175], a[216:219]
 v_mul_f32 v35, s42, v167
 v_min_f32 v32, s47, v32
 v_mfma_f32_16x16x32_bf16 a[216:219], a[24:27], a[168:171], a[216:219]
 v_min_f32 v33, s47, v33
 v_min_f32 v34, s47, v34
 v_mfma_f32_16x16x32_bf16 a[216:219], a[8:11], a[164:167], a[216:219]
 v_min_f32 v35, s47, v35
 v_mul_f32 v40, s43, v172
 v_mfma_f32_16x16x32_bf16 a[212:215], a[4:7], a[164:167], a[212:215]
 v_exp_f32 v32, v32
 v_mfma_f32_16x16x32_bf16 a[212:215], a[20:23], a[168:171], a[212:215]
 v_mul_f32 v41, s43, v173
 v_mul_f32 v42, s43, v174
 v_mfma_f32_16x16x32_bf16 a[212:215], a[36:39], a[172:175], a[212:215]
 v_exp_f32 v33, v33
 v_mfma_f32_16x16x32_bf16 a[212:215], a[52:55], a[176:179], a[212:215]
 v_mul_f32 v43, s43, v175
 v_add_f32 v28, 1.0, v32
 v_mfma_f32_16x16x32_bf16 a[212:215], a[68:71], a[180:183], a[212:215]
 v_exp_f32 v34, v34
 v_mfma_f32_16x16x32_bf16 a[208:211], a[64:67], a[180:183], a[208:211]
 v_exp_f32 v35, v35
 v_mfma_f32_16x16x32_bf16 a[208:211], a[48:51], a[176:179], a[208:211]
 v_exp_f32 v40, v40
 v_mfma_f32_16x16x32_bf16 a[208:211], a[32:35], a[172:175], a[208:211]
 v_add_f32 v29, 1.0, v33
 v_add_f32 v30, 1.0, v34
 v_mfma_f32_16x16x32_bf16 a[208:211], a[16:19], a[168:171], a[208:211]
 v_exp_f32 v41, v41
 v_mfma_f32_16x16x32_bf16 a[208:211], a[0:3], a[164:167], a[208:211]
 v_add_f32 v31, 1.0, v35
 v_fmac_f32 v28, v28, v40
 v_mfma_f32_16x16x32_bf16 a[224:227], a[0:3], a[168:171], a[224:227]
 v_exp_f32 v42, v42
 v_mfma_f32_16x16x32_bf16 a[224:227], a[16:19], a[172:175], a[224:227]
 v_exp_f32 v43, v43
 v_mfma_f32_16x16x32_bf16 a[224:227], a[32:35], a[176:179], a[224:227]
 v_fmac_f32 v29, v29, v41
 v_fmac_f32 v30, v30, v42
 v_mfma_f32_16x16x32_bf16 a[224:227], a[48:51], a[180:183], a[224:227]
 ds_read_b128 a[164:167], v4 offset:6528
 v_fmac_f32 v31, v31, v43
 v_mfma_f32_16x16x32_bf16 a[224:227], a[64:67], a[184:187], a[224:227]
 v_rcp_f32 v28, v28
 v_mfma_f32_16x16x32_bf16 a[228:231], a[68:71], a[184:187], a[228:231]
 v_rcp_f32 v29, v29
 v_mfma_f32_16x16x32_bf16 a[228:231], a[52:55], a[180:183], a[228:231]
 v_rcp_f32 v30, v30
 v_mfma_f32_16x16x32_bf16 a[228:231], a[36:39], a[176:179], a[228:231]
 v_rcp_f32 v31, v31
 v_mfma_f32_16x16x32_bf16 a[228:231], a[20:23], a[172:175], a[228:231]
 v_fma_f32 v32, v32, v28, -v28
 v_fma_f32 v33, v33, v29, -v29
 v_mfma_f32_16x16x32_bf16 a[228:231], a[4:7], a[168:171], a[228:231]
 v_fma_f32 v34, v34, v30, -v30
 v_fma_f32 v35, v35, v31, -v31
 v_mfma_f32_16x16x32_bf16 a[232:235], a[8:11], a[168:171], a[232:235]
 v_cvt_pk_bf16_f32 v18, v32, v33
 v_cvt_pk_bf16_f32 v19, v34, v35
 v_mfma_f32_16x16x32_bf16 a[232:235], a[24:27], a[172:175], a[232:235]
 s_add_u32 s46, s40, 14336
 buffer_store_dwordx4 v[16:19], v6, s[12:15], s46 offen
 v_mul_f32 v20, s42, v176
 v_mfma_f32_16x16x32_bf16 a[232:235], a[40:43], a[176:179], a[232:235]
 v_mul_f32 v21, s42, v177
 v_mul_f32 v22, s42, v178
 v_mfma_f32_16x16x32_bf16 a[232:235], a[56:59], a[180:183], a[232:235]
 v_mul_f32 v23, s42, v179
 v_min_f32 v20, s47, v20
 v_mfma_f32_16x16x32_bf16 a[232:235], a[72:75], a[184:187], a[232:235]
 v_min_f32 v21, s47, v21
 v_min_f32 v22, s47, v22
 v_mfma_f32_16x16x32_bf16 a[236:239], a[76:79], a[184:187], a[236:239]
 v_min_f32 v23, s47, v23
 v_mul_f32 v24, s43, v184
 v_mfma_f32_16x16x32_bf16 a[236:239], a[60:63], a[180:183], a[236:239]
 v_exp_f32 v20, v20
 v_mfma_f32_16x16x32_bf16 a[236:239], a[44:47], a[176:179], a[236:239]
 v_mul_f32 v25, s43, v185
 v_mul_f32 v26, s43, v186
 v_mfma_f32_16x16x32_bf16 a[236:239], a[28:31], a[172:175], a[236:239]
 v_exp_f32 v21, v21
 v_mfma_f32_16x16x32_bf16 a[236:239], a[12:15], a[168:171], a[236:239]
 v_mul_f32 v27, s43, v187
 v_add_f32 v28, 1.0, v20
 v_mfma_f32_16x16x32_bf16 a[252:255], a[12:15], a[172:175], a[252:255]
 v_exp_f32 v22, v22
 v_mfma_f32_16x16x32_bf16 a[252:255], a[28:31], a[176:179], a[252:255]
 v_exp_f32 v23, v23
 v_mfma_f32_16x16x32_bf16 a[252:255], a[44:47], a[180:183], a[252:255]
 v_exp_f32 v24, v24
 v_mfma_f32_16x16x32_bf16 a[252:255], a[60:63], a[184:187], a[252:255]
 ds_read_b128 a[168:171], v4 offset:10880
 v_add_f32 v29, 1.0, v21
 v_mfma_f32_16x16x32_bf16 a[252:255], a[76:79], a[188:191], a[252:255]
 v_exp_f32 v25, v25
 v_mfma_f32_16x16x32_bf16 a[248:251], a[72:75], a[188:191], a[248:251]
 v_add_f32 v30, 1.0, v22
 v_add_f32 v31, 1.0, v23
 v_mfma_f32_16x16x32_bf16 a[248:251], a[56:59], a[184:187], a[248:251]
 v_exp_f32 v26, v26
 v_mfma_f32_16x16x32_bf16 a[248:251], a[40:43], a[180:183], a[248:251]
 v_exp_f32 v27, v27
 v_mfma_f32_16x16x32_bf16 a[248:251], a[24:27], a[176:179], a[248:251]
 v_fmac_f32 v28, v28, v24
 v_fmac_f32 v29, v29, v25
 v_mfma_f32_16x16x32_bf16 a[248:251], a[8:11], a[172:175], a[248:251]
 v_fmac_f32 v30, v30, v26
 v_fmac_f32 v31, v31, v27
 v_mfma_f32_16x16x32_bf16 a[244:247], a[4:7], a[172:175], a[244:247]
 v_rcp_f32 v28, v28
 v_mfma_f32_16x16x32_bf16 a[244:247], a[20:23], a[176:179], a[244:247]
 v_rcp_f32 v29, v29
 v_mfma_f32_16x16x32_bf16 a[244:247], a[36:39], a[180:183], a[244:247]
 v_rcp_f32 v30, v30
 v_mfma_f32_16x16x32_bf16 a[244:247], a[52:55], a[184:187], a[244:247]
 v_rcp_f32 v31, v31
 v_mfma_f32_16x16x32_bf16 a[244:247], a[68:71], a[188:191], a[244:247]
 v_fma_f32 v20, v20, v28, -v28
 v_fma_f32 v21, v21, v29, -v29
 v_mfma_f32_16x16x32_bf16 a[240:243], a[64:67], a[188:191], a[240:243]
 v_fma_f32 v22, v22, v30, -v30
 v_fma_f32 v23, v23, v31, -v31
 v_mfma_f32_16x16x32_bf16 a[240:243], a[48:51], a[184:187], a[240:243]
 v_cvt_pk_bf16_f32 v16, v20, v21
 v_cvt_pk_bf16_f32 v17, v22, v23
 v_mfma_f32_16x16x32_bf16 a[240:243], a[32:35], a[180:183], a[240:243]
 v_mul_f32 v32, s42, v180
 v_mul_f32 v33, s42, v181
 v_mfma_f32_16x16x32_bf16 a[240:243], a[16:19], a[176:179], a[240:243]
 v_mul_f32 v34, s42, v182
 v_mul_f32 v35, s42, v183
 v_mfma_f32_16x16x32_bf16 a[240:243], a[0:3], a[172:175], a[240:243]
 s_waitcnt lgkmcnt(0)
 v_min_f32 v32, s47, v32
 v_min_f32 v33, s47, v33
 v_mfma_f32_16x16x32_bf16 v[240:243], a[80:83], a[192:195], v[240:243]
 v_min_f32 v34, s47, v34
 v_min_f32 v35, s47, v35
 v_mfma_f32_16x16x32_bf16 v[240:243], a[96:99], a[196:199], v[240:243]
 v_exp_f32 v32, v32
 v_mfma_f32_16x16x32_bf16 v[240:243], a[112:115], a[200:203], v[240:243]
 v_mul_f32 v40, s43, v188
 v_mul_f32 v41, s43, v189
 v_mfma_f32_16x16x32_bf16 v[240:243], a[128:131], a[204:207], v[240:243]
 ds_read_b128 a[188:191], v4 offset:15232
 v_mul_f32 v42, s43, v190
 v_mfma_f32_16x16x32_bf16 v[240:243], a[144:147], a[160:163], v[240:243]
 v_exp_f32 v33, v33
 v_mfma_f32_16x16x32_bf16 v[244:247], a[148:151], a[160:163], v[244:247]
 v_mul_f32 v43, s43, v191
 v_add_f32 v28, 1.0, v32
 v_mfma_f32_16x16x32_bf16 v[244:247], a[132:135], a[204:207], v[244:247]
 v_exp_f32 v34, v34
 v_mfma_f32_16x16x32_bf16 v[244:247], a[116:119], a[200:203], v[244:247]
 v_exp_f32 v35, v35
 v_mfma_f32_16x16x32_bf16 v[244:247], a[100:103], a[196:199], v[244:247]
 v_exp_f32 v40, v40
 v_mfma_f32_16x16x32_bf16 v[244:247], a[84:87], a[192:195], v[244:247]
 v_add_f32 v29, 1.0, v33
 v_add_f32 v30, 1.0, v34
 v_mfma_f32_16x16x32_bf16 v[248:251], a[88:91], a[192:195], v[248:251]
 v_exp_f32 v41, v41
 v_mfma_f32_16x16x32_bf16 v[248:251], a[104:107], a[196:199], v[248:251]
 v_add_f32 v31, 1.0, v35
 v_fmac_f32 v28, v28, v40
 v_mfma_f32_16x16x32_bf16 v[248:251], a[120:123], a[200:203], v[248:251]
 v_exp_f32 v42, v42
 v_mfma_f32_16x16x32_bf16 v[248:251], a[136:139], a[204:207], v[248:251]
 v_exp_f32 v43, v43
 v_mfma_f32_16x16x32_bf16 v[248:251], a[152:155], a[160:163], v[248:251]
 v_fmac_f32 v29, v29, v41
 v_fmac_f32 v30, v30, v42
 v_mfma_f32_16x16x32_bf16 v[252:255], a[156:159], a[160:163], v[252:255]
 v_fmac_f32 v31, v31, v43
 v_mul_f32 v20, s42, v192
 v_mfma_f32_16x16x32_bf16 v[252:255], a[140:143], a[204:207], v[252:255]
 v_rcp_f32 v28, v28
 v_mfma_f32_16x16x32_bf16 v[252:255], a[124:127], a[200:203], v[252:255]
 v_rcp_f32 v29, v29
 v_mfma_f32_16x16x32_bf16 v[252:255], a[108:111], a[196:199], v[252:255]
 v_rcp_f32 v30, v30
 v_mfma_f32_16x16x32_bf16 v[252:255], a[92:95], a[192:195], v[252:255]
 v_rcp_f32 v31, v31
 v_mfma_f32_16x16x32_bf16 a[220:223], a[92:95], a[196:199], a[220:223]
 v_fma_f32 v32, v32, v28, -v28
 v_fma_f32 v33, v33, v29, -v29
 v_mfma_f32_16x16x32_bf16 a[220:223], a[108:111], a[200:203], a[220:223]
 v_fma_f32 v34, v34, v30, -v30
 v_fma_f32 v35, v35, v31, -v31
 v_mfma_f32_16x16x32_bf16 a[220:223], a[124:127], a[204:207], a[220:223]
 v_cvt_pk_bf16_f32 v18, v32, v33
 v_cvt_pk_bf16_f32 v19, v34, v35
 v_mfma_f32_16x16x32_bf16 a[220:223], a[140:143], a[160:163], a[220:223]
 s_add_u32 s46, s40, 1024
 buffer_store_dwordx4 v[16:19], v6, s[12:15], s46 offen
 v_mul_f32 v21, s42, v193
 v_mfma_f32_16x16x32_bf16 a[220:223], a[156:159], a[164:167], a[220:223]
 v_mul_f32 v22, s42, v194
 v_mul_f32 v23, s42, v195
 v_mfma_f32_16x16x32_bf16 a[216:219], a[152:155], a[164:167], a[216:219]
 v_min_f32 v20, s47, v20
 v_min_f32 v21, s47, v21
 v_mfma_f32_16x16x32_bf16 a[216:219], a[136:139], a[160:163], a[216:219]
 v_min_f32 v22, s47, v22
 v_min_f32 v23, s47, v23
 v_mfma_f32_16x16x32_bf16 a[216:219], a[120:123], a[204:207], a[216:219]
 v_exp_f32 v20, v20
 v_mfma_f32_16x16x32_bf16 a[216:219], a[104:107], a[200:203], a[216:219]
 v_mul_f32 v24, s43, v200
 v_mul_f32 v25, s43, v201
 v_mfma_f32_16x16x32_bf16 a[216:219], a[88:91], a[196:199], a[216:219]
 v_exp_f32 v21, v21
 v_mfma_f32_16x16x32_bf16 a[212:215], a[84:87], a[196:199], a[212:215]
 v_mul_f32 v26, s43, v202
 v_mul_f32 v27, s43, v203
 v_mfma_f32_16x16x32_bf16 a[212:215], a[100:103], a[200:203], a[212:215]
 v_exp_f32 v22, v22
 v_mfma_f32_16x16x32_bf16 a[212:215], a[116:119], a[204:207], a[212:215]
 v_exp_f32 v23, v23
 v_mfma_f32_16x16x32_bf16 a[212:215], a[132:135], a[160:163], a[212:215]
 v_exp_f32 v24, v24
 v_mfma_f32_16x16x32_bf16 a[212:215], a[148:151], a[164:167], a[212:215]
 v_add_f32 v28, 1.0, v20
 v_add_f32 v29, 1.0, v21
 v_mfma_f32_16x16x32_bf16 a[208:211], a[144:147], a[164:167], a[208:211]
 v_exp_f32 v25, v25
 v_mfma_f32_16x16x32_bf16 a[208:211], a[128:131], a[160:163], a[208:211]
 v_add_f32 v30, 1.0, v22
 v_add_f32 v31, 1.0, v23
 v_mfma_f32_16x16x32_bf16 a[208:211], a[112:115], a[204:207], a[208:211]
 v_exp_f32 v26, v26
 v_mfma_f32_16x16x32_bf16 a[208:211], a[96:99], a[200:203], a[208:211]
 v_exp_f32 v27, v27
 v_mfma_f32_16x16x32_bf16 a[208:211], a[80:83], a[196:199], a[208:211]
 v_fmac_f32 v28, v28, v24
 v_fmac_f32 v29, v29, v25
 v_mfma_f32_16x16x32_bf16 a[224:227], a[80:83], a[200:203], a[224:227]
 v_fmac_f32 v30, v30, v26
 v_fmac_f32 v31, v31, v27
 v_mfma_f32_16x16x32_bf16 a[224:227], a[96:99], a[204:207], a[224:227]
 v_rcp_f32 v28, v28
 v_mfma_f32_16x16x32_bf16 a[224:227], a[112:115], a[160:163], a[224:227]
 v_rcp_f32 v29, v29
 v_mfma_f32_16x16x32_bf16 a[224:227], a[128:131], a[164:167], a[224:227]
 v_rcp_f32 v30, v30
 v_mfma_f32_16x16x32_bf16 a[224:227], a[144:147], a[168:171], a[224:227]
 v_rcp_f32 v31, v31
 v_mfma_f32_16x16x32_bf16 a[228:231], a[148:151], a[168:171], a[228:231]
 v_fma_f32 v20, v20, v28, -v28
 v_fma_f32 v21, v21, v29, -v29
 v_mfma_f32_16x16x32_bf16 a[228:231], a[132:135], a[164:167], a[228:231]
 v_fma_f32 v22, v22, v30, -v30
 v_fma_f32 v23, v23, v31, -v31
 v_mfma_f32_16x16x32_bf16 a[228:231], a[116:119], a[160:163], a[228:231]
 v_cvt_pk_bf16_f32 v16, v20, v21
 v_cvt_pk_bf16_f32 v17, v22, v23
 v_mfma_f32_16x16x32_bf16 a[228:231], a[100:103], a[204:207], a[228:231]
 v_mul_f32 v32, s42, v196
 v_mul_f32 v33, s42, v197
 v_mfma_f32_16x16x32_bf16 a[228:231], a[84:87], a[200:203], a[228:231]
 v_mul_f32 v34, s42, v198
 v_mul_f32 v35, s42, v199
 v_mfma_f32_16x16x32_bf16 a[232:235], a[88:91], a[200:203], a[232:235]
 v_min_f32 v32, s47, v32
 v_min_f32 v33, s47, v33
 v_mfma_f32_16x16x32_bf16 a[232:235], a[104:107], a[204:207], a[232:235]
 v_min_f32 v34, s47, v34
 v_min_f32 v35, s47, v35
 v_mfma_f32_16x16x32_bf16 a[232:235], a[120:123], a[160:163], a[232:235]
 v_exp_f32 v32, v32
 v_mfma_f32_16x16x32_bf16 a[232:235], a[136:139], a[164:167], a[232:235]
 v_mul_f32 v40, s43, v204
 v_mul_f32 v41, s43, v205
 v_mfma_f32_16x16x32_bf16 a[232:235], a[152:155], a[168:171], a[232:235]
 v_exp_f32 v33, v33
 v_mfma_f32_16x16x32_bf16 a[236:239], a[156:159], a[168:171], a[236:239]
 v_mul_f32 v42, s43, v206
 v_mul_f32 v43, s43, v207
 v_mfma_f32_16x16x32_bf16 a[236:239], a[140:143], a[164:167], a[236:239]
 v_exp_f32 v34, v34
 v_mfma_f32_16x16x32_bf16 a[236:239], a[124:127], a[160:163], a[236:239]
 v_exp_f32 v35, v35
 v_mfma_f32_16x16x32_bf16 a[236:239], a[108:111], a[204:207], a[236:239]
 v_exp_f32 v40, v40
 v_mfma_f32_16x16x32_bf16 a[236:239], a[92:95], a[200:203], a[236:239]
 v_add_f32 v28, 1.0, v32
 v_add_f32 v29, 1.0, v33
 v_mfma_f32_16x16x32_bf16 a[252:255], a[92:95], a[204:207], a[252:255]
 v_exp_f32 v41, v41
 v_mfma_f32_16x16x32_bf16 a[252:255], a[108:111], a[160:163], a[252:255]
 v_add_f32 v30, 1.0, v34
 v_add_f32 v31, 1.0, v35
 v_mfma_f32_16x16x32_bf16 a[252:255], a[124:127], a[164:167], a[252:255]
 v_exp_f32 v42, v42
 v_mfma_f32_16x16x32_bf16 a[252:255], a[140:143], a[168:171], a[252:255]
 s_waitcnt lgkmcnt(0)
 v_exp_f32 v43, v43
 v_mfma_f32_16x16x32_bf16 a[252:255], a[156:159], a[188:191], a[252:255]
 v_fmac_f32 v28, v28, v40
 v_fmac_f32 v29, v29, v41
 v_mfma_f32_16x16x32_bf16 a[248:251], a[152:155], a[188:191], a[248:251]
 v_fmac_f32 v30, v30, v42
 v_fmac_f32 v31, v31, v43
 v_mfma_f32_16x16x32_bf16 a[248:251], a[136:139], a[168:171], a[248:251]
 v_rcp_f32 v28, v28
 v_mfma_f32_16x16x32_bf16 a[248:251], a[120:123], a[164:167], a[248:251]
 v_rcp_f32 v29, v29
 v_mfma_f32_16x16x32_bf16 a[248:251], a[104:107], a[160:163], a[248:251]
 v_rcp_f32 v30, v30
 v_mfma_f32_16x16x32_bf16 a[248:251], a[88:91], a[204:207], a[248:251]
 v_rcp_f32 v31, v31
 v_mfma_f32_16x16x32_bf16 a[244:247], a[84:87], a[204:207], a[244:247]
 v_fma_f32 v32, v32, v28, -v28
 v_fma_f32 v33, v33, v29, -v29
 v_mfma_f32_16x16x32_bf16 a[244:247], a[100:103], a[160:163], a[244:247]
 v_fma_f32 v34, v34, v30, -v30
 v_fma_f32 v35, v35, v31, -v31
 v_mfma_f32_16x16x32_bf16 a[244:247], a[116:119], a[164:167], a[244:247]
 v_cvt_pk_bf16_f32 v18, v32, v33
 v_cvt_pk_bf16_f32 v19, v34, v35
 v_mfma_f32_16x16x32_bf16 a[244:247], a[132:135], a[168:171], a[244:247]
 s_add_u32 s46, s40, 3072
 buffer_store_dwordx4 v[16:19], v6, s[12:15], s46 offen
 v_mfma_f32_16x16x32_bf16 a[244:247], a[148:151], a[188:191], a[244:247]
 v_mfma_f32_16x16x32_bf16 a[240:243], a[144:147], a[188:191], a[240:243]
 v_mfma_f32_16x16x32_bf16 a[240:243], a[128:131], a[168:171], a[240:243]
 v_mfma_f32_16x16x32_bf16 a[240:243], a[112:115], a[164:167], a[240:243]
 v_mfma_f32_16x16x32_bf16 a[240:243], a[96:99], a[160:163], a[240:243]
 v_mfma_f32_16x16x32_bf16 a[240:243], a[80:83], a[204:207], a[240:243]
 s_nop 7
 v_pk_mul_f32 v[20:21], v[208:209], s[42:43] op_sel_hi:[1,0]
 v_pk_mul_f32 v[22:23], v[210:211], s[42:43] op_sel_hi:[1,0]
 v_pk_mul_f32 v[24:25], v[216:217], s[42:43] op_sel:[0,1] op_sel_hi:[1,1]
 v_pk_mul_f32 v[26:27], v[218:219], s[42:43] op_sel:[0,1] op_sel_hi:[1,1]
 v_min_f32 v20, s47, v20
 v_min_f32 v21, s47, v21
 v_min_f32 v22, s47, v22
 v_min_f32 v23, s47, v23
 v_exp_f32 v24, v24
 v_exp_f32 v25, v25
 v_exp_f32 v26, v26
 v_exp_f32 v27, v27
 v_exp_f32 v20, v20
 v_exp_f32 v21, v21
 v_exp_f32 v22, v22
 v_exp_f32 v23, v23
 v_pk_add_f32 v[28:29], v[20:21], 1.0 op_sel_hi:[1,0]
 v_pk_add_f32 v[30:31], v[22:23], 1.0 op_sel_hi:[1,0]
 v_pk_fma_f32 v[28:29], v[28:29], v[24:25], v[28:29]
 v_pk_fma_f32 v[30:31], v[30:31], v[26:27], v[30:31]
 v_rcp_f32 v28, v28
 v_rcp_f32 v29, v29
 v_rcp_f32 v30, v30
 v_rcp_f32 v31, v31
 v_pk_fma_f32 v[20:21], v[20:21], v[28:29], v[28:29] neg_lo:[0,0,1] neg_hi:[0,0,1]
 v_pk_fma_f32 v[22:23], v[22:23], v[30:31], v[30:31] neg_lo:[0,0,1] neg_hi:[0,0,1]
 v_cvt_pk_bf16_f32 v16, v20, v21
 v_cvt_pk_bf16_f32 v17, v22, v23
 v_pk_mul_f32 v[20:21], v[212:213], s[42:43] op_sel_hi:[1,0]
 v_pk_mul_f32 v[22:23], v[214:215], s[42:43] op_sel_hi:[1,0]
 v_pk_mul_f32 v[24:25], v[220:221], s[42:43] op_sel:[0,1] op_sel_hi:[1,1]
 v_pk_mul_f32 v[26:27], v[222:223], s[42:43] op_sel:[0,1] op_sel_hi:[1,1]
 v_min_f32 v20, s47, v20
 v_min_f32 v21, s47, v21
 v_min_f32 v22, s47, v22
 v_min_f32 v23, s47, v23
 v_exp_f32 v24, v24
 v_exp_f32 v25, v25
 v_exp_f32 v26, v26
 v_exp_f32 v27, v27
 v_exp_f32 v20, v20
 v_exp_f32 v21, v21
 v_exp_f32 v22, v22
 v_exp_f32 v23, v23
 v_pk_add_f32 v[28:29], v[20:21], 1.0 op_sel_hi:[1,0]
 v_pk_add_f32 v[30:31], v[22:23], 1.0 op_sel_hi:[1,0]
 v_pk_fma_f32 v[28:29], v[28:29], v[24:25], v[28:29]
 v_pk_fma_f32 v[30:31], v[30:31], v[26:27], v[30:31]
 v_rcp_f32 v28, v28
 v_rcp_f32 v29, v29
 v_rcp_f32 v30, v30
 v_rcp_f32 v31, v31
 v_pk_fma_f32 v[20:21], v[20:21], v[28:29], v[28:29] neg_lo:[0,0,1] neg_hi:[0,0,1]
 v_pk_fma_f32 v[22:23], v[22:23], v[30:31], v[30:31] neg_lo:[0,0,1] neg_hi:[0,0,1]
 v_cvt_pk_bf16_f32 v18, v20, v21
 v_cvt_pk_bf16_f32 v19, v22, v23
 s_add_u32 s46, s40, 5120
 buffer_store_dwordx4 v[16:19], v6, s[12:15], s46 offen
 s_nop 1
 v_pk_mul_f32 v[20:21], v[224:225], s[42:43] op_sel_hi:[1,0]
 v_pk_mul_f32 v[22:23], v[226:227], s[42:43] op_sel_hi:[1,0]
 v_pk_mul_f32 v[24:25], v[232:233], s[42:43] op_sel:[0,1] op_sel_hi:[1,1]
 v_pk_mul_f32 v[26:27], v[234:235], s[42:43] op_sel:[0,1] op_sel_hi:[1,1]
 v_min_f32 v20, s47, v20
 v_min_f32 v21, s47, v21
 v_min_f32 v22, s47, v22
 v_min_f32 v23, s47, v23
 v_exp_f32 v24, v24
 v_exp_f32 v25, v25
 v_exp_f32 v26, v26
 v_exp_f32 v27, v27
 v_exp_f32 v20, v20
 v_exp_f32 v21, v21
 v_exp_f32 v22, v22
 v_exp_f32 v23, v23
 v_pk_add_f32 v[28:29], v[20:21], 1.0 op_sel_hi:[1,0]
 v_pk_add_f32 v[30:31], v[22:23], 1.0 op_sel_hi:[1,0]
 v_pk_fma_f32 v[28:29], v[28:29], v[24:25], v[28:29]
 v_pk_fma_f32 v[30:31], v[30:31], v[26:27], v[30:31]
 v_rcp_f32 v28, v28
 v_rcp_f32 v29, v29
 v_rcp_f32 v30, v30
 v_rcp_f32 v31, v31
 v_pk_fma_f32 v[20:21], v[20:21], v[28:29], v[28:29] neg_lo:[0,0,1] neg_hi:[0,0,1]
 v_pk_fma_f32 v[22:23], v[22:23], v[30:31], v[30:31] neg_lo:[0,0,1] neg_hi:[0,0,1]
 v_cvt_pk_bf16_f32 v16, v20, v21
 v_cvt_pk_bf16_f32 v17, v22, v23
 v_pk_mul_f32 v[20:21], v[228:229], s[42:43] op_sel_hi:[1,0]
 v_pk_mul_f32 v[22:23], v[230:231], s[42:43] op_sel_hi:[1,0]
 v_pk_mul_f32 v[24:25], v[236:237], s[42:43] op_sel:[0,1] op_sel_hi:[1,1]
 v_pk_mul_f32 v[26:27], v[238:239], s[42:43] op_sel:[0,1] op_sel_hi:[1,1]
 v_min_f32 v20, s47, v20
 v_min_f32 v21, s47, v21
 v_min_f32 v22, s47, v22
 v_min_f32 v23, s47, v23
 v_exp_f32 v24, v24
 v_exp_f32 v25, v25
 v_exp_f32 v26, v26
 v_exp_f32 v27, v27
 v_exp_f32 v20, v20
 v_exp_f32 v21, v21
 v_exp_f32 v22, v22
 v_exp_f32 v23, v23
 v_pk_add_f32 v[28:29], v[20:21], 1.0 op_sel_hi:[1,0]
 v_pk_add_f32 v[30:31], v[22:23], 1.0 op_sel_hi:[1,0]
 v_pk_fma_f32 v[28:29], v[28:29], v[24:25], v[28:29]
 v_pk_fma_f32 v[30:31], v[30:31], v[26:27], v[30:31]
 v_rcp_f32 v28, v28
 v_rcp_f32 v29, v29
 v_rcp_f32 v30, v30
 v_rcp_f32 v31, v31
 v_pk_fma_f32 v[20:21], v[20:21], v[28:29], v[28:29] neg_lo:[0,0,1] neg_hi:[0,0,1]
 v_pk_fma_f32 v[22:23], v[22:23], v[30:31], v[30:31] neg_lo:[0,0,1] neg_hi:[0,0,1]
 v_cvt_pk_bf16_f32 v18, v20, v21
 v_cvt_pk_bf16_f32 v19, v22, v23
 s_add_u32 s46, s40, 7168
 buffer_store_dwordx4 v[16:19], v6, s[12:15], s46 offen
 s_nop 1
 v_pk_mul_f32 v[20:21], v[240:241], s[42:43] op_sel_hi:[1,0]
 v_pk_mul_f32 v[22:23], v[242:243], s[42:43] op_sel_hi:[1,0]
 v_pk_mul_f32 v[24:25], v[248:249], s[42:43] op_sel:[0,1] op_sel_hi:[1,1]
 v_pk_mul_f32 v[26:27], v[250:251], s[42:43] op_sel:[0,1] op_sel_hi:[1,1]
 v_min_f32 v20, s47, v20
 v_min_f32 v21, s47, v21
 v_min_f32 v22, s47, v22
 v_min_f32 v23, s47, v23
 v_exp_f32 v24, v24
 v_exp_f32 v25, v25
 v_exp_f32 v26, v26
 v_exp_f32 v27, v27
 v_exp_f32 v20, v20
 v_exp_f32 v21, v21
 v_exp_f32 v22, v22
 v_exp_f32 v23, v23
 v_pk_add_f32 v[28:29], v[20:21], 1.0 op_sel_hi:[1,0]
 v_pk_add_f32 v[30:31], v[22:23], 1.0 op_sel_hi:[1,0]
 v_pk_fma_f32 v[28:29], v[28:29], v[24:25], v[28:29]
 v_pk_fma_f32 v[30:31], v[30:31], v[26:27], v[30:31]
 v_rcp_f32 v28, v28
 v_rcp_f32 v29, v29
 v_rcp_f32 v30, v30
 v_rcp_f32 v31, v31
 v_pk_fma_f32 v[20:21], v[20:21], v[28:29], v[28:29] neg_lo:[0,0,1] neg_hi:[0,0,1]
 v_pk_fma_f32 v[22:23], v[22:23], v[30:31], v[30:31] neg_lo:[0,0,1] neg_hi:[0,0,1]
 v_cvt_pk_bf16_f32 v16, v20, v21
 v_cvt_pk_bf16_f32 v17, v22, v23
 v_pk_mul_f32 v[20:21], v[244:245], s[42:43] op_sel_hi:[1,0]
 v_pk_mul_f32 v[22:23], v[246:247], s[42:43] op_sel_hi:[1,0]
 v_pk_mul_f32 v[24:25], v[252:253], s[42:43] op_sel:[0,1] op_sel_hi:[1,1]
 v_pk_mul_f32 v[26:27], v[254:255], s[42:43] op_sel:[0,1] op_sel_hi:[1,1]
 v_min_f32 v20, s47, v20
 v_min_f32 v21, s47, v21
 v_min_f32 v22, s47, v22
 v_min_f32 v23, s47, v23
 v_exp_f32 v24, v24
 v_exp_f32 v25, v25
 v_exp_f32 v26, v26
 v_exp_f32 v27, v27
 v_exp_f32 v20, v20
 v_exp_f32 v21, v21
 v_exp_f32 v22, v22
 v_exp_f32 v23, v23
 v_pk_add_f32 v[28:29], v[20:21], 1.0 op_sel_hi:[1,0]
 v_pk_add_f32 v[30:31], v[22:23], 1.0 op_sel_hi:[1,0]
 v_pk_fma_f32 v[28:29], v[28:29], v[24:25], v[28:29]
 v_pk_fma_f32 v[30:31], v[30:31], v[26:27], v[30:31]
 v_rcp_f32 v28, v28
 v_rcp_f32 v29, v29
 v_rcp_f32 v30, v30
 v_rcp_f32 v31, v31
 v_pk_fma_f32 v[20:21], v[20:21], v[28:29], v[28:29] neg_lo:[0,0,1] neg_hi:[0,0,1]
 v_pk_fma_f32 v[22:23], v[22:23], v[30:31], v[30:31] neg_lo:[0,0,1] neg_hi:[0,0,1]
 v_cvt_pk_bf16_f32 v18, v20, v21
 v_cvt_pk_bf16_f32 v19, v22, v23
 s_add_u32 s46, s40, 9216
 buffer_store_dwordx4 v[16:19], v6, s[12:15], s46 offen
 s_nop 1
 v_accvgpr_read_b32 v20, a208
 v_accvgpr_read_b32 v21, a209
 v_accvgpr_read_b32 v22, a210
 v_accvgpr_read_b32 v23, a211
 v_accvgpr_read_b32 v24, a216
 v_accvgpr_read_b32 v25, a217
 v_accvgpr_read_b32 v26, a218
 v_accvgpr_read_b32 v27, a219
 v_pk_mul_f32 v[20:21], v[20:21], s[42:43] op_sel_hi:[1,0]
 v_pk_mul_f32 v[22:23], v[22:23], s[42:43] op_sel_hi:[1,0]
 v_pk_mul_f32 v[24:25], v[24:25], s[42:43] op_sel:[0,1] op_sel_hi:[1,1]
 v_pk_mul_f32 v[26:27], v[26:27], s[42:43] op_sel:[0,1] op_sel_hi:[1,1]
 v_min_f32 v20, s47, v20
 v_min_f32 v21, s47, v21
 v_min_f32 v22, s47, v22
 v_min_f32 v23, s47, v23
 v_exp_f32 v24, v24
 v_exp_f32 v25, v25
 v_exp_f32 v26, v26
 v_exp_f32 v27, v27
 v_exp_f32 v20, v20
 v_exp_f32 v21, v21
 v_exp_f32 v22, v22
 v_exp_f32 v23, v23
 v_pk_add_f32 v[28:29], v[20:21], 1.0 op_sel_hi:[1,0]
 v_pk_add_f32 v[30:31], v[22:23], 1.0 op_sel_hi:[1,0]
 v_pk_fma_f32 v[28:29], v[28:29], v[24:25], v[28:29]
 v_pk_fma_f32 v[30:31], v[30:31], v[26:27], v[30:31]
 v_rcp_f32 v28, v28
 v_rcp_f32 v29, v29
 v_rcp_f32 v30, v30
 v_rcp_f32 v31, v31
 v_pk_fma_f32 v[20:21], v[20:21], v[28:29], v[28:29] neg_lo:[0,0,1] neg_hi:[0,0,1]
 v_pk_fma_f32 v[22:23], v[22:23], v[30:31], v[30:31] neg_lo:[0,0,1] neg_hi:[0,0,1]
 v_cvt_pk_bf16_f32 v16, v20, v21
 v_cvt_pk_bf16_f32 v17, v22, v23
 v_accvgpr_read_b32 v20, a212
 v_accvgpr_read_b32 v21, a213
 v_accvgpr_read_b32 v22, a214
 v_accvgpr_read_b32 v23, a215
 v_accvgpr_read_b32 v24, a220
 v_accvgpr_read_b32 v25, a221
 v_accvgpr_read_b32 v26, a222
 v_accvgpr_read_b32 v27, a223
 v_pk_mul_f32 v[20:21], v[20:21], s[42:43] op_sel_hi:[1,0]
 v_pk_mul_f32 v[22:23], v[22:23], s[42:43] op_sel_hi:[1,0]
 v_pk_mul_f32 v[24:25], v[24:25], s[42:43] op_sel:[0,1] op_sel_hi:[1,1]
 v_pk_mul_f32 v[26:27], v[26:27], s[42:43] op_sel:[0,1] op_sel_hi:[1,1]
 v_min_f32 v20, s47, v20
 v_min_f32 v21, s47, v21
 v_min_f32 v22, s47, v22
 v_min_f32 v23, s47, v23
 v_exp_f32 v24, v24
 v_exp_f32 v25, v25
 v_exp_f32 v26, v26
 v_exp_f32 v27, v27
 v_exp_f32 v20, v20
 v_exp_f32 v21, v21
 v_exp_f32 v22, v22
 v_exp_f32 v23, v23
 v_pk_add_f32 v[28:29], v[20:21], 1.0 op_sel_hi:[1,0]
 v_pk_add_f32 v[30:31], v[22:23], 1.0 op_sel_hi:[1,0]
 v_pk_fma_f32 v[28:29], v[28:29], v[24:25], v[28:29]
 v_pk_fma_f32 v[30:31], v[30:31], v[26:27], v[30:31]
 v_rcp_f32 v28, v28
 v_rcp_f32 v29, v29
 v_rcp_f32 v30, v30
 v_rcp_f32 v31, v31
 v_pk_fma_f32 v[20:21], v[20:21], v[28:29], v[28:29] neg_lo:[0,0,1] neg_hi:[0,0,1]
 v_pk_fma_f32 v[22:23], v[22:23], v[30:31], v[30:31] neg_lo:[0,0,1] neg_hi:[0,0,1]
 v_cvt_pk_bf16_f32 v18, v20, v21
 v_cvt_pk_bf16_f32 v19, v22, v23
 s_add_u32 s46, s40, 11264
 buffer_store_dwordx4 v[16:19], v6, s[12:15], s46 offen
 s_nop 1
 v_accvgpr_read_b32 v20, a224
 v_accvgpr_read_b32 v21, a225
 v_accvgpr_read_b32 v22, a226
 v_accvgpr_read_b32 v23, a227
 v_accvgpr_read_b32 v24, a232
 v_accvgpr_read_b32 v25, a233
 v_accvgpr_read_b32 v26, a234
 v_accvgpr_read_b32 v27, a235
 v_pk_mul_f32 v[20:21], v[20:21], s[42:43] op_sel_hi:[1,0]
 v_pk_mul_f32 v[22:23], v[22:23], s[42:43] op_sel_hi:[1,0]
 v_pk_mul_f32 v[24:25], v[24:25], s[42:43] op_sel:[0,1] op_sel_hi:[1,1]
 v_pk_mul_f32 v[26:27], v[26:27], s[42:43] op_sel:[0,1] op_sel_hi:[1,1]
 v_min_f32 v20, s47, v20
 v_min_f32 v21, s47, v21
 v_min_f32 v22, s47, v22
 v_min_f32 v23, s47, v23
 v_exp_f32 v24, v24
 v_exp_f32 v25, v25
 v_exp_f32 v26, v26
 v_exp_f32 v27, v27
 v_exp_f32 v20, v20
 v_exp_f32 v21, v21
 v_exp_f32 v22, v22
 v_exp_f32 v23, v23
 v_pk_add_f32 v[28:29], v[20:21], 1.0 op_sel_hi:[1,0]
 v_pk_add_f32 v[30:31], v[22:23], 1.0 op_sel_hi:[1,0]
 v_pk_fma_f32 v[28:29], v[28:29], v[24:25], v[28:29]
 v_pk_fma_f32 v[30:31], v[30:31], v[26:27], v[30:31]
 v_rcp_f32 v28, v28
 v_rcp_f32 v29, v29
 v_rcp_f32 v30, v30
 v_rcp_f32 v31, v31
 v_pk_fma_f32 v[20:21], v[20:21], v[28:29], v[28:29] neg_lo:[0,0,1] neg_hi:[0,0,1]
 v_pk_fma_f32 v[22:23], v[22:23], v[30:31], v[30:31] neg_lo:[0,0,1] neg_hi:[0,0,1]
 v_cvt_pk_bf16_f32 v16, v20, v21
 v_cvt_pk_bf16_f32 v17, v22, v23
 v_accvgpr_read_b32 v20, a228
 v_accvgpr_read_b32 v21, a229
 v_accvgpr_read_b32 v22, a230
 v_accvgpr_read_b32 v23, a231
 v_accvgpr_read_b32 v24, a236
 v_accvgpr_read_b32 v25, a237
 v_accvgpr_read_b32 v26, a238
 v_accvgpr_read_b32 v27, a239
 v_pk_mul_f32 v[20:21], v[20:21], s[42:43] op_sel_hi:[1,0]
 v_pk_mul_f32 v[22:23], v[22:23], s[42:43] op_sel_hi:[1,0]
 v_pk_mul_f32 v[24:25], v[24:25], s[42:43] op_sel:[0,1] op_sel_hi:[1,1]
 v_pk_mul_f32 v[26:27], v[26:27], s[42:43] op_sel:[0,1] op_sel_hi:[1,1]
 v_min_f32 v20, s47, v20
 v_min_f32 v21, s47, v21
 v_min_f32 v22, s47, v22
 v_min_f32 v23, s47, v23
 v_exp_f32 v24, v24
 v_exp_f32 v25, v25
 v_exp_f32 v26, v26
 v_exp_f32 v27, v27
 v_exp_f32 v20, v20
 v_exp_f32 v21, v21
 v_exp_f32 v22, v22
 v_exp_f32 v23, v23
 v_pk_add_f32 v[28:29], v[20:21], 1.0 op_sel_hi:[1,0]
 v_pk_add_f32 v[30:31], v[22:23], 1.0 op_sel_hi:[1,0]
 v_pk_fma_f32 v[28:29], v[28:29], v[24:25], v[28:29]
 v_pk_fma_f32 v[30:31], v[30:31], v[26:27], v[30:31]
 v_rcp_f32 v28, v28
 v_rcp_f32 v29, v29
 v_rcp_f32 v30, v30
 v_rcp_f32 v31, v31
 v_pk_fma_f32 v[20:21], v[20:21], v[28:29], v[28:29] neg_lo:[0,0,1] neg_hi:[0,0,1]
 v_pk_fma_f32 v[22:23], v[22:23], v[30:31], v[30:31] neg_lo:[0,0,1] neg_hi:[0,0,1]
 v_cvt_pk_bf16_f32 v18, v20, v21
 v_cvt_pk_bf16_f32 v19, v22, v23
 s_add_u32 s46, s40, 13312
 buffer_store_dwordx4 v[16:19], v6, s[12:15], s46 offen
 s_nop 1
 v_accvgpr_read_b32 v20, a240
 v_accvgpr_read_b32 v21, a241
 v_accvgpr_read_b32 v22, a242
 v_accvgpr_read_b32 v23, a243
 v_accvgpr_read_b32 v24, a248
 v_accvgpr_read_b32 v25, a249
 v_accvgpr_read_b32 v26, a250
 v_accvgpr_read_b32 v27, a251
 v_pk_mul_f32 v[20:21], v[20:21], s[42:43] op_sel_hi:[1,0]
 v_pk_mul_f32 v[22:23], v[22:23], s[42:43] op_sel_hi:[1,0]
 v_pk_mul_f32 v[24:25], v[24:25], s[42:43] op_sel:[0,1] op_sel_hi:[1,1]
 v_pk_mul_f32 v[26:27], v[26:27], s[42:43] op_sel:[0,1] op_sel_hi:[1,1]
 v_min_f32 v20, s47, v20
 v_min_f32 v21, s47, v21
 v_min_f32 v22, s47, v22
 v_min_f32 v23, s47, v23
 v_exp_f32 v24, v24
 v_exp_f32 v25, v25
 v_exp_f32 v26, v26
 v_exp_f32 v27, v27
 v_exp_f32 v20, v20
 v_exp_f32 v21, v21
 v_exp_f32 v22, v22
 v_exp_f32 v23, v23
 v_pk_add_f32 v[28:29], v[20:21], 1.0 op_sel_hi:[1,0]
 v_pk_add_f32 v[30:31], v[22:23], 1.0 op_sel_hi:[1,0]
 v_pk_fma_f32 v[28:29], v[28:29], v[24:25], v[28:29]
 v_pk_fma_f32 v[30:31], v[30:31], v[26:27], v[30:31]
 v_rcp_f32 v28, v28
 v_rcp_f32 v29, v29
 v_rcp_f32 v30, v30
 v_rcp_f32 v31, v31
 v_pk_fma_f32 v[20:21], v[20:21], v[28:29], v[28:29] neg_lo:[0,0,1] neg_hi:[0,0,1]
 v_pk_fma_f32 v[22:23], v[22:23], v[30:31], v[30:31] neg_lo:[0,0,1] neg_hi:[0,0,1]
 v_cvt_pk_bf16_f32 v16, v20, v21
 v_cvt_pk_bf16_f32 v17, v22, v23
 v_accvgpr_read_b32 v20, a244
 v_accvgpr_read_b32 v21, a245
 v_accvgpr_read_b32 v22, a246
 v_accvgpr_read_b32 v23, a247
 v_accvgpr_read_b32 v24, a252
 v_accvgpr_read_b32 v25, a253
 v_accvgpr_read_b32 v26, a254
 v_accvgpr_read_b32 v27, a255
 v_pk_mul_f32 v[20:21], v[20:21], s[42:43] op_sel_hi:[1,0]
 v_pk_mul_f32 v[22:23], v[22:23], s[42:43] op_sel_hi:[1,0]
 v_pk_mul_f32 v[24:25], v[24:25], s[42:43] op_sel:[0,1] op_sel_hi:[1,1]
 v_pk_mul_f32 v[26:27], v[26:27], s[42:43] op_sel:[0,1] op_sel_hi:[1,1]
 v_min_f32 v20, s47, v20
 v_min_f32 v21, s47, v21
 v_min_f32 v22, s47, v22
 v_min_f32 v23, s47, v23
 v_exp_f32 v24, v24
 v_exp_f32 v25, v25
 v_exp_f32 v26, v26
 v_exp_f32 v27, v27
 v_exp_f32 v20, v20
 v_exp_f32 v21, v21
 v_exp_f32 v22, v22
 v_exp_f32 v23, v23
 v_pk_add_f32 v[28:29], v[20:21], 1.0 op_sel_hi:[1,0]
 v_pk_add_f32 v[30:31], v[22:23], 1.0 op_sel_hi:[1,0]
 v_pk_fma_f32 v[28:29], v[28:29], v[24:25], v[28:29]
 v_pk_fma_f32 v[30:31], v[30:31], v[26:27], v[30:31]
 v_rcp_f32 v28, v28
 v_rcp_f32 v29, v29
 v_rcp_f32 v30, v30
 v_rcp_f32 v31, v31
 v_pk_fma_f32 v[20:21], v[20:21], v[28:29], v[28:29] neg_lo:[0,0,1] neg_hi:[0,0,1]
 v_pk_fma_f32 v[22:23], v[22:23], v[30:31], v[30:31] neg_lo:[0,0,1] neg_hi:[0,0,1]
 v_cvt_pk_bf16_f32 v18, v20, v21
 v_cvt_pk_bf16_f32 v19, v22, v23
 s_add_u32 s46, s40, 15360
 buffer_store_dwordx4 v[16:19], v6, s[12:15], s46 offen
 s_nop 1
 s_waitcnt vmcnt(0) lgkmcnt(0)
 s_endpgm
L_e16:
L_p15:
 s_waitcnt lgkmcnt(5)
 ds_read_b128 a[184:187], v1 offset:26112
 v_mul_f32 v20, s42, v192
 v_mfma_f32_16x16x32_bf16 v[48:51], a[0:3], a[160:163], 0
 s_waitcnt lgkmcnt(5)
 v_mul_f32 v21, s42, v193
 v_mul_f32 v22, s42, v194
 v_mfma_f32_16x16x32_bf16 v[48:51], a[16:19], a[164:167], v[48:51]
 s_waitcnt lgkmcnt(4)
 v_mul_f32 v23, s42, v195
 v_min_f32 v20, s47, v20
 v_mfma_f32_16x16x32_bf16 v[48:51], a[32:35], a[168:171], v[48:51]
 s_waitcnt lgkmcnt(3)
 v_min_f32 v21, s47, v21
 v_min_f32 v22, s47, v22
 v_mfma_f32_16x16x32_bf16 v[48:51], a[48:51], a[172:175], v[48:51]
 s_waitcnt lgkmcnt(2)
 ds_read_b128 a[188:191], v1 offset:30464
 v_min_f32 v23, s47, v23
 v_mfma_f32_16x16x32_bf16 v[48:51], a[64:67], a[176:179], v[48:51]
 v_exp_f32 v20, v20
 v_mfma_f32_16x16x32_bf16 v[52:55], a[68:71], a[176:179], 0
 v_mul_f32 v24, s43, v200
 v_mul_f32 v25, s43, v201
 v_mfma_f32_16x16x32_bf16 v[52:55], a[52:55], a[172:175], v[52:55]
 s_add_u32 m0, s26, 0
 v_exp_f32 v21, v21
 v_mfma_f32_16x16x32_bf16 v[52:55], a[36:39], a[168:171], v[52:55]
 buffer_load_dwordx4 v7, s[4:7], 0 offen nt lds
 v_mul_f32 v26, s43, v202
 v_mfma_f32_16x16x32_bf16 v[52:55], a[20:23], a[164:167], v[52:55]
 v_mul_f32 v27, s43, v203
 v_add_f32 v28, 1.0, v20
 v_mfma_f32_16x16x32_bf16 v[52:55], a[4:7], a[160:163], v[52:55]
 v_exp_f32 v22, v22
 v_mfma_f32_16x16x32_bf16 v[56:59], a[8:11], a[160:163], 0
 v_exp_f32 v23, v23
 v_mfma_f32_16x16x32_bf16 v[56:59], a[24:27], a[164:167], v[56:59]
 v_exp_f32 v24, v24
 v_mfma_f32_16x16x32_bf16 v[56:59], a[40:43], a[168:171], v[56:59]
 v_add_f32 v29, 1.0, v21
 v_add_f32 v30, 1.0, v22
 v_mfma_f32_16x16x32_bf16 v[56:59], a[56:59], a[172:175], v[56:59]
 v_exp_f32 v25, v25
 v_mfma_f32_16x16x32_bf16 v[56:59], a[72:75], a[176:179], v[56:59]
 v_add_f32 v31, 1.0, v23
 v_fmac_f32 v28, v28, v24
 v_mfma_f32_16x16x32_bf16 v[60:63], a[76:79], a[176:179], 0
 v_exp_f32 v26, v26
 v_mfma_f32_16x16x32_bf16 v[60:63], a[60:63], a[172:175], v[60:63]
 v_exp_f32 v27, v27
 v_mfma_f32_16x16x32_bf16 v[60:63], a[44:47], a[168:171], v[60:63]
 v_fmac_f32 v29, v29, v25
 v_fmac_f32 v30, v30, v26
 v_mfma_f32_16x16x32_bf16 v[60:63], a[28:31], a[164:167], v[60:63]
 v_fmac_f32 v31, v31, v27
 v_mul_f32 v32, s42, v196
 v_mfma_f32_16x16x32_bf16 v[60:63], a[12:15], a[160:163], v[60:63]
 v_rcp_f32 v28, v28
 v_mfma_f32_16x16x32_bf16 v[76:79], a[12:15], a[164:167], 0
 v_rcp_f32 v29, v29
 v_mfma_f32_16x16x32_bf16 v[76:79], a[28:31], a[168:171], v[76:79]
 v_rcp_f32 v30, v30
 v_mfma_f32_16x16x32_bf16 v[76:79], a[44:47], a[172:175], v[76:79]
 v_rcp_f32 v31, v31
 v_mfma_f32_16x16x32_bf16 v[76:79], a[60:63], a[176:179], v[76:79]
 s_waitcnt lgkmcnt(0)
 ds_read_b128 a[192:195], v3 offset:2176
 v_fma_f32 v20, v20, v28, -v28
 v_mfma_f32_16x16x32_bf16 v[76:79], a[76:79], a[180:183], v[76:79]
 v_fma_f32 v21, v21, v29, -v29
 v_fma_f32 v22, v22, v30, -v30
 v_mfma_f32_16x16x32_bf16 v[72:75], a[72:75], a[180:183], 0
 v_fma_f32 v23, v23, v31, -v31
 v_cvt_pk_bf16_f32 v16, v20, v21
 v_mfma_f32_16x16x32_bf16 v[72:75], a[56:59], a[176:179], v[72:75]
 v_cvt_pk_bf16_f32 v17, v22, v23
 v_mul_f32 v33, s42, v197
 v_mfma_f32_16x16x32_bf16 v[72:75], a[40:43], a[172:175], v[72:75]
 v_mul_f32 v34, s42, v198
 v_mul_f32 v35, s42, v199
 v_mfma_f32_16x16x32_bf16 v[72:75], a[24:27], a[168:171], v[72:75]
 v_min_f32 v32, s47, v32
 v_min_f32 v33, s47, v33
 v_mfma_f32_16x16x32_bf16 v[72:75], a[8:11], a[164:167], v[72:75]
 v_min_f32 v34, s47, v34
 v_min_f32 v35, s47, v35
 v_mfma_f32_16x16x32_bf16 v[68:71], a[4:7], a[164:167], 0
 v_exp_f32 v32, v32
 v_mfma_f32_16x16x32_bf16 v[68:71], a[20:23], a[168:171], v[68:71]
 v_mul_f32 v40, s43, v204
 v_mul_f32 v41, s43, v205
 v_mfma_f32_16x16x32_bf16 v[68:71], a[36:39], a[172:175], v[68:71]
 v_exp_f32 v33, v33
 v_mfma_f32_16x16x32_bf16 v[68:71], a[52:55], a[176:179], v[68:71]
 v_mul_f32 v42, s43, v206
 v_mul_f32 v43, s43, v207
 v_mfma_f32_16x16x32_bf16 v[68:71], a[68:71], a[180:183], v[68:71]
 v_exp_f32 v34, v34
 v_mfma_f32_16x16x32_bf16 v[64:67], a[64:67], a[180:183], 0
 v_exp_f32 v35, v35
 v_mfma_f32_16x16x32_bf16 v[64:67], a[48:51], a[176:179], v[64:67]
 v_exp_f32 v40, v40
 v_mfma_f32_16x16x32_bf16 v[64:67], a[32:35], a[172:175], v[64:67]
 v_add_f32 v28, 1.0, v32
 v_add_f32 v29, 1.0, v33
 v_mfma_f32_16x16x32_bf16 v[64:67], a[16:19], a[168:171], v[64:67]
 v_exp_f32 v41, v41
 v_mfma_f32_16x16x32_bf16 v[64:67], a[0:3], a[164:167], v[64:67]
 ds_read_b64_tr_b16 a[80:81], v46 offset:0
 v_add_f32 v30, 1.0, v34
 v_mfma_f32_16x16x32_bf16 v[80:83], a[0:3], a[168:171], 0
 v_add_f32 v31, 1.0, v35
 v_fmac_f32 v28, v28, v40
 v_mfma_f32_16x16x32_bf16 v[80:83], a[16:19], a[172:175], v[80:83]
 ds_read_b64_tr_b16 a[82:83], v46 offset:256
 v_fmac_f32 v29, v29, v41
 v_mfma_f32_16x16x32_bf16 v[80:83], a[32:35], a[176:179], v[80:83]
 v_exp_f32 v42, v42
 v_mfma_f32_16x16x32_bf16 v[80:83], a[48:51], a[180:183], v[80:83]
 s_add_u32 m0, s26, 1024
 ds_read_b128 a[196:199], v3 offset:6528
 ds_read_b64_tr_b16 a[84:85], v46 offset:8
 v_mfma_f32_16x16x32_bf16 v[80:83], a[64:67], a[184:187], v[80:83]
 buffer_load_dwordx4 v8, s[4:7], 0 offen nt lds
 v_fmac_f32 v30, v30, v42
 v_mfma_f32_16x16x32_bf16 v[84:87], a[68:71], a[184:187], 0
 ds_read_b64_tr_b16 a[86:87], v46 offset:264
 v_mul_f32 v20, s42, v208
 v_mfma_f32_16x16x32_bf16 v[84:87], a[52:55], a[180:183], v[84:87]
 v_exp_f32 v43, v43
 v_mfma_f32_16x16x32_bf16 v[84:87], a[36:39], a[176:179], v[84:87]
 s_waitcnt vmcnt(20)
 ds_read_b64_tr_b16 a[96:97], v46 offset:4096
 v_fmac_f32 v31, v31, v43
 v_mfma_f32_16x16x32_bf16 v[84:87], a[20:23], a[172:175], v[84:87]
 v_rcp_f32 v28, v28
 v_mfma_f32_16x16x32_bf16 v[84:87], a[4:7], a[168:171], v[84:87]
 ds_read_b64_tr_b16 a[98:99], v46 offset:4352
 v_fma_f32 v32, v32, v28, -v28
 v_mfma_f32_16x16x32_bf16 v[88:91], a[8:11], a[168:171], 0
 v_rcp_f32 v29, v29
 v_mfma_f32_16x16x32_bf16 v[88:91], a[24:27], a[172:175], v[88:91]
 s_add_u32 m0, s29, 0
 ds_read_b64_tr_b16 a[100:101], v46 offset:4104
 v_fma_f32 v33, v33, v29, -v29
 v_mfma_f32_16x16x32_bf16 v[88:91], a[40:43], a[176:179], v[88:91]
 s_waitcnt lgkmcnt(3)
 buffer_load_dwordx4 v5, s[8:11], s76 offen offset:0 lds
 v_cvt_pk_bf16_f32 v18, v32, v33
 v_mfma_f32_16x16x32_bf16 v[88:91], a[56:59], a[180:183], v[88:91]
 ds_read_b64_tr_b16 a[102:103], v46 offset:4360
 v_mul_f32 v21, s42, v209
 v_mfma_f32_16x16x32_bf16 v[88:91], a[72:75], a[184:187], v[88:91]
 v_rcp_f32 v30, v30
 v_mfma_f32_16x16x32_bf16 v[92:95], a[76:79], a[184:187], 0
 s_waitcnt vmcnt(19)
 ds_read_b64_tr_b16 a[112:113], v46 offset:8192
 v_fma_f32 v34, v34, v30, -v30
 v_mfma_f32_16x16x32_bf16 v[92:95], a[60:63], a[180:183], v[92:95]
 v_rcp_f32 v31, v31
 v_mfma_f32_16x16x32_bf16 v[92:95], a[44:47], a[176:179], v[92:95]
 ds_read_b64_tr_b16 a[114:115], v46 offset:8448
 v_fma_f32 v35, v35, v31, -v31
 v_mfma_f32_16x16x32_bf16 v[92:95], a[28:31], a[172:175], v[92:95]
 s_add_u32 s46, s40, 3072
 v_cvt_pk_bf16_f32 v19, v34, v35
 buffer_store_dwordx4 v[16:19], v6, s[12:15], s46 offen
 v_mfma_f32_16x16x32_bf16 v[92:95], a[12:15], a[168:171], v[92:95]
 ds_read_b64_tr_b16 a[116:117], v46 offset:8200
 v_mul_f32 v22, s42, v210
 v_mfma_f32_16x16x32_bf16 v[108:111], a[12:15], a[172:175], 0
 v_mul_f32 v23, s42, v211
 v_min_f32 v20, s47, v20
 v_mfma_f32_16x16x32_bf16 v[108:111], a[28:31], a[176:179], v[108:111]
 ds_read_b64_tr_b16 a[118:119], v46 offset:8456
 v_min_f32 v21, s47, v21
 v_mfma_f32_16x16x32_bf16 v[108:111], a[44:47], a[180:183], v[108:111]
 v_min_f32 v22, s47, v22
 v_min_f32 v23, s47, v23
 v_mfma_f32_16x16x32_bf16 v[108:111], a[60:63], a[184:187], v[108:111]
 s_waitcnt vmcnt(18)
 ds_read_b128 a[200:203], v3 offset:10880
 ds_read_b64_tr_b16 a[128:129], v46 offset:12288
 v_mfma_f32_16x16x32_bf16 v[108:111], a[76:79], a[188:191], v[108:111]
 s_add_u32 m0, s29, 2048
 v_exp_f32 v20, v20
 v_mfma_f32_16x16x32_bf16 v[104:107], a[72:75], a[188:191], 0
 ds_read_b64_tr_b16 a[130:131], v46 offset:12544
 buffer_load_dwordx4 v5, s[8:11], s77 offen offset:0 lds
 v_mfma_f32_16x16x32_bf16 v[104:107], a[56:59], a[184:187], v[104:107]
 v_mul_f32 v24, s43, v216
 v_mul_f32 v25, s43, v217
 v_mfma_f32_16x16x32_bf16 v[104:107], a[40:43], a[180:183], v[104:107]
 ds_read_b64_tr_b16 a[132:133], v46 offset:12296
 v_mul_f32 v26, s43, v218
 v_mfma_f32_16x16x32_bf16 v[104:107], a[24:27], a[176:179], v[104:107]
 v_exp_f32 v21, v21
 v_mfma_f32_16x16x32_bf16 v[104:107], a[8:11], a[172:175], v[104:107]
 ds_read_b64_tr_b16 a[134:135], v46 offset:12552
 v_mul_f32 v27, s43, v219
 v_mfma_f32_16x16x32_bf16 v[100:103], a[4:7], a[172:175], 0
 v_exp_f32 v22, v22
 v_mfma_f32_16x16x32_bf16 v[100:103], a[20:23], a[176:179], v[100:103]
 s_waitcnt vmcnt(17)
 ds_read_b64_tr_b16 a[144:145], v46 offset:16384
 v_add_f32 v28, 1.0, v20
 v_mfma_f32_16x16x32_bf16 v[100:103], a[36:39], a[180:183], v[100:103]
 v_exp_f32 v23, v23
 v_mfma_f32_16x16x32_bf16 v[100:103], a[52:55], a[184:187], v[100:103]
 ds_read_b64_tr_b16 a[146:147], v46 offset:16640
 v_add_f32 v29, 1.0, v21
 v_mfma_f32_16x16x32_bf16 v[100:103], a[68:71], a[188:191], v[100:103]
 v_exp_f32 v24, v24
 v_mfma_f32_16x16x32_bf16 v[96:99], a[64:67], a[188:191], 0
 s_add_u32 m0, s29, 4096
 ds_read_b64_tr_b16 a[148:149], v46 offset:16392
 v_add_f32 v30, 1.0, v22
 v_mfma_f32_16x16x32_bf16 v[96:99], a[48:51], a[184:187], v[96:99]
 s_waitcnt lgkmcnt(6)
 buffer_load_dwordx4 v5, s[8:11], s78 offen offset:0 lds
 v_add_f32 v31, 1.0, v23
 v_mfma_f32_16x16x32_bf16 v[96:99], a[32:35], a[180:183], v[96:99]
 ds_read_b64_tr_b16 a[150:151], v46 offset:16648
 v_fmac_f32 v28, v28, v24
 v_mfma_f32_16x16x32_bf16 v[96:99], a[16:19], a[176:179], v[96:99]
 v_exp_f32 v25, v25
 v_mfma_f32_16x16x32_bf16 v[96:99], a[0:3], a[172:175], v[96:99]
 s_waitcnt vmcnt(16)
 ds_read_b64_tr_b16 a[88:89], v46 offset:1024
 v_fmac_f32 v29, v29, v25
 v_mfma_f32_16x16x32_bf16 v[112:115], a[0:3], a[176:179], 0
 s_add_u32 m0, s26, 2048
 v_exp_f32 v26, v26
 v_mfma_f32_16x16x32_bf16 v[112:115], a[16:19], a[180:183], v[112:115]
 ds_read_b64_tr_b16 a[90:91], v46 offset:1280
 buffer_load_dwordx4 v9, s[4:7], 0 offen nt lds
 v_mfma_f32_16x16x32_bf16 v[112:115], a[32:35], a[184:187], v[112:115]
 v_exp_f32 v27, v27
 v_mfma_f32_16x16x32_bf16 v[112:115], a[48:51], a[188:191], v[112:115]
 ds_read_b128 a[204:207], v3 offset:15232
 ds_read_b64_tr_b16 a[92:93], v46 offset:1032
 v_mfma_f32_16x16x32_bf16 v[112:115], a[64:67], a[192:195], v[112:115]
 v_fmac_f32 v30, v30, v26
 v_fmac_f32 v31, v31, v27
 v_mfma_f32_16x16x32_bf16 v[116:119], a[68:71], a[192:195], 0
 ds_read_b64_tr_b16 a[94:95], v46 offset:1288
 v_mul_f32 v32, s42, v212
 v_mfma_f32_16x16x32_bf16 v[116:119], a[52:55], a[188:191], v[116:119]
 v_rcp_f32 v28, v28
 v_mfma_f32_16x16x32_bf16 v[116:119], a[36:39], a[184:187], v[116:119]
 s_waitcnt vmcnt(14)
 ds_read_b64_tr_b16 a[104:105], v46 offset:5120
 v_fma_f32 v20, v20, v28, -v28
 v_mfma_f32_16x16x32_bf16 v[116:119], a[20:23], a[180:183], v[116:119]
 s_add_u32 m0, s29, 6144
 v_rcp_f32 v29, v29
 v_mfma_f32_16x16x32_bf16 v[116:119], a[4:7], a[176:179], v[116:119]
 ds_read_b64_tr_b16 a[106:107], v46 offset:5376
 buffer_load_dwordx4 v5, s[8:11], s79 offen offset:0 lds
 v_mfma_f32_16x16x32_bf16 v[120:123], a[8:11], a[176:179], 0
 v_rcp_f32 v30, v30
 v_mfma_f32_16x16x32_bf16 v[120:123], a[24:27], a[180:183], v[120:123]
 ds_read_b64_tr_b16 a[108:109], v46 offset:5128
 v_fma_f32 v21, v21, v29, -v29
 v_mfma_f32_16x16x32_bf16 v[120:123], a[40:43], a[184:187], v[120:123]
 v_rcp_f32 v31, v31
 v_mfma_f32_16x16x32_bf16 v[120:123], a[56:59], a[188:191], v[120:123]
 ds_read_b64_tr_b16 a[110:111], v46 offset:5384
 v_fma_f32 v22, v22, v30, -v30
 v_mfma_f32_16x16x32_bf16 v[120:123], a[72:75], a[192:195], v[120:123]
 v_fma_f32 v23, v23, v31, -v31
 v_cvt_pk_bf16_f32 v16, v20, v21
 v_mfma_f32_16x16x32_bf16 v[124:127], a[76:79], a[192:195], 0
 s_waitcnt vmcnt(13)
 ds_read_b64_tr_b16 a[120:121], v46 offset:9216
 v_cvt_pk_bf16_f32 v17, v22, v23
 v_mfma_f32_16x16x32_bf16 v[124:127], a[60:63], a[188:191], v[124:127]
 v_mul_f32 v33, s42, v213
 v_mul_f32 v34, s42, v214
 v_mfma_f32_16x16x32_bf16 v[124:127], a[44:47], a[184:187], v[124:127]
 ds_read_b64_tr_b16 a[122:123], v46 offset:9472
 v_mul_f32 v35, s42, v215
 v_mfma_f32_16x16x32_bf16 v[124:127], a[28:31], a[180:183], v[124:127]
 v_min_f32 v32, s47, v32
 v_min_f32 v33, s47, v33
 v_mfma_f32_16x16x32_bf16 v[124:127], a[12:15], a[176:179], v[124:127]
 ds_read_b128 a[160:163], v2 offset:0
 ds_read_b64_tr_b16 a[124:125], v46 offset:9224
 v_mfma_f32_16x16x32_bf16 v[140:143], a[12:15], a[180:183], 0
 ds_read_b128 a[164:167], v2 offset:4352
 v_min_f32 v34, s47, v34
 v_mfma_f32_16x16x32_bf16 v[140:143], a[28:31], a[184:187], v[140:143]
 s_add_u32 m0, s29, 8192
 ds_read_b128 a[168:171], v2 offset:8704
 ds_read_b64_tr_b16 a[126:127], v46 offset:9480
 v_mfma_f32_16x16x32_bf16 v[140:143], a[44:47], a[188:191], v[140:143]
 ds_read_b128 a[172:175], v2 offset:13056
 buffer_load_dwordx4 v5, s[8:11], s80 offen offset:0 lds
 v_mfma_f32_16x16x32_bf16 v[140:143], a[60:63], a[192:195], v[140:143]
 s_waitcnt vmcnt(12)
 ds_read_b128 a[176:179], v2 offset:17408
 ds_read_b64_tr_b16 a[136:137], v46 offset:13312
 v_mfma_f32_16x16x32_bf16 v[140:143], a[76:79], a[196:199], v[140:143]
 v_min_f32 v35, s47, v35
 v_mul_f32 v40, s43, v220
 v_mfma_f32_16x16x32_bf16 v[136:139], a[72:75], a[196:199], 0
 ds_read_b64_tr_b16 a[138:139], v46 offset:13568
 v_mul_f32 v41, s43, v221
 v_mfma_f32_16x16x32_bf16 v[136:139], a[56:59], a[192:195], v[136:139]
 v_exp_f32 v32, v32
 v_mfma_f32_16x16x32_bf16 v[136:139], a[40:43], a[188:191], v[136:139]
 ds_read_b64_tr_b16 a[140:141], v46 offset:13320
 v_mul_f32 v42, s43, v222
 v_mfma_f32_16x16x32_bf16 v[136:139], a[24:27], a[184:187], v[136:139]
 v_exp_f32 v33, v33
 v_mfma_f32_16x16x32_bf16 v[136:139], a[8:11], a[180:183], v[136:139]
 ds_read_b64_tr_b16 a[142:143], v46 offset:13576
 v_mul_f32 v43, s43, v223
 v_mfma_f32_16x16x32_bf16 v[132:135], a[4:7], a[180:183], 0
 v_exp_f32 v34, v34
 v_mfma_f32_16x16x32_bf16 v[132:135], a[20:23], a[184:187], v[132:135]
 s_waitcnt vmcnt(10)
 ds_read_b64_tr_b16 a[152:153], v46 offset:17408
 v_add_f32 v28, 1.0, v32
 v_mfma_f32_16x16x32_bf16 v[132:135], a[36:39], a[188:191], v[132:135]
 v_exp_f32 v35, v35
 v_mfma_f32_16x16x32_bf16 v[132:135], a[52:55], a[192:195], v[132:135]
 s_add_u32 m0, s29, 10240
 ds_read_b64_tr_b16 a[154:155], v46 offset:17664
 v_add_f32 v29, 1.0, v33
 v_mfma_f32_16x16x32_bf16 v[132:135], a[68:71], a[196:199], v[132:135]
 buffer_load_dwordx4 v5, s[8:11], s81 offen offset:0 lds
 v_add_f32 v30, 1.0, v34
 v_mfma_f32_16x16x32_bf16 v[128:131], a[64:67], a[196:199], 0
 ds_read_b64_tr_b16 a[156:157], v46 offset:17416
 v_add_f32 v31, 1.0, v35
 v_mfma_f32_16x16x32_bf16 v[128:131], a[48:51], a[192:195], v[128:131]
 v_exp_f32 v40, v40
 v_mfma_f32_16x16x32_bf16 v[128:131], a[32:35], a[188:191], v[128:131]
 s_add_u32 m0, s26, 3072
 ds_read_b64_tr_b16 a[158:159], v46 offset:17672
 v_fmac_f32 v28, v28, v40
 v_mfma_f32_16x16x32_bf16 v[128:131], a[16:19], a[184:187], v[128:131]
 buffer_load_dwordx4 v10, s[4:7], 0 offen nt lds
 v_mul_f32 v20, s42, v224
 v_mfma_f32_16x16x32_bf16 v[128:131], a[0:3], a[180:183], v[128:131]
 v_exp_f32 v41, v41
 v_mfma_f32_16x16x32_bf16 v[144:147], a[0:3], a[184:187], 0
 v_exp_f32 v42, v42
 v_mfma_f32_16x16x32_bf16 v[144:147], a[16:19], a[188:191], v[144:147]
 v_exp_f32 v43, v43
 v_mfma_f32_16x16x32_bf16 v[144:147], a[32:35], a[192:195], v[144:147]
 v_fmac_f32 v29, v29, v41
 v_fmac_f32 v30, v30, v42
 v_mfma_f32_16x16x32_bf16 v[144:147], a[48:51], a[196:199], v[144:147]
 ds_read_b128 a[180:183], v2 offset:21760
 v_fmac_f32 v31, v31, v43
 v_mfma_f32_16x16x32_bf16 v[144:147], a[64:67], a[200:203], v[144:147]
 v_rcp_f32 v28, v28
 v_mfma_f32_16x16x32_bf16 v[148:151], a[68:71], a[200:203], 0
 s_add_u32 m0, s29, 12288
 v_rcp_f32 v29, v29
 v_mfma_f32_16x16x32_bf16 v[148:151], a[52:55], a[196:199], v[148:151]
 s_waitcnt lgkmcnt(3)
 buffer_load_dwordx4 v5, s[8:11], s82 offen offset:0 lds
 v_fma_f32 v32, v32, v28, -v28
 v_mfma_f32_16x16x32_bf16 v[148:151], a[36:39], a[192:195], v[148:151]
 v_rcp_f32 v30, v30
 v_mfma_f32_16x16x32_bf16 v[148:151], a[20:23], a[188:191], v[148:151]
 v_rcp_f32 v31, v31
 v_mfma_f32_16x16x32_bf16 v[148:151], a[4:7], a[184:187], v[148:151]
 v_fma_f32 v33, v33, v29, -v29
 v_fma_f32 v34, v34, v30, -v30
 v_mfma_f32_16x16x32_bf16 v[152:155], a[8:11], a[184:187], 0
 v_fma_f32 v35, v35, v31, -v31
 v_cvt_pk_bf16_f32 v18, v32, v33
 v_mfma_f32_16x16x32_bf16 v[152:155], a[24:27], a[188:191], v[152:155]
 s_add_u32 s46, s40, 5120
 v_cvt_pk_bf16_f32 v19, v34, v35
 buffer_store_dwordx4 v[16:19], v6, s[12:15], s46 offen
 v_mfma_f32_16x16x32_bf16 v[152:155], a[40:43], a[192:195], v[152:155]
 v_mul_f32 v21, s42, v225
 v_mul_f32 v22, s42, v226
 v_mfma_f32_16x16x32_bf16 v[152:155], a[56:59], a[196:199], v[152:155]
 v_mul_f32 v23, s42, v227
 v_min_f32 v20, s47, v20
 v_mfma_f32_16x16x32_bf16 v[152:155], a[72:75], a[200:203], v[152:155]
 v_min_f32 v21, s47, v21
 v_min_f32 v22, s47, v22
 v_mfma_f32_16x16x32_bf16 v[156:159], a[76:79], a[200:203], 0
 v_min_f32 v23, s47, v23
 v_mul_f32 v24, s43, v232
 v_mfma_f32_16x16x32_bf16 v[156:159], a[60:63], a[196:199], v[156:159]
 v_exp_f32 v20, v20
 v_mfma_f32_16x16x32_bf16 v[156:159], a[44:47], a[192:195], v[156:159]
 s_add_u32 m0, s29, 14336
 v_mul_f32 v25, s43, v233
 v_mul_f32 v26, s43, v234
 v_mfma_f32_16x16x32_bf16 v[156:159], a[28:31], a[188:191], v[156:159]
 buffer_load_dwordx4 v5, s[8:11], s83 offen offset:0 lds
 v_mul_f32 v27, s43, v235
 v_mfma_f32_16x16x32_bf16 v[156:159], a[12:15], a[184:187], v[156:159]
 v_exp_f32 v21, v21
 v_mfma_f32_16x16x32_bf16 v[172:175], a[12:15], a[188:191], 0
 v_exp_f32 v22, v22
 v_mfma_f32_16x16x32_bf16 v[172:175], a[28:31], a[192:195], v[172:175]
 v_exp_f32 v23, v23
 v_mfma_f32_16x16x32_bf16 v[172:175], a[44:47], a[196:199], v[172:175]
 v_exp_f32 v24, v24
 v_mfma_f32_16x16x32_bf16 v[172:175], a[60:63], a[200:203], v[172:175]
 ds_read_b128 a[184:187], v2 offset:26112
 v_add_f32 v28, 1.0, v20
 v_mfma_f32_16x16x32_bf16 v[172:175], a[76:79], a[204:207], v[172:175]
 v_add_f32 v29, 1.0, v21
 v_add_f32 v30, 1.0, v22
 v_mfma_f32_16x16x32_bf16 v[168:171], a[72:75], a[204:207], 0
 v_exp_f32 v25, v25
 v_mfma_f32_16x16x32_bf16 v[168:171], a[56:59], a[200:203], v[168:171]
 v_add_f32 v31, 1.0, v23
 v_fmac_f32 v28, v28, v24
 v_mfma_f32_16x16x32_bf16 v[168:171], a[40:43], a[196:199], v[168:171]
 v_exp_f32 v26, v26
 v_mfma_f32_16x16x32_bf16 v[168:171], a[24:27], a[192:195], v[168:171]
 v_exp_f32 v27, v27
 v_mfma_f32_16x16x32_bf16 v[168:171], a[8:11], a[188:191], v[168:171]
 v_fmac_f32 v29, v29, v25
 v_fmac_f32 v30, v30, v26
 v_mfma_f32_16x16x32_bf16 v[164:167], a[4:7], a[188:191], 0
 s_add_u32 m0, s29, 16384
 v_fmac_f32 v31, v31, v27
 v_mul_f32 v32, s42, v228
 v_mfma_f32_16x16x32_bf16 v[164:167], a[20:23], a[192:195], v[164:167]
 buffer_load_dwordx4 v5, s[8:11], s84 offen offset:0 lds
 v_mul_f32 v33, s42, v229
 v_mfma_f32_16x16x32_bf16 v[164:167], a[36:39], a[196:199], v[164:167]
 v_rcp_f32 v28, v28
 v_mfma_f32_16x16x32_bf16 v[164:167], a[52:55], a[200:203], v[164:167]
 v_rcp_f32 v29, v29
 v_mfma_f32_16x16x32_bf16 v[164:167], a[68:71], a[204:207], v[164:167]
 s_add_u32 m0, s26, 4096
 v_rcp_f32 v30, v30
 v_mfma_f32_16x16x32_bf16 v[160:163], a[64:67], a[204:207], 0
 buffer_load_dwordx4 v11, s[4:7], 0 offen nt lds
 v_fma_f32 v20, v20, v28, -v28
 v_mfma_f32_16x16x32_bf16 v[160:163], a[48:51], a[200:203], v[160:163]
 v_rcp_f32 v31, v31
 v_mfma_f32_16x16x32_bf16 v[160:163], a[32:35], a[196:199], v[160:163]
 v_fma_f32 v21, v21, v29, -v29
 v_fma_f32 v22, v22, v30, -v30
 v_mfma_f32_16x16x32_bf16 v[160:163], a[16:19], a[192:195], v[160:163]
 v_fma_f32 v23, v23, v31, -v31
 v_cvt_pk_bf16_f32 v16, v20, v21
 v_mfma_f32_16x16x32_bf16 v[160:163], a[0:3], a[188:191], v[160:163]
 v_cvt_pk_bf16_f32 v17, v22, v23
 v_mul_f32 v34, s42, v230
 v_mfma_f32_16x16x32_bf16 v[48:51], a[80:83], a[160:163], v[48:51]
 v_mul_f32 v35, s42, v231
 v_min_f32 v32, s47, v32
 v_mfma_f32_16x16x32_bf16 v[48:51], a[96:99], a[164:167], v[48:51]
 v_min_f32 v33, s47, v33
 v_min_f32 v34, s47, v34
 v_mfma_f32_16x16x32_bf16 v[48:51], a[112:115], a[168:171], v[48:51]
 s_add_u32 m0, s29, 18432
 v_min_f32 v35, s47, v35
 v_mul_f32 v40, s43, v236
 v_mfma_f32_16x16x32_bf16 v[48:51], a[128:131], a[172:175], v[48:51]
 ds_read_b128 a[204:207], v2 offset:30464
 buffer_load_dwordx4 v5, s[8:11], s85 offen offset:0 lds
 v_mfma_f32_16x16x32_bf16 v[48:51], a[144:147], a[176:179], v[48:51]
 v_exp_f32 v32, v32
 v_mfma_f32_16x16x32_bf16 v[52:55], a[148:151], a[176:179], v[52:55]
 v_mul_f32 v41, s43, v237
 v_mul_f32 v42, s43, v238
 v_mfma_f32_16x16x32_bf16 v[52:55], a[132:135], a[172:175], v[52:55]
 v_exp_f32 v33, v33
 v_mfma_f32_16x16x32_bf16 v[52:55], a[116:119], a[168:171], v[52:55]
 v_mul_f32 v43, s43, v239
 v_add_f32 v28, 1.0, v32
 v_mfma_f32_16x16x32_bf16 v[52:55], a[100:103], a[164:167], v[52:55]
 v_exp_f32 v34, v34
 v_mfma_f32_16x16x32_bf16 v[52:55], a[84:87], a[160:163], v[52:55]
 v_exp_f32 v35, v35
 v_mfma_f32_16x16x32_bf16 v[56:59], a[88:91], a[160:163], v[56:59]
 v_exp_f32 v40, v40
 v_mfma_f32_16x16x32_bf16 v[56:59], a[104:107], a[164:167], v[56:59]
 v_add_f32 v29, 1.0, v33
 v_add_f32 v30, 1.0, v34
 v_mfma_f32_16x16x32_bf16 v[56:59], a[120:123], a[168:171], v[56:59]
 v_exp_f32 v41, v41
 v_mfma_f32_16x16x32_bf16 v[56:59], a[136:139], a[172:175], v[56:59]
 v_add_f32 v31, 1.0, v35
 v_fmac_f32 v28, v28, v40
 v_mfma_f32_16x16x32_bf16 v[56:59], a[152:155], a[176:179], v[56:59]
 s_waitcnt lgkmcnt(1)
 v_exp_f32 v42, v42
 v_mfma_f32_16x16x32_bf16 v[60:63], a[156:159], a[176:179], v[60:63]
 s_add_u32 m0, s29, 0
 v_exp_f32 v43, v43
 v_mfma_f32_16x16x32_bf16 v[60:63], a[140:143], a[172:175], v[60:63]
 buffer_load_dwordx4 v5, s[8:11], s76 offen offset:1024 lds
 v_fmac_f32 v29, v29, v41
 v_mfma_f32_16x16x32_bf16 v[60:63], a[124:127], a[168:171], v[60:63]
 v_fmac_f32 v30, v30, v42
 v_fmac_f32 v31, v31, v43
 v_mfma_f32_16x16x32_bf16 v[60:63], a[108:111], a[164:167], v[60:63]
 v_rcp_f32 v28, v28
 v_mfma_f32_16x16x32_bf16 v[60:63], a[92:95], a[160:163], v[60:63]
 ds_read_b128 a[200:203], v1 offset:2176
 v_fma_f32 v32, v32, v28, -v28
 v_mfma_f32_16x16x32_bf16 v[76:79], a[92:95], a[164:167], v[76:79]
 ds_read_b128 a[196:199], v1 offset:6528
 v_mul_f32 v20, s42, v240
 v_mfma_f32_16x16x32_bf16 v[76:79], a[108:111], a[168:171], v[76:79]
 ds_read_b128 a[192:195], v1 offset:10880
 v_mul_f32 v21, s42, v241
 v_mfma_f32_16x16x32_bf16 v[76:79], a[124:127], a[172:175], v[76:79]
 ds_read_b128 a[188:191], v1 offset:15232
 v_mul_f32 v22, s42, v242
 v_mfma_f32_16x16x32_bf16 v[76:79], a[140:143], a[176:179], v[76:79]
 ds_read_b128 a[160:163], v1 offset:19584
 v_mul_f32 v23, s42, v243
 v_mfma_f32_16x16x32_bf16 v[76:79], a[156:159], a[180:183], v[76:79]
 v_rcp_f32 v29, v29
 v_mfma_f32_16x16x32_bf16 v[72:75], a[152:155], a[180:183], v[72:75]
 v_rcp_f32 v30, v30
 v_mfma_f32_16x16x32_bf16 v[72:75], a[136:139], a[176:179], v[72:75]
 v_rcp_f32 v31, v31
 v_mfma_f32_16x16x32_bf16 v[72:75], a[120:123], a[172:175], v[72:75]
 s_add_u32 m0, s29, 2048
 v_fma_f32 v33, v33, v29, -v29
 v_fma_f32 v34, v34, v30, -v30
 v_mfma_f32_16x16x32_bf16 v[72:75], a[104:107], a[168:171], v[72:75]
 buffer_load_dwordx4 v5, s[8:11], s77 offen offset:1024 lds
 v_fma_f32 v35, v35, v31, -v31
 v_mfma_f32_16x16x32_bf16 v[72:75], a[88:91], a[164:167], v[72:75]
 v_cvt_pk_bf16_f32 v18, v32, v33
 v_cvt_pk_bf16_f32 v19, v34, v35
 v_mfma_f32_16x16x32_bf16 v[68:71], a[84:87], a[164:167], v[68:71]
 s_add_u32 s46, s40, 7168
 buffer_store_dwordx4 v[16:19], v6, s[12:15], s46 offen
 v_min_f32 v20, s47, v20
 v_mfma_f32_16x16x32_bf16 v[68:71], a[100:103], a[168:171], v[68:71]
 s_add_u32 m0, s26, 5120
 v_min_f32 v21, s47, v21
 v_min_f32 v22, s47, v22
 v_mfma_f32_16x16x32_bf16 v[68:71], a[116:119], a[172:175], v[68:71]
 buffer_load_dwordx4 v12, s[4:7], 0 offen nt lds
 v_min_f32 v23, s47, v23
 v_mfma_f32_16x16x32_bf16 v[68:71], a[132:135], a[176:179], v[68:71]
 v_exp_f32 v20, v20
 v_mfma_f32_16x16x32_bf16 v[68:71], a[148:151], a[180:183], v[68:71]
 v_mul_f32 v24, s43, v248
 v_mul_f32 v25, s43, v249
 v_mfma_f32_16x16x32_bf16 v[64:67], a[144:147], a[180:183], v[64:67]
 v_exp_f32 v21, v21
 v_mfma_f32_16x16x32_bf16 v[64:67], a[128:131], a[176:179], v[64:67]
 v_mul_f32 v26, s43, v250
 v_mul_f32 v27, s43, v251
 v_mfma_f32_16x16x32_bf16 v[64:67], a[112:115], a[172:175], v[64:67]
 v_exp_f32 v22, v22
 v_mfma_f32_16x16x32_bf16 v[64:67], a[96:99], a[168:171], v[64:67]
 v_exp_f32 v23, v23
 v_mfma_f32_16x16x32_bf16 v[64:67], a[80:83], a[164:167], v[64:67]
 s_add_u32 m0, s29, 4096
 v_exp_f32 v24, v24
 v_mfma_f32_16x16x32_bf16 v[80:83], a[80:83], a[168:171], v[80:83]
 buffer_load_dwordx4 v5, s[8:11], s78 offen offset:1024 lds
 v_add_f32 v28, 1.0, v20
 v_mfma_f32_16x16x32_bf16 v[80:83], a[96:99], a[172:175], v[80:83]
 v_add_f32 v29, 1.0, v21
 v_add_f32 v30, 1.0, v22
 v_mfma_f32_16x16x32_bf16 v[80:83], a[112:115], a[176:179], v[80:83]
 v_exp_f32 v25, v25
 v_mfma_f32_16x16x32_bf16 v[80:83], a[128:131], a[180:183], v[80:83]
 ds_read_b128 a[164:167], v1 offset:23936
 v_add_f32 v31, 1.0, v23
 v_mfma_f32_16x16x32_bf16 v[80:83], a[144:147], a[184:187], v[80:83]
 v_exp_f32 v26, v26
 v_mfma_f32_16x16x32_bf16 v[84:87], a[148:151], a[184:187], v[84:87]
 v_exp_f32 v27, v27
 v_mfma_f32_16x16x32_bf16 v[84:87], a[132:135], a[180:183], v[84:87]
 v_fmac_f32 v28, v28, v24
 v_fmac_f32 v29, v29, v25
 v_mfma_f32_16x16x32_bf16 v[84:87], a[116:119], a[176:179], v[84:87]
 v_fmac_f32 v30, v30, v26
 v_fmac_f32 v31, v31, v27
 v_mfma_f32_16x16x32_bf16 v[84:87], a[100:103], a[172:175], v[84:87]
 v_rcp_f32 v28, v28
 v_mfma_f32_16x16x32_bf16 v[84:87], a[84:87], a[168:171], v[84:87]
 v_rcp_f32 v29, v29
 v_mfma_f32_16x16x32_bf16 v[88:91], a[88:91], a[168:171], v[88:91]
 v_rcp_f32 v30, v30
 v_mfma_f32_16x16x32_bf16 v[88:91], a[104:107], a[172:175], v[88:91]
 v_rcp_f32 v31, v31
 v_mfma_f32_16x16x32_bf16 v[88:91], a[120:123], a[176:179], v[88:91]
 s_add_u32 m0, s29, 6144
 v_fma_f32 v20, v20, v28, -v28
 v_fma_f32 v21, v21, v29, -v29
 v_mfma_f32_16x16x32_bf16 v[88:91], a[136:139], a[180:183], v[88:91]
 buffer_load_dwordx4 v5, s[8:11], s79 offen offset:1024 lds
 v_fma_f32 v22, v22, v30, -v30
 v_mfma_f32_16x16x32_bf16 v[88:91], a[152:155], a[184:187], v[88:91]
 v_fma_f32 v23, v23, v31, -v31
 v_cvt_pk_bf16_f32 v16, v20, v21
 v_mfma_f32_16x16x32_bf16 v[92:95], a[156:159], a[184:187], v[92:95]
 v_cvt_pk_bf16_f32 v17, v22, v23
 v_mul_f32 v32, s42, v244
 v_mfma_f32_16x16x32_bf16 v[92:95], a[140:143], a[180:183], v[92:95]
 v_mul_f32 v33, s42, v245
 v_mul_f32 v34, s42, v246
 v_mfma_f32_16x16x32_bf16 v[92:95], a[124:127], a[176:179], v[92:95]
 v_mul_f32 v35, s42, v247
 v_min_f32 v32, s47, v32
 v_mfma_f32_16x16x32_bf16 v[92:95], a[108:111], a[172:175], v[92:95]
 v_min_f32 v33, s47, v33
 v_min_f32 v34, s47, v34
 v_mfma_f32_16x16x32_bf16 v[92:95], a[92:95], a[168:171], v[92:95]
 v_min_f32 v35, s47, v35
 v_mul_f32 v40, s43, v252
 v_mfma_f32_16x16x32_bf16 v[108:111], a[92:95], a[172:175], v[108:111]
 v_exp_f32 v32, v32
 v_mfma_f32_16x16x32_bf16 v[108:111], a[108:111], a[176:179], v[108:111]
 v_mul_f32 v41, s43, v253
 v_mul_f32 v42, s43, v254
 v_mfma_f32_16x16x32_bf16 v[108:111], a[124:127], a[180:183], v[108:111]
 v_exp_f32 v33, v33
 v_mfma_f32_16x16x32_bf16 v[108:111], a[140:143], a[184:187], v[108:111]
 s_waitcnt lgkmcnt(0)
 ds_read_b128 a[168:171], v1 offset:28288
 v_mul_f32 v43, s43, v255
 v_mfma_f32_16x16x32_bf16 v[108:111], a[156:159], a[204:207], v[108:111]
 s_add_u32 m0, s29, 8192
 v_exp_f32 v34, v34
 v_mfma_f32_16x16x32_bf16 v[104:107], a[152:155], a[204:207], v[104:107]
 buffer_load_dwordx4 v5, s[8:11], s80 offen offset:1024 lds
 v_add_f32 v28, 1.0, v32
 v_mfma_f32_16x16x32_bf16 v[104:107], a[136:139], a[184:187], v[104:107]
 v_exp_f32 v35, v35
 v_mfma_f32_16x16x32_bf16 v[104:107], a[120:123], a[180:183], v[104:107]
 v_exp_f32 v40, v40
 v_mfma_f32_16x16x32_bf16 v[104:107], a[104:107], a[176:179], v[104:107]
 s_add_u32 m0, s26, 6144
 v_add_f32 v29, 1.0, v33
 v_add_f32 v30, 1.0, v34
 v_mfma_f32_16x16x32_bf16 v[104:107], a[88:91], a[172:175], v[104:107]
 buffer_load_dwordx4 v13, s[4:7], 0 offen nt lds
 v_add_f32 v31, 1.0, v35
 v_mfma_f32_16x16x32_bf16 v[100:103], a[84:87], a[172:175], v[100:103]
 v_exp_f32 v41, v41
 v_mfma_f32_16x16x32_bf16 v[100:103], a[100:103], a[176:179], v[100:103]
 v_exp_f32 v42, v42
 v_mfma_f32_16x16x32_bf16 v[100:103], a[116:119], a[180:183], v[100:103]
 v_exp_f32 v43, v43
 v_mfma_f32_16x16x32_bf16 v[100:103], a[132:135], a[184:187], v[100:103]
 v_fmac_f32 v28, v28, v40
 v_fmac_f32 v29, v29, v41
 v_mfma_f32_16x16x32_bf16 v[100:103], a[148:151], a[204:207], v[100:103]
 v_fmac_f32 v30, v30, v42
 v_fmac_f32 v31, v31, v43
 v_mfma_f32_16x16x32_bf16 v[96:99], a[144:147], a[204:207], v[96:99]
 v_rcp_f32 v28, v28
 v_mfma_f32_16x16x32_bf16 v[96:99], a[128:131], a[184:187], v[96:99]
 v_rcp_f32 v29, v29
 v_mfma_f32_16x16x32_bf16 v[96:99], a[112:115], a[180:183], v[96:99]
 s_add_u32 m0, s29, 10240
 v_rcp_f32 v30, v30
 v_mfma_f32_16x16x32_bf16 v[96:99], a[96:99], a[176:179], v[96:99]
 buffer_load_dwordx4 v5, s[8:11], s81 offen offset:1024 lds
 v_fma_f32 v32, v32, v28, -v28
 v_mfma_f32_16x16x32_bf16 v[96:99], a[80:83], a[172:175], v[96:99]
 v_rcp_f32 v31, v31
 v_mfma_f32_16x16x32_bf16 v[176:179], a[0:3], a[200:203], 0
 v_fma_f32 v33, v33, v29, -v29
 v_fma_f32 v34, v34, v30, -v30
 v_mfma_f32_16x16x32_bf16 v[176:179], a[16:19], a[196:199], v[176:179]
 v_fma_f32 v35, v35, v31, -v31
 v_cvt_pk_bf16_f32 v18, v32, v33
 v_mfma_f32_16x16x32_bf16 v[176:179], a[32:35], a[192:195], v[176:179]
 s_add_u32 s46, s40, 9216
 v_cvt_pk_bf16_f32 v19, v34, v35
 buffer_store_dwordx4 v[16:19], v6, s[12:15], s46 offen
 v_mfma_f32_16x16x32_bf16 v[176:179], a[48:51], a[188:191], v[176:179]
 ds_read_b128 a[204:207], v3 offset:0
 v_accvgpr_read_b32 v20, a208
 v_mfma_f32_16x16x32_bf16 v[176:179], a[64:67], a[160:163], v[176:179]
 v_accvgpr_read_b32 v24, a216
 v_accvgpr_read_b32 v21, a209
 v_mfma_f32_16x16x32_bf16 v[180:183], a[68:71], a[160:163], 0
 v_accvgpr_read_b32 v25, a217
 v_accvgpr_read_b32 v22, a210
 v_mfma_f32_16x16x32_bf16 v[180:183], a[52:55], a[188:191], v[180:183]
 v_accvgpr_read_b32 v26, a218
 v_accvgpr_read_b32 v23, a211
 v_mfma_f32_16x16x32_bf16 v[180:183], a[36:39], a[192:195], v[180:183]
 v_accvgpr_read_b32 v27, a219
 v_mul_f32 v20, s42, v20
 v_mfma_f32_16x16x32_bf16 v[180:183], a[20:23], a[196:199], v[180:183]
 v_mul_f32 v21, s42, v21
 v_mul_f32 v22, s42, v22
 v_mfma_f32_16x16x32_bf16 v[180:183], a[4:7], a[200:203], v[180:183]
 s_add_u32 m0, s29, 12288
 v_mul_f32 v23, s42, v23
 v_min_f32 v20, s47, v20
 v_mfma_f32_16x16x32_bf16 v[184:187], a[8:11], a[200:203], 0
 buffer_load_dwordx4 v5, s[8:11], s82 offen offset:1024 lds
 v_min_f32 v21, s47, v21
 v_mfma_f32_16x16x32_bf16 v[184:187], a[24:27], a[196:199], v[184:187]
 v_min_f32 v22, s47, v22
 v_min_f32 v23, s47, v23
 v_mfma_f32_16x16x32_bf16 v[184:187], a[40:43], a[192:195], v[184:187]
 v_exp_f32 v20, v20
 v_mfma_f32_16x16x32_bf16 v[184:187], a[56:59], a[188:191], v[184:187]
 v_mul_f32 v24, s43, v24
 v_mul_f32 v25, s43, v25
 v_mfma_f32_16x16x32_bf16 v[184:187], a[72:75], a[160:163], v[184:187]
 v_exp_f32 v21, v21
 v_mfma_f32_16x16x32_bf16 v[188:191], a[76:79], a[160:163], 0
 v_mul_f32 v26, s43, v26
 v_mul_f32 v27, s43, v27
 v_mfma_f32_16x16x32_bf16 v[188:191], a[60:63], a[188:191], v[188:191]
 v_exp_f32 v22, v22
 v_mfma_f32_16x16x32_bf16 v[188:191], a[44:47], a[192:195], v[188:191]
 v_exp_f32 v23, v23
 v_mfma_f32_16x16x32_bf16 v[188:191], a[28:31], a[196:199], v[188:191]
 v_exp_f32 v24, v24
 v_mfma_f32_16x16x32_bf16 v[188:191], a[12:15], a[200:203], v[188:191]
 v_add_f32 v28, 1.0, v20
 v_add_f32 v29, 1.0, v21
 v_mfma_f32_16x16x32_bf16 v[204:207], a[12:15], a[196:199], 0
 v_exp_f32 v25, v25
 v_mfma_f32_16x16x32_bf16 v[204:207], a[28:31], a[192:195], v[204:207]
 s_add_u32 m0, s29, 14336
 v_add_f32 v30, 1.0, v22
 v_add_f32 v31, 1.0, v23
 v_mfma_f32_16x16x32_bf16 v[204:207], a[44:47], a[188:191], v[204:207]
 buffer_load_dwordx4 v5, s[8:11], s83 offen offset:1024 lds
 v_fmac_f32 v28, v28, v24
 v_mfma_f32_16x16x32_bf16 v[204:207], a[60:63], a[160:163], v[204:207]
 ds_read_b128 a[184:187], v3 offset:4352
 v_fmac_f32 v29, v29, v25
 v_mfma_f32_16x16x32_bf16 v[204:207], a[76:79], a[164:167], v[204:207]
 v_exp_f32 v26, v26
 v_mfma_f32_16x16x32_bf16 v[200:203], a[72:75], a[164:167], 0
 s_add_u32 m0, s26, 7168
 v_exp_f32 v27, v27
 v_mfma_f32_16x16x32_bf16 v[200:203], a[56:59], a[160:163], v[200:203]
 buffer_load_dwordx4 v14, s[4:7], 0 offen nt lds
 v_fmac_f32 v30, v30, v26
 v_mfma_f32_16x16x32_bf16 v[200:203], a[40:43], a[188:191], v[200:203]
 s_add_u32 s4, s4, 128
 s_addc_u32 s5, s5, 0
 s_xor_b32 s26, s26, 0x10000
 v_mfma_f32_16x16x32_bf16 v[200:203], a[24:27], a[192:195], v[200:203]
 s_xor_b32 s27, s27, s31
 v_fmac_f32 v31, v31, v27
 v_accvgpr_read_b32 v32, a212
 v_mfma_f32_16x16x32_bf16 v[200:203], a[8:11], a[196:199], v[200:203]
 v_rcp_f32 v28, v28
 v_mfma_f32_16x16x32_bf16 v[196:199], a[4:7], a[196:199], 0
 v_rcp_f32 v29, v29
 v_mfma_f32_16x16x32_bf16 v[196:199], a[20:23], a[192:195], v[196:199]
 v_rcp_f32 v30, v30
 v_mfma_f32_16x16x32_bf16 v[196:199], a[36:39], a[188:191], v[196:199]
 v_rcp_f32 v31, v31
 v_mfma_f32_16x16x32_bf16 v[196:199], a[52:55], a[160:163], v[196:199]
 v_fma_f32 v20, v20, v28, -v28
 v_fma_f32 v21, v21, v29, -v29
 v_mfma_f32_16x16x32_bf16 v[196:199], a[68:71], a[164:167], v[196:199]
 s_add_u32 m0, s29, 16384
 v_fma_f32 v22, v22, v30, -v30
 v_fma_f32 v23, v23, v31, -v31
 v_mfma_f32_16x16x32_bf16 v[192:195], a[64:67], a[164:167], 0
 buffer_load_dwordx4 v5, s[8:11], s84 offen offset:1024 lds
 v_cvt_pk_bf16_f32 v16, v20, v21
 v_mfma_f32_16x16x32_bf16 v[192:195], a[48:51], a[160:163], v[192:195]
 v_cvt_pk_bf16_f32 v17, v22, v23
 v_accvgpr_read_b32 v40, a220
 v_mfma_f32_16x16x32_bf16 v[192:195], a[32:35], a[188:191], v[192:195]
 v_accvgpr_read_b32 v33, a213
 v_accvgpr_read_b32 v41, a221
 v_mfma_f32_16x16x32_bf16 v[192:195], a[16:19], a[192:195], v[192:195]
 v_accvgpr_read_b32 v34, a214
 v_accvgpr_read_b32 v42, a222
 v_mfma_f32_16x16x32_bf16 v[192:195], a[0:3], a[196:199], v[192:195]
 v_accvgpr_read_b32 v35, a215
 v_accvgpr_read_b32 v43, a223
 v_mfma_f32_16x16x32_bf16 v[208:211], a[0:3], a[192:195], 0
 v_mul_f32 v32, s42, v32
 v_mul_f32 v33, s42, v33
 v_mfma_f32_16x16x32_bf16 v[208:211], a[16:19], a[188:191], v[208:211]
 v_mul_f32 v34, s42, v34
 v_mul_f32 v35, s42, v35
 v_mfma_f32_16x16x32_bf16 v[208:211], a[32:35], a[160:163], v[208:211]
 v_min_f32 v32, s47, v32
 v_min_f32 v33, s47, v33
 v_mfma_f32_16x16x32_bf16 v[208:211], a[48:51], a[164:167], v[208:211]
 s_waitcnt lgkmcnt(0)
 ds_read_b128 a[180:183], v3 offset:8704
 v_min_f32 v34, s47, v34
 v_mfma_f32_16x16x32_bf16 v[208:211], a[64:67], a[168:171], v[208:211]
 v_min_f32 v35, s47, v35
 v_mul_f32 v40, s43, v40
 v_mfma_f32_16x16x32_bf16 v[212:215], a[68:71], a[168:171], 0
 v_exp_f32 v32, v32
 v_mfma_f32_16x16x32_bf16 v[212:215], a[52:55], a[164:167], v[212:215]
 s_add_u32 m0, s29, 18432
 v_mul_f32 v41, s43, v41
 v_mul_f32 v42, s43, v42
 v_mfma_f32_16x16x32_bf16 v[212:215], a[36:39], a[160:163], v[212:215]
 buffer_load_dwordx4 v5, s[8:11], s85 offen offset:1024 lds
 v_mul_f32 v43, s43, v43
 v_mfma_f32_16x16x32_bf16 v[212:215], a[20:23], a[188:191], v[212:215]
 s_add_u32 s8, s8, 0x10000
 s_addc_u32 s9, s9, 0
 v_add_f32 v28, 1.0, v32
 v_mfma_f32_16x16x32_bf16 v[212:215], a[4:7], a[192:195], v[212:215]
 v_exp_f32 v33, v33
 v_mfma_f32_16x16x32_bf16 v[216:219], a[8:11], a[192:195], 0
 v_exp_f32 v34, v34
 v_mfma_f32_16x16x32_bf16 v[216:219], a[24:27], a[188:191], v[216:219]
 v_exp_f32 v35, v35
 v_mfma_f32_16x16x32_bf16 v[216:219], a[40:43], a[160:163], v[216:219]
 v_exp_f32 v40, v40
 v_mfma_f32_16x16x32_bf16 v[216:219], a[56:59], a[164:167], v[216:219]
 v_add_f32 v29, 1.0, v33
 v_add_f32 v30, 1.0, v34
 v_mfma_f32_16x16x32_bf16 v[216:219], a[72:75], a[168:171], v[216:219]
 v_exp_f32 v41, v41
 v_mfma_f32_16x16x32_bf16 v[220:223], a[76:79], a[168:171], 0
 v_add_f32 v31, 1.0, v35
 v_fmac_f32 v28, v28, v40
 v_mfma_f32_16x16x32_bf16 v[220:223], a[60:63], a[164:167], v[220:223]
 v_exp_f32 v42, v42
 v_mfma_f32_16x16x32_bf16 v[220:223], a[44:47], a[160:163], v[220:223]
 v_exp_f32 v43, v43
 v_mfma_f32_16x16x32_bf16 v[220:223], a[28:31], a[188:191], v[220:223]
 v_fmac_f32 v29, v29, v41
 v_fmac_f32 v30, v30, v42
 v_mfma_f32_16x16x32_bf16 v[220:223], a[12:15], a[192:195], v[220:223]
 v_fmac_f32 v31, v31, v43
 v_accvgpr_read_b32 v20, a224
 v_mfma_f32_16x16x32_bf16 v[236:239], a[12:15], a[188:191], 0
 v_rcp_f32 v28, v28
 v_mfma_f32_16x16x32_bf16 v[236:239], a[28:31], a[160:163], v[236:239]
 v_rcp_f32 v29, v29
 v_mfma_f32_16x16x32_bf16 v[236:239], a[44:47], a[164:167], v[236:239]
 v_rcp_f32 v30, v30
 v_mfma_f32_16x16x32_bf16 v[236:239], a[60:63], a[168:171], v[236:239]
 ds_read_b128 a[176:179], v3 offset:13056
 v_fma_f32 v32, v32, v28, -v28
 v_mfma_f32_16x16x32_bf16 v[236:239], a[76:79], a[204:207], v[236:239]
 v_rcp_f32 v31, v31
 v_mfma_f32_16x16x32_bf16 v[232:235], a[72:75], a[204:207], 0
 v_fma_f32 v33, v33, v29, -v29
 v_fma_f32 v34, v34, v30, -v30
 v_mfma_f32_16x16x32_bf16 v[232:235], a[56:59], a[168:171], v[232:235]
 v_fma_f32 v35, v35, v31, -v31
 v_cvt_pk_bf16_f32 v18, v32, v33
 v_mfma_f32_16x16x32_bf16 v[232:235], a[40:43], a[164:167], v[232:235]
 s_add_u32 s46, s40, 11264
 v_cvt_pk_bf16_f32 v19, v34, v35
 buffer_store_dwordx4 v[16:19], v6, s[12:15], s46 offen
 v_mfma_f32_16x16x32_bf16 v[232:235], a[24:27], a[160:163], v[232:235]
 v_accvgpr_read_b32 v24, a232
 v_accvgpr_read_b32 v21, a225
 v_mfma_f32_16x16x32_bf16 v[232:235], a[8:11], a[188:191], v[232:235]
 v_accvgpr_read_b32 v25, a233
 v_accvgpr_read_b32 v22, a226
 v_mfma_f32_16x16x32_bf16 v[228:231], a[4:7], a[188:191], 0
 v_accvgpr_read_b32 v26, a234
 v_accvgpr_read_b32 v23, a227
 v_mfma_f32_16x16x32_bf16 v[228:231], a[20:23], a[160:163], v[228:231]
 v_accvgpr_read_b32 v27, a235
 v_mul_f32 v20, s42, v20
 v_mfma_f32_16x16x32_bf16 v[228:231], a[36:39], a[164:167], v[228:231]
 v_mul_f32 v21, s42, v21
 v_mul_f32 v22, s42, v22
 v_mfma_f32_16x16x32_bf16 v[228:231], a[52:55], a[168:171], v[228:231]
 v_mul_f32 v23, s42, v23
 v_min_f32 v20, s47, v20
 v_mfma_f32_16x16x32_bf16 v[228:231], a[68:71], a[204:207], v[228:231]
 v_min_f32 v21, s47, v21
 v_min_f32 v22, s47, v22
 v_mfma_f32_16x16x32_bf16 v[224:227], a[64:67], a[204:207], 0
 v_min_f32 v23, s47, v23
 v_mul_f32 v24, s43, v24
 v_mfma_f32_16x16x32_bf16 v[224:227], a[48:51], a[168:171], v[224:227]
 v_exp_f32 v20, v20
 v_mfma_f32_16x16x32_bf16 v[224:227], a[32:35], a[164:167], v[224:227]
 v_mul_f32 v25, s43, v25
 v_mul_f32 v26, s43, v26
 v_mfma_f32_16x16x32_bf16 v[224:227], a[16:19], a[160:163], v[224:227]
 v_exp_f32 v21, v21
 v_mfma_f32_16x16x32_bf16 v[224:227], a[0:3], a[188:191], v[224:227]
 ds_read_b128 a[172:175], v2 offset:17408
 v_mul_f32 v27, s43, v27
 v_mfma_f32_16x16x32_bf16 v[240:243], a[0:3], a[160:163], 0
 ds_read_b128 a[200:203], v2 offset:21760
 v_add_f32 v28, 1.0, v20
 v_mfma_f32_16x16x32_bf16 v[240:243], a[16:19], a[164:167], v[240:243]
 ds_read_b128 a[196:199], v2 offset:26112
 v_add_f32 v29, 1.0, v21
 v_mfma_f32_16x16x32_bf16 v[240:243], a[32:35], a[168:171], v[240:243]
 ds_read_b128 a[192:195], v2 offset:30464
 v_accvgpr_read_b32 v32, a228
 v_mfma_f32_16x16x32_bf16 v[240:243], a[48:51], a[204:207], v[240:243]
 ds_read_b128 a[188:191], v4 offset:2176
 v_accvgpr_read_b32 v40, a236
 v_mfma_f32_16x16x32_bf16 v[240:243], a[64:67], a[184:187], v[240:243]
 v_exp_f32 v22, v22
 v_mfma_f32_16x16x32_bf16 v[244:247], a[68:71], a[184:187], 0
 v_exp_f32 v23, v23
 v_mfma_f32_16x16x32_bf16 v[244:247], a[52:55], a[204:207], v[244:247]
 v_exp_f32 v24, v24
 v_mfma_f32_16x16x32_bf16 v[244:247], a[36:39], a[168:171], v[244:247]
 v_exp_f32 v25, v25
 v_mfma_f32_16x16x32_bf16 v[244:247], a[20:23], a[164:167], v[244:247]
 v_add_f32 v30, 1.0, v22
 v_add_f32 v31, 1.0, v23
 v_mfma_f32_16x16x32_bf16 v[244:247], a[4:7], a[160:163], v[244:247]
 v_exp_f32 v26, v26
 v_mfma_f32_16x16x32_bf16 v[248:251], a[8:11], a[160:163], 0
 v_exp_f32 v27, v27
 v_mfma_f32_16x16x32_bf16 v[248:251], a[24:27], a[164:167], v[248:251]
 v_fmac_f32 v28, v28, v24
 v_fmac_f32 v29, v29, v25
 v_mfma_f32_16x16x32_bf16 v[248:251], a[40:43], a[168:171], v[248:251]
 v_fmac_f32 v30, v30, v26
 v_fmac_f32 v31, v31, v27
 v_mfma_f32_16x16x32_bf16 v[248:251], a[56:59], a[204:207], v[248:251]
 v_rcp_f32 v28, v28
 v_mfma_f32_16x16x32_bf16 v[248:251], a[72:75], a[184:187], v[248:251]
 v_rcp_f32 v29, v29
 v_mfma_f32_16x16x32_bf16 v[252:255], a[76:79], a[184:187], 0
 v_rcp_f32 v30, v30
 v_mfma_f32_16x16x32_bf16 v[252:255], a[60:63], a[204:207], v[252:255]
 v_rcp_f32 v31, v31
 v_mfma_f32_16x16x32_bf16 v[252:255], a[44:47], a[168:171], v[252:255]
 v_fma_f32 v20, v20, v28, -v28
 v_fma_f32 v21, v21, v29, -v29
 v_mfma_f32_16x16x32_bf16 v[252:255], a[28:31], a[164:167], v[252:255]
 v_fma_f32 v22, v22, v30, -v30
 v_fma_f32 v23, v23, v31, -v31
 v_mfma_f32_16x16x32_bf16 v[252:255], a[12:15], a[160:163], v[252:255]
 v_cvt_pk_bf16_f32 v16, v20, v21
 v_cvt_pk_bf16_f32 v17, v22, v23
 v_mfma_f32_16x16x32_bf16 a[220:223], a[12:15], a[164:167], 0
 v_accvgpr_read_b32 v33, a229
 v_accvgpr_read_b32 v41, a237
 v_mfma_f32_16x16x32_bf16 a[220:223], a[28:31], a[168:171], a[220:223]
 v_accvgpr_read_b32 v34, a230
 v_accvgpr_read_b32 v42, a238
 v_mfma_f32_16x16x32_bf16 a[220:223], a[44:47], a[204:207], a[220:223]
 v_accvgpr_read_b32 v35, a231
 v_accvgpr_read_b32 v43, a239
 v_mfma_f32_16x16x32_bf16 a[220:223], a[60:63], a[184:187], a[220:223]
 s_waitcnt lgkmcnt(0)
 ds_read_b128 a[160:163], v4 offset:6528
 v_mul_f32 v32, s42, v32
 v_mfma_f32_16x16x32_bf16 a[220:223], a[76:79], a[180:183], a[220:223]
 v_mul_f32 v33, s42, v33
 v_mul_f32 v34, s42, v34
 v_mfma_f32_16x16x32_bf16 a[216:219], a[72:75], a[180:183], 0
 v_mul_f32 v35, s42, v35
 v_min_f32 v32, s47, v32
 v_mfma_f32_16x16x32_bf16 a[216:219], a[56:59], a[184:187], a[216:219]
 v_min_f32 v33, s47, v33
 v_min_f32 v34, s47, v34
 v_mfma_f32_16x16x32_bf16 a[216:219], a[40:43], a[204:207], a[216:219]
 v_min_f32 v35, s47, v35
 v_mul_f32 v40, s43, v40
 v_mfma_f32_16x16x32_bf16 a[216:219], a[24:27], a[168:171], a[216:219]
 v_exp_f32 v32, v32
 v_mfma_f32_16x16x32_bf16 a[216:219], a[8:11], a[164:167], a[216:219]
 v_mul_f32 v41, s43, v41
 v_mul_f32 v42, s43, v42
 v_mfma_f32_16x16x32_bf16 a[212:215], a[4:7], a[164:167], 0
 v_exp_f32 v33, v33
 v_mfma_f32_16x16x32_bf16 a[212:215], a[20:23], a[168:171], a[212:215]
 v_mul_f32 v43, s43, v43
 v_add_f32 v28, 1.0, v32
 v_mfma_f32_16x16x32_bf16 a[212:215], a[36:39], a[204:207], a[212:215]
 v_exp_f32 v34, v34
 v_mfma_f32_16x16x32_bf16 a[212:215], a[52:55], a[184:187], a[212:215]
 v_exp_f32 v35, v35
 v_mfma_f32_16x16x32_bf16 a[212:215], a[68:71], a[180:183], a[212:215]
 v_exp_f32 v40, v40
 v_mfma_f32_16x16x32_bf16 a[208:211], a[64:67], a[180:183], 0
 v_add_f32 v29, 1.0, v33
 v_add_f32 v30, 1.0, v34
 v_mfma_f32_16x16x32_bf16 a[208:211], a[48:51], a[184:187], a[208:211]
 v_exp_f32 v41, v41
 v_mfma_f32_16x16x32_bf16 a[208:211], a[32:35], a[204:207], a[208:211]
 v_add_f32 v31, 1.0, v35
 v_fmac_f32 v28, v28, v40
 v_mfma_f32_16x16x32_bf16 a[208:211], a[16:19], a[168:171], a[208:211]
 v_exp_f32 v42, v42
 v_mfma_f32_16x16x32_bf16 a[208:211], a[0:3], a[164:167], a[208:211]
 v_exp_f32 v43, v43
 v_mfma_f32_16x16x32_bf16 a[224:227], a[0:3], a[168:171], 0
 s_waitcnt vmcnt(7)
 ds_read_b64_tr_b16 a[0:1], v46 offset:0
 v_fmac_f32 v29, v29, v41
 v_mfma_f32_16x16x32_bf16 a[224:227], a[16:19], a[204:207], a[224:227]
 v_fmac_f32 v30, v30, v42
 v_fmac_f32 v31, v31, v43
 v_mfma_f32_16x16x32_bf16 a[224:227], a[32:35], a[184:187], a[224:227]
 v_rcp_f32 v28, v28
 v_mfma_f32_16x16x32_bf16 a[224:227], a[48:51], a[180:183], a[224:227]
 ds_read_b128 a[164:167], v4 offset:10880
 ds_read_b64_tr_b16 a[2:3], v46 offset:256
 v_mfma_f32_16x16x32_bf16 a[224:227], a[64:67], a[176:179], a[224:227]
 v_rcp_f32 v29, v29
 v_mfma_f32_16x16x32_bf16 a[228:231], a[68:71], a[176:179], 0
 v_rcp_f32 v30, v30
 v_mfma_f32_16x16x32_bf16 a[228:231], a[52:55], a[180:183], a[228:231]
 v_rcp_f32 v31, v31
 v_mfma_f32_16x16x32_bf16 a[228:231], a[36:39], a[184:187], a[228:231]
 v_fma_f32 v32, v32, v28, -v28
 v_fma_f32 v33, v33, v29, -v29
 v_mfma_f32_16x16x32_bf16 a[228:231], a[20:23], a[204:207], a[228:231]
 v_fma_f32 v34, v34, v30, -v30
 v_fma_f32 v35, v35, v31, -v31
 v_mfma_f32_16x16x32_bf16 a[228:231], a[4:7], a[168:171], a[228:231]
 ds_read_b64_tr_b16 a[4:5], v46 offset:8
 v_cvt_pk_bf16_f32 v18, v32, v33
 v_mfma_f32_16x16x32_bf16 a[232:235], a[8:11], a[168:171], 0
 s_add_u32 s46, s40, 13312
 v_cvt_pk_bf16_f32 v19, v34, v35
 buffer_store_dwordx4 v[16:19], v6, s[12:15], s46 offen
 v_mfma_f32_16x16x32_bf16 a[232:235], a[24:27], a[204:207], a[232:235]
 v_accvgpr_read_b32 v20, a240
 v_accvgpr_read_b32 v24, a248
 v_mfma_f32_16x16x32_bf16 a[232:235], a[40:43], a[184:187], a[232:235]
 ds_read_b64_tr_b16 a[6:7], v46 offset:264
 v_accvgpr_read_b32 v21, a241
 v_mfma_f32_16x16x32_bf16 a[232:235], a[56:59], a[180:183], a[232:235]
 v_accvgpr_read_b32 v25, a249
 v_accvgpr_read_b32 v22, a242
 v_mfma_f32_16x16x32_bf16 a[232:235], a[72:75], a[176:179], a[232:235]
 v_accvgpr_read_b32 v26, a250
 v_accvgpr_read_b32 v23, a243
 v_mfma_f32_16x16x32_bf16 a[236:239], a[76:79], a[176:179], 0
 ds_read_b64_tr_b16 a[16:17], v46 offset:4096
 v_accvgpr_read_b32 v27, a251
 v_mfma_f32_16x16x32_bf16 a[236:239], a[60:63], a[180:183], a[236:239]
 v_mul_f32 v20, s42, v20
 v_mul_f32 v21, s42, v21
 v_mfma_f32_16x16x32_bf16 a[236:239], a[44:47], a[184:187], a[236:239]
 v_mul_f32 v22, s42, v22
 v_mul_f32 v23, s42, v23
 v_mfma_f32_16x16x32_bf16 a[236:239], a[28:31], a[204:207], a[236:239]
 s_add_u32 m0, s29, 0
 ds_read_b64_tr_b16 a[18:19], v46 offset:4352
 v_min_f32 v20, s47, v20
 v_mfma_f32_16x16x32_bf16 a[236:239], a[12:15], a[168:171], a[236:239]
 s_waitcnt lgkmcnt(2)
 buffer_load_dwordx4 v5, s[8:11], s76 offen offset:0 lds
 v_min_f32 v21, s47, v21
 v_mfma_f32_16x16x32_bf16 v[112:115], a[80:83], a[172:175], v[112:115]
 v_min_f32 v22, s47, v22
 v_min_f32 v23, s47, v23
 v_mfma_f32_16x16x32_bf16 v[112:115], a[96:99], a[200:203], v[112:115]
 ds_read_b64_tr_b16 a[20:21], v46 offset:4104
 v_mul_f32 v24, s43, v24
 v_mfma_f32_16x16x32_bf16 v[112:115], a[112:115], a[196:199], v[112:115]
 v_exp_f32 v20, v20
 v_mfma_f32_16x16x32_bf16 v[112:115], a[128:131], a[192:195], v[112:115]
 ds_read_b128 a[176:179], v4 offset:15232
 v_mul_f32 v25, s43, v25
 v_mfma_f32_16x16x32_bf16 v[112:115], a[144:147], a[188:191], v[112:115]
 ds_read_b64_tr_b16 a[22:23], v46 offset:4360
 v_mul_f32 v26, s43, v26
 v_mfma_f32_16x16x32_bf16 v[116:119], a[148:151], a[188:191], v[116:119]
 v_exp_f32 v21, v21
 v_mfma_f32_16x16x32_bf16 v[116:119], a[132:135], a[192:195], v[116:119]
 v_mul_f32 v27, s43, v27
 v_add_f32 v28, 1.0, v20
 v_mfma_f32_16x16x32_bf16 v[116:119], a[116:119], a[196:199], v[116:119]
 s_add_u32 m0, s29, 2048
 ds_read_b64_tr_b16 a[32:33], v46 offset:8192
 v_add_f32 v29, 1.0, v21
 v_mfma_f32_16x16x32_bf16 v[116:119], a[100:103], a[200:203], v[116:119]
 buffer_load_dwordx4 v5, s[8:11], s77 offen offset:0 lds
 v_accvgpr_read_b32 v32, a244
 v_mfma_f32_16x16x32_bf16 v[116:119], a[84:87], a[172:175], v[116:119]
 v_exp_f32 v22, v22
 v_mfma_f32_16x16x32_bf16 v[120:123], a[88:91], a[172:175], v[120:123]
 ds_read_b64_tr_b16 a[34:35], v46 offset:8448
 v_add_f32 v30, 1.0, v22
 v_mfma_f32_16x16x32_bf16 v[120:123], a[104:107], a[200:203], v[120:123]
 v_exp_f32 v23, v23
 v_mfma_f32_16x16x32_bf16 v[120:123], a[120:123], a[196:199], v[120:123]
 v_exp_f32 v24, v24
 v_mfma_f32_16x16x32_bf16 v[120:123], a[136:139], a[192:195], v[120:123]
 ds_read_b64_tr_b16 a[36:37], v46 offset:8200
 v_add_f32 v31, 1.0, v23
 v_mfma_f32_16x16x32_bf16 v[120:123], a[152:155], a[188:191], v[120:123]
 v_exp_f32 v25, v25
 v_mfma_f32_16x16x32_bf16 v[124:127], a[156:159], a[188:191], v[124:127]
 v_exp_f32 v26, v26
 v_mfma_f32_16x16x32_bf16 v[124:127], a[140:143], a[192:195], v[124:127]
 ds_read_b64_tr_b16 a[38:39], v46 offset:8456
 v_fmac_f32 v28, v28, v24
 v_mfma_f32_16x16x32_bf16 v[124:127], a[124:127], a[196:199], v[124:127]
 s_add_u32 m0, s29, 4096
 v_exp_f32 v27, v27
 v_mfma_f32_16x16x32_bf16 v[124:127], a[108:111], a[200:203], v[124:127]
 s_waitcnt lgkmcnt(4)
 buffer_load_dwordx4 v5, s[8:11], s78 offen offset:0 lds
 v_fmac_f32 v29, v29, v25
 v_mfma_f32_16x16x32_bf16 v[124:127], a[92:95], a[172:175], v[124:127]
 ds_read_b128 a[180:183], v2 offset:2176
 ds_read_b64_tr_b16 a[48:49], v46 offset:12288
 v_mfma_f32_16x16x32_bf16 v[140:143], a[92:95], a[200:203], v[140:143]
 ds_read_b128 a[184:187], v2 offset:6528
 v_fmac_f32 v30, v30, v26
 v_mfma_f32_16x16x32_bf16 v[140:143], a[108:111], a[196:199], v[140:143]
 ds_read_b128 a[204:207], v2 offset:10880
 v_fmac_f32 v31, v31, v27
 v_mfma_f32_16x16x32_bf16 v[140:143], a[124:127], a[192:195], v[140:143]
 ds_read_b128 a[168:171], v2 offset:15232
 ds_read_b64_tr_b16 a[50:51], v46 offset:12544
 v_mfma_f32_16x16x32_bf16 v[140:143], a[140:143], a[188:191], v[140:143]
 ds_read_b128 a[172:175], v2 offset:19584
 v_accvgpr_read_b32 v40, a252
 v_mfma_f32_16x16x32_bf16 v[140:143], a[156:159], a[160:163], v[140:143]
 v_rcp_f32 v28, v28
 v_mfma_f32_16x16x32_bf16 v[136:139], a[152:155], a[160:163], v[136:139]
 ds_read_b64_tr_b16 a[52:53], v46 offset:12296
 v_fma_f32 v20, v20, v28, -v28
 v_mfma_f32_16x16x32_bf16 v[136:139], a[136:139], a[188:191], v[136:139]
 v_rcp_f32 v29, v29
 v_mfma_f32_16x16x32_bf16 v[136:139], a[120:123], a[192:195], v[136:139]
 s_add_u32 m0, s29, 6144
 v_rcp_f32 v30, v30
 v_mfma_f32_16x16x32_bf16 v[136:139], a[104:107], a[196:199], v[136:139]
 ds_read_b64_tr_b16 a[54:55], v46 offset:12552
 buffer_load_dwordx4 v5, s[8:11], s79 offen offset:0 lds
 v_mfma_f32_16x16x32_bf16 v[136:139], a[88:91], a[200:203], v[136:139]
 v_rcp_f32 v31, v31
 v_mfma_f32_16x16x32_bf16 v[132:135], a[84:87], a[200:203], v[132:135]
 v_fma_f32 v21, v21, v29, -v29
 v_fma_f32 v22, v22, v30, -v30
 v_mfma_f32_16x16x32_bf16 v[132:135], a[100:103], a[196:199], v[132:135]
 ds_read_b64_tr_b16 a[64:65], v46 offset:16384
 v_fma_f32 v23, v23, v31, -v31
 v_mfma_f32_16x16x32_bf16 v[132:135], a[116:119], a[192:195], v[132:135]
 v_cvt_pk_bf16_f32 v16, v20, v21
 v_cvt_pk_bf16_f32 v17, v22, v23
 v_mfma_f32_16x16x32_bf16 v[132:135], a[132:135], a[188:191], v[132:135]
 v_accvgpr_read_b32 v33, a245
 v_accvgpr_read_b32 v41, a253
 v_mfma_f32_16x16x32_bf16 v[132:135], a[148:151], a[160:163], v[132:135]
 ds_read_b64_tr_b16 a[66:67], v46 offset:16640
 v_accvgpr_read_b32 v34, a246
 v_mfma_f32_16x16x32_bf16 v[128:131], a[144:147], a[160:163], v[128:131]
 v_accvgpr_read_b32 v42, a254
 v_accvgpr_read_b32 v35, a247
 v_mfma_f32_16x16x32_bf16 v[128:131], a[128:131], a[188:191], v[128:131]
 v_accvgpr_read_b32 v43, a255
 v_mul_f32 v32, s42, v32
 v_mfma_f32_16x16x32_bf16 v[128:131], a[112:115], a[192:195], v[128:131]
 s_add_u32 m0, s29, 8192
 ds_read_b64_tr_b16 a[68:69], v46 offset:16392
 v_mul_f32 v33, s42, v33
 v_mfma_f32_16x16x32_bf16 v[128:131], a[96:99], a[196:199], v[128:131]
 s_waitcnt lgkmcnt(4)
 buffer_load_dwordx4 v5, s[8:11], s80 offen offset:0 lds
 v_mul_f32 v34, s42, v34
 v_mfma_f32_16x16x32_bf16 v[128:131], a[80:83], a[200:203], v[128:131]
 v_mul_f32 v35, s42, v35
 v_min_f32 v32, s47, v32
 v_mfma_f32_16x16x32_bf16 v[144:147], a[80:83], a[196:199], v[144:147]
 ds_read_b64_tr_b16 a[70:71], v46 offset:16648
 v_min_f32 v33, s47, v33
 v_mfma_f32_16x16x32_bf16 v[144:147], a[96:99], a[192:195], v[144:147]
 v_min_f32 v34, s47, v34
 v_min_f32 v35, s47, v35
 v_mfma_f32_16x16x32_bf16 v[144:147], a[112:115], a[188:191], v[144:147]
 v_exp_f32 v32, v32
 v_mfma_f32_16x16x32_bf16 v[144:147], a[128:131], a[160:163], v[144:147]
 ds_read_b128 a[200:203], v2 offset:23936
 ds_read_b64_tr_b16 a[8:9], v46 offset:1024
 v_mfma_f32_16x16x32_bf16 v[144:147], a[144:147], a[164:167], v[144:147]
 v_mul_f32 v40, s43, v40
 v_mul_f32 v41, s43, v41
 v_mfma_f32_16x16x32_bf16 v[148:151], a[148:151], a[164:167], v[148:151]
 v_exp_f32 v33, v33
 v_mfma_f32_16x16x32_bf16 v[148:151], a[132:135], a[160:163], v[148:151]
 ds_read_b64_tr_b16 a[10:11], v46 offset:1280
 v_mul_f32 v42, s43, v42
 v_mfma_f32_16x16x32_bf16 v[148:151], a[116:119], a[188:191], v[148:151]
 s_add_u32 m0, s29, 10240
 v_mul_f32 v43, s43, v43
 v_add_f32 v28, 1.0, v32
 v_mfma_f32_16x16x32_bf16 v[148:151], a[100:103], a[192:195], v[148:151]
 buffer_load_dwordx4 v5, s[8:11], s81 offen offset:0 lds
 v_add_f32 v29, 1.0, v33
 v_mfma_f32_16x16x32_bf16 v[148:151], a[84:87], a[196:199], v[148:151]
 ds_read_b64_tr_b16 a[12:13], v46 offset:1032
 v_mfma_f32_16x16x32_bf16 v[152:155], a[88:91], a[196:199], v[152:155]
 v_exp_f32 v34, v34
 v_mfma_f32_16x16x32_bf16 v[152:155], a[104:107], a[192:195], v[152:155]
 v_exp_f32 v35, v35
 v_mfma_f32_16x16x32_bf16 v[152:155], a[120:123], a[188:191], v[152:155]
 ds_read_b64_tr_b16 a[14:15], v46 offset:1288
 v_add_f32 v30, 1.0, v34
 v_mfma_f32_16x16x32_bf16 v[152:155], a[136:139], a[160:163], v[152:155]
 v_exp_f32 v40, v40
 v_mfma_f32_16x16x32_bf16 v[152:155], a[152:155], a[164:167], v[152:155]
 v_exp_f32 v41, v41
 v_mfma_f32_16x16x32_bf16 v[156:159], a[156:159], a[164:167], v[156:159]
 ds_read_b64_tr_b16 a[24:25], v46 offset:5120
 v_add_f32 v31, 1.0, v35
 v_mfma_f32_16x16x32_bf16 v[156:159], a[140:143], a[160:163], v[156:159]
 v_exp_f32 v42, v42
 v_mfma_f32_16x16x32_bf16 v[156:159], a[124:127], a[188:191], v[156:159]
 s_add_u32 m0, s29, 12288
 v_exp_f32 v43, v43
 v_mfma_f32_16x16x32_bf16 v[156:159], a[108:111], a[192:195], v[156:159]
 s_waitcnt lgkmcnt(3)
 ds_read_b64_tr_b16 a[26:27], v46 offset:5376
 buffer_load_dwordx4 v5, s[8:11], s82 offen offset:0 lds
 v_mfma_f32_16x16x32_bf16 v[156:159], a[92:95], a[196:199], v[156:159]
 v_fmac_f32 v28, v28, v40
 v_fmac_f32 v29, v29, v41
 v_mfma_f32_16x16x32_bf16 v[172:175], a[92:95], a[192:195], v[172:175]
 v_fmac_f32 v30, v30, v42
 v_fmac_f32 v31, v31, v43
 v_mfma_f32_16x16x32_bf16 v[172:175], a[108:111], a[188:191], v[172:175]
 ds_read_b64_tr_b16 a[28:29], v46 offset:5128
 v_mfma_f32_16x16x32_bf16 v[172:175], a[124:127], a[160:163], v[172:175]
 v_rcp_f32 v28, v28
 v_mfma_f32_16x16x32_bf16 v[172:175], a[140:143], a[164:167], v[172:175]
 ds_read_b128 a[196:199], v2 offset:28288
 v_fma_f32 v32, v32, v28, -v28
 v_mfma_f32_16x16x32_bf16 v[172:175], a[156:159], a[176:179], v[172:175]
 ds_read_b64_tr_b16 a[30:31], v46 offset:5384
 v_mfma_f32_16x16x32_bf16 v[168:171], a[152:155], a[176:179], v[168:171]
 v_rcp_f32 v29, v29
 v_mfma_f32_16x16x32_bf16 v[168:171], a[136:139], a[164:167], v[168:171]
 s_add_u32 m0, s29, 14336
 v_rcp_f32 v30, v30
 v_mfma_f32_16x16x32_bf16 v[168:171], a[120:123], a[160:163], v[168:171]
 ds_read_b64_tr_b16 a[40:41], v46 offset:9216
 buffer_load_dwordx4 v5, s[8:11], s83 offen offset:0 lds
 v_mfma_f32_16x16x32_bf16 v[168:171], a[104:107], a[188:191], v[168:171]
 v_rcp_f32 v31, v31
 v_mfma_f32_16x16x32_bf16 v[168:171], a[88:91], a[192:195], v[168:171]
 v_fma_f32 v33, v33, v29, -v29
 v_fma_f32 v34, v34, v30, -v30
 v_mfma_f32_16x16x32_bf16 v[164:167], a[84:87], a[192:195], v[164:167]
 ds_read_b64_tr_b16 a[42:43], v46 offset:9472
 v_fma_f32 v35, v35, v31, -v31
 v_mfma_f32_16x16x32_bf16 v[164:167], a[100:103], a[188:191], v[164:167]
 v_cvt_pk_bf16_f32 v18, v32, v33
 v_cvt_pk_bf16_f32 v19, v34, v35
 v_mfma_f32_16x16x32_bf16 v[164:167], a[116:119], a[160:163], v[164:167]
 s_add_u32 s46, s40, 15360
 buffer_store_dwordx4 v[16:19], v6, s[12:15], s46 offen
 v_mfma_f32_16x16x32_bf16 v[164:167], a[132:135], a[164:167], v[164:167]
 ds_read_b64_tr_b16 a[44:45], v46 offset:9224
 v_mfma_f32_16x16x32_bf16 v[164:167], a[148:151], a[176:179], v[164:167]
 v_mfma_f32_16x16x32_bf16 v[160:163], a[144:147], a[176:179], v[160:163]
 v_mfma_f32_16x16x32_bf16 v[160:163], a[128:131], a[164:167], v[160:163]
 s_add_u32 m0, s29, 16384
 ds_read_b64_tr_b16 a[46:47], v46 offset:9480
 v_mfma_f32_16x16x32_bf16 v[160:163], a[112:115], a[160:163], v[160:163]
 buffer_load_dwordx4 v5, s[8:11], s84 offen offset:0 lds
 v_mfma_f32_16x16x32_bf16 v[160:163], a[96:99], a[188:191], v[160:163]
 v_mfma_f32_16x16x32_bf16 v[160:163], a[80:83], a[192:195], v[160:163]
 s_waitcnt vmcnt(11)
 ds_read_b64_tr_b16 a[56:57], v46 offset:13312
 v_mfma_f32_16x16x32_bf16 v[176:179], a[80:83], a[180:183], v[176:179]
 v_mfma_f32_16x16x32_bf16 v[176:179], a[96:99], a[184:187], v[176:179]
 v_mfma_f32_16x16x32_bf16 v[176:179], a[112:115], a[204:207], v[176:179]
 ds_read_b64_tr_b16 a[58:59], v46 offset:13568
 v_mfma_f32_16x16x32_bf16 v[176:179], a[128:131], a[168:171], v[176:179]
 ds_read_b128 a[188:191], v4 offset:0
 v_mfma_f32_16x16x32_bf16 v[176:179], a[144:147], a[172:175], v[176:179]
 v_mfma_f32_16x16x32_bf16 v[180:183], a[148:151], a[172:175], v[180:183]
 ds_read_b64_tr_b16 a[60:61], v46 offset:13320
 v_mfma_f32_16x16x32_bf16 v[180:183], a[132:135], a[168:171], v[180:183]
 s_add_u32 m0, s29, 18432
 v_mfma_f32_16x16x32_bf16 v[180:183], a[116:119], a[204:207], v[180:183]
 buffer_load_dwordx4 v5, s[8:11], s85 offen offset:0 lds
 v_mfma_f32_16x16x32_bf16 v[180:183], a[100:103], a[184:187], v[180:183]
 ds_read_b64_tr_b16 a[62:63], v46 offset:13576
 v_mfma_f32_16x16x32_bf16 v[180:183], a[84:87], a[180:183], v[180:183]
 v_mfma_f32_16x16x32_bf16 v[184:187], a[88:91], a[180:183], v[184:187]
 v_mfma_f32_16x16x32_bf16 v[184:187], a[104:107], a[184:187], v[184:187]
 ds_read_b64_tr_b16 a[72:73], v46 offset:17408
 v_mfma_f32_16x16x32_bf16 v[184:187], a[120:123], a[204:207], v[184:187]
 v_mfma_f32_16x16x32_bf16 v[184:187], a[136:139], a[168:171], v[184:187]
 v_mfma_f32_16x16x32_bf16 v[184:187], a[152:155], a[172:175], v[184:187]
 ds_read_b64_tr_b16 a[74:75], v46 offset:17664
 v_mfma_f32_16x16x32_bf16 v[188:191], a[156:159], a[172:175], v[188:191]
 v_mfma_f32_16x16x32_bf16 v[188:191], a[140:143], a[168:171], v[188:191]
 s_add_u32 m0, s29, 0
 v_mfma_f32_16x16x32_bf16 v[188:191], a[124:127], a[204:207], v[188:191]
 s_waitcnt lgkmcnt(3)
 ds_read_b64_tr_b16 a[76:77], v46 offset:17416
 buffer_load_dwordx4 v5, s[8:11], s76 offen offset:1024 lds
 v_mfma_f32_16x16x32_bf16 v[188:191], a[108:111], a[184:187], v[188:191]
 v_mfma_f32_16x16x32_bf16 v[188:191], a[92:95], a[180:183], v[188:191]
 v_mfma_f32_16x16x32_bf16 v[204:207], a[92:95], a[184:187], v[204:207]
 ds_read_b64_tr_b16 a[78:79], v46 offset:17672
 v_mfma_f32_16x16x32_bf16 v[204:207], a[108:111], a[204:207], v[204:207]
 v_mfma_f32_16x16x32_bf16 v[204:207], a[124:127], a[168:171], v[204:207]
 v_mfma_f32_16x16x32_bf16 v[204:207], a[140:143], a[172:175], v[204:207]
 ds_read_b128 a[192:195], v4 offset:4352
 v_mfma_f32_16x16x32_bf16 v[204:207], a[156:159], a[200:203], v[204:207]
 v_mfma_f32_16x16x32_bf16 v[200:203], a[152:155], a[200:203], v[200:203]
 v_mfma_f32_16x16x32_bf16 v[200:203], a[136:139], a[172:175], v[200:203]
 s_add_u32 m0, s29, 2048
 v_mfma_f32_16x16x32_bf16 v[200:203], a[120:123], a[168:171], v[200:203]
 buffer_load_dwordx4 v5, s[8:11], s77 offen offset:1024 lds
 v_mfma_f32_16x16x32_bf16 v[200:203], a[104:107], a[204:207], v[200:203]
 v_mfma_f32_16x16x32_bf16 v[200:203], a[88:91], a[184:187], v[200:203]
 v_mfma_f32_16x16x32_bf16 v[196:199], a[84:87], a[184:187], v[196:199]
 v_mfma_f32_16x16x32_bf16 v[196:199], a[100:103], a[204:207], v[196:199]
 v_mfma_f32_16x16x32_bf16 v[196:199], a[116:119], a[168:171], v[196:199]
 v_mfma_f32_16x16x32_bf16 v[196:199], a[132:135], a[172:175], v[196:199]
 v_mfma_f32_16x16x32_bf16 v[196:199], a[148:151], a[200:203], v[196:199]
 v_mfma_f32_16x16x32_bf16 v[192:195], a[144:147], a[200:203], v[192:195]
 v_mfma_f32_16x16x32_bf16 v[192:195], a[128:131], a[172:175], v[192:195]
 s_add_u32 m0, s29, 4096
 v_mfma_f32_16x16x32_bf16 v[192:195], a[112:115], a[168:171], v[192:195]
 buffer_load_dwordx4 v5, s[8:11], s78 offen offset:1024 lds
 v_mfma_f32_16x16x32_bf16 v[192:195], a[96:99], a[204:207], v[192:195]
 v_mfma_f32_16x16x32_bf16 v[192:195], a[80:83], a[184:187], v[192:195]
 v_mfma_f32_16x16x32_bf16 v[208:211], a[80:83], a[204:207], v[208:211]
 v_mfma_f32_16x16x32_bf16 v[208:211], a[96:99], a[168:171], v[208:211]
 v_mfma_f32_16x16x32_bf16 v[208:211], a[112:115], a[172:175], v[208:211]
 v_mfma_f32_16x16x32_bf16 v[208:211], a[128:131], a[200:203], v[208:211]
 ds_read_b128 a[184:187], v4 offset:8704
 v_mfma_f32_16x16x32_bf16 v[208:211], a[144:147], a[196:199], v[208:211]
 v_mfma_f32_16x16x32_bf16 v[212:215], a[148:151], a[196:199], v[212:215]
 v_mfma_f32_16x16x32_bf16 v[212:215], a[132:135], a[200:203], v[212:215]
 s_add_u32 m0, s29, 6144
 v_mfma_f32_16x16x32_bf16 v[212:215], a[116:119], a[172:175], v[212:215]
 buffer_load_dwordx4 v5, s[8:11], s79 offen offset:1024 lds
 v_mfma_f32_16x16x32_bf16 v[212:215], a[100:103], a[168:171], v[212:215]
 v_mfma_f32_16x16x32_bf16 v[212:215], a[84:87], a[204:207], v[212:215]
 v_mfma_f32_16x16x32_bf16 v[216:219], a[88:91], a[204:207], v[216:219]
 v_mfma_f32_16x16x32_bf16 v[216:219], a[104:107], a[168:171], v[216:219]
 v_mfma_f32_16x16x32_bf16 v[216:219], a[120:123], a[172:175], v[216:219]
 v_mfma_f32_16x16x32_bf16 v[216:219], a[136:139], a[200:203], v[216:219]
 v_mfma_f32_16x16x32_bf16 v[216:219], a[152:155], a[196:199], v[216:219]
 v_mfma_f32_16x16x32_bf16 v[220:223], a[156:159], a[196:199], v[220:223]
 s_add_u32 m0, s29, 8192
 v_mfma_f32_16x16x32_bf16 v[220:223], a[140:143], a[200:203], v[220:223]
 buffer_load_dwordx4 v5, s[8:11], s80 offen offset:1024 lds
 v_mfma_f32_16x16x32_bf16 v[220:223], a[124:127], a[172:175], v[220:223]
 v_mfma_f32_16x16x32_bf16 v[220:223], a[108:111], a[168:171], v[220:223]
 v_mfma_f32_16x16x32_bf16 v[220:223], a[92:95], a[204:207], v[220:223]
 v_mfma_f32_16x16x32_bf16 v[236:239], a[92:95], a[168:171], v[236:239]
 v_mfma_f32_16x16x32_bf16 v[236:239], a[108:111], a[172:175], v[236:239]
 v_mfma_f32_16x16x32_bf16 v[236:239], a[124:127], a[200:203], v[236:239]
 v_mfma_f32_16x16x32_bf16 v[236:239], a[140:143], a[196:199], v[236:239]
 ds_read_b128 a[204:207], v4 offset:13056
 v_mfma_f32_16x16x32_bf16 v[236:239], a[156:159], a[188:191], v[236:239]
 v_mfma_f32_16x16x32_bf16 v[232:235], a[152:155], a[188:191], v[232:235]
 s_add_u32 m0, s29, 10240
 v_mfma_f32_16x16x32_bf16 v[232:235], a[136:139], a[196:199], v[232:235]
 buffer_load_dwordx4 v5, s[8:11], s81 offen offset:1024 lds
 v_mfma_f32_16x16x32_bf16 v[232:235], a[120:123], a[200:203], v[232:235]
 v_mfma_f32_16x16x32_bf16 v[232:235], a[104:107], a[172:175], v[232:235]
 v_mfma_f32_16x16x32_bf16 v[232:235], a[88:91], a[168:171], v[232:235]
 v_mfma_f32_16x16x32_bf16 v[228:231], a[84:87], a[168:171], v[228:231]
 v_mfma_f32_16x16x32_bf16 v[228:231], a[100:103], a[172:175], v[228:231]
 s_waitcnt lgkmcnt(0)
 s_barrier
 v_mfma_f32_16x16x32_bf16 v[228:231], a[116:119], a[200:203], v[228:231]
 v_xor_b32 v1, 0x10000, v1
 v_xor_b32 v2, 0x10000, v2
 v_mfma_f32_16x16x32_bf16 v[228:231], a[132:135], a[196:199], v[228:231]
 v_xor_b32 v3, 0x10000, v3
 v_xor_b32 v4, 0x10000, v4
 v_mfma_f32_16x16x32_bf16 v[228:231], a[148:151], a[188:191], v[228:231]
 ds_read_b128 a[160:163], v1 offset:0
 ds_read_b128 a[164:167], v1 offset:4352
 v_mfma_f32_16x16x32_bf16 v[224:227], a[144:147], a[188:191], v[224:227]
 s_add_u32 m0, s29, 12288
 v_mfma_f32_16x16x32_bf16 v[224:227], a[128:131], a[196:199], v[224:227]
 buffer_load_dwordx4 v5, s[8:11], s82 offen offset:1024 lds
 v_mfma_f32_16x16x32_bf16 v[224:227], a[112:115], a[200:203], v[224:227]
 v_mfma_f32_16x16x32_bf16 v[224:227], a[96:99], a[172:175], v[224:227]
 v_mfma_f32_16x16x32_bf16 v[224:227], a[80:83], a[168:171], v[224:227]
 ds_read_b128 a[168:171], v1 offset:8704
 v_mfma_f32_16x16x32_bf16 v[240:243], a[80:83], a[172:175], v[240:243]
 v_mfma_f32_16x16x32_bf16 v[240:243], a[96:99], a[200:203], v[240:243]
 v_mfma_f32_16x16x32_bf16 v[240:243], a[112:115], a[196:199], v[240:243]
 v_mfma_f32_16x16x32_bf16 v[240:243], a[128:131], a[188:191], v[240:243]
 v_mfma_f32_16x16x32_bf16 v[240:243], a[144:147], a[192:195], v[240:243]
 v_mfma_f32_16x16x32_bf16 v[244:247], a[148:151], a[192:195], v[244:247]
 s_add_u32 m0, s29, 14336
 v_mfma_f32_16x16x32_bf16 v[244:247], a[132:135], a[188:191], v[244:247]
 buffer_load_dwordx4 v5, s[8:11], s83 offen offset:1024 lds
 v_mfma_f32_16x16x32_bf16 v[244:247], a[116:119], a[196:199], v[244:247]
 v_mfma_f32_16x16x32_bf16 v[244:247], a[100:103], a[200:203], v[244:247]
 v_mfma_f32_16x16x32_bf16 v[244:247], a[84:87], a[172:175], v[244:247]
 v_mfma_f32_16x16x32_bf16 v[248:251], a[88:91], a[172:175], v[248:251]
 v_mfma_f32_16x16x32_bf16 v[248:251], a[104:107], a[200:203], v[248:251]
 v_mfma_f32_16x16x32_bf16 v[248:251], a[120:123], a[196:199], v[248:251]
 v_mfma_f32_16x16x32_bf16 v[248:251], a[136:139], a[188:191], v[248:251]
 v_mfma_f32_16x16x32_bf16 v[248:251], a[152:155], a[192:195], v[248:251]
 v_mfma_f32_16x16x32_bf16 v[252:255], a[156:159], a[192:195], v[252:255]
 s_add_u32 m0, s29, 16384
 v_mfma_f32_16x16x32_bf16 v[252:255], a[140:143], a[188:191], v[252:255]
 buffer_load_dwordx4 v5, s[8:11], s84 offen offset:1024 lds
 v_mfma_f32_16x16x32_bf16 v[252:255], a[124:127], a[196:199], v[252:255]
 v_mfma_f32_16x16x32_bf16 v[252:255], a[108:111], a[200:203], v[252:255]
 v_mfma_f32_16x16x32_bf16 v[252:255], a[92:95], a[172:175], v[252:255]
 ds_read_b128 a[172:175], v1 offset:13056
 ds_read_b128 a[176:179], v1 offset:17408
 v_mfma_f32_16x16x32_bf16 a[220:223], a[92:95], a[200:203], a[220:223]
 ds_read_b128 a[180:183], v1 offset:21760
 v_mfma_f32_16x16x32_bf16 a[220:223], a[108:111], a[196:199], a[220:223]
 v_mfma_f32_16x16x32_bf16 a[220:223], a[124:127], a[188:191], a[220:223]
 v_mfma_f32_16x16x32_bf16 a[220:223], a[140:143], a[192:195], a[220:223]
 v_mfma_f32_16x16x32_bf16 a[220:223], a[156:159], a[184:187], a[220:223]
 v_mfma_f32_16x16x32_bf16 a[216:219], a[152:155], a[184:187], a[216:219]
 s_add_u32 m0, s29, 18432
 v_mfma_f32_16x16x32_bf16 a[216:219], a[136:139], a[192:195], a[216:219]
 buffer_load_dwordx4 v5, s[8:11], s85 offen offset:1024 lds
 v_mfma_f32_16x16x32_bf16 a[216:219], a[120:123], a[188:191], a[216:219]
 s_add_u32 s8, s8, 0x10000
 s_addc_u32 s9, s9, 0
 v_mfma_f32_16x16x32_bf16 a[216:219], a[104:107], a[196:199], a[216:219]
 v_mfma_f32_16x16x32_bf16 a[216:219], a[88:91], a[200:203], a[216:219]
 v_mfma_f32_16x16x32_bf16 a[212:215], a[84:87], a[200:203], a[212:215]
 v_mfma_f32_16x16x32_bf16 a[212:215], a[100:103], a[196:199], a[212:215]
 v_mfma_f32_16x16x32_bf16 a[212:215], a[116:119], a[188:191], a[212:215]
 v_mfma_f32_16x16x32_bf16 a[212:215], a[132:135], a[192:195], a[212:215]
 v_mfma_f32_16x16x32_bf16 a[212:215], a[148:151], a[184:187], a[212:215]
 v_mfma_f32_16x16x32_bf16 a[208:211], a[144:147], a[184:187], a[208:211]
 v_mfma_f32_16x16x32_bf16 a[208:211], a[128:131], a[192:195], a[208:211]
 v_mfma_f32_16x16x32_bf16 a[208:211], a[112:115], a[188:191], a[208:211]
 v_mfma_f32_16x16x32_bf16 a[208:211], a[96:99], a[196:199], a[208:211]
 v_mfma_f32_16x16x32_bf16 a[208:211], a[80:83], a[200:203], a[208:211]
 v_mfma_f32_16x16x32_bf16 a[224:227], a[80:83], a[196:199], a[224:227]
 v_mfma_f32_16x16x32_bf16 a[224:227], a[96:99], a[188:191], a[224:227]
 v_mfma_f32_16x16x32_bf16 a[224:227], a[112:115], a[192:195], a[224:227]
 v_mfma_f32_16x16x32_bf16 a[224:227], a[128:131], a[184:187], a[224:227]
 v_mfma_f32_16x16x32_bf16 a[224:227], a[144:147], a[204:207], a[224:227]
 v_mfma_f32_16x16x32_bf16 a[228:231], a[148:151], a[204:207], a[228:231]
 v_mfma_f32_16x16x32_bf16 a[228:231], a[132:135], a[184:187], a[228:231]
 v_mfma_f32_16x16x32_bf16 a[228:231], a[116:119], a[192:195], a[228:231]
 v_mfma_f32_16x16x32_bf16 a[228:231], a[100:103], a[188:191], a[228:231]
 v_mfma_f32_16x16x32_bf16 a[228:231], a[84:87], a[196:199], a[228:231]
 v_mfma_f32_16x16x32_bf16 a[232:235], a[88:91], a[196:199], a[232:235]
 v_mfma_f32_16x16x32_bf16 a[232:235], a[104:107], a[188:191], a[232:235]
 v_mfma_f32_16x16x32_bf16 a[232:235], a[120:123], a[192:195], a[232:235]
 v_mfma_f32_16x16x32_bf16 a[232:235], a[136:139], a[184:187], a[232:235]
 v_mfma_f32_16x16x32_bf16 a[232:235], a[152:155], a[204:207], a[232:235]
 v_mfma_f32_16x16x32_bf16 a[236:239], a[156:159], a[204:207], a[236:239]
 v_mfma_f32_16x16x32_bf16 a[236:239], a[140:143], a[184:187], a[236:239]
 v_mfma_f32_16x16x32_bf16 a[236:239], a[124:127], a[192:195], a[236:239]
 v_mfma_f32_16x16x32_bf16 a[236:239], a[108:111], a[188:191], a[236:239]
 v_mfma_f32_16x16x32_bf16 a[236:239], a[92:95], a[196:199], a[236:239]
 s_add_u32 s12, s20, s68
 s_addc_u32 s13, s21, 0
 s_add_u32 s40, s69, s45
 v_mad_i32_i24 v6, v39, s71, v6
 s_movk_i32 s25, 100
 s_movk_i32 s23, 100
 s_mov_b32 s30, 6
 v_min_u32 v47, L_e15-L_f15-4, v47
 s_add_u32 s88, s86, L_f15-L_c0
 s_addc_u32 s89, s87, 0
.p2align 6
L_mid15:
 s_waitcnt lgkmcnt(5)
 ds_read_b128 a[184:187], v1 offset:26112
 ds_read_b128 a[188:191], v1 offset:30464
 v_mfma_f32_16x16x32_bf16 v[48:51], a[0:3], a[160:163], v[48:51]
 s_waitcnt lgkmcnt(6)
 v_mfma_f32_16x16x32_bf16 v[48:51], a[16:19], a[164:167], v[48:51]
 s_waitcnt vmcnt(18) lgkmcnt(5)
 ds_read_b64_tr_b16 a[80:81], v46 offset:0
 v_mfma_f32_16x16x32_bf16 v[48:51], a[32:35], a[168:171], v[48:51]
 s_waitcnt lgkmcnt(5)
 v_mfma_f32_16x16x32_bf16 v[48:51], a[48:51], a[172:175], v[48:51]
 s_waitcnt lgkmcnt(4)
 v_mfma_f32_16x16x32_bf16 v[48:51], a[64:67], a[176:179], v[48:51]
 s_waitcnt lgkmcnt(3)
 ds_read_b64_tr_b16 a[82:83], v46 offset:256
 v_mfma_f32_16x16x32_bf16 v[64:67], a[64:67], a[180:183], v[64:67]
 v_mfma_f32_16x16x32_bf16 v[64:67], a[48:51], a[176:179], v[64:67]
 s_add_u32 m0, s26, 0
 v_mfma_f32_16x16x32_bf16 v[64:67], a[32:35], a[172:175], v[64:67]
 ds_read_b64_tr_b16 a[84:85], v46 offset:8
 buffer_load_dwordx4 v7, s[4:7], 0 offen nt lds
 v_mfma_f32_16x16x32_bf16 v[64:67], a[16:19], a[168:171], v[64:67]
 v_mfma_f32_16x16x32_bf16 v[64:67], a[0:3], a[164:167], v[64:67]
 v_mfma_f32_16x16x32_bf16 v[80:83], a[0:3], a[168:171], v[80:83]
 ds_read_b64_tr_b16 a[86:87], v46 offset:264
 v_mfma_f32_16x16x32_bf16 v[80:83], a[16:19], a[172:175], v[80:83]
 v_mfma_f32_16x16x32_bf16 v[80:83], a[32:35], a[176:179], v[80:83]
 v_mfma_f32_16x16x32_bf16 v[80:83], a[48:51], a[180:183], v[80:83]
 s_waitcnt vmcnt(17) lgkmcnt(3)
 ds_read_b64_tr_b16 a[96:97], v46 offset:4096
 v_mfma_f32_16x16x32_bf16 v[80:83], a[64:67], a[184:187], v[80:83]
 v_mfma_f32_16x16x32_bf16 v[96:99], a[64:67], a[188:191], v[96:99]
 v_mfma_f32_16x16x32_bf16 v[96:99], a[48:51], a[184:187], v[96:99]
 s_add_u32 m0, s29, 0
 ds_read_b64_tr_b16 a[98:99], v46 offset:4352
 v_mfma_f32_16x16x32_bf16 v[96:99], a[32:35], a[180:183], v[96:99]
 s_waitcnt lgkmcnt(2)
 buffer_load_dwordx4 v5, s[8:11], s76 offen offset:0 lds
 v_mfma_f32_16x16x32_bf16 v[96:99], a[16:19], a[176:179], v[96:99]
 v_mfma_f32_16x16x32_bf16 v[96:99], a[0:3], a[172:175], v[96:99]
 ds_read_b64_tr_b16 a[100:101], v46 offset:4104
 v_mfma_f32_16x16x32_bf16 v[100:103], a[4:7], a[172:175], v[100:103]
 v_mfma_f32_16x16x32_bf16 v[100:103], a[20:23], a[176:179], v[100:103]
 v_mfma_f32_16x16x32_bf16 v[100:103], a[36:39], a[180:183], v[100:103]
 ds_read_b64_tr_b16 a[102:103], v46 offset:4360
 v_mfma_f32_16x16x32_bf16 v[100:103], a[52:55], a[184:187], v[100:103]
 ds_read_b128 a[192:195], v3 offset:2176
 v_mfma_f32_16x16x32_bf16 v[100:103], a[68:71], a[188:191], v[100:103]
 ds_read_b128 a[196:199], v3 offset:6528
 v_mfma_f32_16x16x32_bf16 v[84:87], a[68:71], a[184:187], v[84:87]
 s_waitcnt vmcnt(16)
 ds_read_b64_tr_b16 a[112:113], v46 offset:8192
 v_mfma_f32_16x16x32_bf16 v[84:87], a[52:55], a[180:183], v[84:87]
 s_add_u32 m0, s29, 2048
 v_mfma_f32_16x16x32_bf16 v[84:87], a[36:39], a[176:179], v[84:87]
 buffer_load_dwordx4 v5, s[8:11], s77 offen offset:0 lds
 v_mfma_f32_16x16x32_bf16 v[84:87], a[20:23], a[172:175], v[84:87]
 ds_read_b64_tr_b16 a[114:115], v46 offset:8448
 v_mfma_f32_16x16x32_bf16 v[84:87], a[4:7], a[168:171], v[84:87]
 v_mfma_f32_16x16x32_bf16 v[68:71], a[4:7], a[164:167], v[68:71]
 v_mfma_f32_16x16x32_bf16 v[68:71], a[20:23], a[168:171], v[68:71]
 ds_read_b64_tr_b16 a[116:117], v46 offset:8200
 v_mfma_f32_16x16x32_bf16 v[68:71], a[36:39], a[172:175], v[68:71]
 v_mfma_f32_16x16x32_bf16 v[68:71], a[52:55], a[176:179], v[68:71]
 ds_read_b128 a[200:203], v3 offset:10880
 v_mfma_f32_16x16x32_bf16 v[68:71], a[68:71], a[180:183], v[68:71]
 ds_read_b128 a[204:207], v3 offset:15232
 ds_read_b64_tr_b16 a[118:119], v46 offset:8456
 v_mfma_f32_16x16x32_bf16 v[52:55], a[68:71], a[176:179], v[52:55]
 v_mfma_f32_16x16x32_bf16 v[52:55], a[52:55], a[172:175], v[52:55]
 s_add_u32 m0, s29, 4096
 v_mfma_f32_16x16x32_bf16 v[52:55], a[36:39], a[168:171], v[52:55]
 s_waitcnt vmcnt(15) lgkmcnt(5)
 ds_read_b64_tr_b16 a[128:129], v46 offset:12288
 buffer_load_dwordx4 v5, s[8:11], s78 offen offset:0 lds
 v_mfma_f32_16x16x32_bf16 v[52:55], a[20:23], a[164:167], v[52:55]
 v_mfma_f32_16x16x32_bf16 v[52:55], a[4:7], a[160:163], v[52:55]
 v_mfma_f32_16x16x32_bf16 v[56:59], a[8:11], a[160:163], v[56:59]
 ds_read_b64_tr_b16 a[130:131], v46 offset:12544
 v_mfma_f32_16x16x32_bf16 v[56:59], a[24:27], a[164:167], v[56:59]
 v_mfma_f32_16x16x32_bf16 v[56:59], a[40:43], a[168:171], v[56:59]
 v_mfma_f32_16x16x32_bf16 v[56:59], a[56:59], a[172:175], v[56:59]
 s_add_u32 m0, s26, 1024
 ds_read_b64_tr_b16 a[132:133], v46 offset:12296
 v_mfma_f32_16x16x32_bf16 v[56:59], a[72:75], a[176:179], v[56:59]
 buffer_load_dwordx4 v8, s[4:7], 0 offen nt lds
 v_mfma_f32_16x16x32_bf16 v[72:75], a[72:75], a[180:183], v[72:75]
 v_mfma_f32_16x16x32_bf16 v[72:75], a[56:59], a[176:179], v[72:75]
 s_add_u32 m0, s29, 6144
 ds_read_b64_tr_b16 a[134:135], v46 offset:12552
 v_mfma_f32_16x16x32_bf16 v[72:75], a[40:43], a[172:175], v[72:75]
 buffer_load_dwordx4 v5, s[8:11], s79 offen offset:0 lds
 v_mfma_f32_16x16x32_bf16 v[72:75], a[24:27], a[168:171], v[72:75]
 v_mfma_f32_16x16x32_bf16 v[72:75], a[8:11], a[164:167], v[72:75]
 s_waitcnt vmcnt(16)
 ds_read_b64_tr_b16 a[144:145], v46 offset:16384
 v_mfma_f32_16x16x32_bf16 v[88:91], a[8:11], a[168:171], v[88:91]
 v_mfma_f32_16x16x32_bf16 v[88:91], a[24:27], a[172:175], v[88:91]
 v_mfma_f32_16x16x32_bf16 v[88:91], a[40:43], a[176:179], v[88:91]
 ds_read_b64_tr_b16 a[146:147], v46 offset:16640
 v_mfma_f32_16x16x32_bf16 v[88:91], a[56:59], a[180:183], v[88:91]
 v_mfma_f32_16x16x32_bf16 v[88:91], a[72:75], a[184:187], v[88:91]
 v_mfma_f32_16x16x32_bf16 v[104:107], a[72:75], a[188:191], v[104:107]
 ds_read_b64_tr_b16 a[148:149], v46 offset:16392
 v_mfma_f32_16x16x32_bf16 v[104:107], a[56:59], a[184:187], v[104:107]
 s_add_u32 m0, s29, 8192
 v_mfma_f32_16x16x32_bf16 v[104:107], a[40:43], a[180:183], v[104:107]
 s_waitcnt lgkmcnt(4)
 buffer_load_dwordx4 v5, s[8:11], s80 offen offset:0 lds
 v_mfma_f32_16x16x32_bf16 v[104:107], a[24:27], a[176:179], v[104:107]
 ds_read_b64_tr_b16 a[150:151], v46 offset:16648
 v_mfma_f32_16x16x32_bf16 v[104:107], a[8:11], a[172:175], v[104:107]
 v_mfma_f32_16x16x32_bf16 v[108:111], a[12:15], a[172:175], v[108:111]
 v_mfma_f32_16x16x32_bf16 v[108:111], a[28:31], a[176:179], v[108:111]
 s_waitcnt vmcnt(15)
 ds_read_b64_tr_b16 a[88:89], v46 offset:1024
 v_mfma_f32_16x16x32_bf16 v[108:111], a[44:47], a[180:183], v[108:111]
 v_mfma_f32_16x16x32_bf16 v[108:111], a[60:63], a[184:187], v[108:111]
 v_mfma_f32_16x16x32_bf16 v[108:111], a[76:79], a[188:191], v[108:111]
 ds_read_b64_tr_b16 a[90:91], v46 offset:1280
 v_mfma_f32_16x16x32_bf16 v[92:95], a[76:79], a[184:187], v[92:95]
 v_mfma_f32_16x16x32_bf16 v[92:95], a[60:63], a[180:183], v[92:95]
 s_add_u32 m0, s29, 10240
 v_mfma_f32_16x16x32_bf16 v[92:95], a[44:47], a[176:179], v[92:95]
 ds_read_b64_tr_b16 a[92:93], v46 offset:1032
 buffer_load_dwordx4 v5, s[8:11], s81 offen offset:0 lds
 v_mfma_f32_16x16x32_bf16 v[92:95], a[28:31], a[172:175], v[92:95]
 v_mfma_f32_16x16x32_bf16 v[92:95], a[12:15], a[168:171], v[92:95]
 v_mfma_f32_16x16x32_bf16 v[76:79], a[12:15], a[164:167], v[76:79]
 ds_read_b64_tr_b16 a[94:95], v46 offset:1288
 v_mfma_f32_16x16x32_bf16 v[76:79], a[28:31], a[168:171], v[76:79]
 v_mfma_f32_16x16x32_bf16 v[76:79], a[44:47], a[172:175], v[76:79]
 v_mfma_f32_16x16x32_bf16 v[76:79], a[60:63], a[176:179], v[76:79]
 s_waitcnt vmcnt(14)
 ds_read_b64_tr_b16 a[104:105], v46 offset:5120
 v_mfma_f32_16x16x32_bf16 v[76:79], a[76:79], a[180:183], v[76:79]
 v_mfma_f32_16x16x32_bf16 v[60:63], a[76:79], a[176:179], v[60:63]
 v_mfma_f32_16x16x32_bf16 v[60:63], a[60:63], a[172:175], v[60:63]
 s_add_u32 m0, s29, 12288
 ds_read_b64_tr_b16 a[106:107], v46 offset:5376
 v_mfma_f32_16x16x32_bf16 v[60:63], a[44:47], a[168:171], v[60:63]
 s_waitcnt lgkmcnt(4)
 buffer_load_dwordx4 v5, s[8:11], s82 offen offset:0 lds
 v_mfma_f32_16x16x32_bf16 v[60:63], a[28:31], a[164:167], v[60:63]
 v_mfma_f32_16x16x32_bf16 v[60:63], a[12:15], a[160:163], v[60:63]
 ds_read_b64_tr_b16 a[108:109], v46 offset:5128
 v_mfma_f32_16x16x32_bf16 v[124:127], a[12:15], a[176:179], v[124:127]
 s_add_u32 m0, s26, 2048
 v_mfma_f32_16x16x32_bf16 v[124:127], a[28:31], a[180:183], v[124:127]
 buffer_load_dwordx4 v9, s[4:7], 0 offen nt lds
 v_mfma_f32_16x16x32_bf16 v[124:127], a[44:47], a[184:187], v[124:127]
 ds_read_b64_tr_b16 a[110:111], v46 offset:5384
 v_mfma_f32_16x16x32_bf16 v[124:127], a[60:63], a[188:191], v[124:127]
 v_mfma_f32_16x16x32_bf16 v[124:127], a[76:79], a[192:195], v[124:127]
 v_mfma_f32_16x16x32_bf16 v[140:143], a[76:79], a[196:199], v[140:143]
 s_waitcnt vmcnt(14)
 ds_read_b64_tr_b16 a[120:121], v46 offset:9216
 v_mfma_f32_16x16x32_bf16 v[140:143], a[60:63], a[192:195], v[140:143]
 v_mfma_f32_16x16x32_bf16 v[140:143], a[44:47], a[188:191], v[140:143]
 s_add_u32 m0, s29, 14336
 v_mfma_f32_16x16x32_bf16 v[140:143], a[28:31], a[184:187], v[140:143]
 ds_read_b64_tr_b16 a[122:123], v46 offset:9472
 buffer_load_dwordx4 v5, s[8:11], s83 offen offset:0 lds
 v_mfma_f32_16x16x32_bf16 v[140:143], a[12:15], a[180:183], v[140:143]
 v_mfma_f32_16x16x32_bf16 v[156:159], a[12:15], a[184:187], v[156:159]
 v_mfma_f32_16x16x32_bf16 v[156:159], a[28:31], a[188:191], v[156:159]
 ds_read_b64_tr_b16 a[124:125], v46 offset:9224
 v_mfma_f32_16x16x32_bf16 v[156:159], a[44:47], a[192:195], v[156:159]
 v_mfma_f32_16x16x32_bf16 v[156:159], a[60:63], a[196:199], v[156:159]
 v_mfma_f32_16x16x32_bf16 v[156:159], a[76:79], a[200:203], v[156:159]
 ds_read_b64_tr_b16 a[126:127], v46 offset:9480
 v_mfma_f32_16x16x32_bf16 v[172:175], a[76:79], a[204:207], v[172:175]
 v_mfma_f32_16x16x32_bf16 v[172:175], a[60:63], a[200:203], v[172:175]
 v_mfma_f32_16x16x32_bf16 v[172:175], a[44:47], a[196:199], v[172:175]
 s_waitcnt vmcnt(13)
 s_add_u32 m0, s29, 16384
 ds_read_b64_tr_b16 a[136:137], v46 offset:13312
 v_mfma_f32_16x16x32_bf16 v[172:175], a[28:31], a[192:195], v[172:175]
 buffer_load_dwordx4 v5, s[8:11], s84 offen offset:0 lds
 v_mfma_f32_16x16x32_bf16 v[172:175], a[12:15], a[188:191], v[172:175]
 ds_read_b128 a[172:175], v1 offset:2176
 v_mfma_f32_16x16x32_bf16 v[168:171], a[8:11], a[188:191], v[168:171]
 ds_read_b128 a[168:171], v1 offset:6528
 ds_read_b64_tr_b16 a[138:139], v46 offset:13568
 v_mfma_f32_16x16x32_bf16 v[168:171], a[24:27], a[192:195], v[168:171]
 ds_read_b128 a[164:167], v1 offset:10880
 v_mfma_f32_16x16x32_bf16 v[168:171], a[40:43], a[196:199], v[168:171]
 ds_read_b128 a[160:163], v1 offset:15232
 v_mfma_f32_16x16x32_bf16 v[168:171], a[56:59], a[200:203], v[168:171]
 ds_read_b64_tr_b16 a[140:141], v46 offset:13320
 v_mfma_f32_16x16x32_bf16 v[168:171], a[72:75], a[204:207], v[168:171]
 v_mfma_f32_16x16x32_bf16 v[152:155], a[72:75], a[200:203], v[152:155]
 v_mfma_f32_16x16x32_bf16 v[152:155], a[56:59], a[196:199], v[152:155]
 ds_read_b64_tr_b16 a[142:143], v46 offset:13576
 v_mfma_f32_16x16x32_bf16 v[152:155], a[40:43], a[192:195], v[152:155]
 s_add_u32 m0, s29, 18432
 v_mfma_f32_16x16x32_bf16 v[152:155], a[24:27], a[188:191], v[152:155]
 buffer_load_dwordx4 v5, s[8:11], s85 offen offset:0 lds
 v_mfma_f32_16x16x32_bf16 v[152:155], a[8:11], a[184:187], v[152:155]
 s_waitcnt vmcnt(13)
 ds_read_b64_tr_b16 a[152:153], v46 offset:17408
 v_mfma_f32_16x16x32_bf16 v[136:139], a[8:11], a[180:183], v[136:139]
 v_mfma_f32_16x16x32_bf16 v[136:139], a[24:27], a[184:187], v[136:139]
 v_mfma_f32_16x16x32_bf16 v[136:139], a[40:43], a[188:191], v[136:139]
 ds_read_b64_tr_b16 a[154:155], v46 offset:17664
 v_mfma_f32_16x16x32_bf16 v[136:139], a[56:59], a[192:195], v[136:139]
 v_mfma_f32_16x16x32_bf16 v[136:139], a[72:75], a[196:199], v[136:139]
 v_mfma_f32_16x16x32_bf16 v[120:123], a[72:75], a[192:195], v[120:123]
 ds_read_b64_tr_b16 a[156:157], v46 offset:17416
 v_mfma_f32_16x16x32_bf16 v[120:123], a[56:59], a[188:191], v[120:123]
 v_mfma_f32_16x16x32_bf16 v[120:123], a[40:43], a[184:187], v[120:123]
 s_add_u32 m0, s29, 0
 v_mfma_f32_16x16x32_bf16 v[120:123], a[24:27], a[180:183], v[120:123]
 s_waitcnt lgkmcnt(3)
 ds_read_b64_tr_b16 a[158:159], v46 offset:17672
 buffer_load_dwordx4 v5, s[8:11], s76 offen offset:1024 lds
 v_mfma_f32_16x16x32_bf16 v[120:123], a[8:11], a[176:179], v[120:123]
 s_add_u32 m0, s26, 3072
 v_mfma_f32_16x16x32_bf16 v[116:119], a[4:7], a[176:179], v[116:119]
 buffer_load_dwordx4 v10, s[4:7], 0 offen nt lds
 v_mfma_f32_16x16x32_bf16 v[116:119], a[20:23], a[180:183], v[116:119]
 v_mfma_f32_16x16x32_bf16 v[116:119], a[36:39], a[184:187], v[116:119]
 v_mfma_f32_16x16x32_bf16 v[116:119], a[52:55], a[188:191], v[116:119]
 v_mfma_f32_16x16x32_bf16 v[116:119], a[68:71], a[192:195], v[116:119]
 v_mfma_f32_16x16x32_bf16 v[132:135], a[68:71], a[196:199], v[132:135]
 v_mfma_f32_16x16x32_bf16 v[132:135], a[52:55], a[192:195], v[132:135]
 v_mfma_f32_16x16x32_bf16 v[132:135], a[36:39], a[188:191], v[132:135]
 s_add_u32 m0, s29, 2048
 v_mfma_f32_16x16x32_bf16 v[132:135], a[20:23], a[184:187], v[132:135]
 buffer_load_dwordx4 v5, s[8:11], s77 offen offset:1024 lds
 v_mfma_f32_16x16x32_bf16 v[132:135], a[4:7], a[180:183], v[132:135]
 v_mfma_f32_16x16x32_bf16 v[148:151], a[4:7], a[184:187], v[148:151]
 v_mfma_f32_16x16x32_bf16 v[148:151], a[20:23], a[188:191], v[148:151]
 v_mfma_f32_16x16x32_bf16 v[148:151], a[36:39], a[192:195], v[148:151]
 v_mfma_f32_16x16x32_bf16 v[148:151], a[52:55], a[196:199], v[148:151]
 v_mfma_f32_16x16x32_bf16 v[148:151], a[68:71], a[200:203], v[148:151]
 v_mfma_f32_16x16x32_bf16 v[164:167], a[68:71], a[204:207], v[164:167]
 v_mfma_f32_16x16x32_bf16 v[164:167], a[52:55], a[200:203], v[164:167]
 v_mfma_f32_16x16x32_bf16 v[164:167], a[36:39], a[196:199], v[164:167]
 s_add_u32 m0, s29, 4096
 v_mfma_f32_16x16x32_bf16 v[164:167], a[20:23], a[192:195], v[164:167]
 buffer_load_dwordx4 v5, s[8:11], s78 offen offset:1024 lds
 v_mfma_f32_16x16x32_bf16 v[164:167], a[4:7], a[188:191], v[164:167]
 v_mfma_f32_16x16x32_bf16 v[160:163], a[0:3], a[188:191], v[160:163]
 v_mfma_f32_16x16x32_bf16 v[160:163], a[16:19], a[192:195], v[160:163]
 v_mfma_f32_16x16x32_bf16 v[160:163], a[32:35], a[196:199], v[160:163]
 v_mfma_f32_16x16x32_bf16 v[160:163], a[48:51], a[200:203], v[160:163]
 v_mfma_f32_16x16x32_bf16 v[160:163], a[64:67], a[204:207], v[160:163]
 ds_read_b128 a[204:207], v1 offset:19584
 v_mfma_f32_16x16x32_bf16 v[144:147], a[64:67], a[200:203], v[144:147]
 ds_read_b128 a[200:203], v1 offset:23936
 v_mfma_f32_16x16x32_bf16 v[144:147], a[48:51], a[196:199], v[144:147]
 v_mfma_f32_16x16x32_bf16 v[144:147], a[32:35], a[192:195], v[144:147]
 s_add_u32 m0, s29, 6144
 v_mfma_f32_16x16x32_bf16 v[144:147], a[16:19], a[188:191], v[144:147]
 buffer_load_dwordx4 v5, s[8:11], s79 offen offset:1024 lds
 v_mfma_f32_16x16x32_bf16 v[144:147], a[0:3], a[184:187], v[144:147]
 v_mfma_f32_16x16x32_bf16 v[128:131], a[0:3], a[180:183], v[128:131]
 v_mfma_f32_16x16x32_bf16 v[128:131], a[16:19], a[184:187], v[128:131]
 v_mfma_f32_16x16x32_bf16 v[128:131], a[32:35], a[188:191], v[128:131]
 v_mfma_f32_16x16x32_bf16 v[128:131], a[48:51], a[192:195], v[128:131]
 v_mfma_f32_16x16x32_bf16 v[128:131], a[64:67], a[196:199], v[128:131]
 ds_read_b128 a[196:199], v1 offset:28288
 v_mfma_f32_16x16x32_bf16 v[112:115], a[64:67], a[192:195], v[112:115]
 ds_read_b128 a[192:195], v3 offset:0
 v_mfma_f32_16x16x32_bf16 v[112:115], a[48:51], a[188:191], v[112:115]
 s_add_u32 m0, s26, 4096
 v_mfma_f32_16x16x32_bf16 v[112:115], a[32:35], a[184:187], v[112:115]
 buffer_load_dwordx4 v11, s[4:7], 0 offen nt lds
 v_mfma_f32_16x16x32_bf16 v[112:115], a[16:19], a[180:183], v[112:115]
 s_add_u32 m0, s29, 8192
 v_mfma_f32_16x16x32_bf16 v[112:115], a[0:3], a[176:179], v[112:115]
 buffer_load_dwordx4 v5, s[8:11], s80 offen offset:1024 lds
 v_mfma_f32_16x16x32_bf16 v[176:179], a[0:3], a[172:175], v[176:179]
 v_mfma_f32_16x16x32_bf16 v[176:179], a[16:19], a[168:171], v[176:179]
 v_mfma_f32_16x16x32_bf16 v[176:179], a[32:35], a[164:167], v[176:179]
 v_mfma_f32_16x16x32_bf16 v[176:179], a[48:51], a[160:163], v[176:179]
 s_waitcnt lgkmcnt(2)
 v_mfma_f32_16x16x32_bf16 v[176:179], a[64:67], a[204:207], v[176:179]
 v_mfma_f32_16x16x32_bf16 v[192:195], a[64:67], a[200:203], v[192:195]
 v_mfma_f32_16x16x32_bf16 v[192:195], a[48:51], a[204:207], v[192:195]
 v_mfma_f32_16x16x32_bf16 v[192:195], a[32:35], a[160:163], v[192:195]
 v_mfma_f32_16x16x32_bf16 v[192:195], a[16:19], a[164:167], v[192:195]
 s_add_u32 m0, s29, 10240
 v_mfma_f32_16x16x32_bf16 v[192:195], a[0:3], a[168:171], v[192:195]
 buffer_load_dwordx4 v5, s[8:11], s81 offen offset:1024 lds
 v_mfma_f32_16x16x32_bf16 v[208:211], a[0:3], a[164:167], v[208:211]
 v_mfma_f32_16x16x32_bf16 v[208:211], a[16:19], a[160:163], v[208:211]
 v_mfma_f32_16x16x32_bf16 v[208:211], a[32:35], a[204:207], v[208:211]
 v_mfma_f32_16x16x32_bf16 v[208:211], a[48:51], a[200:203], v[208:211]
 s_waitcnt lgkmcnt(0)
 v_mfma_f32_16x16x32_bf16 v[208:211], a[64:67], a[196:199], v[208:211]
 v_mfma_f32_16x16x32_bf16 v[224:227], a[64:67], a[192:195], v[224:227]
 v_mfma_f32_16x16x32_bf16 v[224:227], a[48:51], a[196:199], v[224:227]
 v_mfma_f32_16x16x32_bf16 v[224:227], a[32:35], a[200:203], v[224:227]
 v_mfma_f32_16x16x32_bf16 v[224:227], a[16:19], a[204:207], v[224:227]
 s_add_u32 m0, s29, 12288
 v_mfma_f32_16x16x32_bf16 v[224:227], a[0:3], a[160:163], v[224:227]
 buffer_load_dwordx4 v5, s[8:11], s82 offen offset:1024 lds
 v_mfma_f32_16x16x32_bf16 v[228:231], a[4:7], a[160:163], v[228:231]
 v_mfma_f32_16x16x32_bf16 v[228:231], a[20:23], a[204:207], v[228:231]
 v_mfma_f32_16x16x32_bf16 v[228:231], a[36:39], a[200:203], v[228:231]
 v_mfma_f32_16x16x32_bf16 v[228:231], a[52:55], a[196:199], v[228:231]
 ds_read_b128 a[188:191], v3 offset:4352
 v_mfma_f32_16x16x32_bf16 v[228:231], a[68:71], a[192:195], v[228:231]
 ds_read_b128 a[184:187], v3 offset:8704
 v_mfma_f32_16x16x32_bf16 v[212:215], a[68:71], a[196:199], v[212:215]
 v_mfma_f32_16x16x32_bf16 v[212:215], a[52:55], a[200:203], v[212:215]
 v_mfma_f32_16x16x32_bf16 v[212:215], a[36:39], a[204:207], v[212:215]
 v_mfma_f32_16x16x32_bf16 v[212:215], a[20:23], a[160:163], v[212:215]
 s_add_u32 m0, s29, 14336
 v_mfma_f32_16x16x32_bf16 v[212:215], a[4:7], a[164:167], v[212:215]
 buffer_load_dwordx4 v5, s[8:11], s83 offen offset:1024 lds
 v_mfma_f32_16x16x32_bf16 v[196:199], a[4:7], a[168:171], v[196:199]
 v_mfma_f32_16x16x32_bf16 v[196:199], a[20:23], a[164:167], v[196:199]
 v_mfma_f32_16x16x32_bf16 v[196:199], a[36:39], a[160:163], v[196:199]
 v_mfma_f32_16x16x32_bf16 v[196:199], a[52:55], a[204:207], v[196:199]
 s_add_u32 m0, s26, 5120
 ds_read_b128 a[180:183], v3 offset:13056
 v_mfma_f32_16x16x32_bf16 v[196:199], a[68:71], a[200:203], v[196:199]
 buffer_load_dwordx4 v12, s[4:7], 0 offen nt lds
 v_mfma_f32_16x16x32_bf16 v[180:183], a[68:71], a[204:207], v[180:183]
 v_mfma_f32_16x16x32_bf16 v[180:183], a[52:55], a[160:163], v[180:183]
 v_mfma_f32_16x16x32_bf16 v[180:183], a[36:39], a[164:167], v[180:183]
 v_mfma_f32_16x16x32_bf16 v[180:183], a[20:23], a[168:171], v[180:183]
 s_add_u32 m0, s29, 16384
 v_mfma_f32_16x16x32_bf16 v[180:183], a[4:7], a[172:175], v[180:183]
 buffer_load_dwordx4 v5, s[8:11], s84 offen offset:1024 lds
 v_mfma_f32_16x16x32_bf16 v[184:187], a[8:11], a[172:175], v[184:187]
 v_mfma_f32_16x16x32_bf16 v[184:187], a[24:27], a[168:171], v[184:187]
 v_mfma_f32_16x16x32_bf16 v[184:187], a[40:43], a[164:167], v[184:187]
 v_mfma_f32_16x16x32_bf16 v[184:187], a[56:59], a[160:163], v[184:187]
 v_mfma_f32_16x16x32_bf16 v[184:187], a[72:75], a[204:207], v[184:187]
 v_mfma_f32_16x16x32_bf16 v[200:203], a[72:75], a[200:203], v[200:203]
 v_mfma_f32_16x16x32_bf16 v[200:203], a[56:59], a[204:207], v[200:203]
 v_mfma_f32_16x16x32_bf16 v[200:203], a[40:43], a[160:163], v[200:203]
 v_mfma_f32_16x16x32_bf16 v[200:203], a[24:27], a[164:167], v[200:203]
 s_add_u32 m0, s29, 18432
 v_mfma_f32_16x16x32_bf16 v[200:203], a[8:11], a[168:171], v[200:203]
 buffer_load_dwordx4 v5, s[8:11], s85 offen offset:1024 lds
 v_mfma_f32_16x16x32_bf16 v[216:219], a[8:11], a[164:167], v[216:219]
 s_add_u32 s8, s8, 0x10000
 s_addc_u32 s9, s9, 0
 v_mfma_f32_16x16x32_bf16 v[216:219], a[24:27], a[160:163], v[216:219]
 v_mfma_f32_16x16x32_bf16 v[216:219], a[40:43], a[204:207], v[216:219]
 v_mfma_f32_16x16x32_bf16 v[216:219], a[56:59], a[200:203], v[216:219]
 v_mfma_f32_16x16x32_bf16 v[216:219], a[72:75], a[196:199], v[216:219]
 v_mfma_f32_16x16x32_bf16 v[232:235], a[72:75], a[192:195], v[232:235]
 v_mfma_f32_16x16x32_bf16 v[232:235], a[56:59], a[196:199], v[232:235]
 v_mfma_f32_16x16x32_bf16 v[232:235], a[40:43], a[200:203], v[232:235]
 v_mfma_f32_16x16x32_bf16 v[232:235], a[24:27], a[204:207], v[232:235]
 v_mfma_f32_16x16x32_bf16 v[232:235], a[8:11], a[160:163], v[232:235]
 v_mfma_f32_16x16x32_bf16 v[236:239], a[12:15], a[160:163], v[236:239]
 v_mfma_f32_16x16x32_bf16 v[236:239], a[28:31], a[204:207], v[236:239]
 v_mfma_f32_16x16x32_bf16 v[236:239], a[44:47], a[200:203], v[236:239]
 v_mfma_f32_16x16x32_bf16 v[236:239], a[60:63], a[196:199], v[236:239]
 v_mfma_f32_16x16x32_bf16 v[236:239], a[76:79], a[192:195], v[236:239]
 v_mfma_f32_16x16x32_bf16 v[220:223], a[76:79], a[196:199], v[220:223]
 v_mfma_f32_16x16x32_bf16 v[220:223], a[60:63], a[200:203], v[220:223]
 v_mfma_f32_16x16x32_bf16 v[220:223], a[44:47], a[204:207], v[220:223]
 v_mfma_f32_16x16x32_bf16 v[220:223], a[28:31], a[160:163], v[220:223]
 v_mfma_f32_16x16x32_bf16 v[220:223], a[12:15], a[164:167], v[220:223]
 v_mfma_f32_16x16x32_bf16 v[204:207], a[12:15], a[168:171], v[204:207]
 s_add_u32 m0, s26, 6144
 v_mfma_f32_16x16x32_bf16 v[204:207], a[28:31], a[164:167], v[204:207]
 buffer_load_dwordx4 v13, s[4:7], 0 offen nt lds
 v_mfma_f32_16x16x32_bf16 v[204:207], a[44:47], a[160:163], v[204:207]
 v_mfma_f32_16x16x32_bf16 v[204:207], a[60:63], a[204:207], v[204:207]
 v_mfma_f32_16x16x32_bf16 v[204:207], a[76:79], a[200:203], v[204:207]
 v_mfma_f32_16x16x32_bf16 v[188:191], a[76:79], a[204:207], v[188:191]
 v_mfma_f32_16x16x32_bf16 v[188:191], a[60:63], a[160:163], v[188:191]
 v_mfma_f32_16x16x32_bf16 v[188:191], a[44:47], a[164:167], v[188:191]
 v_mfma_f32_16x16x32_bf16 v[188:191], a[28:31], a[168:171], v[188:191]
 v_mfma_f32_16x16x32_bf16 v[188:191], a[12:15], a[172:175], v[188:191]
 ds_read_b128 a[176:179], v2 offset:0
 v_mfma_f32_16x16x32_bf16 v[252:255], a[12:15], a[204:207], v[252:255]
 ds_read_b128 a[160:163], v2 offset:4352
 v_mfma_f32_16x16x32_bf16 v[252:255], a[28:31], a[200:203], v[252:255]
 ds_read_b128 a[164:167], v2 offset:8704
 v_mfma_f32_16x16x32_bf16 v[252:255], a[44:47], a[196:199], v[252:255]
 ds_read_b128 a[168:171], v2 offset:13056
 v_mfma_f32_16x16x32_bf16 v[252:255], a[60:63], a[192:195], v[252:255]
 s_waitcnt lgkmcnt(4)
 ds_read_b128 a[172:175], v2 offset:17408
 v_mfma_f32_16x16x32_bf16 v[252:255], a[76:79], a[188:191], v[252:255]
 v_mfma_f32_16x16x32_bf16 a[220:223], a[76:79], a[184:187], a[220:223]
 v_mfma_f32_16x16x32_bf16 a[220:223], a[60:63], a[188:191], a[220:223]
 v_mfma_f32_16x16x32_bf16 a[220:223], a[44:47], a[192:195], a[220:223]
 v_mfma_f32_16x16x32_bf16 a[220:223], a[28:31], a[196:199], a[220:223]
 v_mfma_f32_16x16x32_bf16 a[220:223], a[12:15], a[200:203], a[220:223]
 v_mfma_f32_16x16x32_bf16 a[236:239], a[12:15], a[196:199], a[236:239]
 v_mfma_f32_16x16x32_bf16 a[236:239], a[28:31], a[192:195], a[236:239]
 v_mfma_f32_16x16x32_bf16 a[236:239], a[44:47], a[188:191], a[236:239]
 v_mfma_f32_16x16x32_bf16 a[236:239], a[60:63], a[184:187], a[236:239]
 v_mfma_f32_16x16x32_bf16 a[236:239], a[76:79], a[180:183], a[236:239]
 v_mfma_f32_16x16x32_bf16 a[232:235], a[72:75], a[180:183], a[232:235]
 v_mfma_f32_16x16x32_bf16 a[232:235], a[56:59], a[184:187], a[232:235]
 v_mfma_f32_16x16x32_bf16 a[232:235], a[40:43], a[188:191], a[232:235]
 v_mfma_f32_16x16x32_bf16 a[232:235], a[24:27], a[192:195], a[232:235]
 v_mfma_f32_16x16x32_bf16 a[232:235], a[8:11], a[196:199], a[232:235]
 v_mfma_f32_16x16x32_bf16 a[216:219], a[8:11], a[200:203], a[216:219]
 v_mfma_f32_16x16x32_bf16 a[216:219], a[24:27], a[196:199], a[216:219]
 v_mfma_f32_16x16x32_bf16 a[216:219], a[40:43], a[192:195], a[216:219]
 v_mfma_f32_16x16x32_bf16 a[216:219], a[56:59], a[188:191], a[216:219]
 v_mfma_f32_16x16x32_bf16 a[216:219], a[72:75], a[184:187], a[216:219]
 v_mfma_f32_16x16x32_bf16 v[248:251], a[72:75], a[188:191], v[248:251]
 v_mfma_f32_16x16x32_bf16 v[248:251], a[56:59], a[192:195], v[248:251]
 v_mfma_f32_16x16x32_bf16 v[248:251], a[40:43], a[196:199], v[248:251]
 s_add_u32 m0, s26, 7168
 v_mfma_f32_16x16x32_bf16 v[248:251], a[24:27], a[200:203], v[248:251]
 buffer_load_dwordx4 v14, s[4:7], 0 offen nt lds
 v_mfma_f32_16x16x32_bf16 v[248:251], a[8:11], a[204:207], v[248:251]
 s_add_u32 s4, s4, 128
 s_addc_u32 s5, s5, 0
 s_xor_b32 s26, s26, 0x10000
 v_mfma_f32_16x16x32_bf16 v[244:247], a[4:7], a[204:207], v[244:247]
 s_xor_b32 s27, s27, s31
 global_load_dword v44, v47, s[88:89]
 v_mfma_f32_16x16x32_bf16 v[244:247], a[20:23], a[200:203], v[244:247]
 v_mfma_f32_16x16x32_bf16 v[244:247], a[36:39], a[196:199], v[244:247]
 v_mfma_f32_16x16x32_bf16 v[244:247], a[52:55], a[192:195], v[244:247]
 v_mfma_f32_16x16x32_bf16 v[244:247], a[68:71], a[188:191], v[244:247]
 v_mfma_f32_16x16x32_bf16 a[212:215], a[68:71], a[184:187], a[212:215]
 v_mfma_f32_16x16x32_bf16 a[212:215], a[52:55], a[188:191], a[212:215]
 v_mfma_f32_16x16x32_bf16 a[212:215], a[36:39], a[192:195], a[212:215]
 v_mfma_f32_16x16x32_bf16 a[212:215], a[20:23], a[196:199], a[212:215]
 v_mfma_f32_16x16x32_bf16 a[212:215], a[4:7], a[200:203], a[212:215]
 v_mfma_f32_16x16x32_bf16 a[228:231], a[4:7], a[196:199], a[228:231]
 v_mfma_f32_16x16x32_bf16 a[228:231], a[20:23], a[192:195], a[228:231]
 v_mfma_f32_16x16x32_bf16 a[228:231], a[36:39], a[188:191], a[228:231]
 v_mfma_f32_16x16x32_bf16 a[228:231], a[52:55], a[184:187], a[228:231]
 v_mfma_f32_16x16x32_bf16 a[228:231], a[68:71], a[180:183], a[228:231]
 v_mfma_f32_16x16x32_bf16 a[224:227], a[64:67], a[180:183], a[224:227]
 ds_read_b128 a[180:183], v2 offset:21760
 v_mfma_f32_16x16x32_bf16 a[224:227], a[48:51], a[184:187], a[224:227]
 v_mfma_f32_16x16x32_bf16 a[224:227], a[32:35], a[188:191], a[224:227]
 v_mfma_f32_16x16x32_bf16 a[224:227], a[16:19], a[192:195], a[224:227]
 v_mfma_f32_16x16x32_bf16 a[224:227], a[0:3], a[196:199], a[224:227]
 v_mfma_f32_16x16x32_bf16 a[208:211], a[0:3], a[200:203], a[208:211]
 v_mfma_f32_16x16x32_bf16 a[208:211], a[16:19], a[196:199], a[208:211]
 v_mfma_f32_16x16x32_bf16 a[208:211], a[32:35], a[192:195], a[208:211]
 v_mfma_f32_16x16x32_bf16 a[208:211], a[48:51], a[188:191], a[208:211]
 v_mfma_f32_16x16x32_bf16 a[208:211], a[64:67], a[184:187], a[208:211]
 ds_read_b128 a[184:187], v2 offset:26112
 v_mfma_f32_16x16x32_bf16 v[240:243], a[64:67], a[188:191], v[240:243]
 ds_read_b128 a[188:191], v2 offset:30464
 v_mfma_f32_16x16x32_bf16 v[240:243], a[48:51], a[192:195], v[240:243]
 v_mfma_f32_16x16x32_bf16 v[240:243], a[32:35], a[196:199], v[240:243]
 v_mfma_f32_16x16x32_bf16 v[240:243], a[16:19], a[200:203], v[240:243]
 v_mfma_f32_16x16x32_bf16 v[240:243], a[0:3], a[204:207], v[240:243]
 s_waitcnt vmcnt(7) lgkmcnt(2)
 ds_read_b64_tr_b16 a[0:1], v46 offset:0
 v_mfma_f32_16x16x32_bf16 v[48:51], a[80:83], a[176:179], v[48:51]
 v_mfma_f32_16x16x32_bf16 v[48:51], a[96:99], a[160:163], v[48:51]
 v_mfma_f32_16x16x32_bf16 v[48:51], a[112:115], a[164:167], v[48:51]
 ds_read_b64_tr_b16 a[2:3], v46 offset:256
 v_mfma_f32_16x16x32_bf16 v[48:51], a[128:131], a[168:171], v[48:51]
 v_mfma_f32_16x16x32_bf16 v[48:51], a[144:147], a[172:175], v[48:51]
 v_mfma_f32_16x16x32_bf16 v[64:67], a[144:147], a[180:183], v[64:67]
 ds_read_b64_tr_b16 a[4:5], v46 offset:8
 v_mfma_f32_16x16x32_bf16 v[64:67], a[128:131], a[172:175], v[64:67]
 v_mfma_f32_16x16x32_bf16 v[64:67], a[112:115], a[168:171], v[64:67]
 v_mfma_f32_16x16x32_bf16 v[64:67], a[96:99], a[164:167], v[64:67]
 ds_read_b64_tr_b16 a[6:7], v46 offset:264
 v_mfma_f32_16x16x32_bf16 v[64:67], a[80:83], a[160:163], v[64:67]
 v_mfma_f32_16x16x32_bf16 v[80:83], a[80:83], a[164:167], v[80:83]
 v_mfma_f32_16x16x32_bf16 v[80:83], a[96:99], a[168:171], v[80:83]
 ds_read_b64_tr_b16 a[16:17], v46 offset:4096
 v_mfma_f32_16x16x32_bf16 v[80:83], a[112:115], a[172:175], v[80:83]
 v_mfma_f32_16x16x32_bf16 v[80:83], a[128:131], a[180:183], v[80:83]
 s_waitcnt lgkmcnt(4)
 v_mfma_f32_16x16x32_bf16 v[80:83], a[144:147], a[184:187], v[80:83]
 s_add_u32 m0, s29, 0
 ds_read_b64_tr_b16 a[18:19], v46 offset:4352
 v_mfma_f32_16x16x32_bf16 v[96:99], a[144:147], a[188:191], v[96:99]
 s_waitcnt lgkmcnt(2)
 buffer_load_dwordx4 v5, s[8:11], s76 offen offset:0 lds
 v_mfma_f32_16x16x32_bf16 v[96:99], a[128:131], a[184:187], v[96:99]
 v_mfma_f32_16x16x32_bf16 v[96:99], a[112:115], a[180:183], v[96:99]
 ds_read_b64_tr_b16 a[20:21], v46 offset:4104
 v_mfma_f32_16x16x32_bf16 v[96:99], a[96:99], a[172:175], v[96:99]
 v_mfma_f32_16x16x32_bf16 v[96:99], a[80:83], a[168:171], v[96:99]
 v_mfma_f32_16x16x32_bf16 v[100:103], a[84:87], a[168:171], v[100:103]
 ds_read_b64_tr_b16 a[22:23], v46 offset:4360
 v_mfma_f32_16x16x32_bf16 v[100:103], a[100:103], a[172:175], v[100:103]
 v_mfma_f32_16x16x32_bf16 v[100:103], a[116:119], a[180:183], v[100:103]
 v_mfma_f32_16x16x32_bf16 v[100:103], a[132:135], a[184:187], v[100:103]
 ds_read_b128 a[192:195], v4 offset:2176
 ds_read_b64_tr_b16 a[32:33], v46 offset:8192
 v_mfma_f32_16x16x32_bf16 v[100:103], a[148:151], a[188:191], v[100:103]
 ds_read_b128 a[196:199], v4 offset:6528
 v_mfma_f32_16x16x32_bf16 v[84:87], a[148:151], a[184:187], v[84:87]
 v_mfma_f32_16x16x32_bf16 v[84:87], a[132:135], a[180:183], v[84:87]
 ds_read_b64_tr_b16 a[34:35], v46 offset:8448
 v_mfma_f32_16x16x32_bf16 v[84:87], a[116:119], a[172:175], v[84:87]
 s_add_u32 m0, s29, 2048
 v_mfma_f32_16x16x32_bf16 v[84:87], a[100:103], a[168:171], v[84:87]
 buffer_load_dwordx4 v5, s[8:11], s77 offen offset:0 lds
 v_mfma_f32_16x16x32_bf16 v[84:87], a[84:87], a[164:167], v[84:87]
 ds_read_b64_tr_b16 a[36:37], v46 offset:8200
 v_mfma_f32_16x16x32_bf16 v[68:71], a[84:87], a[160:163], v[68:71]
 v_mfma_f32_16x16x32_bf16 v[68:71], a[100:103], a[164:167], v[68:71]
 v_mfma_f32_16x16x32_bf16 v[68:71], a[116:119], a[168:171], v[68:71]
 ds_read_b64_tr_b16 a[38:39], v46 offset:8456
 v_mfma_f32_16x16x32_bf16 v[68:71], a[132:135], a[172:175], v[68:71]
 ds_read_b128 a[200:203], v4 offset:10880
 v_mfma_f32_16x16x32_bf16 v[68:71], a[148:151], a[180:183], v[68:71]
 ds_read_b128 a[204:207], v4 offset:15232
 v_mfma_f32_16x16x32_bf16 v[52:55], a[148:151], a[172:175], v[52:55]
 ds_read_b64_tr_b16 a[48:49], v46 offset:12288
 v_mfma_f32_16x16x32_bf16 v[52:55], a[132:135], a[168:171], v[52:55]
 v_mfma_f32_16x16x32_bf16 v[52:55], a[116:119], a[164:167], v[52:55]
 v_mfma_f32_16x16x32_bf16 v[52:55], a[100:103], a[160:163], v[52:55]
 ds_read_b64_tr_b16 a[50:51], v46 offset:12544
 v_mfma_f32_16x16x32_bf16 v[52:55], a[84:87], a[176:179], v[52:55]
 v_mfma_f32_16x16x32_bf16 v[56:59], a[88:91], a[176:179], v[56:59]
 s_add_u32 m0, s29, 4096
 v_mfma_f32_16x16x32_bf16 v[56:59], a[104:107], a[160:163], v[56:59]
 s_waitcnt lgkmcnt(5)
 ds_read_b64_tr_b16 a[52:53], v46 offset:12296
 buffer_load_dwordx4 v5, s[8:11], s78 offen offset:0 lds
 v_mfma_f32_16x16x32_bf16 v[56:59], a[120:123], a[164:167], v[56:59]
 v_mfma_f32_16x16x32_bf16 v[56:59], a[136:139], a[168:171], v[56:59]
 v_mfma_f32_16x16x32_bf16 v[56:59], a[152:155], a[172:175], v[56:59]
 ds_read_b64_tr_b16 a[54:55], v46 offset:12552
 v_mfma_f32_16x16x32_bf16 v[72:75], a[152:155], a[180:183], v[72:75]
 v_mfma_f32_16x16x32_bf16 v[72:75], a[136:139], a[172:175], v[72:75]
 v_mfma_f32_16x16x32_bf16 v[72:75], a[120:123], a[168:171], v[72:75]
 ds_read_b64_tr_b16 a[64:65], v46 offset:16384
 v_mfma_f32_16x16x32_bf16 v[72:75], a[104:107], a[164:167], v[72:75]
 v_mfma_f32_16x16x32_bf16 v[72:75], a[88:91], a[160:163], v[72:75]
 v_mfma_f32_16x16x32_bf16 v[88:91], a[88:91], a[164:167], v[88:91]
 ds_read_b64_tr_b16 a[66:67], v46 offset:16640
 v_mfma_f32_16x16x32_bf16 v[88:91], a[104:107], a[168:171], v[88:91]
 v_mfma_f32_16x16x32_bf16 v[88:91], a[120:123], a[172:175], v[88:91]
 v_mfma_f32_16x16x32_bf16 v[88:91], a[136:139], a[180:183], v[88:91]
 s_add_u32 m0, s29, 6144
 ds_read_b64_tr_b16 a[68:69], v46 offset:16392
 v_mfma_f32_16x16x32_bf16 v[88:91], a[152:155], a[184:187], v[88:91]
 buffer_load_dwordx4 v5, s[8:11], s79 offen offset:0 lds
 v_mfma_f32_16x16x32_bf16 v[104:107], a[152:155], a[188:191], v[104:107]
 v_mfma_f32_16x16x32_bf16 v[104:107], a[136:139], a[184:187], v[104:107]
 ds_read_b64_tr_b16 a[70:71], v46 offset:16648
 v_mfma_f32_16x16x32_bf16 v[104:107], a[120:123], a[180:183], v[104:107]
 v_mfma_f32_16x16x32_bf16 v[104:107], a[104:107], a[172:175], v[104:107]
 v_mfma_f32_16x16x32_bf16 v[104:107], a[88:91], a[168:171], v[104:107]
 ds_read_b64_tr_b16 a[8:9], v46 offset:1024
 v_mfma_f32_16x16x32_bf16 v[108:111], a[92:95], a[168:171], v[108:111]
 v_mfma_f32_16x16x32_bf16 v[108:111], a[108:111], a[172:175], v[108:111]
 v_mfma_f32_16x16x32_bf16 v[108:111], a[124:127], a[180:183], v[108:111]
 ds_read_b64_tr_b16 a[10:11], v46 offset:1280
 v_mfma_f32_16x16x32_bf16 v[108:111], a[140:143], a[184:187], v[108:111]
 v_mfma_f32_16x16x32_bf16 v[108:111], a[156:159], a[188:191], v[108:111]
 v_mfma_f32_16x16x32_bf16 v[92:95], a[156:159], a[184:187], v[92:95]
 ds_read_b64_tr_b16 a[12:13], v46 offset:1032
 v_mfma_f32_16x16x32_bf16 v[92:95], a[140:143], a[180:183], v[92:95]
 s_add_u32 m0, s29, 8192
 v_mfma_f32_16x16x32_bf16 v[92:95], a[124:127], a[172:175], v[92:95]
 s_waitcnt lgkmcnt(4)
 buffer_load_dwordx4 v5, s[8:11], s80 offen offset:0 lds
 v_mfma_f32_16x16x32_bf16 v[92:95], a[108:111], a[168:171], v[92:95]
 ds_read_b64_tr_b16 a[14:15], v46 offset:1288
 v_mfma_f32_16x16x32_bf16 v[92:95], a[92:95], a[164:167], v[92:95]
 v_mfma_f32_16x16x32_bf16 v[76:79], a[92:95], a[160:163], v[76:79]
 v_mfma_f32_16x16x32_bf16 v[76:79], a[108:111], a[164:167], v[76:79]
 ds_read_b64_tr_b16 a[24:25], v46 offset:5120
 v_mfma_f32_16x16x32_bf16 v[76:79], a[124:127], a[168:171], v[76:79]
 v_mfma_f32_16x16x32_bf16 v[76:79], a[140:143], a[172:175], v[76:79]
 v_mfma_f32_16x16x32_bf16 v[76:79], a[156:159], a[180:183], v[76:79]
 ds_read_b64_tr_b16 a[26:27], v46 offset:5376
 v_mfma_f32_16x16x32_bf16 v[60:63], a[156:159], a[172:175], v[60:63]
 v_mfma_f32_16x16x32_bf16 v[60:63], a[140:143], a[168:171], v[60:63]
 v_mfma_f32_16x16x32_bf16 v[60:63], a[124:127], a[164:167], v[60:63]
 ds_read_b64_tr_b16 a[28:29], v46 offset:5128
 v_mfma_f32_16x16x32_bf16 v[60:63], a[108:111], a[160:163], v[60:63]
 v_mfma_f32_16x16x32_bf16 v[60:63], a[92:95], a[176:179], v[60:63]
 s_add_u32 m0, s29, 10240
 v_mfma_f32_16x16x32_bf16 v[124:127], a[92:95], a[172:175], v[124:127]
 ds_read_b64_tr_b16 a[30:31], v46 offset:5384
 buffer_load_dwordx4 v5, s[8:11], s81 offen offset:0 lds
 v_mfma_f32_16x16x32_bf16 v[124:127], a[108:111], a[180:183], v[124:127]
 v_mfma_f32_16x16x32_bf16 v[124:127], a[124:127], a[184:187], v[124:127]
 v_mfma_f32_16x16x32_bf16 v[124:127], a[140:143], a[188:191], v[124:127]
 ds_read_b64_tr_b16 a[40:41], v46 offset:9216
 v_mfma_f32_16x16x32_bf16 v[124:127], a[156:159], a[192:195], v[124:127]
 v_mfma_f32_16x16x32_bf16 v[140:143], a[156:159], a[196:199], v[140:143]
 v_mfma_f32_16x16x32_bf16 v[140:143], a[140:143], a[192:195], v[140:143]
 ds_read_b64_tr_b16 a[42:43], v46 offset:9472
 v_mfma_f32_16x16x32_bf16 v[140:143], a[124:127], a[188:191], v[140:143]
 v_mfma_f32_16x16x32_bf16 v[140:143], a[108:111], a[184:187], v[140:143]
 v_mfma_f32_16x16x32_bf16 v[140:143], a[92:95], a[180:183], v[140:143]
 ds_read_b64_tr_b16 a[44:45], v46 offset:9224
 v_mfma_f32_16x16x32_bf16 v[156:159], a[92:95], a[184:187], v[156:159]
 v_mfma_f32_16x16x32_bf16 v[156:159], a[108:111], a[188:191], v[156:159]
 v_mfma_f32_16x16x32_bf16 v[156:159], a[124:127], a[192:195], v[156:159]
 s_add_u32 m0, s29, 12288
 ds_read_b64_tr_b16 a[46:47], v46 offset:9480
 v_mfma_f32_16x16x32_bf16 v[156:159], a[140:143], a[196:199], v[156:159]
 buffer_load_dwordx4 v5, s[8:11], s82 offen offset:0 lds
 v_mfma_f32_16x16x32_bf16 v[156:159], a[156:159], a[200:203], v[156:159]
 v_mfma_f32_16x16x32_bf16 v[172:175], a[156:159], a[204:207], v[172:175]
 s_waitcnt vmcnt(7)
 ds_read_b64_tr_b16 a[56:57], v46 offset:13312
 v_mfma_f32_16x16x32_bf16 v[172:175], a[140:143], a[200:203], v[172:175]
 v_mfma_f32_16x16x32_bf16 v[172:175], a[124:127], a[196:199], v[172:175]
 v_mfma_f32_16x16x32_bf16 v[172:175], a[108:111], a[192:195], v[172:175]
 ds_read_b64_tr_b16 a[58:59], v46 offset:13568
 v_mfma_f32_16x16x32_bf16 v[172:175], a[92:95], a[188:191], v[172:175]
 ds_read_b128 a[168:171], v2 offset:2176
 v_mfma_f32_16x16x32_bf16 v[168:171], a[88:91], a[188:191], v[168:171]
 ds_read_b128 a[164:167], v2 offset:6528
 v_mfma_f32_16x16x32_bf16 v[168:171], a[104:107], a[192:195], v[168:171]
 ds_read_b128 a[160:163], v2 offset:10880
 ds_read_b64_tr_b16 a[60:61], v46 offset:13320
 v_mfma_f32_16x16x32_bf16 v[168:171], a[120:123], a[196:199], v[168:171]
 ds_read_b128 a[176:179], v2 offset:15232
 v_mfma_f32_16x16x32_bf16 v[168:171], a[136:139], a[200:203], v[168:171]
 v_mfma_f32_16x16x32_bf16 v[168:171], a[152:155], a[204:207], v[168:171]
 ds_read_b64_tr_b16 a[62:63], v46 offset:13576
 v_mfma_f32_16x16x32_bf16 v[152:155], a[152:155], a[200:203], v[152:155]
 s_add_u32 m0, s29, 14336
 v_mfma_f32_16x16x32_bf16 v[152:155], a[136:139], a[196:199], v[152:155]
 buffer_load_dwordx4 v5, s[8:11], s83 offen offset:0 lds
 v_mfma_f32_16x16x32_bf16 v[152:155], a[120:123], a[192:195], v[152:155]
 ds_read_b64_tr_b16 a[72:73], v46 offset:17408
 v_mfma_f32_16x16x32_bf16 v[152:155], a[104:107], a[188:191], v[152:155]
 v_mfma_f32_16x16x32_bf16 v[152:155], a[88:91], a[184:187], v[152:155]
 v_mfma_f32_16x16x32_bf16 v[136:139], a[88:91], a[180:183], v[136:139]
 ds_read_b64_tr_b16 a[74:75], v46 offset:17664
 v_mfma_f32_16x16x32_bf16 v[136:139], a[104:107], a[184:187], v[136:139]
 v_mfma_f32_16x16x32_bf16 v[136:139], a[120:123], a[188:191], v[136:139]
 v_mfma_f32_16x16x32_bf16 v[136:139], a[136:139], a[192:195], v[136:139]
 ds_read_b64_tr_b16 a[76:77], v46 offset:17416
 v_mfma_f32_16x16x32_bf16 v[136:139], a[152:155], a[196:199], v[136:139]
 v_mfma_f32_16x16x32_bf16 v[120:123], a[152:155], a[192:195], v[120:123]
 v_mfma_f32_16x16x32_bf16 v[120:123], a[136:139], a[188:191], v[120:123]
 ds_read_b64_tr_b16 a[78:79], v46 offset:17672
 v_mfma_f32_16x16x32_bf16 v[120:123], a[120:123], a[184:187], v[120:123]
 v_mfma_f32_16x16x32_bf16 v[120:123], a[104:107], a[180:183], v[120:123]
 s_add_u32 m0, s29, 16384
 v_mfma_f32_16x16x32_bf16 v[120:123], a[88:91], a[172:175], v[120:123]
 s_waitcnt lgkmcnt(3)
 buffer_load_dwordx4 v5, s[8:11], s84 offen offset:0 lds
 v_mfma_f32_16x16x32_bf16 v[116:119], a[84:87], a[172:175], v[116:119]
 v_mfma_f32_16x16x32_bf16 v[116:119], a[100:103], a[180:183], v[116:119]
 v_mfma_f32_16x16x32_bf16 v[116:119], a[116:119], a[184:187], v[116:119]
 v_mfma_f32_16x16x32_bf16 v[116:119], a[132:135], a[188:191], v[116:119]
 v_mfma_f32_16x16x32_bf16 v[116:119], a[148:151], a[192:195], v[116:119]
 v_mfma_f32_16x16x32_bf16 v[132:135], a[148:151], a[196:199], v[132:135]
 v_mfma_f32_16x16x32_bf16 v[132:135], a[132:135], a[192:195], v[132:135]
 v_mfma_f32_16x16x32_bf16 v[132:135], a[116:119], a[188:191], v[132:135]
 v_mfma_f32_16x16x32_bf16 v[132:135], a[100:103], a[184:187], v[132:135]
 v_mfma_f32_16x16x32_bf16 v[132:135], a[84:87], a[180:183], v[132:135]
 v_mfma_f32_16x16x32_bf16 v[148:151], a[84:87], a[184:187], v[148:151]
 v_mfma_f32_16x16x32_bf16 v[148:151], a[100:103], a[188:191], v[148:151]
 s_add_u32 m0, s29, 18432
 v_mfma_f32_16x16x32_bf16 v[148:151], a[116:119], a[192:195], v[148:151]
 buffer_load_dwordx4 v5, s[8:11], s85 offen offset:0 lds
 v_mfma_f32_16x16x32_bf16 v[148:151], a[132:135], a[196:199], v[148:151]
 v_mfma_f32_16x16x32_bf16 v[148:151], a[148:151], a[200:203], v[148:151]
 v_mfma_f32_16x16x32_bf16 v[164:167], a[148:151], a[204:207], v[164:167]
 v_mfma_f32_16x16x32_bf16 v[164:167], a[132:135], a[200:203], v[164:167]
 v_mfma_f32_16x16x32_bf16 v[164:167], a[116:119], a[196:199], v[164:167]
 v_mfma_f32_16x16x32_bf16 v[164:167], a[100:103], a[192:195], v[164:167]
 v_mfma_f32_16x16x32_bf16 v[164:167], a[84:87], a[188:191], v[164:167]
 v_mfma_f32_16x16x32_bf16 v[160:163], a[80:83], a[188:191], v[160:163]
 v_mfma_f32_16x16x32_bf16 v[160:163], a[96:99], a[192:195], v[160:163]
 v_mfma_f32_16x16x32_bf16 v[160:163], a[112:115], a[196:199], v[160:163]
 v_mfma_f32_16x16x32_bf16 v[160:163], a[128:131], a[200:203], v[160:163]
 v_mfma_f32_16x16x32_bf16 v[160:163], a[144:147], a[204:207], v[160:163]
 s_add_u32 m0, s29, 0
 ds_read_b128 a[204:207], v2 offset:19584
 v_mfma_f32_16x16x32_bf16 v[144:147], a[144:147], a[200:203], v[144:147]
 ds_read_b128 a[200:203], v2 offset:23936
 buffer_load_dwordx4 v5, s[8:11], s76 offen offset:1024 lds
 v_mfma_f32_16x16x32_bf16 v[144:147], a[128:131], a[196:199], v[144:147]
 v_mfma_f32_16x16x32_bf16 v[144:147], a[112:115], a[192:195], v[144:147]
 v_mfma_f32_16x16x32_bf16 v[144:147], a[96:99], a[188:191], v[144:147]
 v_mfma_f32_16x16x32_bf16 v[144:147], a[80:83], a[184:187], v[144:147]
 v_mfma_f32_16x16x32_bf16 v[128:131], a[80:83], a[180:183], v[128:131]
 v_mfma_f32_16x16x32_bf16 v[128:131], a[96:99], a[184:187], v[128:131]
 v_mfma_f32_16x16x32_bf16 v[128:131], a[112:115], a[188:191], v[128:131]
 v_mfma_f32_16x16x32_bf16 v[128:131], a[128:131], a[192:195], v[128:131]
 v_mfma_f32_16x16x32_bf16 v[128:131], a[144:147], a[196:199], v[128:131]
 ds_read_b128 a[196:199], v2 offset:28288
 v_mfma_f32_16x16x32_bf16 v[112:115], a[144:147], a[192:195], v[112:115]
 ds_read_b128 a[192:195], v4 offset:0
 v_mfma_f32_16x16x32_bf16 v[112:115], a[128:131], a[188:191], v[112:115]
 v_mfma_f32_16x16x32_bf16 v[112:115], a[112:115], a[184:187], v[112:115]
 s_add_u32 m0, s29, 2048
 v_mfma_f32_16x16x32_bf16 v[112:115], a[96:99], a[180:183], v[112:115]
 buffer_load_dwordx4 v5, s[8:11], s77 offen offset:1024 lds
 v_mfma_f32_16x16x32_bf16 v[112:115], a[80:83], a[172:175], v[112:115]
 v_mfma_f32_16x16x32_bf16 v[176:179], a[80:83], a[168:171], v[176:179]
 v_mfma_f32_16x16x32_bf16 v[176:179], a[96:99], a[164:167], v[176:179]
 v_mfma_f32_16x16x32_bf16 v[176:179], a[112:115], a[160:163], v[176:179]
 v_mfma_f32_16x16x32_bf16 v[176:179], a[128:131], a[176:179], v[176:179]
 s_waitcnt lgkmcnt(2)
 v_mfma_f32_16x16x32_bf16 v[176:179], a[144:147], a[204:207], v[176:179]
 v_mfma_f32_16x16x32_bf16 v[192:195], a[144:147], a[200:203], v[192:195]
 v_mfma_f32_16x16x32_bf16 v[192:195], a[128:131], a[204:207], v[192:195]
 v_mfma_f32_16x16x32_bf16 v[192:195], a[112:115], a[176:179], v[192:195]
 v_mfma_f32_16x16x32_bf16 v[192:195], a[96:99], a[160:163], v[192:195]
 v_mfma_f32_16x16x32_bf16 v[192:195], a[80:83], a[164:167], v[192:195]
 v_mfma_f32_16x16x32_bf16 v[208:211], a[80:83], a[160:163], v[208:211]
 s_add_u32 m0, s29, 4096
 v_mfma_f32_16x16x32_bf16 v[208:211], a[96:99], a[176:179], v[208:211]
 buffer_load_dwordx4 v5, s[8:11], s78 offen offset:1024 lds
 v_mfma_f32_16x16x32_bf16 v[208:211], a[112:115], a[204:207], v[208:211]
 v_mfma_f32_16x16x32_bf16 v[208:211], a[128:131], a[200:203], v[208:211]
 s_waitcnt lgkmcnt(0)
 v_mfma_f32_16x16x32_bf16 v[208:211], a[144:147], a[196:199], v[208:211]
 v_mfma_f32_16x16x32_bf16 v[224:227], a[144:147], a[192:195], v[224:227]
 v_mfma_f32_16x16x32_bf16 v[224:227], a[128:131], a[196:199], v[224:227]
 v_mfma_f32_16x16x32_bf16 v[224:227], a[112:115], a[200:203], v[224:227]
 v_mfma_f32_16x16x32_bf16 v[224:227], a[96:99], a[204:207], v[224:227]
 v_mfma_f32_16x16x32_bf16 v[224:227], a[80:83], a[176:179], v[224:227]
 v_mfma_f32_16x16x32_bf16 v[228:231], a[84:87], a[176:179], v[228:231]
 v_mfma_f32_16x16x32_bf16 v[228:231], a[100:103], a[204:207], v[228:231]
 v_mfma_f32_16x16x32_bf16 v[228:231], a[116:119], a[200:203], v[228:231]
 v_mfma_f32_16x16x32_bf16 v[228:231], a[132:135], a[196:199], v[228:231]
 s_add_u32 m0, s29, 6144
 ds_read_b128 a[188:191], v4 offset:4352
 v_mfma_f32_16x16x32_bf16 v[228:231], a[148:151], a[192:195], v[228:231]
 ds_read_b128 a[184:187], v4 offset:8704
 buffer_load_dwordx4 v5, s[8:11], s79 offen offset:1024 lds
 v_mfma_f32_16x16x32_bf16 v[212:215], a[148:151], a[196:199], v[212:215]
 v_mfma_f32_16x16x32_bf16 v[212:215], a[132:135], a[200:203], v[212:215]
 v_mfma_f32_16x16x32_bf16 v[212:215], a[116:119], a[204:207], v[212:215]
 v_mfma_f32_16x16x32_bf16 v[212:215], a[100:103], a[176:179], v[212:215]
 v_mfma_f32_16x16x32_bf16 v[212:215], a[84:87], a[160:163], v[212:215]
 v_mfma_f32_16x16x32_bf16 v[196:199], a[84:87], a[164:167], v[196:199]
 v_mfma_f32_16x16x32_bf16 v[196:199], a[100:103], a[160:163], v[196:199]
 v_mfma_f32_16x16x32_bf16 v[196:199], a[116:119], a[176:179], v[196:199]
 v_mfma_f32_16x16x32_bf16 v[196:199], a[132:135], a[204:207], v[196:199]
 ds_read_b128 a[180:183], v4 offset:13056
 v_mfma_f32_16x16x32_bf16 v[196:199], a[148:151], a[200:203], v[196:199]
 v_mfma_f32_16x16x32_bf16 v[180:183], a[148:151], a[204:207], v[180:183]
 v_mfma_f32_16x16x32_bf16 v[180:183], a[132:135], a[176:179], v[180:183]
 s_add_u32 m0, s29, 8192
 v_mfma_f32_16x16x32_bf16 v[180:183], a[116:119], a[160:163], v[180:183]
 buffer_load_dwordx4 v5, s[8:11], s80 offen offset:1024 lds
 v_mfma_f32_16x16x32_bf16 v[180:183], a[100:103], a[164:167], v[180:183]
 v_mfma_f32_16x16x32_bf16 v[180:183], a[84:87], a[168:171], v[180:183]
 v_mfma_f32_16x16x32_bf16 v[184:187], a[88:91], a[168:171], v[184:187]
 v_mfma_f32_16x16x32_bf16 v[184:187], a[104:107], a[164:167], v[184:187]
 v_mfma_f32_16x16x32_bf16 v[184:187], a[120:123], a[160:163], v[184:187]
 v_mfma_f32_16x16x32_bf16 v[184:187], a[136:139], a[176:179], v[184:187]
 v_mfma_f32_16x16x32_bf16 v[184:187], a[152:155], a[204:207], v[184:187]
 v_mfma_f32_16x16x32_bf16 v[200:203], a[152:155], a[200:203], v[200:203]
 v_mfma_f32_16x16x32_bf16 v[200:203], a[136:139], a[204:207], v[200:203]
 v_mfma_f32_16x16x32_bf16 v[200:203], a[120:123], a[176:179], v[200:203]
 v_mfma_f32_16x16x32_bf16 v[200:203], a[104:107], a[160:163], v[200:203]
 v_mfma_f32_16x16x32_bf16 v[200:203], a[88:91], a[164:167], v[200:203]
 s_add_u32 m0, s29, 10240
 v_mfma_f32_16x16x32_bf16 v[216:219], a[88:91], a[160:163], v[216:219]
 buffer_load_dwordx4 v5, s[8:11], s81 offen offset:1024 lds
 v_mfma_f32_16x16x32_bf16 v[216:219], a[104:107], a[176:179], v[216:219]
 v_mfma_f32_16x16x32_bf16 v[216:219], a[120:123], a[204:207], v[216:219]
 v_mfma_f32_16x16x32_bf16 v[216:219], a[136:139], a[200:203], v[216:219]
 v_mfma_f32_16x16x32_bf16 v[216:219], a[152:155], a[196:199], v[216:219]
 v_mfma_f32_16x16x32_bf16 v[232:235], a[152:155], a[192:195], v[232:235]
 v_mfma_f32_16x16x32_bf16 v[232:235], a[136:139], a[196:199], v[232:235]
 v_mfma_f32_16x16x32_bf16 v[232:235], a[120:123], a[200:203], v[232:235]
 v_mfma_f32_16x16x32_bf16 v[232:235], a[104:107], a[204:207], v[232:235]
 v_mfma_f32_16x16x32_bf16 v[232:235], a[88:91], a[176:179], v[232:235]
 v_mfma_f32_16x16x32_bf16 v[236:239], a[92:95], a[176:179], v[236:239]
 v_mfma_f32_16x16x32_bf16 v[236:239], a[108:111], a[204:207], v[236:239]
 v_mfma_f32_16x16x32_bf16 v[236:239], a[124:127], a[200:203], v[236:239]
 s_add_u32 m0, s29, 12288
 v_mfma_f32_16x16x32_bf16 v[236:239], a[140:143], a[196:199], v[236:239]
 buffer_load_dwordx4 v5, s[8:11], s82 offen offset:1024 lds
 v_mfma_f32_16x16x32_bf16 v[236:239], a[156:159], a[192:195], v[236:239]
 v_mfma_f32_16x16x32_bf16 v[220:223], a[156:159], a[196:199], v[220:223]
 v_mfma_f32_16x16x32_bf16 v[220:223], a[140:143], a[200:203], v[220:223]
 v_mfma_f32_16x16x32_bf16 v[220:223], a[124:127], a[204:207], v[220:223]
 v_mfma_f32_16x16x32_bf16 v[220:223], a[108:111], a[176:179], v[220:223]
 v_mfma_f32_16x16x32_bf16 v[220:223], a[92:95], a[160:163], v[220:223]
 v_mfma_f32_16x16x32_bf16 v[204:207], a[92:95], a[164:167], v[204:207]
 v_mfma_f32_16x16x32_bf16 v[204:207], a[108:111], a[160:163], v[204:207]
 v_mfma_f32_16x16x32_bf16 v[204:207], a[124:127], a[176:179], v[204:207]
 v_mfma_f32_16x16x32_bf16 v[204:207], a[140:143], a[204:207], v[204:207]
 v_mfma_f32_16x16x32_bf16 v[204:207], a[156:159], a[200:203], v[204:207]
 v_mfma_f32_16x16x32_bf16 v[188:191], a[156:159], a[204:207], v[188:191]
 s_add_u32 m0, s29, 14336
 v_mfma_f32_16x16x32_bf16 v[188:191], a[140:143], a[176:179], v[188:191]
 buffer_load_dwordx4 v5, s[8:11], s83 offen offset:1024 lds
 v_mfma_f32_16x16x32_bf16 v[188:191], a[124:127], a[160:163], v[188:191]
 s_waitcnt lgkmcnt(0)
 s_barrier
 v_mfma_f32_16x16x32_bf16 v[188:191], a[108:111], a[164:167], v[188:191]
 v_xor_b32 v1, 0x10000, v1
 v_xor_b32 v2, 0x10000, v2
 v_mfma_f32_16x16x32_bf16 v[188:191], a[92:95], a[168:171], v[188:191]
 v_xor_b32 v3, 0x10000, v3
 v_xor_b32 v4, 0x10000, v4
 v_mfma_f32_16x16x32_bf16 v[252:255], a[92:95], a[204:207], v[252:255]
 ds_read_b128 a[160:163], v1 offset:0
 ds_read_b128 a[164:167], v1 offset:4352
 v_mfma_f32_16x16x32_bf16 v[252:255], a[108:111], a[200:203], v[252:255]
 ds_read_b128 a[168:171], v1 offset:8704
 ds_read_b128 a[172:175], v1 offset:13056
 v_mfma_f32_16x16x32_bf16 v[252:255], a[124:127], a[196:199], v[252:255]
 ds_read_b128 a[176:179], v1 offset:17408
 v_mfma_f32_16x16x32_bf16 v[252:255], a[140:143], a[192:195], v[252:255]
 v_mfma_f32_16x16x32_bf16 v[252:255], a[156:159], a[188:191], v[252:255]
 v_mfma_f32_16x16x32_bf16 a[220:223], a[156:159], a[184:187], a[220:223]
 v_mfma_f32_16x16x32_bf16 a[220:223], a[140:143], a[188:191], a[220:223]
 v_mfma_f32_16x16x32_bf16 a[220:223], a[124:127], a[192:195], a[220:223]
 v_mfma_f32_16x16x32_bf16 a[220:223], a[108:111], a[196:199], a[220:223]
 s_add_u32 m0, s29, 16384
 v_mfma_f32_16x16x32_bf16 a[220:223], a[92:95], a[200:203], a[220:223]
 buffer_load_dwordx4 v5, s[8:11], s84 offen offset:1024 lds
 v_mfma_f32_16x16x32_bf16 a[236:239], a[92:95], a[196:199], a[236:239]
 v_mfma_f32_16x16x32_bf16 a[236:239], a[108:111], a[192:195], a[236:239]
 v_mfma_f32_16x16x32_bf16 a[236:239], a[124:127], a[188:191], a[236:239]
 v_mfma_f32_16x16x32_bf16 a[236:239], a[140:143], a[184:187], a[236:239]
 v_mfma_f32_16x16x32_bf16 a[236:239], a[156:159], a[180:183], a[236:239]
 v_mfma_f32_16x16x32_bf16 a[232:235], a[152:155], a[180:183], a[232:235]
 v_mfma_f32_16x16x32_bf16 a[232:235], a[136:139], a[184:187], a[232:235]
 v_mfma_f32_16x16x32_bf16 a[232:235], a[120:123], a[188:191], a[232:235]
 v_mfma_f32_16x16x32_bf16 a[232:235], a[104:107], a[192:195], a[232:235]
 v_mfma_f32_16x16x32_bf16 a[232:235], a[88:91], a[196:199], a[232:235]
 v_mfma_f32_16x16x32_bf16 a[216:219], a[88:91], a[200:203], a[216:219]
 v_mfma_f32_16x16x32_bf16 a[216:219], a[104:107], a[196:199], a[216:219]
 s_add_u32 m0, s29, 18432
 v_mfma_f32_16x16x32_bf16 a[216:219], a[120:123], a[192:195], a[216:219]
 buffer_load_dwordx4 v5, s[8:11], s85 offen offset:1024 lds
 v_mfma_f32_16x16x32_bf16 a[216:219], a[136:139], a[188:191], a[216:219]
 s_add_u32 s8, s8, 0x10000
 s_addc_u32 s9, s9, 0
 v_mfma_f32_16x16x32_bf16 a[216:219], a[152:155], a[184:187], a[216:219]
 v_mfma_f32_16x16x32_bf16 v[248:251], a[152:155], a[188:191], v[248:251]
 v_mfma_f32_16x16x32_bf16 v[248:251], a[136:139], a[192:195], v[248:251]
 v_mfma_f32_16x16x32_bf16 v[248:251], a[120:123], a[196:199], v[248:251]
 v_mfma_f32_16x16x32_bf16 v[248:251], a[104:107], a[200:203], v[248:251]
 v_mfma_f32_16x16x32_bf16 v[248:251], a[88:91], a[204:207], v[248:251]
 v_mfma_f32_16x16x32_bf16 v[244:247], a[84:87], a[204:207], v[244:247]
 v_mfma_f32_16x16x32_bf16 v[244:247], a[100:103], a[200:203], v[244:247]
 v_mfma_f32_16x16x32_bf16 v[244:247], a[116:119], a[196:199], v[244:247]
 v_mfma_f32_16x16x32_bf16 v[244:247], a[132:135], a[192:195], v[244:247]
 v_mfma_f32_16x16x32_bf16 v[244:247], a[148:151], a[188:191], v[244:247]
 v_mfma_f32_16x16x32_bf16 a[212:215], a[148:151], a[184:187], a[212:215]
 v_mfma_f32_16x16x32_bf16 a[212:215], a[132:135], a[188:191], a[212:215]
 v_mfma_f32_16x16x32_bf16 a[212:215], a[116:119], a[192:195], a[212:215]
 v_mfma_f32_16x16x32_bf16 a[212:215], a[100:103], a[196:199], a[212:215]
 v_mfma_f32_16x16x32_bf16 a[212:215], a[84:87], a[200:203], a[212:215]
 v_mfma_f32_16x16x32_bf16 a[228:231], a[84:87], a[196:199], a[228:231]
 v_mfma_f32_16x16x32_bf16 a[228:231], a[100:103], a[192:195], a[228:231]
 v_mfma_f32_16x16x32_bf16 a[228:231], a[116:119], a[188:191], a[228:231]
 v_mfma_f32_16x16x32_bf16 a[228:231], a[132:135], a[184:187], a[228:231]
 v_mfma_f32_16x16x32_bf16 a[228:231], a[148:151], a[180:183], a[228:231]
 v_mfma_f32_16x16x32_bf16 a[224:227], a[144:147], a[180:183], a[224:227]
 ds_read_b128 a[180:183], v1 offset:21760
 v_mfma_f32_16x16x32_bf16 a[224:227], a[128:131], a[184:187], a[224:227]
 v_mfma_f32_16x16x32_bf16 a[224:227], a[112:115], a[188:191], a[224:227]
 v_mfma_f32_16x16x32_bf16 a[224:227], a[96:99], a[192:195], a[224:227]
 v_mfma_f32_16x16x32_bf16 a[224:227], a[80:83], a[196:199], a[224:227]
 v_mfma_f32_16x16x32_bf16 a[208:211], a[80:83], a[200:203], a[208:211]
 v_mfma_f32_16x16x32_bf16 a[208:211], a[96:99], a[196:199], a[208:211]
 v_mfma_f32_16x16x32_bf16 a[208:211], a[112:115], a[192:195], a[208:211]
 v_mfma_f32_16x16x32_bf16 a[208:211], a[128:131], a[188:191], a[208:211]
 v_mfma_f32_16x16x32_bf16 a[208:211], a[144:147], a[184:187], a[208:211]
 v_mfma_f32_16x16x32_bf16 v[240:243], a[144:147], a[188:191], v[240:243]
 v_mfma_f32_16x16x32_bf16 v[240:243], a[128:131], a[192:195], v[240:243]
 v_mfma_f32_16x16x32_bf16 v[240:243], a[112:115], a[196:199], v[240:243]
 v_mfma_f32_16x16x32_bf16 v[240:243], a[96:99], a[200:203], v[240:243]
 v_mfma_f32_16x16x32_bf16 v[240:243], a[80:83], a[204:207], v[240:243]
 s_sub_u32 s30, s30, 1
 s_cmp_lg_u32 s30, 0
 s_cbranch_scc1 L_mid15
L_f15:
 s_waitcnt lgkmcnt(5)
 ds_read_b128 a[184:187], v1 offset:26112
 v_mfma_f32_16x16x32_bf16 v[48:51], a[0:3], a[160:163], v[48:51]
 s_waitcnt lgkmcnt(5)
 v_mfma_f32_16x16x32_bf16 v[48:51], a[16:19], a[164:167], v[48:51]
 s_waitcnt vmcnt(18) lgkmcnt(4)
 ds_read_b64_tr_b16 a[80:81], v46 offset:0
 v_mfma_f32_16x16x32_bf16 v[48:51], a[32:35], a[168:171], v[48:51]
 s_waitcnt lgkmcnt(4)
 ds_read_b64_tr_b16 a[82:83], v46 offset:256
 v_mfma_f32_16x16x32_bf16 v[48:51], a[48:51], a[172:175], v[48:51]
 s_waitcnt lgkmcnt(4)
 ds_read_b128 a[188:191], v1 offset:30464
 ds_read_b64_tr_b16 a[84:85], v46 offset:8
 v_mfma_f32_16x16x32_bf16 v[48:51], a[64:67], a[176:179], v[48:51]
 ds_read_b64_tr_b16 a[86:87], v46 offset:264
 v_mfma_f32_16x16x32_bf16 v[52:55], a[68:71], a[176:179], v[52:55]
 s_waitcnt vmcnt(16)
 ds_read_b64_tr_b16 a[96:97], v46 offset:4096
 v_mfma_f32_16x16x32_bf16 v[52:55], a[52:55], a[172:175], v[52:55]
 ds_read_b64_tr_b16 a[98:99], v46 offset:4352
 v_mfma_f32_16x16x32_bf16 v[52:55], a[36:39], a[168:171], v[52:55]
 ds_read_b64_tr_b16 a[100:101], v46 offset:4104
 v_mfma_f32_16x16x32_bf16 v[52:55], a[20:23], a[164:167], v[52:55]
 ds_read_b64_tr_b16 a[102:103], v46 offset:4360
 v_mfma_f32_16x16x32_bf16 v[52:55], a[4:7], a[160:163], v[52:55]
 s_waitcnt vmcnt(14)
 ds_read_b64_tr_b16 a[112:113], v46 offset:8192
 v_mfma_f32_16x16x32_bf16 v[56:59], a[8:11], a[160:163], v[56:59]
 ds_read_b64_tr_b16 a[114:115], v46 offset:8448
 v_mfma_f32_16x16x32_bf16 v[56:59], a[24:27], a[164:167], v[56:59]
 ds_read_b64_tr_b16 a[116:117], v46 offset:8200
 v_mfma_f32_16x16x32_bf16 v[56:59], a[40:43], a[168:171], v[56:59]
 ds_read_b64_tr_b16 a[118:119], v46 offset:8456
 v_mfma_f32_16x16x32_bf16 v[56:59], a[56:59], a[172:175], v[56:59]
 s_waitcnt vmcnt(12)
 ds_read_b64_tr_b16 a[128:129], v46 offset:12288
 v_mfma_f32_16x16x32_bf16 v[56:59], a[72:75], a[176:179], v[56:59]
 ds_read_b64_tr_b16 a[130:131], v46 offset:12544
 v_mfma_f32_16x16x32_bf16 v[60:63], a[76:79], a[176:179], v[60:63]
 ds_read_b64_tr_b16 a[132:133], v46 offset:12296
 v_mfma_f32_16x16x32_bf16 v[60:63], a[60:63], a[172:175], v[60:63]
 ds_read_b64_tr_b16 a[134:135], v46 offset:12552
 v_mfma_f32_16x16x32_bf16 v[60:63], a[44:47], a[168:171], v[60:63]
 s_waitcnt vmcnt(10)
 ds_read_b64_tr_b16 a[144:145], v46 offset:16384
 v_mfma_f32_16x16x32_bf16 v[60:63], a[28:31], a[164:167], v[60:63]
 ds_read_b64_tr_b16 a[146:147], v46 offset:16640
 v_mfma_f32_16x16x32_bf16 v[60:63], a[12:15], a[160:163], v[60:63]
 ds_read_b128 a[192:195], v2 offset:0
 ds_read_b64_tr_b16 a[148:149], v46 offset:16392
 v_mfma_f32_16x16x32_bf16 v[76:79], a[12:15], a[164:167], v[76:79]
 ds_read_b128 a[196:199], v2 offset:4352
 ds_read_b64_tr_b16 a[150:151], v46 offset:16648
 v_mfma_f32_16x16x32_bf16 v[76:79], a[28:31], a[168:171], v[76:79]
 s_waitcnt vmcnt(8)
 ds_read_b128 a[200:203], v2 offset:8704
 ds_read_b64_tr_b16 a[88:89], v46 offset:1024
 v_mfma_f32_16x16x32_bf16 v[76:79], a[44:47], a[172:175], v[76:79]
 ds_read_b128 a[204:207], v2 offset:13056
 ds_read_b64_tr_b16 a[90:91], v46 offset:1280
 v_mfma_f32_16x16x32_bf16 v[76:79], a[60:63], a[176:179], v[76:79]
 s_waitcnt lgkmcnt(15)
 ds_read_b128 a[160:163], v2 offset:17408
 ds_read_b64_tr_b16 a[92:93], v46 offset:1032
 v_mfma_f32_16x16x32_bf16 v[76:79], a[76:79], a[180:183], v[76:79]
 ds_read_b64_tr_b16 a[94:95], v46 offset:1288
 v_mfma_f32_16x16x32_bf16 v[72:75], a[72:75], a[180:183], v[72:75]
 s_waitcnt vmcnt(6)
 ds_read_b64_tr_b16 a[104:105], v46 offset:5120
 v_mfma_f32_16x16x32_bf16 v[72:75], a[56:59], a[176:179], v[72:75]
 ds_read_b64_tr_b16 a[106:107], v46 offset:5376
 v_mfma_f32_16x16x32_bf16 v[72:75], a[40:43], a[172:175], v[72:75]
 ds_read_b64_tr_b16 a[108:109], v46 offset:5128
 v_mfma_f32_16x16x32_bf16 v[72:75], a[24:27], a[168:171], v[72:75]
 ds_read_b64_tr_b16 a[110:111], v46 offset:5384
 v_mfma_f32_16x16x32_bf16 v[72:75], a[8:11], a[164:167], v[72:75]
 s_waitcnt vmcnt(4)
 ds_read_b64_tr_b16 a[120:121], v46 offset:9216
 v_mfma_f32_16x16x32_bf16 v[68:71], a[4:7], a[164:167], v[68:71]
 ds_read_b64_tr_b16 a[122:123], v46 offset:9472
 v_mfma_f32_16x16x32_bf16 v[68:71], a[20:23], a[168:171], v[68:71]
 ds_read_b64_tr_b16 a[124:125], v46 offset:9224
 v_mfma_f32_16x16x32_bf16 v[68:71], a[36:39], a[172:175], v[68:71]
 ds_read_b64_tr_b16 a[126:127], v46 offset:9480
 v_mfma_f32_16x16x32_bf16 v[68:71], a[52:55], a[176:179], v[68:71]
 s_waitcnt vmcnt(2)
 ds_read_b64_tr_b16 a[136:137], v46 offset:13312
 v_mfma_f32_16x16x32_bf16 v[68:71], a[68:71], a[180:183], v[68:71]
 ds_read_b64_tr_b16 a[138:139], v46 offset:13568
 v_mfma_f32_16x16x32_bf16 v[64:67], a[64:67], a[180:183], v[64:67]
 ds_read_b64_tr_b16 a[140:141], v46 offset:13320
 v_mfma_f32_16x16x32_bf16 v[64:67], a[48:51], a[176:179], v[64:67]
 ds_read_b64_tr_b16 a[142:143], v46 offset:13576
 v_mfma_f32_16x16x32_bf16 v[64:67], a[32:35], a[172:175], v[64:67]
 s_waitcnt vmcnt(0)
 ds_read_b64_tr_b16 a[152:153], v46 offset:17408
 v_mfma_f32_16x16x32_bf16 v[64:67], a[16:19], a[168:171], v[64:67]
 ds_read_b64_tr_b16 a[154:155], v46 offset:17664
 v_mfma_f32_16x16x32_bf16 v[64:67], a[0:3], a[164:167], v[64:67]
 ds_read_b64_tr_b16 a[156:157], v46 offset:17416
 v_mfma_f32_16x16x32_bf16 v[80:83], a[0:3], a[168:171], v[80:83]
 ds_read_b64_tr_b16 a[158:159], v46 offset:17672
 v_mfma_f32_16x16x32_bf16 v[80:83], a[16:19], a[172:175], v[80:83]
 v_mfma_f32_16x16x32_bf16 v[80:83], a[32:35], a[176:179], v[80:83]
 v_mfma_f32_16x16x32_bf16 v[80:83], a[48:51], a[180:183], v[80:83]
 ds_read_b128 a[164:167], v2 offset:21760
 v_mfma_f32_16x16x32_bf16 v[80:83], a[64:67], a[184:187], v[80:83]
 v_mfma_f32_16x16x32_bf16 v[84:87], a[68:71], a[184:187], v[84:87]
 v_mfma_f32_16x16x32_bf16 v[84:87], a[52:55], a[180:183], v[84:87]
 v_mfma_f32_16x16x32_bf16 v[84:87], a[36:39], a[176:179], v[84:87]
 v_mfma_f32_16x16x32_bf16 v[84:87], a[20:23], a[172:175], v[84:87]
 v_mfma_f32_16x16x32_bf16 v[84:87], a[4:7], a[168:171], v[84:87]
 v_mfma_f32_16x16x32_bf16 v[88:91], a[8:11], a[168:171], v[88:91]
 v_mfma_f32_16x16x32_bf16 v[88:91], a[24:27], a[172:175], v[88:91]
 v_mfma_f32_16x16x32_bf16 v[88:91], a[40:43], a[176:179], v[88:91]
 v_mfma_f32_16x16x32_bf16 v[88:91], a[56:59], a[180:183], v[88:91]
 v_mfma_f32_16x16x32_bf16 v[88:91], a[72:75], a[184:187], v[88:91]
 v_mfma_f32_16x16x32_bf16 v[92:95], a[76:79], a[184:187], v[92:95]
 v_mfma_f32_16x16x32_bf16 v[92:95], a[60:63], a[180:183], v[92:95]
 v_mfma_f32_16x16x32_bf16 v[92:95], a[44:47], a[176:179], v[92:95]
 v_mfma_f32_16x16x32_bf16 v[92:95], a[28:31], a[172:175], v[92:95]
 v_mfma_f32_16x16x32_bf16 v[92:95], a[12:15], a[168:171], v[92:95]
 v_mfma_f32_16x16x32_bf16 v[108:111], a[12:15], a[172:175], v[108:111]
 v_mfma_f32_16x16x32_bf16 v[108:111], a[28:31], a[176:179], v[108:111]
 v_mfma_f32_16x16x32_bf16 v[108:111], a[44:47], a[180:183], v[108:111]
 v_mfma_f32_16x16x32_bf16 v[108:111], a[60:63], a[184:187], v[108:111]
 ds_read_b128 a[168:171], v2 offset:26112
 v_mfma_f32_16x16x32_bf16 v[108:111], a[76:79], a[188:191], v[108:111]
 v_mfma_f32_16x16x32_bf16 v[104:107], a[72:75], a[188:191], v[104:107]
 v_mfma_f32_16x16x32_bf16 v[104:107], a[56:59], a[184:187], v[104:107]
 v_mfma_f32_16x16x32_bf16 v[104:107], a[40:43], a[180:183], v[104:107]
 v_mfma_f32_16x16x32_bf16 v[104:107], a[24:27], a[176:179], v[104:107]
 v_mfma_f32_16x16x32_bf16 v[104:107], a[8:11], a[172:175], v[104:107]
 v_mfma_f32_16x16x32_bf16 v[100:103], a[4:7], a[172:175], v[100:103]
 v_mfma_f32_16x16x32_bf16 v[100:103], a[20:23], a[176:179], v[100:103]
 v_mfma_f32_16x16x32_bf16 v[100:103], a[36:39], a[180:183], v[100:103]
 v_mfma_f32_16x16x32_bf16 v[100:103], a[52:55], a[184:187], v[100:103]
 v_mfma_f32_16x16x32_bf16 v[100:103], a[68:71], a[188:191], v[100:103]
 v_mfma_f32_16x16x32_bf16 v[96:99], a[64:67], a[188:191], v[96:99]
 v_mfma_f32_16x16x32_bf16 v[96:99], a[48:51], a[184:187], v[96:99]
 v_mfma_f32_16x16x32_bf16 v[96:99], a[32:35], a[180:183], v[96:99]
 v_mfma_f32_16x16x32_bf16 v[96:99], a[16:19], a[176:179], v[96:99]
 v_mfma_f32_16x16x32_bf16 v[96:99], a[0:3], a[172:175], v[96:99]
 s_waitcnt lgkmcnt(0)
 v_mfma_f32_16x16x32_bf16 v[48:51], a[80:83], a[192:195], v[48:51]
 v_mfma_f32_16x16x32_bf16 v[48:51], a[96:99], a[196:199], v[48:51]
 v_mfma_f32_16x16x32_bf16 v[48:51], a[112:115], a[200:203], v[48:51]
 v_mfma_f32_16x16x32_bf16 v[48:51], a[128:131], a[204:207], v[48:51]
 ds_read_b128 a[188:191], v2 offset:30464
 v_mfma_f32_16x16x32_bf16 v[48:51], a[144:147], a[160:163], v[48:51]
 v_mfma_f32_16x16x32_bf16 v[52:55], a[148:151], a[160:163], v[52:55]
 v_mfma_f32_16x16x32_bf16 v[52:55], a[132:135], a[204:207], v[52:55]
 v_mfma_f32_16x16x32_bf16 v[52:55], a[116:119], a[200:203], v[52:55]
 v_mfma_f32_16x16x32_bf16 v[52:55], a[100:103], a[196:199], v[52:55]
 v_mfma_f32_16x16x32_bf16 v[52:55], a[84:87], a[192:195], v[52:55]
 v_mfma_f32_16x16x32_bf16 v[56:59], a[88:91], a[192:195], v[56:59]
 v_mfma_f32_16x16x32_bf16 v[56:59], a[104:107], a[196:199], v[56:59]
 v_mfma_f32_16x16x32_bf16 v[56:59], a[120:123], a[200:203], v[56:59]
 v_mfma_f32_16x16x32_bf16 v[56:59], a[136:139], a[204:207], v[56:59]
 v_mfma_f32_16x16x32_bf16 v[56:59], a[152:155], a[160:163], v[56:59]
 v_mfma_f32_16x16x32_bf16 v[60:63], a[156:159], a[160:163], v[60:63]
 v_mfma_f32_16x16x32_bf16 v[60:63], a[140:143], a[204:207], v[60:63]
 v_mfma_f32_16x16x32_bf16 v[60:63], a[124:127], a[200:203], v[60:63]
 v_mfma_f32_16x16x32_bf16 v[60:63], a[108:111], a[196:199], v[60:63]
 v_mfma_f32_16x16x32_bf16 v[60:63], a[92:95], a[192:195], v[60:63]
 ds_read_b128 a[184:187], v1 offset:17408
 v_mfma_f32_16x16x32_bf16 v[76:79], a[92:95], a[196:199], v[76:79]
 ds_read_b128 a[180:183], v1 offset:21760
 v_mfma_f32_16x16x32_bf16 v[76:79], a[108:111], a[200:203], v[76:79]
 ds_read_b128 a[176:179], v1 offset:26112
 v_mfma_f32_16x16x32_bf16 v[76:79], a[124:127], a[204:207], v[76:79]
 ds_read_b128 a[172:175], v1 offset:30464
 v_mfma_f32_16x16x32_bf16 v[76:79], a[140:143], a[160:163], v[76:79]
 ds_read_b128 a[192:195], v3 offset:2176
 v_mfma_f32_16x16x32_bf16 v[76:79], a[156:159], a[164:167], v[76:79]
 v_mfma_f32_16x16x32_bf16 v[72:75], a[152:155], a[164:167], v[72:75]
 v_mfma_f32_16x16x32_bf16 v[72:75], a[136:139], a[160:163], v[72:75]
 v_mfma_f32_16x16x32_bf16 v[72:75], a[120:123], a[204:207], v[72:75]
 v_mul_f32 v20, s42, v48
 v_mul_f32 v21, s42, v49
 v_mfma_f32_16x16x32_bf16 v[72:75], a[104:107], a[200:203], v[72:75]
 v_mul_f32 v22, s42, v50
 v_mul_f32 v23, s42, v51
 v_mfma_f32_16x16x32_bf16 v[72:75], a[88:91], a[196:199], v[72:75]
 v_min_f32 v20, s47, v20
 v_min_f32 v21, s47, v21
 v_mfma_f32_16x16x32_bf16 v[68:71], a[84:87], a[196:199], v[68:71]
 v_min_f32 v22, s47, v22
 v_min_f32 v23, s47, v23
 v_mfma_f32_16x16x32_bf16 v[68:71], a[100:103], a[200:203], v[68:71]
 v_exp_f32 v20, v20
 v_mul_f32 v24, s43, v56
 v_mfma_f32_16x16x32_bf16 v[68:71], a[116:119], a[204:207], v[68:71]
 v_mul_f32 v25, s43, v57
 v_mul_f32 v26, s43, v58
 v_mfma_f32_16x16x32_bf16 v[68:71], a[132:135], a[160:163], v[68:71]
 v_exp_f32 v21, v21
 v_mfma_f32_16x16x32_bf16 v[68:71], a[148:151], a[164:167], v[68:71]
 v_mul_f32 v27, s43, v59
 v_add_f32 v28, 1.0, v20
 v_mfma_f32_16x16x32_bf16 v[64:67], a[144:147], a[164:167], v[64:67]
 v_exp_f32 v22, v22
 v_mfma_f32_16x16x32_bf16 v[64:67], a[128:131], a[160:163], v[64:67]
 v_exp_f32 v23, v23
 v_mfma_f32_16x16x32_bf16 v[64:67], a[112:115], a[204:207], v[64:67]
 v_exp_f32 v24, v24
 v_add_f32 v29, 1.0, v21
 v_mfma_f32_16x16x32_bf16 v[64:67], a[96:99], a[200:203], v[64:67]
 v_exp_f32 v25, v25
 v_mfma_f32_16x16x32_bf16 v[64:67], a[80:83], a[196:199], v[64:67]
 v_add_f32 v30, 1.0, v22
 v_add_f32 v31, 1.0, v23
 v_mfma_f32_16x16x32_bf16 v[80:83], a[80:83], a[200:203], v[80:83]
 v_exp_f32 v26, v26
 v_mfma_f32_16x16x32_bf16 v[80:83], a[96:99], a[204:207], v[80:83]
 v_exp_f32 v27, v27
 v_mfma_f32_16x16x32_bf16 v[80:83], a[112:115], a[160:163], v[80:83]
 v_fmac_f32 v28, v28, v24
 v_fmac_f32 v29, v29, v25
 v_fmac_f32 v30, v30, v26
 v_mfma_f32_16x16x32_bf16 v[80:83], a[128:131], a[164:167], v[80:83]
 ds_read_b128 a[196:199], v3 offset:6528
 v_fmac_f32 v31, v31, v27
 v_mfma_f32_16x16x32_bf16 v[80:83], a[144:147], a[168:171], v[80:83]
 v_rcp_f32 v28, v28
 v_mfma_f32_16x16x32_bf16 v[84:87], a[148:151], a[168:171], v[84:87]
 v_rcp_f32 v29, v29
 v_mfma_f32_16x16x32_bf16 v[84:87], a[132:135], a[164:167], v[84:87]
 v_rcp_f32 v30, v30
 v_mfma_f32_16x16x32_bf16 v[84:87], a[116:119], a[160:163], v[84:87]
 v_rcp_f32 v31, v31
 v_fma_f32 v20, v20, v28, -v28
 v_mfma_f32_16x16x32_bf16 v[84:87], a[100:103], a[204:207], v[84:87]
 v_fma_f32 v21, v21, v29, -v29
 v_fma_f32 v22, v22, v30, -v30
 v_mfma_f32_16x16x32_bf16 v[84:87], a[84:87], a[200:203], v[84:87]
 v_fma_f32 v23, v23, v31, -v31
 v_cvt_pk_bf16_f32 v16, v20, v21
 v_mfma_f32_16x16x32_bf16 v[88:91], a[88:91], a[200:203], v[88:91]
 v_cvt_pk_bf16_f32 v17, v22, v23
 v_mul_f32 v32, s42, v52
 v_mfma_f32_16x16x32_bf16 v[88:91], a[104:107], a[204:207], v[88:91]
 v_mul_f32 v33, s42, v53
 v_mul_f32 v34, s42, v54
 v_mfma_f32_16x16x32_bf16 v[88:91], a[120:123], a[160:163], v[88:91]
 v_mul_f32 v35, s42, v55
 v_min_f32 v32, s47, v32
 v_mfma_f32_16x16x32_bf16 v[88:91], a[136:139], a[164:167], v[88:91]
 v_min_f32 v33, s47, v33
 v_min_f32 v34, s47, v34
 v_min_f32 v35, s47, v35
 v_mfma_f32_16x16x32_bf16 v[88:91], a[152:155], a[168:171], v[88:91]
 v_exp_f32 v32, v32
 v_mfma_f32_16x16x32_bf16 v[92:95], a[156:159], a[168:171], v[92:95]
 v_mul_f32 v40, s43, v60
 v_mul_f32 v41, s43, v61
 v_mfma_f32_16x16x32_bf16 v[92:95], a[140:143], a[164:167], v[92:95]
 v_exp_f32 v33, v33
 v_mfma_f32_16x16x32_bf16 v[92:95], a[124:127], a[160:163], v[92:95]
 v_mul_f32 v42, s43, v62
 v_mul_f32 v43, s43, v63
 v_mfma_f32_16x16x32_bf16 v[92:95], a[108:111], a[204:207], v[92:95]
 v_exp_f32 v34, v34
 v_add_f32 v28, 1.0, v32
 v_mfma_f32_16x16x32_bf16 v[92:95], a[92:95], a[200:203], v[92:95]
 v_exp_f32 v35, v35
 v_mfma_f32_16x16x32_bf16 v[108:111], a[92:95], a[204:207], v[108:111]
 v_exp_f32 v40, v40
 v_mfma_f32_16x16x32_bf16 v[108:111], a[108:111], a[160:163], v[108:111]
 v_add_f32 v29, 1.0, v33
 v_add_f32 v30, 1.0, v34
 v_mfma_f32_16x16x32_bf16 v[108:111], a[124:127], a[164:167], v[108:111]
 v_exp_f32 v41, v41
 v_mfma_f32_16x16x32_bf16 v[108:111], a[140:143], a[168:171], v[108:111]
 s_waitcnt lgkmcnt(0)
 ds_read_b128 a[200:203], v3 offset:10880
 v_add_f32 v31, 1.0, v35
 v_fmac_f32 v28, v28, v40
 v_mfma_f32_16x16x32_bf16 v[108:111], a[156:159], a[188:191], v[108:111]
 v_exp_f32 v42, v42
 v_mfma_f32_16x16x32_bf16 v[104:107], a[152:155], a[188:191], v[104:107]
 v_exp_f32 v43, v43
 v_mfma_f32_16x16x32_bf16 v[104:107], a[136:139], a[168:171], v[104:107]
 v_fmac_f32 v29, v29, v41
 v_fmac_f32 v30, v30, v42
 v_mfma_f32_16x16x32_bf16 v[104:107], a[120:123], a[164:167], v[104:107]
 v_fmac_f32 v31, v31, v43
 v_mul_f32 v20, s42, v64
 v_mfma_f32_16x16x32_bf16 v[104:107], a[104:107], a[160:163], v[104:107]
 v_rcp_f32 v28, v28
 v_mfma_f32_16x16x32_bf16 v[104:107], a[88:91], a[204:207], v[104:107]
 v_rcp_f32 v29, v29
 v_fma_f32 v32, v32, v28, -v28
 v_mfma_f32_16x16x32_bf16 v[100:103], a[84:87], a[204:207], v[100:103]
 v_rcp_f32 v30, v30
 v_mfma_f32_16x16x32_bf16 v[100:103], a[100:103], a[160:163], v[100:103]
 v_rcp_f32 v31, v31
 v_mfma_f32_16x16x32_bf16 v[100:103], a[116:119], a[164:167], v[100:103]
 v_fma_f32 v33, v33, v29, -v29
 v_fma_f32 v34, v34, v30, -v30
 v_mfma_f32_16x16x32_bf16 v[100:103], a[132:135], a[168:171], v[100:103]
 v_fma_f32 v35, v35, v31, -v31
 v_cvt_pk_bf16_f32 v18, v32, v33
 v_mfma_f32_16x16x32_bf16 v[100:103], a[148:151], a[188:191], v[100:103]
 s_add_u32 s46, s40, 0
 v_cvt_pk_bf16_f32 v19, v34, v35
 buffer_store_dwordx4 v[16:19], v6, s[12:15], s46 offen
 v_mul_f32 v21, s42, v65
 v_mfma_f32_16x16x32_bf16 v[96:99], a[144:147], a[188:191], v[96:99]
 v_mul_f32 v22, s42, v66
 v_mul_f32 v23, s42, v67
 v_mfma_f32_16x16x32_bf16 v[96:99], a[128:131], a[168:171], v[96:99]
 v_min_f32 v20, s47, v20
 v_min_f32 v21, s47, v21
 v_mfma_f32_16x16x32_bf16 v[96:99], a[112:115], a[164:167], v[96:99]
 v_min_f32 v22, s47, v22
 v_min_f32 v23, s47, v23
 v_mfma_f32_16x16x32_bf16 v[96:99], a[96:99], a[160:163], v[96:99]
 v_exp_f32 v20, v20
 v_mfma_f32_16x16x32_bf16 v[96:99], a[80:83], a[204:207], v[96:99]
 v_mul_f32 v24, s43, v72
 v_mul_f32 v25, s43, v73
 v_mul_f32 v26, s43, v74
 v_mfma_f32_16x16x32_bf16 v[112:115], a[0:3], a[184:187], v[112:115]
 v_exp_f32 v21, v21
 v_mfma_f32_16x16x32_bf16 v[112:115], a[16:19], a[180:183], v[112:115]
 v_mul_f32 v27, s43, v75
 v_add_f32 v28, 1.0, v20
 v_mfma_f32_16x16x32_bf16 v[112:115], a[32:35], a[176:179], v[112:115]
 v_exp_f32 v22, v22
 v_mfma_f32_16x16x32_bf16 v[112:115], a[48:51], a[172:175], v[112:115]
 ds_read_b128 a[188:191], v3 offset:15232
 v_add_f32 v29, 1.0, v21
 v_mfma_f32_16x16x32_bf16 v[112:115], a[64:67], a[192:195], v[112:115]
 v_exp_f32 v23, v23
 v_mfma_f32_16x16x32_bf16 v[116:119], a[68:71], a[192:195], v[116:119]
 v_exp_f32 v24, v24
 v_add_f32 v30, 1.0, v22
 v_mfma_f32_16x16x32_bf16 v[116:119], a[52:55], a[172:175], v[116:119]
 v_exp_f32 v25, v25
 v_mfma_f32_16x16x32_bf16 v[116:119], a[36:39], a[176:179], v[116:119]
 v_add_f32 v31, 1.0, v23
 v_fmac_f32 v28, v28, v24
 v_mfma_f32_16x16x32_bf16 v[116:119], a[20:23], a[180:183], v[116:119]
 v_exp_f32 v26, v26
 v_mfma_f32_16x16x32_bf16 v[116:119], a[4:7], a[184:187], v[116:119]
 v_exp_f32 v27, v27
 v_mfma_f32_16x16x32_bf16 v[120:123], a[8:11], a[184:187], v[120:123]
 v_fmac_f32 v29, v29, v25
 v_fmac_f32 v30, v30, v26
 v_fmac_f32 v31, v31, v27
 v_mfma_f32_16x16x32_bf16 v[120:123], a[24:27], a[180:183], v[120:123]
 v_rcp_f32 v28, v28
 v_mfma_f32_16x16x32_bf16 v[120:123], a[40:43], a[176:179], v[120:123]
 v_rcp_f32 v29, v29
 v_mfma_f32_16x16x32_bf16 v[120:123], a[56:59], a[172:175], v[120:123]
 v_rcp_f32 v30, v30
 v_mfma_f32_16x16x32_bf16 v[120:123], a[72:75], a[192:195], v[120:123]
 v_rcp_f32 v31, v31
 v_mfma_f32_16x16x32_bf16 v[124:127], a[76:79], a[192:195], v[124:127]
 v_fma_f32 v20, v20, v28, -v28
 v_fma_f32 v21, v21, v29, -v29
 v_fma_f32 v22, v22, v30, -v30
 v_mfma_f32_16x16x32_bf16 v[124:127], a[60:63], a[172:175], v[124:127]
 v_fma_f32 v23, v23, v31, -v31
 v_cvt_pk_bf16_f32 v16, v20, v21
 v_mfma_f32_16x16x32_bf16 v[124:127], a[44:47], a[176:179], v[124:127]
 v_cvt_pk_bf16_f32 v17, v22, v23
 v_mul_f32 v32, s42, v68
 v_mfma_f32_16x16x32_bf16 v[124:127], a[28:31], a[180:183], v[124:127]
 v_mul_f32 v33, s42, v69
 v_mul_f32 v34, s42, v70
 v_mfma_f32_16x16x32_bf16 v[124:127], a[12:15], a[184:187], v[124:127]
 ds_read_b128 a[168:171], v2 offset:17408
 v_mul_f32 v35, s42, v71
 v_mfma_f32_16x16x32_bf16 v[140:143], a[12:15], a[180:183], v[140:143]
 ds_read_b128 a[164:167], v2 offset:21760
 v_min_f32 v32, s47, v32
 v_mfma_f32_16x16x32_bf16 v[140:143], a[28:31], a[176:179], v[140:143]
 ds_read_b128 a[160:163], v2 offset:26112
 v_min_f32 v33, s47, v33
 v_min_f32 v34, s47, v34
 v_mfma_f32_16x16x32_bf16 v[140:143], a[44:47], a[172:175], v[140:143]
 ds_read_b128 a[204:207], v2 offset:30464
 v_min_f32 v35, s47, v35
 v_mfma_f32_16x16x32_bf16 v[140:143], a[60:63], a[192:195], v[140:143]
 ds_read_b128 a[184:187], v4 offset:2176
 v_mul_f32 v40, s43, v76
 v_mfma_f32_16x16x32_bf16 v[140:143], a[76:79], a[196:199], v[140:143]
 v_exp_f32 v32, v32
 v_mfma_f32_16x16x32_bf16 v[136:139], a[72:75], a[196:199], v[136:139]
 v_mul_f32 v41, s43, v77
 v_mul_f32 v42, s43, v78
 v_mfma_f32_16x16x32_bf16 v[136:139], a[56:59], a[192:195], v[136:139]
 v_exp_f32 v33, v33
 v_mul_f32 v43, s43, v79
 v_mfma_f32_16x16x32_bf16 v[136:139], a[40:43], a[172:175], v[136:139]
 v_exp_f32 v34, v34
 v_mfma_f32_16x16x32_bf16 v[136:139], a[24:27], a[176:179], v[136:139]
 v_exp_f32 v35, v35
 v_mfma_f32_16x16x32_bf16 v[136:139], a[8:11], a[180:183], v[136:139]
 v_exp_f32 v40, v40
 v_mfma_f32_16x16x32_bf16 v[132:135], a[4:7], a[180:183], v[132:135]
 v_add_f32 v28, 1.0, v32
 v_add_f32 v29, 1.0, v33
 v_mfma_f32_16x16x32_bf16 v[132:135], a[20:23], a[176:179], v[132:135]
 v_exp_f32 v41, v41
 v_add_f32 v30, 1.0, v34
 v_mfma_f32_16x16x32_bf16 v[132:135], a[36:39], a[172:175], v[132:135]
 v_add_f32 v31, 1.0, v35
 v_fmac_f32 v28, v28, v40
 v_mfma_f32_16x16x32_bf16 v[132:135], a[52:55], a[192:195], v[132:135]
 v_exp_f32 v42, v42
 v_mfma_f32_16x16x32_bf16 v[132:135], a[68:71], a[196:199], v[132:135]
 v_exp_f32 v43, v43
 v_mfma_f32_16x16x32_bf16 v[128:131], a[64:67], a[196:199], v[128:131]
 v_fmac_f32 v29, v29, v41
 v_fmac_f32 v30, v30, v42
 v_mfma_f32_16x16x32_bf16 v[128:131], a[48:51], a[192:195], v[128:131]
 v_fmac_f32 v31, v31, v43
 v_mul_f32 v20, s42, v80
 v_mfma_f32_16x16x32_bf16 v[128:131], a[32:35], a[172:175], v[128:131]
 v_rcp_f32 v28, v28
 v_mul_f32 v21, s42, v81
 v_mfma_f32_16x16x32_bf16 v[128:131], a[16:19], a[176:179], v[128:131]
 v_rcp_f32 v29, v29
 v_mfma_f32_16x16x32_bf16 v[128:131], a[0:3], a[180:183], v[128:131]
 v_rcp_f32 v30, v30
 v_mfma_f32_16x16x32_bf16 v[144:147], a[0:3], a[176:179], v[144:147]
 v_rcp_f32 v31, v31
 v_mfma_f32_16x16x32_bf16 v[144:147], a[16:19], a[172:175], v[144:147]
 v_fma_f32 v32, v32, v28, -v28
 v_fma_f32 v33, v33, v29, -v29
 v_mfma_f32_16x16x32_bf16 v[144:147], a[32:35], a[192:195], v[144:147]
 v_fma_f32 v34, v34, v30, -v30
 v_fma_f32 v35, v35, v31, -v31
 v_cvt_pk_bf16_f32 v18, v32, v33
 v_mfma_f32_16x16x32_bf16 v[144:147], a[48:51], a[196:199], v[144:147]
 s_waitcnt lgkmcnt(0)
 ds_read_b128 a[180:183], v4 offset:6528
 v_cvt_pk_bf16_f32 v19, v34, v35
 v_mfma_f32_16x16x32_bf16 v[144:147], a[64:67], a[200:203], v[144:147]
 s_add_u32 s46, s40, 2048
 buffer_store_dwordx4 v[16:19], v6, s[12:15], s46 offen
 v_mul_f32 v22, s42, v82
 v_mfma_f32_16x16x32_bf16 v[148:151], a[68:71], a[200:203], v[148:151]
 v_mul_f32 v23, s42, v83
 v_min_f32 v20, s47, v20
 v_mfma_f32_16x16x32_bf16 v[148:151], a[52:55], a[196:199], v[148:151]
 v_min_f32 v21, s47, v21
 v_min_f32 v22, s47, v22
 v_mfma_f32_16x16x32_bf16 v[148:151], a[36:39], a[192:195], v[148:151]
 v_min_f32 v23, s47, v23
 v_exp_f32 v20, v20
 v_mfma_f32_16x16x32_bf16 v[148:151], a[20:23], a[172:175], v[148:151]
 v_mul_f32 v24, s43, v88
 v_mul_f32 v25, s43, v89
 v_mfma_f32_16x16x32_bf16 v[148:151], a[4:7], a[176:179], v[148:151]
 v_exp_f32 v21, v21
 v_mfma_f32_16x16x32_bf16 v[152:155], a[8:11], a[176:179], v[152:155]
 v_mul_f32 v26, s43, v90
 v_mul_f32 v27, s43, v91
 v_mfma_f32_16x16x32_bf16 v[152:155], a[24:27], a[172:175], v[152:155]
 v_exp_f32 v22, v22
 v_mfma_f32_16x16x32_bf16 v[152:155], a[40:43], a[192:195], v[152:155]
 v_exp_f32 v23, v23
 v_mfma_f32_16x16x32_bf16 v[152:155], a[56:59], a[196:199], v[152:155]
 v_exp_f32 v24, v24
 v_add_f32 v28, 1.0, v20
 v_mfma_f32_16x16x32_bf16 v[152:155], a[72:75], a[200:203], v[152:155]
 v_add_f32 v29, 1.0, v21
 v_add_f32 v30, 1.0, v22
 v_mfma_f32_16x16x32_bf16 v[156:159], a[76:79], a[200:203], v[156:159]
 v_exp_f32 v25, v25
 v_mfma_f32_16x16x32_bf16 v[156:159], a[60:63], a[196:199], v[156:159]
 v_add_f32 v31, 1.0, v23
 v_fmac_f32 v28, v28, v24
 v_mfma_f32_16x16x32_bf16 v[156:159], a[44:47], a[192:195], v[156:159]
 v_exp_f32 v26, v26
 v_mfma_f32_16x16x32_bf16 v[156:159], a[28:31], a[172:175], v[156:159]
 v_exp_f32 v27, v27
 v_fmac_f32 v29, v29, v25
 v_mfma_f32_16x16x32_bf16 v[156:159], a[12:15], a[176:179], v[156:159]
 v_fmac_f32 v30, v30, v26
 v_fmac_f32 v31, v31, v27
 v_mfma_f32_16x16x32_bf16 v[172:175], a[12:15], a[172:175], v[172:175]
 v_rcp_f32 v28, v28
 v_mfma_f32_16x16x32_bf16 v[172:175], a[28:31], a[192:195], v[172:175]
 v_rcp_f32 v29, v29
 v_mfma_f32_16x16x32_bf16 v[172:175], a[44:47], a[196:199], v[172:175]
 v_rcp_f32 v30, v30
 v_mfma_f32_16x16x32_bf16 v[172:175], a[60:63], a[200:203], v[172:175]
 ds_read_b128 a[176:179], v4 offset:10880
 v_rcp_f32 v31, v31
 v_mfma_f32_16x16x32_bf16 v[172:175], a[76:79], a[188:191], v[172:175]
 v_fma_f32 v20, v20, v28, -v28
 v_fma_f32 v21, v21, v29, -v29
 v_mfma_f32_16x16x32_bf16 v[168:171], a[72:75], a[188:191], v[168:171]
 v_fma_f32 v22, v22, v30, -v30
 v_fma_f32 v23, v23, v31, -v31
 v_mfma_f32_16x16x32_bf16 v[168:171], a[56:59], a[200:203], v[168:171]
 v_cvt_pk_bf16_f32 v16, v20, v21
 v_cvt_pk_bf16_f32 v17, v22, v23
 v_mfma_f32_16x16x32_bf16 v[168:171], a[40:43], a[196:199], v[168:171]
 v_mul_f32 v32, s42, v84
 v_mul_f32 v33, s42, v85
 v_mfma_f32_16x16x32_bf16 v[168:171], a[24:27], a[192:195], v[168:171]
 v_mul_f32 v34, s42, v86
 v_mul_f32 v35, s42, v87
 v_mfma_f32_16x16x32_bf16 v[168:171], a[8:11], a[172:175], v[168:171]
 v_min_f32 v32, s47, v32
 v_min_f32 v33, s47, v33
 v_min_f32 v34, s47, v34
 v_mfma_f32_16x16x32_bf16 v[164:167], a[4:7], a[172:175], v[164:167]
 v_min_f32 v35, s47, v35
 v_mul_f32 v40, s43, v92
 v_mfma_f32_16x16x32_bf16 v[164:167], a[20:23], a[192:195], v[164:167]
 v_exp_f32 v32, v32
 v_mfma_f32_16x16x32_bf16 v[164:167], a[36:39], a[196:199], v[164:167]
 v_mul_f32 v41, s43, v93
 v_mul_f32 v42, s43, v94
 v_mfma_f32_16x16x32_bf16 v[164:167], a[52:55], a[200:203], v[164:167]
 v_exp_f32 v33, v33
 v_mfma_f32_16x16x32_bf16 v[164:167], a[68:71], a[188:191], v[164:167]
 v_mul_f32 v43, s43, v95
 v_exp_f32 v34, v34
 v_mfma_f32_16x16x32_bf16 v[160:163], a[64:67], a[188:191], v[160:163]
 v_exp_f32 v35, v35
 v_mfma_f32_16x16x32_bf16 v[160:163], a[48:51], a[200:203], v[160:163]
 v_exp_f32 v40, v40
 v_mfma_f32_16x16x32_bf16 v[160:163], a[32:35], a[196:199], v[160:163]
 v_add_f32 v28, 1.0, v32
 v_add_f32 v29, 1.0, v33
 v_mfma_f32_16x16x32_bf16 v[160:163], a[16:19], a[192:195], v[160:163]
 v_exp_f32 v41, v41
 v_mfma_f32_16x16x32_bf16 v[160:163], a[0:3], a[172:175], v[160:163]
 v_add_f32 v30, 1.0, v34
 v_add_f32 v31, 1.0, v35
 v_fmac_f32 v28, v28, v40
 v_mfma_f32_16x16x32_bf16 v[112:115], a[80:83], a[168:171], v[112:115]
 v_exp_f32 v42, v42
 v_mfma_f32_16x16x32_bf16 v[112:115], a[96:99], a[164:167], v[112:115]
 v_exp_f32 v43, v43
 v_mfma_f32_16x16x32_bf16 v[112:115], a[112:115], a[160:163], v[112:115]
 v_fmac_f32 v29, v29, v41
 v_fmac_f32 v30, v30, v42
 v_mfma_f32_16x16x32_bf16 v[112:115], a[128:131], a[204:207], v[112:115]
 ds_read_b128 a[188:191], v4 offset:15232
 v_fmac_f32 v31, v31, v43
 v_mfma_f32_16x16x32_bf16 v[112:115], a[144:147], a[184:187], v[112:115]
 v_rcp_f32 v28, v28
 v_mfma_f32_16x16x32_bf16 v[116:119], a[148:151], a[184:187], v[116:119]
 v_rcp_f32 v29, v29
 v_fma_f32 v32, v32, v28, -v28
 v_mfma_f32_16x16x32_bf16 v[116:119], a[132:135], a[204:207], v[116:119]
 v_rcp_f32 v30, v30
 v_mfma_f32_16x16x32_bf16 v[116:119], a[116:119], a[160:163], v[116:119]
 v_rcp_f32 v31, v31
 v_mfma_f32_16x16x32_bf16 v[116:119], a[100:103], a[164:167], v[116:119]
 v_fma_f32 v33, v33, v29, -v29
 v_fma_f32 v34, v34, v30, -v30
 v_mfma_f32_16x16x32_bf16 v[116:119], a[84:87], a[168:171], v[116:119]
 v_fma_f32 v35, v35, v31, -v31
 v_cvt_pk_bf16_f32 v18, v32, v33
 v_mfma_f32_16x16x32_bf16 v[120:123], a[88:91], a[168:171], v[120:123]
 s_add_u32 s46, s40, 4096
 v_cvt_pk_bf16_f32 v19, v34, v35
 buffer_store_dwordx4 v[16:19], v6, s[12:15], s46 offen
 v_mul_f32 v20, s42, v96
 v_mfma_f32_16x16x32_bf16 v[120:123], a[104:107], a[164:167], v[120:123]
 v_mul_f32 v21, s42, v97
 v_mul_f32 v22, s42, v98
 v_mfma_f32_16x16x32_bf16 v[120:123], a[120:123], a[160:163], v[120:123]
 v_mul_f32 v23, s42, v99
 v_min_f32 v20, s47, v20
 v_mfma_f32_16x16x32_bf16 v[120:123], a[136:139], a[204:207], v[120:123]
 v_min_f32 v21, s47, v21
 v_min_f32 v22, s47, v22
 v_mfma_f32_16x16x32_bf16 v[120:123], a[152:155], a[184:187], v[120:123]
 v_min_f32 v23, s47, v23
 v_mul_f32 v24, s43, v104
 v_mfma_f32_16x16x32_bf16 v[124:127], a[156:159], a[184:187], v[124:127]
 v_exp_f32 v20, v20
 v_mul_f32 v25, s43, v105
 v_mfma_f32_16x16x32_bf16 v[124:127], a[140:143], a[204:207], v[124:127]
 v_exp_f32 v21, v21
 v_mfma_f32_16x16x32_bf16 v[124:127], a[124:127], a[160:163], v[124:127]
 v_mul_f32 v26, s43, v106
 v_mul_f32 v27, s43, v107
 v_mfma_f32_16x16x32_bf16 v[124:127], a[108:111], a[164:167], v[124:127]
 v_exp_f32 v22, v22
 v_mfma_f32_16x16x32_bf16 v[124:127], a[92:95], a[168:171], v[124:127]
 ds_read_b128 a[200:203], v1 offset:2176
 v_add_f32 v28, 1.0, v20
 v_mfma_f32_16x16x32_bf16 v[140:143], a[92:95], a[164:167], v[140:143]
 ds_read_b128 a[196:199], v1 offset:6528
 v_add_f32 v29, 1.0, v21
 v_mfma_f32_16x16x32_bf16 v[140:143], a[108:111], a[160:163], v[140:143]
 ds_read_b128 a[192:195], v1 offset:10880
 v_exp_f32 v23, v23
 v_mfma_f32_16x16x32_bf16 v[140:143], a[124:127], a[204:207], v[140:143]
 ds_read_b128 a[172:175], v1 offset:15232
 v_add_f32 v30, 1.0, v22
 v_mfma_f32_16x16x32_bf16 v[140:143], a[140:143], a[184:187], v[140:143]
 s_waitcnt lgkmcnt(4)
 ds_read_b128 a[168:171], v1 offset:19584
 v_add_f32 v31, 1.0, v23
 v_mfma_f32_16x16x32_bf16 v[140:143], a[156:159], a[180:183], v[140:143]
 v_exp_f32 v24, v24
 v_mfma_f32_16x16x32_bf16 v[136:139], a[152:155], a[180:183], v[136:139]
 v_exp_f32 v25, v25
 v_mfma_f32_16x16x32_bf16 v[136:139], a[136:139], a[184:187], v[136:139]
 v_exp_f32 v26, v26
 v_fmac_f32 v28, v28, v24
 v_mfma_f32_16x16x32_bf16 v[136:139], a[120:123], a[204:207], v[136:139]
 v_exp_f32 v27, v27
 v_mfma_f32_16x16x32_bf16 v[136:139], a[104:107], a[160:163], v[136:139]
 v_fmac_f32 v29, v29, v25
 v_fmac_f32 v30, v30, v26
 v_mfma_f32_16x16x32_bf16 v[136:139], a[88:91], a[164:167], v[136:139]
 v_fmac_f32 v31, v31, v27
 v_mul_f32 v32, s42, v100
 v_mfma_f32_16x16x32_bf16 v[132:135], a[84:87], a[164:167], v[132:135]
 v_rcp_f32 v28, v28
 v_mfma_f32_16x16x32_bf16 v[132:135], a[100:103], a[160:163], v[132:135]
 v_rcp_f32 v29, v29
 v_fma_f32 v20, v20, v28, -v28
 v_mfma_f32_16x16x32_bf16 v[132:135], a[116:119], a[204:207], v[132:135]
 v_rcp_f32 v30, v30
 v_mfma_f32_16x16x32_bf16 v[132:135], a[132:135], a[184:187], v[132:135]
 v_rcp_f32 v31, v31
 v_mfma_f32_16x16x32_bf16 v[132:135], a[148:151], a[180:183], v[132:135]
 v_fma_f32 v21, v21, v29, -v29
 v_fma_f32 v22, v22, v30, -v30
 v_mfma_f32_16x16x32_bf16 v[128:131], a[144:147], a[180:183], v[128:131]
 v_fma_f32 v23, v23, v31, -v31
 v_cvt_pk_bf16_f32 v16, v20, v21
 v_mfma_f32_16x16x32_bf16 v[128:131], a[128:131], a[184:187], v[128:131]
 v_cvt_pk_bf16_f32 v17, v22, v23
 v_mul_f32 v33, s42, v101
 v_mfma_f32_16x16x32_bf16 v[128:131], a[112:115], a[204:207], v[128:131]
 v_mul_f32 v34, s42, v102
 v_mul_f32 v35, s42, v103
 v_min_f32 v32, s47, v32
 v_mfma_f32_16x16x32_bf16 v[128:131], a[96:99], a[160:163], v[128:131]
 v_min_f32 v33, s47, v33
 v_min_f32 v34, s47, v34
 v_mfma_f32_16x16x32_bf16 v[128:131], a[80:83], a[164:167], v[128:131]
 v_min_f32 v35, s47, v35
 v_mul_f32 v40, s43, v108
 v_mfma_f32_16x16x32_bf16 v[144:147], a[80:83], a[160:163], v[144:147]
 v_exp_f32 v32, v32
 v_mfma_f32_16x16x32_bf16 v[144:147], a[96:99], a[204:207], v[144:147]
 v_mul_f32 v41, s43, v109
 v_mul_f32 v42, s43, v110
 v_mfma_f32_16x16x32_bf16 v[144:147], a[112:115], a[184:187], v[144:147]
 v_exp_f32 v33, v33
 v_mul_f32 v43, s43, v111
 v_mfma_f32_16x16x32_bf16 v[144:147], a[128:131], a[180:183], v[144:147]
 ds_read_b128 a[164:167], v1 offset:23936
 v_add_f32 v28, 1.0, v32
 v_mfma_f32_16x16x32_bf16 v[144:147], a[144:147], a[176:179], v[144:147]
 v_exp_f32 v34, v34
 v_mfma_f32_16x16x32_bf16 v[148:151], a[148:151], a[176:179], v[148:151]
 v_exp_f32 v35, v35
 v_mfma_f32_16x16x32_bf16 v[148:151], a[132:135], a[180:183], v[148:151]
 v_exp_f32 v40, v40
 v_mfma_f32_16x16x32_bf16 v[148:151], a[116:119], a[184:187], v[148:151]
 v_add_f32 v29, 1.0, v33
 v_exp_f32 v41, v41
 v_mfma_f32_16x16x32_bf16 v[148:151], a[100:103], a[204:207], v[148:151]
 v_add_f32 v30, 1.0, v34
 v_add_f32 v31, 1.0, v35
 v_mfma_f32_16x16x32_bf16 v[148:151], a[84:87], a[160:163], v[148:151]
 v_exp_f32 v42, v42
 v_mfma_f32_16x16x32_bf16 v[152:155], a[88:91], a[160:163], v[152:155]
 v_exp_f32 v43, v43
 v_mfma_f32_16x16x32_bf16 v[152:155], a[104:107], a[204:207], v[152:155]
 v_fmac_f32 v28, v28, v40
 v_fmac_f32 v29, v29, v41
 v_mfma_f32_16x16x32_bf16 v[152:155], a[120:123], a[184:187], v[152:155]
 v_fmac_f32 v30, v30, v42
 v_fmac_f32 v31, v31, v43
 v_mfma_f32_16x16x32_bf16 v[152:155], a[136:139], a[180:183], v[152:155]
 v_rcp_f32 v28, v28
 v_mul_f32 v20, s42, v112
 v_mfma_f32_16x16x32_bf16 v[152:155], a[152:155], a[176:179], v[152:155]
 v_rcp_f32 v29, v29
 v_mfma_f32_16x16x32_bf16 v[156:159], a[156:159], a[176:179], v[156:159]
 v_rcp_f32 v30, v30
 v_mfma_f32_16x16x32_bf16 v[156:159], a[140:143], a[180:183], v[156:159]
 v_rcp_f32 v31, v31
 v_mfma_f32_16x16x32_bf16 v[156:159], a[124:127], a[184:187], v[156:159]
 v_fma_f32 v32, v32, v28, -v28
 v_fma_f32 v33, v33, v29, -v29
 v_mfma_f32_16x16x32_bf16 v[156:159], a[108:111], a[204:207], v[156:159]
 v_fma_f32 v34, v34, v30, -v30
 v_fma_f32 v35, v35, v31, -v31
 v_cvt_pk_bf16_f32 v18, v32, v33
 v_mfma_f32_16x16x32_bf16 v[156:159], a[92:95], a[160:163], v[156:159]
 s_add_u32 s46, s40, 6144
 v_cvt_pk_bf16_f32 v19, v34, v35
 buffer_store_dwordx4 v[16:19], v6, s[12:15], s46 offen
 v_mfma_f32_16x16x32_bf16 v[172:175], a[92:95], a[204:207], v[172:175]
 v_mul_f32 v21, s42, v113
 v_mul_f32 v22, s42, v114
 v_mfma_f32_16x16x32_bf16 v[172:175], a[108:111], a[184:187], v[172:175]
 v_mul_f32 v23, s42, v115
 v_min_f32 v20, s47, v20
 v_mfma_f32_16x16x32_bf16 v[172:175], a[124:127], a[180:183], v[172:175]
 v_min_f32 v21, s47, v21
 v_min_f32 v22, s47, v22
 v_mfma_f32_16x16x32_bf16 v[172:175], a[140:143], a[176:179], v[172:175]
 ds_read_b128 a[160:163], v1 offset:28288
 v_min_f32 v23, s47, v23
 v_mul_f32 v24, s43, v120
 v_mfma_f32_16x16x32_bf16 v[172:175], a[156:159], a[188:191], v[172:175]
 v_exp_f32 v20, v20
 v_mfma_f32_16x16x32_bf16 v[168:171], a[152:155], a[188:191], v[168:171]
 v_mul_f32 v25, s43, v121
 v_mul_f32 v26, s43, v122
 v_mfma_f32_16x16x32_bf16 v[168:171], a[136:139], a[176:179], v[168:171]
 v_exp_f32 v21, v21
 v_mfma_f32_16x16x32_bf16 v[168:171], a[120:123], a[180:183], v[168:171]
 v_mul_f32 v27, s43, v123
 v_add_f32 v28, 1.0, v20
 v_mfma_f32_16x16x32_bf16 v[168:171], a[104:107], a[184:187], v[168:171]
 v_exp_f32 v22, v22
 v_mfma_f32_16x16x32_bf16 v[168:171], a[88:91], a[204:207], v[168:171]
 v_exp_f32 v23, v23
 v_add_f32 v29, 1.0, v21
 v_mfma_f32_16x16x32_bf16 v[164:167], a[84:87], a[204:207], v[164:167]
 v_exp_f32 v24, v24
 v_mfma_f32_16x16x32_bf16 v[164:167], a[100:103], a[184:187], v[164:167]
 v_exp_f32 v25, v25
 v_mfma_f32_16x16x32_bf16 v[164:167], a[116:119], a[180:183], v[164:167]
 v_add_f32 v30, 1.0, v22
 v_add_f32 v31, 1.0, v23
 v_mfma_f32_16x16x32_bf16 v[164:167], a[132:135], a[176:179], v[164:167]
 v_exp_f32 v26, v26
 v_mfma_f32_16x16x32_bf16 v[164:167], a[148:151], a[188:191], v[164:167]
 v_exp_f32 v27, v27
 v_fmac_f32 v28, v28, v24
 v_mfma_f32_16x16x32_bf16 v[160:163], a[144:147], a[188:191], v[160:163]
 v_fmac_f32 v29, v29, v25
 v_fmac_f32 v30, v30, v26
 v_mfma_f32_16x16x32_bf16 v[160:163], a[128:131], a[176:179], v[160:163]
 v_fmac_f32 v31, v31, v27
 v_mul_f32 v32, s42, v116
 v_mfma_f32_16x16x32_bf16 v[160:163], a[112:115], a[180:183], v[160:163]
 v_rcp_f32 v28, v28
 v_mfma_f32_16x16x32_bf16 v[160:163], a[96:99], a[184:187], v[160:163]
 v_rcp_f32 v29, v29
 v_mfma_f32_16x16x32_bf16 v[160:163], a[80:83], a[204:207], v[160:163]
 s_waitcnt lgkmcnt(0)
 v_rcp_f32 v30, v30
 v_fma_f32 v20, v20, v28, -v28
 v_mfma_f32_16x16x32_bf16 v[176:179], a[0:3], a[200:203], v[176:179]
 v_rcp_f32 v31, v31
 v_mfma_f32_16x16x32_bf16 v[176:179], a[16:19], a[196:199], v[176:179]
 v_fma_f32 v21, v21, v29, -v29
 v_fma_f32 v22, v22, v30, -v30
 v_mfma_f32_16x16x32_bf16 v[176:179], a[32:35], a[192:195], v[176:179]
 v_fma_f32 v23, v23, v31, -v31
 v_cvt_pk_bf16_f32 v16, v20, v21
 v_mfma_f32_16x16x32_bf16 v[176:179], a[48:51], a[172:175], v[176:179]
 ds_read_b128 a[188:191], v3 offset:0
 v_cvt_pk_bf16_f32 v17, v22, v23
 v_mfma_f32_16x16x32_bf16 v[176:179], a[64:67], a[168:171], v[176:179]
 v_mul_f32 v33, s42, v117
 v_mul_f32 v34, s42, v118
 v_mfma_f32_16x16x32_bf16 v[180:183], a[68:71], a[168:171], v[180:183]
 v_mul_f32 v35, s42, v119
 v_min_f32 v32, s47, v32
 v_min_f32 v33, s47, v33
 v_mfma_f32_16x16x32_bf16 v[180:183], a[52:55], a[172:175], v[180:183]
 v_min_f32 v34, s47, v34
 v_min_f32 v35, s47, v35
 v_mfma_f32_16x16x32_bf16 v[180:183], a[36:39], a[192:195], v[180:183]
 v_exp_f32 v32, v32
 v_mfma_f32_16x16x32_bf16 v[180:183], a[20:23], a[196:199], v[180:183]
 v_mul_f32 v40, s43, v124
 v_mul_f32 v41, s43, v125
 v_mfma_f32_16x16x32_bf16 v[180:183], a[4:7], a[200:203], v[180:183]
 v_exp_f32 v33, v33
 v_mfma_f32_16x16x32_bf16 v[184:187], a[8:11], a[200:203], v[184:187]
 v_mul_f32 v42, s43, v126
 v_mul_f32 v43, s43, v127
 v_add_f32 v28, 1.0, v32
 v_mfma_f32_16x16x32_bf16 v[184:187], a[24:27], a[196:199], v[184:187]
 v_exp_f32 v34, v34
 v_mfma_f32_16x16x32_bf16 v[184:187], a[40:43], a[192:195], v[184:187]
 v_exp_f32 v35, v35
 v_mfma_f32_16x16x32_bf16 v[184:187], a[56:59], a[172:175], v[184:187]
 v_exp_f32 v40, v40
 v_mfma_f32_16x16x32_bf16 v[184:187], a[72:75], a[168:171], v[184:187]
 v_add_f32 v29, 1.0, v33
 v_add_f32 v30, 1.0, v34
 v_mfma_f32_16x16x32_bf16 v[188:191], a[76:79], a[168:171], v[188:191]
 v_exp_f32 v41, v41
 v_add_f32 v31, 1.0, v35
 v_mfma_f32_16x16x32_bf16 v[188:191], a[60:63], a[172:175], v[188:191]
 v_exp_f32 v42, v42
 v_mfma_f32_16x16x32_bf16 v[188:191], a[44:47], a[192:195], v[188:191]
 v_exp_f32 v43, v43
 v_mfma_f32_16x16x32_bf16 v[188:191], a[28:31], a[196:199], v[188:191]
 v_fmac_f32 v28, v28, v40
 v_fmac_f32 v29, v29, v41
 v_mfma_f32_16x16x32_bf16 v[188:191], a[12:15], a[200:203], v[188:191]
 ds_read_b128 a[176:179], v2 offset:2176
 v_fmac_f32 v30, v30, v42
 v_mfma_f32_16x16x32_bf16 v[204:207], a[12:15], a[196:199], v[204:207]
 ds_read_b128 a[180:183], v2 offset:6528
 v_fmac_f32 v31, v31, v43
 v_mfma_f32_16x16x32_bf16 v[204:207], a[28:31], a[192:195], v[204:207]
 ds_read_b128 a[184:187], v2 offset:10880
 v_rcp_f32 v28, v28
 v_mfma_f32_16x16x32_bf16 v[204:207], a[44:47], a[172:175], v[204:207]
 ds_read_b128 a[204:207], v2 offset:15232
 v_fma_f32 v32, v32, v28, -v28
 v_mfma_f32_16x16x32_bf16 v[204:207], a[60:63], a[168:171], v[204:207]
 ds_read_b128 a[200:203], v2 offset:19584
 v_mul_f32 v20, s42, v128
 v_mfma_f32_16x16x32_bf16 v[204:207], a[76:79], a[164:167], v[204:207]
 v_rcp_f32 v29, v29
 v_mfma_f32_16x16x32_bf16 v[200:203], a[72:75], a[164:167], v[200:203]
 v_rcp_f32 v30, v30
 v_mfma_f32_16x16x32_bf16 v[200:203], a[56:59], a[168:171], v[200:203]
 v_rcp_f32 v31, v31
 v_fma_f32 v33, v33, v29, -v29
 v_mfma_f32_16x16x32_bf16 v[200:203], a[40:43], a[172:175], v[200:203]
 v_fma_f32 v34, v34, v30, -v30
 v_fma_f32 v35, v35, v31, -v31
 v_mfma_f32_16x16x32_bf16 v[200:203], a[24:27], a[192:195], v[200:203]
 v_cvt_pk_bf16_f32 v18, v32, v33
 v_cvt_pk_bf16_f32 v19, v34, v35
 v_mfma_f32_16x16x32_bf16 v[200:203], a[8:11], a[196:199], v[200:203]
 s_add_u32 s46, s40, 8192
 buffer_store_dwordx4 v[16:19], v6, s[12:15], s46 offen
 v_mul_f32 v21, s42, v129
 v_mfma_f32_16x16x32_bf16 v[196:199], a[4:7], a[196:199], v[196:199]
 v_mul_f32 v22, s42, v130
 v_mul_f32 v23, s42, v131
 v_mfma_f32_16x16x32_bf16 v[196:199], a[20:23], a[192:195], v[196:199]
 v_min_f32 v20, s47, v20
 v_min_f32 v21, s47, v21
 v_min_f32 v22, s47, v22
 v_mfma_f32_16x16x32_bf16 v[196:199], a[36:39], a[172:175], v[196:199]
 v_min_f32 v23, s47, v23
 v_mul_f32 v24, s43, v136
 v_mfma_f32_16x16x32_bf16 v[196:199], a[52:55], a[168:171], v[196:199]
 v_exp_f32 v20, v20
 v_mfma_f32_16x16x32_bf16 v[196:199], a[68:71], a[164:167], v[196:199]
 v_mul_f32 v25, s43, v137
 v_mul_f32 v26, s43, v138
 v_mfma_f32_16x16x32_bf16 v[192:195], a[64:67], a[164:167], v[192:195]
 v_exp_f32 v21, v21
 v_mfma_f32_16x16x32_bf16 v[192:195], a[48:51], a[168:171], v[192:195]
 v_mul_f32 v27, s43, v139
 v_add_f32 v28, 1.0, v20
 v_mfma_f32_16x16x32_bf16 v[192:195], a[32:35], a[172:175], v[192:195]
 v_exp_f32 v22, v22
 v_add_f32 v29, 1.0, v21
 v_mfma_f32_16x16x32_bf16 v[192:195], a[16:19], a[192:195], v[192:195]
 v_exp_f32 v23, v23
 v_mfma_f32_16x16x32_bf16 v[192:195], a[0:3], a[196:199], v[192:195]
 v_exp_f32 v24, v24
 v_mfma_f32_16x16x32_bf16 v[208:211], a[0:3], a[192:195], v[208:211]
 v_exp_f32 v25, v25
 v_mfma_f32_16x16x32_bf16 v[208:211], a[16:19], a[172:175], v[208:211]
 v_add_f32 v30, 1.0, v22
 v_add_f32 v31, 1.0, v23
 v_mfma_f32_16x16x32_bf16 v[208:211], a[32:35], a[168:171], v[208:211]
 v_exp_f32 v26, v26
 v_fmac_f32 v28, v28, v24
 v_mfma_f32_16x16x32_bf16 v[208:211], a[48:51], a[164:167], v[208:211]
 ds_read_b128 a[196:199], v2 offset:23936
 v_fmac_f32 v29, v29, v25
 v_mfma_f32_16x16x32_bf16 v[208:211], a[64:67], a[160:163], v[208:211]
 v_exp_f32 v27, v27
 v_mfma_f32_16x16x32_bf16 v[212:215], a[68:71], a[160:163], v[212:215]
 v_fmac_f32 v30, v30, v26
 v_fmac_f32 v31, v31, v27
 v_mfma_f32_16x16x32_bf16 v[212:215], a[52:55], a[164:167], v[212:215]
 v_rcp_f32 v28, v28
 v_mfma_f32_16x16x32_bf16 v[212:215], a[36:39], a[168:171], v[212:215]
 v_rcp_f32 v29, v29
 v_fma_f32 v20, v20, v28, -v28
 v_mfma_f32_16x16x32_bf16 v[212:215], a[20:23], a[172:175], v[212:215]
 v_rcp_f32 v30, v30
 v_mfma_f32_16x16x32_bf16 v[212:215], a[4:7], a[192:195], v[212:215]
 v_rcp_f32 v31, v31
 v_mfma_f32_16x16x32_bf16 v[216:219], a[8:11], a[192:195], v[216:219]
 v_fma_f32 v21, v21, v29, -v29
 v_fma_f32 v22, v22, v30, -v30
 v_mfma_f32_16x16x32_bf16 v[216:219], a[24:27], a[172:175], v[216:219]
 v_fma_f32 v23, v23, v31, -v31
 v_cvt_pk_bf16_f32 v16, v20, v21
 v_mfma_f32_16x16x32_bf16 v[216:219], a[40:43], a[168:171], v[216:219]
 v_cvt_pk_bf16_f32 v17, v22, v23
 v_mul_f32 v32, s42, v132
 v_mfma_f32_16x16x32_bf16 v[216:219], a[56:59], a[164:167], v[216:219]
 v_mul_f32 v33, s42, v133
 v_mul_f32 v34, s42, v134
 v_mul_f32 v35, s42, v135
 v_mfma_f32_16x16x32_bf16 v[216:219], a[72:75], a[160:163], v[216:219]
 v_min_f32 v32, s47, v32
 v_min_f32 v33, s47, v33
 v_mfma_f32_16x16x32_bf16 v[220:223], a[76:79], a[160:163], v[220:223]
 v_min_f32 v34, s47, v34
 v_min_f32 v35, s47, v35
 v_mfma_f32_16x16x32_bf16 v[220:223], a[60:63], a[164:167], v[220:223]
 v_exp_f32 v32, v32
 v_mfma_f32_16x16x32_bf16 v[220:223], a[44:47], a[168:171], v[220:223]
 v_mul_f32 v40, s43, v140
 v_mul_f32 v41, s43, v141
 v_mfma_f32_16x16x32_bf16 v[220:223], a[28:31], a[172:175], v[220:223]
 v_exp_f32 v33, v33
 v_mul_f32 v42, s43, v142
 v_mfma_f32_16x16x32_bf16 v[220:223], a[12:15], a[192:195], v[220:223]
 v_mul_f32 v43, s43, v143
 v_add_f32 v28, 1.0, v32
 v_mfma_f32_16x16x32_bf16 v[236:239], a[12:15], a[172:175], v[236:239]
 v_exp_f32 v34, v34
 v_mfma_f32_16x16x32_bf16 v[236:239], a[28:31], a[168:171], v[236:239]
 v_exp_f32 v35, v35
 v_mfma_f32_16x16x32_bf16 v[236:239], a[44:47], a[164:167], v[236:239]
 v_exp_f32 v40, v40
 v_mfma_f32_16x16x32_bf16 v[236:239], a[60:63], a[160:163], v[236:239]
 s_waitcnt lgkmcnt(0)
 ds_read_b128 a[192:195], v2 offset:28288
 v_add_f32 v29, 1.0, v33
 v_add_f32 v30, 1.0, v34
 v_mfma_f32_16x16x32_bf16 v[236:239], a[76:79], a[188:191], v[236:239]
 v_exp_f32 v41, v41
 v_mfma_f32_16x16x32_bf16 v[232:235], a[72:75], a[188:191], v[232:235]
 v_add_f32 v31, 1.0, v35
 v_fmac_f32 v28, v28, v40
 v_mfma_f32_16x16x32_bf16 v[232:235], a[56:59], a[160:163], v[232:235]
 v_exp_f32 v42, v42
 v_mfma_f32_16x16x32_bf16 v[232:235], a[40:43], a[164:167], v[232:235]
 v_exp_f32 v43, v43
 v_mfma_f32_16x16x32_bf16 v[232:235], a[24:27], a[168:171], v[232:235]
 v_fmac_f32 v29, v29, v41
 v_fmac_f32 v30, v30, v42
 v_mfma_f32_16x16x32_bf16 v[232:235], a[8:11], a[172:175], v[232:235]
 v_fmac_f32 v31, v31, v43
 v_rcp_f32 v28, v28
 v_mfma_f32_16x16x32_bf16 v[228:231], a[4:7], a[172:175], v[228:231]
 v_rcp_f32 v29, v29
 v_mfma_f32_16x16x32_bf16 v[228:231], a[20:23], a[168:171], v[228:231]
 v_rcp_f32 v30, v30
 v_mfma_f32_16x16x32_bf16 v[228:231], a[36:39], a[164:167], v[228:231]
 v_rcp_f32 v31, v31
 v_mfma_f32_16x16x32_bf16 v[228:231], a[52:55], a[160:163], v[228:231]
 v_fma_f32 v32, v32, v28, -v28
 v_fma_f32 v33, v33, v29, -v29
 v_mfma_f32_16x16x32_bf16 v[228:231], a[68:71], a[188:191], v[228:231]
 v_fma_f32 v34, v34, v30, -v30
 v_fma_f32 v35, v35, v31, -v31
 v_cvt_pk_bf16_f32 v18, v32, v33
 v_mfma_f32_16x16x32_bf16 v[224:227], a[64:67], a[188:191], v[224:227]
 s_add_u32 s46, s40, 10240
 v_cvt_pk_bf16_f32 v19, v34, v35
 buffer_store_dwordx4 v[16:19], v6, s[12:15], s46 offen
 v_mfma_f32_16x16x32_bf16 v[224:227], a[48:51], a[160:163], v[224:227]
 v_mul_f32 v20, s42, v144
 v_mul_f32 v21, s42, v145
 v_mfma_f32_16x16x32_bf16 v[224:227], a[32:35], a[164:167], v[224:227]
 v_mul_f32 v22, s42, v146
 v_mul_f32 v23, s42, v147
 v_mfma_f32_16x16x32_bf16 v[224:227], a[16:19], a[168:171], v[224:227]
 v_min_f32 v20, s47, v20
 v_min_f32 v21, s47, v21
 v_mfma_f32_16x16x32_bf16 v[224:227], a[0:3], a[172:175], v[224:227]
 v_min_f32 v22, s47, v22
 v_min_f32 v23, s47, v23
 v_mul_f32 v24, s43, v152
 v_mfma_f32_16x16x32_bf16 v[176:179], a[80:83], a[176:179], v[176:179]
 v_exp_f32 v20, v20
 v_mfma_f32_16x16x32_bf16 v[176:179], a[96:99], a[180:183], v[176:179]
 v_mul_f32 v25, s43, v153
 v_mul_f32 v26, s43, v154
 v_mfma_f32_16x16x32_bf16 v[176:179], a[112:115], a[184:187], v[176:179]
 v_exp_f32 v21, v21
 v_mfma_f32_16x16x32_bf16 v[176:179], a[128:131], a[204:207], v[176:179]
 ds_read_b128 a[188:191], v4 offset:0
 v_mul_f32 v27, s43, v155
 v_mfma_f32_16x16x32_bf16 v[176:179], a[144:147], a[200:203], v[176:179]
 v_exp_f32 v22, v22
 v_mfma_f32_16x16x32_bf16 v[180:183], a[148:151], a[200:203], v[180:183]
 v_exp_f32 v23, v23
 v_add_f32 v28, 1.0, v20
 v_mfma_f32_16x16x32_bf16 v[180:183], a[132:135], a[204:207], v[180:183]
 v_exp_f32 v24, v24
 v_mfma_f32_16x16x32_bf16 v[180:183], a[116:119], a[184:187], v[180:183]
 v_add_f32 v29, 1.0, v21
 v_add_f32 v30, 1.0, v22
 v_mfma_f32_16x16x32_bf16 v[180:183], a[100:103], a[180:183], v[180:183]
 v_exp_f32 v25, v25
 v_mfma_f32_16x16x32_bf16 v[180:183], a[84:87], a[176:179], v[180:183]
 v_add_f32 v31, 1.0, v23
 v_fmac_f32 v28, v28, v24
 v_mfma_f32_16x16x32_bf16 v[184:187], a[88:91], a[176:179], v[184:187]
 v_exp_f32 v26, v26
 v_fmac_f32 v29, v29, v25
 v_mfma_f32_16x16x32_bf16 v[184:187], a[104:107], a[180:183], v[184:187]
 v_exp_f32 v27, v27
 v_mfma_f32_16x16x32_bf16 v[184:187], a[120:123], a[184:187], v[184:187]
 v_fmac_f32 v30, v30, v26
 v_fmac_f32 v31, v31, v27
 v_mfma_f32_16x16x32_bf16 v[184:187], a[136:139], a[204:207], v[184:187]
 v_rcp_f32 v28, v28
 v_mfma_f32_16x16x32_bf16 v[184:187], a[152:155], a[200:203], v[184:187]
 v_rcp_f32 v29, v29
 v_mfma_f32_16x16x32_bf16 v[188:191], a[156:159], a[200:203], v[188:191]
 v_rcp_f32 v30, v30
 v_fma_f32 v20, v20, v28, -v28
 v_mfma_f32_16x16x32_bf16 v[188:191], a[140:143], a[204:207], v[188:191]
 v_rcp_f32 v31, v31
 v_mfma_f32_16x16x32_bf16 v[188:191], a[124:127], a[184:187], v[188:191]
 v_fma_f32 v21, v21, v29, -v29
 v_fma_f32 v22, v22, v30, -v30
 v_mfma_f32_16x16x32_bf16 v[188:191], a[108:111], a[180:183], v[188:191]
 v_fma_f32 v23, v23, v31, -v31
 v_cvt_pk_bf16_f32 v16, v20, v21
 v_mfma_f32_16x16x32_bf16 v[188:191], a[92:95], a[176:179], v[188:191]
 ds_read_b128 a[160:163], v1 offset:19584
 v_cvt_pk_bf16_f32 v17, v22, v23
 v_mfma_f32_16x16x32_bf16 v[204:207], a[92:95], a[180:183], v[204:207]
 ds_read_b128 a[164:167], v1 offset:23936
 v_mul_f32 v32, s42, v148
 v_mfma_f32_16x16x32_bf16 v[204:207], a[108:111], a[184:187], v[204:207]
 ds_read_b128 a[168:171], v1 offset:28288
 v_mul_f32 v33, s42, v149
 v_mul_f32 v34, s42, v150
 v_mfma_f32_16x16x32_bf16 v[204:207], a[124:127], a[204:207], v[204:207]
 ds_read_b128 a[172:175], v3 offset:0
 v_mul_f32 v35, s42, v151
 v_mfma_f32_16x16x32_bf16 v[204:207], a[140:143], a[200:203], v[204:207]
 ds_read_b128 a[176:179], v3 offset:4352
 v_min_f32 v32, s47, v32
 v_mfma_f32_16x16x32_bf16 v[204:207], a[156:159], a[196:199], v[204:207]
 v_min_f32 v33, s47, v33
 v_min_f32 v34, s47, v34
 v_mfma_f32_16x16x32_bf16 v[200:203], a[152:155], a[196:199], v[200:203]
 v_min_f32 v35, s47, v35
 v_mul_f32 v40, s43, v156
 v_mfma_f32_16x16x32_bf16 v[200:203], a[136:139], a[200:203], v[200:203]
 v_exp_f32 v32, v32
 v_mul_f32 v41, s43, v157
 v_mfma_f32_16x16x32_bf16 v[200:203], a[120:123], a[204:207], v[200:203]
 v_exp_f32 v33, v33
 v_mfma_f32_16x16x32_bf16 v[200:203], a[104:107], a[184:187], v[200:203]
 v_mul_f32 v42, s43, v158
 v_mul_f32 v43, s43, v159
 v_mfma_f32_16x16x32_bf16 v[200:203], a[88:91], a[180:183], v[200:203]
 v_exp_f32 v34, v34
 v_mfma_f32_16x16x32_bf16 v[196:199], a[84:87], a[180:183], v[196:199]
 v_exp_f32 v35, v35
 v_mfma_f32_16x16x32_bf16 v[196:199], a[100:103], a[184:187], v[196:199]
 v_exp_f32 v40, v40
 v_add_f32 v28, 1.0, v32
 v_mfma_f32_16x16x32_bf16 v[196:199], a[116:119], a[204:207], v[196:199]
 v_add_f32 v29, 1.0, v33
 v_add_f32 v30, 1.0, v34
 v_mfma_f32_16x16x32_bf16 v[196:199], a[132:135], a[200:203], v[196:199]
 v_exp_f32 v41, v41
 v_mfma_f32_16x16x32_bf16 v[196:199], a[148:151], a[196:199], v[196:199]
 v_add_f32 v31, 1.0, v35
 v_fmac_f32 v28, v28, v40
 v_mfma_f32_16x16x32_bf16 v[192:195], a[144:147], a[196:199], v[192:195]
 v_exp_f32 v42, v42
 v_mfma_f32_16x16x32_bf16 v[192:195], a[128:131], a[200:203], v[192:195]
 v_exp_f32 v43, v43
 v_mfma_f32_16x16x32_bf16 v[192:195], a[112:115], a[204:207], v[192:195]
 v_fmac_f32 v29, v29, v41
 v_fmac_f32 v30, v30, v42
 v_fmac_f32 v31, v31, v43
 v_mfma_f32_16x16x32_bf16 v[192:195], a[96:99], a[184:187], v[192:195]
 v_rcp_f32 v28, v28
 v_mfma_f32_16x16x32_bf16 v[192:195], a[80:83], a[180:183], v[192:195]
 v_rcp_f32 v29, v29
 v_mfma_f32_16x16x32_bf16 v[208:211], a[80:83], a[184:187], v[208:211]
 v_rcp_f32 v30, v30
 v_mfma_f32_16x16x32_bf16 v[208:211], a[96:99], a[204:207], v[208:211]
 v_rcp_f32 v31, v31
 v_mfma_f32_16x16x32_bf16 v[208:211], a[112:115], a[200:203], v[208:211]
 v_fma_f32 v32, v32, v28, -v28
 v_fma_f32 v33, v33, v29, -v29
 v_fma_f32 v34, v34, v30, -v30
 v_mfma_f32_16x16x32_bf16 v[208:211], a[128:131], a[196:199], v[208:211]
 s_waitcnt lgkmcnt(0)
 ds_read_b128 a[180:183], v3 offset:8704
 v_fma_f32 v35, v35, v31, -v31
 v_mfma_f32_16x16x32_bf16 v[208:211], a[144:147], a[192:195], v[208:211]
 v_cvt_pk_bf16_f32 v18, v32, v33
 v_cvt_pk_bf16_f32 v19, v34, v35
 v_mfma_f32_16x16x32_bf16 v[212:215], a[148:151], a[192:195], v[212:215]
 s_add_u32 s46, s40, 12288
 buffer_store_dwordx4 v[16:19], v6, s[12:15], s46 offen
 v_mul_f32 v20, s42, v160
 v_mfma_f32_16x16x32_bf16 v[212:215], a[132:135], a[196:199], v[212:215]
 v_mul_f32 v21, s42, v161
 v_mul_f32 v22, s42, v162
 v_mfma_f32_16x16x32_bf16 v[212:215], a[116:119], a[200:203], v[212:215]
 v_mul_f32 v23, s42, v163
 v_min_f32 v20, s47, v20
 v_min_f32 v21, s47, v21
 v_mfma_f32_16x16x32_bf16 v[212:215], a[100:103], a[204:207], v[212:215]
 v_min_f32 v22, s47, v22
 v_min_f32 v23, s47, v23
 v_mfma_f32_16x16x32_bf16 v[212:215], a[84:87], a[184:187], v[212:215]
 v_exp_f32 v20, v20
 v_mfma_f32_16x16x32_bf16 v[216:219], a[88:91], a[184:187], v[216:219]
 v_mul_f32 v24, s43, v168
 v_mul_f32 v25, s43, v169
 v_mfma_f32_16x16x32_bf16 v[216:219], a[104:107], a[204:207], v[216:219]
 v_exp_f32 v21, v21
 v_mfma_f32_16x16x32_bf16 v[216:219], a[120:123], a[200:203], v[216:219]
 v_mul_f32 v26, s43, v170
 v_mul_f32 v27, s43, v171
 v_mfma_f32_16x16x32_bf16 v[216:219], a[136:139], a[196:199], v[216:219]
 v_exp_f32 v22, v22
 v_add_f32 v28, 1.0, v20
 v_mfma_f32_16x16x32_bf16 v[216:219], a[152:155], a[192:195], v[216:219]
 v_exp_f32 v23, v23
 v_mfma_f32_16x16x32_bf16 v[220:223], a[156:159], a[192:195], v[220:223]
 v_exp_f32 v24, v24
 v_mfma_f32_16x16x32_bf16 v[220:223], a[140:143], a[196:199], v[220:223]
 v_add_f32 v29, 1.0, v21
 v_add_f32 v30, 1.0, v22
 v_mfma_f32_16x16x32_bf16 v[220:223], a[124:127], a[200:203], v[220:223]
 v_exp_f32 v25, v25
 v_mfma_f32_16x16x32_bf16 v[220:223], a[108:111], a[204:207], v[220:223]
 v_add_f32 v31, 1.0, v23
 v_exp_f32 v26, v26
 v_mfma_f32_16x16x32_bf16 v[220:223], a[92:95], a[184:187], v[220:223]
 v_exp_f32 v27, v27
 v_mfma_f32_16x16x32_bf16 v[236:239], a[92:95], a[204:207], v[236:239]
 v_fmac_f32 v28, v28, v24
 v_fmac_f32 v29, v29, v25
 v_mfma_f32_16x16x32_bf16 v[236:239], a[108:111], a[200:203], v[236:239]
 v_fmac_f32 v30, v30, v26
 v_fmac_f32 v31, v31, v27
 v_mfma_f32_16x16x32_bf16 v[236:239], a[124:127], a[196:199], v[236:239]
 v_rcp_f32 v28, v28
 v_mfma_f32_16x16x32_bf16 v[236:239], a[140:143], a[192:195], v[236:239]
 ds_read_b128 a[184:187], v3 offset:13056
 v_rcp_f32 v29, v29
 v_mfma_f32_16x16x32_bf16 v[236:239], a[156:159], a[188:191], v[236:239]
 v_rcp_f32 v30, v30
 v_mfma_f32_16x16x32_bf16 v[232:235], a[152:155], a[188:191], v[232:235]
 v_rcp_f32 v31, v31
 v_mfma_f32_16x16x32_bf16 v[232:235], a[136:139], a[192:195], v[232:235]
 v_fma_f32 v20, v20, v28, -v28
 v_fma_f32 v21, v21, v29, -v29
 v_mfma_f32_16x16x32_bf16 v[232:235], a[120:123], a[196:199], v[232:235]
 v_fma_f32 v22, v22, v30, -v30
 v_fma_f32 v23, v23, v31, -v31
 v_mfma_f32_16x16x32_bf16 v[232:235], a[104:107], a[200:203], v[232:235]
 v_cvt_pk_bf16_f32 v16, v20, v21
 v_cvt_pk_bf16_f32 v17, v22, v23
 v_mfma_f32_16x16x32_bf16 v[232:235], a[88:91], a[204:207], v[232:235]
 v_mul_f32 v32, s42, v164
 v_mul_f32 v33, s42, v165
 v_mul_f32 v34, s42, v166
 v_mfma_f32_16x16x32_bf16 v[228:231], a[84:87], a[204:207], v[228:231]
 v_mul_f32 v35, s42, v167
 v_min_f32 v32, s47, v32
 v_mfma_f32_16x16x32_bf16 v[228:231], a[100:103], a[200:203], v[228:231]
 v_min_f32 v33, s47, v33
 v_min_f32 v34, s47, v34
 v_mfma_f32_16x16x32_bf16 v[228:231], a[116:119], a[196:199], v[228:231]
 v_min_f32 v35, s47, v35
 v_mul_f32 v40, s43, v172
 v_mfma_f32_16x16x32_bf16 v[228:231], a[132:135], a[192:195], v[228:231]
 v_exp_f32 v32, v32
 v_mfma_f32_16x16x32_bf16 v[228:231], a[148:151], a[188:191], v[228:231]
 v_mul_f32 v41, s43, v173
 v_exp_f32 v33, v33
 v_mfma_f32_16x16x32_bf16 v[224:227], a[144:147], a[188:191], v[224:227]
 v_mul_f32 v42, s43, v174
 v_mul_f32 v43, s43, v175
 v_mfma_f32_16x16x32_bf16 v[224:227], a[128:131], a[192:195], v[224:227]
 v_exp_f32 v34, v34
 v_mfma_f32_16x16x32_bf16 v[224:227], a[112:115], a[196:199], v[224:227]
 v_exp_f32 v35, v35
 v_mfma_f32_16x16x32_bf16 v[224:227], a[96:99], a[200:203], v[224:227]
 v_exp_f32 v40, v40
 v_mfma_f32_16x16x32_bf16 v[224:227], a[80:83], a[204:207], v[224:227]
 ds_read_b128 a[188:191], v2 offset:19584
 v_add_f32 v28, 1.0, v32
 v_add_f32 v29, 1.0, v33
 v_mfma_f32_16x16x32_bf16 v[240:243], a[0:3], a[160:163], v[240:243]
 ds_read_b128 a[192:195], v2 offset:23936
 v_add_f32 v30, 1.0, v34
 v_mfma_f32_16x16x32_bf16 v[240:243], a[16:19], a[164:167], v[240:243]
 ds_read_b128 a[196:199], v2 offset:28288
 v_add_f32 v31, 1.0, v35
 v_mfma_f32_16x16x32_bf16 v[240:243], a[32:35], a[168:171], v[240:243]
 ds_read_b128 a[200:203], v4 offset:0
 v_fmac_f32 v28, v28, v40
 v_mfma_f32_16x16x32_bf16 v[240:243], a[48:51], a[172:175], v[240:243]
 ds_read_b128 a[204:207], v4 offset:4352
 v_mul_f32 v20, s42, v176
 v_mfma_f32_16x16x32_bf16 v[240:243], a[64:67], a[176:179], v[240:243]
 v_exp_f32 v41, v41
 v_mfma_f32_16x16x32_bf16 v[244:247], a[68:71], a[176:179], v[244:247]
 v_exp_f32 v42, v42
 v_fmac_f32 v29, v29, v41
 v_mfma_f32_16x16x32_bf16 v[244:247], a[52:55], a[172:175], v[244:247]
 v_exp_f32 v43, v43
 v_mfma_f32_16x16x32_bf16 v[244:247], a[36:39], a[168:171], v[244:247]
 v_fmac_f32 v30, v30, v42
 v_fmac_f32 v31, v31, v43
 v_mfma_f32_16x16x32_bf16 v[244:247], a[20:23], a[164:167], v[244:247]
 v_rcp_f32 v28, v28
 v_mfma_f32_16x16x32_bf16 v[244:247], a[4:7], a[160:163], v[244:247]
 v_rcp_f32 v29, v29
 v_mfma_f32_16x16x32_bf16 v[248:251], a[8:11], a[160:163], v[248:251]
 v_rcp_f32 v30, v30
 v_fma_f32 v32, v32, v28, -v28
 v_mfma_f32_16x16x32_bf16 v[248:251], a[24:27], a[164:167], v[248:251]
 v_rcp_f32 v31, v31
 v_mfma_f32_16x16x32_bf16 v[248:251], a[40:43], a[168:171], v[248:251]
 v_fma_f32 v33, v33, v29, -v29
 v_fma_f32 v34, v34, v30, -v30
 v_mfma_f32_16x16x32_bf16 v[248:251], a[56:59], a[172:175], v[248:251]
 v_fma_f32 v35, v35, v31, -v31
 v_cvt_pk_bf16_f32 v18, v32, v33
 v_mfma_f32_16x16x32_bf16 v[248:251], a[72:75], a[176:179], v[248:251]
 s_add_u32 s46, s40, 14336
 v_cvt_pk_bf16_f32 v19, v34, v35
 buffer_store_dwordx4 v[16:19], v6, s[12:15], s46 offen
 v_mfma_f32_16x16x32_bf16 v[252:255], a[76:79], a[176:179], v[252:255]
 v_mul_f32 v21, s42, v177
 v_mul_f32 v22, s42, v178
 v_mul_f32 v23, s42, v179
 v_mfma_f32_16x16x32_bf16 v[252:255], a[60:63], a[172:175], v[252:255]
 v_min_f32 v20, s47, v20
 v_min_f32 v21, s47, v21
 v_mfma_f32_16x16x32_bf16 v[252:255], a[44:47], a[168:171], v[252:255]
 v_min_f32 v22, s47, v22
 v_min_f32 v23, s47, v23
 v_mfma_f32_16x16x32_bf16 v[252:255], a[28:31], a[164:167], v[252:255]
 v_exp_f32 v20, v20
 v_mfma_f32_16x16x32_bf16 v[252:255], a[12:15], a[160:163], v[252:255]
 v_mul_f32 v24, s43, v184
 v_mul_f32 v25, s43, v185
 v_mfma_f32_16x16x32_bf16 a[220:223], a[12:15], a[164:167], a[220:223]
 v_exp_f32 v21, v21
 v_mfma_f32_16x16x32_bf16 a[220:223], a[28:31], a[168:171], a[220:223]
 v_mul_f32 v26, s43, v186
 v_mul_f32 v27, s43, v187
 v_add_f32 v28, 1.0, v20
 v_mfma_f32_16x16x32_bf16 a[220:223], a[44:47], a[172:175], a[220:223]
 v_exp_f32 v22, v22
 v_mfma_f32_16x16x32_bf16 a[220:223], a[60:63], a[176:179], a[220:223]
 s_waitcnt lgkmcnt(0)
 ds_read_b128 a[160:163], v4 offset:8704
 v_add_f32 v29, 1.0, v21
 v_mfma_f32_16x16x32_bf16 a[220:223], a[76:79], a[180:183], a[220:223]
 v_exp_f32 v23, v23
 v_mfma_f32_16x16x32_bf16 a[216:219], a[72:75], a[180:183], a[216:219]
 v_exp_f32 v24, v24
 v_mfma_f32_16x16x32_bf16 a[216:219], a[56:59], a[176:179], a[216:219]
 v_exp_f32 v25, v25
 v_add_f32 v30, 1.0, v22
 v_mfma_f32_16x16x32_bf16 a[216:219], a[40:43], a[172:175], a[216:219]
 v_add_f32 v31, 1.0, v23
 v_fmac_f32 v28, v28, v24
 v_mfma_f32_16x16x32_bf16 a[216:219], a[24:27], a[168:171], a[216:219]
 v_exp_f32 v26, v26
 v_mfma_f32_16x16x32_bf16 a[216:219], a[8:11], a[164:167], a[216:219]
 v_exp_f32 v27, v27
 v_mfma_f32_16x16x32_bf16 a[212:215], a[4:7], a[164:167], a[212:215]
 v_fmac_f32 v29, v29, v25
 v_fmac_f32 v30, v30, v26
 v_mfma_f32_16x16x32_bf16 a[212:215], a[20:23], a[168:171], a[212:215]
 v_fmac_f32 v31, v31, v27
 v_rcp_f32 v28, v28
 v_mfma_f32_16x16x32_bf16 a[212:215], a[36:39], a[172:175], a[212:215]
 v_rcp_f32 v29, v29
 v_mfma_f32_16x16x32_bf16 a[212:215], a[52:55], a[176:179], a[212:215]
 v_rcp_f32 v30, v30
 v_mfma_f32_16x16x32_bf16 a[212:215], a[68:71], a[180:183], a[212:215]
 v_rcp_f32 v31, v31
 v_mfma_f32_16x16x32_bf16 a[208:211], a[64:67], a[180:183], a[208:211]
 v_fma_f32 v20, v20, v28, -v28
 v_fma_f32 v21, v21, v29, -v29
 v_mfma_f32_16x16x32_bf16 a[208:211], a[48:51], a[176:179], a[208:211]
 v_fma_f32 v22, v22, v30, -v30
 v_fma_f32 v23, v23, v31, -v31
 v_mfma_f32_16x16x32_bf16 a[208:211], a[32:35], a[172:175], a[208:211]
 v_cvt_pk_bf16_f32 v16, v20, v21
 v_cvt_pk_bf16_f32 v17, v22, v23
 v_mul_f32 v32, s42, v180
 v_mfma_f32_16x16x32_bf16 a[208:211], a[16:19], a[168:171], a[208:211]
 v_mul_f32 v33, s42, v181
 v_mul_f32 v34, s42, v182
 v_mfma_f32_16x16x32_bf16 a[208:211], a[0:3], a[164:167], a[208:211]
 v_mul_f32 v35, s42, v183
 v_min_f32 v32, s47, v32
 v_mfma_f32_16x16x32_bf16 a[224:227], a[0:3], a[168:171], a[224:227]
 v_min_f32 v33, s47, v33
 v_min_f32 v34, s47, v34
 v_mfma_f32_16x16x32_bf16 a[224:227], a[16:19], a[172:175], a[224:227]
 v_min_f32 v35, s47, v35
 v_mul_f32 v40, s43, v188
 v_mfma_f32_16x16x32_bf16 a[224:227], a[32:35], a[176:179], a[224:227]
 v_exp_f32 v32, v32
 v_mul_f32 v41, s43, v189
 v_mfma_f32_16x16x32_bf16 a[224:227], a[48:51], a[180:183], a[224:227]
 ds_read_b128 a[164:167], v4 offset:13056
 v_mul_f32 v42, s43, v190
 v_mfma_f32_16x16x32_bf16 a[224:227], a[64:67], a[184:187], a[224:227]
 v_exp_f32 v33, v33
 v_mfma_f32_16x16x32_bf16 a[228:231], a[68:71], a[184:187], a[228:231]
 v_mul_f32 v43, s43, v191
 v_add_f32 v28, 1.0, v32
 v_mfma_f32_16x16x32_bf16 a[228:231], a[52:55], a[180:183], a[228:231]
 v_exp_f32 v34, v34
 v_mfma_f32_16x16x32_bf16 a[228:231], a[36:39], a[176:179], a[228:231]
 v_exp_f32 v35, v35
 v_add_f32 v29, 1.0, v33
 v_mfma_f32_16x16x32_bf16 a[228:231], a[20:23], a[172:175], a[228:231]
 v_exp_f32 v40, v40
 v_mfma_f32_16x16x32_bf16 a[228:231], a[4:7], a[168:171], a[228:231]
 v_exp_f32 v41, v41
 v_mfma_f32_16x16x32_bf16 a[232:235], a[8:11], a[168:171], a[232:235]
 v_add_f32 v30, 1.0, v34
 v_add_f32 v31, 1.0, v35
 v_mfma_f32_16x16x32_bf16 a[232:235], a[24:27], a[172:175], a[232:235]
 v_exp_f32 v42, v42
 v_mfma_f32_16x16x32_bf16 a[232:235], a[40:43], a[176:179], a[232:235]
 v_exp_f32 v43, v43
 v_mfma_f32_16x16x32_bf16 a[232:235], a[56:59], a[180:183], a[232:235]
 v_fmac_f32 v28, v28, v40
 v_fmac_f32 v29, v29, v41
 v_fmac_f32 v30, v30, v42
 v_mfma_f32_16x16x32_bf16 a[232:235], a[72:75], a[184:187], a[232:235]
 v_fmac_f32 v31, v31, v43
 v_mul_f32 v20, s42, v192
 v_mfma_f32_16x16x32_bf16 a[236:239], a[76:79], a[184:187], a[236:239]
 v_rcp_f32 v28, v28
 v_mfma_f32_16x16x32_bf16 a[236:239], a[60:63], a[180:183], a[236:239]
 v_rcp_f32 v29, v29
 v_mfma_f32_16x16x32_bf16 a[236:239], a[44:47], a[176:179], a[236:239]
 v_rcp_f32 v30, v30
 v_mfma_f32_16x16x32_bf16 a[236:239], a[28:31], a[172:175], a[236:239]
 v_rcp_f32 v31, v31
 v_fma_f32 v32, v32, v28, -v28
 v_mfma_f32_16x16x32_bf16 a[236:239], a[12:15], a[168:171], a[236:239]
 v_fma_f32 v33, v33, v29, -v29
 v_fma_f32 v34, v34, v30, -v30
 v_mfma_f32_16x16x32_bf16 v[240:243], a[80:83], a[188:191], v[240:243]
 v_fma_f32 v35, v35, v31, -v31
 v_cvt_pk_bf16_f32 v18, v32, v33
 v_mfma_f32_16x16x32_bf16 v[240:243], a[96:99], a[192:195], v[240:243]
 s_add_u32 s46, s40, 1024
 v_cvt_pk_bf16_f32 v19, v34, v35
 buffer_store_dwordx4 v[16:19], v6, s[12:15], s46 offen
 v_mfma_f32_16x16x32_bf16 v[240:243], a[112:115], a[196:199], v[240:243]
 v_mul_f32 v21, s42, v193
 v_mul_f32 v22, s42, v194
 v_mfma_f32_16x16x32_bf16 v[240:243], a[128:131], a[200:203], v[240:243]
 v_mul_f32 v23, s42, v195
 v_min_f32 v20, s47, v20
 v_min_f32 v21, s47, v21
 v_mfma_f32_16x16x32_bf16 v[240:243], a[144:147], a[204:207], v[240:243]
 v_min_f32 v22, s47, v22
 v_min_f32 v23, s47, v23
 v_mfma_f32_16x16x32_bf16 v[244:247], a[148:151], a[204:207], v[244:247]
 v_exp_f32 v20, v20
 v_mfma_f32_16x16x32_bf16 v[244:247], a[132:135], a[200:203], v[244:247]
 v_mul_f32 v24, s43, v200
 v_mul_f32 v25, s43, v201
 v_mfma_f32_16x16x32_bf16 v[244:247], a[116:119], a[196:199], v[244:247]
 v_exp_f32 v21, v21
 v_mfma_f32_16x16x32_bf16 v[244:247], a[100:103], a[192:195], v[244:247]
 v_mul_f32 v26, s43, v202
 v_mul_f32 v27, s43, v203
 v_mfma_f32_16x16x32_bf16 v[244:247], a[84:87], a[188:191], v[244:247]
 v_exp_f32 v22, v22
 v_add_f32 v28, 1.0, v20
 v_mfma_f32_16x16x32_bf16 v[248:251], a[88:91], a[188:191], v[248:251]
 v_exp_f32 v23, v23
 v_mfma_f32_16x16x32_bf16 v[248:251], a[104:107], a[192:195], v[248:251]
 v_exp_f32 v24, v24
 v_mfma_f32_16x16x32_bf16 v[248:251], a[120:123], a[196:199], v[248:251]
 v_add_f32 v29, 1.0, v21
 v_add_f32 v30, 1.0, v22
 v_mfma_f32_16x16x32_bf16 v[248:251], a[136:139], a[200:203], v[248:251]
 v_exp_f32 v25, v25
 v_mfma_f32_16x16x32_bf16 v[248:251], a[152:155], a[204:207], v[248:251]
 v_add_f32 v31, 1.0, v23
 v_exp_f32 v26, v26
 v_mfma_f32_16x16x32_bf16 v[252:255], a[156:159], a[204:207], v[252:255]
 v_exp_f32 v27, v27
 v_mfma_f32_16x16x32_bf16 v[252:255], a[140:143], a[200:203], v[252:255]
 v_fmac_f32 v28, v28, v24
 v_fmac_f32 v29, v29, v25
 v_mfma_f32_16x16x32_bf16 v[252:255], a[124:127], a[196:199], v[252:255]
 v_fmac_f32 v30, v30, v26
 v_fmac_f32 v31, v31, v27
 v_mfma_f32_16x16x32_bf16 v[252:255], a[108:111], a[192:195], v[252:255]
 v_rcp_f32 v28, v28
 v_mfma_f32_16x16x32_bf16 v[252:255], a[92:95], a[188:191], v[252:255]
 v_rcp_f32 v29, v29
 v_fma_f32 v20, v20, v28, -v28
 v_mfma_f32_16x16x32_bf16 a[220:223], a[92:95], a[192:195], a[220:223]
 v_rcp_f32 v30, v30
 v_mfma_f32_16x16x32_bf16 a[220:223], a[108:111], a[196:199], a[220:223]
 v_rcp_f32 v31, v31
 v_mfma_f32_16x16x32_bf16 a[220:223], a[124:127], a[200:203], a[220:223]
 v_fma_f32 v21, v21, v29, -v29
 v_fma_f32 v22, v22, v30, -v30
 v_mfma_f32_16x16x32_bf16 a[220:223], a[140:143], a[204:207], a[220:223]
 s_waitcnt lgkmcnt(0)
 v_fma_f32 v23, v23, v31, -v31
 v_cvt_pk_bf16_f32 v16, v20, v21
 v_mfma_f32_16x16x32_bf16 a[220:223], a[156:159], a[160:163], a[220:223]
 v_cvt_pk_bf16_f32 v17, v22, v23
 v_mul_f32 v32, s42, v196
 v_mfma_f32_16x16x32_bf16 a[216:219], a[152:155], a[160:163], a[216:219]
 v_mul_f32 v33, s42, v197
 v_mul_f32 v34, s42, v198
 v_mul_f32 v35, s42, v199
 v_mfma_f32_16x16x32_bf16 a[216:219], a[136:139], a[204:207], a[216:219]
 v_min_f32 v32, s47, v32
 v_min_f32 v33, s47, v33
 v_mfma_f32_16x16x32_bf16 a[216:219], a[120:123], a[200:203], a[216:219]
 v_min_f32 v34, s47, v34
 v_min_f32 v35, s47, v35
 v_mfma_f32_16x16x32_bf16 a[216:219], a[104:107], a[196:199], a[216:219]
 v_exp_f32 v32, v32
 v_mfma_f32_16x16x32_bf16 a[216:219], a[88:91], a[192:195], a[216:219]
 v_mul_f32 v40, s43, v204
 v_mul_f32 v41, s43, v205
 v_mfma_f32_16x16x32_bf16 a[212:215], a[84:87], a[192:195], a[212:215]
 v_exp_f32 v33, v33
 v_mul_f32 v42, s43, v206
 v_mfma_f32_16x16x32_bf16 a[212:215], a[100:103], a[196:199], a[212:215]
 v_mul_f32 v43, s43, v207
 v_add_f32 v28, 1.0, v32
 v_mfma_f32_16x16x32_bf16 a[212:215], a[116:119], a[200:203], a[212:215]
 v_exp_f32 v34, v34
 v_mfma_f32_16x16x32_bf16 a[212:215], a[132:135], a[204:207], a[212:215]
 v_exp_f32 v35, v35
 v_mfma_f32_16x16x32_bf16 a[212:215], a[148:151], a[160:163], a[212:215]
 v_exp_f32 v40, v40
 v_mfma_f32_16x16x32_bf16 a[208:211], a[144:147], a[160:163], a[208:211]
 v_add_f32 v29, 1.0, v33
 v_exp_f32 v41, v41
 v_mfma_f32_16x16x32_bf16 a[208:211], a[128:131], a[204:207], a[208:211]
 v_add_f32 v30, 1.0, v34
 v_add_f32 v31, 1.0, v35
 v_mfma_f32_16x16x32_bf16 a[208:211], a[112:115], a[200:203], a[208:211]
 v_exp_f32 v42, v42
 v_mfma_f32_16x16x32_bf16 a[208:211], a[96:99], a[196:199], a[208:211]
 v_exp_f32 v43, v43
 v_mfma_f32_16x16x32_bf16 a[208:211], a[80:83], a[192:195], a[208:211]
 v_fmac_f32 v28, v28, v40
 v_fmac_f32 v29, v29, v41
 v_mfma_f32_16x16x32_bf16 a[224:227], a[80:83], a[196:199], a[224:227]
 v_fmac_f32 v30, v30, v42
 v_fmac_f32 v31, v31, v43
 v_mfma_f32_16x16x32_bf16 a[224:227], a[96:99], a[200:203], a[224:227]
 v_rcp_f32 v28, v28
 v_mfma_f32_16x16x32_bf16 a[224:227], a[112:115], a[204:207], a[224:227]
 v_rcp_f32 v29, v29
 v_mfma_f32_16x16x32_bf16 a[224:227], a[128:131], a[160:163], a[224:227]
 v_rcp_f32 v30, v30
 v_mfma_f32_16x16x32_bf16 a[224:227], a[144:147], a[164:167], a[224:227]
 v_rcp_f32 v31, v31
 v_mfma_f32_16x16x32_bf16 a[228:231], a[148:151], a[164:167], a[228:231]
 v_fma_f32 v32, v32, v28, -v28
 v_fma_f32 v33, v33, v29, -v29
 v_mfma_f32_16x16x32_bf16 a[228:231], a[132:135], a[160:163], a[228:231]
 v_fma_f32 v34, v34, v30, -v30
 v_fma_f32 v35, v35, v31, -v31
 v_cvt_pk_bf16_f32 v18, v32, v33
 v_mfma_f32_16x16x32_bf16 a[228:231], a[116:119], a[204:207], a[228:231]
 s_add_u32 s46, s40, 3072
 v_cvt_pk_bf16_f32 v19, v34, v35
 buffer_store_dwordx4 v[16:19], v6, s[12:15], s46 offen
 v_mfma_f32_16x16x32_bf16 a[228:231], a[100:103], a[200:203], a[228:231]
 v_mfma_f32_16x16x32_bf16 a[228:231], a[84:87], a[196:199], a[228:231]
 v_mfma_f32_16x16x32_bf16 a[232:235], a[88:91], a[196:199], a[232:235]
 v_mfma_f32_16x16x32_bf16 a[232:235], a[104:107], a[200:203], a[232:235]
 v_mfma_f32_16x16x32_bf16 a[232:235], a[120:123], a[204:207], a[232:235]
 v_mfma_f32_16x16x32_bf16 a[232:235], a[136:139], a[160:163], a[232:235]
 v_mfma_f32_16x16x32_bf16 a[232:235], a[152:155], a[164:167], a[232:235]
 v_mfma_f32_16x16x32_bf16 a[236:239], a[156:159], a[164:167], a[236:239]
 v_mfma_f32_16x16x32_bf16 a[236:239], a[140:143], a[160:163], a[236:239]
 v_mfma_f32_16x16x32_bf16 a[236:239], a[124:127], a[204:207], a[236:239]
 v_mfma_f32_16x16x32_bf16 a[236:239], a[108:111], a[200:203], a[236:239]
 v_mfma_f32_16x16x32_bf16 a[236:239], a[92:95], a[196:199], a[236:239]
 s_nop 7
 v_pk_mul_f32 v[20:21], v[208:209], s[42:43] op_sel_hi:[1,0]
 v_pk_mul_f32 v[22:23], v[210:211], s[42:43] op_sel_hi:[1,0]
 v_pk_mul_f32 v[24:25], v[216:217], s[42:43] op_sel:[0,1] op_sel_hi:[1,1]
 v_pk_mul_f32 v[26:27], v[218:219], s[42:43] op_sel:[0,1] op_sel_hi:[1,1]
 v_min_f32 v20, s47, v20
 v_min_f32 v21, s47, v21
 v_min_f32 v22, s47, v22
 v_min_f32 v23, s47, v23
 v_exp_f32 v24, v24
 v_exp_f32 v25, v25
 v_exp_f32 v26, v26
 v_exp_f32 v27, v27
 v_exp_f32 v20, v20
 v_exp_f32 v21, v21
 v_exp_f32 v22, v22
 v_exp_f32 v23, v23
 v_pk_add_f32 v[28:29], v[20:21], 1.0 op_sel_hi:[1,0]
 v_pk_add_f32 v[30:31], v[22:23], 1.0 op_sel_hi:[1,0]
 v_pk_fma_f32 v[28:29], v[28:29], v[24:25], v[28:29]
 v_pk_fma_f32 v[30:31], v[30:31], v[26:27], v[30:31]
 v_rcp_f32 v28, v28
 v_rcp_f32 v29, v29
 v_rcp_f32 v30, v30
 v_rcp_f32 v31, v31
 v_pk_fma_f32 v[20:21], v[20:21], v[28:29], v[28:29] neg_lo:[0,0,1] neg_hi:[0,0,1]
 v_pk_fma_f32 v[22:23], v[22:23], v[30:31], v[30:31] neg_lo:[0,0,1] neg_hi:[0,0,1]
 v_cvt_pk_bf16_f32 v16, v20, v21
 v_cvt_pk_bf16_f32 v17, v22, v23
 v_pk_mul_f32 v[20:21], v[212:213], s[42:43] op_sel_hi:[1,0]
 v_pk_mul_f32 v[22:23], v[214:215], s[42:43] op_sel_hi:[1,0]
 v_pk_mul_f32 v[24:25], v[220:221], s[42:43] op_sel:[0,1] op_sel_hi:[1,1]
 v_pk_mul_f32 v[26:27], v[222:223], s[42:43] op_sel:[0,1] op_sel_hi:[1,1]
 v_min_f32 v20, s47, v20
 v_min_f32 v21, s47, v21
 v_min_f32 v22, s47, v22
 v_min_f32 v23, s47, v23
 v_exp_f32 v24, v24
 v_exp_f32 v25, v25
 v_exp_f32 v26, v26
 v_exp_f32 v27, v27
 v_exp_f32 v20, v20
 v_exp_f32 v21, v21
 v_exp_f32 v22, v22
 v_exp_f32 v23, v23
 v_pk_add_f32 v[28:29], v[20:21], 1.0 op_sel_hi:[1,0]
 v_pk_add_f32 v[30:31], v[22:23], 1.0 op_sel_hi:[1,0]
 v_pk_fma_f32 v[28:29], v[28:29], v[24:25], v[28:29]
 v_pk_fma_f32 v[30:31], v[30:31], v[26:27], v[30:31]
 v_rcp_f32 v28, v28
 v_rcp_f32 v29, v29
 v_rcp_f32 v30, v30
 v_rcp_f32 v31, v31
 v_pk_fma_f32 v[20:21], v[20:21], v[28:29], v[28:29] neg_lo:[0,0,1] neg_hi:[0,0,1]
 v_pk_fma_f32 v[22:23], v[22:23], v[30:31], v[30:31] neg_lo:[0,0,1] neg_hi:[0,0,1]
 v_cvt_pk_bf16_f32 v18, v20, v21
 v_cvt_pk_bf16_f32 v19, v22, v23
 s_add_u32 s46, s40, 5120
 buffer_store_dwordx4 v[16:19], v6, s[12:15], s46 offen
 s_nop 1
 v_pk_mul_f32 v[20:21], v[224:225], s[42:43] op_sel_hi:[1,0]
 v_pk_mul_f32 v[22:23], v[226:227], s[42:43] op_sel_hi:[1,0]
 v_pk_mul_f32 v[24:25], v[232:233], s[42:43] op_sel:[0,1] op_sel_hi:[1,1]
 v_pk_mul_f32 v[26:27], v[234:235], s[42:43] op_sel:[0,1] op_sel_hi:[1,1]
 v_min_f32 v20, s47, v20
 v_min_f32 v21, s47, v21
 v_min_f32 v22, s47, v22
 v_min_f32 v23, s47, v23
 v_exp_f32 v24, v24
 v_exp_f32 v25, v25
 v_exp_f32 v26, v26
 v_exp_f32 v27, v27
 v_exp_f32 v20, v20
 v_exp_f32 v21, v21
 v_exp_f32 v22, v22
 v_exp_f32 v23, v23
 v_pk_add_f32 v[28:29], v[20:21], 1.0 op_sel_hi:[1,0]
 v_pk_add_f32 v[30:31], v[22:23], 1.0 op_sel_hi:[1,0]
 v_pk_fma_f32 v[28:29], v[28:29], v[24:25], v[28:29]
 v_pk_fma_f32 v[30:31], v[30:31], v[26:27], v[30:31]
 v_rcp_f32 v28, v28
 v_rcp_f32 v29, v29
 v_rcp_f32 v30, v30
 v_rcp_f32 v31, v31
 v_pk_fma_f32 v[20:21], v[20:21], v[28:29], v[28:29] neg_lo:[0,0,1] neg_hi:[0,0,1]
 v_pk_fma_f32 v[22:23], v[22:23], v[30:31], v[30:31] neg_lo:[0,0,1] neg_hi:[0,0,1]
 v_cvt_pk_bf16_f32 v16, v20, v21
 v_cvt_pk_bf16_f32 v17, v22, v23
 v_pk_mul_f32 v[20:21], v[228:229], s[42:43] op_sel_hi:[1,0]
 v_pk_mul_f32 v[22:23], v[230:231], s[42:43] op_sel_hi:[1,0]
 v_pk_mul_f32 v[24:25], v[236:237], s[42:43] op_sel:[0,1] op_sel_hi:[1,1]
 v_pk_mul_f32 v[26:27], v[238:239], s[42:43] op_sel:[0,1] op_sel_hi:[1,1]
 v_min_f32 v20, s47, v20
 v_min_f32 v21, s47, v21
 v_min_f32 v22, s47, v22
 v_min_f32 v23, s47, v23
 v_exp_f32 v24, v24
 v_exp_f32 v25, v25
 v_exp_f32 v26, v26
 v_exp_f32 v27, v27
 v_exp_f32 v20, v20
 v_exp_f32 v21, v21
 v_exp_f32 v22, v22
 v_exp_f32 v23, v23
 v_pk_add_f32 v[28:29], v[20:21], 1.0 op_sel_hi:[1,0]
 v_pk_add_f32 v[30:31], v[22:23], 1.0 op_sel_hi:[1,0]
 v_pk_fma_f32 v[28:29], v[28:29], v[24:25], v[28:29]
 v_pk_fma_f32 v[30:31], v[30:31], v[26:27], v[30:31]
 v_rcp_f32 v28, v28
 v_rcp_f32 v29, v29
 v_rcp_f32 v30, v30
 v_rcp_f32 v31, v31
 v_pk_fma_f32 v[20:21], v[20:21], v[28:29], v[28:29] neg_lo:[0,0,1] neg_hi:[0,0,1]
 v_pk_fma_f32 v[22:23], v[22:23], v[30:31], v[30:31] neg_lo:[0,0,1] neg_hi:[0,0,1]
 v_cvt_pk_bf16_f32 v18, v20, v21
 v_cvt_pk_bf16_f32 v19, v22, v23
 s_add_u32 s46, s40, 7168
 buffer_store_dwordx4 v[16:19], v6, s[12:15], s46 offen
 s_nop 1
 v_pk_mul_f32 v[20:21], v[240:241], s[42:43] op_sel_hi:[1,0]
 v_pk_mul_f32 v[22:23], v[242:243], s[42:43] op_sel_hi:[1,0]
 v_pk_mul_f32 v[24:25], v[248:249], s[42:43] op_sel:[0,1] op_sel_hi:[1,1]
 v_pk_mul_f32 v[26:27], v[250:251], s[42:43] op_sel:[0,1] op_sel_hi:[1,1]
 v_min_f32 v20, s47, v20
 v_min_f32 v21, s47, v21
 v_min_f32 v22, s47, v22
 v_min_f32 v23, s47, v23
 v_exp_f32 v24, v24
 v_exp_f32 v25, v25
 v_exp_f32 v26, v26
 v_exp_f32 v27, v27
 v_exp_f32 v20, v20
 v_exp_f32 v21, v21
 v_exp_f32 v22, v22
 v_exp_f32 v23, v23
 v_pk_add_f32 v[28:29], v[20:21], 1.0 op_sel_hi:[1,0]
 v_pk_add_f32 v[30:31], v[22:23], 1.0 op_sel_hi:[1,0]
 v_pk_fma_f32 v[28:29], v[28:29], v[24:25], v[28:29]
 v_pk_fma_f32 v[30:31], v[30:31], v[26:27], v[30:31]
 v_rcp_f32 v28, v28
 v_rcp_f32 v29, v29
 v_rcp_f32 v30, v30
 v_rcp_f32 v31, v31
 v_pk_fma_f32 v[20:21], v[20:21], v[28:29], v[28:29] neg_lo:[0,0,1] neg_hi:[0,0,1]
 v_pk_fma_f32 v[22:23], v[22:23], v[30:31], v[30:31] neg_lo:[0,0,1] neg_hi:[0,0,1]
 v_cvt_pk_bf16_f32 v16, v20, v21
 v_cvt_pk_bf16_f32 v17, v22, v23
 v_pk_mul_f32 v[20:21], v[244:245], s[42:43] op_sel_hi:[1,0]
 v_pk_mul_f32 v[22:23], v[246:247], s[42:43] op_sel_hi:[1,0]
 v_pk_mul_f32 v[24:25], v[252:253], s[42:43] op_sel:[0,1] op_sel_hi:[1,1]
 v_pk_mul_f32 v[26:27], v[254:255], s[42:43] op_sel:[0,1] op_sel_hi:[1,1]
 v_min_f32 v20, s47, v20
 v_min_f32 v21, s47, v21
 v_min_f32 v22, s47, v22
 v_min_f32 v23, s47, v23
 v_exp_f32 v24, v24
 v_exp_f32 v25, v25
 v_exp_f32 v26, v26
 v_exp_f32 v27, v27
 v_exp_f32 v20, v20
 v_exp_f32 v21, v21
 v_exp_f32 v22, v22
 v_exp_f32 v23, v23
 v_pk_add_f32 v[28:29], v[20:21], 1.0 op_sel_hi:[1,0]
 v_pk_add_f32 v[30:31], v[22:23], 1.0 op_sel_hi:[1,0]
 v_pk_fma_f32 v[28:29], v[28:29], v[24:25], v[28:29]
 v_pk_fma_f32 v[30:31], v[30:31], v[26:27], v[30:31]
 v_rcp_f32 v28, v28
 v_rcp_f32 v29, v29
 v_rcp_f32 v30, v30
 v_rcp_f32 v31, v31
 v_pk_fma_f32 v[20:21], v[20:21], v[28:29], v[28:29] neg_lo:[0,0,1] neg_hi:[0,0,1]
 v_pk_fma_f32 v[22:23], v[22:23], v[30:31], v[30:31] neg_lo:[0,0,1] neg_hi:[0,0,1]
 v_cvt_pk_bf16_f32 v18, v20, v21
 v_cvt_pk_bf16_f32 v19, v22, v23
 s_add_u32 s46, s40, 9216
 buffer_store_dwordx4 v[16:19], v6, s[12:15], s46 offen
 s_nop 1
 v_accvgpr_read_b32 v20, a208
 v_accvgpr_read_b32 v21, a209
 v_accvgpr_read_b32 v22, a210
 v_accvgpr_read_b32 v23, a211
 v_accvgpr_read_b32 v24, a216
 v_accvgpr_read_b32 v25, a217
 v_accvgpr_read_b32 v26, a218
 v_accvgpr_read_b32 v27, a219
 v_pk_mul_f32 v[20:21], v[20:21], s[42:43] op_sel_hi:[1,0]
 v_pk_mul_f32 v[22:23], v[22:23], s[42:43] op_sel_hi:[1,0]
 v_pk_mul_f32 v[24:25], v[24:25], s[42:43] op_sel:[0,1] op_sel_hi:[1,1]
 v_pk_mul_f32 v[26:27], v[26:27], s[42:43] op_sel:[0,1] op_sel_hi:[1,1]
 v_min_f32 v20, s47, v20
 v_min_f32 v21, s47, v21
 v_min_f32 v22, s47, v22
 v_min_f32 v23, s47, v23
 v_exp_f32 v24, v24
 v_exp_f32 v25, v25
 v_exp_f32 v26, v26
 v_exp_f32 v27, v27
 v_exp_f32 v20, v20
 v_exp_f32 v21, v21
 v_exp_f32 v22, v22
 v_exp_f32 v23, v23
 v_pk_add_f32 v[28:29], v[20:21], 1.0 op_sel_hi:[1,0]
 v_pk_add_f32 v[30:31], v[22:23], 1.0 op_sel_hi:[1,0]
 v_pk_fma_f32 v[28:29], v[28:29], v[24:25], v[28:29]
 v_pk_fma_f32 v[30:31], v[30:31], v[26:27], v[30:31]
 v_rcp_f32 v28, v28
 v_rcp_f32 v29, v29
 v_rcp_f32 v30, v30
 v_rcp_f32 v31, v31
 v_pk_fma_f32 v[20:21], v[20:21], v[28:29], v[28:29] neg_lo:[0,0,1] neg_hi:[0,0,1]
 v_pk_fma_f32 v[22:23], v[22:23], v[30:31], v[30:31] neg_lo:[0,0,1] neg_hi:[0,0,1]
 v_cvt_pk_bf16_f32 v16, v20, v21
 v_cvt_pk_bf16_f32 v17, v22, v23
 v_accvgpr_read_b32 v20, a212
 v_accvgpr_read_b32 v21, a213
 v_accvgpr_read_b32 v22, a214
 v_accvgpr_read_b32 v23, a215
 v_accvgpr_read_b32 v24, a220
 v_accvgpr_read_b32 v25, a221
 v_accvgpr_read_b32 v26, a222
 v_accvgpr_read_b32 v27, a223
 v_pk_mul_f32 v[20:21], v[20:21], s[42:43] op_sel_hi:[1,0]
 v_pk_mul_f32 v[22:23], v[22:23], s[42:43] op_sel_hi:[1,0]
 v_pk_mul_f32 v[24:25], v[24:25], s[42:43] op_sel:[0,1] op_sel_hi:[1,1]
 v_pk_mul_f32 v[26:27], v[26:27], s[42:43] op_sel:[0,1] op_sel_hi:[1,1]
 v_min_f32 v20, s47, v20
 v_min_f32 v21, s47, v21
 v_min_f32 v22, s47, v22
 v_min_f32 v23, s47, v23
 v_exp_f32 v24, v24
 v_exp_f32 v25, v25
 v_exp_f32 v26, v26
 v_exp_f32 v27, v27
 v_exp_f32 v20, v20
 v_exp_f32 v21, v21
 v_exp_f32 v22, v22
 v_exp_f32 v23, v23
 v_pk_add_f32 v[28:29], v[20:21], 1.0 op_sel_hi:[1,0]
 v_pk_add_f32 v[30:31], v[22:23], 1.0 op_sel_hi:[1,0]
 v_pk_fma_f32 v[28:29], v[28:29], v[24:25], v[28:29]
 v_pk_fma_f32 v[30:31], v[30:31], v[26:27], v[30:31]
 v_rcp_f32 v28, v28
 v_rcp_f32 v29, v29
 v_rcp_f32 v30, v30
 v_rcp_f32 v31, v31
 v_pk_fma_f32 v[20:21], v[20:21], v[28:29], v[28:29] neg_lo:[0,0,1] neg_hi:[0,0,1]
 v_pk_fma_f32 v[22:23], v[22:23], v[30:31], v[30:31] neg_lo:[0,0,1] neg_hi:[0,0,1]
 v_cvt_pk_bf16_f32 v18, v20, v21
 v_cvt_pk_bf16_f32 v19, v22, v23
 s_add_u32 s46, s40, 11264
 buffer_store_dwordx4 v[16:19], v6, s[12:15], s46 offen
 s_nop 1
 v_accvgpr_read_b32 v20, a224
 v_accvgpr_read_b32 v21, a225
 v_accvgpr_read_b32 v22, a226
 v_accvgpr_read_b32 v23, a227
 v_accvgpr_read_b32 v24, a232
 v_accvgpr_read_b32 v25, a233
 v_accvgpr_read_b32 v26, a234
 v_accvgpr_read_b32 v27, a235
 v_pk_mul_f32 v[20:21], v[20:21], s[42:43] op_sel_hi:[1,0]
 v_pk_mul_f32 v[22:23], v[22:23], s[42:43] op_sel_hi:[1,0]
 v_pk_mul_f32 v[24:25], v[24:25], s[42:43] op_sel:[0,1] op_sel_hi:[1,1]
 v_pk_mul_f32 v[26:27], v[26:27], s[42:43] op_sel:[0,1] op_sel_hi:[1,1]
 v_min_f32 v20, s47, v20
 v_min_f32 v21, s47, v21
 v_min_f32 v22, s47, v22
 v_min_f32 v23, s47, v23
 v_exp_f32 v24, v24
 v_exp_f32 v25, v25
 v_exp_f32 v26, v26
 v_exp_f32 v27, v27
 v_exp_f32 v20, v20
 v_exp_f32 v21, v21
 v_exp_f32 v22, v22
 v_exp_f32 v23, v23
 v_pk_add_f32 v[28:29], v[20:21], 1.0 op_sel_hi:[1,0]
 v_pk_add_f32 v[30:31], v[22:23], 1.0 op_sel_hi:[1,0]
 v_pk_fma_f32 v[28:29], v[28:29], v[24:25], v[28:29]
 v_pk_fma_f32 v[30:31], v[30:31], v[26:27], v[30:31]
 v_rcp_f32 v28, v28
 v_rcp_f32 v29, v29
 v_rcp_f32 v30, v30
 v_rcp_f32 v31, v31
 v_pk_fma_f32 v[20:21], v[20:21], v[28:29], v[28:29] neg_lo:[0,0,1] neg_hi:[0,0,1]
 v_pk_fma_f32 v[22:23], v[22:23], v[30:31], v[30:31] neg_lo:[0,0,1] neg_hi:[0,0,1]
 v_cvt_pk_bf16_f32 v16, v20, v21
 v_cvt_pk_bf16_f32 v17, v22, v23
 v_accvgpr_read_b32 v20, a228
 v_accvgpr_read_b32 v21, a229
 v_accvgpr_read_b32 v22, a230
 v_accvgpr_read_b32 v23, a231
 v_accvgpr_read_b32 v24, a236
 v_accvgpr_read_b32 v25, a237
 v_accvgpr_read_b32 v26, a238
 v_accvgpr_read_b32 v27, a239
 v_pk_mul_f32 v[20:21], v[20:21], s[42:43] op_sel_hi:[1,0]
 v_pk_mul_f32 v[22:23], v[22:23], s[42:43] op_sel_hi:[1,0]
 v_pk_mul_f32 v[24:25], v[24:25], s[42:43] op_sel:[0,1] op_sel_hi:[1,1]
 v_pk_mul_f32 v[26:27], v[26:27], s[42:43] op_sel:[0,1] op_sel_hi:[1,1]
 v_min_f32 v20, s47, v20
 v_min_f32 v21, s47, v21
 v_min_f32 v22, s47, v22
 v_min_f32 v23, s47, v23
 v_exp_f32 v24, v24
 v_exp_f32 v25, v25
 v_exp_f32 v26, v26
 v_exp_f32 v27, v27
 v_exp_f32 v20, v20
 v_exp_f32 v21, v21
 v_exp_f32 v22, v22
 v_exp_f32 v23, v23
 v_pk_add_f32 v[28:29], v[20:21], 1.0 op_sel_hi:[1,0]
 v_pk_add_f32 v[30:31], v[22:23], 1.0 op_sel_hi:[1,0]
 v_pk_fma_f32 v[28:29], v[28:29], v[24:25], v[28:29]
 v_pk_fma_f32 v[30:31], v[30:31], v[26:27], v[30:31]
 v_rcp_f32 v28, v28
 v_rcp_f32 v29, v29
 v_rcp_f32 v30, v30
 v_rcp_f32 v31, v31
 v_pk_fma_f32 v[20:21], v[20:21], v[28:29], v[28:29] neg_lo:[0,0,1] neg_hi:[0,0,1]
 v_pk_fma_f32 v[22:23], v[22:23], v[30:31], v[30:31] neg_lo:[0,0,1] neg_hi:[0,0,1]
 v_cvt_pk_bf16_f32 v18, v20, v21
 v_cvt_pk_bf16_f32 v19, v22, v23
 s_add_u32 s46, s40, 13312
 buffer_store_dwordx4 v[16:19], v6, s[12:15], s46 offen
 s_nop 1
 s_waitcnt vmcnt(0) lgkmcnt(0)
 s_endpgm
L_e15:
L_p14:
 s_waitcnt lgkmcnt(5)
 ds_read_b128 a[184:187], v1 offset:26112
 v_mul_f32 v20, s42, v192
 v_mfma_f32_16x16x32_bf16 v[48:51], a[0:3], a[160:163], 0
 s_waitcnt lgkmcnt(5)
 v_mul_f32 v21, s42, v193
 v_mul_f32 v22, s42, v194
 v_mfma_f32_16x16x32_bf16 v[48:51], a[16:19], a[164:167], v[48:51]
 s_waitcnt lgkmcnt(4)
 v_mul_f32 v23, s42, v195
 v_min_f32 v20, s47, v20
 v_mfma_f32_16x16x32_bf16 v[48:51], a[32:35], a[168:171], v[48:51]
 s_waitcnt lgkmcnt(3)
 v_min_f32 v21, s47, v21
 v_min_f32 v22, s47, v22
 v_mfma_f32_16x16x32_bf16 v[48:51], a[48:51], a[172:175], v[48:51]
 s_waitcnt lgkmcnt(2)
 ds_read_b128 a[188:191], v3 offset:0
 v_min_f32 v23, s47, v23
 v_mfma_f32_16x16x32_bf16 v[48:51], a[64:67], a[176:179], v[48:51]
 v_exp_f32 v20, v20
 v_mfma_f32_16x16x32_bf16 v[52:55], a[68:71], a[176:179], 0
 v_mul_f32 v24, s43, v200
 v_mul_f32 v25, s43, v201
 v_mfma_f32_16x16x32_bf16 v[52:55], a[52:55], a[172:175], v[52:55]
 s_add_u32 m0, s26, 0
 v_exp_f32 v21, v21
 v_mfma_f32_16x16x32_bf16 v[52:55], a[36:39], a[168:171], v[52:55]
 buffer_load_dwordx4 v7, s[4:7], 0 offen nt lds
 v_mul_f32 v26, s43, v202
 v_mfma_f32_16x16x32_bf16 v[52:55], a[20:23], a[164:167], v[52:55]
 v_mul_f32 v27, s43, v203
 v_add_f32 v28, 1.0, v20
 v_mfma_f32_16x16x32_bf16 v[52:55], a[4:7], a[160:163], v[52:55]
 v_exp_f32 v22, v22
 v_mfma_f32_16x16x32_bf16 v[56:59], a[8:11], a[160:163], 0
 v_exp_f32 v23, v23
 v_mfma_f32_16x16x32_bf16 v[56:59], a[24:27], a[164:167], v[56:59]
 v_exp_f32 v24, v24
 v_mfma_f32_16x16x32_bf16 v[56:59], a[40:43], a[168:171], v[56:59]
 v_add_f32 v29, 1.0, v21
 v_add_f32 v30, 1.0, v22
 v_mfma_f32_16x16x32_bf16 v[56:59], a[56:59], a[172:175], v[56:59]
 v_exp_f32 v25, v25
 v_mfma_f32_16x16x32_bf16 v[56:59], a[72:75], a[176:179], v[56:59]
 v_add_f32 v31, 1.0, v23
 v_fmac_f32 v28, v28, v24
 v_mfma_f32_16x16x32_bf16 v[60:63], a[76:79], a[176:179], 0
 v_exp_f32 v26, v26
 v_mfma_f32_16x16x32_bf16 v[60:63], a[60:63], a[172:175], v[60:63]
 v_exp_f32 v27, v27
 v_mfma_f32_16x16x32_bf16 v[60:63], a[44:47], a[168:171], v[60:63]
 v_fmac_f32 v29, v29, v25
 v_fmac_f32 v30, v30, v26
 v_mfma_f32_16x16x32_bf16 v[60:63], a[28:31], a[164:167], v[60:63]
 v_fmac_f32 v31, v31, v27
 v_mul_f32 v32, s42, v196
 v_mfma_f32_16x16x32_bf16 v[60:63], a[12:15], a[160:163], v[60:63]
 v_rcp_f32 v28, v28
 v_mfma_f32_16x16x32_bf16 v[76:79], a[12:15], a[164:167], 0
 v_rcp_f32 v29, v29
 v_mfma_f32_16x16x32_bf16 v[76:79], a[28:31], a[168:171], v[76:79]
 v_rcp_f32 v30, v30
 v_mfma_f32_16x16x32_bf16 v[76:79], a[44:47], a[172:175], v[76:79]
 v_rcp_f32 v31, v31
 v_mfma_f32_16x16x32_bf16 v[76:79], a[60:63], a[176:179], v[76:79]
 s_waitcnt lgkmcnt(0)
 ds_read_b128 a[192:195], v3 offset:4352
 v_fma_f32 v20, v20, v28, -v28
 v_mfma_f32_16x16x32_bf16 v[76:79], a[76:79], a[180:183], v[76:79]
 v_fma_f32 v21, v21, v29, -v29
 v_fma_f32 v22, v22, v30, -v30
 v_mfma_f32_16x16x32_bf16 v[72:75], a[72:75], a[180:183], 0
 v_fma_f32 v23, v23, v31, -v31
 v_cvt_pk_bf16_f32 v16, v20, v21
 v_mfma_f32_16x16x32_bf16 v[72:75], a[56:59], a[176:179], v[72:75]
 v_cvt_pk_bf16_f32 v17, v22, v23
 v_mul_f32 v33, s42, v197
 v_mfma_f32_16x16x32_bf16 v[72:75], a[40:43], a[172:175], v[72:75]
 v_mul_f32 v34, s42, v198
 v_mul_f32 v35, s42, v199
 v_mfma_f32_16x16x32_bf16 v[72:75], a[24:27], a[168:171], v[72:75]
 v_min_f32 v32, s47, v32
 v_min_f32 v33, s47, v33
 v_mfma_f32_16x16x32_bf16 v[72:75], a[8:11], a[164:167], v[72:75]
 v_min_f32 v34, s47, v34
 v_min_f32 v35, s47, v35
 v_mfma_f32_16x16x32_bf16 v[68:71], a[4:7], a[164:167], 0
 v_exp_f32 v32, v32
 v_mfma_f32_16x16x32_bf16 v[68:71], a[20:23], a[168:171], v[68:71]
 v_mul_f32 v40, s43, v204
 v_mul_f32 v41, s43, v205
 v_mfma_f32_16x16x32_bf16 v[68:71], a[36:39], a[172:175], v[68:71]
 v_exp_f32 v33, v33
 v_mfma_f32_16x16x32_bf16 v[68:71], a[52:55], a[176:179], v[68:71]
 v_mul_f32 v42, s43, v206
 v_mul_f32 v43, s43, v207
 v_mfma_f32_16x16x32_bf16 v[68:71], a[68:71], a[180:183], v[68:71]
 v_exp_f32 v34, v34
 v_mfma_f32_16x16x32_bf16 v[64:67], a[64:67], a[180:183], 0
 v_exp_f32 v35, v35
 v_mfma_f32_16x16x32_bf16 v[64:67], a[48:51], a[176:179], v[64:67]
 v_exp_f32 v40, v40
 v_mfma_f32_16x16x32_bf16 v[64:67], a[32:35], a[172:175], v[64:67]
 v_add_f32 v28, 1.0, v32
 v_add_f32 v29, 1.0, v33
 v_mfma_f32_16x16x32_bf16 v[64:67], a[16:19], a[168:171], v[64:67]
 v_exp_f32 v41, v41
 v_mfma_f32_16x16x32_bf16 v[64:67], a[0:3], a[164:167], v[64:67]
 ds_read_b64_tr_b16 a[80:81], v46 offset:0
 v_add_f32 v30, 1.0, v34
 v_mfma_f32_16x16x32_bf16 v[80:83], a[0:3], a[168:171], 0
 v_add_f32 v31, 1.0, v35
 v_fmac_f32 v28, v28, v40
 v_mfma_f32_16x16x32_bf16 v[80:83], a[16:19], a[172:175], v[80:83]
 ds_read_b64_tr_b16 a[82:83], v46 offset:256
 v_fmac_f32 v29, v29, v41
 v_mfma_f32_16x16x32_bf16 v[80:83], a[32:35], a[176:179], v[80:83]
 v_exp_f32 v42, v42
 v_mfma_f32_16x16x32_bf16 v[80:83], a[48:51], a[180:183], v[80:83]
 s_add_u32 m0, s26, 1024
 ds_read_b128 a[196:199], v3 offset:8704
 ds_read_b64_tr_b16 a[84:85], v46 offset:8
 v_mfma_f32_16x16x32_bf16 v[80:83], a[64:67], a[184:187], v[80:83]
 buffer_load_dwordx4 v8, s[4:7], 0 offen nt lds
 v_fmac_f32 v30, v30, v42
 v_mfma_f32_16x16x32_bf16 v[84:87], a[68:71], a[184:187], 0
 ds_read_b64_tr_b16 a[86:87], v46 offset:264
 v_mul_f32 v20, s42, v208
 v_mfma_f32_16x16x32_bf16 v[84:87], a[52:55], a[180:183], v[84:87]
 v_exp_f32 v43, v43
 v_mfma_f32_16x16x32_bf16 v[84:87], a[36:39], a[176:179], v[84:87]
 s_waitcnt vmcnt(20)
 ds_read_b64_tr_b16 a[96:97], v46 offset:4096
 v_fmac_f32 v31, v31, v43
 v_mfma_f32_16x16x32_bf16 v[84:87], a[20:23], a[172:175], v[84:87]
 v_rcp_f32 v28, v28
 v_mfma_f32_16x16x32_bf16 v[84:87], a[4:7], a[168:171], v[84:87]
 ds_read_b64_tr_b16 a[98:99], v46 offset:4352
 v_fma_f32 v32, v32, v28, -v28
 v_mfma_f32_16x16x32_bf16 v[88:91], a[8:11], a[168:171], 0
 v_rcp_f32 v29, v29
 v_mfma_f32_16x16x32_bf16 v[88:91], a[24:27], a[172:175], v[88:91]
 s_add_u32 m0, s29, 0
 ds_read_b64_tr_b16 a[100:101], v46 offset:4104
 v_fma_f32 v33, v33, v29, -v29
 v_mfma_f32_16x16x32_bf16 v[88:91], a[40:43], a[176:179], v[88:91]
 s_waitcnt lgkmcnt(3)
 buffer_load_dwordx4 v5, s[8:11], s76 offen offset:0 lds
 v_cvt_pk_bf16_f32 v18, v32, v33
 v_mfma_f32_16x16x32_bf16 v[88:91], a[56:59], a[180:183], v[88:91]
 ds_read_b64_tr_b16 a[102:103], v46 offset:4360
 v_mul_f32 v21, s42, v209
 v_mfma_f32_16x16x32_bf16 v[88:91], a[72:75], a[184:187], v[88:91]
 v_rcp_f32 v30, v30
 v_mfma_f32_16x16x32_bf16 v[92:95], a[76:79], a[184:187], 0
 s_waitcnt vmcnt(19)
 ds_read_b64_tr_b16 a[112:113], v46 offset:8192
 v_fma_f32 v34, v34, v30, -v30
 v_mfma_f32_16x16x32_bf16 v[92:95], a[60:63], a[180:183], v[92:95]
 v_rcp_f32 v31, v31
 v_mfma_f32_16x16x32_bf16 v[92:95], a[44:47], a[176:179], v[92:95]
 ds_read_b64_tr_b16 a[114:115], v46 offset:8448
 v_fma_f32 v35, v35, v31, -v31
 v_mfma_f32_16x16x32_bf16 v[92:95], a[28:31], a[172:175], v[92:95]
 s_add_u32 s46, s40, 3072
 v_cvt_pk_bf16_f32 v19, v34, v35
 buffer_store_dwordx4 v[16:19], v6, s[12:15], s46 offen
 v_mfma_f32_16x16x32_bf16 v[92:95], a[12:15], a[168:171], v[92:95]
 ds_read_b64_tr_b16 a[116:117], v46 offset:8200
 v_mul_f32 v22, s42, v210
 v_mfma_f32_16x16x32_bf16 v[108:111], a[12:15], a[172:175], 0
 v_mul_f32 v23, s42, v211
 v_min_f32 v20, s47, v20
 v_mfma_f32_16x16x32_bf16 v[108:111], a[28:31], a[176:179], v[108:111]
 ds_read_b64_tr_b16 a[118:119], v46 offset:8456
 v_min_f32 v21, s47, v21
 v_mfma_f32_16x16x32_bf16 v[108:111], a[44:47], a[180:183], v[108:111]
 v_min_f32 v22, s47, v22
 v_min_f32 v23, s47, v23
 v_mfma_f32_16x16x32_bf16 v[108:111], a[60:63], a[184:187], v[108:111]
 s_waitcnt vmcnt(18)
 ds_read_b128 a[200:203], v3 offset:13056
 ds_read_b64_tr_b16 a[128:129], v46 offset:12288
 v_mfma_f32_16x16x32_bf16 v[108:111], a[76:79], a[188:191], v[108:111]
 s_add_u32 m0, s29, 2048
 v_exp_f32 v20, v20
 v_mfma_f32_16x16x32_bf16 v[104:107], a[72:75], a[188:191], 0
 ds_read_b64_tr_b16 a[130:131], v46 offset:12544
 buffer_load_dwordx4 v5, s[8:11], s77 offen offset:0 lds
 v_mfma_f32_16x16x32_bf16 v[104:107], a[56:59], a[184:187], v[104:107]
 v_mul_f32 v24, s43, v216
 v_mul_f32 v25, s43, v217
 v_mfma_f32_16x16x32_bf16 v[104:107], a[40:43], a[180:183], v[104:107]
 ds_read_b64_tr_b16 a[132:133], v46 offset:12296
 v_mul_f32 v26, s43, v218
 v_mfma_f32_16x16x32_bf16 v[104:107], a[24:27], a[176:179], v[104:107]
 v_exp_f32 v21, v21
 v_mfma_f32_16x16x32_bf16 v[104:107], a[8:11], a[172:175], v[104:107]
 ds_read_b64_tr_b16 a[134:135], v46 offset:12552
 v_mul_f32 v27, s43, v219
 v_mfma_f32_16x16x32_bf16 v[100:103], a[4:7], a[172:175], 0
 v_exp_f32 v22, v22
 v_mfma_f32_16x16x32_bf16 v[100:103], a[20:23], a[176:179], v[100:103]
 s_waitcnt vmcnt(17)
 ds_read_b64_tr_b16 a[144:145], v46 offset:16384
 v_add_f32 v28, 1.0, v20
 v_mfma_f32_16x16x32_bf16 v[100:103], a[36:39], a[180:183], v[100:103]
 v_exp_f32 v23, v23
 v_mfma_f32_16x16x32_bf16 v[100:103], a[52:55], a[184:187], v[100:103]
 s_add_u32 m0, s29, 4096
 ds_read_b64_tr_b16 a[146:147], v46 offset:16640
 v_add_f32 v29, 1.0, v21
 v_mfma_f32_16x16x32_bf16 v[100:103], a[68:71], a[188:191], v[100:103]
 s_waitcnt lgkmcnt(7)
 buffer_load_dwordx4 v5, s[8:11], s78 offen offset:0 lds
 v_add_f32 v30, 1.0, v22
 v_mfma_f32_16x16x32_bf16 v[96:99], a[64:67], a[188:191], 0
 ds_read_b64_tr_b16 a[148:149], v46 offset:16392
 v_add_f32 v31, 1.0, v23
 v_mfma_f32_16x16x32_bf16 v[96:99], a[48:51], a[184:187], v[96:99]
 v_exp_f32 v24, v24
 v_mfma_f32_16x16x32_bf16 v[96:99], a[32:35], a[180:183], v[96:99]
 ds_read_b64_tr_b16 a[150:151], v46 offset:16648
 v_fmac_f32 v28, v28, v24
 v_mfma_f32_16x16x32_bf16 v[96:99], a[16:19], a[176:179], v[96:99]
 v_exp_f32 v25, v25
 v_mfma_f32_16x16x32_bf16 v[96:99], a[0:3], a[172:175], v[96:99]
 s_waitcnt vmcnt(16)
 ds_read_b128 a[204:207], v2 offset:0
 ds_read_b64_tr_b16 a[88:89], v46 offset:1024
 v_mfma_f32_16x16x32_bf16 v[112:115], a[0:3], a[176:179], 0
 ds_read_b128 a[160:163], v2 offset:4352
 v_fmac_f32 v29, v29, v25
 v_mfma_f32_16x16x32_bf16 v[112:115], a[16:19], a[180:183], v[112:115]
 s_add_u32 m0, s26, 2048
 ds_read_b128 a[164:167], v2 offset:8704
 ds_read_b64_tr_b16 a[90:91], v46 offset:1280
 v_mfma_f32_16x16x32_bf16 v[112:115], a[32:35], a[184:187], v[112:115]
 ds_read_b128 a[168:171], v2 offset:13056
 buffer_load_dwordx4 v9, s[4:7], 0 offen nt lds
 v_mfma_f32_16x16x32_bf16 v[112:115], a[48:51], a[188:191], v[112:115]
 ds_read_b128 a[172:175], v2 offset:17408
 ds_read_b64_tr_b16 a[92:93], v46 offset:1032
 v_mfma_f32_16x16x32_bf16 v[112:115], a[64:67], a[192:195], v[112:115]
 v_exp_f32 v26, v26
 v_mfma_f32_16x16x32_bf16 v[116:119], a[68:71], a[192:195], 0
 s_add_u32 m0, s29, 6144
 ds_read_b64_tr_b16 a[94:95], v46 offset:1288
 v_fmac_f32 v30, v30, v26
 v_mfma_f32_16x16x32_bf16 v[116:119], a[52:55], a[188:191], v[116:119]
 buffer_load_dwordx4 v5, s[8:11], s79 offen offset:0 lds
 v_mul_f32 v32, s42, v212
 v_mfma_f32_16x16x32_bf16 v[116:119], a[36:39], a[184:187], v[116:119]
 s_waitcnt vmcnt(15)
 ds_read_b64_tr_b16 a[104:105], v46 offset:5120
 v_mul_f32 v33, s42, v213
 v_mfma_f32_16x16x32_bf16 v[116:119], a[20:23], a[180:183], v[116:119]
 v_exp_f32 v27, v27
 v_mfma_f32_16x16x32_bf16 v[116:119], a[4:7], a[176:179], v[116:119]
 ds_read_b64_tr_b16 a[106:107], v46 offset:5376
 v_fmac_f32 v31, v31, v27
 v_mfma_f32_16x16x32_bf16 v[120:123], a[8:11], a[176:179], 0
 v_rcp_f32 v28, v28
 v_mfma_f32_16x16x32_bf16 v[120:123], a[24:27], a[180:183], v[120:123]
 ds_read_b64_tr_b16 a[108:109], v46 offset:5128
 v_fma_f32 v20, v20, v28, -v28
 v_mfma_f32_16x16x32_bf16 v[120:123], a[40:43], a[184:187], v[120:123]
 v_rcp_f32 v29, v29
 v_mfma_f32_16x16x32_bf16 v[120:123], a[56:59], a[188:191], v[120:123]
 ds_read_b64_tr_b16 a[110:111], v46 offset:5384
 v_fma_f32 v21, v21, v29, -v29
 v_mfma_f32_16x16x32_bf16 v[120:123], a[72:75], a[192:195], v[120:123]
 v_rcp_f32 v30, v30
 v_mfma_f32_16x16x32_bf16 v[124:127], a[76:79], a[192:195], 0
 s_waitcnt vmcnt(13)
 ds_read_b64_tr_b16 a[120:121], v46 offset:9216
 v_fma_f32 v22, v22, v30, -v30
 v_mfma_f32_16x16x32_bf16 v[124:127], a[60:63], a[188:191], v[124:127]
 s_add_u32 m0, s29, 8192
 v_rcp_f32 v31, v31
 v_mfma_f32_16x16x32_bf16 v[124:127], a[44:47], a[184:187], v[124:127]
 ds_read_b64_tr_b16 a[122:123], v46 offset:9472
 buffer_load_dwordx4 v5, s[8:11], s80 offen offset:0 lds
 v_mfma_f32_16x16x32_bf16 v[124:127], a[28:31], a[180:183], v[124:127]
 v_fma_f32 v23, v23, v31, -v31
 v_cvt_pk_bf16_f32 v16, v20, v21
 v_mfma_f32_16x16x32_bf16 v[124:127], a[12:15], a[176:179], v[124:127]
 ds_read_b64_tr_b16 a[124:125], v46 offset:9224
 v_cvt_pk_bf16_f32 v17, v22, v23
 v_mfma_f32_16x16x32_bf16 v[140:143], a[12:15], a[180:183], 0
 v_mul_f32 v34, s42, v214
 v_mul_f32 v35, s42, v215
 v_mfma_f32_16x16x32_bf16 v[140:143], a[28:31], a[184:187], v[140:143]
 ds_read_b64_tr_b16 a[126:127], v46 offset:9480
 v_min_f32 v32, s47, v32
 v_mfma_f32_16x16x32_bf16 v[140:143], a[44:47], a[188:191], v[140:143]
 v_min_f32 v33, s47, v33
 v_min_f32 v34, s47, v34
 v_mfma_f32_16x16x32_bf16 v[140:143], a[60:63], a[192:195], v[140:143]
 s_waitcnt vmcnt(12)
 ds_read_b128 a[176:179], v2 offset:21760
 ds_read_b64_tr_b16 a[136:137], v46 offset:13312
 v_mfma_f32_16x16x32_bf16 v[140:143], a[76:79], a[196:199], v[140:143]
 v_min_f32 v35, s47, v35
 v_mul_f32 v40, s43, v220
 v_mfma_f32_16x16x32_bf16 v[136:139], a[72:75], a[196:199], 0
 ds_read_b64_tr_b16 a[138:139], v46 offset:13568
 v_mul_f32 v41, s43, v221
 v_mfma_f32_16x16x32_bf16 v[136:139], a[56:59], a[192:195], v[136:139]
 v_exp_f32 v32, v32
 v_mfma_f32_16x16x32_bf16 v[136:139], a[40:43], a[188:191], v[136:139]
 ds_read_b64_tr_b16 a[140:141], v46 offset:13320
 v_mul_f32 v42, s43, v222
 v_mfma_f32_16x16x32_bf16 v[136:139], a[24:27], a[184:187], v[136:139]
 s_add_u32 m0, s29, 10240
 v_exp_f32 v33, v33
 v_mfma_f32_16x16x32_bf16 v[136:139], a[8:11], a[180:183], v[136:139]
 ds_read_b64_tr_b16 a[142:143], v46 offset:13576
 buffer_load_dwordx4 v5, s[8:11], s81 offen offset:0 lds
 v_mfma_f32_16x16x32_bf16 v[132:135], a[4:7], a[180:183], 0
 v_mul_f32 v43, s43, v223
 v_add_f32 v28, 1.0, v32
 v_mfma_f32_16x16x32_bf16 v[132:135], a[20:23], a[184:187], v[132:135]
 s_waitcnt vmcnt(11)
 ds_read_b64_tr_b16 a[152:153], v46 offset:17408
 v_add_f32 v29, 1.0, v33
 v_mfma_f32_16x16x32_bf16 v[132:135], a[36:39], a[188:191], v[132:135]
 v_exp_f32 v34, v34
 v_mfma_f32_16x16x32_bf16 v[132:135], a[52:55], a[192:195], v[132:135]
 ds_read_b64_tr_b16 a[154:155], v46 offset:17664
 v_add_f32 v30, 1.0, v34
 v_mfma_f32_16x16x32_bf16 v[132:135], a[68:71], a[196:199], v[132:135]
 v_exp_f32 v35, v35
 v_mfma_f32_16x16x32_bf16 v[128:131], a[64:67], a[196:199], 0
 ds_read_b64_tr_b16 a[156:157], v46 offset:17416
 v_add_f32 v31, 1.0, v35
 v_mfma_f32_16x16x32_bf16 v[128:131], a[48:51], a[192:195], v[128:131]
 v_exp_f32 v40, v40
 v_mfma_f32_16x16x32_bf16 v[128:131], a[32:35], a[188:191], v[128:131]
 ds_read_b64_tr_b16 a[158:159], v46 offset:17672
 v_fmac_f32 v28, v28, v40
 v_mfma_f32_16x16x32_bf16 v[128:131], a[16:19], a[184:187], v[128:131]
 v_exp_f32 v41, v41
 v_mfma_f32_16x16x32_bf16 v[128:131], a[0:3], a[180:183], v[128:131]
 s_add_u32 m0, s29, 12288
 v_exp_f32 v42, v42
 v_mfma_f32_16x16x32_bf16 v[144:147], a[0:3], a[184:187], 0
 s_waitcnt lgkmcnt(5)
 buffer_load_dwordx4 v5, s[8:11], s82 offen offset:0 lds
 v_fmac_f32 v29, v29, v41
 v_mfma_f32_16x16x32_bf16 v[144:147], a[16:19], a[188:191], v[144:147]
 s_add_u32 m0, s26, 3072
 v_exp_f32 v43, v43
 v_mfma_f32_16x16x32_bf16 v[144:147], a[32:35], a[192:195], v[144:147]
 buffer_load_dwordx4 v10, s[4:7], 0 offen nt lds
 v_fmac_f32 v30, v30, v42
 v_mfma_f32_16x16x32_bf16 v[144:147], a[48:51], a[196:199], v[144:147]
 ds_read_b128 a[180:183], v2 offset:26112
 v_fmac_f32 v31, v31, v43
 v_mfma_f32_16x16x32_bf16 v[144:147], a[64:67], a[200:203], v[144:147]
 v_rcp_f32 v28, v28
 v_mfma_f32_16x16x32_bf16 v[148:151], a[68:71], a[200:203], 0
 v_rcp_f32 v29, v29
 v_mfma_f32_16x16x32_bf16 v[148:151], a[52:55], a[196:199], v[148:151]
 v_rcp_f32 v30, v30
 v_mfma_f32_16x16x32_bf16 v[148:151], a[36:39], a[192:195], v[148:151]
 v_rcp_f32 v31, v31
 v_mfma_f32_16x16x32_bf16 v[148:151], a[20:23], a[188:191], v[148:151]
 v_fma_f32 v32, v32, v28, -v28
 v_fma_f32 v33, v33, v29, -v29
 v_mfma_f32_16x16x32_bf16 v[148:151], a[4:7], a[184:187], v[148:151]
 v_fma_f32 v34, v34, v30, -v30
 v_fma_f32 v35, v35, v31, -v31
 v_mfma_f32_16x16x32_bf16 v[152:155], a[8:11], a[184:187], 0
 s_add_u32 m0, s29, 14336
 v_cvt_pk_bf16_f32 v18, v32, v33
 v_cvt_pk_bf16_f32 v19, v34, v35
 v_mfma_f32_16x16x32_bf16 v[152:155], a[24:27], a[188:191], v[152:155]
 s_add_u32 s46, s40, 5120
 buffer_load_dwordx4 v5, s[8:11], s83 offen offset:0 lds
 buffer_store_dwordx4 v[16:19], v6, s[12:15], s46 offen
 v_mfma_f32_16x16x32_bf16 v[152:155], a[40:43], a[192:195], v[152:155]
 v_mul_f32 v20, s42, v224
 v_mul_f32 v21, s42, v225
 v_mfma_f32_16x16x32_bf16 v[152:155], a[56:59], a[196:199], v[152:155]
 v_mul_f32 v22, s42, v226
 v_mul_f32 v23, s42, v227
 v_mfma_f32_16x16x32_bf16 v[152:155], a[72:75], a[200:203], v[152:155]
 v_min_f32 v20, s47, v20
 v_min_f32 v21, s47, v21
 v_mfma_f32_16x16x32_bf16 v[156:159], a[76:79], a[200:203], 0
 v_min_f32 v22, s47, v22
 v_min_f32 v23, s47, v23
 v_mfma_f32_16x16x32_bf16 v[156:159], a[60:63], a[196:199], v[156:159]
 v_exp_f32 v20, v20
 v_mfma_f32_16x16x32_bf16 v[156:159], a[44:47], a[192:195], v[156:159]
 v_mul_f32 v24, s43, v232
 v_mul_f32 v25, s43, v233
 v_mfma_f32_16x16x32_bf16 v[156:159], a[28:31], a[188:191], v[156:159]
 v_exp_f32 v21, v21
 v_mfma_f32_16x16x32_bf16 v[156:159], a[12:15], a[184:187], v[156:159]
 v_mul_f32 v26, s43, v234
 v_mul_f32 v27, s43, v235
 v_mfma_f32_16x16x32_bf16 v[48:51], a[80:83], a[204:207], v[48:51]
 v_exp_f32 v22, v22
 v_mfma_f32_16x16x32_bf16 v[48:51], a[96:99], a[160:163], v[48:51]
 v_exp_f32 v23, v23
 v_mfma_f32_16x16x32_bf16 v[48:51], a[112:115], a[164:167], v[48:51]
 s_add_u32 m0, s29, 16384
 v_exp_f32 v24, v24
 v_mfma_f32_16x16x32_bf16 v[48:51], a[128:131], a[168:171], v[48:51]
 ds_read_b128 a[200:203], v4 offset:0
 buffer_load_dwordx4 v5, s[8:11], s84 offen offset:0 lds
 v_mfma_f32_16x16x32_bf16 v[48:51], a[144:147], a[172:175], v[48:51]
 v_add_f32 v28, 1.0, v20
 v_add_f32 v29, 1.0, v21
 v_mfma_f32_16x16x32_bf16 v[52:55], a[148:151], a[172:175], v[52:55]
 v_exp_f32 v25, v25
 v_mfma_f32_16x16x32_bf16 v[52:55], a[132:135], a[168:171], v[52:55]
 v_add_f32 v30, 1.0, v22
 v_add_f32 v31, 1.0, v23
 v_mfma_f32_16x16x32_bf16 v[52:55], a[116:119], a[164:167], v[52:55]
 v_exp_f32 v26, v26
 v_mfma_f32_16x16x32_bf16 v[52:55], a[100:103], a[160:163], v[52:55]
 v_exp_f32 v27, v27
 v_mfma_f32_16x16x32_bf16 v[52:55], a[84:87], a[204:207], v[52:55]
 v_fmac_f32 v28, v28, v24
 v_fmac_f32 v29, v29, v25
 v_mfma_f32_16x16x32_bf16 v[56:59], a[88:91], a[204:207], v[56:59]
 v_fmac_f32 v30, v30, v26
 v_fmac_f32 v31, v31, v27
 v_mfma_f32_16x16x32_bf16 v[56:59], a[104:107], a[160:163], v[56:59]
 v_rcp_f32 v28, v28
 v_mfma_f32_16x16x32_bf16 v[56:59], a[120:123], a[164:167], v[56:59]
 v_rcp_f32 v29, v29
 v_mfma_f32_16x16x32_bf16 v[56:59], a[136:139], a[168:171], v[56:59]
 s_waitcnt lgkmcnt(1)
 s_add_u32 m0, s29, 18432
 v_fma_f32 v20, v20, v28, -v28
 v_mfma_f32_16x16x32_bf16 v[56:59], a[152:155], a[172:175], v[56:59]
 buffer_load_dwordx4 v5, s[8:11], s85 offen offset:0 lds
 v_fma_f32 v21, v21, v29, -v29
 v_mfma_f32_16x16x32_bf16 v[60:63], a[156:159], a[172:175], v[60:63]
 v_rcp_f32 v30, v30
 v_mfma_f32_16x16x32_bf16 v[60:63], a[140:143], a[168:171], v[60:63]
 v_rcp_f32 v31, v31
 v_mfma_f32_16x16x32_bf16 v[60:63], a[124:127], a[164:167], v[60:63]
 v_fma_f32 v22, v22, v30, -v30
 v_fma_f32 v23, v23, v31, -v31
 v_mfma_f32_16x16x32_bf16 v[60:63], a[108:111], a[160:163], v[60:63]
 s_add_u32 m0, s26, 4096
 v_cvt_pk_bf16_f32 v16, v20, v21
 v_cvt_pk_bf16_f32 v17, v22, v23
 v_mfma_f32_16x16x32_bf16 v[60:63], a[92:95], a[204:207], v[60:63]
 ds_read_b128 a[196:199], v1 offset:2176
 buffer_load_dwordx4 v11, s[4:7], 0 offen nt lds
 v_mfma_f32_16x16x32_bf16 v[76:79], a[92:95], a[160:163], v[76:79]
 ds_read_b128 a[192:195], v1 offset:6528
 v_mul_f32 v32, s42, v228
 v_mfma_f32_16x16x32_bf16 v[76:79], a[108:111], a[164:167], v[76:79]
 ds_read_b128 a[188:191], v1 offset:10880
 v_mul_f32 v33, s42, v229
 v_mfma_f32_16x16x32_bf16 v[76:79], a[124:127], a[168:171], v[76:79]
 ds_read_b128 a[184:187], v1 offset:15232
 v_mul_f32 v34, s42, v230
 v_mfma_f32_16x16x32_bf16 v[76:79], a[140:143], a[172:175], v[76:79]
 ds_read_b128 a[204:207], v1 offset:19584
 v_mul_f32 v35, s42, v231
 v_mfma_f32_16x16x32_bf16 v[76:79], a[156:159], a[176:179], v[76:79]
 v_min_f32 v32, s47, v32
 v_min_f32 v33, s47, v33
 v_mfma_f32_16x16x32_bf16 v[72:75], a[152:155], a[176:179], v[72:75]
 s_add_u32 m0, s29, 0
 v_min_f32 v34, s47, v34
 v_min_f32 v35, s47, v35
 v_mfma_f32_16x16x32_bf16 v[72:75], a[136:139], a[172:175], v[72:75]
 buffer_load_dwordx4 v5, s[8:11], s76 offen offset:1024 lds
 v_mul_f32 v40, s43, v236
 v_mfma_f32_16x16x32_bf16 v[72:75], a[120:123], a[168:171], v[72:75]
 v_exp_f32 v32, v32
 v_mfma_f32_16x16x32_bf16 v[72:75], a[104:107], a[164:167], v[72:75]
 v_mul_f32 v41, s43, v237
 v_mul_f32 v42, s43, v238
 v_mfma_f32_16x16x32_bf16 v[72:75], a[88:91], a[160:163], v[72:75]
 v_exp_f32 v33, v33
 v_mfma_f32_16x16x32_bf16 v[68:71], a[84:87], a[160:163], v[68:71]
 v_mul_f32 v43, s43, v239
 v_add_f32 v28, 1.0, v32
 v_mfma_f32_16x16x32_bf16 v[68:71], a[100:103], a[164:167], v[68:71]
 v_exp_f32 v34, v34
 v_mfma_f32_16x16x32_bf16 v[68:71], a[116:119], a[168:171], v[68:71]
 v_exp_f32 v35, v35
 v_mfma_f32_16x16x32_bf16 v[68:71], a[132:135], a[172:175], v[68:71]
 v_exp_f32 v40, v40
 v_mfma_f32_16x16x32_bf16 v[68:71], a[148:151], a[176:179], v[68:71]
 v_add_f32 v29, 1.0, v33
 v_add_f32 v30, 1.0, v34
 v_mfma_f32_16x16x32_bf16 v[64:67], a[144:147], a[176:179], v[64:67]
 v_exp_f32 v41, v41
 v_mfma_f32_16x16x32_bf16 v[64:67], a[128:131], a[172:175], v[64:67]
 s_add_u32 m0, s29, 2048
 v_add_f32 v31, 1.0, v35
 v_fmac_f32 v28, v28, v40
 v_mfma_f32_16x16x32_bf16 v[64:67], a[112:115], a[168:171], v[64:67]
 buffer_load_dwordx4 v5, s[8:11], s77 offen offset:1024 lds
 v_fmac_f32 v29, v29, v41
 v_mfma_f32_16x16x32_bf16 v[64:67], a[96:99], a[164:167], v[64:67]
 v_exp_f32 v42, v42
 v_mfma_f32_16x16x32_bf16 v[64:67], a[80:83], a[160:163], v[64:67]
 v_exp_f32 v43, v43
 v_mfma_f32_16x16x32_bf16 v[80:83], a[80:83], a[164:167], v[80:83]
 v_fmac_f32 v30, v30, v42
 v_fmac_f32 v31, v31, v43
 v_mfma_f32_16x16x32_bf16 v[80:83], a[96:99], a[168:171], v[80:83]
 v_rcp_f32 v28, v28
 v_mfma_f32_16x16x32_bf16 v[80:83], a[112:115], a[172:175], v[80:83]
 v_rcp_f32 v29, v29
 v_mfma_f32_16x16x32_bf16 v[80:83], a[128:131], a[176:179], v[80:83]
 ds_read_b128 a[160:163], v1 offset:23936
 v_fma_f32 v32, v32, v28, -v28
 v_mfma_f32_16x16x32_bf16 v[80:83], a[144:147], a[180:183], v[80:83]
 v_rcp_f32 v30, v30
 v_mfma_f32_16x16x32_bf16 v[84:87], a[148:151], a[180:183], v[84:87]
 v_rcp_f32 v31, v31
 v_mfma_f32_16x16x32_bf16 v[84:87], a[132:135], a[176:179], v[84:87]
 v_fma_f32 v33, v33, v29, -v29
 v_fma_f32 v34, v34, v30, -v30
 v_mfma_f32_16x16x32_bf16 v[84:87], a[116:119], a[172:175], v[84:87]
 s_add_u32 m0, s29, 4096
 v_fma_f32 v35, v35, v31, -v31
 v_cvt_pk_bf16_f32 v18, v32, v33
 v_mfma_f32_16x16x32_bf16 v[84:87], a[100:103], a[168:171], v[84:87]
 buffer_load_dwordx4 v5, s[8:11], s78 offen offset:1024 lds
 v_cvt_pk_bf16_f32 v19, v34, v35
 v_mfma_f32_16x16x32_bf16 v[84:87], a[84:87], a[164:167], v[84:87]
 s_add_u32 s46, s40, 7168
 buffer_store_dwordx4 v[16:19], v6, s[12:15], s46 offen
 v_mul_f32 v20, s42, v240
 v_mfma_f32_16x16x32_bf16 v[88:91], a[88:91], a[164:167], v[88:91]
 v_mul_f32 v21, s42, v241
 v_mul_f32 v22, s42, v242
 v_mfma_f32_16x16x32_bf16 v[88:91], a[104:107], a[168:171], v[88:91]
 v_mul_f32 v23, s42, v243
 v_min_f32 v20, s47, v20
 v_mfma_f32_16x16x32_bf16 v[88:91], a[120:123], a[172:175], v[88:91]
 v_min_f32 v21, s47, v21
 v_min_f32 v22, s47, v22
 v_mfma_f32_16x16x32_bf16 v[88:91], a[136:139], a[176:179], v[88:91]
 v_min_f32 v23, s47, v23
 v_mul_f32 v24, s43, v248
 v_mfma_f32_16x16x32_bf16 v[88:91], a[152:155], a[180:183], v[88:91]
 v_exp_f32 v20, v20
 v_mfma_f32_16x16x32_bf16 v[92:95], a[156:159], a[180:183], v[92:95]
 s_add_u32 m0, s26, 5120
 v_mul_f32 v25, s43, v249
 v_mul_f32 v26, s43, v250
 v_mfma_f32_16x16x32_bf16 v[92:95], a[140:143], a[176:179], v[92:95]
 buffer_load_dwordx4 v12, s[4:7], 0 offen nt lds
 v_mul_f32 v27, s43, v251
 v_mfma_f32_16x16x32_bf16 v[92:95], a[124:127], a[172:175], v[92:95]
 v_exp_f32 v21, v21
 v_mfma_f32_16x16x32_bf16 v[92:95], a[108:111], a[168:171], v[92:95]
 v_exp_f32 v22, v22
 v_mfma_f32_16x16x32_bf16 v[92:95], a[92:95], a[164:167], v[92:95]
 s_add_u32 m0, s29, 6144
 v_exp_f32 v23, v23
 v_mfma_f32_16x16x32_bf16 v[108:111], a[92:95], a[168:171], v[108:111]
 buffer_load_dwordx4 v5, s[8:11], s79 offen offset:1024 lds
 v_add_f32 v28, 1.0, v20
 v_mfma_f32_16x16x32_bf16 v[108:111], a[108:111], a[172:175], v[108:111]
 v_exp_f32 v24, v24
 v_mfma_f32_16x16x32_bf16 v[108:111], a[124:127], a[176:179], v[108:111]
 v_add_f32 v29, 1.0, v21
 v_add_f32 v30, 1.0, v22
 v_mfma_f32_16x16x32_bf16 v[108:111], a[140:143], a[180:183], v[108:111]
 s_waitcnt lgkmcnt(0)
 ds_read_b128 a[164:167], v1 offset:28288
 v_add_f32 v31, 1.0, v23
 v_mfma_f32_16x16x32_bf16 v[108:111], a[156:159], a[200:203], v[108:111]
 v_exp_f32 v25, v25
 v_mfma_f32_16x16x32_bf16 v[104:107], a[152:155], a[200:203], v[104:107]
 v_exp_f32 v26, v26
 v_mfma_f32_16x16x32_bf16 v[104:107], a[136:139], a[180:183], v[104:107]
 v_exp_f32 v27, v27
 v_mfma_f32_16x16x32_bf16 v[104:107], a[120:123], a[176:179], v[104:107]
 v_fmac_f32 v28, v28, v24
 v_fmac_f32 v29, v29, v25
 v_mfma_f32_16x16x32_bf16 v[104:107], a[104:107], a[172:175], v[104:107]
 v_fmac_f32 v30, v30, v26
 v_fmac_f32 v31, v31, v27
 v_mfma_f32_16x16x32_bf16 v[104:107], a[88:91], a[168:171], v[104:107]
 v_rcp_f32 v28, v28
 v_mfma_f32_16x16x32_bf16 v[100:103], a[84:87], a[168:171], v[100:103]
 s_add_u32 m0, s29, 8192
 v_rcp_f32 v29, v29
 v_mfma_f32_16x16x32_bf16 v[100:103], a[100:103], a[172:175], v[100:103]
 buffer_load_dwordx4 v5, s[8:11], s80 offen offset:1024 lds
 v_fma_f32 v20, v20, v28, -v28
 v_mfma_f32_16x16x32_bf16 v[100:103], a[116:119], a[176:179], v[100:103]
 v_rcp_f32 v30, v30
 v_mfma_f32_16x16x32_bf16 v[100:103], a[132:135], a[180:183], v[100:103]
 v_rcp_f32 v31, v31
 v_mfma_f32_16x16x32_bf16 v[100:103], a[148:151], a[200:203], v[100:103]
 v_fma_f32 v21, v21, v29, -v29
 v_fma_f32 v22, v22, v30, -v30
 v_mfma_f32_16x16x32_bf16 v[96:99], a[144:147], a[200:203], v[96:99]
 v_fma_f32 v23, v23, v31, -v31
 v_cvt_pk_bf16_f32 v16, v20, v21
 v_mfma_f32_16x16x32_bf16 v[96:99], a[128:131], a[180:183], v[96:99]
 v_cvt_pk_bf16_f32 v17, v22, v23
 v_mul_f32 v32, s42, v244
 v_mfma_f32_16x16x32_bf16 v[96:99], a[112:115], a[176:179], v[96:99]
 v_mul_f32 v33, s42, v245
 v_mul_f32 v34, s42, v246
 v_mfma_f32_16x16x32_bf16 v[96:99], a[96:99], a[172:175], v[96:99]
 v_mul_f32 v35, s42, v247
 v_min_f32 v32, s47, v32
 v_mfma_f32_16x16x32_bf16 v[96:99], a[80:83], a[168:171], v[96:99]
 v_min_f32 v33, s47, v33
 v_min_f32 v34, s47, v34
 v_mfma_f32_16x16x32_bf16 v[176:179], a[0:3], a[196:199], 0
 v_min_f32 v35, s47, v35
 v_mul_f32 v40, s43, v252
 v_mfma_f32_16x16x32_bf16 v[176:179], a[16:19], a[192:195], v[176:179]
 v_exp_f32 v32, v32
 v_mfma_f32_16x16x32_bf16 v[176:179], a[32:35], a[188:191], v[176:179]
 s_add_u32 m0, s29, 10240
 v_mul_f32 v41, s43, v253
 v_mul_f32 v42, s43, v254
 v_mfma_f32_16x16x32_bf16 v[176:179], a[48:51], a[184:187], v[176:179]
 ds_read_b128 a[200:203], v3 offset:2176
 buffer_load_dwordx4 v5, s[8:11], s81 offen offset:1024 lds
 v_mfma_f32_16x16x32_bf16 v[176:179], a[64:67], a[204:207], v[176:179]
 v_exp_f32 v33, v33
 v_mfma_f32_16x16x32_bf16 v[180:183], a[68:71], a[204:207], 0
 v_mul_f32 v43, s43, v255
 v_add_f32 v28, 1.0, v32
 v_mfma_f32_16x16x32_bf16 v[180:183], a[52:55], a[184:187], v[180:183]
 v_exp_f32 v34, v34
 v_mfma_f32_16x16x32_bf16 v[180:183], a[36:39], a[188:191], v[180:183]
 v_exp_f32 v35, v35
 v_mfma_f32_16x16x32_bf16 v[180:183], a[20:23], a[192:195], v[180:183]
 v_exp_f32 v40, v40
 v_mfma_f32_16x16x32_bf16 v[180:183], a[4:7], a[196:199], v[180:183]
 v_add_f32 v29, 1.0, v33
 v_add_f32 v30, 1.0, v34
 v_mfma_f32_16x16x32_bf16 v[184:187], a[8:11], a[196:199], 0
 v_exp_f32 v41, v41
 v_mfma_f32_16x16x32_bf16 v[184:187], a[24:27], a[192:195], v[184:187]
 v_add_f32 v31, 1.0, v35
 v_fmac_f32 v28, v28, v40
 v_mfma_f32_16x16x32_bf16 v[184:187], a[40:43], a[188:191], v[184:187]
 v_exp_f32 v42, v42
 v_mfma_f32_16x16x32_bf16 v[184:187], a[56:59], a[184:187], v[184:187]
 s_add_u32 m0, s29, 12288
 v_exp_f32 v43, v43
 v_mfma_f32_16x16x32_bf16 v[184:187], a[72:75], a[204:207], v[184:187]
 buffer_load_dwordx4 v5, s[8:11], s82 offen offset:1024 lds
 v_fmac_f32 v29, v29, v41
 v_mfma_f32_16x16x32_bf16 v[188:191], a[76:79], a[204:207], 0
 s_add_u32 m0, s26, 6144
 v_fmac_f32 v30, v30, v42
 v_fmac_f32 v31, v31, v43
 v_mfma_f32_16x16x32_bf16 v[188:191], a[60:63], a[184:187], v[188:191]
 buffer_load_dwordx4 v13, s[4:7], 0 offen nt lds
 v_accvgpr_read_b32 v20, a208
 v_mfma_f32_16x16x32_bf16 v[188:191], a[44:47], a[188:191], v[188:191]
 v_rcp_f32 v28, v28
 v_mfma_f32_16x16x32_bf16 v[188:191], a[28:31], a[192:195], v[188:191]
 v_rcp_f32 v29, v29
 v_mfma_f32_16x16x32_bf16 v[188:191], a[12:15], a[196:199], v[188:191]
 v_rcp_f32 v30, v30
 v_mfma_f32_16x16x32_bf16 v[204:207], a[12:15], a[192:195], 0
 v_rcp_f32 v31, v31
 v_mfma_f32_16x16x32_bf16 v[204:207], a[28:31], a[188:191], v[204:207]
 v_fma_f32 v32, v32, v28, -v28
 v_fma_f32 v33, v33, v29, -v29
 v_mfma_f32_16x16x32_bf16 v[204:207], a[44:47], a[184:187], v[204:207]
 v_fma_f32 v34, v34, v30, -v30
 v_fma_f32 v35, v35, v31, -v31
 v_mfma_f32_16x16x32_bf16 v[204:207], a[60:63], a[204:207], v[204:207]
 ds_read_b128 a[180:183], v3 offset:6528
 v_cvt_pk_bf16_f32 v18, v32, v33
 v_mfma_f32_16x16x32_bf16 v[204:207], a[76:79], a[160:163], v[204:207]
 s_add_u32 m0, s29, 14336
 v_cvt_pk_bf16_f32 v19, v34, v35
 v_accvgpr_read_b32 v24, a216
 v_mfma_f32_16x16x32_bf16 v[200:203], a[72:75], a[160:163], 0
 s_add_u32 s46, s40, 9216
 buffer_load_dwordx4 v5, s[8:11], s83 offen offset:1024 lds
 buffer_store_dwordx4 v[16:19], v6, s[12:15], s46 offen
 v_mfma_f32_16x16x32_bf16 v[200:203], a[56:59], a[204:207], v[200:203]
 v_accvgpr_read_b32 v21, a209
 v_accvgpr_read_b32 v25, a217
 v_mfma_f32_16x16x32_bf16 v[200:203], a[40:43], a[184:187], v[200:203]
 v_accvgpr_read_b32 v22, a210
 v_accvgpr_read_b32 v26, a218
 v_mfma_f32_16x16x32_bf16 v[200:203], a[24:27], a[188:191], v[200:203]
 v_accvgpr_read_b32 v23, a211
 v_accvgpr_read_b32 v27, a219
 v_mfma_f32_16x16x32_bf16 v[200:203], a[8:11], a[192:195], v[200:203]
 v_mul_f32 v20, s42, v20
 v_mul_f32 v21, s42, v21
 v_mfma_f32_16x16x32_bf16 v[196:199], a[4:7], a[192:195], 0
 v_mul_f32 v22, s42, v22
 v_mul_f32 v23, s42, v23
 v_mfma_f32_16x16x32_bf16 v[196:199], a[20:23], a[188:191], v[196:199]
 v_min_f32 v20, s47, v20
 v_min_f32 v21, s47, v21
 v_mfma_f32_16x16x32_bf16 v[196:199], a[36:39], a[184:187], v[196:199]
 v_min_f32 v22, s47, v22
 v_min_f32 v23, s47, v23
 v_mfma_f32_16x16x32_bf16 v[196:199], a[52:55], a[204:207], v[196:199]
 v_exp_f32 v20, v20
 v_mfma_f32_16x16x32_bf16 v[196:199], a[68:71], a[160:163], v[196:199]
 v_mul_f32 v24, s43, v24
 v_mul_f32 v25, s43, v25
 v_mfma_f32_16x16x32_bf16 v[192:195], a[64:67], a[160:163], 0
 v_exp_f32 v21, v21
 v_mfma_f32_16x16x32_bf16 v[192:195], a[48:51], a[204:207], v[192:195]
 s_add_u32 m0, s29, 16384
 v_mul_f32 v26, s43, v26
 v_mul_f32 v27, s43, v27
 v_mfma_f32_16x16x32_bf16 v[192:195], a[32:35], a[184:187], v[192:195]
 buffer_load_dwordx4 v5, s[8:11], s84 offen offset:1024 lds
 v_add_f32 v28, 1.0, v20
 v_mfma_f32_16x16x32_bf16 v[192:195], a[16:19], a[188:191], v[192:195]
 v_exp_f32 v22, v22
 v_mfma_f32_16x16x32_bf16 v[192:195], a[0:3], a[192:195], v[192:195]
 v_exp_f32 v23, v23
 v_mfma_f32_16x16x32_bf16 v[208:211], a[0:3], a[188:191], 0
 v_exp_f32 v24, v24
 v_mfma_f32_16x16x32_bf16 v[208:211], a[16:19], a[184:187], v[208:211]
 v_add_f32 v29, 1.0, v21
 v_add_f32 v30, 1.0, v22
 v_mfma_f32_16x16x32_bf16 v[208:211], a[32:35], a[204:207], v[208:211]
 v_exp_f32 v25, v25
 v_mfma_f32_16x16x32_bf16 v[208:211], a[48:51], a[160:163], v[208:211]
 s_waitcnt lgkmcnt(0)
 ds_read_b128 a[176:179], v3 offset:10880
 v_add_f32 v31, 1.0, v23
 v_mfma_f32_16x16x32_bf16 v[208:211], a[64:67], a[164:167], v[208:211]
 v_exp_f32 v26, v26
 v_mfma_f32_16x16x32_bf16 v[212:215], a[68:71], a[164:167], 0
 v_exp_f32 v27, v27
 v_mfma_f32_16x16x32_bf16 v[212:215], a[52:55], a[160:163], v[212:215]
 v_fmac_f32 v28, v28, v24
 v_fmac_f32 v29, v29, v25
 v_mfma_f32_16x16x32_bf16 v[212:215], a[36:39], a[204:207], v[212:215]
 s_add_u32 m0, s29, 18432
 v_fmac_f32 v30, v30, v26
 v_fmac_f32 v31, v31, v27
 v_mfma_f32_16x16x32_bf16 v[212:215], a[20:23], a[184:187], v[212:215]
 buffer_load_dwordx4 v5, s[8:11], s85 offen offset:1024 lds
 v_accvgpr_read_b32 v32, a212
 v_mfma_f32_16x16x32_bf16 v[212:215], a[4:7], a[188:191], v[212:215]
 s_add_u32 s8, s8, 0x10000
 s_addc_u32 s9, s9, 0
 v_accvgpr_read_b32 v40, a220
 v_mfma_f32_16x16x32_bf16 v[216:219], a[8:11], a[188:191], 0
 v_rcp_f32 v28, v28
 v_mfma_f32_16x16x32_bf16 v[216:219], a[24:27], a[184:187], v[216:219]
 v_rcp_f32 v29, v29
 v_mfma_f32_16x16x32_bf16 v[216:219], a[40:43], a[204:207], v[216:219]
 s_add_u32 m0, s26, 7168
 v_rcp_f32 v30, v30
 v_mfma_f32_16x16x32_bf16 v[216:219], a[56:59], a[160:163], v[216:219]
 buffer_load_dwordx4 v14, s[4:7], 0 offen nt lds
 v_fma_f32 v20, v20, v28, -v28
 v_mfma_f32_16x16x32_bf16 v[216:219], a[72:75], a[164:167], v[216:219]
 s_add_u32 s4, s4, 128
 s_addc_u32 s5, s5, 0
 s_xor_b32 s26, s26, 0x10000
 v_mfma_f32_16x16x32_bf16 v[220:223], a[76:79], a[164:167], 0
 s_xor_b32 s27, s27, s31
 v_rcp_f32 v31, v31
 v_mfma_f32_16x16x32_bf16 v[220:223], a[60:63], a[160:163], v[220:223]
 v_fma_f32 v21, v21, v29, -v29
 v_fma_f32 v22, v22, v30, -v30
 v_mfma_f32_16x16x32_bf16 v[220:223], a[44:47], a[204:207], v[220:223]
 v_fma_f32 v23, v23, v31, -v31
 v_cvt_pk_bf16_f32 v16, v20, v21
 v_mfma_f32_16x16x32_bf16 v[220:223], a[28:31], a[184:187], v[220:223]
 v_cvt_pk_bf16_f32 v17, v22, v23
 v_accvgpr_read_b32 v33, a213
 v_mfma_f32_16x16x32_bf16 v[220:223], a[12:15], a[188:191], v[220:223]
 v_accvgpr_read_b32 v41, a221
 v_accvgpr_read_b32 v34, a214
 v_mfma_f32_16x16x32_bf16 v[236:239], a[12:15], a[184:187], 0
 v_accvgpr_read_b32 v42, a222
 v_accvgpr_read_b32 v35, a215
 v_mfma_f32_16x16x32_bf16 v[236:239], a[28:31], a[204:207], v[236:239]
 v_accvgpr_read_b32 v43, a223
 v_mul_f32 v32, s42, v32
 v_mfma_f32_16x16x32_bf16 v[236:239], a[44:47], a[160:163], v[236:239]
 v_mul_f32 v33, s42, v33
 v_mul_f32 v34, s42, v34
 v_mfma_f32_16x16x32_bf16 v[236:239], a[60:63], a[164:167], v[236:239]
 ds_read_b128 a[172:175], v3 offset:15232
 v_mul_f32 v35, s42, v35
 v_mfma_f32_16x16x32_bf16 v[236:239], a[76:79], a[200:203], v[236:239]
 v_min_f32 v32, s47, v32
 v_min_f32 v33, s47, v33
 v_mfma_f32_16x16x32_bf16 v[232:235], a[72:75], a[200:203], 0
 v_min_f32 v34, s47, v34
 v_min_f32 v35, s47, v35
 v_mfma_f32_16x16x32_bf16 v[232:235], a[56:59], a[164:167], v[232:235]
 v_exp_f32 v32, v32
 v_mfma_f32_16x16x32_bf16 v[232:235], a[40:43], a[160:163], v[232:235]
 v_mul_f32 v40, s43, v40
 v_mul_f32 v41, s43, v41
 v_mfma_f32_16x16x32_bf16 v[232:235], a[24:27], a[204:207], v[232:235]
 v_exp_f32 v33, v33
 v_mfma_f32_16x16x32_bf16 v[232:235], a[8:11], a[184:187], v[232:235]
 v_mul_f32 v42, s43, v42
 v_mul_f32 v43, s43, v43
 v_mfma_f32_16x16x32_bf16 v[228:231], a[4:7], a[184:187], 0
 v_exp_f32 v34, v34
 v_mfma_f32_16x16x32_bf16 v[228:231], a[20:23], a[204:207], v[228:231]
 v_exp_f32 v35, v35
 v_mfma_f32_16x16x32_bf16 v[228:231], a[36:39], a[160:163], v[228:231]
 v_exp_f32 v40, v40
 v_mfma_f32_16x16x32_bf16 v[228:231], a[52:55], a[164:167], v[228:231]
 v_add_f32 v28, 1.0, v32
 v_add_f32 v29, 1.0, v33
 v_mfma_f32_16x16x32_bf16 v[228:231], a[68:71], a[200:203], v[228:231]
 v_exp_f32 v41, v41
 v_mfma_f32_16x16x32_bf16 v[224:227], a[64:67], a[200:203], 0
 v_add_f32 v30, 1.0, v34
 v_add_f32 v31, 1.0, v35
 v_mfma_f32_16x16x32_bf16 v[224:227], a[48:51], a[164:167], v[224:227]
 v_exp_f32 v42, v42
 v_mfma_f32_16x16x32_bf16 v[224:227], a[32:35], a[160:163], v[224:227]
 v_exp_f32 v43, v43
 v_mfma_f32_16x16x32_bf16 v[224:227], a[16:19], a[204:207], v[224:227]
 v_fmac_f32 v28, v28, v40
 v_fmac_f32 v29, v29, v41
 v_mfma_f32_16x16x32_bf16 v[224:227], a[0:3], a[184:187], v[224:227]
 ds_read_b128 a[168:171], v2 offset:17408
 v_fmac_f32 v30, v30, v42
 v_mfma_f32_16x16x32_bf16 v[240:243], a[0:3], a[204:207], 0
 ds_read_b128 a[196:199], v2 offset:21760
 v_fmac_f32 v31, v31, v43
 v_mfma_f32_16x16x32_bf16 v[240:243], a[16:19], a[160:163], v[240:243]
 ds_read_b128 a[192:195], v2 offset:26112
 v_accvgpr_read_b32 v20, a224
 v_mfma_f32_16x16x32_bf16 v[240:243], a[32:35], a[164:167], v[240:243]
 ds_read_b128 a[188:191], v4 offset:0
 v_accvgpr_read_b32 v24, a232
 v_mfma_f32_16x16x32_bf16 v[240:243], a[48:51], a[200:203], v[240:243]
 ds_read_b128 a[184:187], v4 offset:4352
 v_accvgpr_read_b32 v21, a225
 v_mfma_f32_16x16x32_bf16 v[240:243], a[64:67], a[180:183], v[240:243]
 v_rcp_f32 v28, v28
 v_mfma_f32_16x16x32_bf16 v[244:247], a[68:71], a[180:183], 0
 v_rcp_f32 v29, v29
 v_mfma_f32_16x16x32_bf16 v[244:247], a[52:55], a[200:203], v[244:247]
 v_rcp_f32 v30, v30
 v_mfma_f32_16x16x32_bf16 v[244:247], a[36:39], a[164:167], v[244:247]
 v_rcp_f32 v31, v31
 v_mfma_f32_16x16x32_bf16 v[244:247], a[20:23], a[160:163], v[244:247]
 v_fma_f32 v32, v32, v28, -v28
 v_fma_f32 v33, v33, v29, -v29
 v_mfma_f32_16x16x32_bf16 v[244:247], a[4:7], a[204:207], v[244:247]
 v_fma_f32 v34, v34, v30, -v30
 v_fma_f32 v35, v35, v31, -v31
 v_mfma_f32_16x16x32_bf16 v[248:251], a[8:11], a[204:207], 0
 v_cvt_pk_bf16_f32 v18, v32, v33
 v_cvt_pk_bf16_f32 v19, v34, v35
 v_mfma_f32_16x16x32_bf16 v[248:251], a[24:27], a[160:163], v[248:251]
 s_add_u32 s46, s40, 11264
 buffer_store_dwordx4 v[16:19], v6, s[12:15], s46 offen
 v_accvgpr_read_b32 v25, a233
 v_mfma_f32_16x16x32_bf16 v[248:251], a[40:43], a[164:167], v[248:251]
 v_accvgpr_read_b32 v22, a226
 v_accvgpr_read_b32 v26, a234
 v_mfma_f32_16x16x32_bf16 v[248:251], a[56:59], a[200:203], v[248:251]
 v_accvgpr_read_b32 v23, a227
 v_accvgpr_read_b32 v27, a235
 v_mfma_f32_16x16x32_bf16 v[248:251], a[72:75], a[180:183], v[248:251]
 v_mul_f32 v20, s42, v20
 v_mul_f32 v21, s42, v21
 v_mfma_f32_16x16x32_bf16 v[252:255], a[76:79], a[180:183], 0
 v_mul_f32 v22, s42, v22
 v_mul_f32 v23, s42, v23
 v_mfma_f32_16x16x32_bf16 v[252:255], a[60:63], a[200:203], v[252:255]
 v_min_f32 v20, s47, v20
 v_min_f32 v21, s47, v21
 v_mfma_f32_16x16x32_bf16 v[252:255], a[44:47], a[164:167], v[252:255]
 v_min_f32 v22, s47, v22
 v_min_f32 v23, s47, v23
 v_mfma_f32_16x16x32_bf16 v[252:255], a[28:31], a[160:163], v[252:255]
 v_exp_f32 v20, v20
 v_mfma_f32_16x16x32_bf16 v[252:255], a[12:15], a[204:207], v[252:255]
 v_mul_f32 v24, s43, v24
 v_mul_f32 v25, s43, v25
 v_mfma_f32_16x16x32_bf16 a[220:223], a[12:15], a[160:163], 0
 v_exp_f32 v21, v21
 v_mfma_f32_16x16x32_bf16 a[220:223], a[28:31], a[164:167], a[220:223]
 v_mul_f32 v26, s43, v26
 v_mul_f32 v27, s43, v27
 v_mfma_f32_16x16x32_bf16 a[220:223], a[44:47], a[200:203], a[220:223]
 v_exp_f32 v22, v22
 v_mfma_f32_16x16x32_bf16 a[220:223], a[60:63], a[180:183], a[220:223]
 s_waitcnt lgkmcnt(0)
 ds_read_b128 a[204:207], v4 offset:8704
 v_add_f32 v28, 1.0, v20
 v_mfma_f32_16x16x32_bf16 a[220:223], a[76:79], a[176:179], a[220:223]
 v_exp_f32 v23, v23
 v_mfma_f32_16x16x32_bf16 a[216:219], a[72:75], a[176:179], 0
 v_exp_f32 v24, v24
 v_mfma_f32_16x16x32_bf16 a[216:219], a[56:59], a[180:183], a[216:219]
 v_add_f32 v29, 1.0, v21
 v_add_f32 v30, 1.0, v22
 v_mfma_f32_16x16x32_bf16 a[216:219], a[40:43], a[200:203], a[216:219]
 v_exp_f32 v25, v25
 v_mfma_f32_16x16x32_bf16 a[216:219], a[24:27], a[164:167], a[216:219]
 v_add_f32 v31, 1.0, v23
 v_fmac_f32 v28, v28, v24
 v_mfma_f32_16x16x32_bf16 a[216:219], a[8:11], a[160:163], a[216:219]
 v_exp_f32 v26, v26
 v_mfma_f32_16x16x32_bf16 a[212:215], a[4:7], a[160:163], 0
 v_exp_f32 v27, v27
 v_mfma_f32_16x16x32_bf16 a[212:215], a[20:23], a[164:167], a[212:215]
 v_fmac_f32 v29, v29, v25
 v_fmac_f32 v30, v30, v26
 v_mfma_f32_16x16x32_bf16 a[212:215], a[36:39], a[200:203], a[212:215]
 v_fmac_f32 v31, v31, v27
 v_accvgpr_read_b32 v32, a228
 v_mfma_f32_16x16x32_bf16 a[212:215], a[52:55], a[180:183], a[212:215]
 v_rcp_f32 v28, v28
 v_mfma_f32_16x16x32_bf16 a[212:215], a[68:71], a[176:179], a[212:215]
 v_rcp_f32 v29, v29
 v_mfma_f32_16x16x32_bf16 a[208:211], a[64:67], a[176:179], 0
 v_rcp_f32 v30, v30
 v_mfma_f32_16x16x32_bf16 a[208:211], a[48:51], a[180:183], a[208:211]
 v_rcp_f32 v31, v31
 v_mfma_f32_16x16x32_bf16 a[208:211], a[32:35], a[200:203], a[208:211]
 v_fma_f32 v20, v20, v28, -v28
 v_fma_f32 v21, v21, v29, -v29
 v_mfma_f32_16x16x32_bf16 a[208:211], a[16:19], a[164:167], a[208:211]
 v_fma_f32 v22, v22, v30, -v30
 v_fma_f32 v23, v23, v31, -v31
 v_mfma_f32_16x16x32_bf16 a[208:211], a[0:3], a[160:163], a[208:211]
 v_cvt_pk_bf16_f32 v16, v20, v21
 v_cvt_pk_bf16_f32 v17, v22, v23
 v_mfma_f32_16x16x32_bf16 a[224:227], a[0:3], a[164:167], 0
 s_waitcnt vmcnt(9)
 ds_read_b64_tr_b16 a[0:1], v46 offset:0
 v_accvgpr_read_b32 v40, a236
 v_mfma_f32_16x16x32_bf16 a[224:227], a[16:19], a[200:203], a[224:227]
 v_accvgpr_read_b32 v33, a229
 v_accvgpr_read_b32 v41, a237
 v_mfma_f32_16x16x32_bf16 a[224:227], a[32:35], a[180:183], a[224:227]
 v_accvgpr_read_b32 v34, a230
 v_accvgpr_read_b32 v42, a238
 v_mfma_f32_16x16x32_bf16 a[224:227], a[48:51], a[176:179], a[224:227]
 ds_read_b128 a[160:163], v4 offset:13056
 ds_read_b64_tr_b16 a[2:3], v46 offset:256
 v_mfma_f32_16x16x32_bf16 a[224:227], a[64:67], a[172:175], a[224:227]
 v_accvgpr_read_b32 v35, a231
 v_accvgpr_read_b32 v43, a239
 v_mfma_f32_16x16x32_bf16 a[228:231], a[68:71], a[172:175], 0
 v_mul_f32 v32, s42, v32
 v_mul_f32 v33, s42, v33
 v_mfma_f32_16x16x32_bf16 a[228:231], a[52:55], a[176:179], a[228:231]
 v_mul_f32 v34, s42, v34
 v_mul_f32 v35, s42, v35
 v_mfma_f32_16x16x32_bf16 a[228:231], a[36:39], a[180:183], a[228:231]
 v_min_f32 v32, s47, v32
 v_min_f32 v33, s47, v33
 v_mfma_f32_16x16x32_bf16 a[228:231], a[20:23], a[200:203], a[228:231]
 v_min_f32 v34, s47, v34
 v_min_f32 v35, s47, v35
 v_mfma_f32_16x16x32_bf16 a[228:231], a[4:7], a[164:167], a[228:231]
 ds_read_b64_tr_b16 a[4:5], v46 offset:8
 v_mul_f32 v40, s43, v40
 v_mfma_f32_16x16x32_bf16 a[232:235], a[8:11], a[164:167], 0
 v_exp_f32 v32, v32
 v_mfma_f32_16x16x32_bf16 a[232:235], a[24:27], a[200:203], a[232:235]
 v_mul_f32 v41, s43, v41
 v_mul_f32 v42, s43, v42
 v_mfma_f32_16x16x32_bf16 a[232:235], a[40:43], a[180:183], a[232:235]
 ds_read_b64_tr_b16 a[6:7], v46 offset:264
 v_mul_f32 v43, s43, v43
 v_mfma_f32_16x16x32_bf16 a[232:235], a[56:59], a[176:179], a[232:235]
 v_exp_f32 v33, v33
 v_mfma_f32_16x16x32_bf16 a[232:235], a[72:75], a[172:175], a[232:235]
 v_exp_f32 v34, v34
 v_mfma_f32_16x16x32_bf16 a[236:239], a[76:79], a[172:175], 0
 ds_read_b64_tr_b16 a[16:17], v46 offset:4096
 v_add_f32 v28, 1.0, v32
 v_mfma_f32_16x16x32_bf16 a[236:239], a[60:63], a[176:179], a[236:239]
 v_exp_f32 v35, v35
 v_mfma_f32_16x16x32_bf16 a[236:239], a[44:47], a[180:183], a[236:239]
 v_exp_f32 v40, v40
 v_mfma_f32_16x16x32_bf16 a[236:239], a[28:31], a[200:203], a[236:239]
 s_add_u32 m0, s29, 0
 ds_read_b64_tr_b16 a[18:19], v46 offset:4352
 v_add_f32 v29, 1.0, v33
 v_mfma_f32_16x16x32_bf16 a[236:239], a[12:15], a[164:167], a[236:239]
 s_waitcnt lgkmcnt(2)
 ds_read_b128 a[172:175], v2 offset:2176
 buffer_load_dwordx4 v5, s[8:11], s76 offen offset:0 lds
 v_mfma_f32_16x16x32_bf16 v[112:115], a[80:83], a[168:171], v[112:115]
 ds_read_b128 a[176:179], v2 offset:6528
 v_add_f32 v30, 1.0, v34
 v_mfma_f32_16x16x32_bf16 v[112:115], a[96:99], a[196:199], v[112:115]
 ds_read_b128 a[180:183], v2 offset:10880
 ds_read_b64_tr_b16 a[20:21], v46 offset:4104
 v_mfma_f32_16x16x32_bf16 v[112:115], a[112:115], a[192:195], v[112:115]
 ds_read_b128 a[200:203], v2 offset:15232
 v_add_f32 v31, 1.0, v35
 v_mfma_f32_16x16x32_bf16 v[112:115], a[128:131], a[188:191], v[112:115]
 ds_read_b128 a[164:167], v2 offset:19584
 v_fmac_f32 v28, v28, v40
 v_mfma_f32_16x16x32_bf16 v[112:115], a[144:147], a[184:187], v[112:115]
 ds_read_b64_tr_b16 a[22:23], v46 offset:4360
 v_accvgpr_read_b32 v20, a240
 v_mfma_f32_16x16x32_bf16 v[116:119], a[148:151], a[184:187], v[116:119]
 v_exp_f32 v41, v41
 v_mfma_f32_16x16x32_bf16 v[116:119], a[132:135], a[188:191], v[116:119]
 s_add_u32 m0, s29, 2048
 v_exp_f32 v42, v42
 v_mfma_f32_16x16x32_bf16 v[116:119], a[116:119], a[192:195], v[116:119]
 ds_read_b64_tr_b16 a[32:33], v46 offset:8192
 buffer_load_dwordx4 v5, s[8:11], s77 offen offset:0 lds
 v_mfma_f32_16x16x32_bf16 v[116:119], a[100:103], a[196:199], v[116:119]
 v_exp_f32 v43, v43
 v_mfma_f32_16x16x32_bf16 v[116:119], a[84:87], a[168:171], v[116:119]
 v_fmac_f32 v29, v29, v41
 v_fmac_f32 v30, v30, v42
 v_mfma_f32_16x16x32_bf16 v[120:123], a[88:91], a[168:171], v[120:123]
 ds_read_b64_tr_b16 a[34:35], v46 offset:8448
 v_fmac_f32 v31, v31, v43
 v_mfma_f32_16x16x32_bf16 v[120:123], a[104:107], a[196:199], v[120:123]
 v_rcp_f32 v28, v28
 v_mfma_f32_16x16x32_bf16 v[120:123], a[120:123], a[192:195], v[120:123]
 v_rcp_f32 v29, v29
 v_mfma_f32_16x16x32_bf16 v[120:123], a[136:139], a[188:191], v[120:123]
 ds_read_b64_tr_b16 a[36:37], v46 offset:8200
 v_fma_f32 v32, v32, v28, -v28
 v_mfma_f32_16x16x32_bf16 v[120:123], a[152:155], a[184:187], v[120:123]
 v_rcp_f32 v30, v30
 v_mfma_f32_16x16x32_bf16 v[124:127], a[156:159], a[184:187], v[124:127]
 s_add_u32 m0, s29, 4096
 v_rcp_f32 v31, v31
 v_mfma_f32_16x16x32_bf16 v[124:127], a[140:143], a[188:191], v[124:127]
 s_waitcnt lgkmcnt(3)
 ds_read_b64_tr_b16 a[38:39], v46 offset:8456
 buffer_load_dwordx4 v5, s[8:11], s78 offen offset:0 lds
 v_mfma_f32_16x16x32_bf16 v[124:127], a[124:127], a[192:195], v[124:127]
 v_fma_f32 v33, v33, v29, -v29
 v_fma_f32 v34, v34, v30, -v30
 v_mfma_f32_16x16x32_bf16 v[124:127], a[108:111], a[196:199], v[124:127]
 v_fma_f32 v35, v35, v31, -v31
 v_cvt_pk_bf16_f32 v18, v32, v33
 v_mfma_f32_16x16x32_bf16 v[124:127], a[92:95], a[168:171], v[124:127]
 ds_read_b64_tr_b16 a[48:49], v46 offset:12288
 v_cvt_pk_bf16_f32 v19, v34, v35
 v_mfma_f32_16x16x32_bf16 v[140:143], a[92:95], a[196:199], v[140:143]
 s_add_u32 s46, s40, 13312
 buffer_store_dwordx4 v[16:19], v6, s[12:15], s46 offen
 v_accvgpr_read_b32 v24, a248
 v_mfma_f32_16x16x32_bf16 v[140:143], a[108:111], a[192:195], v[140:143]
 v_accvgpr_read_b32 v21, a241
 v_accvgpr_read_b32 v25, a249
 v_mfma_f32_16x16x32_bf16 v[140:143], a[124:127], a[188:191], v[140:143]
 ds_read_b64_tr_b16 a[50:51], v46 offset:12544
 v_accvgpr_read_b32 v22, a242
 v_mfma_f32_16x16x32_bf16 v[140:143], a[140:143], a[184:187], v[140:143]
 ds_read_b128 a[168:171], v2 offset:23936
 v_accvgpr_read_b32 v26, a250
 v_mfma_f32_16x16x32_bf16 v[140:143], a[156:159], a[204:207], v[140:143]
 s_add_u32 m0, s29, 6144
 v_accvgpr_read_b32 v23, a243
 v_accvgpr_read_b32 v27, a251
 v_mfma_f32_16x16x32_bf16 v[136:139], a[152:155], a[204:207], v[136:139]
 ds_read_b64_tr_b16 a[52:53], v46 offset:12296
 buffer_load_dwordx4 v5, s[8:11], s79 offen offset:0 lds
 v_mfma_f32_16x16x32_bf16 v[136:139], a[136:139], a[184:187], v[136:139]
 v_mul_f32 v20, s42, v20
 v_mul_f32 v21, s42, v21
 v_mfma_f32_16x16x32_bf16 v[136:139], a[120:123], a[188:191], v[136:139]
 v_mul_f32 v22, s42, v22
 v_mul_f32 v23, s42, v23
 v_mfma_f32_16x16x32_bf16 v[136:139], a[104:107], a[192:195], v[136:139]
 ds_read_b64_tr_b16 a[54:55], v46 offset:12552
 v_min_f32 v20, s47, v20
 v_mfma_f32_16x16x32_bf16 v[136:139], a[88:91], a[196:199], v[136:139]
 v_min_f32 v21, s47, v21
 v_min_f32 v22, s47, v22
 v_mfma_f32_16x16x32_bf16 v[132:135], a[84:87], a[196:199], v[132:135]
 v_min_f32 v23, s47, v23
 v_mul_f32 v24, s43, v24
 v_mfma_f32_16x16x32_bf16 v[132:135], a[100:103], a[192:195], v[132:135]
 ds_read_b64_tr_b16 a[64:65], v46 offset:16384
 v_mul_f32 v25, s43, v25
 v_mfma_f32_16x16x32_bf16 v[132:135], a[116:119], a[188:191], v[132:135]
 v_exp_f32 v20, v20
 v_mfma_f32_16x16x32_bf16 v[132:135], a[132:135], a[184:187], v[132:135]
 s_add_u32 m0, s29, 8192
 v_exp_f32 v21, v21
 v_mfma_f32_16x16x32_bf16 v[132:135], a[148:151], a[204:207], v[132:135]
 s_waitcnt lgkmcnt(4)
 ds_read_b64_tr_b16 a[66:67], v46 offset:16640
 buffer_load_dwordx4 v5, s[8:11], s80 offen offset:0 lds
 v_mfma_f32_16x16x32_bf16 v[128:131], a[144:147], a[204:207], v[128:131]
 v_mul_f32 v26, s43, v26
 v_mul_f32 v27, s43, v27
 v_mfma_f32_16x16x32_bf16 v[128:131], a[128:131], a[184:187], v[128:131]
 v_exp_f32 v22, v22
 v_mfma_f32_16x16x32_bf16 v[128:131], a[112:115], a[188:191], v[128:131]
 ds_read_b64_tr_b16 a[68:69], v46 offset:16392
 v_add_f32 v28, 1.0, v20
 v_mfma_f32_16x16x32_bf16 v[128:131], a[96:99], a[192:195], v[128:131]
 v_exp_f32 v23, v23
 v_mfma_f32_16x16x32_bf16 v[128:131], a[80:83], a[196:199], v[128:131]
 v_exp_f32 v24, v24
 v_mfma_f32_16x16x32_bf16 v[144:147], a[80:83], a[192:195], v[144:147]
 ds_read_b64_tr_b16 a[70:71], v46 offset:16648
 v_add_f32 v29, 1.0, v21
 v_mfma_f32_16x16x32_bf16 v[144:147], a[96:99], a[188:191], v[144:147]
 v_exp_f32 v25, v25
 v_mfma_f32_16x16x32_bf16 v[144:147], a[112:115], a[184:187], v[144:147]
 v_add_f32 v30, 1.0, v22
 v_add_f32 v31, 1.0, v23
 v_mfma_f32_16x16x32_bf16 v[144:147], a[128:131], a[204:207], v[144:147]
 s_add_u32 m0, s29, 10240
 ds_read_b128 a[196:199], v2 offset:28288
 ds_read_b64_tr_b16 a[8:9], v46 offset:1024
 v_mfma_f32_16x16x32_bf16 v[144:147], a[144:147], a[160:163], v[144:147]
 buffer_load_dwordx4 v5, s[8:11], s81 offen offset:0 lds
 v_fmac_f32 v28, v28, v24
 v_mfma_f32_16x16x32_bf16 v[148:151], a[148:151], a[160:163], v[148:151]
 v_exp_f32 v26, v26
 v_mfma_f32_16x16x32_bf16 v[148:151], a[132:135], a[204:207], v[148:151]
 ds_read_b64_tr_b16 a[10:11], v46 offset:1280
 v_fmac_f32 v29, v29, v25
 v_mfma_f32_16x16x32_bf16 v[148:151], a[116:119], a[184:187], v[148:151]
 v_exp_f32 v27, v27
 v_mfma_f32_16x16x32_bf16 v[148:151], a[100:103], a[188:191], v[148:151]
 v_fmac_f32 v30, v30, v26
 v_fmac_f32 v31, v31, v27
 v_mfma_f32_16x16x32_bf16 v[148:151], a[84:87], a[192:195], v[148:151]
 ds_read_b64_tr_b16 a[12:13], v46 offset:1032
 v_accvgpr_read_b32 v32, a244
 v_mfma_f32_16x16x32_bf16 v[152:155], a[88:91], a[192:195], v[152:155]
 v_rcp_f32 v28, v28
 v_mfma_f32_16x16x32_bf16 v[152:155], a[104:107], a[188:191], v[152:155]
 s_add_u32 m0, s29, 12288
 v_rcp_f32 v29, v29
 v_mfma_f32_16x16x32_bf16 v[152:155], a[120:123], a[184:187], v[152:155]
 s_waitcnt lgkmcnt(4)
 ds_read_b64_tr_b16 a[14:15], v46 offset:1288
 buffer_load_dwordx4 v5, s[8:11], s82 offen offset:0 lds
 v_mfma_f32_16x16x32_bf16 v[152:155], a[136:139], a[204:207], v[152:155]
 v_rcp_f32 v30, v30
 v_mfma_f32_16x16x32_bf16 v[152:155], a[152:155], a[160:163], v[152:155]
 v_rcp_f32 v31, v31
 v_mfma_f32_16x16x32_bf16 v[156:159], a[156:159], a[160:163], v[156:159]
 ds_read_b64_tr_b16 a[24:25], v46 offset:5120
 v_fma_f32 v20, v20, v28, -v28
 v_mfma_f32_16x16x32_bf16 v[156:159], a[140:143], a[204:207], v[156:159]
 v_fma_f32 v21, v21, v29, -v29
 v_fma_f32 v22, v22, v30, -v30
 v_mfma_f32_16x16x32_bf16 v[156:159], a[124:127], a[184:187], v[156:159]
 v_fma_f32 v23, v23, v31, -v31
 v_cvt_pk_bf16_f32 v16, v20, v21
 v_mfma_f32_16x16x32_bf16 v[156:159], a[108:111], a[188:191], v[156:159]
 ds_read_b64_tr_b16 a[26:27], v46 offset:5376
 v_cvt_pk_bf16_f32 v17, v22, v23
 v_mfma_f32_16x16x32_bf16 v[156:159], a[92:95], a[192:195], v[156:159]
 s_add_u32 m0, s29, 14336
 v_accvgpr_read_b32 v40, a252
 v_accvgpr_read_b32 v33, a245
 v_mfma_f32_16x16x32_bf16 v[176:179], a[80:83], a[172:175], v[176:179]
 buffer_load_dwordx4 v5, s[8:11], s83 offen offset:0 lds
 v_accvgpr_read_b32 v41, a253
 v_mfma_f32_16x16x32_bf16 v[176:179], a[96:99], a[176:179], v[176:179]
 ds_read_b64_tr_b16 a[28:29], v46 offset:5128
 v_accvgpr_read_b32 v34, a246
 v_mfma_f32_16x16x32_bf16 v[176:179], a[112:115], a[180:183], v[176:179]
 v_accvgpr_read_b32 v42, a254
 v_accvgpr_read_b32 v35, a247
 v_mfma_f32_16x16x32_bf16 v[176:179], a[128:131], a[200:203], v[176:179]
 ds_read_b128 a[204:207], v4 offset:2176
 v_accvgpr_read_b32 v43, a255
 v_mfma_f32_16x16x32_bf16 v[176:179], a[144:147], a[164:167], v[176:179]
 ds_read_b64_tr_b16 a[30:31], v46 offset:5384
 v_mul_f32 v32, s42, v32
 v_mfma_f32_16x16x32_bf16 v[180:183], a[148:151], a[164:167], v[180:183]
 v_mul_f32 v33, s42, v33
 v_mul_f32 v34, s42, v34
 v_mfma_f32_16x16x32_bf16 v[180:183], a[132:135], a[200:203], v[180:183]
 v_mul_f32 v35, s42, v35
 v_min_f32 v32, s47, v32
 v_mfma_f32_16x16x32_bf16 v[180:183], a[116:119], a[180:183], v[180:183]
 s_waitcnt vmcnt(10)
 ds_read_b64_tr_b16 a[40:41], v46 offset:9216
 v_min_f32 v33, s47, v33
 v_mfma_f32_16x16x32_bf16 v[180:183], a[100:103], a[176:179], v[180:183]
 s_add_u32 m0, s29, 16384
 v_min_f32 v34, s47, v34
 v_min_f32 v35, s47, v35
 v_mfma_f32_16x16x32_bf16 v[180:183], a[84:87], a[172:175], v[180:183]
 buffer_load_dwordx4 v5, s[8:11], s84 offen offset:0 lds
 v_mul_f32 v40, s43, v40
 v_mfma_f32_16x16x32_bf16 v[184:187], a[88:91], a[172:175], v[184:187]
 ds_read_b64_tr_b16 a[42:43], v46 offset:9472
 v_mul_f32 v41, s43, v41
 v_mfma_f32_16x16x32_bf16 v[184:187], a[104:107], a[176:179], v[184:187]
 v_exp_f32 v32, v32
 v_mfma_f32_16x16x32_bf16 v[184:187], a[120:123], a[180:183], v[184:187]
 v_exp_f32 v33, v33
 v_mfma_f32_16x16x32_bf16 v[184:187], a[136:139], a[200:203], v[184:187]
 ds_read_b64_tr_b16 a[44:45], v46 offset:9224
 v_mul_f32 v42, s43, v42
 v_mfma_f32_16x16x32_bf16 v[184:187], a[152:155], a[164:167], v[184:187]
 v_mul_f32 v43, s43, v43
 v_add_f32 v28, 1.0, v32
 v_mfma_f32_16x16x32_bf16 v[188:191], a[156:159], a[164:167], v[188:191]
 v_exp_f32 v34, v34
 v_mfma_f32_16x16x32_bf16 v[188:191], a[140:143], a[200:203], v[188:191]
 ds_read_b64_tr_b16 a[46:47], v46 offset:9480
 v_add_f32 v29, 1.0, v33
 v_mfma_f32_16x16x32_bf16 v[188:191], a[124:127], a[180:183], v[188:191]
 s_add_u32 m0, s29, 18432
 v_exp_f32 v35, v35
 v_mfma_f32_16x16x32_bf16 v[188:191], a[108:111], a[176:179], v[188:191]
 buffer_load_dwordx4 v5, s[8:11], s85 offen offset:0 lds
 v_add_f32 v30, 1.0, v34
 v_mfma_f32_16x16x32_bf16 v[188:191], a[92:95], a[172:175], v[188:191]
 ds_read_b64_tr_b16 a[56:57], v46 offset:13312
 v_add_f32 v31, 1.0, v35
 v_mfma_f32_16x16x32_bf16 v[204:207], a[92:95], a[176:179], v[204:207]
 v_exp_f32 v40, v40
 v_mfma_f32_16x16x32_bf16 v[204:207], a[108:111], a[180:183], v[204:207]
 v_exp_f32 v41, v41
 v_mfma_f32_16x16x32_bf16 v[204:207], a[124:127], a[200:203], v[204:207]
 ds_read_b64_tr_b16 a[58:59], v46 offset:13568
 v_fmac_f32 v28, v28, v40
 v_mfma_f32_16x16x32_bf16 v[204:207], a[140:143], a[164:167], v[204:207]
 ds_read_b128 a[184:187], v4 offset:6528
 v_fmac_f32 v29, v29, v41
 v_mfma_f32_16x16x32_bf16 v[204:207], a[156:159], a[168:171], v[204:207]
 v_exp_f32 v42, v42
 v_mfma_f32_16x16x32_bf16 v[200:203], a[152:155], a[168:171], v[200:203]
 ds_read_b64_tr_b16 a[60:61], v46 offset:13320
 v_fmac_f32 v30, v30, v42
 v_mfma_f32_16x16x32_bf16 v[200:203], a[136:139], a[164:167], v[200:203]
 s_add_u32 m0, s29, 0
 v_exp_f32 v43, v43
 v_mfma_f32_16x16x32_bf16 v[200:203], a[120:123], a[200:203], v[200:203]
 s_waitcnt lgkmcnt(5)
 buffer_load_dwordx4 v5, s[8:11], s76 offen offset:1024 lds
 v_fmac_f32 v31, v31, v43
 v_mfma_f32_16x16x32_bf16 v[200:203], a[104:107], a[180:183], v[200:203]
 ds_read_b64_tr_b16 a[62:63], v46 offset:13576
 v_mfma_f32_16x16x32_bf16 v[200:203], a[88:91], a[176:179], v[200:203]
 v_rcp_f32 v28, v28
 v_mfma_f32_16x16x32_bf16 v[196:199], a[84:87], a[176:179], v[196:199]
 v_rcp_f32 v29, v29
 v_mfma_f32_16x16x32_bf16 v[196:199], a[100:103], a[180:183], v[196:199]
 ds_read_b64_tr_b16 a[72:73], v46 offset:17408
 v_fma_f32 v32, v32, v28, -v28
 v_mfma_f32_16x16x32_bf16 v[196:199], a[116:119], a[200:203], v[196:199]
 v_rcp_f32 v30, v30
 v_mfma_f32_16x16x32_bf16 v[196:199], a[132:135], a[164:167], v[196:199]
 v_rcp_f32 v31, v31
 v_mfma_f32_16x16x32_bf16 v[196:199], a[148:151], a[168:171], v[196:199]
 ds_read_b64_tr_b16 a[74:75], v46 offset:17664
 v_fma_f32 v33, v33, v29, -v29
 v_mfma_f32_16x16x32_bf16 v[192:195], a[144:147], a[168:171], v[192:195]
 s_add_u32 m0, s29, 2048
 v_fma_f32 v34, v34, v30, -v30
 v_fma_f32 v35, v35, v31, -v31
 v_mfma_f32_16x16x32_bf16 v[192:195], a[128:131], a[164:167], v[192:195]
 buffer_load_dwordx4 v5, s[8:11], s77 offen offset:1024 lds
 v_cvt_pk_bf16_f32 v18, v32, v33
 v_mfma_f32_16x16x32_bf16 v[192:195], a[112:115], a[200:203], v[192:195]
 ds_read_b64_tr_b16 a[76:77], v46 offset:17416
 v_cvt_pk_bf16_f32 v19, v34, v35
 v_mfma_f32_16x16x32_bf16 v[192:195], a[96:99], a[180:183], v[192:195]
 s_add_u32 s46, s40, 15360
 buffer_store_dwordx4 v[16:19], v6, s[12:15], s46 offen
 v_mfma_f32_16x16x32_bf16 v[192:195], a[80:83], a[176:179], v[192:195]
 v_mfma_f32_16x16x32_bf16 v[208:211], a[80:83], a[180:183], v[208:211]
 ds_read_b64_tr_b16 a[78:79], v46 offset:17672
 v_mfma_f32_16x16x32_bf16 v[208:211], a[96:99], a[200:203], v[208:211]
 v_mfma_f32_16x16x32_bf16 v[208:211], a[112:115], a[164:167], v[208:211]
 v_mfma_f32_16x16x32_bf16 v[208:211], a[128:131], a[168:171], v[208:211]
 ds_read_b128 a[188:191], v4 offset:10880
 v_mfma_f32_16x16x32_bf16 v[208:211], a[144:147], a[196:199], v[208:211]
 s_add_u32 m0, s29, 4096
 v_mfma_f32_16x16x32_bf16 v[212:215], a[148:151], a[196:199], v[212:215]
 buffer_load_dwordx4 v5, s[8:11], s78 offen offset:1024 lds
 v_mfma_f32_16x16x32_bf16 v[212:215], a[132:135], a[168:171], v[212:215]
 v_mfma_f32_16x16x32_bf16 v[212:215], a[116:119], a[164:167], v[212:215]
 v_mfma_f32_16x16x32_bf16 v[212:215], a[100:103], a[200:203], v[212:215]
 v_mfma_f32_16x16x32_bf16 v[212:215], a[84:87], a[180:183], v[212:215]
 v_mfma_f32_16x16x32_bf16 v[216:219], a[88:91], a[180:183], v[216:219]
 v_mfma_f32_16x16x32_bf16 v[216:219], a[104:107], a[200:203], v[216:219]
 v_mfma_f32_16x16x32_bf16 v[216:219], a[120:123], a[164:167], v[216:219]
 v_mfma_f32_16x16x32_bf16 v[216:219], a[136:139], a[168:171], v[216:219]
 s_add_u32 m0, s29, 6144
 v_mfma_f32_16x16x32_bf16 v[216:219], a[152:155], a[196:199], v[216:219]
 buffer_load_dwordx4 v5, s[8:11], s79 offen offset:1024 lds
 v_mfma_f32_16x16x32_bf16 v[220:223], a[156:159], a[196:199], v[220:223]
 v_mfma_f32_16x16x32_bf16 v[220:223], a[140:143], a[168:171], v[220:223]
 v_mfma_f32_16x16x32_bf16 v[220:223], a[124:127], a[164:167], v[220:223]
 v_mfma_f32_16x16x32_bf16 v[220:223], a[108:111], a[200:203], v[220:223]
 v_mfma_f32_16x16x32_bf16 v[220:223], a[92:95], a[180:183], v[220:223]
 v_mfma_f32_16x16x32_bf16 v[236:239], a[92:95], a[200:203], v[236:239]
 v_mfma_f32_16x16x32_bf16 v[236:239], a[108:111], a[164:167], v[236:239]
 s_add_u32 m0, s29, 8192
 v_mfma_f32_16x16x32_bf16 v[236:239], a[124:127], a[168:171], v[236:239]
 s_waitcnt lgkmcnt(0)
 buffer_load_dwordx4 v5, s[8:11], s80 offen offset:1024 lds
 v_mfma_f32_16x16x32_bf16 v[236:239], a[140:143], a[196:199], v[236:239]
 ds_read_b128 a[192:195], v4 offset:15232
 v_mfma_f32_16x16x32_bf16 v[236:239], a[156:159], a[204:207], v[236:239]
 v_mfma_f32_16x16x32_bf16 v[232:235], a[152:155], a[204:207], v[232:235]
 v_mfma_f32_16x16x32_bf16 v[232:235], a[136:139], a[196:199], v[232:235]
 v_mfma_f32_16x16x32_bf16 v[232:235], a[120:123], a[168:171], v[232:235]
 v_mfma_f32_16x16x32_bf16 v[232:235], a[104:107], a[164:167], v[232:235]
 v_mfma_f32_16x16x32_bf16 v[232:235], a[88:91], a[200:203], v[232:235]
 v_mfma_f32_16x16x32_bf16 v[228:231], a[84:87], a[200:203], v[228:231]
 s_add_u32 m0, s29, 10240
 v_mfma_f32_16x16x32_bf16 v[228:231], a[100:103], a[164:167], v[228:231]
 s_waitcnt lgkmcnt(0)
 s_barrier
 buffer_load_dwordx4 v5, s[8:11], s81 offen offset:1024 lds
 v_mfma_f32_16x16x32_bf16 v[228:231], a[116:119], a[168:171], v[228:231]
 v_xor_b32 v1, 0x10000, v1
 v_xor_b32 v2, 0x10000, v2
 v_mfma_f32_16x16x32_bf16 v[228:231], a[132:135], a[196:199], v[228:231]
 v_xor_b32 v3, 0x10000, v3
 v_xor_b32 v4, 0x10000, v4
 v_mfma_f32_16x16x32_bf16 v[228:231], a[148:151], a[204:207], v[228:231]
 ds_read_b128 a[160:163], v1 offset:0
 v_mfma_f32_16x16x32_bf16 v[224:227], a[144:147], a[204:207], v[224:227]
 v_mfma_f32_16x16x32_bf16 v[224:227], a[128:131], a[196:199], v[224:227]
 v_mfma_f32_16x16x32_bf16 v[224:227], a[112:115], a[168:171], v[224:227]
 v_mfma_f32_16x16x32_bf16 v[224:227], a[96:99], a[164:167], v[224:227]
 v_mfma_f32_16x16x32_bf16 v[224:227], a[80:83], a[200:203], v[224:227]
 s_add_u32 m0, s29, 12288
 v_mfma_f32_16x16x32_bf16 v[240:243], a[80:83], a[164:167], v[240:243]
 buffer_load_dwordx4 v5, s[8:11], s82 offen offset:1024 lds
 v_mfma_f32_16x16x32_bf16 v[240:243], a[96:99], a[168:171], v[240:243]
 v_mfma_f32_16x16x32_bf16 v[240:243], a[112:115], a[196:199], v[240:243]
 v_mfma_f32_16x16x32_bf16 v[240:243], a[128:131], a[204:207], v[240:243]
 v_mfma_f32_16x16x32_bf16 v[240:243], a[144:147], a[184:187], v[240:243]
 v_mfma_f32_16x16x32_bf16 v[244:247], a[148:151], a[184:187], v[244:247]
 v_mfma_f32_16x16x32_bf16 v[244:247], a[132:135], a[204:207], v[244:247]
 v_mfma_f32_16x16x32_bf16 v[244:247], a[116:119], a[196:199], v[244:247]
 v_mfma_f32_16x16x32_bf16 v[244:247], a[100:103], a[168:171], v[244:247]
 s_add_u32 m0, s29, 14336
 v_mfma_f32_16x16x32_bf16 v[244:247], a[84:87], a[164:167], v[244:247]
 buffer_load_dwordx4 v5, s[8:11], s83 offen offset:1024 lds
 v_mfma_f32_16x16x32_bf16 v[248:251], a[88:91], a[164:167], v[248:251]
 v_mfma_f32_16x16x32_bf16 v[248:251], a[104:107], a[168:171], v[248:251]
 v_mfma_f32_16x16x32_bf16 v[248:251], a[120:123], a[196:199], v[248:251]
 v_mfma_f32_16x16x32_bf16 v[248:251], a[136:139], a[204:207], v[248:251]
 v_mfma_f32_16x16x32_bf16 v[248:251], a[152:155], a[184:187], v[248:251]
 v_mfma_f32_16x16x32_bf16 v[252:255], a[156:159], a[184:187], v[252:255]
 v_mfma_f32_16x16x32_bf16 v[252:255], a[140:143], a[204:207], v[252:255]
 v_mfma_f32_16x16x32_bf16 v[252:255], a[124:127], a[196:199], v[252:255]
 s_add_u32 m0, s29, 16384
 v_mfma_f32_16x16x32_bf16 v[252:255], a[108:111], a[168:171], v[252:255]
 buffer_load_dwordx4 v5, s[8:11], s84 offen offset:1024 lds
 v_mfma_f32_16x16x32_bf16 v[252:255], a[92:95], a[164:167], v[252:255]
 ds_read_b128 a[164:167], v1 offset:4352
 v_mfma_f32_16x16x32_bf16 a[220:223], a[92:95], a[168:171], a[220:223]
 v_mfma_f32_16x16x32_bf16 a[220:223], a[108:111], a[196:199], a[220:223]
 v_mfma_f32_16x16x32_bf16 a[220:223], a[124:127], a[204:207], a[220:223]
 v_mfma_f32_16x16x32_bf16 a[220:223], a[140:143], a[184:187], a[220:223]
 v_mfma_f32_16x16x32_bf16 a[220:223], a[156:159], a[188:191], a[220:223]
 v_mfma_f32_16x16x32_bf16 a[216:219], a[152:155], a[188:191], a[216:219]
 v_mfma_f32_16x16x32_bf16 a[216:219], a[136:139], a[184:187], a[216:219]
 s_add_u32 m0, s29, 18432
 v_mfma_f32_16x16x32_bf16 a[216:219], a[120:123], a[204:207], a[216:219]
 buffer_load_dwordx4 v5, s[8:11], s85 offen offset:1024 lds
 v_mfma_f32_16x16x32_bf16 a[216:219], a[104:107], a[196:199], a[216:219]
 s_add_u32 s8, s8, 0x10000
 s_addc_u32 s9, s9, 0
 v_mfma_f32_16x16x32_bf16 a[216:219], a[88:91], a[168:171], a[216:219]
 v_mfma_f32_16x16x32_bf16 a[212:215], a[84:87], a[168:171], a[212:215]
 v_mfma_f32_16x16x32_bf16 a[212:215], a[100:103], a[196:199], a[212:215]
 v_mfma_f32_16x16x32_bf16 a[212:215], a[116:119], a[204:207], a[212:215]
 v_mfma_f32_16x16x32_bf16 a[212:215], a[132:135], a[184:187], a[212:215]
 v_mfma_f32_16x16x32_bf16 a[212:215], a[148:151], a[188:191], a[212:215]
 v_mfma_f32_16x16x32_bf16 a[208:211], a[144:147], a[188:191], a[208:211]
 v_mfma_f32_16x16x32_bf16 a[208:211], a[128:131], a[184:187], a[208:211]
 v_mfma_f32_16x16x32_bf16 a[208:211], a[112:115], a[204:207], a[208:211]
 v_mfma_f32_16x16x32_bf16 a[208:211], a[96:99], a[196:199], a[208:211]
 v_mfma_f32_16x16x32_bf16 a[208:211], a[80:83], a[168:171], a[208:211]
 ds_read_b128 a[168:171], v1 offset:8704
 ds_read_b128 a[172:175], v1 offset:13056
 v_mfma_f32_16x16x32_bf16 a[224:227], a[80:83], a[196:199], a[224:227]
 ds_read_b128 a[176:179], v1 offset:17408
 ds_read_b128 a[180:183], v1 offset:21760
 v_mfma_f32_16x16x32_bf16 a[224:227], a[96:99], a[204:207], a[224:227]
 v_mfma_f32_16x16x32_bf16 a[224:227], a[112:115], a[184:187], a[224:227]
 v_mfma_f32_16x16x32_bf16 a[224:227], a[128:131], a[188:191], a[224:227]
 v_mfma_f32_16x16x32_bf16 a[224:227], a[144:147], a[192:195], a[224:227]
 v_mfma_f32_16x16x32_bf16 a[228:231], a[148:151], a[192:195], a[228:231]
 v_mfma_f32_16x16x32_bf16 a[228:231], a[132:135], a[188:191], a[228:231]
 v_mfma_f32_16x16x32_bf16 a[228:231], a[116:119], a[184:187], a[228:231]
 v_mfma_f32_16x16x32_bf16 a[228:231], a[100:103], a[204:207], a[228:231]
 v_mfma_f32_16x16x32_bf16 a[228:231], a[84:87], a[196:199], a[228:231]
 v_mfma_f32_16x16x32_bf16 a[232:235], a[88:91], a[196:199], a[232:235]
 v_mfma_f32_16x16x32_bf16 a[232:235], a[104:107], a[204:207], a[232:235]
 v_mfma_f32_16x16x32_bf16 a[232:235], a[120:123], a[184:187], a[232:235]
 v_mfma_f32_16x16x32_bf16 a[232:235], a[136:139], a[188:191], a[232:235]
 v_mfma_f32_16x16x32_bf16 a[232:235], a[152:155], a[192:195], a[232:235]
 v_mfma_f32_16x16x32_bf16 a[236:239], a[156:159], a[192:195], a[236:239]
 v_mfma_f32_16x16x32_bf16 a[236:239], a[140:143], a[188:191], a[236:239]
 v_mfma_f32_16x16x32_bf16 a[236:239], a[124:127], a[184:187], a[236:239]
 v_mfma_f32_16x16x32_bf16 a[236:239], a[108:111], a[204:207], a[236:239]
 v_mfma_f32_16x16x32_bf16 a[236:239], a[92:95], a[196:199], a[236:239]
 s_add_u32 s12, s20, s68
 s_addc_u32 s13, s21, 0
 s_add_u32 s40, s69, s45
 v_mad_i32_i24 v6, v39, s71, v6
 s_movk_i32 s25, 100
 s_movk_i32 s23, 100
 s_mov_b32 s30, 6
 v_min_u32 v47, L_e14-L_f14-4, v47
 s_add_u32 s88, s86, L_f14-L_c0
 s_addc_u32 s89, s87, 0
.p2align 6
L_mid14:
 s_waitcnt lgkmcnt(5)
 ds_read_b128 a[184:187], v1 offset:26112
 ds_read_b128 a[188:191], v3 offset:0
 v_mfma_f32_16x16x32_bf16 v[48:51], a[0:3], a[160:163], v[48:51]
 s_waitcnt lgkmcnt(6)
 v_mfma_f32_16x16x32_bf16 v[48:51], a[16:19], a[164:167], v[48:51]
 s_waitcnt vmcnt(20) lgkmcnt(5)
 ds_read_b64_tr_b16 a[80:81], v46 offset:0
 v_mfma_f32_16x16x32_bf16 v[48:51], a[32:35], a[168:171], v[48:51]
 s_waitcnt lgkmcnt(5)
 v_mfma_f32_16x16x32_bf16 v[48:51], a[48:51], a[172:175], v[48:51]
 s_waitcnt lgkmcnt(4)
 v_mfma_f32_16x16x32_bf16 v[48:51], a[64:67], a[176:179], v[48:51]
 s_waitcnt lgkmcnt(3)
 ds_read_b64_tr_b16 a[82:83], v46 offset:256
 v_mfma_f32_16x16x32_bf16 v[64:67], a[64:67], a[180:183], v[64:67]
 v_mfma_f32_16x16x32_bf16 v[64:67], a[48:51], a[176:179], v[64:67]
 s_add_u32 m0, s26, 0
 v_mfma_f32_16x16x32_bf16 v[64:67], a[32:35], a[172:175], v[64:67]
 ds_read_b64_tr_b16 a[84:85], v46 offset:8
 buffer_load_dwordx4 v7, s[4:7], 0 offen nt lds
 v_mfma_f32_16x16x32_bf16 v[64:67], a[16:19], a[168:171], v[64:67]
 v_mfma_f32_16x16x32_bf16 v[64:67], a[0:3], a[164:167], v[64:67]
 v_mfma_f32_16x16x32_bf16 v[80:83], a[0:3], a[168:171], v[80:83]
 ds_read_b64_tr_b16 a[86:87], v46 offset:264
 v_mfma_f32_16x16x32_bf16 v[80:83], a[16:19], a[172:175], v[80:83]
 v_mfma_f32_16x16x32_bf16 v[80:83], a[32:35], a[176:179], v[80:83]
 v_mfma_f32_16x16x32_bf16 v[80:83], a[48:51], a[180:183], v[80:83]
 s_waitcnt vmcnt(18) lgkmcnt(3)
 ds_read_b64_tr_b16 a[96:97], v46 offset:4096
 v_mfma_f32_16x16x32_bf16 v[80:83], a[64:67], a[184:187], v[80:83]
 v_mfma_f32_16x16x32_bf16 v[96:99], a[64:67], a[188:191], v[96:99]
 v_mfma_f32_16x16x32_bf16 v[96:99], a[48:51], a[184:187], v[96:99]
 s_add_u32 m0, s29, 0
 ds_read_b64_tr_b16 a[98:99], v46 offset:4352
 v_mfma_f32_16x16x32_bf16 v[96:99], a[32:35], a[180:183], v[96:99]
 s_waitcnt lgkmcnt(2)
 buffer_load_dwordx4 v5, s[8:11], s76 offen offset:0 lds
 v_mfma_f32_16x16x32_bf16 v[96:99], a[16:19], a[176:179], v[96:99]
 v_mfma_f32_16x16x32_bf16 v[96:99], a[0:3], a[172:175], v[96:99]
 ds_read_b64_tr_b16 a[100:101], v46 offset:4104
 v_mfma_f32_16x16x32_bf16 v[100:103], a[4:7], a[172:175], v[100:103]
 v_mfma_f32_16x16x32_bf16 v[100:103], a[20:23], a[176:179], v[100:103]
 v_mfma_f32_16x16x32_bf16 v[100:103], a[36:39], a[180:183], v[100:103]
 ds_read_b64_tr_b16 a[102:103], v46 offset:4360
 v_mfma_f32_16x16x32_bf16 v[100:103], a[52:55], a[184:187], v[100:103]
 ds_read_b128 a[200:203], v3 offset:4352
 v_mfma_f32_16x16x32_bf16 v[100:103], a[68:71], a[188:191], v[100:103]
 ds_read_b128 a[204:207], v3 offset:8704
 v_mfma_f32_16x16x32_bf16 v[84:87], a[68:71], a[184:187], v[84:87]
 s_waitcnt vmcnt(17)
 s_add_u32 m0, s29, 2048
 ds_read_b64_tr_b16 a[112:113], v46 offset:8192
 v_mfma_f32_16x16x32_bf16 v[84:87], a[52:55], a[180:183], v[84:87]
 buffer_load_dwordx4 v5, s[8:11], s77 offen offset:0 lds
 v_mfma_f32_16x16x32_bf16 v[84:87], a[36:39], a[176:179], v[84:87]
 v_mfma_f32_16x16x32_bf16 v[84:87], a[20:23], a[172:175], v[84:87]
 ds_read_b64_tr_b16 a[114:115], v46 offset:8448
 v_mfma_f32_16x16x32_bf16 v[84:87], a[4:7], a[168:171], v[84:87]
 v_mfma_f32_16x16x32_bf16 v[68:71], a[4:7], a[164:167], v[68:71]
 v_mfma_f32_16x16x32_bf16 v[68:71], a[20:23], a[168:171], v[68:71]
 ds_read_b64_tr_b16 a[116:117], v46 offset:8200
 v_mfma_f32_16x16x32_bf16 v[68:71], a[36:39], a[172:175], v[68:71]
 v_mfma_f32_16x16x32_bf16 v[68:71], a[52:55], a[176:179], v[68:71]
 ds_read_b128 a[192:195], v3 offset:13056
 v_mfma_f32_16x16x32_bf16 v[68:71], a[68:71], a[180:183], v[68:71]
 s_add_u32 m0, s29, 4096
 ds_read_b64_tr_b16 a[118:119], v46 offset:8456
 v_mfma_f32_16x16x32_bf16 v[52:55], a[68:71], a[176:179], v[52:55]
 s_waitcnt lgkmcnt(6)
 buffer_load_dwordx4 v5, s[8:11], s78 offen offset:0 lds
 v_mfma_f32_16x16x32_bf16 v[52:55], a[52:55], a[172:175], v[52:55]
 v_mfma_f32_16x16x32_bf16 v[52:55], a[36:39], a[168:171], v[52:55]
 s_waitcnt vmcnt(16)
 ds_read_b64_tr_b16 a[128:129], v46 offset:12288
 v_mfma_f32_16x16x32_bf16 v[52:55], a[20:23], a[164:167], v[52:55]
 v_mfma_f32_16x16x32_bf16 v[52:55], a[4:7], a[160:163], v[52:55]
 v_mfma_f32_16x16x32_bf16 v[56:59], a[8:11], a[160:163], v[56:59]
 ds_read_b64_tr_b16 a[130:131], v46 offset:12544
 v_mfma_f32_16x16x32_bf16 v[56:59], a[24:27], a[164:167], v[56:59]
 v_mfma_f32_16x16x32_bf16 v[56:59], a[40:43], a[168:171], v[56:59]
 v_mfma_f32_16x16x32_bf16 v[56:59], a[56:59], a[172:175], v[56:59]
 s_add_u32 m0, s29, 6144
 ds_read_b64_tr_b16 a[132:133], v46 offset:12296
 v_mfma_f32_16x16x32_bf16 v[56:59], a[72:75], a[176:179], v[56:59]
 buffer_load_dwordx4 v5, s[8:11], s79 offen offset:0 lds
 v_mfma_f32_16x16x32_bf16 v[72:75], a[72:75], a[180:183], v[72:75]
 s_add_u32 m0, s26, 1024
 v_mfma_f32_16x16x32_bf16 v[72:75], a[56:59], a[176:179], v[72:75]
 ds_read_b64_tr_b16 a[134:135], v46 offset:12552
 buffer_load_dwordx4 v8, s[4:7], 0 offen nt lds
 v_mfma_f32_16x16x32_bf16 v[72:75], a[40:43], a[172:175], v[72:75]
 v_mfma_f32_16x16x32_bf16 v[72:75], a[24:27], a[168:171], v[72:75]
 v_mfma_f32_16x16x32_bf16 v[72:75], a[8:11], a[164:167], v[72:75]
 s_waitcnt vmcnt(16)
 ds_read_b64_tr_b16 a[144:145], v46 offset:16384
 v_mfma_f32_16x16x32_bf16 v[88:91], a[8:11], a[168:171], v[88:91]
 v_mfma_f32_16x16x32_bf16 v[88:91], a[24:27], a[172:175], v[88:91]
 v_mfma_f32_16x16x32_bf16 v[88:91], a[40:43], a[176:179], v[88:91]
 s_add_u32 m0, s29, 8192
 ds_read_b64_tr_b16 a[146:147], v46 offset:16640
 v_mfma_f32_16x16x32_bf16 v[88:91], a[56:59], a[180:183], v[88:91]
 s_waitcnt lgkmcnt(4)
 buffer_load_dwordx4 v5, s[8:11], s80 offen offset:0 lds
 v_mfma_f32_16x16x32_bf16 v[88:91], a[72:75], a[184:187], v[88:91]
 v_mfma_f32_16x16x32_bf16 v[104:107], a[72:75], a[188:191], v[104:107]
 ds_read_b64_tr_b16 a[148:149], v46 offset:16392
 v_mfma_f32_16x16x32_bf16 v[104:107], a[56:59], a[184:187], v[104:107]
 v_mfma_f32_16x16x32_bf16 v[104:107], a[40:43], a[180:183], v[104:107]
 v_mfma_f32_16x16x32_bf16 v[104:107], a[24:27], a[176:179], v[104:107]
 ds_read_b64_tr_b16 a[150:151], v46 offset:16648
 v_mfma_f32_16x16x32_bf16 v[104:107], a[8:11], a[172:175], v[104:107]
 v_mfma_f32_16x16x32_bf16 v[108:111], a[12:15], a[172:175], v[108:111]
 v_mfma_f32_16x16x32_bf16 v[108:111], a[28:31], a[176:179], v[108:111]
 s_waitcnt vmcnt(15)
 s_add_u32 m0, s29, 10240
 ds_read_b64_tr_b16 a[88:89], v46 offset:1024
 v_mfma_f32_16x16x32_bf16 v[108:111], a[44:47], a[180:183], v[108:111]
 buffer_load_dwordx4 v5, s[8:11], s81 offen offset:0 lds
 v_mfma_f32_16x16x32_bf16 v[108:111], a[60:63], a[184:187], v[108:111]
 v_mfma_f32_16x16x32_bf16 v[108:111], a[76:79], a[188:191], v[108:111]
 ds_read_b64_tr_b16 a[90:91], v46 offset:1280
 v_mfma_f32_16x16x32_bf16 v[92:95], a[76:79], a[184:187], v[92:95]
 v_mfma_f32_16x16x32_bf16 v[92:95], a[60:63], a[180:183], v[92:95]
 v_mfma_f32_16x16x32_bf16 v[92:95], a[44:47], a[176:179], v[92:95]
 ds_read_b64_tr_b16 a[92:93], v46 offset:1032
 v_mfma_f32_16x16x32_bf16 v[92:95], a[28:31], a[172:175], v[92:95]
 v_mfma_f32_16x16x32_bf16 v[92:95], a[12:15], a[168:171], v[92:95]
 v_mfma_f32_16x16x32_bf16 v[76:79], a[12:15], a[164:167], v[76:79]
 s_add_u32 m0, s29, 12288
 ds_read_b64_tr_b16 a[94:95], v46 offset:1288
 v_mfma_f32_16x16x32_bf16 v[76:79], a[28:31], a[168:171], v[76:79]
 s_waitcnt lgkmcnt(4)
 buffer_load_dwordx4 v5, s[8:11], s82 offen offset:0 lds
 v_mfma_f32_16x16x32_bf16 v[76:79], a[44:47], a[172:175], v[76:79]
 v_mfma_f32_16x16x32_bf16 v[76:79], a[60:63], a[176:179], v[76:79]
 s_waitcnt vmcnt(15)
 ds_read_b64_tr_b16 a[104:105], v46 offset:5120
 v_mfma_f32_16x16x32_bf16 v[76:79], a[76:79], a[180:183], v[76:79]
 v_mfma_f32_16x16x32_bf16 v[60:63], a[76:79], a[176:179], v[60:63]
 v_mfma_f32_16x16x32_bf16 v[60:63], a[60:63], a[172:175], v[60:63]
 ds_read_b64_tr_b16 a[106:107], v46 offset:5376
 v_mfma_f32_16x16x32_bf16 v[60:63], a[44:47], a[168:171], v[60:63]
 v_mfma_f32_16x16x32_bf16 v[60:63], a[28:31], a[164:167], v[60:63]
 v_mfma_f32_16x16x32_bf16 v[60:63], a[12:15], a[160:163], v[60:63]
 ds_read_b128 a[164:167], v1 offset:2176
 ds_read_b64_tr_b16 a[108:109], v46 offset:5128
 v_mfma_f32_16x16x32_bf16 v[124:127], a[12:15], a[176:179], v[124:127]
 s_add_u32 m0, s29, 14336
 ds_read_b128 a[196:199], v1 offset:6528
 v_mfma_f32_16x16x32_bf16 v[124:127], a[28:31], a[180:183], v[124:127]
 ds_read_b128 a[172:175], v1 offset:10880
 buffer_load_dwordx4 v5, s[8:11], s83 offen offset:0 lds
 v_mfma_f32_16x16x32_bf16 v[124:127], a[44:47], a[184:187], v[124:127]
 s_add_u32 m0, s26, 2048
 ds_read_b128 a[160:163], v1 offset:15232
 ds_read_b64_tr_b16 a[110:111], v46 offset:5384
 v_mfma_f32_16x16x32_bf16 v[124:127], a[60:63], a[188:191], v[124:127]
 ds_read_b128 a[168:171], v1 offset:19584
 buffer_load_dwordx4 v9, s[4:7], 0 offen nt lds
 v_mfma_f32_16x16x32_bf16 v[124:127], a[76:79], a[200:203], v[124:127]
 v_mfma_f32_16x16x32_bf16 v[140:143], a[76:79], a[204:207], v[140:143]
 s_waitcnt vmcnt(15)
 ds_read_b64_tr_b16 a[120:121], v46 offset:9216
 v_mfma_f32_16x16x32_bf16 v[140:143], a[60:63], a[200:203], v[140:143]
 v_mfma_f32_16x16x32_bf16 v[140:143], a[44:47], a[188:191], v[140:143]
 v_mfma_f32_16x16x32_bf16 v[140:143], a[28:31], a[184:187], v[140:143]
 ds_read_b64_tr_b16 a[122:123], v46 offset:9472
 v_mfma_f32_16x16x32_bf16 v[140:143], a[12:15], a[180:183], v[140:143]
 s_add_u32 m0, s29, 16384
 v_mfma_f32_16x16x32_bf16 v[156:159], a[12:15], a[184:187], v[156:159]
 buffer_load_dwordx4 v5, s[8:11], s84 offen offset:0 lds
 v_mfma_f32_16x16x32_bf16 v[156:159], a[28:31], a[188:191], v[156:159]
 ds_read_b64_tr_b16 a[124:125], v46 offset:9224
 v_mfma_f32_16x16x32_bf16 v[156:159], a[44:47], a[200:203], v[156:159]
 v_mfma_f32_16x16x32_bf16 v[156:159], a[60:63], a[204:207], v[156:159]
 v_mfma_f32_16x16x32_bf16 v[156:159], a[76:79], a[192:195], v[156:159]
 ds_read_b64_tr_b16 a[126:127], v46 offset:9480
 v_mfma_f32_16x16x32_bf16 v[152:155], a[72:75], a[192:195], v[152:155]
 v_mfma_f32_16x16x32_bf16 v[152:155], a[56:59], a[204:207], v[152:155]
 v_mfma_f32_16x16x32_bf16 v[152:155], a[40:43], a[200:203], v[152:155]
 s_waitcnt vmcnt(14)
 ds_read_b64_tr_b16 a[136:137], v46 offset:13312
 v_mfma_f32_16x16x32_bf16 v[152:155], a[24:27], a[188:191], v[152:155]
 s_add_u32 m0, s29, 18432
 v_mfma_f32_16x16x32_bf16 v[152:155], a[8:11], a[184:187], v[152:155]
 buffer_load_dwordx4 v5, s[8:11], s85 offen offset:0 lds
 v_mfma_f32_16x16x32_bf16 v[136:139], a[8:11], a[180:183], v[136:139]
 ds_read_b64_tr_b16 a[138:139], v46 offset:13568
 v_mfma_f32_16x16x32_bf16 v[136:139], a[24:27], a[184:187], v[136:139]
 v_mfma_f32_16x16x32_bf16 v[136:139], a[40:43], a[188:191], v[136:139]
 v_mfma_f32_16x16x32_bf16 v[136:139], a[56:59], a[200:203], v[136:139]
 ds_read_b64_tr_b16 a[140:141], v46 offset:13320
 v_mfma_f32_16x16x32_bf16 v[136:139], a[72:75], a[204:207], v[136:139]
 v_mfma_f32_16x16x32_bf16 v[120:123], a[72:75], a[200:203], v[120:123]
 v_mfma_f32_16x16x32_bf16 v[120:123], a[56:59], a[188:191], v[120:123]
 ds_read_b64_tr_b16 a[142:143], v46 offset:13576
 v_mfma_f32_16x16x32_bf16 v[120:123], a[40:43], a[184:187], v[120:123]
 s_add_u32 m0, s29, 0
 v_mfma_f32_16x16x32_bf16 v[120:123], a[24:27], a[180:183], v[120:123]
 s_waitcnt lgkmcnt(4)
 buffer_load_dwordx4 v5, s[8:11], s76 offen offset:1024 lds
 v_mfma_f32_16x16x32_bf16 v[120:123], a[8:11], a[176:179], v[120:123]
 s_waitcnt vmcnt(14)
 ds_read_b64_tr_b16 a[152:153], v46 offset:17408
 v_mfma_f32_16x16x32_bf16 v[116:119], a[4:7], a[176:179], v[116:119]
 v_mfma_f32_16x16x32_bf16 v[116:119], a[20:23], a[180:183], v[116:119]
 v_mfma_f32_16x16x32_bf16 v[116:119], a[36:39], a[184:187], v[116:119]
 ds_read_b64_tr_b16 a[154:155], v46 offset:17664
 v_mfma_f32_16x16x32_bf16 v[116:119], a[52:55], a[188:191], v[116:119]
 v_mfma_f32_16x16x32_bf16 v[116:119], a[68:71], a[200:203], v[116:119]
 v_mfma_f32_16x16x32_bf16 v[132:135], a[68:71], a[204:207], v[132:135]
 ds_read_b64_tr_b16 a[156:157], v46 offset:17416
 v_mfma_f32_16x16x32_bf16 v[132:135], a[52:55], a[200:203], v[132:135]
 s_add_u32 m0, s29, 2048
 v_mfma_f32_16x16x32_bf16 v[132:135], a[36:39], a[188:191], v[132:135]
 buffer_load_dwordx4 v5, s[8:11], s77 offen offset:1024 lds
 v_mfma_f32_16x16x32_bf16 v[132:135], a[20:23], a[184:187], v[132:135]
 ds_read_b64_tr_b16 a[158:159], v46 offset:17672
 v_mfma_f32_16x16x32_bf16 v[132:135], a[4:7], a[180:183], v[132:135]
 s_add_u32 m0, s26, 3072
 v_mfma_f32_16x16x32_bf16 v[148:151], a[4:7], a[184:187], v[148:151]
 buffer_load_dwordx4 v10, s[4:7], 0 offen nt lds
 v_mfma_f32_16x16x32_bf16 v[148:151], a[20:23], a[188:191], v[148:151]
 v_mfma_f32_16x16x32_bf16 v[148:151], a[36:39], a[200:203], v[148:151]
 v_mfma_f32_16x16x32_bf16 v[148:151], a[52:55], a[204:207], v[148:151]
 v_mfma_f32_16x16x32_bf16 v[148:151], a[68:71], a[192:195], v[148:151]
 v_mfma_f32_16x16x32_bf16 v[144:147], a[64:67], a[192:195], v[144:147]
 s_add_u32 m0, s29, 4096
 ds_read_b128 a[192:195], v1 offset:23936
 v_mfma_f32_16x16x32_bf16 v[144:147], a[48:51], a[204:207], v[144:147]
 buffer_load_dwordx4 v5, s[8:11], s78 offen offset:1024 lds
 v_mfma_f32_16x16x32_bf16 v[144:147], a[32:35], a[200:203], v[144:147]
 v_mfma_f32_16x16x32_bf16 v[144:147], a[16:19], a[188:191], v[144:147]
 v_mfma_f32_16x16x32_bf16 v[144:147], a[0:3], a[184:187], v[144:147]
 v_mfma_f32_16x16x32_bf16 v[128:131], a[0:3], a[180:183], v[128:131]
 v_mfma_f32_16x16x32_bf16 v[128:131], a[16:19], a[184:187], v[128:131]
 v_mfma_f32_16x16x32_bf16 v[128:131], a[32:35], a[188:191], v[128:131]
 v_mfma_f32_16x16x32_bf16 v[128:131], a[48:51], a[200:203], v[128:131]
 v_mfma_f32_16x16x32_bf16 v[128:131], a[64:67], a[204:207], v[128:131]
 s_add_u32 m0, s29, 6144
 ds_read_b128 a[204:207], v1 offset:28288
 v_mfma_f32_16x16x32_bf16 v[112:115], a[64:67], a[200:203], v[112:115]
 ds_read_b128 a[200:203], v3 offset:2176
 buffer_load_dwordx4 v5, s[8:11], s79 offen offset:1024 lds
 v_mfma_f32_16x16x32_bf16 v[112:115], a[48:51], a[188:191], v[112:115]
 v_mfma_f32_16x16x32_bf16 v[112:115], a[32:35], a[184:187], v[112:115]
 v_mfma_f32_16x16x32_bf16 v[112:115], a[16:19], a[180:183], v[112:115]
 v_mfma_f32_16x16x32_bf16 v[112:115], a[0:3], a[176:179], v[112:115]
 v_mfma_f32_16x16x32_bf16 v[176:179], a[0:3], a[164:167], v[176:179]
 v_mfma_f32_16x16x32_bf16 v[176:179], a[16:19], a[196:199], v[176:179]
 v_mfma_f32_16x16x32_bf16 v[176:179], a[32:35], a[172:175], v[176:179]
 v_mfma_f32_16x16x32_bf16 v[176:179], a[48:51], a[160:163], v[176:179]
 v_mfma_f32_16x16x32_bf16 v[176:179], a[64:67], a[168:171], v[176:179]
 s_waitcnt lgkmcnt(2)
 s_add_u32 m0, s29, 8192
 v_mfma_f32_16x16x32_bf16 v[192:195], a[64:67], a[192:195], v[192:195]
 buffer_load_dwordx4 v5, s[8:11], s80 offen offset:1024 lds
 v_mfma_f32_16x16x32_bf16 v[192:195], a[48:51], a[168:171], v[192:195]
 v_mfma_f32_16x16x32_bf16 v[192:195], a[32:35], a[160:163], v[192:195]
 v_mfma_f32_16x16x32_bf16 v[192:195], a[16:19], a[172:175], v[192:195]
 v_mfma_f32_16x16x32_bf16 v[192:195], a[0:3], a[196:199], v[192:195]
 v_mfma_f32_16x16x32_bf16 v[208:211], a[0:3], a[172:175], v[208:211]
 v_mfma_f32_16x16x32_bf16 v[208:211], a[16:19], a[160:163], v[208:211]
 v_mfma_f32_16x16x32_bf16 v[208:211], a[32:35], a[168:171], v[208:211]
 v_mfma_f32_16x16x32_bf16 v[208:211], a[48:51], a[192:195], v[208:211]
 s_waitcnt lgkmcnt(0)
 s_add_u32 m0, s29, 10240
 v_mfma_f32_16x16x32_bf16 v[208:211], a[64:67], a[204:207], v[208:211]
 buffer_load_dwordx4 v5, s[8:11], s81 offen offset:1024 lds
 v_mfma_f32_16x16x32_bf16 v[224:227], a[64:67], a[200:203], v[224:227]
 v_mfma_f32_16x16x32_bf16 v[224:227], a[48:51], a[204:207], v[224:227]
 s_add_u32 m0, s26, 4096
 v_mfma_f32_16x16x32_bf16 v[224:227], a[32:35], a[192:195], v[224:227]
 buffer_load_dwordx4 v11, s[4:7], 0 offen nt lds
 v_mfma_f32_16x16x32_bf16 v[224:227], a[16:19], a[168:171], v[224:227]
 v_mfma_f32_16x16x32_bf16 v[224:227], a[0:3], a[160:163], v[224:227]
 v_mfma_f32_16x16x32_bf16 v[228:231], a[4:7], a[160:163], v[228:231]
 v_mfma_f32_16x16x32_bf16 v[228:231], a[20:23], a[168:171], v[228:231]
 v_mfma_f32_16x16x32_bf16 v[228:231], a[36:39], a[192:195], v[228:231]
 s_add_u32 m0, s29, 12288
 v_mfma_f32_16x16x32_bf16 v[228:231], a[52:55], a[204:207], v[228:231]
 ds_read_b128 a[188:191], v3 offset:6528
 buffer_load_dwordx4 v5, s[8:11], s82 offen offset:1024 lds
 v_mfma_f32_16x16x32_bf16 v[228:231], a[68:71], a[200:203], v[228:231]
 ds_read_b128 a[184:187], v3 offset:10880
 v_mfma_f32_16x16x32_bf16 v[212:215], a[68:71], a[204:207], v[212:215]
 v_mfma_f32_16x16x32_bf16 v[212:215], a[52:55], a[192:195], v[212:215]
 v_mfma_f32_16x16x32_bf16 v[212:215], a[36:39], a[168:171], v[212:215]
 v_mfma_f32_16x16x32_bf16 v[212:215], a[20:23], a[160:163], v[212:215]
 v_mfma_f32_16x16x32_bf16 v[212:215], a[4:7], a[172:175], v[212:215]
 v_mfma_f32_16x16x32_bf16 v[196:199], a[4:7], a[196:199], v[196:199]
 v_mfma_f32_16x16x32_bf16 v[196:199], a[20:23], a[172:175], v[196:199]
 s_add_u32 m0, s29, 14336
 v_mfma_f32_16x16x32_bf16 v[196:199], a[36:39], a[160:163], v[196:199]
 buffer_load_dwordx4 v5, s[8:11], s83 offen offset:1024 lds
 v_mfma_f32_16x16x32_bf16 v[196:199], a[52:55], a[168:171], v[196:199]
 ds_read_b128 a[176:179], v3 offset:15232
 v_mfma_f32_16x16x32_bf16 v[196:199], a[68:71], a[192:195], v[196:199]
 v_mfma_f32_16x16x32_bf16 v[180:183], a[68:71], a[168:171], v[180:183]
 v_mfma_f32_16x16x32_bf16 v[180:183], a[52:55], a[160:163], v[180:183]
 v_mfma_f32_16x16x32_bf16 v[180:183], a[36:39], a[172:175], v[180:183]
 v_mfma_f32_16x16x32_bf16 v[180:183], a[20:23], a[196:199], v[180:183]
 v_mfma_f32_16x16x32_bf16 v[180:183], a[4:7], a[164:167], v[180:183]
 v_mfma_f32_16x16x32_bf16 v[184:187], a[8:11], a[164:167], v[184:187]
 s_add_u32 m0, s29, 16384
 v_mfma_f32_16x16x32_bf16 v[184:187], a[24:27], a[196:199], v[184:187]
 buffer_load_dwordx4 v5, s[8:11], s84 offen offset:1024 lds
 v_mfma_f32_16x16x32_bf16 v[184:187], a[40:43], a[172:175], v[184:187]
 v_mfma_f32_16x16x32_bf16 v[184:187], a[56:59], a[160:163], v[184:187]
 v_mfma_f32_16x16x32_bf16 v[184:187], a[72:75], a[168:171], v[184:187]
 v_mfma_f32_16x16x32_bf16 v[200:203], a[72:75], a[192:195], v[200:203]
 v_mfma_f32_16x16x32_bf16 v[200:203], a[56:59], a[168:171], v[200:203]
 v_mfma_f32_16x16x32_bf16 v[200:203], a[40:43], a[160:163], v[200:203]
 v_mfma_f32_16x16x32_bf16 v[200:203], a[24:27], a[172:175], v[200:203]
 v_mfma_f32_16x16x32_bf16 v[200:203], a[8:11], a[196:199], v[200:203]
 s_add_u32 m0, s29, 18432
 v_mfma_f32_16x16x32_bf16 v[216:219], a[8:11], a[172:175], v[216:219]
 buffer_load_dwordx4 v5, s[8:11], s85 offen offset:1024 lds
 v_mfma_f32_16x16x32_bf16 v[216:219], a[24:27], a[160:163], v[216:219]
 s_add_u32 s8, s8, 0x10000
 s_addc_u32 s9, s9, 0
 v_mfma_f32_16x16x32_bf16 v[216:219], a[40:43], a[168:171], v[216:219]
 v_mfma_f32_16x16x32_bf16 v[216:219], a[56:59], a[192:195], v[216:219]
 s_add_u32 m0, s26, 5120
 v_mfma_f32_16x16x32_bf16 v[216:219], a[72:75], a[204:207], v[216:219]
 buffer_load_dwordx4 v12, s[4:7], 0 offen nt lds
 v_mfma_f32_16x16x32_bf16 v[232:235], a[72:75], a[200:203], v[232:235]
 v_mfma_f32_16x16x32_bf16 v[232:235], a[56:59], a[204:207], v[232:235]
 v_mfma_f32_16x16x32_bf16 v[232:235], a[40:43], a[192:195], v[232:235]
 v_mfma_f32_16x16x32_bf16 v[232:235], a[24:27], a[168:171], v[232:235]
 v_mfma_f32_16x16x32_bf16 v[232:235], a[8:11], a[160:163], v[232:235]
 v_mfma_f32_16x16x32_bf16 v[236:239], a[12:15], a[160:163], v[236:239]
 v_mfma_f32_16x16x32_bf16 v[236:239], a[28:31], a[168:171], v[236:239]
 v_mfma_f32_16x16x32_bf16 v[236:239], a[44:47], a[192:195], v[236:239]
 v_mfma_f32_16x16x32_bf16 v[236:239], a[60:63], a[204:207], v[236:239]
 v_mfma_f32_16x16x32_bf16 v[236:239], a[76:79], a[200:203], v[236:239]
 v_mfma_f32_16x16x32_bf16 v[220:223], a[76:79], a[204:207], v[220:223]
 v_mfma_f32_16x16x32_bf16 v[220:223], a[60:63], a[192:195], v[220:223]
 v_mfma_f32_16x16x32_bf16 v[220:223], a[44:47], a[168:171], v[220:223]
 v_mfma_f32_16x16x32_bf16 v[220:223], a[28:31], a[160:163], v[220:223]
 v_mfma_f32_16x16x32_bf16 v[220:223], a[12:15], a[172:175], v[220:223]
 v_mfma_f32_16x16x32_bf16 v[204:207], a[12:15], a[196:199], v[204:207]
 v_mfma_f32_16x16x32_bf16 v[204:207], a[28:31], a[172:175], v[204:207]
 v_mfma_f32_16x16x32_bf16 v[204:207], a[44:47], a[160:163], v[204:207]
 v_mfma_f32_16x16x32_bf16 v[204:207], a[60:63], a[168:171], v[204:207]
 v_mfma_f32_16x16x32_bf16 v[204:207], a[76:79], a[192:195], v[204:207]
 v_mfma_f32_16x16x32_bf16 v[188:191], a[76:79], a[168:171], v[188:191]
 v_mfma_f32_16x16x32_bf16 v[188:191], a[60:63], a[160:163], v[188:191]
 v_mfma_f32_16x16x32_bf16 v[188:191], a[44:47], a[172:175], v[188:191]
 v_mfma_f32_16x16x32_bf16 v[188:191], a[28:31], a[196:199], v[188:191]
 v_mfma_f32_16x16x32_bf16 v[188:191], a[12:15], a[164:167], v[188:191]
 ds_read_b128 a[180:183], v2 offset:0
 v_mfma_f32_16x16x32_bf16 v[252:255], a[12:15], a[168:171], v[252:255]
 ds_read_b128 a[196:199], v2 offset:4352
 v_mfma_f32_16x16x32_bf16 v[252:255], a[28:31], a[192:195], v[252:255]
 ds_read_b128 a[160:163], v2 offset:8704
 v_mfma_f32_16x16x32_bf16 v[252:255], a[44:47], a[204:207], v[252:255]
 ds_read_b128 a[172:175], v2 offset:13056
 v_mfma_f32_16x16x32_bf16 v[252:255], a[60:63], a[200:203], v[252:255]
 s_waitcnt lgkmcnt(4)
 ds_read_b128 a[164:167], v2 offset:17408
 v_mfma_f32_16x16x32_bf16 v[252:255], a[76:79], a[188:191], v[252:255]
 v_mfma_f32_16x16x32_bf16 a[220:223], a[76:79], a[184:187], a[220:223]
 v_mfma_f32_16x16x32_bf16 a[220:223], a[60:63], a[188:191], a[220:223]
 v_mfma_f32_16x16x32_bf16 a[220:223], a[44:47], a[200:203], a[220:223]
 v_mfma_f32_16x16x32_bf16 a[220:223], a[28:31], a[204:207], a[220:223]
 v_mfma_f32_16x16x32_bf16 a[220:223], a[12:15], a[192:195], a[220:223]
 v_mfma_f32_16x16x32_bf16 a[236:239], a[12:15], a[204:207], a[236:239]
 s_add_u32 m0, s26, 6144
 v_mfma_f32_16x16x32_bf16 a[236:239], a[28:31], a[200:203], a[236:239]
 buffer_load_dwordx4 v13, s[4:7], 0 offen nt lds
 v_mfma_f32_16x16x32_bf16 a[236:239], a[44:47], a[188:191], a[236:239]
 v_mfma_f32_16x16x32_bf16 a[236:239], a[60:63], a[184:187], a[236:239]
 v_mfma_f32_16x16x32_bf16 a[236:239], a[76:79], a[176:179], a[236:239]
 v_mfma_f32_16x16x32_bf16 a[232:235], a[72:75], a[176:179], a[232:235]
 v_mfma_f32_16x16x32_bf16 a[232:235], a[56:59], a[184:187], a[232:235]
 v_mfma_f32_16x16x32_bf16 a[232:235], a[40:43], a[188:191], a[232:235]
 v_mfma_f32_16x16x32_bf16 a[232:235], a[24:27], a[200:203], a[232:235]
 v_mfma_f32_16x16x32_bf16 a[232:235], a[8:11], a[204:207], a[232:235]
 v_mfma_f32_16x16x32_bf16 a[216:219], a[8:11], a[192:195], a[216:219]
 v_mfma_f32_16x16x32_bf16 a[216:219], a[24:27], a[204:207], a[216:219]
 v_mfma_f32_16x16x32_bf16 a[216:219], a[40:43], a[200:203], a[216:219]
 v_mfma_f32_16x16x32_bf16 a[216:219], a[56:59], a[188:191], a[216:219]
 v_mfma_f32_16x16x32_bf16 a[216:219], a[72:75], a[184:187], a[216:219]
 v_mfma_f32_16x16x32_bf16 v[248:251], a[72:75], a[188:191], v[248:251]
 v_mfma_f32_16x16x32_bf16 v[248:251], a[56:59], a[200:203], v[248:251]
 v_mfma_f32_16x16x32_bf16 v[248:251], a[40:43], a[204:207], v[248:251]
 v_mfma_f32_16x16x32_bf16 v[248:251], a[24:27], a[192:195], v[248:251]
 v_mfma_f32_16x16x32_bf16 v[248:251], a[8:11], a[168:171], v[248:251]
 v_mfma_f32_16x16x32_bf16 v[244:247], a[4:7], a[168:171], v[244:247]
 v_mfma_f32_16x16x32_bf16 v[244:247], a[20:23], a[192:195], v[244:247]
 v_mfma_f32_16x16x32_bf16 v[244:247], a[36:39], a[204:207], v[244:247]
 v_mfma_f32_16x16x32_bf16 v[244:247], a[52:55], a[200:203], v[244:247]
 v_mfma_f32_16x16x32_bf16 v[244:247], a[68:71], a[188:191], v[244:247]
 v_mfma_f32_16x16x32_bf16 a[212:215], a[68:71], a[184:187], a[212:215]
 v_mfma_f32_16x16x32_bf16 a[212:215], a[52:55], a[188:191], a[212:215]
 v_mfma_f32_16x16x32_bf16 a[212:215], a[36:39], a[200:203], a[212:215]
 v_mfma_f32_16x16x32_bf16 a[212:215], a[20:23], a[204:207], a[212:215]
 v_mfma_f32_16x16x32_bf16 a[212:215], a[4:7], a[192:195], a[212:215]
 v_mfma_f32_16x16x32_bf16 a[228:231], a[4:7], a[204:207], a[228:231]
 v_mfma_f32_16x16x32_bf16 a[228:231], a[20:23], a[200:203], a[228:231]
 v_mfma_f32_16x16x32_bf16 a[228:231], a[36:39], a[188:191], a[228:231]
 v_mfma_f32_16x16x32_bf16 a[228:231], a[52:55], a[184:187], a[228:231]
 v_mfma_f32_16x16x32_bf16 a[228:231], a[68:71], a[176:179], a[228:231]
 v_mfma_f32_16x16x32_bf16 a[224:227], a[64:67], a[176:179], a[224:227]
 ds_read_b128 a[176:179], v2 offset:21760
 v_mfma_f32_16x16x32_bf16 a[224:227], a[48:51], a[184:187], a[224:227]
 v_mfma_f32_16x16x32_bf16 a[224:227], a[32:35], a[188:191], a[224:227]
 s_add_u32 m0, s26, 7168
 v_mfma_f32_16x16x32_bf16 a[224:227], a[16:19], a[200:203], a[224:227]
 buffer_load_dwordx4 v14, s[4:7], 0 offen nt lds
 v_mfma_f32_16x16x32_bf16 a[224:227], a[0:3], a[204:207], a[224:227]
 s_add_u32 s4, s4, 128
 s_addc_u32 s5, s5, 0
 s_xor_b32 s26, s26, 0x10000
 v_mfma_f32_16x16x32_bf16 a[208:211], a[0:3], a[192:195], a[208:211]
 s_xor_b32 s27, s27, s31
 global_load_dword v44, v47, s[88:89]
 v_mfma_f32_16x16x32_bf16 a[208:211], a[16:19], a[204:207], a[208:211]
 v_mfma_f32_16x16x32_bf16 a[208:211], a[32:35], a[200:203], a[208:211]
 v_mfma_f32_16x16x32_bf16 a[208:211], a[48:51], a[188:191], a[208:211]
 v_mfma_f32_16x16x32_bf16 a[208:211], a[64:67], a[184:187], a[208:211]
 ds_read_b128 a[184:187], v2 offset:26112
 v_mfma_f32_16x16x32_bf16 v[240:243], a[64:67], a[188:191], v[240:243]
 ds_read_b128 a[188:191], v4 offset:0
 v_mfma_f32_16x16x32_bf16 v[240:243], a[48:51], a[200:203], v[240:243]
 v_mfma_f32_16x16x32_bf16 v[240:243], a[32:35], a[204:207], v[240:243]
 v_mfma_f32_16x16x32_bf16 v[240:243], a[16:19], a[192:195], v[240:243]
 v_mfma_f32_16x16x32_bf16 v[240:243], a[0:3], a[168:171], v[240:243]
 s_waitcnt vmcnt(8) lgkmcnt(2)
 ds_read_b64_tr_b16 a[0:1], v46 offset:0
 v_mfma_f32_16x16x32_bf16 v[48:51], a[80:83], a[180:183], v[48:51]
 v_mfma_f32_16x16x32_bf16 v[48:51], a[96:99], a[196:199], v[48:51]
 v_mfma_f32_16x16x32_bf16 v[48:51], a[112:115], a[160:163], v[48:51]
 ds_read_b64_tr_b16 a[2:3], v46 offset:256
 v_mfma_f32_16x16x32_bf16 v[48:51], a[128:131], a[172:175], v[48:51]
 v_mfma_f32_16x16x32_bf16 v[48:51], a[144:147], a[164:167], v[48:51]
 v_mfma_f32_16x16x32_bf16 v[64:67], a[144:147], a[176:179], v[64:67]
 ds_read_b64_tr_b16 a[4:5], v46 offset:8
 v_mfma_f32_16x16x32_bf16 v[64:67], a[128:131], a[164:167], v[64:67]
 v_mfma_f32_16x16x32_bf16 v[64:67], a[112:115], a[172:175], v[64:67]
 v_mfma_f32_16x16x32_bf16 v[64:67], a[96:99], a[160:163], v[64:67]
 ds_read_b64_tr_b16 a[6:7], v46 offset:264
 v_mfma_f32_16x16x32_bf16 v[64:67], a[80:83], a[196:199], v[64:67]
 v_mfma_f32_16x16x32_bf16 v[80:83], a[80:83], a[160:163], v[80:83]
 v_mfma_f32_16x16x32_bf16 v[80:83], a[96:99], a[172:175], v[80:83]
 ds_read_b64_tr_b16 a[16:17], v46 offset:4096
 v_mfma_f32_16x16x32_bf16 v[80:83], a[112:115], a[164:167], v[80:83]
 v_mfma_f32_16x16x32_bf16 v[80:83], a[128:131], a[176:179], v[80:83]
 s_waitcnt lgkmcnt(4)
 v_mfma_f32_16x16x32_bf16 v[80:83], a[144:147], a[184:187], v[80:83]
 s_add_u32 m0, s29, 0
 ds_read_b64_tr_b16 a[18:19], v46 offset:4352
 v_mfma_f32_16x16x32_bf16 v[96:99], a[144:147], a[188:191], v[96:99]
 s_waitcnt lgkmcnt(2)
 buffer_load_dwordx4 v5, s[8:11], s76 offen offset:0 lds
 v_mfma_f32_16x16x32_bf16 v[96:99], a[128:131], a[184:187], v[96:99]
 v_mfma_f32_16x16x32_bf16 v[96:99], a[112:115], a[176:179], v[96:99]
 ds_read_b64_tr_b16 a[20:21], v46 offset:4104
 v_mfma_f32_16x16x32_bf16 v[96:99], a[96:99], a[164:167], v[96:99]
 v_mfma_f32_16x16x32_bf16 v[96:99], a[80:83], a[172:175], v[96:99]
 v_mfma_f32_16x16x32_bf16 v[100:103], a[84:87], a[172:175], v[100:103]
 ds_read_b64_tr_b16 a[22:23], v46 offset:4360
 v_mfma_f32_16x16x32_bf16 v[100:103], a[100:103], a[164:167], v[100:103]
 v_mfma_f32_16x16x32_bf16 v[100:103], a[116:119], a[176:179], v[100:103]
 v_mfma_f32_16x16x32_bf16 v[100:103], a[132:135], a[184:187], v[100:103]
 ds_read_b128 a[200:203], v4 offset:4352
 ds_read_b64_tr_b16 a[32:33], v46 offset:8192
 v_mfma_f32_16x16x32_bf16 v[100:103], a[148:151], a[188:191], v[100:103]
 ds_read_b128 a[204:207], v4 offset:8704
 v_mfma_f32_16x16x32_bf16 v[84:87], a[148:151], a[184:187], v[84:87]
 v_mfma_f32_16x16x32_bf16 v[84:87], a[132:135], a[176:179], v[84:87]
 s_add_u32 m0, s29, 2048
 ds_read_b64_tr_b16 a[34:35], v46 offset:8448
 v_mfma_f32_16x16x32_bf16 v[84:87], a[116:119], a[164:167], v[84:87]
 buffer_load_dwordx4 v5, s[8:11], s77 offen offset:0 lds
 v_mfma_f32_16x16x32_bf16 v[84:87], a[100:103], a[172:175], v[84:87]
 v_mfma_f32_16x16x32_bf16 v[84:87], a[84:87], a[160:163], v[84:87]
 ds_read_b64_tr_b16 a[36:37], v46 offset:8200
 v_mfma_f32_16x16x32_bf16 v[68:71], a[84:87], a[196:199], v[68:71]
 v_mfma_f32_16x16x32_bf16 v[68:71], a[100:103], a[160:163], v[68:71]
 v_mfma_f32_16x16x32_bf16 v[68:71], a[116:119], a[172:175], v[68:71]
 ds_read_b64_tr_b16 a[38:39], v46 offset:8456
 v_mfma_f32_16x16x32_bf16 v[68:71], a[132:135], a[164:167], v[68:71]
 ds_read_b128 a[192:195], v4 offset:13056
 v_mfma_f32_16x16x32_bf16 v[68:71], a[148:151], a[176:179], v[68:71]
 v_mfma_f32_16x16x32_bf16 v[52:55], a[148:151], a[164:167], v[52:55]
 ds_read_b64_tr_b16 a[48:49], v46 offset:12288
 v_mfma_f32_16x16x32_bf16 v[52:55], a[132:135], a[172:175], v[52:55]
 v_mfma_f32_16x16x32_bf16 v[52:55], a[116:119], a[160:163], v[52:55]
 v_mfma_f32_16x16x32_bf16 v[52:55], a[100:103], a[196:199], v[52:55]
 s_add_u32 m0, s29, 4096
 ds_read_b64_tr_b16 a[50:51], v46 offset:12544
 v_mfma_f32_16x16x32_bf16 v[52:55], a[84:87], a[180:183], v[52:55]
 s_waitcnt lgkmcnt(5)
 buffer_load_dwordx4 v5, s[8:11], s78 offen offset:0 lds
 v_mfma_f32_16x16x32_bf16 v[56:59], a[88:91], a[180:183], v[56:59]
 v_mfma_f32_16x16x32_bf16 v[56:59], a[104:107], a[196:199], v[56:59]
 ds_read_b64_tr_b16 a[52:53], v46 offset:12296
 v_mfma_f32_16x16x32_bf16 v[56:59], a[120:123], a[160:163], v[56:59]
 v_mfma_f32_16x16x32_bf16 v[56:59], a[136:139], a[172:175], v[56:59]
 v_mfma_f32_16x16x32_bf16 v[56:59], a[152:155], a[164:167], v[56:59]
 ds_read_b64_tr_b16 a[54:55], v46 offset:12552
 v_mfma_f32_16x16x32_bf16 v[72:75], a[152:155], a[176:179], v[72:75]
 v_mfma_f32_16x16x32_bf16 v[72:75], a[136:139], a[164:167], v[72:75]
 v_mfma_f32_16x16x32_bf16 v[72:75], a[120:123], a[172:175], v[72:75]
 ds_read_b64_tr_b16 a[64:65], v46 offset:16384
 v_mfma_f32_16x16x32_bf16 v[72:75], a[104:107], a[160:163], v[72:75]
 v_mfma_f32_16x16x32_bf16 v[72:75], a[88:91], a[196:199], v[72:75]
 v_mfma_f32_16x16x32_bf16 v[88:91], a[88:91], a[160:163], v[88:91]
 s_add_u32 m0, s29, 6144
 ds_read_b64_tr_b16 a[66:67], v46 offset:16640
 v_mfma_f32_16x16x32_bf16 v[88:91], a[104:107], a[172:175], v[88:91]
 buffer_load_dwordx4 v5, s[8:11], s79 offen offset:0 lds
 v_mfma_f32_16x16x32_bf16 v[88:91], a[120:123], a[164:167], v[88:91]
 v_mfma_f32_16x16x32_bf16 v[88:91], a[136:139], a[176:179], v[88:91]
 ds_read_b64_tr_b16 a[68:69], v46 offset:16392
 v_mfma_f32_16x16x32_bf16 v[88:91], a[152:155], a[184:187], v[88:91]
 v_mfma_f32_16x16x32_bf16 v[104:107], a[152:155], a[188:191], v[104:107]
 v_mfma_f32_16x16x32_bf16 v[104:107], a[136:139], a[184:187], v[104:107]
 ds_read_b64_tr_b16 a[70:71], v46 offset:16648
 v_mfma_f32_16x16x32_bf16 v[104:107], a[120:123], a[176:179], v[104:107]
 v_mfma_f32_16x16x32_bf16 v[104:107], a[104:107], a[164:167], v[104:107]
 v_mfma_f32_16x16x32_bf16 v[104:107], a[88:91], a[172:175], v[104:107]
 ds_read_b64_tr_b16 a[8:9], v46 offset:1024
 v_mfma_f32_16x16x32_bf16 v[108:111], a[92:95], a[172:175], v[108:111]
 v_mfma_f32_16x16x32_bf16 v[108:111], a[108:111], a[164:167], v[108:111]
 v_mfma_f32_16x16x32_bf16 v[108:111], a[124:127], a[176:179], v[108:111]
 s_add_u32 m0, s29, 8192
 ds_read_b64_tr_b16 a[10:11], v46 offset:1280
 v_mfma_f32_16x16x32_bf16 v[108:111], a[140:143], a[184:187], v[108:111]
 s_waitcnt lgkmcnt(4)
 buffer_load_dwordx4 v5, s[8:11], s80 offen offset:0 lds
 v_mfma_f32_16x16x32_bf16 v[108:111], a[156:159], a[188:191], v[108:111]
 v_mfma_f32_16x16x32_bf16 v[92:95], a[156:159], a[184:187], v[92:95]
 ds_read_b64_tr_b16 a[12:13], v46 offset:1032
 v_mfma_f32_16x16x32_bf16 v[92:95], a[140:143], a[176:179], v[92:95]
 v_mfma_f32_16x16x32_bf16 v[92:95], a[124:127], a[164:167], v[92:95]
 v_mfma_f32_16x16x32_bf16 v[92:95], a[108:111], a[172:175], v[92:95]
 ds_read_b64_tr_b16 a[14:15], v46 offset:1288
 v_mfma_f32_16x16x32_bf16 v[92:95], a[92:95], a[160:163], v[92:95]
 v_mfma_f32_16x16x32_bf16 v[76:79], a[92:95], a[196:199], v[76:79]
 v_mfma_f32_16x16x32_bf16 v[76:79], a[108:111], a[160:163], v[76:79]
 ds_read_b64_tr_b16 a[24:25], v46 offset:5120
 v_mfma_f32_16x16x32_bf16 v[76:79], a[124:127], a[172:175], v[76:79]
 v_mfma_f32_16x16x32_bf16 v[76:79], a[140:143], a[164:167], v[76:79]
 v_mfma_f32_16x16x32_bf16 v[76:79], a[156:159], a[176:179], v[76:79]
 s_add_u32 m0, s29, 10240
 ds_read_b64_tr_b16 a[26:27], v46 offset:5376
 v_mfma_f32_16x16x32_bf16 v[60:63], a[156:159], a[164:167], v[60:63]
 buffer_load_dwordx4 v5, s[8:11], s81 offen offset:0 lds
 v_mfma_f32_16x16x32_bf16 v[60:63], a[140:143], a[172:175], v[60:63]
 v_mfma_f32_16x16x32_bf16 v[60:63], a[124:127], a[160:163], v[60:63]
 ds_read_b64_tr_b16 a[28:29], v46 offset:5128
 v_mfma_f32_16x16x32_bf16 v[60:63], a[108:111], a[196:199], v[60:63]
 v_mfma_f32_16x16x32_bf16 v[60:63], a[92:95], a[180:183], v[60:63]
 ds_read_b128 a[180:183], v2 offset:2176
 v_mfma_f32_16x16x32_bf16 v[124:127], a[92:95], a[164:167], v[124:127]
 ds_read_b128 a[168:171], v2 offset:6528
 ds_read_b64_tr_b16 a[30:31], v46 offset:5384
 v_mfma_f32_16x16x32_bf16 v[124:127], a[108:111], a[176:179], v[124:127]
 ds_read_b128 a[172:175], v2 offset:10880
 v_mfma_f32_16x16x32_bf16 v[124:127], a[124:127], a[184:187], v[124:127]
 ds_read_b128 a[160:163], v2 offset:15232
 v_mfma_f32_16x16x32_bf16 v[124:127], a[140:143], a[188:191], v[124:127]
 ds_read_b128 a[196:199], v2 offset:19584
 ds_read_b64_tr_b16 a[40:41], v46 offset:9216
 v_mfma_f32_16x16x32_bf16 v[124:127], a[156:159], a[200:203], v[124:127]
 v_mfma_f32_16x16x32_bf16 v[140:143], a[156:159], a[204:207], v[140:143]
 v_mfma_f32_16x16x32_bf16 v[140:143], a[140:143], a[200:203], v[140:143]
 s_add_u32 m0, s29, 12288
 ds_read_b64_tr_b16 a[42:43], v46 offset:9472
 v_mfma_f32_16x16x32_bf16 v[140:143], a[124:127], a[188:191], v[140:143]
 buffer_load_dwordx4 v5, s[8:11], s82 offen offset:0 lds
 v_mfma_f32_16x16x32_bf16 v[140:143], a[108:111], a[184:187], v[140:143]
 v_mfma_f32_16x16x32_bf16 v[140:143], a[92:95], a[176:179], v[140:143]
 ds_read_b64_tr_b16 a[44:45], v46 offset:9224
 v_mfma_f32_16x16x32_bf16 v[156:159], a[92:95], a[184:187], v[156:159]
 v_mfma_f32_16x16x32_bf16 v[156:159], a[108:111], a[188:191], v[156:159]
 v_mfma_f32_16x16x32_bf16 v[156:159], a[124:127], a[200:203], v[156:159]
 ds_read_b64_tr_b16 a[46:47], v46 offset:9480
 v_mfma_f32_16x16x32_bf16 v[156:159], a[140:143], a[204:207], v[156:159]
 v_mfma_f32_16x16x32_bf16 v[156:159], a[156:159], a[192:195], v[156:159]
 v_mfma_f32_16x16x32_bf16 v[152:155], a[152:155], a[192:195], v[152:155]
 s_waitcnt vmcnt(9)
 ds_read_b64_tr_b16 a[56:57], v46 offset:13312
 v_mfma_f32_16x16x32_bf16 v[152:155], a[136:139], a[204:207], v[152:155]
 v_mfma_f32_16x16x32_bf16 v[152:155], a[120:123], a[200:203], v[152:155]
 v_mfma_f32_16x16x32_bf16 v[152:155], a[104:107], a[188:191], v[152:155]
 s_add_u32 m0, s29, 14336
 ds_read_b64_tr_b16 a[58:59], v46 offset:13568
 v_mfma_f32_16x16x32_bf16 v[152:155], a[88:91], a[184:187], v[152:155]
 buffer_load_dwordx4 v5, s[8:11], s83 offen offset:0 lds
 v_mfma_f32_16x16x32_bf16 v[136:139], a[88:91], a[176:179], v[136:139]
 v_mfma_f32_16x16x32_bf16 v[136:139], a[104:107], a[184:187], v[136:139]
 ds_read_b64_tr_b16 a[60:61], v46 offset:13320
 v_mfma_f32_16x16x32_bf16 v[136:139], a[120:123], a[188:191], v[136:139]
 v_mfma_f32_16x16x32_bf16 v[136:139], a[136:139], a[200:203], v[136:139]
 v_mfma_f32_16x16x32_bf16 v[136:139], a[152:155], a[204:207], v[136:139]
 ds_read_b64_tr_b16 a[62:63], v46 offset:13576
 v_mfma_f32_16x16x32_bf16 v[120:123], a[152:155], a[200:203], v[120:123]
 v_mfma_f32_16x16x32_bf16 v[120:123], a[136:139], a[188:191], v[120:123]
 v_mfma_f32_16x16x32_bf16 v[120:123], a[120:123], a[184:187], v[120:123]
 ds_read_b64_tr_b16 a[72:73], v46 offset:17408
 v_mfma_f32_16x16x32_bf16 v[120:123], a[104:107], a[176:179], v[120:123]
 v_mfma_f32_16x16x32_bf16 v[120:123], a[88:91], a[164:167], v[120:123]
 v_mfma_f32_16x16x32_bf16 v[116:119], a[84:87], a[164:167], v[116:119]
 s_add_u32 m0, s29, 16384
 ds_read_b64_tr_b16 a[74:75], v46 offset:17664
 v_mfma_f32_16x16x32_bf16 v[116:119], a[100:103], a[176:179], v[116:119]
 s_waitcnt lgkmcnt(4)
 buffer_load_dwordx4 v5, s[8:11], s84 offen offset:0 lds
 v_mfma_f32_16x16x32_bf16 v[116:119], a[116:119], a[184:187], v[116:119]
 v_mfma_f32_16x16x32_bf16 v[116:119], a[132:135], a[188:191], v[116:119]
 ds_read_b64_tr_b16 a[76:77], v46 offset:17416
 v_mfma_f32_16x16x32_bf16 v[116:119], a[148:151], a[200:203], v[116:119]
 v_mfma_f32_16x16x32_bf16 v[132:135], a[148:151], a[204:207], v[132:135]
 v_mfma_f32_16x16x32_bf16 v[132:135], a[132:135], a[200:203], v[132:135]
 ds_read_b64_tr_b16 a[78:79], v46 offset:17672
 v_mfma_f32_16x16x32_bf16 v[132:135], a[116:119], a[188:191], v[132:135]
 v_mfma_f32_16x16x32_bf16 v[132:135], a[100:103], a[184:187], v[132:135]
 v_mfma_f32_16x16x32_bf16 v[132:135], a[84:87], a[176:179], v[132:135]
 v_mfma_f32_16x16x32_bf16 v[148:151], a[84:87], a[184:187], v[148:151]
 v_mfma_f32_16x16x32_bf16 v[148:151], a[100:103], a[188:191], v[148:151]
 v_mfma_f32_16x16x32_bf16 v[148:151], a[116:119], a[200:203], v[148:151]
 s_add_u32 m0, s29, 18432
 v_mfma_f32_16x16x32_bf16 v[148:151], a[132:135], a[204:207], v[148:151]
 buffer_load_dwordx4 v5, s[8:11], s85 offen offset:0 lds
 v_mfma_f32_16x16x32_bf16 v[148:151], a[148:151], a[192:195], v[148:151]
 v_mfma_f32_16x16x32_bf16 v[144:147], a[144:147], a[192:195], v[144:147]
 ds_read_b128 a[192:195], v2 offset:23936
 v_mfma_f32_16x16x32_bf16 v[144:147], a[128:131], a[204:207], v[144:147]
 v_mfma_f32_16x16x32_bf16 v[144:147], a[112:115], a[200:203], v[144:147]
 v_mfma_f32_16x16x32_bf16 v[144:147], a[96:99], a[188:191], v[144:147]
 v_mfma_f32_16x16x32_bf16 v[144:147], a[80:83], a[184:187], v[144:147]
 v_mfma_f32_16x16x32_bf16 v[128:131], a[80:83], a[176:179], v[128:131]
 v_mfma_f32_16x16x32_bf16 v[128:131], a[96:99], a[184:187], v[128:131]
 v_mfma_f32_16x16x32_bf16 v[128:131], a[112:115], a[188:191], v[128:131]
 v_mfma_f32_16x16x32_bf16 v[128:131], a[128:131], a[200:203], v[128:131]
 v_mfma_f32_16x16x32_bf16 v[128:131], a[144:147], a[204:207], v[128:131]
 s_add_u32 m0, s29, 0
 ds_read_b128 a[204:207], v2 offset:28288
 v_mfma_f32_16x16x32_bf16 v[112:115], a[144:147], a[200:203], v[112:115]
 ds_read_b128 a[200:203], v4 offset:2176
 buffer_load_dwordx4 v5, s[8:11], s76 offen offset:1024 lds
 v_mfma_f32_16x16x32_bf16 v[112:115], a[128:131], a[188:191], v[112:115]
 v_mfma_f32_16x16x32_bf16 v[112:115], a[112:115], a[184:187], v[112:115]
 v_mfma_f32_16x16x32_bf16 v[112:115], a[96:99], a[176:179], v[112:115]
 v_mfma_f32_16x16x32_bf16 v[112:115], a[80:83], a[164:167], v[112:115]
 v_mfma_f32_16x16x32_bf16 v[176:179], a[80:83], a[180:183], v[176:179]
 v_mfma_f32_16x16x32_bf16 v[176:179], a[96:99], a[168:171], v[176:179]
 v_mfma_f32_16x16x32_bf16 v[176:179], a[112:115], a[172:175], v[176:179]
 v_mfma_f32_16x16x32_bf16 v[176:179], a[128:131], a[160:163], v[176:179]
 v_mfma_f32_16x16x32_bf16 v[176:179], a[144:147], a[196:199], v[176:179]
 s_waitcnt lgkmcnt(2)
 v_mfma_f32_16x16x32_bf16 v[192:195], a[144:147], a[192:195], v[192:195]
 v_mfma_f32_16x16x32_bf16 v[192:195], a[128:131], a[196:199], v[192:195]
 s_add_u32 m0, s29, 2048
 v_mfma_f32_16x16x32_bf16 v[192:195], a[112:115], a[160:163], v[192:195]
 buffer_load_dwordx4 v5, s[8:11], s77 offen offset:1024 lds
 v_mfma_f32_16x16x32_bf16 v[192:195], a[96:99], a[172:175], v[192:195]
 v_mfma_f32_16x16x32_bf16 v[192:195], a[80:83], a[168:171], v[192:195]
 v_mfma_f32_16x16x32_bf16 v[208:211], a[80:83], a[172:175], v[208:211]
 v_mfma_f32_16x16x32_bf16 v[208:211], a[96:99], a[160:163], v[208:211]
 v_mfma_f32_16x16x32_bf16 v[208:211], a[112:115], a[196:199], v[208:211]
 v_mfma_f32_16x16x32_bf16 v[208:211], a[128:131], a[192:195], v[208:211]
 s_waitcnt lgkmcnt(0)
 v_mfma_f32_16x16x32_bf16 v[208:211], a[144:147], a[204:207], v[208:211]
 v_mfma_f32_16x16x32_bf16 v[224:227], a[144:147], a[200:203], v[224:227]
 v_mfma_f32_16x16x32_bf16 v[224:227], a[128:131], a[204:207], v[224:227]
 v_mfma_f32_16x16x32_bf16 v[224:227], a[112:115], a[192:195], v[224:227]
 v_mfma_f32_16x16x32_bf16 v[224:227], a[96:99], a[196:199], v[224:227]
 s_add_u32 m0, s29, 4096
 v_mfma_f32_16x16x32_bf16 v[224:227], a[80:83], a[160:163], v[224:227]
 buffer_load_dwordx4 v5, s[8:11], s78 offen offset:1024 lds
 v_mfma_f32_16x16x32_bf16 v[228:231], a[84:87], a[160:163], v[228:231]
 v_mfma_f32_16x16x32_bf16 v[228:231], a[100:103], a[196:199], v[228:231]
 v_mfma_f32_16x16x32_bf16 v[228:231], a[116:119], a[192:195], v[228:231]
 v_mfma_f32_16x16x32_bf16 v[228:231], a[132:135], a[204:207], v[228:231]
 ds_read_b128 a[188:191], v4 offset:6528
 v_mfma_f32_16x16x32_bf16 v[228:231], a[148:151], a[200:203], v[228:231]
 ds_read_b128 a[184:187], v4 offset:10880
 v_mfma_f32_16x16x32_bf16 v[212:215], a[148:151], a[204:207], v[212:215]
 v_mfma_f32_16x16x32_bf16 v[212:215], a[132:135], a[192:195], v[212:215]
 v_mfma_f32_16x16x32_bf16 v[212:215], a[116:119], a[196:199], v[212:215]
 v_mfma_f32_16x16x32_bf16 v[212:215], a[100:103], a[160:163], v[212:215]
 v_mfma_f32_16x16x32_bf16 v[212:215], a[84:87], a[172:175], v[212:215]
 v_mfma_f32_16x16x32_bf16 v[196:199], a[84:87], a[168:171], v[196:199]
 s_add_u32 m0, s29, 6144
 v_mfma_f32_16x16x32_bf16 v[196:199], a[100:103], a[172:175], v[196:199]
 buffer_load_dwordx4 v5, s[8:11], s79 offen offset:1024 lds
 v_mfma_f32_16x16x32_bf16 v[196:199], a[116:119], a[160:163], v[196:199]
 v_mfma_f32_16x16x32_bf16 v[196:199], a[132:135], a[196:199], v[196:199]
 ds_read_b128 a[176:179], v4 offset:15232
 v_mfma_f32_16x16x32_bf16 v[196:199], a[148:151], a[192:195], v[196:199]
 v_mfma_f32_16x16x32_bf16 v[180:183], a[148:151], a[196:199], v[180:183]
 v_mfma_f32_16x16x32_bf16 v[180:183], a[132:135], a[160:163], v[180:183]
 v_mfma_f32_16x16x32_bf16 v[180:183], a[116:119], a[172:175], v[180:183]
 v_mfma_f32_16x16x32_bf16 v[180:183], a[100:103], a[168:171], v[180:183]
 v_mfma_f32_16x16x32_bf16 v[180:183], a[84:87], a[180:183], v[180:183]
 v_mfma_f32_16x16x32_bf16 v[184:187], a[88:91], a[180:183], v[184:187]
 v_mfma_f32_16x16x32_bf16 v[184:187], a[104:107], a[168:171], v[184:187]
 v_mfma_f32_16x16x32_bf16 v[184:187], a[120:123], a[172:175], v[184:187]
 s_add_u32 m0, s29, 8192
 v_mfma_f32_16x16x32_bf16 v[184:187], a[136:139], a[160:163], v[184:187]
 buffer_load_dwordx4 v5, s[8:11], s80 offen offset:1024 lds
 v_mfma_f32_16x16x32_bf16 v[184:187], a[152:155], a[196:199], v[184:187]
 v_mfma_f32_16x16x32_bf16 v[200:203], a[152:155], a[192:195], v[200:203]
 v_mfma_f32_16x16x32_bf16 v[200:203], a[136:139], a[196:199], v[200:203]
 v_mfma_f32_16x16x32_bf16 v[200:203], a[120:123], a[160:163], v[200:203]
 v_mfma_f32_16x16x32_bf16 v[200:203], a[104:107], a[172:175], v[200:203]
 v_mfma_f32_16x16x32_bf16 v[200:203], a[88:91], a[168:171], v[200:203]
 v_mfma_f32_16x16x32_bf16 v[216:219], a[88:91], a[172:175], v[216:219]
 v_mfma_f32_16x16x32_bf16 v[216:219], a[104:107], a[160:163], v[216:219]
 v_mfma_f32_16x16x32_bf16 v[216:219], a[120:123], a[196:199], v[216:219]
 v_mfma_f32_16x16x32_bf16 v[216:219], a[136:139], a[192:195], v[216:219]
 v_mfma_f32_16x16x32_bf16 v[216:219], a[152:155], a[204:207], v[216:219]
 s_add_u32 m0, s29, 10240
 v_mfma_f32_16x16x32_bf16 v[232:235], a[152:155], a[200:203], v[232:235]
 buffer_load_dwordx4 v5, s[8:11], s81 offen offset:1024 lds
 v_mfma_f32_16x16x32_bf16 v[232:235], a[136:139], a[204:207], v[232:235]
 v_mfma_f32_16x16x32_bf16 v[232:235], a[120:123], a[192:195], v[232:235]
 v_mfma_f32_16x16x32_bf16 v[232:235], a[104:107], a[196:199], v[232:235]
 v_mfma_f32_16x16x32_bf16 v[232:235], a[88:91], a[160:163], v[232:235]
 v_mfma_f32_16x16x32_bf16 v[236:239], a[92:95], a[160:163], v[236:239]
 v_mfma_f32_16x16x32_bf16 v[236:239], a[108:111], a[196:199], v[236:239]
 v_mfma_f32_16x16x32_bf16 v[236:239], a[124:127], a[192:195], v[236:239]
 v_mfma_f32_16x16x32_bf16 v[236:239], a[140:143], a[204:207], v[236:239]
 v_mfma_f32_16x16x32_bf16 v[236:239], a[156:159], a[200:203], v[236:239]
 v_mfma_f32_16x16x32_bf16 v[220:223], a[156:159], a[204:207], v[220:223]
 v_mfma_f32_16x16x32_bf16 v[220:223], a[140:143], a[192:195], v[220:223]
 s_add_u32 m0, s29, 12288
 v_mfma_f32_16x16x32_bf16 v[220:223], a[124:127], a[196:199], v[220:223]
 buffer_load_dwordx4 v5, s[8:11], s82 offen offset:1024 lds
 v_mfma_f32_16x16x32_bf16 v[220:223], a[108:111], a[160:163], v[220:223]
 v_mfma_f32_16x16x32_bf16 v[220:223], a[92:95], a[172:175], v[220:223]
 v_mfma_f32_16x16x32_bf16 v[204:207], a[92:95], a[168:171], v[204:207]
 v_mfma_f32_16x16x32_bf16 v[204:207], a[108:111], a[172:175], v[204:207]
 v_mfma_f32_16x16x32_bf16 v[204:207], a[124:127], a[160:163], v[204:207]
 v_mfma_f32_16x16x32_bf16 v[204:207], a[140:143], a[196:199], v[204:207]
 v_mfma_f32_16x16x32_bf16 v[204:207], a[156:159], a[192:195], v[204:207]
 v_mfma_f32_16x16x32_bf16 v[188:191], a[156:159], a[196:199], v[188:191]
 v_mfma_f32_16x16x32_bf16 v[188:191], a[140:143], a[160:163], v[188:191]
 s_waitcnt vmcnt(10) lgkmcnt(0)
 s_barrier
 v_mfma_f32_16x16x32_bf16 v[188:191], a[124:127], a[172:175], v[188:191]
 v_xor_b32 v1, 0x10000, v1
 v_xor_b32 v2, 0x10000, v2
 v_mfma_f32_16x16x32_bf16 v[188:191], a[108:111], a[168:171], v[188:191]
 v_xor_b32 v3, 0x10000, v3
 v_xor_b32 v4, 0x10000, v4
 v_mfma_f32_16x16x32_bf16 v[188:191], a[92:95], a[180:183], v[188:191]
 ds_read_b128 a[160:163], v1 offset:0
 ds_read_b128 a[164:167], v1 offset:4352
 v_mfma_f32_16x16x32_bf16 v[252:255], a[92:95], a[196:199], v[252:255]
 s_add_u32 m0, s29, 14336
 ds_read_b128 a[168:171], v1 offset:8704
 ds_read_b128 a[172:175], v1 offset:13056
 v_mfma_f32_16x16x32_bf16 v[252:255], a[108:111], a[192:195], v[252:255]
 buffer_load_dwordx4 v5, s[8:11], s83 offen offset:1024 lds
 v_mfma_f32_16x16x32_bf16 v[252:255], a[124:127], a[204:207], v[252:255]
 v_mfma_f32_16x16x32_bf16 v[252:255], a[140:143], a[200:203], v[252:255]
 v_mfma_f32_16x16x32_bf16 v[252:255], a[156:159], a[188:191], v[252:255]
 v_mfma_f32_16x16x32_bf16 a[220:223], a[156:159], a[184:187], a[220:223]
 v_mfma_f32_16x16x32_bf16 a[220:223], a[140:143], a[188:191], a[220:223]
 v_mfma_f32_16x16x32_bf16 a[220:223], a[124:127], a[200:203], a[220:223]
 v_mfma_f32_16x16x32_bf16 a[220:223], a[108:111], a[204:207], a[220:223]
 v_mfma_f32_16x16x32_bf16 a[220:223], a[92:95], a[192:195], a[220:223]
 v_mfma_f32_16x16x32_bf16 a[236:239], a[92:95], a[204:207], a[236:239]
 s_add_u32 m0, s29, 16384
 v_mfma_f32_16x16x32_bf16 a[236:239], a[108:111], a[200:203], a[236:239]
 buffer_load_dwordx4 v5, s[8:11], s84 offen offset:1024 lds
 v_mfma_f32_16x16x32_bf16 a[236:239], a[124:127], a[188:191], a[236:239]
 v_mfma_f32_16x16x32_bf16 a[236:239], a[140:143], a[184:187], a[236:239]
 v_mfma_f32_16x16x32_bf16 a[236:239], a[156:159], a[176:179], a[236:239]
 v_mfma_f32_16x16x32_bf16 a[232:235], a[152:155], a[176:179], a[232:235]
 v_mfma_f32_16x16x32_bf16 a[232:235], a[136:139], a[184:187], a[232:235]
 v_mfma_f32_16x16x32_bf16 a[232:235], a[120:123], a[188:191], a[232:235]
 v_mfma_f32_16x16x32_bf16 a[232:235], a[104:107], a[200:203], a[232:235]
 v_mfma_f32_16x16x32_bf16 a[232:235], a[88:91], a[204:207], a[232:235]
 v_mfma_f32_16x16x32_bf16 a[216:219], a[88:91], a[192:195], a[216:219]
 v_mfma_f32_16x16x32_bf16 a[216:219], a[104:107], a[204:207], a[216:219]
 v_mfma_f32_16x16x32_bf16 a[216:219], a[120:123], a[200:203], a[216:219]
 s_add_u32 m0, s29, 18432
 v_mfma_f32_16x16x32_bf16 a[216:219], a[136:139], a[188:191], a[216:219]
 buffer_load_dwordx4 v5, s[8:11], s85 offen offset:1024 lds
 v_mfma_f32_16x16x32_bf16 a[216:219], a[152:155], a[184:187], a[216:219]
 s_add_u32 s8, s8, 0x10000
 s_addc_u32 s9, s9, 0
 v_mfma_f32_16x16x32_bf16 v[248:251], a[152:155], a[188:191], v[248:251]
 v_mfma_f32_16x16x32_bf16 v[248:251], a[136:139], a[200:203], v[248:251]
 v_mfma_f32_16x16x32_bf16 v[248:251], a[120:123], a[204:207], v[248:251]
 v_mfma_f32_16x16x32_bf16 v[248:251], a[104:107], a[192:195], v[248:251]
 v_mfma_f32_16x16x32_bf16 v[248:251], a[88:91], a[196:199], v[248:251]
 v_mfma_f32_16x16x32_bf16 v[244:247], a[84:87], a[196:199], v[244:247]
 v_mfma_f32_16x16x32_bf16 v[244:247], a[100:103], a[192:195], v[244:247]
 v_mfma_f32_16x16x32_bf16 v[244:247], a[116:119], a[204:207], v[244:247]
 v_mfma_f32_16x16x32_bf16 v[244:247], a[132:135], a[200:203], v[244:247]
 v_mfma_f32_16x16x32_bf16 v[244:247], a[148:151], a[188:191], v[244:247]
 v_mfma_f32_16x16x32_bf16 a[212:215], a[148:151], a[184:187], a[212:215]
 v_mfma_f32_16x16x32_bf16 a[212:215], a[132:135], a[188:191], a[212:215]
 v_mfma_f32_16x16x32_bf16 a[212:215], a[116:119], a[200:203], a[212:215]
 v_mfma_f32_16x16x32_bf16 a[212:215], a[100:103], a[204:207], a[212:215]
 v_mfma_f32_16x16x32_bf16 a[212:215], a[84:87], a[192:195], a[212:215]
 v_mfma_f32_16x16x32_bf16 a[228:231], a[84:87], a[204:207], a[228:231]
 v_mfma_f32_16x16x32_bf16 a[228:231], a[100:103], a[200:203], a[228:231]
 v_mfma_f32_16x16x32_bf16 a[228:231], a[116:119], a[188:191], a[228:231]
 v_mfma_f32_16x16x32_bf16 a[228:231], a[132:135], a[184:187], a[228:231]
 v_mfma_f32_16x16x32_bf16 a[228:231], a[148:151], a[176:179], a[228:231]
 v_mfma_f32_16x16x32_bf16 a[224:227], a[144:147], a[176:179], a[224:227]
 ds_read_b128 a[176:179], v1 offset:17408
 ds_read_b128 a[180:183], v1 offset:21760
 v_mfma_f32_16x16x32_bf16 a[224:227], a[128:131], a[184:187], a[224:227]
 v_mfma_f32_16x16x32_bf16 a[224:227], a[112:115], a[188:191], a[224:227]
 v_mfma_f32_16x16x32_bf16 a[224:227], a[96:99], a[200:203], a[224:227]
 v_mfma_f32_16x16x32_bf16 a[224:227], a[80:83], a[204:207], a[224:227]
 v_mfma_f32_16x16x32_bf16 a[208:211], a[80:83], a[192:195], a[208:211]
 v_mfma_f32_16x16x32_bf16 a[208:211], a[96:99], a[204:207], a[208:211]
 v_mfma_f32_16x16x32_bf16 a[208:211], a[112:115], a[200:203], a[208:211]
 v_mfma_f32_16x16x32_bf16 a[208:211], a[128:131], a[188:191], a[208:211]
 v_mfma_f32_16x16x32_bf16 a[208:211], a[144:147], a[184:187], a[208:211]
 v_mfma_f32_16x16x32_bf16 v[240:243], a[144:147], a[188:191], v[240:243]
 v_mfma_f32_16x16x32_bf16 v[240:243], a[128:131], a[200:203], v[240:243]
 v_mfma_f32_16x16x32_bf16 v[240:243], a[112:115], a[204:207], v[240:243]
 v_mfma_f32_16x16x32_bf16 v[240:243], a[96:99], a[192:195], v[240:243]
 v_mfma_f32_16x16x32_bf16 v[240:243], a[80:83], a[196:199], v[240:243]
 s_sub_u32 s30, s30, 1
 s_cmp_lg_u32 s30, 0
 s_cbranch_scc1 L_mid14
L_f14:
 s_waitcnt lgkmcnt(5)
 ds_read_b128 a[184:187], v1 offset:26112
 v_mfma_f32_16x16x32_bf16 v[48:51], a[0:3], a[160:163], v[48:51]
 s_waitcnt lgkmcnt(5)
 v_mfma_f32_16x16x32_bf16 v[48:51], a[16:19], a[164:167], v[48:51]
 s_waitcnt lgkmcnt(4)
 ds_read_b64_tr_b16 a[80:81], v46 offset:0
 v_mfma_f32_16x16x32_bf16 v[48:51], a[32:35], a[168:171], v[48:51]
 s_waitcnt lgkmcnt(4)
 ds_read_b64_tr_b16 a[82:83], v46 offset:256
 v_mfma_f32_16x16x32_bf16 v[48:51], a[48:51], a[172:175], v[48:51]
 s_waitcnt lgkmcnt(4)
 ds_read_b128 a[188:191], v3 offset:0
 ds_read_b64_tr_b16 a[84:85], v46 offset:8
 v_mfma_f32_16x16x32_bf16 v[48:51], a[64:67], a[176:179], v[48:51]
 ds_read_b64_tr_b16 a[86:87], v46 offset:264
 v_mfma_f32_16x16x32_bf16 v[52:55], a[68:71], a[176:179], v[52:55]
 ds_read_b64_tr_b16 a[96:97], v46 offset:4096
 v_mfma_f32_16x16x32_bf16 v[52:55], a[52:55], a[172:175], v[52:55]
 ds_read_b64_tr_b16 a[98:99], v46 offset:4352
 v_mfma_f32_16x16x32_bf16 v[52:55], a[36:39], a[168:171], v[52:55]
 ds_read_b64_tr_b16 a[100:101], v46 offset:4104
 v_mfma_f32_16x16x32_bf16 v[52:55], a[20:23], a[164:167], v[52:55]
 ds_read_b64_tr_b16 a[102:103], v46 offset:4360
 v_mfma_f32_16x16x32_bf16 v[52:55], a[4:7], a[160:163], v[52:55]
 ds_read_b64_tr_b16 a[112:113], v46 offset:8192
 v_mfma_f32_16x16x32_bf16 v[56:59], a[8:11], a[160:163], v[56:59]
 ds_read_b64_tr_b16 a[114:115], v46 offset:8448
 v_mfma_f32_16x16x32_bf16 v[56:59], a[24:27], a[164:167], v[56:59]
 ds_read_b64_tr_b16 a[116:117], v46 offset:8200
 v_mfma_f32_16x16x32_bf16 v[56:59], a[40:43], a[168:171], v[56:59]
 ds_read_b64_tr_b16 a[118:119], v46 offset:8456
 v_mfma_f32_16x16x32_bf16 v[56:59], a[56:59], a[172:175], v[56:59]
 s_waitcnt vmcnt(12)
 ds_read_b64_tr_b16 a[128:129], v46 offset:12288
 v_mfma_f32_16x16x32_bf16 v[56:59], a[72:75], a[176:179], v[56:59]
 ds_read_b64_tr_b16 a[130:131], v46 offset:12544
 v_mfma_f32_16x16x32_bf16 v[60:63], a[76:79], a[176:179], v[60:63]
 ds_read_b64_tr_b16 a[132:133], v46 offset:12296
 v_mfma_f32_16x16x32_bf16 v[60:63], a[60:63], a[172:175], v[60:63]
 ds_read_b64_tr_b16 a[134:135], v46 offset:12552
 v_mfma_f32_16x16x32_bf16 v[60:63], a[44:47], a[168:171], v[60:63]
 s_waitcnt vmcnt(10)
 ds_read_b64_tr_b16 a[144:145], v46 offset:16384
 v_mfma_f32_16x16x32_bf16 v[60:63], a[28:31], a[164:167], v[60:63]
 ds_read_b64_tr_b16 a[146:147], v46 offset:16640
 v_mfma_f32_16x16x32_bf16 v[60:63], a[12:15], a[160:163], v[60:63]
 ds_read_b128 a[192:195], v2 offset:0
 ds_read_b64_tr_b16 a[148:149], v46 offset:16392
 v_mfma_f32_16x16x32_bf16 v[76:79], a[12:15], a[164:167], v[76:79]
 ds_read_b128 a[196:199], v2 offset:4352
 ds_read_b64_tr_b16 a[150:151], v46 offset:16648
 v_mfma_f32_16x16x32_bf16 v[76:79], a[28:31], a[168:171], v[76:79]
 s_waitcnt vmcnt(8)
 ds_read_b128 a[200:203], v2 offset:8704
 ds_read_b64_tr_b16 a[88:89], v46 offset:1024
 v_mfma_f32_16x16x32_bf16 v[76:79], a[44:47], a[172:175], v[76:79]
 ds_read_b128 a[204:207], v2 offset:13056
 ds_read_b64_tr_b16 a[90:91], v46 offset:1280
 v_mfma_f32_16x16x32_bf16 v[76:79], a[60:63], a[176:179], v[76:79]
 s_waitcnt lgkmcnt(15)
 ds_read_b128 a[160:163], v2 offset:17408
 ds_read_b64_tr_b16 a[92:93], v46 offset:1032
 v_mfma_f32_16x16x32_bf16 v[76:79], a[76:79], a[180:183], v[76:79]
 ds_read_b64_tr_b16 a[94:95], v46 offset:1288
 v_mfma_f32_16x16x32_bf16 v[72:75], a[72:75], a[180:183], v[72:75]
 s_waitcnt vmcnt(6)
 ds_read_b64_tr_b16 a[104:105], v46 offset:5120
 v_mfma_f32_16x16x32_bf16 v[72:75], a[56:59], a[176:179], v[72:75]
 ds_read_b64_tr_b16 a[106:107], v46 offset:5376
 v_mfma_f32_16x16x32_bf16 v[72:75], a[40:43], a[172:175], v[72:75]
 ds_read_b64_tr_b16 a[108:109], v46 offset:5128
 v_mfma_f32_16x16x32_bf16 v[72:75], a[24:27], a[168:171], v[72:75]
 ds_read_b64_tr_b16 a[110:111], v46 offset:5384
 v_mfma_f32_16x16x32_bf16 v[72:75], a[8:11], a[164:167], v[72:75]
 s_waitcnt vmcnt(4)
 ds_read_b64_tr_b16 a[120:121], v46 offset:9216
 v_mfma_f32_16x16x32_bf16 v[68:71], a[4:7], a[164:167], v[68:71]
 ds_read_b64_tr_b16 a[122:123], v46 offset:9472
 v_mfma_f32_16x16x32_bf16 v[68:71], a[20:23], a[168:171], v[68:71]
 ds_read_b64_tr_b16 a[124:125], v46 offset:9224
 v_mfma_f32_16x16x32_bf16 v[68:71], a[36:39], a[172:175], v[68:71]
 ds_read_b64_tr_b16 a[126:127], v46 offset:9480
 v_mfma_f32_16x16x32_bf16 v[68:71], a[52:55], a[176:179], v[68:71]
 s_waitcnt vmcnt(2)
 ds_read_b64_tr_b16 a[136:137], v46 offset:13312
 v_mfma_f32_16x16x32_bf16 v[68:71], a[68:71], a[180:183], v[68:71]
 ds_read_b64_tr_b16 a[138:139], v46 offset:13568
 v_mfma_f32_16x16x32_bf16 v[64:67], a[64:67], a[180:183], v[64:67]
 ds_read_b64_tr_b16 a[140:141], v46 offset:13320
 v_mfma_f32_16x16x32_bf16 v[64:67], a[48:51], a[176:179], v[64:67]
 ds_read_b64_tr_b16 a[142:143], v46 offset:13576
 v_mfma_f32_16x16x32_bf16 v[64:67], a[32:35], a[172:175], v[64:67]
 s_waitcnt vmcnt(0)
 ds_read_b64_tr_b16 a[152:153], v46 offset:17408
 v_mfma_f32_16x16x32_bf16 v[64:67], a[16:19], a[168:171], v[64:67]
 ds_read_b64_tr_b16 a[154:155], v46 offset:17664
 v_mfma_f32_16x16x32_bf16 v[64:67], a[0:3], a[164:167], v[64:67]
 ds_read_b64_tr_b16 a[156:157], v46 offset:17416
 v_mfma_f32_16x16x32_bf16 v[80:83], a[0:3], a[168:171], v[80:83]
 ds_read_b64_tr_b16 a[158:159], v46 offset:17672
 v_mfma_f32_16x16x32_bf16 v[80:83], a[16:19], a[172:175], v[80:83]
 v_mfma_f32_16x16x32_bf16 v[80:83], a[32:35], a[176:179], v[80:83]
 v_mfma_f32_16x16x32_bf16 v[80:83], a[48:51], a[180:183], v[80:83]
 ds_read_b128 a[164:167], v2 offset:21760
 v_mfma_f32_16x16x32_bf16 v[80:83], a[64:67], a[184:187], v[80:83]
 v_mfma_f32_16x16x32_bf16 v[84:87], a[68:71], a[184:187], v[84:87]
 v_mfma_f32_16x16x32_bf16 v[84:87], a[52:55], a[180:183], v[84:87]
 v_mfma_f32_16x16x32_bf16 v[84:87], a[36:39], a[176:179], v[84:87]
 v_mfma_f32_16x16x32_bf16 v[84:87], a[20:23], a[172:175], v[84:87]
 v_mfma_f32_16x16x32_bf16 v[84:87], a[4:7], a[168:171], v[84:87]
 v_mfma_f32_16x16x32_bf16 v[88:91], a[8:11], a[168:171], v[88:91]
 v_mfma_f32_16x16x32_bf16 v[88:91], a[24:27], a[172:175], v[88:91]
 v_mfma_f32_16x16x32_bf16 v[88:91], a[40:43], a[176:179], v[88:91]
 v_mfma_f32_16x16x32_bf16 v[88:91], a[56:59], a[180:183], v[88:91]
 v_mfma_f32_16x16x32_bf16 v[88:91], a[72:75], a[184:187], v[88:91]
 v_mfma_f32_16x16x32_bf16 v[92:95], a[76:79], a[184:187], v[92:95]
 v_mfma_f32_16x16x32_bf16 v[92:95], a[60:63], a[180:183], v[92:95]
 v_mfma_f32_16x16x32_bf16 v[92:95], a[44:47], a[176:179], v[92:95]
 v_mfma_f32_16x16x32_bf16 v[92:95], a[28:31], a[172:175], v[92:95]
 v_mfma_f32_16x16x32_bf16 v[92:95], a[12:15], a[168:171], v[92:95]
 v_mfma_f32_16x16x32_bf16 v[108:111], a[12:15], a[172:175], v[108:111]
 v_mfma_f32_16x16x32_bf16 v[108:111], a[28:31], a[176:179], v[108:111]
 v_mfma_f32_16x16x32_bf16 v[108:111], a[44:47], a[180:183], v[108:111]
 v_mfma_f32_16x16x32_bf16 v[108:111], a[60:63], a[184:187], v[108:111]
 ds_read_b128 a[168:171], v2 offset:26112
 v_mfma_f32_16x16x32_bf16 v[108:111], a[76:79], a[188:191], v[108:111]
 v_mfma_f32_16x16x32_bf16 v[104:107], a[72:75], a[188:191], v[104:107]
 v_mfma_f32_16x16x32_bf16 v[104:107], a[56:59], a[184:187], v[104:107]
 v_mfma_f32_16x16x32_bf16 v[104:107], a[40:43], a[180:183], v[104:107]
 v_mfma_f32_16x16x32_bf16 v[104:107], a[24:27], a[176:179], v[104:107]
 v_mfma_f32_16x16x32_bf16 v[104:107], a[8:11], a[172:175], v[104:107]
 v_mfma_f32_16x16x32_bf16 v[100:103], a[4:7], a[172:175], v[100:103]
 v_mfma_f32_16x16x32_bf16 v[100:103], a[20:23], a[176:179], v[100:103]
 v_mfma_f32_16x16x32_bf16 v[100:103], a[36:39], a[180:183], v[100:103]
 v_mfma_f32_16x16x32_bf16 v[100:103], a[52:55], a[184:187], v[100:103]
 v_mfma_f32_16x16x32_bf16 v[100:103], a[68:71], a[188:191], v[100:103]
 v_mfma_f32_16x16x32_bf16 v[96:99], a[64:67], a[188:191], v[96:99]
 v_mfma_f32_16x16x32_bf16 v[96:99], a[48:51], a[184:187], v[96:99]
 v_mfma_f32_16x16x32_bf16 v[96:99], a[32:35], a[180:183], v[96:99]
 v_mfma_f32_16x16x32_bf16 v[96:99], a[16:19], a[176:179], v[96:99]
 v_mfma_f32_16x16x32_bf16 v[96:99], a[0:3], a[172:175], v[96:99]
 s_waitcnt lgkmcnt(0)
 v_mfma_f32_16x16x32_bf16 v[48:51], a[80:83], a[192:195], v[48:51]
 v_mfma_f32_16x16x32_bf16 v[48:51], a[96:99], a[196:199], v[48:51]
 v_mfma_f32_16x16x32_bf16 v[48:51], a[112:115], a[200:203], v[48:51]
 v_mfma_f32_16x16x32_bf16 v[48:51], a[128:131], a[204:207], v[48:51]
 ds_read_b128 a[188:191], v4 offset:0
 v_mfma_f32_16x16x32_bf16 v[48:51], a[144:147], a[160:163], v[48:51]
 v_mfma_f32_16x16x32_bf16 v[52:55], a[148:151], a[160:163], v[52:55]
 v_mfma_f32_16x16x32_bf16 v[52:55], a[132:135], a[204:207], v[52:55]
 v_mfma_f32_16x16x32_bf16 v[52:55], a[116:119], a[200:203], v[52:55]
 v_mfma_f32_16x16x32_bf16 v[52:55], a[100:103], a[196:199], v[52:55]
 v_mfma_f32_16x16x32_bf16 v[52:55], a[84:87], a[192:195], v[52:55]
 v_mfma_f32_16x16x32_bf16 v[56:59], a[88:91], a[192:195], v[56:59]
 v_mfma_f32_16x16x32_bf16 v[56:59], a[104:107], a[196:199], v[56:59]
 v_mfma_f32_16x16x32_bf16 v[56:59], a[120:123], a[200:203], v[56:59]
 v_mfma_f32_16x16x32_bf16 v[56:59], a[136:139], a[204:207], v[56:59]
 v_mfma_f32_16x16x32_bf16 v[56:59], a[152:155], a[160:163], v[56:59]
 v_mfma_f32_16x16x32_bf16 v[60:63], a[156:159], a[160:163], v[60:63]
 v_mfma_f32_16x16x32_bf16 v[60:63], a[140:143], a[204:207], v[60:63]
 v_mfma_f32_16x16x32_bf16 v[60:63], a[124:127], a[200:203], v[60:63]
 v_mfma_f32_16x16x32_bf16 v[60:63], a[108:111], a[196:199], v[60:63]
 v_mfma_f32_16x16x32_bf16 v[60:63], a[92:95], a[192:195], v[60:63]
 ds_read_b128 a[184:187], v1 offset:17408
 v_mfma_f32_16x16x32_bf16 v[76:79], a[92:95], a[196:199], v[76:79]
 ds_read_b128 a[180:183], v1 offset:21760
 v_mfma_f32_16x16x32_bf16 v[76:79], a[108:111], a[200:203], v[76:79]
 ds_read_b128 a[176:179], v1 offset:26112
 v_mfma_f32_16x16x32_bf16 v[76:79], a[124:127], a[204:207], v[76:79]
 ds_read_b128 a[172:175], v3 offset:0
 v_mfma_f32_16x16x32_bf16 v[76:79], a[140:143], a[160:163], v[76:79]
 ds_read_b128 a[192:195], v3 offset:4352
 v_mfma_f32_16x16x32_bf16 v[76:79], a[156:159], a[164:167], v[76:79]
 v_mfma_f32_16x16x32_bf16 v[72:75], a[152:155], a[164:167], v[72:75]
 v_mfma_f32_16x16x32_bf16 v[72:75], a[136:139], a[160:163], v[72:75]
 v_mfma_f32_16x16x32_bf16 v[72:75], a[120:123], a[204:207], v[72:75]
 v_mul_f32 v20, s42, v48
 v_mul_f32 v21, s42, v49
 v_mfma_f32_16x16x32_bf16 v[72:75], a[104:107], a[200:203], v[72:75]
 v_mul_f32 v22, s42, v50
 v_mul_f32 v23, s42, v51
 v_mfma_f32_16x16x32_bf16 v[72:75], a[88:91], a[196:199], v[72:75]
 v_min_f32 v20, s47, v20
 v_min_f32 v21, s47, v21
 v_mfma_f32_16x16x32_bf16 v[68:71], a[84:87], a[196:199], v[68:71]
 v_min_f32 v22, s47, v22
 v_min_f32 v23, s47, v23
 v_mfma_f32_16x16x32_bf16 v[68:71], a[100:103], a[200:203], v[68:71]
 v_exp_f32 v20, v20
 v_mul_f32 v24, s43, v56
 v_mfma_f32_16x16x32_bf16 v[68:71], a[116:119], a[204:207], v[68:71]
 v_mul_f32 v25, s43, v57
 v_mul_f32 v26, s43, v58
 v_mfma_f32_16x16x32_bf16 v[68:71], a[132:135], a[160:163], v[68:71]
 v_exp_f32 v21, v21
 v_mfma_f32_16x16x32_bf16 v[68:71], a[148:151], a[164:167], v[68:71]
 v_mul_f32 v27, s43, v59
 v_add_f32 v28, 1.0, v20
 v_mfma_f32_16x16x32_bf16 v[64:67], a[144:147], a[164:167], v[64:67]
 v_exp_f32 v22, v22
 v_mfma_f32_16x16x32_bf16 v[64:67], a[128:131], a[160:163], v[64:67]
 v_exp_f32 v23, v23
 v_mfma_f32_16x16x32_bf16 v[64:67], a[112:115], a[204:207], v[64:67]
 v_exp_f32 v24, v24
 v_mfma_f32_16x16x32_bf16 v[64:67], a[96:99], a[200:203], v[64:67]
 v_add_f32 v29, 1.0, v21
 v_add_f32 v30, 1.0, v22
 v_mfma_f32_16x16x32_bf16 v[64:67], a[80:83], a[196:199], v[64:67]
 v_exp_f32 v25, v25
 v_add_f32 v31, 1.0, v23
 v_mfma_f32_16x16x32_bf16 v[80:83], a[80:83], a[200:203], v[80:83]
 v_exp_f32 v26, v26
 v_mfma_f32_16x16x32_bf16 v[80:83], a[96:99], a[204:207], v[80:83]
 v_exp_f32 v27, v27
 v_mfma_f32_16x16x32_bf16 v[80:83], a[112:115], a[160:163], v[80:83]
 v_fmac_f32 v28, v28, v24
 v_fmac_f32 v29, v29, v25
 v_mfma_f32_16x16x32_bf16 v[80:83], a[128:131], a[164:167], v[80:83]
 ds_read_b128 a[196:199], v3 offset:8704
 v_fmac_f32 v30, v30, v26
 v_mfma_f32_16x16x32_bf16 v[80:83], a[144:147], a[168:171], v[80:83]
 v_fmac_f32 v31, v31, v27
 v_mul_f32 v32, s42, v52
 v_mfma_f32_16x16x32_bf16 v[84:87], a[148:151], a[168:171], v[84:87]
 v_rcp_f32 v28, v28
 v_mfma_f32_16x16x32_bf16 v[84:87], a[132:135], a[164:167], v[84:87]
 v_rcp_f32 v29, v29
 v_mfma_f32_16x16x32_bf16 v[84:87], a[116:119], a[160:163], v[84:87]
 v_rcp_f32 v30, v30
 v_fma_f32 v20, v20, v28, -v28
 v_mfma_f32_16x16x32_bf16 v[84:87], a[100:103], a[204:207], v[84:87]
 v_rcp_f32 v31, v31
 v_mfma_f32_16x16x32_bf16 v[84:87], a[84:87], a[200:203], v[84:87]
 v_fma_f32 v21, v21, v29, -v29
 v_fma_f32 v22, v22, v30, -v30
 v_mfma_f32_16x16x32_bf16 v[88:91], a[88:91], a[200:203], v[88:91]
 v_fma_f32 v23, v23, v31, -v31
 v_cvt_pk_bf16_f32 v16, v20, v21
 v_mfma_f32_16x16x32_bf16 v[88:91], a[104:107], a[204:207], v[88:91]
 v_cvt_pk_bf16_f32 v17, v22, v23
 v_mul_f32 v33, s42, v53
 v_mfma_f32_16x16x32_bf16 v[88:91], a[120:123], a[160:163], v[88:91]
 v_mul_f32 v34, s42, v54
 v_mul_f32 v35, s42, v55
 v_mfma_f32_16x16x32_bf16 v[88:91], a[136:139], a[164:167], v[88:91]
 v_min_f32 v32, s47, v32
 v_min_f32 v33, s47, v33
 v_mfma_f32_16x16x32_bf16 v[88:91], a[152:155], a[168:171], v[88:91]
 v_min_f32 v34, s47, v34
 v_min_f32 v35, s47, v35
 v_mfma_f32_16x16x32_bf16 v[92:95], a[156:159], a[168:171], v[92:95]
 v_exp_f32 v32, v32
 v_mul_f32 v40, s43, v60
 v_mfma_f32_16x16x32_bf16 v[92:95], a[140:143], a[164:167], v[92:95]
 v_mul_f32 v41, s43, v61
 v_mul_f32 v42, s43, v62
 v_mfma_f32_16x16x32_bf16 v[92:95], a[124:127], a[160:163], v[92:95]
 v_exp_f32 v33, v33
 v_mfma_f32_16x16x32_bf16 v[92:95], a[108:111], a[204:207], v[92:95]
 v_mul_f32 v43, s43, v63
 v_add_f32 v28, 1.0, v32
 v_mfma_f32_16x16x32_bf16 v[92:95], a[92:95], a[200:203], v[92:95]
 v_exp_f32 v34, v34
 v_mfma_f32_16x16x32_bf16 v[108:111], a[92:95], a[204:207], v[108:111]
 v_exp_f32 v35, v35
 v_mfma_f32_16x16x32_bf16 v[108:111], a[108:111], a[160:163], v[108:111]
 v_exp_f32 v40, v40
 v_mfma_f32_16x16x32_bf16 v[108:111], a[124:127], a[164:167], v[108:111]
 v_add_f32 v29, 1.0, v33
 v_add_f32 v30, 1.0, v34
 v_mfma_f32_16x16x32_bf16 v[108:111], a[140:143], a[168:171], v[108:111]
 s_waitcnt lgkmcnt(0)
 ds_read_b128 a[200:203], v3 offset:13056
 v_exp_f32 v41, v41
 v_mfma_f32_16x16x32_bf16 v[108:111], a[156:159], a[188:191], v[108:111]
 v_add_f32 v31, 1.0, v35
 v_fmac_f32 v28, v28, v40
 v_mfma_f32_16x16x32_bf16 v[104:107], a[152:155], a[188:191], v[104:107]
 v_exp_f32 v42, v42
 v_mfma_f32_16x16x32_bf16 v[104:107], a[136:139], a[168:171], v[104:107]
 v_exp_f32 v43, v43
 v_mfma_f32_16x16x32_bf16 v[104:107], a[120:123], a[164:167], v[104:107]
 v_fmac_f32 v29, v29, v41
 v_fmac_f32 v30, v30, v42
 v_mfma_f32_16x16x32_bf16 v[104:107], a[104:107], a[160:163], v[104:107]
 v_fmac_f32 v31, v31, v43
 v_mul_f32 v20, s42, v64
 v_mfma_f32_16x16x32_bf16 v[104:107], a[88:91], a[204:207], v[104:107]
 v_rcp_f32 v28, v28
 v_mfma_f32_16x16x32_bf16 v[100:103], a[84:87], a[204:207], v[100:103]
 v_rcp_f32 v29, v29
 v_mfma_f32_16x16x32_bf16 v[100:103], a[100:103], a[160:163], v[100:103]
 v_rcp_f32 v30, v30
 v_fma_f32 v32, v32, v28, -v28
 v_mfma_f32_16x16x32_bf16 v[100:103], a[116:119], a[164:167], v[100:103]
 v_rcp_f32 v31, v31
 v_mfma_f32_16x16x32_bf16 v[100:103], a[132:135], a[168:171], v[100:103]
 v_fma_f32 v33, v33, v29, -v29
 v_fma_f32 v34, v34, v30, -v30
 v_mfma_f32_16x16x32_bf16 v[100:103], a[148:151], a[188:191], v[100:103]
 v_fma_f32 v35, v35, v31, -v31
 v_cvt_pk_bf16_f32 v18, v32, v33
 v_mfma_f32_16x16x32_bf16 v[96:99], a[144:147], a[188:191], v[96:99]
 s_add_u32 s46, s40, 0
 v_cvt_pk_bf16_f32 v19, v34, v35
 buffer_store_dwordx4 v[16:19], v6, s[12:15], s46 offen
 v_mfma_f32_16x16x32_bf16 v[96:99], a[128:131], a[168:171], v[96:99]
 v_mul_f32 v21, s42, v65
 v_mul_f32 v22, s42, v66
 v_mfma_f32_16x16x32_bf16 v[96:99], a[112:115], a[164:167], v[96:99]
 v_mul_f32 v23, s42, v67
 v_min_f32 v20, s47, v20
 v_mfma_f32_16x16x32_bf16 v[96:99], a[96:99], a[160:163], v[96:99]
 v_min_f32 v21, s47, v21
 v_min_f32 v22, s47, v22
 v_mfma_f32_16x16x32_bf16 v[96:99], a[80:83], a[204:207], v[96:99]
 ds_read_b128 a[188:191], v2 offset:17408
 v_min_f32 v23, s47, v23
 v_mul_f32 v24, s43, v72
 v_mfma_f32_16x16x32_bf16 v[112:115], a[0:3], a[184:187], v[112:115]
 ds_read_b128 a[168:171], v2 offset:21760
 v_mul_f32 v25, s43, v73
 v_mfma_f32_16x16x32_bf16 v[112:115], a[16:19], a[180:183], v[112:115]
 ds_read_b128 a[164:167], v2 offset:26112
 v_mul_f32 v26, s43, v74
 v_mfma_f32_16x16x32_bf16 v[112:115], a[32:35], a[176:179], v[112:115]
 ds_read_b128 a[160:163], v4 offset:0
 v_mul_f32 v27, s43, v75
 v_mfma_f32_16x16x32_bf16 v[112:115], a[48:51], a[172:175], v[112:115]
 ds_read_b128 a[204:207], v4 offset:4352
 v_mfma_f32_16x16x32_bf16 v[112:115], a[64:67], a[192:195], v[112:115]
 v_exp_f32 v20, v20
 v_mfma_f32_16x16x32_bf16 v[116:119], a[68:71], a[192:195], v[116:119]
 v_exp_f32 v21, v21
 v_mfma_f32_16x16x32_bf16 v[116:119], a[52:55], a[172:175], v[116:119]
 v_exp_f32 v22, v22
 v_mfma_f32_16x16x32_bf16 v[116:119], a[36:39], a[176:179], v[116:119]
 v_exp_f32 v23, v23
 v_add_f32 v28, 1.0, v20
 v_mfma_f32_16x16x32_bf16 v[116:119], a[20:23], a[180:183], v[116:119]
 v_exp_f32 v24, v24
 v_mfma_f32_16x16x32_bf16 v[116:119], a[4:7], a[184:187], v[116:119]
 v_add_f32 v29, 1.0, v21
 v_add_f32 v30, 1.0, v22
 v_mfma_f32_16x16x32_bf16 v[120:123], a[8:11], a[184:187], v[120:123]
 v_exp_f32 v25, v25
 v_mfma_f32_16x16x32_bf16 v[120:123], a[24:27], a[180:183], v[120:123]
 v_add_f32 v31, 1.0, v23
 v_fmac_f32 v28, v28, v24
 v_mfma_f32_16x16x32_bf16 v[120:123], a[40:43], a[176:179], v[120:123]
 v_exp_f32 v26, v26
 v_mfma_f32_16x16x32_bf16 v[120:123], a[56:59], a[172:175], v[120:123]
 v_exp_f32 v27, v27
 v_mfma_f32_16x16x32_bf16 v[120:123], a[72:75], a[192:195], v[120:123]
 v_fmac_f32 v29, v29, v25
 v_fmac_f32 v30, v30, v26
 v_mfma_f32_16x16x32_bf16 v[124:127], a[76:79], a[192:195], v[124:127]
 v_fmac_f32 v31, v31, v27
 v_rcp_f32 v28, v28
 v_mfma_f32_16x16x32_bf16 v[124:127], a[60:63], a[172:175], v[124:127]
 v_rcp_f32 v29, v29
 v_mfma_f32_16x16x32_bf16 v[124:127], a[44:47], a[176:179], v[124:127]
 v_rcp_f32 v30, v30
 v_mfma_f32_16x16x32_bf16 v[124:127], a[28:31], a[180:183], v[124:127]
 v_rcp_f32 v31, v31
 v_mfma_f32_16x16x32_bf16 v[124:127], a[12:15], a[184:187], v[124:127]
 v_fma_f32 v20, v20, v28, -v28
 v_fma_f32 v21, v21, v29, -v29
 v_mfma_f32_16x16x32_bf16 v[140:143], a[12:15], a[180:183], v[140:143]
 v_fma_f32 v22, v22, v30, -v30
 v_fma_f32 v23, v23, v31, -v31
 v_mfma_f32_16x16x32_bf16 v[140:143], a[28:31], a[176:179], v[140:143]
 v_cvt_pk_bf16_f32 v16, v20, v21
 v_cvt_pk_bf16_f32 v17, v22, v23
 v_mfma_f32_16x16x32_bf16 v[140:143], a[44:47], a[172:175], v[140:143]
 v_mul_f32 v32, s42, v68
 v_mul_f32 v33, s42, v69
 v_mfma_f32_16x16x32_bf16 v[140:143], a[60:63], a[192:195], v[140:143]
 ds_read_b128 a[184:187], v4 offset:8704
 v_mul_f32 v34, s42, v70
 v_mul_f32 v35, s42, v71
 v_mfma_f32_16x16x32_bf16 v[140:143], a[76:79], a[196:199], v[140:143]
 v_min_f32 v32, s47, v32
 v_min_f32 v33, s47, v33
 v_mfma_f32_16x16x32_bf16 v[136:139], a[72:75], a[196:199], v[136:139]
 v_min_f32 v34, s47, v34
 v_min_f32 v35, s47, v35
 v_mfma_f32_16x16x32_bf16 v[136:139], a[56:59], a[192:195], v[136:139]
 v_exp_f32 v32, v32
 v_mfma_f32_16x16x32_bf16 v[136:139], a[40:43], a[172:175], v[136:139]
 v_mul_f32 v40, s43, v76
 v_mul_f32 v41, s43, v77
 v_mfma_f32_16x16x32_bf16 v[136:139], a[24:27], a[176:179], v[136:139]
 v_exp_f32 v33, v33
 v_mfma_f32_16x16x32_bf16 v[136:139], a[8:11], a[180:183], v[136:139]
 v_mul_f32 v42, s43, v78
 v_mul_f32 v43, s43, v79
 v_mfma_f32_16x16x32_bf16 v[132:135], a[4:7], a[180:183], v[132:135]
 v_exp_f32 v34, v34
 v_mfma_f32_16x16x32_bf16 v[132:135], a[20:23], a[176:179], v[132:135]
 v_exp_f32 v35, v35
 v_add_f32 v28, 1.0, v32
 v_mfma_f32_16x16x32_bf16 v[132:135], a[36:39], a[172:175], v[132:135]
 v_exp_f32 v40, v40
 v_mfma_f32_16x16x32_bf16 v[132:135], a[52:55], a[192:195], v[132:135]
 v_add_f32 v29, 1.0, v33
 v_add_f32 v30, 1.0, v34
 v_mfma_f32_16x16x32_bf16 v[132:135], a[68:71], a[196:199], v[132:135]
 v_exp_f32 v41, v41
 v_mfma_f32_16x16x32_bf16 v[128:131], a[64:67], a[196:199], v[128:131]
 v_add_f32 v31, 1.0, v35
 v_fmac_f32 v28, v28, v40
 v_mfma_f32_16x16x32_bf16 v[128:131], a[48:51], a[192:195], v[128:131]
 v_exp_f32 v42, v42
 v_mfma_f32_16x16x32_bf16 v[128:131], a[32:35], a[172:175], v[128:131]
 v_exp_f32 v43, v43
 v_mfma_f32_16x16x32_bf16 v[128:131], a[16:19], a[176:179], v[128:131]
 v_fmac_f32 v29, v29, v41
 v_fmac_f32 v30, v30, v42
 v_mfma_f32_16x16x32_bf16 v[128:131], a[0:3], a[180:183], v[128:131]
 v_fmac_f32 v31, v31, v43
 v_rcp_f32 v28, v28
 v_mfma_f32_16x16x32_bf16 v[144:147], a[0:3], a[176:179], v[144:147]
 v_rcp_f32 v29, v29
 v_mfma_f32_16x16x32_bf16 v[144:147], a[16:19], a[172:175], v[144:147]
 v_rcp_f32 v30, v30
 v_mfma_f32_16x16x32_bf16 v[144:147], a[32:35], a[192:195], v[144:147]
 v_rcp_f32 v31, v31
 v_mfma_f32_16x16x32_bf16 v[144:147], a[48:51], a[196:199], v[144:147]
 s_waitcnt lgkmcnt(0)
 ds_read_b128 a[180:183], v4 offset:13056
 v_fma_f32 v32, v32, v28, -v28
 v_mfma_f32_16x16x32_bf16 v[144:147], a[64:67], a[200:203], v[144:147]
 v_fma_f32 v33, v33, v29, -v29
 v_fma_f32 v34, v34, v30, -v30
 v_mfma_f32_16x16x32_bf16 v[148:151], a[68:71], a[200:203], v[148:151]
 v_fma_f32 v35, v35, v31, -v31
 v_cvt_pk_bf16_f32 v18, v32, v33
 v_mfma_f32_16x16x32_bf16 v[148:151], a[52:55], a[196:199], v[148:151]
 s_add_u32 s46, s40, 2048
 v_cvt_pk_bf16_f32 v19, v34, v35
 buffer_store_dwordx4 v[16:19], v6, s[12:15], s46 offen
 v_mfma_f32_16x16x32_bf16 v[148:151], a[36:39], a[192:195], v[148:151]
 v_mul_f32 v20, s42, v80
 v_mul_f32 v21, s42, v81
 v_mul_f32 v22, s42, v82
 v_mfma_f32_16x16x32_bf16 v[148:151], a[20:23], a[172:175], v[148:151]
 v_mul_f32 v23, s42, v83
 v_min_f32 v20, s47, v20
 v_mfma_f32_16x16x32_bf16 v[148:151], a[4:7], a[176:179], v[148:151]
 v_min_f32 v21, s47, v21
 v_min_f32 v22, s47, v22
 v_mfma_f32_16x16x32_bf16 v[152:155], a[8:11], a[176:179], v[152:155]
 v_min_f32 v23, s47, v23
 v_mul_f32 v24, s43, v88
 v_mfma_f32_16x16x32_bf16 v[152:155], a[24:27], a[172:175], v[152:155]
 v_exp_f32 v20, v20
 v_mfma_f32_16x16x32_bf16 v[152:155], a[40:43], a[192:195], v[152:155]
 v_mul_f32 v25, s43, v89
 v_mul_f32 v26, s43, v90
 v_mfma_f32_16x16x32_bf16 v[152:155], a[56:59], a[196:199], v[152:155]
 v_exp_f32 v21, v21
 v_mfma_f32_16x16x32_bf16 v[152:155], a[72:75], a[200:203], v[152:155]
 v_mul_f32 v27, s43, v91
 v_add_f32 v28, 1.0, v20
 v_mfma_f32_16x16x32_bf16 v[156:159], a[76:79], a[200:203], v[156:159]
 v_exp_f32 v22, v22
 v_add_f32 v29, 1.0, v21
 v_mfma_f32_16x16x32_bf16 v[156:159], a[60:63], a[196:199], v[156:159]
 v_exp_f32 v23, v23
 v_mfma_f32_16x16x32_bf16 v[156:159], a[44:47], a[192:195], v[156:159]
 v_exp_f32 v24, v24
 v_mfma_f32_16x16x32_bf16 v[156:159], a[28:31], a[172:175], v[156:159]
 v_exp_f32 v25, v25
 v_mfma_f32_16x16x32_bf16 v[156:159], a[12:15], a[176:179], v[156:159]
 ds_read_b128 a[200:203], v1 offset:2176
 v_add_f32 v30, 1.0, v22
 v_mfma_f32_16x16x32_bf16 v[112:115], a[80:83], a[188:191], v[112:115]
 ds_read_b128 a[196:199], v1 offset:6528
 v_add_f32 v31, 1.0, v23
 v_mfma_f32_16x16x32_bf16 v[112:115], a[96:99], a[168:171], v[112:115]
 ds_read_b128 a[192:195], v1 offset:10880
 v_fmac_f32 v28, v28, v24
 v_mfma_f32_16x16x32_bf16 v[112:115], a[112:115], a[164:167], v[112:115]
 ds_read_b128 a[172:175], v1 offset:15232
 v_fmac_f32 v29, v29, v25
 v_mfma_f32_16x16x32_bf16 v[112:115], a[128:131], a[160:163], v[112:115]
 ds_read_b128 a[176:179], v1 offset:19584
 v_exp_f32 v26, v26
 v_mfma_f32_16x16x32_bf16 v[112:115], a[144:147], a[204:207], v[112:115]
 v_exp_f32 v27, v27
 v_mfma_f32_16x16x32_bf16 v[116:119], a[148:151], a[204:207], v[116:119]
 v_fmac_f32 v30, v30, v26
 v_fmac_f32 v31, v31, v27
 v_mfma_f32_16x16x32_bf16 v[116:119], a[132:135], a[160:163], v[116:119]
 v_rcp_f32 v28, v28
 v_mfma_f32_16x16x32_bf16 v[116:119], a[116:119], a[164:167], v[116:119]
 v_rcp_f32 v29, v29
 v_mfma_f32_16x16x32_bf16 v[116:119], a[100:103], a[168:171], v[116:119]
 v_rcp_f32 v30, v30
 v_mfma_f32_16x16x32_bf16 v[116:119], a[84:87], a[188:191], v[116:119]
 v_rcp_f32 v31, v31
 v_mfma_f32_16x16x32_bf16 v[120:123], a[88:91], a[188:191], v[120:123]
 v_fma_f32 v20, v20, v28, -v28
 v_fma_f32 v21, v21, v29, -v29
 v_mfma_f32_16x16x32_bf16 v[120:123], a[104:107], a[168:171], v[120:123]
 v_fma_f32 v22, v22, v30, -v30
 v_fma_f32 v23, v23, v31, -v31
 v_cvt_pk_bf16_f32 v16, v20, v21
 v_mfma_f32_16x16x32_bf16 v[120:123], a[120:123], a[164:167], v[120:123]
 v_cvt_pk_bf16_f32 v17, v22, v23
 v_mul_f32 v32, s42, v84
 v_mfma_f32_16x16x32_bf16 v[120:123], a[136:139], a[160:163], v[120:123]
 v_mul_f32 v33, s42, v85
 v_mul_f32 v34, s42, v86
 v_mfma_f32_16x16x32_bf16 v[120:123], a[152:155], a[204:207], v[120:123]
 v_mul_f32 v35, s42, v87
 v_min_f32 v32, s47, v32
 v_mfma_f32_16x16x32_bf16 v[124:127], a[156:159], a[204:207], v[124:127]
 v_min_f32 v33, s47, v33
 v_min_f32 v34, s47, v34
 v_mfma_f32_16x16x32_bf16 v[124:127], a[140:143], a[160:163], v[124:127]
 v_min_f32 v35, s47, v35
 v_mul_f32 v40, s43, v92
 v_mfma_f32_16x16x32_bf16 v[124:127], a[124:127], a[164:167], v[124:127]
 v_exp_f32 v32, v32
 v_mfma_f32_16x16x32_bf16 v[124:127], a[108:111], a[168:171], v[124:127]
 v_mul_f32 v41, s43, v93
 v_mul_f32 v42, s43, v94
 v_mfma_f32_16x16x32_bf16 v[124:127], a[92:95], a[188:191], v[124:127]
 v_exp_f32 v33, v33
 v_mul_f32 v43, s43, v95
 v_mfma_f32_16x16x32_bf16 v[140:143], a[92:95], a[168:171], v[140:143]
 v_exp_f32 v34, v34
 v_mfma_f32_16x16x32_bf16 v[140:143], a[108:111], a[164:167], v[140:143]
 v_exp_f32 v35, v35
 v_mfma_f32_16x16x32_bf16 v[140:143], a[124:127], a[160:163], v[140:143]
 v_exp_f32 v40, v40
 v_mfma_f32_16x16x32_bf16 v[140:143], a[140:143], a[204:207], v[140:143]
 ds_read_b128 a[188:191], v1 offset:23936
 v_add_f32 v28, 1.0, v32
 v_mfma_f32_16x16x32_bf16 v[140:143], a[156:159], a[184:187], v[140:143]
 v_add_f32 v29, 1.0, v33
 v_add_f32 v30, 1.0, v34
 v_mfma_f32_16x16x32_bf16 v[136:139], a[152:155], a[184:187], v[136:139]
 v_exp_f32 v41, v41
 v_mfma_f32_16x16x32_bf16 v[136:139], a[136:139], a[204:207], v[136:139]
 v_add_f32 v31, 1.0, v35
 v_fmac_f32 v28, v28, v40
 v_mfma_f32_16x16x32_bf16 v[136:139], a[120:123], a[160:163], v[136:139]
 v_exp_f32 v42, v42
 v_fmac_f32 v29, v29, v41
 v_mfma_f32_16x16x32_bf16 v[136:139], a[104:107], a[164:167], v[136:139]
 v_exp_f32 v43, v43
 v_mfma_f32_16x16x32_bf16 v[136:139], a[88:91], a[168:171], v[136:139]
 v_fmac_f32 v30, v30, v42
 v_fmac_f32 v31, v31, v43
 v_mfma_f32_16x16x32_bf16 v[132:135], a[84:87], a[168:171], v[132:135]
 v_rcp_f32 v28, v28
 v_mfma_f32_16x16x32_bf16 v[132:135], a[100:103], a[164:167], v[132:135]
 v_rcp_f32 v29, v29
 v_mfma_f32_16x16x32_bf16 v[132:135], a[116:119], a[160:163], v[132:135]
 v_rcp_f32 v30, v30
 v_mfma_f32_16x16x32_bf16 v[132:135], a[132:135], a[204:207], v[132:135]
 v_rcp_f32 v31, v31
 v_mfma_f32_16x16x32_bf16 v[132:135], a[148:151], a[184:187], v[132:135]
 v_fma_f32 v32, v32, v28, -v28
 v_fma_f32 v33, v33, v29, -v29
 v_mfma_f32_16x16x32_bf16 v[128:131], a[144:147], a[184:187], v[128:131]
 v_fma_f32 v34, v34, v30, -v30
 v_fma_f32 v35, v35, v31, -v31
 v_cvt_pk_bf16_f32 v18, v32, v33
 v_mfma_f32_16x16x32_bf16 v[128:131], a[128:131], a[204:207], v[128:131]
 s_add_u32 s46, s40, 4096
 v_cvt_pk_bf16_f32 v19, v34, v35
 buffer_store_dwordx4 v[16:19], v6, s[12:15], s46 offen
 v_mfma_f32_16x16x32_bf16 v[128:131], a[112:115], a[160:163], v[128:131]
 v_mul_f32 v20, s42, v96
 v_mul_f32 v21, s42, v97
 v_mfma_f32_16x16x32_bf16 v[128:131], a[96:99], a[164:167], v[128:131]
 v_mul_f32 v22, s42, v98
 v_mul_f32 v23, s42, v99
 v_mfma_f32_16x16x32_bf16 v[128:131], a[80:83], a[168:171], v[128:131]
 v_min_f32 v20, s47, v20
 v_min_f32 v21, s47, v21
 v_mfma_f32_16x16x32_bf16 v[144:147], a[80:83], a[164:167], v[144:147]
 v_min_f32 v22, s47, v22
 v_min_f32 v23, s47, v23
 v_mfma_f32_16x16x32_bf16 v[144:147], a[96:99], a[160:163], v[144:147]
 v_exp_f32 v20, v20
 v_mfma_f32_16x16x32_bf16 v[144:147], a[112:115], a[204:207], v[144:147]
 v_mul_f32 v24, s43, v104
 v_mul_f32 v25, s43, v105
 v_mfma_f32_16x16x32_bf16 v[144:147], a[128:131], a[184:187], v[144:147]
 s_waitcnt lgkmcnt(0)
 ds_read_b128 a[168:171], v1 offset:28288
 v_exp_f32 v21, v21
 v_mfma_f32_16x16x32_bf16 v[144:147], a[144:147], a[180:183], v[144:147]
 v_mul_f32 v26, s43, v106
 v_mul_f32 v27, s43, v107
 v_mfma_f32_16x16x32_bf16 v[148:151], a[148:151], a[180:183], v[148:151]
 v_exp_f32 v22, v22
 v_mfma_f32_16x16x32_bf16 v[148:151], a[132:135], a[184:187], v[148:151]
 v_exp_f32 v23, v23
 v_mfma_f32_16x16x32_bf16 v[148:151], a[116:119], a[204:207], v[148:151]
 v_exp_f32 v24, v24
 v_mfma_f32_16x16x32_bf16 v[148:151], a[100:103], a[160:163], v[148:151]
 v_add_f32 v28, 1.0, v20
 v_add_f32 v29, 1.0, v21
 v_mfma_f32_16x16x32_bf16 v[148:151], a[84:87], a[164:167], v[148:151]
 v_exp_f32 v25, v25
 v_mfma_f32_16x16x32_bf16 v[152:155], a[88:91], a[164:167], v[152:155]
 v_add_f32 v30, 1.0, v22
 v_add_f32 v31, 1.0, v23
 v_mfma_f32_16x16x32_bf16 v[152:155], a[104:107], a[160:163], v[152:155]
 v_exp_f32 v26, v26
 v_fmac_f32 v28, v28, v24
 v_mfma_f32_16x16x32_bf16 v[152:155], a[120:123], a[204:207], v[152:155]
 v_exp_f32 v27, v27
 v_mfma_f32_16x16x32_bf16 v[152:155], a[136:139], a[184:187], v[152:155]
 v_fmac_f32 v29, v29, v25
 v_fmac_f32 v30, v30, v26
 v_mfma_f32_16x16x32_bf16 v[152:155], a[152:155], a[180:183], v[152:155]
 v_fmac_f32 v31, v31, v27
 v_mul_f32 v32, s42, v100
 v_mfma_f32_16x16x32_bf16 v[156:159], a[156:159], a[180:183], v[156:159]
 v_rcp_f32 v28, v28
 v_mfma_f32_16x16x32_bf16 v[156:159], a[140:143], a[184:187], v[156:159]
 v_rcp_f32 v29, v29
 v_mfma_f32_16x16x32_bf16 v[156:159], a[124:127], a[204:207], v[156:159]
 v_rcp_f32 v30, v30
 v_mfma_f32_16x16x32_bf16 v[156:159], a[108:111], a[160:163], v[156:159]
 v_rcp_f32 v31, v31
 v_mfma_f32_16x16x32_bf16 v[156:159], a[92:95], a[164:167], v[156:159]
 v_fma_f32 v20, v20, v28, -v28
 v_fma_f32 v21, v21, v29, -v29
 v_fma_f32 v22, v22, v30, -v30
 v_mfma_f32_16x16x32_bf16 v[176:179], a[0:3], a[200:203], v[176:179]
 v_fma_f32 v23, v23, v31, -v31
 v_cvt_pk_bf16_f32 v16, v20, v21
 v_mfma_f32_16x16x32_bf16 v[176:179], a[16:19], a[196:199], v[176:179]
 v_cvt_pk_bf16_f32 v17, v22, v23
 v_mul_f32 v33, s42, v101
 v_mfma_f32_16x16x32_bf16 v[176:179], a[32:35], a[192:195], v[176:179]
 v_mul_f32 v34, s42, v102
 v_mul_f32 v35, s42, v103
 v_mfma_f32_16x16x32_bf16 v[176:179], a[48:51], a[172:175], v[176:179]
 ds_read_b128 a[180:183], v3 offset:2176
 v_min_f32 v32, s47, v32
 v_mfma_f32_16x16x32_bf16 v[176:179], a[64:67], a[176:179], v[176:179]
 v_min_f32 v33, s47, v33
 v_min_f32 v34, s47, v34
 v_mfma_f32_16x16x32_bf16 v[180:183], a[68:71], a[176:179], v[180:183]
 v_min_f32 v35, s47, v35
 v_mul_f32 v40, s43, v108
 v_mfma_f32_16x16x32_bf16 v[180:183], a[52:55], a[172:175], v[180:183]
 v_exp_f32 v32, v32
 v_mfma_f32_16x16x32_bf16 v[180:183], a[36:39], a[192:195], v[180:183]
 v_mul_f32 v41, s43, v109
 v_exp_f32 v33, v33
 v_mfma_f32_16x16x32_bf16 v[180:183], a[20:23], a[196:199], v[180:183]
 v_mul_f32 v42, s43, v110
 v_mul_f32 v43, s43, v111
 v_mfma_f32_16x16x32_bf16 v[180:183], a[4:7], a[200:203], v[180:183]
 v_exp_f32 v34, v34
 v_mfma_f32_16x16x32_bf16 v[184:187], a[8:11], a[200:203], v[184:187]
 v_exp_f32 v35, v35
 v_mfma_f32_16x16x32_bf16 v[184:187], a[24:27], a[196:199], v[184:187]
 v_exp_f32 v40, v40
 v_mfma_f32_16x16x32_bf16 v[184:187], a[40:43], a[192:195], v[184:187]
 v_add_f32 v28, 1.0, v32
 v_add_f32 v29, 1.0, v33
 v_mfma_f32_16x16x32_bf16 v[184:187], a[56:59], a[172:175], v[184:187]
 v_exp_f32 v41, v41
 v_mfma_f32_16x16x32_bf16 v[184:187], a[72:75], a[176:179], v[184:187]
 v_add_f32 v30, 1.0, v34
 v_add_f32 v31, 1.0, v35
 v_mfma_f32_16x16x32_bf16 v[188:191], a[76:79], a[176:179], v[188:191]
 v_exp_f32 v42, v42
 v_fmac_f32 v28, v28, v40
 v_mfma_f32_16x16x32_bf16 v[188:191], a[60:63], a[172:175], v[188:191]
 v_exp_f32 v43, v43
 v_mfma_f32_16x16x32_bf16 v[188:191], a[44:47], a[192:195], v[188:191]
 v_fmac_f32 v29, v29, v41
 v_fmac_f32 v30, v30, v42
 v_mfma_f32_16x16x32_bf16 v[188:191], a[28:31], a[196:199], v[188:191]
 v_fmac_f32 v31, v31, v43
 v_mul_f32 v20, s42, v112
 v_mfma_f32_16x16x32_bf16 v[188:191], a[12:15], a[200:203], v[188:191]
 ds_read_b128 a[184:187], v2 offset:2176
 v_mul_f32 v21, s42, v113
 v_mfma_f32_16x16x32_bf16 v[204:207], a[12:15], a[196:199], v[204:207]
 ds_read_b128 a[204:207], v2 offset:6528
 v_mul_f32 v22, s42, v114
 v_mfma_f32_16x16x32_bf16 v[204:207], a[28:31], a[192:195], v[204:207]
 ds_read_b128 a[160:163], v2 offset:10880
 v_mul_f32 v23, s42, v115
 v_mfma_f32_16x16x32_bf16 v[204:207], a[44:47], a[172:175], v[204:207]
 ds_read_b128 a[164:167], v2 offset:15232
 v_min_f32 v20, s47, v20
 v_mfma_f32_16x16x32_bf16 v[204:207], a[60:63], a[176:179], v[204:207]
 ds_read_b128 a[200:203], v2 offset:19584
 v_rcp_f32 v28, v28
 v_mfma_f32_16x16x32_bf16 v[204:207], a[76:79], a[188:191], v[204:207]
 v_rcp_f32 v29, v29
 v_mfma_f32_16x16x32_bf16 v[200:203], a[72:75], a[188:191], v[200:203]
 v_rcp_f32 v30, v30
 v_mfma_f32_16x16x32_bf16 v[200:203], a[56:59], a[176:179], v[200:203]
 v_rcp_f32 v31, v31
 v_mfma_f32_16x16x32_bf16 v[200:203], a[40:43], a[172:175], v[200:203]
 v_fma_f32 v32, v32, v28, -v28
 v_fma_f32 v33, v33, v29, -v29
 v_mfma_f32_16x16x32_bf16 v[200:203], a[24:27], a[192:195], v[200:203]
 v_fma_f32 v34, v34, v30, -v30
 v_fma_f32 v35, v35, v31, -v31
 v_mfma_f32_16x16x32_bf16 v[200:203], a[8:11], a[196:199], v[200:203]
 v_cvt_pk_bf16_f32 v18, v32, v33
 v_cvt_pk_bf16_f32 v19, v34, v35
 v_mfma_f32_16x16x32_bf16 v[196:199], a[4:7], a[196:199], v[196:199]
 s_add_u32 s46, s40, 6144
 buffer_store_dwordx4 v[16:19], v6, s[12:15], s46 offen
 v_min_f32 v21, s47, v21
 v_mfma_f32_16x16x32_bf16 v[196:199], a[20:23], a[192:195], v[196:199]
 v_min_f32 v22, s47, v22
 v_min_f32 v23, s47, v23
 v_mul_f32 v24, s43, v120
 v_mfma_f32_16x16x32_bf16 v[196:199], a[36:39], a[172:175], v[196:199]
 v_exp_f32 v20, v20
 v_mfma_f32_16x16x32_bf16 v[196:199], a[52:55], a[176:179], v[196:199]
 v_mul_f32 v25, s43, v121
 v_mul_f32 v26, s43, v122
 v_mfma_f32_16x16x32_bf16 v[196:199], a[68:71], a[188:191], v[196:199]
 v_exp_f32 v21, v21
 v_mfma_f32_16x16x32_bf16 v[192:195], a[64:67], a[188:191], v[192:195]
 v_mul_f32 v27, s43, v123
 v_add_f32 v28, 1.0, v20
 v_mfma_f32_16x16x32_bf16 v[192:195], a[48:51], a[176:179], v[192:195]
 v_exp_f32 v22, v22
 v_mfma_f32_16x16x32_bf16 v[192:195], a[32:35], a[172:175], v[192:195]
 v_exp_f32 v23, v23
 v_mfma_f32_16x16x32_bf16 v[192:195], a[16:19], a[192:195], v[192:195]
 v_exp_f32 v24, v24
 v_mfma_f32_16x16x32_bf16 v[192:195], a[0:3], a[196:199], v[192:195]
 v_add_f32 v29, 1.0, v21
 v_exp_f32 v25, v25
 v_mfma_f32_16x16x32_bf16 v[208:211], a[0:3], a[192:195], v[208:211]
 v_add_f32 v30, 1.0, v22
 v_add_f32 v31, 1.0, v23
 v_mfma_f32_16x16x32_bf16 v[208:211], a[16:19], a[172:175], v[208:211]
 v_exp_f32 v26, v26
 v_mfma_f32_16x16x32_bf16 v[208:211], a[32:35], a[176:179], v[208:211]
 v_exp_f32 v27, v27
 v_mfma_f32_16x16x32_bf16 v[208:211], a[48:51], a[188:191], v[208:211]
 s_waitcnt lgkmcnt(0)
 ds_read_b128 a[196:199], v2 offset:23936
 v_fmac_f32 v28, v28, v24
 v_mfma_f32_16x16x32_bf16 v[208:211], a[64:67], a[168:171], v[208:211]
 v_fmac_f32 v29, v29, v25
 v_fmac_f32 v30, v30, v26
 v_mfma_f32_16x16x32_bf16 v[212:215], a[68:71], a[168:171], v[212:215]
 v_fmac_f32 v31, v31, v27
 v_mul_f32 v32, s42, v116
 v_mfma_f32_16x16x32_bf16 v[212:215], a[52:55], a[188:191], v[212:215]
 v_rcp_f32 v28, v28
 v_mfma_f32_16x16x32_bf16 v[212:215], a[36:39], a[176:179], v[212:215]
 v_rcp_f32 v29, v29
 v_fma_f32 v20, v20, v28, -v28
 v_mfma_f32_16x16x32_bf16 v[212:215], a[20:23], a[172:175], v[212:215]
 v_rcp_f32 v30, v30
 v_mfma_f32_16x16x32_bf16 v[212:215], a[4:7], a[192:195], v[212:215]
 v_rcp_f32 v31, v31
 v_mfma_f32_16x16x32_bf16 v[216:219], a[8:11], a[192:195], v[216:219]
 v_fma_f32 v21, v21, v29, -v29
 v_fma_f32 v22, v22, v30, -v30
 v_mfma_f32_16x16x32_bf16 v[216:219], a[24:27], a[172:175], v[216:219]
 v_fma_f32 v23, v23, v31, -v31
 v_cvt_pk_bf16_f32 v16, v20, v21
 v_mfma_f32_16x16x32_bf16 v[216:219], a[40:43], a[176:179], v[216:219]
 v_cvt_pk_bf16_f32 v17, v22, v23
 v_mul_f32 v33, s42, v117
 v_mfma_f32_16x16x32_bf16 v[216:219], a[56:59], a[188:191], v[216:219]
 v_mul_f32 v34, s42, v118
 v_mul_f32 v35, s42, v119
 v_mfma_f32_16x16x32_bf16 v[216:219], a[72:75], a[168:171], v[216:219]
 v_min_f32 v32, s47, v32
 v_min_f32 v33, s47, v33
 v_mfma_f32_16x16x32_bf16 v[220:223], a[76:79], a[168:171], v[220:223]
 v_min_f32 v34, s47, v34
 v_min_f32 v35, s47, v35
 v_mul_f32 v40, s43, v124
 v_mfma_f32_16x16x32_bf16 v[220:223], a[60:63], a[188:191], v[220:223]
 v_exp_f32 v32, v32
 v_mfma_f32_16x16x32_bf16 v[220:223], a[44:47], a[176:179], v[220:223]
 v_mul_f32 v41, s43, v125
 v_mul_f32 v42, s43, v126
 v_mfma_f32_16x16x32_bf16 v[220:223], a[28:31], a[172:175], v[220:223]
 v_exp_f32 v33, v33
 v_mfma_f32_16x16x32_bf16 v[220:223], a[12:15], a[192:195], v[220:223]
 v_mul_f32 v43, s43, v127
 v_add_f32 v28, 1.0, v32
 v_mfma_f32_16x16x32_bf16 v[236:239], a[12:15], a[172:175], v[236:239]
 v_exp_f32 v34, v34
 v_mfma_f32_16x16x32_bf16 v[236:239], a[28:31], a[176:179], v[236:239]
 v_exp_f32 v35, v35
 v_mfma_f32_16x16x32_bf16 v[236:239], a[44:47], a[188:191], v[236:239]
 v_exp_f32 v40, v40
 v_mfma_f32_16x16x32_bf16 v[236:239], a[60:63], a[168:171], v[236:239]
 ds_read_b128 a[192:195], v2 offset:28288
 v_add_f32 v29, 1.0, v33
 v_add_f32 v30, 1.0, v34
 v_mfma_f32_16x16x32_bf16 v[236:239], a[76:79], a[180:183], v[236:239]
 v_exp_f32 v41, v41
 v_mfma_f32_16x16x32_bf16 v[232:235], a[72:75], a[180:183], v[232:235]
 v_add_f32 v31, 1.0, v35
 v_fmac_f32 v28, v28, v40
 v_mfma_f32_16x16x32_bf16 v[232:235], a[56:59], a[168:171], v[232:235]
 v_exp_f32 v42, v42
 v_mfma_f32_16x16x32_bf16 v[232:235], a[40:43], a[188:191], v[232:235]
 v_exp_f32 v43, v43
 v_mfma_f32_16x16x32_bf16 v[232:235], a[24:27], a[176:179], v[232:235]
 v_fmac_f32 v29, v29, v41
 v_fmac_f32 v30, v30, v42
 v_mfma_f32_16x16x32_bf16 v[232:235], a[8:11], a[172:175], v[232:235]
 v_fmac_f32 v31, v31, v43
 v_mul_f32 v20, s42, v128
 v_mfma_f32_16x16x32_bf16 v[228:231], a[4:7], a[172:175], v[228:231]
 v_rcp_f32 v28, v28
 v_mfma_f32_16x16x32_bf16 v[228:231], a[20:23], a[176:179], v[228:231]
 v_rcp_f32 v29, v29
 v_fma_f32 v32, v32, v28, -v28
 v_mfma_f32_16x16x32_bf16 v[228:231], a[36:39], a[188:191], v[228:231]
 v_rcp_f32 v30, v30
 v_mfma_f32_16x16x32_bf16 v[228:231], a[52:55], a[168:171], v[228:231]
 v_rcp_f32 v31, v31
 v_mfma_f32_16x16x32_bf16 v[228:231], a[68:71], a[180:183], v[228:231]
 v_fma_f32 v33, v33, v29, -v29
 v_fma_f32 v34, v34, v30, -v30
 v_mfma_f32_16x16x32_bf16 v[224:227], a[64:67], a[180:183], v[224:227]
 v_fma_f32 v35, v35, v31, -v31
 v_cvt_pk_bf16_f32 v18, v32, v33
 v_mfma_f32_16x16x32_bf16 v[224:227], a[48:51], a[168:171], v[224:227]
 s_add_u32 s46, s40, 8192
 v_cvt_pk_bf16_f32 v19, v34, v35
 buffer_store_dwordx4 v[16:19], v6, s[12:15], s46 offen
 v_mfma_f32_16x16x32_bf16 v[224:227], a[32:35], a[188:191], v[224:227]
 v_mul_f32 v21, s42, v129
 v_mul_f32 v22, s42, v130
 v_mfma_f32_16x16x32_bf16 v[224:227], a[16:19], a[176:179], v[224:227]
 v_mul_f32 v23, s42, v131
 v_min_f32 v20, s47, v20
 v_mfma_f32_16x16x32_bf16 v[224:227], a[0:3], a[172:175], v[224:227]
 v_min_f32 v21, s47, v21
 v_min_f32 v22, s47, v22
 v_min_f32 v23, s47, v23
 v_mfma_f32_16x16x32_bf16 v[176:179], a[80:83], a[184:187], v[176:179]
 v_exp_f32 v20, v20
 v_mfma_f32_16x16x32_bf16 v[176:179], a[96:99], a[204:207], v[176:179]
 v_mul_f32 v24, s43, v136
 v_mul_f32 v25, s43, v137
 v_mfma_f32_16x16x32_bf16 v[176:179], a[112:115], a[160:163], v[176:179]
 v_exp_f32 v21, v21
 v_mfma_f32_16x16x32_bf16 v[176:179], a[128:131], a[164:167], v[176:179]
 ds_read_b128 a[180:183], v4 offset:2176
 v_mul_f32 v26, s43, v138
 v_mfma_f32_16x16x32_bf16 v[176:179], a[144:147], a[200:203], v[176:179]
 v_mul_f32 v27, s43, v139
 v_add_f32 v28, 1.0, v20
 v_mfma_f32_16x16x32_bf16 v[180:183], a[148:151], a[200:203], v[180:183]
 v_exp_f32 v22, v22
 v_mfma_f32_16x16x32_bf16 v[180:183], a[132:135], a[164:167], v[180:183]
 v_exp_f32 v23, v23
 v_mfma_f32_16x16x32_bf16 v[180:183], a[116:119], a[160:163], v[180:183]
 v_exp_f32 v24, v24
 v_add_f32 v29, 1.0, v21
 v_mfma_f32_16x16x32_bf16 v[180:183], a[100:103], a[204:207], v[180:183]
 v_exp_f32 v25, v25
 v_mfma_f32_16x16x32_bf16 v[180:183], a[84:87], a[184:187], v[180:183]
 v_add_f32 v30, 1.0, v22
 v_add_f32 v31, 1.0, v23
 v_mfma_f32_16x16x32_bf16 v[184:187], a[88:91], a[184:187], v[184:187]
 v_exp_f32 v26, v26
 v_mfma_f32_16x16x32_bf16 v[184:187], a[104:107], a[204:207], v[184:187]
 v_exp_f32 v27, v27
 v_mfma_f32_16x16x32_bf16 v[184:187], a[120:123], a[160:163], v[184:187]
 v_fmac_f32 v28, v28, v24
 v_fmac_f32 v29, v29, v25
 v_mfma_f32_16x16x32_bf16 v[184:187], a[136:139], a[164:167], v[184:187]
 v_fmac_f32 v30, v30, v26
 v_fmac_f32 v31, v31, v27
 v_mfma_f32_16x16x32_bf16 v[184:187], a[152:155], a[200:203], v[184:187]
 v_rcp_f32 v28, v28
 v_mfma_f32_16x16x32_bf16 v[188:191], a[156:159], a[200:203], v[188:191]
 v_rcp_f32 v29, v29
 v_fma_f32 v20, v20, v28, -v28
 v_mfma_f32_16x16x32_bf16 v[188:191], a[140:143], a[164:167], v[188:191]
 v_rcp_f32 v30, v30
 v_mfma_f32_16x16x32_bf16 v[188:191], a[124:127], a[160:163], v[188:191]
 v_rcp_f32 v31, v31
 v_mfma_f32_16x16x32_bf16 v[188:191], a[108:111], a[204:207], v[188:191]
 v_fma_f32 v21, v21, v29, -v29
 v_fma_f32 v22, v22, v30, -v30
 v_mfma_f32_16x16x32_bf16 v[188:191], a[92:95], a[184:187], v[188:191]
 ds_read_b128 a[168:171], v1 offset:19584
 v_fma_f32 v23, v23, v31, -v31
 v_mfma_f32_16x16x32_bf16 v[204:207], a[92:95], a[204:207], v[204:207]
 ds_read_b128 a[188:191], v1 offset:23936
 v_cvt_pk_bf16_f32 v16, v20, v21
 v_mfma_f32_16x16x32_bf16 v[204:207], a[108:111], a[160:163], v[204:207]
 ds_read_b128 a[176:179], v1 offset:28288
 v_cvt_pk_bf16_f32 v17, v22, v23
 v_mfma_f32_16x16x32_bf16 v[204:207], a[124:127], a[164:167], v[204:207]
 ds_read_b128 a[172:175], v3 offset:2176
 v_mul_f32 v32, s42, v132
 v_mfma_f32_16x16x32_bf16 v[204:207], a[140:143], a[200:203], v[204:207]
 s_waitcnt lgkmcnt(4)
 ds_read_b128 a[184:187], v3 offset:6528
 v_mul_f32 v33, s42, v133
 v_mul_f32 v34, s42, v134
 v_mfma_f32_16x16x32_bf16 v[204:207], a[156:159], a[196:199], v[204:207]
 v_mul_f32 v35, s42, v135
 v_min_f32 v32, s47, v32
 v_mfma_f32_16x16x32_bf16 v[200:203], a[152:155], a[196:199], v[200:203]
 v_min_f32 v33, s47, v33
 v_min_f32 v34, s47, v34
 v_mfma_f32_16x16x32_bf16 v[200:203], a[136:139], a[200:203], v[200:203]
 v_min_f32 v35, s47, v35
 v_mul_f32 v40, s43, v140
 v_mfma_f32_16x16x32_bf16 v[200:203], a[120:123], a[164:167], v[200:203]
 v_exp_f32 v32, v32
 v_mfma_f32_16x16x32_bf16 v[200:203], a[104:107], a[160:163], v[200:203]
 v_mul_f32 v41, s43, v141
 v_mul_f32 v42, s43, v142
 v_mfma_f32_16x16x32_bf16 v[200:203], a[88:91], a[204:207], v[200:203]
 v_exp_f32 v33, v33
 v_mfma_f32_16x16x32_bf16 v[196:199], a[84:87], a[204:207], v[196:199]
 v_mul_f32 v43, s43, v143
 v_add_f32 v28, 1.0, v32
 v_mfma_f32_16x16x32_bf16 v[196:199], a[100:103], a[160:163], v[196:199]
 v_exp_f32 v34, v34
 v_add_f32 v29, 1.0, v33
 v_mfma_f32_16x16x32_bf16 v[196:199], a[116:119], a[164:167], v[196:199]
 v_exp_f32 v35, v35
 v_mfma_f32_16x16x32_bf16 v[196:199], a[132:135], a[200:203], v[196:199]
 v_exp_f32 v40, v40
 v_mfma_f32_16x16x32_bf16 v[196:199], a[148:151], a[196:199], v[196:199]
 v_exp_f32 v41, v41
 v_mfma_f32_16x16x32_bf16 v[192:195], a[144:147], a[196:199], v[192:195]
 v_add_f32 v30, 1.0, v34
 v_add_f32 v31, 1.0, v35
 v_mfma_f32_16x16x32_bf16 v[192:195], a[128:131], a[200:203], v[192:195]
 v_exp_f32 v42, v42
 v_mfma_f32_16x16x32_bf16 v[192:195], a[112:115], a[164:167], v[192:195]
 v_exp_f32 v43, v43
 v_mfma_f32_16x16x32_bf16 v[192:195], a[96:99], a[160:163], v[192:195]
 v_fmac_f32 v28, v28, v40
 v_fmac_f32 v29, v29, v41
 v_mfma_f32_16x16x32_bf16 v[192:195], a[80:83], a[204:207], v[192:195]
 v_fmac_f32 v30, v30, v42
 v_fmac_f32 v31, v31, v43
 v_mul_f32 v20, s42, v144
 v_mfma_f32_16x16x32_bf16 v[208:211], a[80:83], a[160:163], v[208:211]
 v_rcp_f32 v28, v28
 v_mfma_f32_16x16x32_bf16 v[208:211], a[96:99], a[164:167], v[208:211]
 v_rcp_f32 v29, v29
 v_mfma_f32_16x16x32_bf16 v[208:211], a[112:115], a[200:203], v[208:211]
 v_rcp_f32 v30, v30
 v_mfma_f32_16x16x32_bf16 v[208:211], a[128:131], a[196:199], v[208:211]
 ds_read_b128 a[204:207], v3 offset:10880
 v_fma_f32 v32, v32, v28, -v28
 v_mfma_f32_16x16x32_bf16 v[208:211], a[144:147], a[192:195], v[208:211]
 v_rcp_f32 v31, v31
 v_mfma_f32_16x16x32_bf16 v[212:215], a[148:151], a[192:195], v[212:215]
 v_fma_f32 v33, v33, v29, -v29
 v_fma_f32 v34, v34, v30, -v30
 v_mfma_f32_16x16x32_bf16 v[212:215], a[132:135], a[196:199], v[212:215]
 v_fma_f32 v35, v35, v31, -v31
 v_cvt_pk_bf16_f32 v18, v32, v33
 v_mfma_f32_16x16x32_bf16 v[212:215], a[116:119], a[200:203], v[212:215]
 s_add_u32 s46, s40, 10240
 v_cvt_pk_bf16_f32 v19, v34, v35
 buffer_store_dwordx4 v[16:19], v6, s[12:15], s46 offen
 v_mul_f32 v21, s42, v145
 v_mfma_f32_16x16x32_bf16 v[212:215], a[100:103], a[164:167], v[212:215]
 v_mul_f32 v22, s42, v146
 v_mul_f32 v23, s42, v147
 v_mfma_f32_16x16x32_bf16 v[212:215], a[84:87], a[160:163], v[212:215]
 v_min_f32 v20, s47, v20
 v_min_f32 v21, s47, v21
 v_mfma_f32_16x16x32_bf16 v[216:219], a[88:91], a[160:163], v[216:219]
 v_min_f32 v22, s47, v22
 v_min_f32 v23, s47, v23
 v_mfma_f32_16x16x32_bf16 v[216:219], a[104:107], a[164:167], v[216:219]
 v_exp_f32 v20, v20
 v_mfma_f32_16x16x32_bf16 v[216:219], a[120:123], a[200:203], v[216:219]
 v_mul_f32 v24, s43, v152
 v_mul_f32 v25, s43, v153
 v_mfma_f32_16x16x32_bf16 v[216:219], a[136:139], a[196:199], v[216:219]
 v_exp_f32 v21, v21
 v_mfma_f32_16x16x32_bf16 v[216:219], a[152:155], a[192:195], v[216:219]
 v_mul_f32 v26, s43, v154
 v_mul_f32 v27, s43, v155
 v_mfma_f32_16x16x32_bf16 v[220:223], a[156:159], a[192:195], v[220:223]
 v_exp_f32 v22, v22
 v_add_f32 v28, 1.0, v20
 v_mfma_f32_16x16x32_bf16 v[220:223], a[140:143], a[196:199], v[220:223]
 v_exp_f32 v23, v23
 v_mfma_f32_16x16x32_bf16 v[220:223], a[124:127], a[200:203], v[220:223]
 v_exp_f32 v24, v24
 v_mfma_f32_16x16x32_bf16 v[220:223], a[108:111], a[164:167], v[220:223]
 v_add_f32 v29, 1.0, v21
 v_add_f32 v30, 1.0, v22
 v_mfma_f32_16x16x32_bf16 v[220:223], a[92:95], a[160:163], v[220:223]
 v_exp_f32 v25, v25
 v_mfma_f32_16x16x32_bf16 v[236:239], a[92:95], a[164:167], v[236:239]
 v_add_f32 v31, 1.0, v23
 v_fmac_f32 v28, v28, v24
 v_mfma_f32_16x16x32_bf16 v[236:239], a[108:111], a[200:203], v[236:239]
 v_exp_f32 v26, v26
 v_mfma_f32_16x16x32_bf16 v[236:239], a[124:127], a[196:199], v[236:239]
 v_exp_f32 v27, v27
 v_mfma_f32_16x16x32_bf16 v[236:239], a[140:143], a[192:195], v[236:239]
 ds_read_b128 a[160:163], v3 offset:15232
 v_fmac_f32 v29, v29, v25
 v_fmac_f32 v30, v30, v26
 v_mfma_f32_16x16x32_bf16 v[236:239], a[156:159], a[180:183], v[236:239]
 v_fmac_f32 v31, v31, v27
 v_mul_f32 v32, s42, v148
 v_mfma_f32_16x16x32_bf16 v[232:235], a[152:155], a[180:183], v[232:235]
 v_rcp_f32 v28, v28
 v_mfma_f32_16x16x32_bf16 v[232:235], a[136:139], a[192:195], v[232:235]
 v_rcp_f32 v29, v29
 v_mfma_f32_16x16x32_bf16 v[232:235], a[120:123], a[196:199], v[232:235]
 v_rcp_f32 v30, v30
 v_mfma_f32_16x16x32_bf16 v[232:235], a[104:107], a[200:203], v[232:235]
 v_rcp_f32 v31, v31
 v_mfma_f32_16x16x32_bf16 v[232:235], a[88:91], a[164:167], v[232:235]
 v_fma_f32 v20, v20, v28, -v28
 v_fma_f32 v21, v21, v29, -v29
 v_mfma_f32_16x16x32_bf16 v[228:231], a[84:87], a[164:167], v[228:231]
 v_fma_f32 v22, v22, v30, -v30
 v_fma_f32 v23, v23, v31, -v31
 v_mfma_f32_16x16x32_bf16 v[228:231], a[100:103], a[200:203], v[228:231]
 v_cvt_pk_bf16_f32 v16, v20, v21
 v_cvt_pk_bf16_f32 v17, v22, v23
 v_mul_f32 v33, s42, v149
 v_mfma_f32_16x16x32_bf16 v[228:231], a[116:119], a[196:199], v[228:231]
 v_mul_f32 v34, s42, v150
 v_mul_f32 v35, s42, v151
 v_mfma_f32_16x16x32_bf16 v[228:231], a[132:135], a[192:195], v[228:231]
 v_min_f32 v32, s47, v32
 v_min_f32 v33, s47, v33
 v_mfma_f32_16x16x32_bf16 v[228:231], a[148:151], a[180:183], v[228:231]
 v_min_f32 v34, s47, v34
 v_min_f32 v35, s47, v35
 v_mfma_f32_16x16x32_bf16 v[224:227], a[144:147], a[180:183], v[224:227]
 v_exp_f32 v32, v32
 v_mfma_f32_16x16x32_bf16 v[224:227], a[128:131], a[192:195], v[224:227]
 v_mul_f32 v40, s43, v156
 v_mul_f32 v41, s43, v157
 v_mfma_f32_16x16x32_bf16 v[224:227], a[112:115], a[196:199], v[224:227]
 v_exp_f32 v33, v33
 v_mfma_f32_16x16x32_bf16 v[224:227], a[96:99], a[200:203], v[224:227]
 v_mul_f32 v42, s43, v158
 v_mul_f32 v43, s43, v159
 v_mfma_f32_16x16x32_bf16 v[224:227], a[80:83], a[164:167], v[224:227]
 s_waitcnt lgkmcnt(0)
 ds_read_b128 a[180:183], v2 offset:19584
 v_exp_f32 v34, v34
 v_mfma_f32_16x16x32_bf16 v[240:243], a[0:3], a[168:171], v[240:243]
 ds_read_b128 a[192:195], v2 offset:23936
 v_add_f32 v28, 1.0, v32
 v_mfma_f32_16x16x32_bf16 v[240:243], a[16:19], a[188:191], v[240:243]
 ds_read_b128 a[196:199], v2 offset:28288
 v_add_f32 v29, 1.0, v33
 v_mfma_f32_16x16x32_bf16 v[240:243], a[32:35], a[176:179], v[240:243]
 ds_read_b128 a[200:203], v4 offset:2176
 v_add_f32 v30, 1.0, v34
 v_mfma_f32_16x16x32_bf16 v[240:243], a[48:51], a[172:175], v[240:243]
 ds_read_b128 a[164:167], v4 offset:6528
 v_mul_f32 v20, s42, v176
 v_mfma_f32_16x16x32_bf16 v[240:243], a[64:67], a[184:187], v[240:243]
 v_exp_f32 v35, v35
 v_mfma_f32_16x16x32_bf16 v[244:247], a[68:71], a[184:187], v[244:247]
 v_exp_f32 v40, v40
 v_mfma_f32_16x16x32_bf16 v[244:247], a[52:55], a[172:175], v[244:247]
 v_exp_f32 v41, v41
 v_mfma_f32_16x16x32_bf16 v[244:247], a[36:39], a[176:179], v[244:247]
 v_add_f32 v31, 1.0, v35
 v_exp_f32 v42, v42
 v_mfma_f32_16x16x32_bf16 v[244:247], a[20:23], a[188:191], v[244:247]
 v_exp_f32 v43, v43
 v_mfma_f32_16x16x32_bf16 v[244:247], a[4:7], a[168:171], v[244:247]
 v_fmac_f32 v28, v28, v40
 v_fmac_f32 v29, v29, v41
 v_mfma_f32_16x16x32_bf16 v[248:251], a[8:11], a[168:171], v[248:251]
 v_fmac_f32 v30, v30, v42
 v_fmac_f32 v31, v31, v43
 v_mfma_f32_16x16x32_bf16 v[248:251], a[24:27], a[188:191], v[248:251]
 v_rcp_f32 v28, v28
 v_mfma_f32_16x16x32_bf16 v[248:251], a[40:43], a[176:179], v[248:251]
 v_rcp_f32 v29, v29
 v_mfma_f32_16x16x32_bf16 v[248:251], a[56:59], a[172:175], v[248:251]
 v_rcp_f32 v30, v30
 v_mfma_f32_16x16x32_bf16 v[248:251], a[72:75], a[184:187], v[248:251]
 v_rcp_f32 v31, v31
 v_mfma_f32_16x16x32_bf16 v[252:255], a[76:79], a[184:187], v[252:255]
 v_fma_f32 v32, v32, v28, -v28
 v_fma_f32 v33, v33, v29, -v29
 v_fma_f32 v34, v34, v30, -v30
 v_mfma_f32_16x16x32_bf16 v[252:255], a[60:63], a[172:175], v[252:255]
 v_fma_f32 v35, v35, v31, -v31
 v_cvt_pk_bf16_f32 v18, v32, v33
 v_mfma_f32_16x16x32_bf16 v[252:255], a[44:47], a[176:179], v[252:255]
 s_add_u32 s46, s40, 12288
 v_cvt_pk_bf16_f32 v19, v34, v35
 buffer_store_dwordx4 v[16:19], v6, s[12:15], s46 offen
 v_mfma_f32_16x16x32_bf16 v[252:255], a[28:31], a[188:191], v[252:255]
 v_mul_f32 v21, s42, v177
 v_mul_f32 v22, s42, v178
 v_mfma_f32_16x16x32_bf16 v[252:255], a[12:15], a[168:171], v[252:255]
 v_mul_f32 v23, s42, v179
 v_min_f32 v20, s47, v20
 v_mfma_f32_16x16x32_bf16 a[220:223], a[12:15], a[188:191], a[220:223]
 v_min_f32 v21, s47, v21
 v_min_f32 v22, s47, v22
 v_mfma_f32_16x16x32_bf16 a[220:223], a[28:31], a[176:179], a[220:223]
 v_min_f32 v23, s47, v23
 v_mul_f32 v24, s43, v184
 v_mfma_f32_16x16x32_bf16 a[220:223], a[44:47], a[172:175], a[220:223]
 v_exp_f32 v20, v20
 v_mfma_f32_16x16x32_bf16 a[220:223], a[60:63], a[184:187], a[220:223]
 ds_read_b128 a[168:171], v4 offset:10880
 v_mul_f32 v25, s43, v185
 v_mul_f32 v26, s43, v186
 v_mfma_f32_16x16x32_bf16 a[220:223], a[76:79], a[204:207], a[220:223]
 v_exp_f32 v21, v21
 v_mfma_f32_16x16x32_bf16 a[216:219], a[72:75], a[204:207], a[216:219]
 v_mul_f32 v27, s43, v187
 v_add_f32 v28, 1.0, v20
 v_mfma_f32_16x16x32_bf16 a[216:219], a[56:59], a[184:187], a[216:219]
 v_exp_f32 v22, v22
 v_mfma_f32_16x16x32_bf16 a[216:219], a[40:43], a[172:175], a[216:219]
 v_exp_f32 v23, v23
 v_mfma_f32_16x16x32_bf16 a[216:219], a[24:27], a[176:179], a[216:219]
 v_exp_f32 v24, v24
 v_mfma_f32_16x16x32_bf16 a[216:219], a[8:11], a[188:191], a[216:219]
 v_add_f32 v29, 1.0, v21
 v_add_f32 v30, 1.0, v22
 v_mfma_f32_16x16x32_bf16 a[212:215], a[4:7], a[188:191], a[212:215]
 v_exp_f32 v25, v25
 v_mfma_f32_16x16x32_bf16 a[212:215], a[20:23], a[176:179], a[212:215]
 v_add_f32 v31, 1.0, v23
 v_exp_f32 v26, v26
 v_mfma_f32_16x16x32_bf16 a[212:215], a[36:39], a[172:175], a[212:215]
 v_exp_f32 v27, v27
 v_mfma_f32_16x16x32_bf16 a[212:215], a[52:55], a[184:187], a[212:215]
 v_fmac_f32 v28, v28, v24
 v_fmac_f32 v29, v29, v25
 v_mfma_f32_16x16x32_bf16 a[212:215], a[68:71], a[204:207], a[212:215]
 v_fmac_f32 v30, v30, v26
 v_fmac_f32 v31, v31, v27
 v_mfma_f32_16x16x32_bf16 a[208:211], a[64:67], a[204:207], a[208:211]
 v_rcp_f32 v28, v28
 v_mfma_f32_16x16x32_bf16 a[208:211], a[48:51], a[184:187], a[208:211]
 v_rcp_f32 v29, v29
 v_mfma_f32_16x16x32_bf16 a[208:211], a[32:35], a[172:175], a[208:211]
 v_rcp_f32 v30, v30
 v_mfma_f32_16x16x32_bf16 a[208:211], a[16:19], a[176:179], a[208:211]
 v_rcp_f32 v31, v31
 v_mfma_f32_16x16x32_bf16 a[208:211], a[0:3], a[188:191], a[208:211]
 v_fma_f32 v20, v20, v28, -v28
 v_fma_f32 v21, v21, v29, -v29
 v_fma_f32 v22, v22, v30, -v30
 v_mfma_f32_16x16x32_bf16 a[224:227], a[0:3], a[176:179], a[224:227]
 v_fma_f32 v23, v23, v31, -v31
 v_cvt_pk_bf16_f32 v16, v20, v21
 v_mfma_f32_16x16x32_bf16 a[224:227], a[16:19], a[172:175], a[224:227]
 v_cvt_pk_bf16_f32 v17, v22, v23
 v_mul_f32 v32, s42, v180
 v_mfma_f32_16x16x32_bf16 a[224:227], a[32:35], a[184:187], a[224:227]
 v_mul_f32 v33, s42, v181
 v_mul_f32 v34, s42, v182
 v_mfma_f32_16x16x32_bf16 a[224:227], a[48:51], a[204:207], a[224:227]
 ds_read_b128 a[188:191], v4 offset:15232
 v_mul_f32 v35, s42, v183
 v_mfma_f32_16x16x32_bf16 a[224:227], a[64:67], a[160:163], a[224:227]
 v_min_f32 v32, s47, v32
 v_min_f32 v33, s47, v33
 v_mfma_f32_16x16x32_bf16 a[228:231], a[68:71], a[160:163], a[228:231]
 v_min_f32 v34, s47, v34
 v_min_f32 v35, s47, v35
 v_mfma_f32_16x16x32_bf16 a[228:231], a[52:55], a[204:207], a[228:231]
 v_exp_f32 v32, v32
 v_mfma_f32_16x16x32_bf16 a[228:231], a[36:39], a[184:187], a[228:231]
 v_mul_f32 v40, s43, v188
 v_mul_f32 v41, s43, v189
 v_mul_f32 v42, s43, v190
 v_mfma_f32_16x16x32_bf16 a[228:231], a[20:23], a[172:175], a[228:231]
 v_exp_f32 v33, v33
 v_mfma_f32_16x16x32_bf16 a[228:231], a[4:7], a[176:179], a[228:231]
 v_mul_f32 v43, s43, v191
 v_add_f32 v28, 1.0, v32
 v_mfma_f32_16x16x32_bf16 a[232:235], a[8:11], a[176:179], a[232:235]
 v_exp_f32 v34, v34
 v_mfma_f32_16x16x32_bf16 a[232:235], a[24:27], a[172:175], a[232:235]
 v_exp_f32 v35, v35
 v_mfma_f32_16x16x32_bf16 a[232:235], a[40:43], a[184:187], a[232:235]
 v_exp_f32 v40, v40
 v_mfma_f32_16x16x32_bf16 a[232:235], a[56:59], a[204:207], a[232:235]
 v_add_f32 v29, 1.0, v33
 v_add_f32 v30, 1.0, v34
 v_mfma_f32_16x16x32_bf16 a[232:235], a[72:75], a[160:163], a[232:235]
 v_exp_f32 v41, v41
 v_mfma_f32_16x16x32_bf16 a[236:239], a[76:79], a[160:163], a[236:239]
 v_add_f32 v31, 1.0, v35
 v_exp_f32 v42, v42
 v_mfma_f32_16x16x32_bf16 a[236:239], a[60:63], a[204:207], a[236:239]
 v_exp_f32 v43, v43
 v_mfma_f32_16x16x32_bf16 a[236:239], a[44:47], a[184:187], a[236:239]
 v_fmac_f32 v28, v28, v40
 v_fmac_f32 v29, v29, v41
 v_mfma_f32_16x16x32_bf16 a[236:239], a[28:31], a[172:175], a[236:239]
 v_fmac_f32 v30, v30, v42
 v_fmac_f32 v31, v31, v43
 v_mfma_f32_16x16x32_bf16 a[236:239], a[12:15], a[176:179], a[236:239]
 s_waitcnt lgkmcnt(0)
 v_rcp_f32 v28, v28
 v_mfma_f32_16x16x32_bf16 v[240:243], a[80:83], a[180:183], v[240:243]
 v_rcp_f32 v29, v29
 v_mfma_f32_16x16x32_bf16 v[240:243], a[96:99], a[192:195], v[240:243]
 v_rcp_f32 v30, v30
 v_mfma_f32_16x16x32_bf16 v[240:243], a[112:115], a[196:199], v[240:243]
 v_rcp_f32 v31, v31
 v_mfma_f32_16x16x32_bf16 v[240:243], a[128:131], a[200:203], v[240:243]
 v_fma_f32 v32, v32, v28, -v28
 v_fma_f32 v33, v33, v29, -v29
 v_fma_f32 v34, v34, v30, -v30
 v_mfma_f32_16x16x32_bf16 v[240:243], a[144:147], a[164:167], v[240:243]
 v_fma_f32 v35, v35, v31, -v31
 v_cvt_pk_bf16_f32 v18, v32, v33
 v_mfma_f32_16x16x32_bf16 v[244:247], a[148:151], a[164:167], v[244:247]
 s_add_u32 s46, s40, 1024
 v_cvt_pk_bf16_f32 v19, v34, v35
 buffer_store_dwordx4 v[16:19], v6, s[12:15], s46 offen
 v_mfma_f32_16x16x32_bf16 v[244:247], a[132:135], a[200:203], v[244:247]
 v_mul_f32 v20, s42, v192
 v_mul_f32 v21, s42, v193
 v_mfma_f32_16x16x32_bf16 v[244:247], a[116:119], a[196:199], v[244:247]
 v_mul_f32 v22, s42, v194
 v_mul_f32 v23, s42, v195
 v_mfma_f32_16x16x32_bf16 v[244:247], a[100:103], a[192:195], v[244:247]
 v_min_f32 v20, s47, v20
 v_min_f32 v21, s47, v21
 v_mfma_f32_16x16x32_bf16 v[244:247], a[84:87], a[180:183], v[244:247]
 v_min_f32 v22, s47, v22
 v_min_f32 v23, s47, v23
 v_mfma_f32_16x16x32_bf16 v[248:251], a[88:91], a[180:183], v[248:251]
 v_exp_f32 v20, v20
 v_mfma_f32_16x16x32_bf16 v[248:251], a[104:107], a[192:195], v[248:251]
 v_mul_f32 v24, s43, v200
 v_mul_f32 v25, s43, v201
 v_mul_f32 v26, s43, v202
 v_mfma_f32_16x16x32_bf16 v[248:251], a[120:123], a[196:199], v[248:251]
 v_exp_f32 v21, v21
 v_mfma_f32_16x16x32_bf16 v[248:251], a[136:139], a[200:203], v[248:251]
 v_mul_f32 v27, s43, v203
 v_add_f32 v28, 1.0, v20
 v_mfma_f32_16x16x32_bf16 v[248:251], a[152:155], a[164:167], v[248:251]
 v_exp_f32 v22, v22
 v_mfma_f32_16x16x32_bf16 v[252:255], a[156:159], a[164:167], v[252:255]
 v_exp_f32 v23, v23
 v_mfma_f32_16x16x32_bf16 v[252:255], a[140:143], a[200:203], v[252:255]
 v_exp_f32 v24, v24
 v_mfma_f32_16x16x32_bf16 v[252:255], a[124:127], a[196:199], v[252:255]
 v_add_f32 v29, 1.0, v21
 v_add_f32 v30, 1.0, v22
 v_mfma_f32_16x16x32_bf16 v[252:255], a[108:111], a[192:195], v[252:255]
 v_exp_f32 v25, v25
 v_mfma_f32_16x16x32_bf16 v[252:255], a[92:95], a[180:183], v[252:255]
 v_add_f32 v31, 1.0, v23
 v_exp_f32 v26, v26
 v_mfma_f32_16x16x32_bf16 a[220:223], a[92:95], a[192:195], a[220:223]
 v_exp_f32 v27, v27
 v_mfma_f32_16x16x32_bf16 a[220:223], a[108:111], a[196:199], a[220:223]
 v_fmac_f32 v28, v28, v24
 v_fmac_f32 v29, v29, v25
 v_mfma_f32_16x16x32_bf16 a[220:223], a[124:127], a[200:203], a[220:223]
 v_fmac_f32 v30, v30, v26
 v_fmac_f32 v31, v31, v27
 v_mfma_f32_16x16x32_bf16 a[220:223], a[140:143], a[164:167], a[220:223]
 v_rcp_f32 v28, v28
 v_mfma_f32_16x16x32_bf16 a[220:223], a[156:159], a[168:171], a[220:223]
 v_rcp_f32 v29, v29
 v_mfma_f32_16x16x32_bf16 a[216:219], a[152:155], a[168:171], a[216:219]
 v_rcp_f32 v30, v30
 v_mfma_f32_16x16x32_bf16 a[216:219], a[136:139], a[164:167], a[216:219]
 v_rcp_f32 v31, v31
 v_mfma_f32_16x16x32_bf16 a[216:219], a[120:123], a[200:203], a[216:219]
 v_fma_f32 v20, v20, v28, -v28
 v_fma_f32 v21, v21, v29, -v29
 v_fma_f32 v22, v22, v30, -v30
 v_mfma_f32_16x16x32_bf16 a[216:219], a[104:107], a[196:199], a[216:219]
 v_fma_f32 v23, v23, v31, -v31
 v_cvt_pk_bf16_f32 v16, v20, v21
 v_mfma_f32_16x16x32_bf16 a[216:219], a[88:91], a[192:195], a[216:219]
 v_cvt_pk_bf16_f32 v17, v22, v23
 v_mul_f32 v32, s42, v196
 v_mfma_f32_16x16x32_bf16 a[212:215], a[84:87], a[192:195], a[212:215]
 v_mul_f32 v33, s42, v197
 v_mul_f32 v34, s42, v198
 v_mfma_f32_16x16x32_bf16 a[212:215], a[100:103], a[196:199], a[212:215]
 v_mul_f32 v35, s42, v199
 v_min_f32 v32, s47, v32
 v_mfma_f32_16x16x32_bf16 a[212:215], a[116:119], a[200:203], a[212:215]
 v_min_f32 v33, s47, v33
 v_min_f32 v34, s47, v34
 v_mfma_f32_16x16x32_bf16 a[212:215], a[132:135], a[164:167], a[212:215]
 v_min_f32 v35, s47, v35
 v_mul_f32 v40, s43, v204
 v_mfma_f32_16x16x32_bf16 a[212:215], a[148:151], a[168:171], a[212:215]
 v_exp_f32 v32, v32
 v_mfma_f32_16x16x32_bf16 a[208:211], a[144:147], a[168:171], a[208:211]
 v_mul_f32 v41, s43, v205
 v_exp_f32 v33, v33
 v_mfma_f32_16x16x32_bf16 a[208:211], a[128:131], a[164:167], a[208:211]
 v_mul_f32 v42, s43, v206
 v_mul_f32 v43, s43, v207
 v_mfma_f32_16x16x32_bf16 a[208:211], a[112:115], a[200:203], a[208:211]
 v_exp_f32 v34, v34
 v_mfma_f32_16x16x32_bf16 a[208:211], a[96:99], a[196:199], a[208:211]
 v_exp_f32 v35, v35
 v_mfma_f32_16x16x32_bf16 a[208:211], a[80:83], a[192:195], a[208:211]
 v_exp_f32 v40, v40
 v_mfma_f32_16x16x32_bf16 a[224:227], a[80:83], a[196:199], a[224:227]
 v_add_f32 v28, 1.0, v32
 v_add_f32 v29, 1.0, v33
 v_mfma_f32_16x16x32_bf16 a[224:227], a[96:99], a[200:203], a[224:227]
 v_exp_f32 v41, v41
 v_mfma_f32_16x16x32_bf16 a[224:227], a[112:115], a[164:167], a[224:227]
 v_add_f32 v30, 1.0, v34
 v_add_f32 v31, 1.0, v35
 v_mfma_f32_16x16x32_bf16 a[224:227], a[128:131], a[168:171], a[224:227]
 v_exp_f32 v42, v42
 v_fmac_f32 v28, v28, v40
 v_mfma_f32_16x16x32_bf16 a[224:227], a[144:147], a[188:191], a[224:227]
 v_exp_f32 v43, v43
 v_mfma_f32_16x16x32_bf16 a[228:231], a[148:151], a[188:191], a[228:231]
 v_fmac_f32 v29, v29, v41
 v_fmac_f32 v30, v30, v42
 v_mfma_f32_16x16x32_bf16 a[228:231], a[132:135], a[168:171], a[228:231]
 v_fmac_f32 v31, v31, v43
 v_mfma_f32_16x16x32_bf16 a[228:231], a[116:119], a[164:167], a[228:231]
 v_rcp_f32 v28, v28
 v_mfma_f32_16x16x32_bf16 a[228:231], a[100:103], a[200:203], a[228:231]
 v_rcp_f32 v29, v29
 v_mfma_f32_16x16x32_bf16 a[228:231], a[84:87], a[196:199], a[228:231]
 v_rcp_f32 v30, v30
 v_mfma_f32_16x16x32_bf16 a[232:235], a[88:91], a[196:199], a[232:235]
 v_rcp_f32 v31, v31
 v_mfma_f32_16x16x32_bf16 a[232:235], a[104:107], a[200:203], a[232:235]
 v_fma_f32 v32, v32, v28, -v28
 v_fma_f32 v33, v33, v29, -v29
 v_fma_f32 v34, v34, v30, -v30
 v_mfma_f32_16x16x32_bf16 a[232:235], a[120:123], a[164:167], a[232:235]
 v_fma_f32 v35, v35, v31, -v31
 v_cvt_pk_bf16_f32 v18, v32, v33
 v_mfma_f32_16x16x32_bf16 a[232:235], a[136:139], a[168:171], a[232:235]
 s_add_u32 s46, s40, 3072
 v_cvt_pk_bf16_f32 v19, v34, v35
 buffer_store_dwordx4 v[16:19], v6, s[12:15], s46 offen
 v_mfma_f32_16x16x32_bf16 a[232:235], a[152:155], a[188:191], a[232:235]
 v_mfma_f32_16x16x32_bf16 a[236:239], a[156:159], a[188:191], a[236:239]
 v_mfma_f32_16x16x32_bf16 a[236:239], a[140:143], a[168:171], a[236:239]
 v_mfma_f32_16x16x32_bf16 a[236:239], a[124:127], a[164:167], a[236:239]
 v_mfma_f32_16x16x32_bf16 a[236:239], a[108:111], a[200:203], a[236:239]
 v_mfma_f32_16x16x32_bf16 a[236:239], a[92:95], a[196:199], a[236:239]
 s_nop 7
 v_pk_mul_f32 v[20:21], v[208:209], s[42:43] op_sel_hi:[1,0]
 v_pk_mul_f32 v[22:23], v[210:211], s[42:43] op_sel_hi:[1,0]
 v_pk_mul_f32 v[24:25], v[216:217], s[42:43] op_sel:[0,1] op_sel_hi:[1,1]
 v_pk_mul_f32 v[26:27], v[218:219], s[42:43] op_sel:[0,1] op_sel_hi:[1,1]
 v_min_f32 v20, s47, v20
 v_min_f32 v21, s47, v21
 v_min_f32 v22, s47, v22
 v_min_f32 v23, s47, v23
 v_exp_f32 v24, v24
 v_exp_f32 v25, v25
 v_exp_f32 v26, v26
 v_exp_f32 v27, v27
 v_exp_f32 v20, v20
 v_exp_f32 v21, v21
 v_exp_f32 v22, v22
 v_exp_f32 v23, v23
 v_pk_add_f32 v[28:29], v[20:21], 1.0 op_sel_hi:[1,0]
 v_pk_add_f32 v[30:31], v[22:23], 1.0 op_sel_hi:[1,0]
 v_pk_fma_f32 v[28:29], v[28:29], v[24:25], v[28:29]
 v_pk_fma_f32 v[30:31], v[30:31], v[26:27], v[30:31]
 v_rcp_f32 v28, v28
 v_rcp_f32 v29, v29
 v_rcp_f32 v30, v30
 v_rcp_f32 v31, v31
 v_pk_fma_f32 v[20:21], v[20:21], v[28:29], v[28:29] neg_lo:[0,0,1] neg_hi:[0,0,1]
 v_pk_fma_f32 v[22:23], v[22:23], v[30:31], v[30:31] neg_lo:[0,0,1] neg_hi:[0,0,1]
 v_cvt_pk_bf16_f32 v16, v20, v21
 v_cvt_pk_bf16_f32 v17, v22, v23
 v_pk_mul_f32 v[20:21], v[212:213], s[42:43] op_sel_hi:[1,0]
 v_pk_mul_f32 v[22:23], v[214:215], s[42:43] op_sel_hi:[1,0]
 v_pk_mul_f32 v[24:25], v[220:221], s[42:43] op_sel:[0,1] op_sel_hi:[1,1]
 v_pk_mul_f32 v[26:27], v[222:223], s[42:43] op_sel:[0,1] op_sel_hi:[1,1]
 v_min_f32 v20, s47, v20
 v_min_f32 v21, s47, v21
 v_min_f32 v22, s47, v22
 v_min_f32 v23, s47, v23
 v_exp_f32 v24, v24
 v_exp_f32 v25, v25
 v_exp_f32 v26, v26
 v_exp_f32 v27, v27
 v_exp_f32 v20, v20
 v_exp_f32 v21, v21
 v_exp_f32 v22, v22
 v_exp_f32 v23, v23
 v_pk_add_f32 v[28:29], v[20:21], 1.0 op_sel_hi:[1,0]
 v_pk_add_f32 v[30:31], v[22:23], 1.0 op_sel_hi:[1,0]
 v_pk_fma_f32 v[28:29], v[28:29], v[24:25], v[28:29]
 v_pk_fma_f32 v[30:31], v[30:31], v[26:27], v[30:31]
 v_rcp_f32 v28, v28
 v_rcp_f32 v29, v29
 v_rcp_f32 v30, v30
 v_rcp_f32 v31, v31
 v_pk_fma_f32 v[20:21], v[20:21], v[28:29], v[28:29] neg_lo:[0,0,1] neg_hi:[0,0,1]
 v_pk_fma_f32 v[22:23], v[22:23], v[30:31], v[30:31] neg_lo:[0,0,1] neg_hi:[0,0,1]
 v_cvt_pk_bf16_f32 v18, v20, v21
 v_cvt_pk_bf16_f32 v19, v22, v23
 s_add_u32 s46, s40, 5120
 buffer_store_dwordx4 v[16:19], v6, s[12:15], s46 offen
 s_nop 1
 v_pk_mul_f32 v[20:21], v[224:225], s[42:43] op_sel_hi:[1,0]
 v_pk_mul_f32 v[22:23], v[226:227], s[42:43] op_sel_hi:[1,0]
 v_pk_mul_f32 v[24:25], v[232:233], s[42:43] op_sel:[0,1] op_sel_hi:[1,1]
 v_pk_mul_f32 v[26:27], v[234:235], s[42:43] op_sel:[0,1] op_sel_hi:[1,1]
 v_min_f32 v20, s47, v20
 v_min_f32 v21, s47, v21
 v_min_f32 v22, s47, v22
 v_min_f32 v23, s47, v23
 v_exp_f32 v24, v24
 v_exp_f32 v25, v25
 v_exp_f32 v26, v26
 v_exp_f32 v27, v27
 v_exp_f32 v20, v20
 v_exp_f32 v21, v21
 v_exp_f32 v22, v22
 v_exp_f32 v23, v23
 v_pk_add_f32 v[28:29], v[20:21], 1.0 op_sel_hi:[1,0]
 v_pk_add_f32 v[30:31], v[22:23], 1.0 op_sel_hi:[1,0]
 v_pk_fma_f32 v[28:29], v[28:29], v[24:25], v[28:29]
 v_pk_fma_f32 v[30:31], v[30:31], v[26:27], v[30:31]
 v_rcp_f32 v28, v28
 v_rcp_f32 v29, v29
 v_rcp_f32 v30, v30
 v_rcp_f32 v31, v31
 v_pk_fma_f32 v[20:21], v[20:21], v[28:29], v[28:29] neg_lo:[0,0,1] neg_hi:[0,0,1]
 v_pk_fma_f32 v[22:23], v[22:23], v[30:31], v[30:31] neg_lo:[0,0,1] neg_hi:[0,0,1]
 v_cvt_pk_bf16_f32 v16, v20, v21
 v_cvt_pk_bf16_f32 v17, v22, v23
 v_pk_mul_f32 v[20:21], v[228:229], s[42:43] op_sel_hi:[1,0]
 v_pk_mul_f32 v[22:23], v[230:231], s[42:43] op_sel_hi:[1,0]
 v_pk_mul_f32 v[24:25], v[236:237], s[42:43] op_sel:[0,1] op_sel_hi:[1,1]
 v_pk_mul_f32 v[26:27], v[238:239], s[42:43] op_sel:[0,1] op_sel_hi:[1,1]
 v_min_f32 v20, s47, v20
 v_min_f32 v21, s47, v21
 v_min_f32 v22, s47, v22
 v_min_f32 v23, s47, v23
 v_exp_f32 v24, v24
 v_exp_f32 v25, v25
 v_exp_f32 v26, v26
 v_exp_f32 v27, v27
 v_exp_f32 v20, v20
 v_exp_f32 v21, v21
 v_exp_f32 v22, v22
 v_exp_f32 v23, v23
 v_pk_add_f32 v[28:29], v[20:21], 1.0 op_sel_hi:[1,0]
 v_pk_add_f32 v[30:31], v[22:23], 1.0 op_sel_hi:[1,0]
 v_pk_fma_f32 v[28:29], v[28:29], v[24:25], v[28:29]
 v_pk_fma_f32 v[30:31], v[30:31], v[26:27], v[30:31]
 v_rcp_f32 v28, v28
 v_rcp_f32 v29, v29
 v_rcp_f32 v30, v30
 v_rcp_f32 v31, v31
 v_pk_fma_f32 v[20:21], v[20:21], v[28:29], v[28:29] neg_lo:[0,0,1] neg_hi:[0,0,1]
 v_pk_fma_f32 v[22:23], v[22:23], v[30:31], v[30:31] neg_lo:[0,0,1] neg_hi:[0,0,1]
 v_cvt_pk_bf16_f32 v18, v20, v21
 v_cvt_pk_bf16_f32 v19, v22, v23
 s_add_u32 s46, s40, 7168
 buffer_store_dwordx4 v[16:19], v6, s[12:15], s46 offen
 s_nop 1
 v_pk_mul_f32 v[20:21], v[240:241], s[42:43] op_sel_hi:[1,0]
 v_pk_mul_f32 v[22:23], v[242:243], s[42:43] op_sel_hi:[1,0]
 v_pk_mul_f32 v[24:25], v[248:249], s[42:43] op_sel:[0,1] op_sel_hi:[1,1]
 v_pk_mul_f32 v[26:27], v[250:251], s[42:43] op_sel:[0,1] op_sel_hi:[1,1]
 v_min_f32 v20, s47, v20
 v_min_f32 v21, s47, v21
 v_min_f32 v22, s47, v22
 v_min_f32 v23, s47, v23
 v_exp_f32 v24, v24
 v_exp_f32 v25, v25
 v_exp_f32 v26, v26
 v_exp_f32 v27, v27
 v_exp_f32 v20, v20
 v_exp_f32 v21, v21
 v_exp_f32 v22, v22
 v_exp_f32 v23, v23
 v_pk_add_f32 v[28:29], v[20:21], 1.0 op_sel_hi:[1,0]
 v_pk_add_f32 v[30:31], v[22:23], 1.0 op_sel_hi:[1,0]
 v_pk_fma_f32 v[28:29], v[28:29], v[24:25], v[28:29]
 v_pk_fma_f32 v[30:31], v[30:31], v[26:27], v[30:31]
 v_rcp_f32 v28, v28
 v_rcp_f32 v29, v29
 v_rcp_f32 v30, v30
 v_rcp_f32 v31, v31
 v_pk_fma_f32 v[20:21], v[20:21], v[28:29], v[28:29] neg_lo:[0,0,1] neg_hi:[0,0,1]
 v_pk_fma_f32 v[22:23], v[22:23], v[30:31], v[30:31] neg_lo:[0,0,1] neg_hi:[0,0,1]
 v_cvt_pk_bf16_f32 v16, v20, v21
 v_cvt_pk_bf16_f32 v17, v22, v23
 v_pk_mul_f32 v[20:21], v[244:245], s[42:43] op_sel_hi:[1,0]
 v_pk_mul_f32 v[22:23], v[246:247], s[42:43] op_sel_hi:[1,0]
 v_pk_mul_f32 v[24:25], v[252:253], s[42:43] op_sel:[0,1] op_sel_hi:[1,1]
 v_pk_mul_f32 v[26:27], v[254:255], s[42:43] op_sel:[0,1] op_sel_hi:[1,1]
 v_min_f32 v20, s47, v20
 v_min_f32 v21, s47, v21
 v_min_f32 v22, s47, v22
 v_min_f32 v23, s47, v23
 v_exp_f32 v24, v24
 v_exp_f32 v25, v25
 v_exp_f32 v26, v26
 v_exp_f32 v27, v27
 v_exp_f32 v20, v20
 v_exp_f32 v21, v21
 v_exp_f32 v22, v22
 v_exp_f32 v23, v23
 v_pk_add_f32 v[28:29], v[20:21], 1.0 op_sel_hi:[1,0]
 v_pk_add_f32 v[30:31], v[22:23], 1.0 op_sel_hi:[1,0]
 v_pk_fma_f32 v[28:29], v[28:29], v[24:25], v[28:29]
 v_pk_fma_f32 v[30:31], v[30:31], v[26:27], v[30:31]
 v_rcp_f32 v28, v28
 v_rcp_f32 v29, v29
 v_rcp_f32 v30, v30
 v_rcp_f32 v31, v31
 v_pk_fma_f32 v[20:21], v[20:21], v[28:29], v[28:29] neg_lo:[0,0,1] neg_hi:[0,0,1]
 v_pk_fma_f32 v[22:23], v[22:23], v[30:31], v[30:31] neg_lo:[0,0,1] neg_hi:[0,0,1]
 v_cvt_pk_bf16_f32 v18, v20, v21
 v_cvt_pk_bf16_f32 v19, v22, v23
 s_add_u32 s46, s40, 9216
 buffer_store_dwordx4 v[16:19], v6, s[12:15], s46 offen
 s_nop 1
 v_accvgpr_read_b32 v20, a208
 v_accvgpr_read_b32 v21, a209
 v_accvgpr_read_b32 v22, a210
 v_accvgpr_read_b32 v23, a211
 v_accvgpr_read_b32 v24, a216
 v_accvgpr_read_b32 v25, a217
 v_accvgpr_read_b32 v26, a218
 v_accvgpr_read_b32 v27, a219
 v_pk_mul_f32 v[20:21], v[20:21], s[42:43] op_sel_hi:[1,0]
 v_pk_mul_f32 v[22:23], v[22:23], s[42:43] op_sel_hi:[1,0]
 v_pk_mul_f32 v[24:25], v[24:25], s[42:43] op_sel:[0,1] op_sel_hi:[1,1]
 v_pk_mul_f32 v[26:27], v[26:27], s[42:43] op_sel:[0,1] op_sel_hi:[1,1]
 v_min_f32 v20, s47, v20
 v_min_f32 v21, s47, v21
 v_min_f32 v22, s47, v22
 v_min_f32 v23, s47, v23
 v_exp_f32 v24, v24
 v_exp_f32 v25, v25
 v_exp_f32 v26, v26
 v_exp_f32 v27, v27
 v_exp_f32 v20, v20
 v_exp_f32 v21, v21
 v_exp_f32 v22, v22
 v_exp_f32 v23, v23
 v_pk_add_f32 v[28:29], v[20:21], 1.0 op_sel_hi:[1,0]
 v_pk_add_f32 v[30:31], v[22:23], 1.0 op_sel_hi:[1,0]
 v_pk_fma_f32 v[28:29], v[28:29], v[24:25], v[28:29]
 v_pk_fma_f32 v[30:31], v[30:31], v[26:27], v[30:31]
 v_rcp_f32 v28, v28
 v_rcp_f32 v29, v29
 v_rcp_f32 v30, v30
 v_rcp_f32 v31, v31
 v_pk_fma_f32 v[20:21], v[20:21], v[28:29], v[28:29] neg_lo:[0,0,1] neg_hi:[0,0,1]
 v_pk_fma_f32 v[22:23], v[22:23], v[30:31], v[30:31] neg_lo:[0,0,1] neg_hi:[0,0,1]
 v_cvt_pk_bf16_f32 v16, v20, v21
 v_cvt_pk_bf16_f32 v17, v22, v23
 v_accvgpr_read_b32 v20, a212
 v_accvgpr_read_b32 v21, a213
 v_accvgpr_read_b32 v22, a214
 v_accvgpr_read_b32 v23, a215
 v_accvgpr_read_b32 v24, a220
 v_accvgpr_read_b32 v25, a221
 v_accvgpr_read_b32 v26, a222
 v_accvgpr_read_b32 v27, a223
 v_pk_mul_f32 v[20:21], v[20:21], s[42:43] op_sel_hi:[1,0]
 v_pk_mul_f32 v[22:23], v[22:23], s[42:43] op_sel_hi:[1,0]
 v_pk_mul_f32 v[24:25], v[24:25], s[42:43] op_sel:[0,1] op_sel_hi:[1,1]
 v_pk_mul_f32 v[26:27], v[26:27], s[42:43] op_sel:[0,1] op_sel_hi:[1,1]
 v_min_f32 v20, s47, v20
 v_min_f32 v21, s47, v21
 v_min_f32 v22, s47, v22
 v_min_f32 v23, s47, v23
 v_exp_f32 v24, v24
 v_exp_f32 v25, v25
 v_exp_f32 v26, v26
 v_exp_f32 v27, v27
 v_exp_f32 v20, v20
 v_exp_f32 v21, v21
 v_exp_f32 v22, v22
 v_exp_f32 v23, v23
 v_pk_add_f32 v[28:29], v[20:21], 1.0 op_sel_hi:[1,0]
 v_pk_add_f32 v[30:31], v[22:23], 1.0 op_sel_hi:[1,0]
 v_pk_fma_f32 v[28:29], v[28:29], v[24:25], v[28:29]
 v_pk_fma_f32 v[30:31], v[30:31], v[26:27], v[30:31]
 v_rcp_f32 v28, v28
 v_rcp_f32 v29, v29
 v_rcp_f32 v30, v30
 v_rcp_f32 v31, v31
 v_pk_fma_f32 v[20:21], v[20:21], v[28:29], v[28:29] neg_lo:[0,0,1] neg_hi:[0,0,1]
 v_pk_fma_f32 v[22:23], v[22:23], v[30:31], v[30:31] neg_lo:[0,0,1] neg_hi:[0,0,1]
 v_cvt_pk_bf16_f32 v18, v20, v21
 v_cvt_pk_bf16_f32 v19, v22, v23
 s_add_u32 s46, s40, 11264
 buffer_store_dwordx4 v[16:19], v6, s[12:15], s46 offen
 s_nop 1
 v_accvgpr_read_b32 v20, a224
 v_accvgpr_read_b32 v21, a225
 v_accvgpr_read_b32 v22, a226
 v_accvgpr_read_b32 v23, a227
 v_accvgpr_read_b32 v24, a232
 v_accvgpr_read_b32 v25, a233
 v_accvgpr_read_b32 v26, a234
 v_accvgpr_read_b32 v27, a235
 v_pk_mul_f32 v[20:21], v[20:21], s[42:43] op_sel_hi:[1,0]
 v_pk_mul_f32 v[22:23], v[22:23], s[42:43] op_sel_hi:[1,0]
 v_pk_mul_f32 v[24:25], v[24:25], s[42:43] op_sel:[0,1] op_sel_hi:[1,1]
 v_pk_mul_f32 v[26:27], v[26:27], s[42:43] op_sel:[0,1] op_sel_hi:[1,1]
 v_min_f32 v20, s47, v20
 v_min_f32 v21, s47, v21
 v_min_f32 v22, s47, v22
 v_min_f32 v23, s47, v23
 v_exp_f32 v24, v24
 v_exp_f32 v25, v25
 v_exp_f32 v26, v26
 v_exp_f32 v27, v27
 v_exp_f32 v20, v20
 v_exp_f32 v21, v21
 v_exp_f32 v22, v22
 v_exp_f32 v23, v23
 v_pk_add_f32 v[28:29], v[20:21], 1.0 op_sel_hi:[1,0]
 v_pk_add_f32 v[30:31], v[22:23], 1.0 op_sel_hi:[1,0]
 v_pk_fma_f32 v[28:29], v[28:29], v[24:25], v[28:29]
 v_pk_fma_f32 v[30:31], v[30:31], v[26:27], v[30:31]
 v_rcp_f32 v28, v28
 v_rcp_f32 v29, v29
 v_rcp_f32 v30, v30
 v_rcp_f32 v31, v31
 v_pk_fma_f32 v[20:21], v[20:21], v[28:29], v[28:29] neg_lo:[0,0,1] neg_hi:[0,0,1]
 v_pk_fma_f32 v[22:23], v[22:23], v[30:31], v[30:31] neg_lo:[0,0,1] neg_hi:[0,0,1]
 v_cvt_pk_bf16_f32 v16, v20, v21
 v_cvt_pk_bf16_f32 v17, v22, v23
 v_accvgpr_read_b32 v20, a228
 v_accvgpr_read_b32 v21, a229
 v_accvgpr_read_b32 v22, a230
 v_accvgpr_read_b32 v23, a231
 v_accvgpr_read_b32 v24, a236
 v_accvgpr_read_b32 v25, a237
 v_accvgpr_read_b32 v26, a238
 v_accvgpr_read_b32 v27, a239
 v_pk_mul_f32 v[20:21], v[20:21], s[42:43] op_sel_hi:[1,0]
 v_pk_mul_f32 v[22:23], v[22:23], s[42:43] op_sel_hi:[1,0]
 v_pk_mul_f32 v[24:25], v[24:25], s[42:43] op_sel:[0,1] op_sel_hi:[1,1]
 v_pk_mul_f32 v[26:27], v[26:27], s[42:43] op_sel:[0,1] op_sel_hi:[1,1]
 v_min_f32 v20, s47, v20
 v_min_f32 v21, s47, v21
 v_min_f32 v22, s47, v22
 v_min_f32 v23, s47, v23
 v_exp_f32 v24, v24
 v_exp_f32 v25, v25
 v_exp_f32 v26, v26
 v_exp_f32 v27, v27
 v_exp_f32 v20, v20
 v_exp_f32 v21, v21
 v_exp_f32 v22, v22
 v_exp_f32 v23, v23
 v_pk_add_f32 v[28:29], v[20:21], 1.0 op_sel_hi:[1,0]
 v_pk_add_f32 v[30:31], v[22:23], 1.0 op_sel_hi:[1,0]
 v_pk_fma_f32 v[28:29], v[28:29], v[24:25], v[28:29]
 v_pk_fma_f32 v[30:31], v[30:31], v[26:27], v[30:31]
 v_rcp_f32 v28, v28
 v_rcp_f32 v29, v29
 v_rcp_f32 v30, v30
 v_rcp_f32 v31, v31
 v_pk_fma_f32 v[20:21], v[20:21], v[28:29], v[28:29] neg_lo:[0,0,1] neg_hi:[0,0,1]
 v_pk_fma_f32 v[22:23], v[22:23], v[30:31], v[30:31] neg_lo:[0,0,1] neg_hi:[0,0,1]
 v_cvt_pk_bf16_f32 v18, v20, v21
 v_cvt_pk_bf16_f32 v19, v22, v23
 s_add_u32 s46, s40, 13312
 buffer_store_dwordx4 v[16:19], v6, s[12:15], s46 offen
 s_nop 1
 s_waitcnt vmcnt(0) lgkmcnt(0)
 s_endpgm
L_e14:
L_done:
 s_endpgm
.section .rodata,"a"
.p2align 6
.amdhsa_kernel standalone__autoregressive_conv_wavernn__speech_kernel
  .amdhsa_next_free_vgpr 512
  .amdhsa_next_free_sgpr 100
  .amdhsa_accum_offset 256
  .amdhsa_group_segment_fixed_size 0
  .amdhsa_kernarg_size 40
  .amdhsa_user_sgpr_count 2
  .amdhsa_user_sgpr_kernarg_segment_ptr 1
  .amdhsa_system_sgpr_workgroup_id_x 1
.end_amdhsa_kernel
```
